```python
import torch

def _softmax(x, axis=-1):
    return torch.softmax(x, dim=axis)

def _gelu(x):
    return torch.nn.functional.gelu(x, approximate='tanh')

def _silu(x):
    return torch.nn.functional.silu(x)

def _sigmoid(x):
    return torch.sigmoid(x)

def _layernorm(x, axis=-1, eps=1e-05):
    m = x.mean(dim=axis, keepdim=True)
    v = x.var(dim=axis, keepdim=True, unbiased=False)
    return (x - m) / torch.sqrt(v + eps)

def _scatter_add(tgt, idx, src, axis=0):
    return tgt.clone().index_add_(axis, idx, src)

def _segment_sum(src, seg, n):
    out = torch.zeros((n,) + src.shape[1:], dtype=src.dtype)
    return out.index_add_(0, seg, src)

def _pad(x, pw):
    flat = tuple((v for pair in reversed(pw) for v in pair))
    return torch.nn.functional.pad(x, flat)
kernel_name = 'concat_heads__sliding_local_dilated__memory_aug_recurrent_mem_tr__prompt'

def setup_inputs():

    _w = lambda a: (lambda t: t.to(torch.bfloat16) if t.is_floating_point() else t)(torch.as_tensor(a))

    def _A_setup():
        B, S, D = (1, 2048, 640)
        return {'x': _w((lambda *s: torch.randn(*s, dtype=torch.bfloat16) * 0.2)(B, S, D)), 'wqkv': _w((lambda *s: torch.randn(*s, dtype=torch.bfloat16) * 0.2)(D, 3 * D)), 'wo': _w((lambda *s: torch.randn(*s, dtype=torch.bfloat16) * 0.05)(D, D))}
    _A_in = _A_setup()

    def _B_setup():
        B, S, Dm = (1, 2048, 640)
        H, Dh = (32, 192)
        M, seg = (8, 32)
        seg = min(seg, S)
        S = S // seg * seg
        return {'x': _w((lambda *s: torch.randn(*s, dtype=torch.bfloat16) * 0.05)(B, S, Dm)), 'mem0': _w((lambda *s: torch.randn(*s, dtype=torch.bfloat16) * 1.6)(B, M, Dm)), 'Wq': _w((lambda *s: torch.randn(*s, dtype=torch.bfloat16) * 0.8)(Dm, H, Dh) * Dm ** (-0.5)), 'Wk': _w((lambda *s: torch.randn(*s, dtype=torch.bfloat16) * 0.8)(Dm, H, Dh) * Dm ** (-0.5)), 'Wv': _w((lambda *s: torch.randn(*s, dtype=torch.bfloat16) * 1.6)(Dm, H, Dh) * Dm ** (-0.5)), 'Wo': _w((lambda *s: torch.randn(*s, dtype=torch.bfloat16) * 1.6)(H, Dh, Dm) * (H * Dh) ** (-0.5)), 'seg_len': seg}
    _B_in = _B_setup()
    return {'A_x': _A_in['x'], 'A_wqkv': _A_in['wqkv'], 'A_wo': _A_in['wo'], 'B_x': _B_in['x'], 'B_mem0': _B_in['mem0'], 'B_Wq': _B_in['Wq'], 'B_Wk': _B_in['Wk'], 'B_Wv': _B_in['Wv'], 'B_Wo': _B_in['Wo'], 'B_seg_len': _B_in['seg_len']}

def reference(A_x, A_wqkv, A_wo, B_x, B_mem0, B_Wq, B_Wk, B_Wv, B_Wo, B_seg_len):

    def _A_ref(x, wqkv, wo):
        B, S, D = x.shape
        H = 32
        Dh = D // H
        W, dil = (8, 2)
        qkv = (lambda x, *d: x.permute(*d))((x @ wqkv).reshape(B, S, 3, H, Dh), 2, 0, 3, 1, 4)
        q, k, v = (qkv[0], qkv[1], qkv[2])
        scale = Dh ** (-0.5)
        pos = torch.arange(S)
        off = torch.arange(W) * dil
        idx = pos[:, None] - off[None, :]
        mask = idx >= 0
        idx_c = torch.where(mask, idx, 0).reshape(-1)
        kg = k[:, :, idx_c, :].reshape(B, H, S, W, Dh)
        vg = v[:, :, idx_c, :].reshape(B, H, S, W, Dh)
        logits = torch.einsum('bhsd,bhswd->bhsw', q, kg) * scale
        logits = torch.where(mask[None, None, :, :], logits, -1000000000.0)
        attn = _softmax(logits, axis=-1)
        o = torch.einsum('bhsw,bhswd->bhsd', attn, vg)
        return (lambda x, *d: x.permute(*d))(o, 0, 2, 1, 3).reshape(B, S, D) @ wo

    def _B_ref(x, mem0, Wq, Wk, Wv, Wo, seg_len):
        B, S, Dm = x.shape
        H, Dh = (Wq.shape[1], Wq.shape[2])
        M = mem0.shape[1]
        scale = Dh ** (-0.5)
        n_seg = S // seg_len
        L = M + seg_len
        idx = torch.arange(L)
        mask = (idx[:, None] < M) | (idx[:, None] >= idx[None, :])
        mem = mem0
        outs = []
        for s in range(n_seg):
            xs = x[:, s * seg_len:(s + 1) * seg_len, :].clone()
            h = torch.concatenate([mem, xs], axis=1)
            q = torch.einsum('btd,dhe->bhte', h, Wq)
            k = torch.einsum('btd,dhe->bhte', h, Wk)
            v = torch.einsum('btd,dhe->bhte', h, Wv)
            scores = torch.einsum('bhqe,bhke->bhqk', q, k) * scale
            scores = torch.where(mask[None, None], scores, -1000000000.0)
            p = _softmax(scores, axis=-1)
            o = torch.einsum('bhqk,bhke->bhqe', p, v)
            o = torch.einsum('bhte,hed->btd', o, Wo)
            mem = o[:, :M, :].clone()
            outs.append(o[:, M:, :])
        return torch.concatenate(outs, axis=1)
    a = _A_ref(A_x, A_wqkv, A_wo)
    b = _B_ref(B_x, B_mem0, B_Wq, B_Wk, B_Wv, B_Wo, B_seg_len)
    return torch.concatenate([a, b], axis=-1)
```

```asm
; @launch grid=(256,1,1) block=(256,1,1) lds=163840
.amdgcn_target "amdgcn-amd-amdhsa--gfx950"
.text
.globl concat_heads__sliding_local_dilated__memory_aug_recurrent_mem_tr__prompt_kernel
.p2align 8
.type concat_heads__sliding_local_dilated__memory_aug_recurrent_mem_tr__prompt_kernel,@function
concat_heads__sliding_local_dilated__memory_aug_recurrent_mem_tr__prompt_kernel:
    s_cmp_ge_u32 s2, 256
    s_cbranch_scc1 L_exit
    s_load_dwordx16 s[64:79], s[0:1], 0
    s_load_dwordx8 s[80:87], s[0:1], 64
    s_load_dwordx2 s[88:89], s[0:1], 96
    s_getreg_b32 s33, hwreg(HW_REG_XCC_ID, 0, 4)
    v_lshrrev_b32 v1, 6, v0
    v_and_b32 v0, 63, v0
    v_readfirstlane_b32 s32, v1
    s_mov_b32 s36, 0x100000
    s_mov_b32 s96, 0
    s_mov_b32 s97, 0
    s_and_b32 s90, s33, 4
    s_lshl_b32 s90, s90, 5
    s_and_b32 s91, s33, 3
    s_lshl_b32 s91, s91, 2
    s_add_u32 s90, s90, s91
    s_lshr_b32 s91, s33, 3
    s_lshl_b32 s91, s91, 4
    s_add_u32 s90, s90, s91
    v_mov_b32 v1, s90
    v_mov_b32 v2, 1
    v_mov_b32 v3, 0
    s_waitcnt lgkmcnt(0)
    s_mov_b32 s8, s86
    s_and_b32 s9, s87, 0xffff
    s_mov_b32 s10, 256
    s_mov_b32 s11, 0x20000
    s_mov_b32 s4, s88
    s_and_b32 s5, s89, 0xffff
    s_mov_b32 s6, 33554432
    s_mov_b32 s7, 0x20000
    s_mov_b32 s28, s84
    s_and_b32 s29, s85, 0xffff
    s_mov_b32 s30, 5242880
    s_mov_b32 s31, 0x20000
    s_cmp_lg_u32 s32, 0
    s_cbranch_scc1 L_norank
    s_mov_b64 exec, 1
    buffer_atomic_add v2, v1, s[8:11], 0 offen sc0 sc1
    s_waitcnt vmcnt(0)
    ds_write_b32 v3, v2
    s_waitcnt lgkmcnt(0)
    s_mov_b64 exec, -1
L_norank:
    s_barrier
    ds_read_b32 v2, v3
    s_waitcnt lgkmcnt(0)
    v_readfirstlane_b32 s35, v2
    s_mov_b32 s34, s33
    s_barrier
    s_cmp_ge_u32 s33, 8
    s_cbranch_scc1 L_norole
    s_cmp_ge_u32 s35, 32
    s_cbranch_scc1 L_norole
    s_lshl_b32 s38, s34, 21
    s_add_u32 s38, s38, 8388608
    s_cmp_lt_u32 s35, 12
    s_cbranch_scc1 L_qkv_f
    s_cmp_lt_u32 s35, 22
    s_cbranch_scc1 L_wo_f
    s_cmp_lt_u32 s35, 24
    s_cbranch_scc1 L_px_f
    s_branch L_pa_f
L_norole:
    s_cmp_lg_u32 s32, 0
    s_cbranch_scc1 L_arr_1
    s_and_b32 s90, s33, 4
    s_lshl_b32 s90, s90, 5
    s_add_u32 s90, s90, 64
    v_mov_b32 v1, s90
    v_mov_b32 v2, 1
    s_mov_b64 exec, 1
    buffer_atomic_add v2, v1, s[8:11], 0 offen sc1
    s_mov_b64 exec, -1
L_arr_1:
    v_lshlrev_b32 v1, 2, v0
L_gw_2:
    buffer_load_dword v2, v1, s[8:11], 0 offen sc1
    s_sub_u32 s36, s36, 1
    s_cbranch_scc1 L_exit
    s_waitcnt vmcnt(0)
    v_readlane_b32 s90, v2, 16
    v_readlane_b32 s91, v2, 48
    s_nop 0
    s_add_u32 s90, s90, s91
    s_cmp_lg_u32 s90, 256
    s_cbranch_scc1 L_gw_2
    v_cmp_eq_u32 s[90:91], 32, v2
    s_nop 0
    s_and_b32 s90, s90, s91
    s_and_b32 s90, s90, 15
    s_cmp_lg_u32 s90, 15
    s_cbranch_scc1 L_slow
L_exit:
    s_endpgm
L_qkv_f:
    s_mov_b32 s12, s74
    s_and_b32 s13, s75, 0xffff
    s_mov_b32 s14, 7864320
    s_mov_b32 s15, 0x20000
    s_mov_b32 s16, s76
    s_and_b32 s17, s77, 0xffff
    s_mov_b32 s18, 7864320
    s_mov_b32 s19, 0x20000
    s_mov_b32 s20, s78
    s_and_b32 s21, s79, 0xffff
    s_mov_b32 s22, 7864320
    s_mov_b32 s23, 0x20000
    s_mov_b32 s24, s70
    s_and_b32 s25, s71, 0xffff
    s_mov_b32 s26, 2621440
    s_mov_b32 s27, 0x20000
    s_mul_i32 s40, s35, 86
    s_lshr_b32 s40, s40, 8
    s_mul_i32 s90, s40, 3
    s_sub_u32 s41, s35, s90
    v_and_b32 v1, 15, v0
    v_lshrrev_b32 v2, 4, v0
    v_lshrrev_b32 v3, 3, v0
    v_and_b32 v4, 7, v0
    s_lshl_b32 s90, s32, 3
    v_add_u32 v5, s90, v3
    s_and_b32 s91, s32, 1
    s_lshl_b32 s91, s91, 2
    v_and_b32 v6, 2, v3
    v_or_b32 v6, s91, v6
    v_xor_b32 v6, v6, v4
    v_lshlrev_b32 v6, 4, v6
    v_mul_u32_u24 v7, 12288, v5
    s_lshl_b32 s92, s34, 2
    s_add_u32 s92, s92, s40
    s_mul_i32 s92, s92, 384
    s_lshl_b32 s93, s41, 7
    s_add_u32 s92, s92, s93
    v_add3_u32 v164, v6, v7, s92
    v_lshrrev_b32 v6, 1, v3
    v_or_b32 v6, s91, v6
    v_xor_b32 v6, v6, v4
    v_lshlrev_b32 v6, 4, v6
    v_mul_u32_u24 v7, 1280, v5
    v_add_u32 v10, v6, v7
    s_mul_i32 s90, s40, 3072
    s_lshl_b32 s91, s41, 10
    s_add_u32 s90, s90, s91
    s_lshl_b32 s91, s32, 8
    s_add_u32 s91, s91, s90
    v_lshl_add_u32 v21, v1, 4, s91
    v_cmp_eq_u32 vcc, 0, v2
    v_mov_b32 v9, 2146435072
    s_nop 0
    v_cndmask_b32 v21, v9, v21, vcc
    v_lshrrev_b32 v3, 2, v1
    v_lshlrev_b32 v3, 1, v3
    v_and_b32 v4, 1, v1
    v_or_b32 v3, v3, v4
    v_lshl_add_u32 v3, v2, 3, v3
    v_lshl_add_u32 v26, v3, 4, s90
    v_and_b32 v4, 2, v1
    v_cmp_ne_u32 vcc, 0, v4
    v_mov_b32 v9, 2146435072
    s_nop 0
    v_cndmask_b32 v26, v9, v26, vcc
    s_mul_i32 s90, s40, 3840
    s_mul_i32 s91, s41, 1280
    s_add_u32 s90, s90, s91
    v_lshrrev_b32 v3, 1, v2
    v_and_b32 v5, 1, v2
    v_lshlrev_b32 v6, 1, v5
    v_or_b32 v7, v6, v3
    v_lshl_add_u32 v7, v7, 4, v1
    v_lshlrev_b32 v7, 2, v7
    v_add_u32 v7, 1024, v7
    v_or_b32 v6, v6, v1
    v_lshl_add_u32 v6, v3, 4, v6
    v_lshlrev_b32 v6, 4, v6
    s_sub_u32 s91, s32, 1
    s_lshl_b32 s91, s91, 9
    v_add_u32 v6, s91, v6
    s_cmp_eq_u32 s32, 0
    s_cselect_b64 vcc, -1, 0
    v_cndmask_b32 v6, v6, v7, vcc
    v_add_u32 v25, s90, v6
    v_cmp_eq_u32 vcc, 0, v4
    v_mov_b32 v9, 2146435072
    s_nop 0
    v_cndmask_b32 v25, v9, v25, vcc
    s_and_b32 s90, s32, 1
    s_lshl_b32 s90, s90, 9
    s_lshr_b32 s91, s32, 1
    s_lshl_b32 s91, s91, 10
    s_add_u32 s90, s90, s91
    v_lshlrev_b32 v6, 4, v1
    v_lshl_add_u32 v6, v3, 8, v6
    v_add_u32 v6, s90, v6
    v_lshl_add_u32 v27, v5, 11, v6
    v_add_u32 v27, 136192, v27
    s_mul_i32 s90, s40, 12288
    s_lshl_b32 s91, s41, 11
    s_add_u32 s90, s90, s91
    v_mul_u32_u24 v7, 6144, v5
    v_add3_u32 v29, v6, v7, s90
    v_and_b32 v6, 9, v1
    v_and_b32 v7, 2, v1
    v_lshl_or_b32 v6, v7, 1, v6
    v_and_b32 v7, 4, v1
    v_lshrrev_b32 v7, 1, v7
    v_or_b32 v6, v6, v7
    v_lshlrev_b32 v6, 4, v6
    v_lshl_add_u32 v6, v2, 8, v6
    s_cmp_eq_u32 s32, 2
    s_cselect_b32 s90, 2048, 0
    s_add_u32 s90, s90, 136192
    v_add_u32 v28, s90, v6
    s_lshl_b32 s90, s40, 7
    s_lshl_b32 s91, s41, 2
    s_add_u32 s92, s91, s32
    s_lshl_b32 s92, s92, 2
    s_add_u32 s92, s92, s90
    s_add_u32 s92, s92, 151552
    v_mov_b32 v30, s92
    s_add_u32 s91, s91, s90
    s_add_u32 s91, s91, 152064
    s_cmp_eq_u32 s32, 3
    s_cselect_b32 s91, s91, 2146435072
    v_mov_b32 v31, s91
    v_cmp_eq_u32 vcc, 0, v0
    v_mov_b32 v9, 2146435072
    s_nop 0
    v_cndmask_b32 v30, v9, v30, vcc
    v_cndmask_b32 v31, v9, v31, vcc
    v_mov_b32 v36, -1
    v_mov_b32 v37, -1
    v_mov_b32 v38, -1
    v_mov_b32 v39, -1
    v_mov_b32 v32, 0
    buffer_store_dword v32, v30, s[4:7], s38 offen
    buffer_store_dword v32, v31, s[4:7], s38 offen
    s_add_u32 s90, s38, 102400
    buffer_store_dwordx4 v[36:39], v21, s[4:7], s90 offen
    s_add_u32 s90, s38, 114688
    buffer_store_dwordx4 v[36:39], v21, s[4:7], s90 offen
    s_add_u32 s90, s38, 126976
    buffer_store_dwordx4 v[36:39], v21, s[4:7], s90 offen
    s_add_u32 s90, s38, 139264
    buffer_store_dwordx4 v[36:39], v21, s[4:7], s90 offen
    s_cmp_eq_u32 s32, 3
    s_cbranch_scc1 L_i1_4
    s_cmp_eq_u32 s32, 0
    s_cbranch_scc1 L_i0_3
    s_add_u32 s90, s38, 40960
    buffer_store_dwordx4 v[36:39], v25, s[4:7], s90 offen
    s_add_u32 s90, s38, 56320
    buffer_store_dwordx4 v[36:39], v25, s[4:7], s90 offen
    s_add_u32 s90, s38, 71680
    buffer_store_dwordx4 v[36:39], v25, s[4:7], s90 offen
    s_add_u32 s90, s38, 87040
    buffer_store_dwordx4 v[36:39], v25, s[4:7], s90 offen
    s_branch L_i1_4
L_i0_3:
    s_add_u32 s90, s38, 40960
    buffer_store_dword v38, v25, s[4:7], s90 offen
    buffer_store_dword v39, v25, s[4:7], s90 offen offset:8
    s_add_u32 s90, s38, 56320
    buffer_store_dword v38, v25, s[4:7], s90 offen
    buffer_store_dword v39, v25, s[4:7], s90 offen offset:8
    s_add_u32 s90, s38, 71680
    buffer_store_dword v38, v25, s[4:7], s90 offen
    buffer_store_dword v39, v25, s[4:7], s90 offen offset:8
    s_add_u32 s90, s38, 87040
    buffer_store_dword v38, v25, s[4:7], s90 offen
    buffer_store_dword v39, v25, s[4:7], s90 offen offset:8
L_i1_4:
    s_lshl_b32 s90, s32, 10
    s_add_u32 m0, s90, 40960
    s_mov_b32 s91, 0
    buffer_load_dwordx4 v164, s[20:23], s91 offen lds
    s_add_u32 m0, m0, 4096
    s_add_u32 s91, s91, 393216
    buffer_load_dwordx4 v164, s[20:23], s91 offen lds
    s_add_u32 m0, m0, 4096
    s_add_u32 s91, s91, 393216
    buffer_load_dwordx4 v164, s[20:23], s91 offen lds
    s_add_u32 m0, m0, 4096
    s_add_u32 s91, s91, 393216
    buffer_load_dwordx4 v164, s[20:23], s91 offen lds
    s_add_u32 m0, m0, 4096
    s_add_u32 s91, s91, 393216
    buffer_load_dwordx4 v164, s[20:23], s91 offen lds
    s_add_u32 m0, m0, 4096
    s_add_u32 s91, s91, 393216
    buffer_load_dwordx4 v164, s[20:23], s91 offen lds
    s_add_u32 m0, m0, 4096
    s_add_u32 s91, s91, 393216
    buffer_load_dwordx4 v164, s[20:23], s91 offen lds
    s_add_u32 m0, m0, 4096
    s_add_u32 s91, s91, 393216
    buffer_load_dwordx4 v164, s[20:23], s91 offen lds
    s_add_u32 m0, m0, 4096
    s_add_u32 s91, s91, 393216
    buffer_load_dwordx4 v164, s[20:23], s91 offen lds
    s_add_u32 m0, m0, 4096
    s_add_u32 s91, s91, 393216
    buffer_load_dwordx4 v164, s[20:23], s91 offen lds
    s_lshl_b32 s90, s32, 10
    s_add_u32 m0, s90, 81920
    s_mov_b32 s91, 3932160
    buffer_load_dwordx4 v164, s[20:23], s91 offen lds
    s_add_u32 m0, m0, 4096
    s_add_u32 s91, s91, 393216
    buffer_load_dwordx4 v164, s[20:23], s91 offen lds
    s_add_u32 m0, m0, 4096
    s_add_u32 s91, s91, 393216
    buffer_load_dwordx4 v164, s[20:23], s91 offen lds
    s_add_u32 m0, m0, 4096
    s_add_u32 s91, s91, 393216
    buffer_load_dwordx4 v164, s[20:23], s91 offen lds
    s_add_u32 m0, m0, 4096
    s_add_u32 s91, s91, 393216
    buffer_load_dwordx4 v164, s[20:23], s91 offen lds
    s_add_u32 m0, m0, 4096
    s_add_u32 s91, s91, 393216
    buffer_load_dwordx4 v164, s[20:23], s91 offen lds
    s_add_u32 m0, m0, 4096
    s_add_u32 s91, s91, 393216
    buffer_load_dwordx4 v164, s[20:23], s91 offen lds
    s_add_u32 m0, m0, 4096
    s_add_u32 s91, s91, 393216
    buffer_load_dwordx4 v164, s[20:23], s91 offen lds
    s_add_u32 m0, m0, 4096
    s_add_u32 s91, s91, 393216
    buffer_load_dwordx4 v164, s[20:23], s91 offen lds
    s_add_u32 m0, m0, 4096
    s_add_u32 s91, s91, 393216
    buffer_load_dwordx4 v164, s[20:23], s91 offen lds
    s_lshl_b32 s90, s32, 10
    s_add_u32 m0, s90, 122880
    s_mov_b32 s91, 0
    buffer_load_dwordx4 v164, s[16:19], s91 offen lds
    s_add_u32 m0, m0, 4096
    s_add_u32 s91, s91, 393216
    buffer_load_dwordx4 v164, s[16:19], s91 offen lds
    s_add_u32 m0, m0, 4096
    s_add_u32 s91, s91, 393216
    buffer_load_dwordx4 v164, s[16:19], s91 offen lds
    s_add_u32 m0, m0, 4096
    s_add_u32 s91, s91, 393216
    buffer_load_dwordx4 v164, s[16:19], s91 offen lds
    s_add_u32 m0, m0, 4096
    s_add_u32 s91, s91, 393216
    buffer_load_dwordx4 v164, s[16:19], s91 offen lds
    s_add_u32 m0, m0, 4096
    s_add_u32 s91, s91, 393216
    buffer_load_dwordx4 v164, s[16:19], s91 offen lds
    s_add_u32 m0, m0, 4096
    s_add_u32 s91, s91, 393216
    buffer_load_dwordx4 v164, s[16:19], s91 offen lds
    s_add_u32 m0, m0, 4096
    s_add_u32 s91, s91, 393216
    buffer_load_dwordx4 v164, s[16:19], s91 offen lds
    s_add_u32 m0, m0, 4096
    s_add_u32 s91, s91, 393216
    buffer_load_dwordx4 v164, s[16:19], s91 offen lds
    s_add_u32 m0, m0, 4096
    s_add_u32 s91, s91, 393216
    buffer_load_dwordx4 v164, s[16:19], s91 offen lds
    s_mov_b32 s49, 0
    s_lshl_b32 s90, s32, 10
    s_add_u32 m0, s90, 0
    s_nop 0
    buffer_load_dwordx4 v10, s[24:27], s49 offen offset:0 lds
    s_add_u32 m0, m0, 3968
    s_nop 0
    buffer_load_dwordx4 v10, s[24:27], s49 offen offset:128 lds
    s_add_u32 m0, m0, 3968
    s_nop 0
    buffer_load_dwordx4 v10, s[24:27], s49 offen offset:256 lds
    s_add_u32 m0, m0, 3968
    s_nop 0
    buffer_load_dwordx4 v10, s[24:27], s49 offen offset:384 lds
    s_add_u32 m0, m0, 3968
    s_nop 0
    buffer_load_dwordx4 v10, s[24:27], s49 offen offset:512 lds
    s_add_u32 m0, m0, 3968
    s_nop 0
    buffer_load_dwordx4 v10, s[24:27], s49 offen offset:640 lds
    s_add_u32 m0, m0, 3968
    s_nop 0
    buffer_load_dwordx4 v10, s[24:27], s49 offen offset:768 lds
    s_add_u32 m0, m0, 3968
    s_nop 0
    buffer_load_dwordx4 v10, s[24:27], s49 offen offset:896 lds
    s_add_u32 m0, m0, 3968
    s_nop 0
    buffer_load_dwordx4 v10, s[24:27], s49 offen offset:1024 lds
    s_add_u32 m0, m0, 3968
    s_nop 0
    buffer_load_dwordx4 v10, s[24:27], s49 offen offset:1152 lds
    v_lshrrev_b32 v3, 2, v1
    v_and_b32 v4, 3, v1
    v_and_b32 v5, 1, v2
    v_lshl_add_u32 v6, v2, 3, v3
    v_lshlrev_b32 v6, 7, v6
    v_and_b32 v7, 2, v3
    v_lshl_or_b32 v7, v5, 2, v7
    v_lshrrev_b32 v8, 1, v4
    s_lshl_b32 s90, s32, 1
    v_or_b32 v8, s90, v8
    v_xor_b32 v7, v7, v8
    v_lshl_add_u32 v6, v7, 4, v6
    v_and_b32 v7, 1, v4
    v_lshl_add_u32 v6, v7, 3, v6
    v_add_u32 v165, 40960, v6
    v_add_u32 v166, 81920, v6
    v_add_u32 v167, 122880, v6
    v_xor_b32 v6, 0, v5
    v_lshl_add_u32 v6, v6, 2, v3
    v_lshl_add_u32 v6, v2, 3, v6
    v_lshlrev_b32 v6, 5, v6
    v_lshl_or_b32 v7, v5, 1, 0
    v_xor_b32 v7, v7, v4
    v_lshl_add_u32 v6, v7, 3, v6
    v_add_u32 v23, 133120, v6
    v_xor_b32 v6, 1, v5
    v_lshl_add_u32 v6, v6, 2, v3
    v_lshl_add_u32 v6, v2, 3, v6
    v_lshlrev_b32 v6, 5, v6
    v_lshl_or_b32 v7, v5, 1, 1
    v_xor_b32 v7, v7, v4
    v_lshl_add_u32 v6, v7, 3, v6
    v_add_u32 v24, 133120, v6
    v_lshrrev_b32 v6, 3, v1
    v_lshlrev_b32 v6, 2, v6
    v_xor_b32 v6, v6, v1
    v_lshlrev_b32 v6, 5, v6
    v_xor_b32 v7, v2, v3
    v_lshl_add_u32 v6, v7, 3, v6
    s_lshl_b32 s90, s32, 9
    s_add_u32 s90, s90, 133120
    v_add_u32 v22, s90, v6
    v_lshlrev_b32 v6, 6, v3
    v_and_b32 v7, 1, v1
    v_lshl_add_u32 v6, v7, 5, v6
    v_lshl_add_u32 v6, v2, 3, v6
    v_and_b32 v7, 2, v1
    v_lshl_add_u32 v6, v7, 1, v6
    s_lshl_b32 s90, s32, 8
    s_add_u32 s90, s90, 135168
    v_add_u32 v19, s90, v6
    v_lshl_add_u32 v20, v1, 3, s90
    v_cmp_ne_u32 vcc, 0, v7
    v_mov_b32 v6, 0x4444
    v_mov_b32 v8, 0xeeee
    v_cndmask_b32 v18, v6, v8, vcc
    v_lshlrev_b32 v6, 3, v1
    v_lshl_add_u32 v6, v5, 7, v6
    v_lshl_add_u32 v6, v2, 8, v6
    v_add_u32 v16, 122880, v6
    v_xor_b32 v17, 128, v16
    s_mul_i32 s90, s32, 2560
    v_lshl_add_u32 v13, v0, 4, s90
    v_lshl_add_u32 v14, v0, 2, s90
    s_add_u32 s51, s90, 122880
    v_mul_u32_u24 v6, 40, v0
    v_add_u32 v15, s51, v6
    v_lshrrev_b32 v6, 3, v1
    v_lshlrev_b32 v6, 10, v6
    v_and_b32 v7, 7, v1
    v_lshl_add_u32 v6, v7, 7, v6
    v_lshrrev_b32 v7, 1, v1
    v_xor_b32 v7, v7, v2
    v_lshl_add_u32 v11, v7, 4, v6
    v_xor_b32 v12, 64, v11
    s_waitcnt vmcnt(30)
    s_barrier
    ds_read_b64_tr_b16 a[160:161], v165 offset:0
    ds_read_b64_tr_b16 a[162:163], v165 offset:512
    ds_read_b64_tr_b16 a[164:165], v165 offset:4096
    ds_read_b64_tr_b16 a[166:167], v165 offset:4608
    ds_read_b64_tr_b16 a[168:169], v165 offset:8192
    ds_read_b64_tr_b16 a[170:171], v165 offset:8704
    ds_read_b64_tr_b16 a[172:173], v165 offset:12288
    ds_read_b64_tr_b16 a[174:175], v165 offset:12800
    ds_read_b64_tr_b16 a[176:177], v165 offset:16384
    ds_read_b64_tr_b16 a[178:179], v165 offset:16896
    ds_read_b64_tr_b16 a[180:181], v165 offset:20480
    ds_read_b64_tr_b16 a[182:183], v165 offset:20992
    ds_read_b64_tr_b16 a[184:185], v165 offset:24576
    ds_read_b64_tr_b16 a[186:187], v165 offset:25088
    ds_read_b64_tr_b16 a[188:189], v165 offset:28672
    ds_read_b64_tr_b16 a[190:191], v165 offset:29184
    ds_read_b64_tr_b16 a[192:193], v165 offset:32768
    ds_read_b64_tr_b16 a[194:195], v165 offset:33280
    ds_read_b64_tr_b16 a[196:197], v165 offset:36864
    ds_read_b64_tr_b16 a[198:199], v165 offset:37376
    s_waitcnt lgkmcnt(0)
    s_barrier
    s_lshl_b32 s90, s32, 10
    s_add_u32 m0, s90, 40960
    s_mov_b32 s91, 3932160
    buffer_load_dwordx4 v164, s[16:19], s91 offen lds
    s_add_u32 m0, m0, 4096
    s_add_u32 s91, s91, 393216
    buffer_load_dwordx4 v164, s[16:19], s91 offen lds
    s_add_u32 m0, m0, 4096
    s_add_u32 s91, s91, 393216
    buffer_load_dwordx4 v164, s[16:19], s91 offen lds
    s_add_u32 m0, m0, 4096
    s_add_u32 s91, s91, 393216
    buffer_load_dwordx4 v164, s[16:19], s91 offen lds
    s_add_u32 m0, m0, 4096
    s_add_u32 s91, s91, 393216
    buffer_load_dwordx4 v164, s[16:19], s91 offen lds
    s_add_u32 m0, m0, 4096
    s_add_u32 s91, s91, 393216
    buffer_load_dwordx4 v164, s[16:19], s91 offen lds
    s_add_u32 m0, m0, 4096
    s_add_u32 s91, s91, 393216
    buffer_load_dwordx4 v164, s[16:19], s91 offen lds
    s_add_u32 m0, m0, 4096
    s_add_u32 s91, s91, 393216
    buffer_load_dwordx4 v164, s[16:19], s91 offen lds
    s_add_u32 m0, m0, 4096
    s_add_u32 s91, s91, 393216
    buffer_load_dwordx4 v164, s[16:19], s91 offen lds
    s_add_u32 m0, m0, 4096
    s_add_u32 s91, s91, 393216
    buffer_load_dwordx4 v164, s[16:19], s91 offen lds
    s_cmp_lg_u32 s32, 0
    s_cbranch_scc1 L_arr_5
    s_and_b32 s90, s33, 4
    s_lshl_b32 s90, s90, 5
    s_add_u32 s90, s90, 64
    v_mov_b32 v1, s90
    v_mov_b32 v2, 1
    s_mov_b64 exec, 1
    buffer_atomic_add v2, v1, s[8:11], 0 offen sc1
    s_mov_b64 exec, -1
L_arr_5:
    s_waitcnt vmcnt(30)
    s_barrier
    ds_read_b64_tr_b16 a[200:201], v166 offset:0
    ds_read_b64_tr_b16 a[202:203], v166 offset:512
    ds_read_b64_tr_b16 a[204:205], v166 offset:4096
    ds_read_b64_tr_b16 a[206:207], v166 offset:4608
    ds_read_b64_tr_b16 a[208:209], v166 offset:8192
    ds_read_b64_tr_b16 a[210:211], v166 offset:8704
    ds_read_b64_tr_b16 a[212:213], v166 offset:12288
    ds_read_b64_tr_b16 a[214:215], v166 offset:12800
    ds_read_b64_tr_b16 a[216:217], v166 offset:16384
    ds_read_b64_tr_b16 a[218:219], v166 offset:16896
    ds_read_b64_tr_b16 a[220:221], v166 offset:20480
    ds_read_b64_tr_b16 a[222:223], v166 offset:20992
    ds_read_b64_tr_b16 a[224:225], v166 offset:24576
    ds_read_b64_tr_b16 a[226:227], v166 offset:25088
    ds_read_b64_tr_b16 a[228:229], v166 offset:28672
    ds_read_b64_tr_b16 a[230:231], v166 offset:29184
    ds_read_b64_tr_b16 a[232:233], v166 offset:32768
    ds_read_b64_tr_b16 a[234:235], v166 offset:33280
    ds_read_b64_tr_b16 a[236:237], v166 offset:36864
    ds_read_b64_tr_b16 a[238:239], v166 offset:37376
    s_waitcnt lgkmcnt(0)
    s_barrier
    s_lshl_b32 s90, s32, 10
    s_add_u32 m0, s90, 81920
    s_mov_b32 s91, 0
    buffer_load_dwordx4 v164, s[12:15], s91 offen lds
    s_add_u32 m0, m0, 4096
    s_add_u32 s91, s91, 393216
    buffer_load_dwordx4 v164, s[12:15], s91 offen lds
    s_add_u32 m0, m0, 4096
    s_add_u32 s91, s91, 393216
    buffer_load_dwordx4 v164, s[12:15], s91 offen lds
    s_add_u32 m0, m0, 4096
    s_add_u32 s91, s91, 393216
    buffer_load_dwordx4 v164, s[12:15], s91 offen lds
    s_add_u32 m0, m0, 4096
    s_add_u32 s91, s91, 393216
    buffer_load_dwordx4 v164, s[12:15], s91 offen lds
    s_add_u32 m0, m0, 4096
    s_add_u32 s91, s91, 393216
    buffer_load_dwordx4 v164, s[12:15], s91 offen lds
    s_add_u32 m0, m0, 4096
    s_add_u32 s91, s91, 393216
    buffer_load_dwordx4 v164, s[12:15], s91 offen lds
    s_add_u32 m0, m0, 4096
    s_add_u32 s91, s91, 393216
    buffer_load_dwordx4 v164, s[12:15], s91 offen lds
    s_add_u32 m0, m0, 4096
    s_add_u32 s91, s91, 393216
    buffer_load_dwordx4 v164, s[12:15], s91 offen lds
    s_add_u32 m0, m0, 4096
    s_add_u32 s91, s91, 393216
    buffer_load_dwordx4 v164, s[12:15], s91 offen lds
    s_waitcnt vmcnt(30)
    s_barrier
    ds_read_b64_tr_b16 a[80:81], v167 offset:0
    ds_read_b64_tr_b16 a[82:83], v167 offset:512
    ds_read_b64_tr_b16 a[84:85], v167 offset:4096
    ds_read_b64_tr_b16 a[86:87], v167 offset:4608
    ds_read_b64_tr_b16 a[88:89], v167 offset:8192
    ds_read_b64_tr_b16 a[90:91], v167 offset:8704
    ds_read_b64_tr_b16 a[92:93], v167 offset:12288
    ds_read_b64_tr_b16 a[94:95], v167 offset:12800
    ds_read_b64_tr_b16 a[96:97], v167 offset:16384
    ds_read_b64_tr_b16 a[98:99], v167 offset:16896
    ds_read_b64_tr_b16 a[100:101], v167 offset:20480
    ds_read_b64_tr_b16 a[102:103], v167 offset:20992
    ds_read_b64_tr_b16 a[104:105], v167 offset:24576
    ds_read_b64_tr_b16 a[106:107], v167 offset:25088
    ds_read_b64_tr_b16 a[108:109], v167 offset:28672
    ds_read_b64_tr_b16 a[110:111], v167 offset:29184
    ds_read_b64_tr_b16 a[112:113], v167 offset:32768
    ds_read_b64_tr_b16 a[114:115], v167 offset:33280
    ds_read_b64_tr_b16 a[116:117], v167 offset:36864
    ds_read_b64_tr_b16 a[118:119], v167 offset:37376
    s_waitcnt lgkmcnt(0)
    s_barrier
    s_lshl_b32 s90, s32, 10
    s_add_u32 m0, s90, 122880
    s_mov_b32 s91, 3932160
    buffer_load_dwordx4 v164, s[12:15], s91 offen lds
    s_add_u32 m0, m0, 4096
    s_add_u32 s91, s91, 393216
    buffer_load_dwordx4 v164, s[12:15], s91 offen lds
    s_add_u32 m0, m0, 4096
    s_add_u32 s91, s91, 393216
    buffer_load_dwordx4 v164, s[12:15], s91 offen lds
    s_add_u32 m0, m0, 4096
    s_add_u32 s91, s91, 393216
    buffer_load_dwordx4 v164, s[12:15], s91 offen lds
    s_add_u32 m0, m0, 4096
    s_add_u32 s91, s91, 393216
    buffer_load_dwordx4 v164, s[12:15], s91 offen lds
    s_add_u32 m0, m0, 4096
    s_add_u32 s91, s91, 393216
    buffer_load_dwordx4 v164, s[12:15], s91 offen lds
    s_add_u32 m0, m0, 4096
    s_add_u32 s91, s91, 393216
    buffer_load_dwordx4 v164, s[12:15], s91 offen lds
    s_add_u32 m0, m0, 4096
    s_add_u32 s91, s91, 393216
    buffer_load_dwordx4 v164, s[12:15], s91 offen lds
    s_add_u32 m0, m0, 4096
    s_add_u32 s91, s91, 393216
    buffer_load_dwordx4 v164, s[12:15], s91 offen lds
    s_add_u32 m0, m0, 4096
    s_add_u32 s91, s91, 393216
    buffer_load_dwordx4 v164, s[12:15], s91 offen lds
    s_waitcnt vmcnt(20)
    s_barrier
    ds_read_b64_tr_b16 a[120:121], v165 offset:0
    ds_read_b64_tr_b16 a[122:123], v165 offset:512
    ds_read_b64_tr_b16 a[124:125], v165 offset:4096
    ds_read_b64_tr_b16 a[126:127], v165 offset:4608
    ds_read_b64_tr_b16 a[128:129], v165 offset:8192
    ds_read_b64_tr_b16 a[130:131], v165 offset:8704
    ds_read_b64_tr_b16 a[132:133], v165 offset:12288
    ds_read_b64_tr_b16 a[134:135], v165 offset:12800
    ds_read_b64_tr_b16 a[136:137], v165 offset:16384
    ds_read_b64_tr_b16 a[138:139], v165 offset:16896
    ds_read_b64_tr_b16 a[140:141], v165 offset:20480
    ds_read_b64_tr_b16 a[142:143], v165 offset:20992
    ds_read_b64_tr_b16 a[144:145], v165 offset:24576
    ds_read_b64_tr_b16 a[146:147], v165 offset:25088
    ds_read_b64_tr_b16 a[148:149], v165 offset:28672
    ds_read_b64_tr_b16 a[150:151], v165 offset:29184
    ds_read_b64_tr_b16 a[152:153], v165 offset:32768
    ds_read_b64_tr_b16 a[154:155], v165 offset:33280
    ds_read_b64_tr_b16 a[156:157], v165 offset:36864
    ds_read_b64_tr_b16 a[158:159], v165 offset:37376
    s_waitcnt lgkmcnt(0)
    s_barrier
    s_mov_b32 s49, 40960
    s_lshl_b32 s90, s32, 10
    s_add_u32 m0, s90, 40960
    s_nop 0
    buffer_load_dwordx4 v10, s[24:27], s49 offen offset:0 lds
    s_add_u32 m0, m0, 3968
    s_nop 0
    buffer_load_dwordx4 v10, s[24:27], s49 offen offset:128 lds
    s_add_u32 m0, m0, 3968
    s_nop 0
    buffer_load_dwordx4 v10, s[24:27], s49 offen offset:256 lds
    s_add_u32 m0, m0, 3968
    s_nop 0
    buffer_load_dwordx4 v10, s[24:27], s49 offen offset:384 lds
    s_add_u32 m0, m0, 3968
    s_nop 0
    buffer_load_dwordx4 v10, s[24:27], s49 offen offset:512 lds
    s_add_u32 m0, m0, 3968
    s_nop 0
    buffer_load_dwordx4 v10, s[24:27], s49 offen offset:640 lds
    s_add_u32 m0, m0, 3968
    s_nop 0
    buffer_load_dwordx4 v10, s[24:27], s49 offen offset:768 lds
    s_add_u32 m0, m0, 3968
    s_nop 0
    buffer_load_dwordx4 v10, s[24:27], s49 offen offset:896 lds
    s_add_u32 m0, m0, 3968
    s_nop 0
    buffer_load_dwordx4 v10, s[24:27], s49 offen offset:1024 lds
    s_add_u32 m0, m0, 3968
    s_nop 0
    buffer_load_dwordx4 v10, s[24:27], s49 offen offset:1152 lds
    s_waitcnt vmcnt(20)
    s_barrier
    ds_read_b64_tr_b16 a[0:1], v166 offset:0
    ds_read_b64_tr_b16 a[2:3], v166 offset:512
    ds_read_b64_tr_b16 a[4:5], v166 offset:4096
    ds_read_b64_tr_b16 a[6:7], v166 offset:4608
    ds_read_b64_tr_b16 a[8:9], v166 offset:8192
    ds_read_b64_tr_b16 a[10:11], v166 offset:8704
    ds_read_b64_tr_b16 a[12:13], v166 offset:12288
    ds_read_b64_tr_b16 a[14:15], v166 offset:12800
    ds_read_b64_tr_b16 a[16:17], v166 offset:16384
    ds_read_b64_tr_b16 a[18:19], v166 offset:16896
    ds_read_b64_tr_b16 a[20:21], v166 offset:20480
    ds_read_b64_tr_b16 a[22:23], v166 offset:20992
    ds_read_b64_tr_b16 a[24:25], v166 offset:24576
    ds_read_b64_tr_b16 a[26:27], v166 offset:25088
    ds_read_b64_tr_b16 a[28:29], v166 offset:28672
    ds_read_b64_tr_b16 a[30:31], v166 offset:29184
    ds_read_b64_tr_b16 a[32:33], v166 offset:32768
    ds_read_b64_tr_b16 a[34:35], v166 offset:33280
    ds_read_b64_tr_b16 a[36:37], v166 offset:36864
    ds_read_b64_tr_b16 a[38:39], v166 offset:37376
    s_waitcnt lgkmcnt(0)
    s_barrier
    s_waitcnt vmcnt(10)
    s_barrier
    ds_read_b64_tr_b16 a[40:41], v167 offset:0
    ds_read_b64_tr_b16 a[42:43], v167 offset:512
    ds_read_b64_tr_b16 a[44:45], v167 offset:4096
    ds_read_b64_tr_b16 a[46:47], v167 offset:4608
    ds_read_b64_tr_b16 a[48:49], v167 offset:8192
    ds_read_b64_tr_b16 a[50:51], v167 offset:8704
    ds_read_b64_tr_b16 a[52:53], v167 offset:12288
    ds_read_b64_tr_b16 a[54:55], v167 offset:12800
    ds_read_b64_tr_b16 a[56:57], v167 offset:16384
    ds_read_b64_tr_b16 a[58:59], v167 offset:16896
    ds_read_b64_tr_b16 a[60:61], v167 offset:20480
    ds_read_b64_tr_b16 a[62:63], v167 offset:20992
    ds_read_b64_tr_b16 a[64:65], v167 offset:24576
    ds_read_b64_tr_b16 a[66:67], v167 offset:25088
    ds_read_b64_tr_b16 a[68:69], v167 offset:28672
    ds_read_b64_tr_b16 a[70:71], v167 offset:29184
    ds_read_b64_tr_b16 a[72:73], v167 offset:32768
    ds_read_b64_tr_b16 a[74:75], v167 offset:33280
    ds_read_b64_tr_b16 a[76:77], v167 offset:36864
    ds_read_b64_tr_b16 a[78:79], v167 offset:37376
    s_waitcnt lgkmcnt(0)
    s_barrier
    s_mov_b32 s52, 40960
    s_mov_b32 s50, 40960
    s_mov_b32 s48, s38
    v_mov_b32 v34, v27
    ds_read_b128 v[116:119], v11 offset:0
    ds_read_b128 v[120:123], v11 offset:2048
    ds_read_b128 v[124:127], v12 offset:0
    ds_read_b128 v[128:131], v12 offset:2048
    ds_read_b128 v[132:135], v11 offset:4096
    ds_read_b128 v[136:139], v11 offset:6144
    s_waitcnt lgkmcnt(4)
    v_mfma_f32_16x16x32_bf16 v[140:143], a[160:163], v[116:119], 0
    v_mfma_f32_16x16x32_bf16 v[144:147], a[160:163], v[120:123], 0
    v_mfma_f32_16x16x32_bf16 v[148:151], a[80:83], v[116:119], 0
    v_mfma_f32_16x16x32_bf16 v[152:155], a[80:83], v[120:123], 0
    v_mfma_f32_16x16x32_bf16 v[156:159], a[0:3], v[116:119], 0
    v_mfma_f32_16x16x32_bf16 v[160:163], a[0:3], v[120:123], 0
    ds_read_b128 v[116:119], v12 offset:4096
    ds_read_b128 v[120:123], v12 offset:6144
    s_waitcnt lgkmcnt(4)
    v_mfma_f32_16x16x32_bf16 v[140:143], a[164:167], v[124:127], v[140:143]
    v_mfma_f32_16x16x32_bf16 v[144:147], a[164:167], v[128:131], v[144:147]
    v_mfma_f32_16x16x32_bf16 v[148:151], a[84:87], v[124:127], v[148:151]
    v_mfma_f32_16x16x32_bf16 v[152:155], a[84:87], v[128:131], v[152:155]
    v_mfma_f32_16x16x32_bf16 v[156:159], a[4:7], v[124:127], v[156:159]
    v_mfma_f32_16x16x32_bf16 v[160:163], a[4:7], v[128:131], v[160:163]
    ds_read_b128 v[124:127], v11 offset:8192
    ds_read_b128 v[128:131], v11 offset:10240
    s_waitcnt lgkmcnt(4)
    v_mfma_f32_16x16x32_bf16 v[140:143], a[168:171], v[132:135], v[140:143]
    v_mfma_f32_16x16x32_bf16 v[144:147], a[168:171], v[136:139], v[144:147]
    v_mfma_f32_16x16x32_bf16 v[148:151], a[88:91], v[132:135], v[148:151]
    v_mfma_f32_16x16x32_bf16 v[152:155], a[88:91], v[136:139], v[152:155]
    v_mfma_f32_16x16x32_bf16 v[156:159], a[8:11], v[132:135], v[156:159]
    v_mfma_f32_16x16x32_bf16 v[160:163], a[8:11], v[136:139], v[160:163]
    ds_read_b128 v[132:135], v12 offset:8192
    ds_read_b128 v[136:139], v12 offset:10240
    s_waitcnt lgkmcnt(4)
    v_mfma_f32_16x16x32_bf16 v[140:143], a[172:175], v[116:119], v[140:143]
    v_mfma_f32_16x16x32_bf16 v[144:147], a[172:175], v[120:123], v[144:147]
    v_mfma_f32_16x16x32_bf16 v[148:151], a[92:95], v[116:119], v[148:151]
    v_mfma_f32_16x16x32_bf16 v[152:155], a[92:95], v[120:123], v[152:155]
    v_mfma_f32_16x16x32_bf16 v[156:159], a[12:15], v[116:119], v[156:159]
    v_mfma_f32_16x16x32_bf16 v[160:163], a[12:15], v[120:123], v[160:163]
    ds_read_b128 v[116:119], v11 offset:12288
    ds_read_b128 v[120:123], v11 offset:14336
    s_waitcnt lgkmcnt(4)
    s_waitcnt vmcnt(0)
    buffer_store_dword v32, v30, s[4:7], s38 offen
    v_mfma_f32_16x16x32_bf16 v[140:143], a[176:179], v[124:127], v[140:143]
    v_mfma_f32_16x16x32_bf16 v[144:147], a[176:179], v[128:131], v[144:147]
    v_mfma_f32_16x16x32_bf16 v[148:151], a[96:99], v[124:127], v[148:151]
    v_mfma_f32_16x16x32_bf16 v[152:155], a[96:99], v[128:131], v[152:155]
    v_mfma_f32_16x16x32_bf16 v[156:159], a[16:19], v[124:127], v[156:159]
    v_mfma_f32_16x16x32_bf16 v[160:163], a[16:19], v[128:131], v[160:163]
    ds_read_b128 v[124:127], v12 offset:12288
    ds_read_b128 v[128:131], v12 offset:14336
    s_waitcnt lgkmcnt(4)
    v_mfma_f32_16x16x32_bf16 v[140:143], a[180:183], v[132:135], v[140:143]
    v_mfma_f32_16x16x32_bf16 v[144:147], a[180:183], v[136:139], v[144:147]
    v_mfma_f32_16x16x32_bf16 v[148:151], a[100:103], v[132:135], v[148:151]
    v_mfma_f32_16x16x32_bf16 v[152:155], a[100:103], v[136:139], v[152:155]
    v_mfma_f32_16x16x32_bf16 v[156:159], a[20:23], v[132:135], v[156:159]
    v_mfma_f32_16x16x32_bf16 v[160:163], a[20:23], v[136:139], v[160:163]
    ds_read_b128 v[132:135], v11 offset:16384
    ds_read_b128 v[136:139], v11 offset:18432
    s_waitcnt lgkmcnt(4)
    v_mfma_f32_16x16x32_bf16 v[140:143], a[184:187], v[116:119], v[140:143]
    v_mfma_f32_16x16x32_bf16 v[144:147], a[184:187], v[120:123], v[144:147]
    v_mfma_f32_16x16x32_bf16 v[148:151], a[104:107], v[116:119], v[148:151]
    v_mfma_f32_16x16x32_bf16 v[152:155], a[104:107], v[120:123], v[152:155]
    v_mfma_f32_16x16x32_bf16 v[156:159], a[24:27], v[116:119], v[156:159]
    v_mfma_f32_16x16x32_bf16 v[160:163], a[24:27], v[120:123], v[160:163]
    ds_read_b128 v[116:119], v12 offset:16384
    ds_read_b128 v[120:123], v12 offset:18432
    s_waitcnt lgkmcnt(4)
    v_mfma_f32_16x16x32_bf16 v[140:143], a[188:191], v[124:127], v[140:143]
    v_mfma_f32_16x16x32_bf16 v[144:147], a[188:191], v[128:131], v[144:147]
    v_mfma_f32_16x16x32_bf16 v[148:151], a[108:111], v[124:127], v[148:151]
    v_mfma_f32_16x16x32_bf16 v[152:155], a[108:111], v[128:131], v[152:155]
    v_mfma_f32_16x16x32_bf16 v[156:159], a[28:31], v[124:127], v[156:159]
    v_mfma_f32_16x16x32_bf16 v[160:163], a[28:31], v[128:131], v[160:163]
    ds_read_b128 v[124:127], v11 offset:20480
    ds_read_b128 v[128:131], v11 offset:22528
    s_waitcnt lgkmcnt(4)
    v_mfma_f32_16x16x32_bf16 v[140:143], a[192:195], v[132:135], v[140:143]
    v_mfma_f32_16x16x32_bf16 v[144:147], a[192:195], v[136:139], v[144:147]
    v_mfma_f32_16x16x32_bf16 v[148:151], a[112:115], v[132:135], v[148:151]
    v_mfma_f32_16x16x32_bf16 v[152:155], a[112:115], v[136:139], v[152:155]
    v_mfma_f32_16x16x32_bf16 v[156:159], a[32:35], v[132:135], v[156:159]
    v_mfma_f32_16x16x32_bf16 v[160:163], a[32:35], v[136:139], v[160:163]
    ds_read_b128 v[132:135], v12 offset:20480
    ds_read_b128 v[136:139], v12 offset:22528
    s_waitcnt lgkmcnt(4)
    v_mfma_f32_16x16x32_bf16 v[140:143], a[196:199], v[116:119], v[140:143]
    v_mfma_f32_16x16x32_bf16 v[144:147], a[196:199], v[120:123], v[144:147]
    v_mfma_f32_16x16x32_bf16 v[148:151], a[116:119], v[116:119], v[148:151]
    v_mfma_f32_16x16x32_bf16 v[152:155], a[116:119], v[120:123], v[152:155]
    v_mfma_f32_16x16x32_bf16 v[156:159], a[36:39], v[116:119], v[156:159]
    v_mfma_f32_16x16x32_bf16 v[160:163], a[36:39], v[120:123], v[160:163]
    ds_read_b128 v[116:119], v11 offset:24576
    ds_read_b128 v[120:123], v11 offset:26624
    s_waitcnt lgkmcnt(4)
    v_mfma_f32_16x16x32_bf16 v[140:143], a[200:203], v[124:127], v[140:143]
    v_mfma_f32_16x16x32_bf16 v[144:147], a[200:203], v[128:131], v[144:147]
    v_mfma_f32_16x16x32_bf16 v[148:151], a[120:123], v[124:127], v[148:151]
    v_mfma_f32_16x16x32_bf16 v[152:155], a[120:123], v[128:131], v[152:155]
    v_mfma_f32_16x16x32_bf16 v[156:159], a[40:43], v[124:127], v[156:159]
    v_mfma_f32_16x16x32_bf16 v[160:163], a[40:43], v[128:131], v[160:163]
    ds_read_b128 v[124:127], v12 offset:24576
    ds_read_b128 v[128:131], v12 offset:26624
    s_waitcnt lgkmcnt(4)
    v_mfma_f32_16x16x32_bf16 v[140:143], a[204:207], v[132:135], v[140:143]
    v_mfma_f32_16x16x32_bf16 v[144:147], a[204:207], v[136:139], v[144:147]
    v_mfma_f32_16x16x32_bf16 v[148:151], a[124:127], v[132:135], v[148:151]
    v_mfma_f32_16x16x32_bf16 v[152:155], a[124:127], v[136:139], v[152:155]
    v_mfma_f32_16x16x32_bf16 v[156:159], a[44:47], v[132:135], v[156:159]
    v_mfma_f32_16x16x32_bf16 v[160:163], a[44:47], v[136:139], v[160:163]
    ds_read_b128 v[132:135], v11 offset:28672
    ds_read_b128 v[136:139], v11 offset:30720
    s_waitcnt lgkmcnt(4)
    v_mfma_f32_16x16x32_bf16 v[140:143], a[208:211], v[116:119], v[140:143]
    v_mfma_f32_16x16x32_bf16 v[144:147], a[208:211], v[120:123], v[144:147]
    v_mfma_f32_16x16x32_bf16 v[148:151], a[128:131], v[116:119], v[148:151]
    v_mfma_f32_16x16x32_bf16 v[152:155], a[128:131], v[120:123], v[152:155]
    v_mfma_f32_16x16x32_bf16 v[156:159], a[48:51], v[116:119], v[156:159]
    v_mfma_f32_16x16x32_bf16 v[160:163], a[48:51], v[120:123], v[160:163]
    ds_read_b128 v[116:119], v12 offset:28672
    ds_read_b128 v[120:123], v12 offset:30720
    s_waitcnt lgkmcnt(4)
    v_mfma_f32_16x16x32_bf16 v[140:143], a[212:215], v[124:127], v[140:143]
    v_mfma_f32_16x16x32_bf16 v[144:147], a[212:215], v[128:131], v[144:147]
    v_mfma_f32_16x16x32_bf16 v[148:151], a[132:135], v[124:127], v[148:151]
    v_mfma_f32_16x16x32_bf16 v[152:155], a[132:135], v[128:131], v[152:155]
    v_mfma_f32_16x16x32_bf16 v[156:159], a[52:55], v[124:127], v[156:159]
    v_mfma_f32_16x16x32_bf16 v[160:163], a[52:55], v[128:131], v[160:163]
    ds_read_b128 v[124:127], v11 offset:32768
    ds_read_b128 v[128:131], v11 offset:34816
    s_waitcnt lgkmcnt(4)
    v_mfma_f32_16x16x32_bf16 v[140:143], a[216:219], v[132:135], v[140:143]
    v_mfma_f32_16x16x32_bf16 v[144:147], a[216:219], v[136:139], v[144:147]
    v_mfma_f32_16x16x32_bf16 v[148:151], a[136:139], v[132:135], v[148:151]
    v_mfma_f32_16x16x32_bf16 v[152:155], a[136:139], v[136:139], v[152:155]
    v_mfma_f32_16x16x32_bf16 v[156:159], a[56:59], v[132:135], v[156:159]
    v_mfma_f32_16x16x32_bf16 v[160:163], a[56:59], v[136:139], v[160:163]
    ds_read_b128 v[132:135], v12 offset:32768
    ds_read_b128 v[136:139], v12 offset:34816
    s_waitcnt lgkmcnt(4)
    v_mfma_f32_16x16x32_bf16 v[140:143], a[220:223], v[116:119], v[140:143]
    v_mfma_f32_16x16x32_bf16 v[144:147], a[220:223], v[120:123], v[144:147]
    v_mfma_f32_16x16x32_bf16 v[148:151], a[140:143], v[116:119], v[148:151]
    v_mfma_f32_16x16x32_bf16 v[152:155], a[140:143], v[120:123], v[152:155]
    v_mfma_f32_16x16x32_bf16 v[156:159], a[60:63], v[116:119], v[156:159]
    v_mfma_f32_16x16x32_bf16 v[160:163], a[60:63], v[120:123], v[160:163]
    ds_read_b128 v[116:119], v11 offset:36864
    ds_read_b128 v[120:123], v11 offset:38912
    s_waitcnt lgkmcnt(4)
    v_mfma_f32_16x16x32_bf16 v[140:143], a[224:227], v[124:127], v[140:143]
    v_mfma_f32_16x16x32_bf16 v[144:147], a[224:227], v[128:131], v[144:147]
    v_mfma_f32_16x16x32_bf16 v[148:151], a[144:147], v[124:127], v[148:151]
    v_mfma_f32_16x16x32_bf16 v[152:155], a[144:147], v[128:131], v[152:155]
    v_mfma_f32_16x16x32_bf16 v[156:159], a[64:67], v[124:127], v[156:159]
    v_mfma_f32_16x16x32_bf16 v[160:163], a[64:67], v[128:131], v[160:163]
    ds_read_b128 v[124:127], v12 offset:36864
    ds_read_b128 v[128:131], v12 offset:38912
    s_waitcnt lgkmcnt(4)
    v_mfma_f32_16x16x32_bf16 v[140:143], a[228:231], v[132:135], v[140:143]
    v_mfma_f32_16x16x32_bf16 v[144:147], a[228:231], v[136:139], v[144:147]
    v_mfma_f32_16x16x32_bf16 v[148:151], a[148:151], v[132:135], v[148:151]
    v_mfma_f32_16x16x32_bf16 v[152:155], a[148:151], v[136:139], v[152:155]
    v_mfma_f32_16x16x32_bf16 v[156:159], a[68:71], v[132:135], v[156:159]
    v_mfma_f32_16x16x32_bf16 v[160:163], a[68:71], v[136:139], v[160:163]
    s_waitcnt lgkmcnt(2)
    v_mfma_f32_16x16x32_bf16 v[140:143], a[232:235], v[116:119], v[140:143]
    v_mfma_f32_16x16x32_bf16 v[144:147], a[232:235], v[120:123], v[144:147]
    v_mfma_f32_16x16x32_bf16 v[148:151], a[152:155], v[116:119], v[148:151]
    v_mfma_f32_16x16x32_bf16 v[152:155], a[152:155], v[120:123], v[152:155]
    v_mfma_f32_16x16x32_bf16 v[156:159], a[72:75], v[116:119], v[156:159]
    v_mfma_f32_16x16x32_bf16 v[160:163], a[72:75], v[120:123], v[160:163]
    s_waitcnt lgkmcnt(0)
    v_mfma_f32_16x16x32_bf16 v[140:143], a[236:239], v[124:127], v[140:143]
    v_mfma_f32_16x16x32_bf16 v[144:147], a[236:239], v[128:131], v[144:147]
    v_mfma_f32_16x16x32_bf16 v[148:151], a[156:159], v[124:127], v[148:151]
    v_mfma_f32_16x16x32_bf16 v[152:155], a[156:159], v[128:131], v[152:155]
    v_mfma_f32_16x16x32_bf16 v[156:159], a[76:79], v[124:127], v[156:159]
    v_mfma_f32_16x16x32_bf16 v[160:163], a[76:79], v[128:131], v[160:163]
    s_nop 2
    v_cvt_pk_bf16_f32 v164, v140, v141
    v_cvt_pk_bf16_f32 v165, v142, v143
    v_cvt_pk_bf16_f32 v166, v144, v145
    v_cvt_pk_bf16_f32 v167, v146, v147
    s_add_u32 s90, s48, 1179648
    v_permlane16_swap_b32 v164, v166
    v_permlane16_swap_b32 v165, v167
    buffer_store_dwordx4 v[164:167], v29, s[4:7], s90 offen
    v_cvt_pk_bf16_f32 v168, v148, v149
    v_cvt_pk_bf16_f32 v169, v150, v151
    v_cvt_pk_bf16_f32 v170, v152, v153
    v_cvt_pk_bf16_f32 v171, v154, v155
    s_add_u32 s90, s48, 786432
    v_permlane16_swap_b32 v168, v170
    v_permlane16_swap_b32 v169, v171
    buffer_store_dwordx4 v[168:171], v29, s[4:7], s90 offen
    ds_write_b128 v34, v[168:171]
    v_cvt_pk_bf16_f32 v172, v156, v157
    v_cvt_pk_bf16_f32 v173, v158, v159
    v_cvt_pk_bf16_f32 v174, v160, v161
    v_cvt_pk_bf16_f32 v175, v162, v163
    s_add_u32 s90, s48, 393216
    v_permlane16_swap_b32 v172, v174
    v_permlane16_swap_b32 v173, v175
    buffer_store_dwordx4 v[172:175], v29, s[4:7], s90 offen
    v_add_u32 v11, s52, v11
    v_add_u32 v12, s52, v12
    s_sub_u32 s50, s50, s52
    s_sub_u32 s52, 0, s52
    s_barrier
    s_add_u32 s48, s38, 49152
    v_add_u32 v34, 4096, v27
    v_mov_b32 v32, 1
    s_mov_b32 s49, 81920
    ds_read_b128 v[116:119], v11 offset:0
    ds_read_b128 v[120:123], v11 offset:2048
    ds_read_b128 v[124:127], v12 offset:0
    ds_read_b128 v[128:131], v12 offset:2048
    ds_read_b128 v[132:135], v11 offset:4096
    ds_read_b128 v[136:139], v11 offset:6144
    s_waitcnt lgkmcnt(4)
    v_mfma_f32_16x16x32_bf16 v[140:143], a[160:163], v[116:119], 0
    v_mfma_f32_16x16x32_bf16 v[144:147], a[160:163], v[120:123], 0
    v_mfma_f32_16x16x32_bf16 v[148:151], a[80:83], v[116:119], 0
    v_mfma_f32_16x16x32_bf16 v[152:155], a[80:83], v[120:123], 0
    v_mfma_f32_16x16x32_bf16 v[156:159], a[0:3], v[116:119], 0
    v_mfma_f32_16x16x32_bf16 v[160:163], a[0:3], v[120:123], 0
    ds_read_b128 v[116:119], v12 offset:4096
    ds_read_b128 v[120:123], v12 offset:6144
    s_waitcnt lgkmcnt(4)
    v_mfma_f32_16x16x32_bf16 v[140:143], a[164:167], v[124:127], v[140:143]
    v_mfma_f32_16x16x32_bf16 v[144:147], a[164:167], v[128:131], v[144:147]
    v_mfma_f32_16x16x32_bf16 v[148:151], a[84:87], v[124:127], v[148:151]
    v_mfma_f32_16x16x32_bf16 v[152:155], a[84:87], v[128:131], v[152:155]
    v_mfma_f32_16x16x32_bf16 v[156:159], a[4:7], v[124:127], v[156:159]
    v_mfma_f32_16x16x32_bf16 v[160:163], a[4:7], v[128:131], v[160:163]
    ds_read_b128 v[124:127], v11 offset:8192
    ds_read_b128 v[128:131], v11 offset:10240
    s_waitcnt lgkmcnt(4)
    v_mfma_f32_16x16x32_bf16 v[140:143], a[168:171], v[132:135], v[140:143]
    v_mfma_f32_16x16x32_bf16 v[144:147], a[168:171], v[136:139], v[144:147]
    v_mfma_f32_16x16x32_bf16 v[148:151], a[88:91], v[132:135], v[148:151]
    v_mfma_f32_16x16x32_bf16 v[152:155], a[88:91], v[136:139], v[152:155]
    v_mfma_f32_16x16x32_bf16 v[156:159], a[8:11], v[132:135], v[156:159]
    v_mfma_f32_16x16x32_bf16 v[160:163], a[8:11], v[136:139], v[160:163]
    ds_read_b128 v[132:135], v12 offset:8192
    ds_read_b128 v[136:139], v12 offset:10240
    s_waitcnt lgkmcnt(4)
    v_mfma_f32_16x16x32_bf16 v[140:143], a[172:175], v[116:119], v[140:143]
    v_mfma_f32_16x16x32_bf16 v[144:147], a[172:175], v[120:123], v[144:147]
    v_mfma_f32_16x16x32_bf16 v[148:151], a[92:95], v[116:119], v[148:151]
    v_mfma_f32_16x16x32_bf16 v[152:155], a[92:95], v[120:123], v[152:155]
    v_mfma_f32_16x16x32_bf16 v[156:159], a[12:15], v[116:119], v[156:159]
    v_mfma_f32_16x16x32_bf16 v[160:163], a[12:15], v[120:123], v[160:163]
    ds_read_b128 v[116:119], v11 offset:12288
    ds_read_b128 v[120:123], v11 offset:14336
    s_waitcnt lgkmcnt(4)
    s_waitcnt vmcnt(0)
    buffer_store_dword v32, v30, s[4:7], s38 offen
    s_lshl_b32 s90, s32, 10
    s_add_u32 m0, s90, s50
    v_mfma_f32_16x16x32_bf16 v[140:143], a[176:179], v[124:127], v[140:143]
    v_mfma_f32_16x16x32_bf16 v[144:147], a[176:179], v[128:131], v[144:147]
    v_mfma_f32_16x16x32_bf16 v[148:151], a[96:99], v[124:127], v[148:151]
    v_mfma_f32_16x16x32_bf16 v[152:155], a[96:99], v[128:131], v[152:155]
    v_mfma_f32_16x16x32_bf16 v[156:159], a[16:19], v[124:127], v[156:159]
    v_mfma_f32_16x16x32_bf16 v[160:163], a[16:19], v[128:131], v[160:163]
    ds_read_b128 v[124:127], v12 offset:12288
    ds_read_b128 v[128:131], v12 offset:14336
    s_waitcnt lgkmcnt(4)
    v_mfma_f32_16x16x32_bf16 v[140:143], a[180:183], v[132:135], v[140:143]
    v_mfma_f32_16x16x32_bf16 v[144:147], a[180:183], v[136:139], v[144:147]
    buffer_load_dwordx4 v10, s[24:27], s49 offen offset:0 lds
    s_add_u32 m0, m0, 3968
    v_mfma_f32_16x16x32_bf16 v[148:151], a[100:103], v[132:135], v[148:151]
    v_mfma_f32_16x16x32_bf16 v[152:155], a[100:103], v[136:139], v[152:155]
    v_mfma_f32_16x16x32_bf16 v[156:159], a[20:23], v[132:135], v[156:159]
    v_mfma_f32_16x16x32_bf16 v[160:163], a[20:23], v[136:139], v[160:163]
    ds_read_b128 v[132:135], v11 offset:16384
    ds_read_b128 v[136:139], v11 offset:18432
    s_waitcnt lgkmcnt(4)
    v_mfma_f32_16x16x32_bf16 v[140:143], a[184:187], v[116:119], v[140:143]
    v_mfma_f32_16x16x32_bf16 v[144:147], a[184:187], v[120:123], v[144:147]
    buffer_load_dwordx4 v10, s[24:27], s49 offen offset:128 lds
    s_add_u32 m0, m0, 3968
    v_mfma_f32_16x16x32_bf16 v[148:151], a[104:107], v[116:119], v[148:151]
    v_mfma_f32_16x16x32_bf16 v[152:155], a[104:107], v[120:123], v[152:155]
    v_mfma_f32_16x16x32_bf16 v[156:159], a[24:27], v[116:119], v[156:159]
    v_mfma_f32_16x16x32_bf16 v[160:163], a[24:27], v[120:123], v[160:163]
    ds_read_b128 v[116:119], v12 offset:16384
    ds_read_b128 v[120:123], v12 offset:18432
    s_waitcnt lgkmcnt(4)
    v_mfma_f32_16x16x32_bf16 v[140:143], a[188:191], v[124:127], v[140:143]
    v_mfma_f32_16x16x32_bf16 v[144:147], a[188:191], v[128:131], v[144:147]
    buffer_load_dwordx4 v10, s[24:27], s49 offen offset:256 lds
    s_add_u32 m0, m0, 3968
    v_mfma_f32_16x16x32_bf16 v[148:151], a[108:111], v[124:127], v[148:151]
    v_mfma_f32_16x16x32_bf16 v[152:155], a[108:111], v[128:131], v[152:155]
    v_mfma_f32_16x16x32_bf16 v[156:159], a[28:31], v[124:127], v[156:159]
    v_mfma_f32_16x16x32_bf16 v[160:163], a[28:31], v[128:131], v[160:163]
    ds_read_b128 v[124:127], v11 offset:20480
    ds_read_b128 v[128:131], v11 offset:22528
    s_waitcnt lgkmcnt(4)
    v_mfma_f32_16x16x32_bf16 v[140:143], a[192:195], v[132:135], v[140:143]
    v_mfma_f32_16x16x32_bf16 v[144:147], a[192:195], v[136:139], v[144:147]
    buffer_load_dwordx4 v10, s[24:27], s49 offen offset:384 lds
    s_add_u32 m0, m0, 3968
    v_mfma_f32_16x16x32_bf16 v[148:151], a[112:115], v[132:135], v[148:151]
    v_mfma_f32_16x16x32_bf16 v[152:155], a[112:115], v[136:139], v[152:155]
    v_mfma_f32_16x16x32_bf16 v[156:159], a[32:35], v[132:135], v[156:159]
    v_mfma_f32_16x16x32_bf16 v[160:163], a[32:35], v[136:139], v[160:163]
    ds_read_b128 v[132:135], v12 offset:20480
    ds_read_b128 v[136:139], v12 offset:22528
    s_waitcnt lgkmcnt(4)
    v_mfma_f32_16x16x32_bf16 v[140:143], a[196:199], v[116:119], v[140:143]
    v_mfma_f32_16x16x32_bf16 v[144:147], a[196:199], v[120:123], v[144:147]
    buffer_load_dwordx4 v10, s[24:27], s49 offen offset:512 lds
    s_add_u32 m0, m0, 3968
    v_mfma_f32_16x16x32_bf16 v[148:151], a[116:119], v[116:119], v[148:151]
    v_mfma_f32_16x16x32_bf16 v[152:155], a[116:119], v[120:123], v[152:155]
    v_mfma_f32_16x16x32_bf16 v[156:159], a[36:39], v[116:119], v[156:159]
    v_mfma_f32_16x16x32_bf16 v[160:163], a[36:39], v[120:123], v[160:163]
    ds_read_b128 v[116:119], v11 offset:24576
    ds_read_b128 v[120:123], v11 offset:26624
    s_waitcnt lgkmcnt(4)
    v_mfma_f32_16x16x32_bf16 v[140:143], a[200:203], v[124:127], v[140:143]
    v_mfma_f32_16x16x32_bf16 v[144:147], a[200:203], v[128:131], v[144:147]
    buffer_load_dwordx4 v10, s[24:27], s49 offen offset:640 lds
    s_add_u32 m0, m0, 3968
    v_mfma_f32_16x16x32_bf16 v[148:151], a[120:123], v[124:127], v[148:151]
    v_mfma_f32_16x16x32_bf16 v[152:155], a[120:123], v[128:131], v[152:155]
    v_mfma_f32_16x16x32_bf16 v[156:159], a[40:43], v[124:127], v[156:159]
    v_mfma_f32_16x16x32_bf16 v[160:163], a[40:43], v[128:131], v[160:163]
    ds_read_b128 v[124:127], v12 offset:24576
    ds_read_b128 v[128:131], v12 offset:26624
    s_waitcnt lgkmcnt(4)
    v_mfma_f32_16x16x32_bf16 v[140:143], a[204:207], v[132:135], v[140:143]
    v_mfma_f32_16x16x32_bf16 v[144:147], a[204:207], v[136:139], v[144:147]
    buffer_load_dwordx4 v10, s[24:27], s49 offen offset:768 lds
    s_add_u32 m0, m0, 3968
    v_mfma_f32_16x16x32_bf16 v[148:151], a[124:127], v[132:135], v[148:151]
    v_mfma_f32_16x16x32_bf16 v[152:155], a[124:127], v[136:139], v[152:155]
    v_mfma_f32_16x16x32_bf16 v[156:159], a[44:47], v[132:135], v[156:159]
    v_mfma_f32_16x16x32_bf16 v[160:163], a[44:47], v[136:139], v[160:163]
    ds_read_b128 v[132:135], v11 offset:28672
    ds_read_b128 v[136:139], v11 offset:30720
    s_waitcnt lgkmcnt(4)
    v_mfma_f32_16x16x32_bf16 v[140:143], a[208:211], v[116:119], v[140:143]
    v_mfma_f32_16x16x32_bf16 v[144:147], a[208:211], v[120:123], v[144:147]
    buffer_load_dwordx4 v10, s[24:27], s49 offen offset:896 lds
    s_add_u32 m0, m0, 3968
    v_mfma_f32_16x16x32_bf16 v[148:151], a[128:131], v[116:119], v[148:151]
    v_mfma_f32_16x16x32_bf16 v[152:155], a[128:131], v[120:123], v[152:155]
    v_mfma_f32_16x16x32_bf16 v[156:159], a[48:51], v[116:119], v[156:159]
    v_mfma_f32_16x16x32_bf16 v[160:163], a[48:51], v[120:123], v[160:163]
    ds_read_b128 v[116:119], v12 offset:28672
    ds_read_b128 v[120:123], v12 offset:30720
    s_waitcnt lgkmcnt(4)
    v_mfma_f32_16x16x32_bf16 v[140:143], a[212:215], v[124:127], v[140:143]
    v_mfma_f32_16x16x32_bf16 v[144:147], a[212:215], v[128:131], v[144:147]
    buffer_load_dwordx4 v10, s[24:27], s49 offen offset:1024 lds
    s_add_u32 m0, m0, 3968
    v_mfma_f32_16x16x32_bf16 v[148:151], a[132:135], v[124:127], v[148:151]
    v_mfma_f32_16x16x32_bf16 v[152:155], a[132:135], v[128:131], v[152:155]
    v_mfma_f32_16x16x32_bf16 v[156:159], a[52:55], v[124:127], v[156:159]
    v_mfma_f32_16x16x32_bf16 v[160:163], a[52:55], v[128:131], v[160:163]
    ds_read_b128 v[124:127], v11 offset:32768
    ds_read_b128 v[128:131], v11 offset:34816
    s_waitcnt lgkmcnt(4)
    v_mfma_f32_16x16x32_bf16 v[140:143], a[216:219], v[132:135], v[140:143]
    v_mfma_f32_16x16x32_bf16 v[144:147], a[216:219], v[136:139], v[144:147]
    buffer_load_dwordx4 v10, s[24:27], s49 offen offset:1152 lds
    v_mfma_f32_16x16x32_bf16 v[148:151], a[136:139], v[132:135], v[148:151]
    v_mfma_f32_16x16x32_bf16 v[152:155], a[136:139], v[136:139], v[152:155]
    v_mfma_f32_16x16x32_bf16 v[156:159], a[56:59], v[132:135], v[156:159]
    v_mfma_f32_16x16x32_bf16 v[160:163], a[56:59], v[136:139], v[160:163]
    ds_read_b128 v[132:135], v12 offset:32768
    ds_read_b128 v[136:139], v12 offset:34816
    s_waitcnt lgkmcnt(4)
    v_mfma_f32_16x16x32_bf16 v[140:143], a[220:223], v[116:119], v[140:143]
    v_mfma_f32_16x16x32_bf16 v[144:147], a[220:223], v[120:123], v[144:147]
    v_mfma_f32_16x16x32_bf16 v[148:151], a[140:143], v[116:119], v[148:151]
    v_mfma_f32_16x16x32_bf16 v[152:155], a[140:143], v[120:123], v[152:155]
    v_mfma_f32_16x16x32_bf16 v[156:159], a[60:63], v[116:119], v[156:159]
    v_mfma_f32_16x16x32_bf16 v[160:163], a[60:63], v[120:123], v[160:163]
    ds_read_b128 v[116:119], v11 offset:36864
    ds_read_b128 v[120:123], v11 offset:38912
    s_waitcnt lgkmcnt(4)
    v_mfma_f32_16x16x32_bf16 v[140:143], a[224:227], v[124:127], v[140:143]
    v_mfma_f32_16x16x32_bf16 v[144:147], a[224:227], v[128:131], v[144:147]
    v_mfma_f32_16x16x32_bf16 v[148:151], a[144:147], v[124:127], v[148:151]
    v_mfma_f32_16x16x32_bf16 v[152:155], a[144:147], v[128:131], v[152:155]
    v_mfma_f32_16x16x32_bf16 v[156:159], a[64:67], v[124:127], v[156:159]
    v_mfma_f32_16x16x32_bf16 v[160:163], a[64:67], v[128:131], v[160:163]
    ds_read_b128 v[124:127], v12 offset:36864
    ds_read_b128 v[128:131], v12 offset:38912
    s_waitcnt lgkmcnt(4)
    v_mfma_f32_16x16x32_bf16 v[140:143], a[228:231], v[132:135], v[140:143]
    v_mfma_f32_16x16x32_bf16 v[144:147], a[228:231], v[136:139], v[144:147]
    v_mfma_f32_16x16x32_bf16 v[148:151], a[148:151], v[132:135], v[148:151]
    v_mfma_f32_16x16x32_bf16 v[152:155], a[148:151], v[136:139], v[152:155]
    v_mfma_f32_16x16x32_bf16 v[156:159], a[68:71], v[132:135], v[156:159]
    v_mfma_f32_16x16x32_bf16 v[160:163], a[68:71], v[136:139], v[160:163]
    s_waitcnt lgkmcnt(2)
    v_mfma_f32_16x16x32_bf16 v[140:143], a[232:235], v[116:119], v[140:143]
    v_mfma_f32_16x16x32_bf16 v[144:147], a[232:235], v[120:123], v[144:147]
    v_mfma_f32_16x16x32_bf16 v[148:151], a[152:155], v[116:119], v[148:151]
    v_mfma_f32_16x16x32_bf16 v[152:155], a[152:155], v[120:123], v[152:155]
    v_mfma_f32_16x16x32_bf16 v[156:159], a[72:75], v[116:119], v[156:159]
    v_mfma_f32_16x16x32_bf16 v[160:163], a[72:75], v[120:123], v[160:163]
    s_waitcnt lgkmcnt(0)
    v_mfma_f32_16x16x32_bf16 v[140:143], a[236:239], v[124:127], v[140:143]
    v_mfma_f32_16x16x32_bf16 v[144:147], a[236:239], v[128:131], v[144:147]
    v_mfma_f32_16x16x32_bf16 v[148:151], a[156:159], v[124:127], v[148:151]
    v_mfma_f32_16x16x32_bf16 v[152:155], a[156:159], v[128:131], v[152:155]
    v_mfma_f32_16x16x32_bf16 v[156:159], a[76:79], v[124:127], v[156:159]
    v_mfma_f32_16x16x32_bf16 v[160:163], a[76:79], v[128:131], v[160:163]
    s_nop 2
    v_cvt_pk_bf16_f32 v164, v140, v141
    v_cvt_pk_bf16_f32 v165, v142, v143
    v_cvt_pk_bf16_f32 v166, v144, v145
    v_cvt_pk_bf16_f32 v167, v146, v147
    s_add_u32 s90, s48, 1179648
    v_permlane16_swap_b32 v164, v166
    v_permlane16_swap_b32 v165, v167
    buffer_store_dwordx4 v[164:167], v29, s[4:7], s90 offen
    v_cvt_pk_bf16_f32 v168, v148, v149
    v_cvt_pk_bf16_f32 v169, v150, v151
    v_cvt_pk_bf16_f32 v170, v152, v153
    v_cvt_pk_bf16_f32 v171, v154, v155
    s_add_u32 s90, s48, 786432
    v_permlane16_swap_b32 v168, v170
    v_permlane16_swap_b32 v169, v171
    buffer_store_dwordx4 v[168:171], v29, s[4:7], s90 offen
    ds_write_b128 v34, v[168:171]
    v_cvt_pk_bf16_f32 v172, v156, v157
    v_cvt_pk_bf16_f32 v173, v158, v159
    v_cvt_pk_bf16_f32 v174, v160, v161
    v_cvt_pk_bf16_f32 v175, v162, v163
    s_add_u32 s90, s48, 393216
    v_permlane16_swap_b32 v172, v174
    v_permlane16_swap_b32 v173, v175
    buffer_store_dwordx4 v[172:175], v29, s[4:7], s90 offen
    v_add_u32 v11, s52, v11
    v_add_u32 v12, s52, v12
    s_sub_u32 s50, s50, s52
    s_sub_u32 s52, 0, s52
    s_waitcnt lgkmcnt(0)
    s_barrier
    v_lshlrev_b32 v1, 2, v0
L_gw_6:
    buffer_load_dword v2, v1, s[8:11], 0 offen sc1
    s_sub_u32 s36, s36, 1
    s_cbranch_scc1 L_exit
    s_waitcnt vmcnt(0)
    v_readlane_b32 s90, v2, 16
    v_readlane_b32 s91, v2, 48
    s_nop 0
    s_add_u32 s90, s90, s91
    s_cmp_lg_u32 s90, 256
    s_cbranch_scc1 L_gw_6
    v_cmp_eq_u32 s[90:91], 32, v2
    s_nop 0
    s_and_b32 s90, s90, s91
    s_and_b32 s90, s90, 15
    s_cmp_lg_u32 s90, 15
    s_cbranch_scc1 L_slow
    s_mov_b32 s37, 0
L_qkv_loop_f:
    s_and_b32 s90, s37, 3
    s_lshl_b32 s91, s90, 12
    v_add_u32 v35, s91, v28
    s_xor_b32 s91, s91, 8192
    v_add_u32 v34, s91, v27
    s_mul_i32 s91, s90, 10240
    s_add_u32 s42, s38, s91
    s_mov_b32 m0, s51
    ds_read_b128 v[100:103], v35
    ds_read_b128 v[104:107], v35 offset:1024
    buffer_load_dwordx4 v13, s[4:7], s42 offen sc1 lds
    buffer_load_dwordx4 v13, s[4:7], s42 offen offset:1024 sc1 lds
    buffer_load_dword v14, s[4:7], s42 offen offset:2048 sc1 lds
    buffer_load_dword v14, s[4:7], s42 offen offset:2304 sc1 lds
    s_mul_i32 s91, s90, 15360
    s_add_u32 s91, s91, 40960
    s_add_u32 s43, s38, s91
    s_mul_i32 s91, s90, 12288
    s_add_u32 s91, s91, 102400
    s_add_u32 s44, s38, s91
    s_add_u32 s90, s37, 3
    s_min_u32 s92, s90, 63
    s_mul_i32 s49, s92, 40960
    s_and_b32 s90, s90, 3
    s_mul_i32 s91, s90, 15360
    s_add_u32 s91, s91, 40960
    s_add_u32 s45, s38, s91
    s_mul_i32 s91, s90, 12288
    s_add_u32 s91, s91, 102400
    s_add_u32 s46, s38, s91
    s_and_b32 s90, s37, 7
    s_mul_i32 s91, s90, 12288
    s_add_u32 s91, s91, 155648
    s_add_u32 s47, s38, s91
    s_add_u32 s90, s37, 2
    v_mov_b32 v32, s90
    s_and_b32 s90, s90, 7
    s_mul_i32 s91, s90, 49152
    s_add_u32 s48, s38, s91
    v_mov_b32 v80, 0
    v_mov_b32 v81, 0
    v_mov_b32 v82, 0
    v_mov_b32 v83, 0
    v_mov_b32 v84, 0
    v_mov_b32 v85, 0
    v_mov_b32 v86, 0
    v_mov_b32 v87, 0
    v_mov_b32 v88, 0
    v_mov_b32 v89, 0
    v_mov_b32 v90, 0
    v_mov_b32 v91, 0
    s_waitcnt vmcnt(0)
    ds_read_b32 v33, v15
    buffer_store_dword v32, v30, s[4:7], s38 offen
    s_add_u32 s90, s37, 1
    s_waitcnt lgkmcnt(0)
    v_cmp_eq_u32 vcc, -1, v33
    v_mov_b32 v32, s90
    s_cbranch_vccz L_got_7
L_poll_8:
    buffer_load_dwordx4 v13, s[4:7], s42 offen sc1 lds
    buffer_load_dwordx4 v13, s[4:7], s42 offen offset:1024 sc1 lds
    buffer_load_dword v14, s[4:7], s42 offen offset:2048 sc1 lds
    buffer_load_dword v14, s[4:7], s42 offen offset:2304 sc1 lds
    s_sub_u32 s36, s36, 1
    s_cbranch_scc1 L_exit
    s_waitcnt vmcnt(0)
    ds_read_b32 v33, v15
    s_waitcnt lgkmcnt(0)
    v_cmp_eq_u32 vcc, -1, v33
    s_cbranch_vccnz L_poll_8
L_got_7:
    s_barrier
    ds_read_b64_tr_b16 v[40:41], v16 offset:0
    ds_read_b64_tr_b16 v[42:43], v17 offset:0
    ds_read_b64_tr_b16 v[44:45], v16 offset:1024
    ds_read_b64_tr_b16 v[46:47], v17 offset:1024
    ds_read_b64_tr_b16 v[48:49], v16 offset:2048
    ds_read_b64_tr_b16 v[50:51], v17 offset:2048
    ds_read_b64_tr_b16 v[52:53], v16 offset:3072
    ds_read_b64_tr_b16 v[54:55], v17 offset:3072
    ds_read_b64_tr_b16 v[56:57], v16 offset:4096
    ds_read_b64_tr_b16 v[58:59], v17 offset:4096
    ds_read_b64_tr_b16 v[60:61], v16 offset:5120
    ds_read_b64_tr_b16 v[62:63], v17 offset:5120
    ds_read_b64_tr_b16 v[64:65], v16 offset:6144
    ds_read_b64_tr_b16 v[66:67], v17 offset:6144
    s_waitcnt lgkmcnt(12)
    v_smfmac_f32_16x16x64_bf16 v[80:83], v[40:43], a[160:167], v18
    ds_read_b64_tr_b16 v[68:69], v16 offset:7168
    ds_read_b64_tr_b16 v[70:71], v17 offset:7168
    s_waitcnt lgkmcnt(12)
    v_smfmac_f32_16x16x64_bf16 v[80:83], v[44:47], a[168:175], v18
    ds_read_b64_tr_b16 v[72:73], v16 offset:8192
    ds_read_b64_tr_b16 v[74:75], v17 offset:8192
    s_waitcnt lgkmcnt(12)
    v_smfmac_f32_16x16x64_bf16 v[80:83], v[48:51], a[176:183], v18
    ds_read_b64_tr_b16 v[76:77], v16 offset:9216
    ds_read_b64_tr_b16 v[78:79], v17 offset:9216
    s_waitcnt lgkmcnt(12)
    v_smfmac_f32_16x16x64_bf16 v[80:83], v[52:55], a[184:191], v18
    s_waitcnt lgkmcnt(10)
    v_smfmac_f32_16x16x64_bf16 v[80:83], v[56:59], a[192:199], v18
    s_waitcnt lgkmcnt(8)
    v_smfmac_f32_16x16x64_bf16 v[80:83], v[60:63], a[200:207], v18
    s_waitcnt lgkmcnt(6)
    v_smfmac_f32_16x16x64_bf16 v[80:83], v[64:67], a[208:215], v18
    s_waitcnt lgkmcnt(4)
    v_smfmac_f32_16x16x64_bf16 v[80:83], v[68:71], a[216:223], v18
    s_waitcnt lgkmcnt(2)
    v_smfmac_f32_16x16x64_bf16 v[80:83], v[72:75], a[224:231], v18
    s_waitcnt lgkmcnt(0)
    v_smfmac_f32_16x16x64_bf16 v[80:83], v[76:79], a[232:239], v18
    v_smfmac_f32_16x16x64_bf16 v[84:87], v[40:43], a[0:7], v18
    v_smfmac_f32_16x16x64_bf16 v[88:91], v[40:43], a[80:87], v18
    v_smfmac_f32_16x16x64_bf16 v[84:87], v[44:47], a[8:15], v18
    v_smfmac_f32_16x16x64_bf16 v[88:91], v[44:47], a[88:95], v18
    v_smfmac_f32_16x16x64_bf16 v[84:87], v[48:51], a[16:23], v18
    v_smfmac_f32_16x16x64_bf16 v[88:91], v[48:51], a[96:103], v18
    v_smfmac_f32_16x16x64_bf16 v[84:87], v[52:55], a[24:31], v18
    v_smfmac_f32_16x16x64_bf16 v[88:91], v[52:55], a[104:111], v18
    v_pk_add_f32 v[80:81], v[80:81], v[82:83]
    v_smfmac_f32_16x16x64_bf16 v[84:87], v[56:59], a[32:39], v18
    v_cmp_u_f32 vcc, v80, v81
    v_cvt_pk_bf16_f32 v112, v80, v81
    v_smfmac_f32_16x16x64_bf16 v[88:91], v[56:59], a[112:119], v18
    ds_write_b32 v19, v112
    v_smfmac_f32_16x16x64_bf16 v[84:87], v[60:63], a[40:47], v18
    s_cbranch_vccnz L_nan_9
L_cont_10:
    v_smfmac_f32_16x16x64_bf16 v[88:91], v[60:63], a[120:127], v18
    ds_read_b64_tr_b16 v[112:113], v20
    ds_read_b64_tr_b16 v[114:115], v20 offset:128
    v_smfmac_f32_16x16x64_bf16 v[84:87], v[64:67], a[48:55], v18
    v_smfmac_f32_16x16x64_bf16 v[88:91], v[64:67], a[128:135], v18
    v_smfmac_f32_16x16x64_bf16 v[84:87], v[68:71], a[56:63], v18
    v_smfmac_f32_16x16x64_bf16 v[88:91], v[68:71], a[136:143], v18
    v_smfmac_f32_16x16x64_bf16 v[84:87], v[72:75], a[64:71], v18
    v_smfmac_f32_16x16x64_bf16 v[88:91], v[72:75], a[144:151], v18
    s_waitcnt lgkmcnt(0)
    buffer_store_dwordx4 v[112:115], v21, s[4:7], s44 offen
    v_smfmac_f32_16x16x64_bf16 v[84:87], v[76:79], a[72:79], v18
    v_smfmac_f32_16x16x64_bf16 v[88:91], v[76:79], a[152:159], v18
    s_cmp_eq_u32 s32, 0
    s_nop 4
    s_cbranch_scc1 L_w0_11
    s_cmp_eq_u32 s32, 3
    s_nop 2
    s_cbranch_scc1 L_w3_12
    s_nop 2
    v_pk_add_f32 v[84:85], v[84:85], v[86:87]
    v_pk_add_f32 v[88:89], v[88:89], v[90:91]
    v_cvt_pk_bf16_f32 v176, v84, v85
    v_cvt_pk_bf16_f32 v177, v88, v89
    ds_write_b64 v22, v[176:177]
    s_waitcnt lgkmcnt(0)
    s_barrier
    ds_read_b64_tr_b16 v[92:93], v23 offset:0
    ds_read_b64_tr_b16 v[94:95], v24 offset:0
    ds_read_b64_tr_b16 v[96:97], v23 offset:1024
    ds_read_b64_tr_b16 v[98:99], v24 offset:1024
    s_waitcnt lgkmcnt(2)
    v_mfma_f32_16x16x32_bf16 v[108:111], v[100:103], v[92:95], 0
    s_waitcnt lgkmcnt(0)
    v_mfma_f32_16x16x32_bf16 v[108:111], v[104:107], v[96:99], v[108:111]
    s_nop 7
    buffer_store_dwordx4 v[108:111], v25, s[4:7], s43 offen
    buffer_store_dwordx4 v[36:39], v25, s[4:7], s45 offen
    s_branch L_join_13
L_w0_11:
    v_pk_add_f32 v[84:85], v[84:85], v[86:87]
    v_pk_add_f32 v[88:89], v[88:89], v[90:91]
    v_cvt_pk_bf16_f32 v176, v84, v85
    v_cvt_pk_bf16_f32 v177, v88, v89
    ds_write_b64 v22, v[176:177]
    s_waitcnt lgkmcnt(0)
    s_barrier
    ds_read_b64_tr_b16 v[92:93], v23 offset:0
    ds_read_b64_tr_b16 v[94:95], v24 offset:0
    ds_read_b64_tr_b16 v[96:97], v23 offset:1024
    ds_read_b64_tr_b16 v[98:99], v24 offset:1024
    s_waitcnt lgkmcnt(2)
    v_mfma_f32_16x16x32_bf16 v[108:111], v[92:95], v[92:95], 0
    s_waitcnt lgkmcnt(0)
    v_mfma_f32_16x16x32_bf16 v[108:111], v[96:99], v[96:99], v[108:111]
    s_nop 7
    buffer_store_dword v110, v25, s[4:7], s43 offen
    buffer_store_dword v111, v25, s[4:7], s43 offen offset:8
    buffer_store_dword v38, v25, s[4:7], s45 offen
    buffer_store_dword v39, v25, s[4:7], s45 offen offset:8
    s_branch L_join_13
L_w3_12:
    v_pk_add_f32 v[84:85], v[84:85], v[86:87]
    v_pk_add_f32 v[88:89], v[88:89], v[90:91]
    v_cvt_pk_bf16_f32 v176, v84, v85
    v_cvt_pk_bf16_f32 v177, v88, v89
    ds_write_b64 v22, v[176:177]
    s_waitcnt lgkmcnt(0)
    s_barrier
    ds_read_b64_tr_b16 v[92:93], v23 offset:0
    ds_read_b64_tr_b16 v[94:95], v24 offset:0
    ds_read_b64_tr_b16 v[96:97], v23 offset:1024
    ds_read_b64_tr_b16 v[98:99], v24 offset:1024
    s_waitcnt lgkmcnt(2)
    buffer_store_dwordx4 v[92:95], v26, s[4:7], s47 offen
    s_waitcnt lgkmcnt(0)
    buffer_store_dwordx4 v[96:99], v26, s[4:7], s47 offen offset:512
L_join_13:
    buffer_store_dwordx4 v[36:39], v21, s[4:7], s46 offen
    s_cmp_ge_u32 s37, 62
    s_cbranch_scc1 L_skip_14
    ds_read_b128 v[116:119], v11 offset:0
    ds_read_b128 v[120:123], v11 offset:2048
    ds_read_b128 v[124:127], v12 offset:0
    ds_read_b128 v[128:131], v12 offset:2048
    ds_read_b128 v[132:135], v11 offset:4096
    ds_read_b128 v[136:139], v11 offset:6144
    s_waitcnt lgkmcnt(4)
    v_mfma_f32_16x16x32_bf16 v[140:143], a[160:163], v[116:119], 0
    v_mfma_f32_16x16x32_bf16 v[144:147], a[160:163], v[120:123], 0
    v_mfma_f32_16x16x32_bf16 v[148:151], a[80:83], v[116:119], 0
    v_mfma_f32_16x16x32_bf16 v[152:155], a[80:83], v[120:123], 0
    v_mfma_f32_16x16x32_bf16 v[156:159], a[0:3], v[116:119], 0
    v_mfma_f32_16x16x32_bf16 v[160:163], a[0:3], v[120:123], 0
    ds_read_b128 v[116:119], v12 offset:4096
    ds_read_b128 v[120:123], v12 offset:6144
    s_waitcnt lgkmcnt(4)
    v_mfma_f32_16x16x32_bf16 v[140:143], a[164:167], v[124:127], v[140:143]
    v_mfma_f32_16x16x32_bf16 v[144:147], a[164:167], v[128:131], v[144:147]
    v_mfma_f32_16x16x32_bf16 v[148:151], a[84:87], v[124:127], v[148:151]
    v_mfma_f32_16x16x32_bf16 v[152:155], a[84:87], v[128:131], v[152:155]
    v_mfma_f32_16x16x32_bf16 v[156:159], a[4:7], v[124:127], v[156:159]
    v_mfma_f32_16x16x32_bf16 v[160:163], a[4:7], v[128:131], v[160:163]
    ds_read_b128 v[124:127], v11 offset:8192
    ds_read_b128 v[128:131], v11 offset:10240
    s_waitcnt lgkmcnt(4)
    v_mfma_f32_16x16x32_bf16 v[140:143], a[168:171], v[132:135], v[140:143]
    v_mfma_f32_16x16x32_bf16 v[144:147], a[168:171], v[136:139], v[144:147]
    v_mfma_f32_16x16x32_bf16 v[148:151], a[88:91], v[132:135], v[148:151]
    v_mfma_f32_16x16x32_bf16 v[152:155], a[88:91], v[136:139], v[152:155]
    v_mfma_f32_16x16x32_bf16 v[156:159], a[8:11], v[132:135], v[156:159]
    v_mfma_f32_16x16x32_bf16 v[160:163], a[8:11], v[136:139], v[160:163]
    ds_read_b128 v[132:135], v12 offset:8192
    ds_read_b128 v[136:139], v12 offset:10240
    s_waitcnt lgkmcnt(4)
    v_mfma_f32_16x16x32_bf16 v[140:143], a[172:175], v[116:119], v[140:143]
    v_mfma_f32_16x16x32_bf16 v[144:147], a[172:175], v[120:123], v[144:147]
    v_mfma_f32_16x16x32_bf16 v[148:151], a[92:95], v[116:119], v[148:151]
    v_mfma_f32_16x16x32_bf16 v[152:155], a[92:95], v[120:123], v[152:155]
    v_mfma_f32_16x16x32_bf16 v[156:159], a[12:15], v[116:119], v[156:159]
    v_mfma_f32_16x16x32_bf16 v[160:163], a[12:15], v[120:123], v[160:163]
    ds_read_b128 v[116:119], v11 offset:12288
    ds_read_b128 v[120:123], v11 offset:14336
    s_waitcnt lgkmcnt(4)
    s_waitcnt vmcnt(0)
    buffer_store_dword v32, v31, s[4:7], s38 offen
    s_lshl_b32 s90, s32, 10
    s_add_u32 m0, s90, s50
    v_mfma_f32_16x16x32_bf16 v[140:143], a[176:179], v[124:127], v[140:143]
    v_mfma_f32_16x16x32_bf16 v[144:147], a[176:179], v[128:131], v[144:147]
    v_mfma_f32_16x16x32_bf16 v[148:151], a[96:99], v[124:127], v[148:151]
    v_mfma_f32_16x16x32_bf16 v[152:155], a[96:99], v[128:131], v[152:155]
    v_mfma_f32_16x16x32_bf16 v[156:159], a[16:19], v[124:127], v[156:159]
    v_mfma_f32_16x16x32_bf16 v[160:163], a[16:19], v[128:131], v[160:163]
    ds_read_b128 v[124:127], v12 offset:12288
    ds_read_b128 v[128:131], v12 offset:14336
    s_waitcnt lgkmcnt(4)
    v_mfma_f32_16x16x32_bf16 v[140:143], a[180:183], v[132:135], v[140:143]
    v_mfma_f32_16x16x32_bf16 v[144:147], a[180:183], v[136:139], v[144:147]
    buffer_load_dwordx4 v10, s[24:27], s49 offen offset:0 lds
    s_add_u32 m0, m0, 3968
    v_mfma_f32_16x16x32_bf16 v[148:151], a[100:103], v[132:135], v[148:151]
    v_mfma_f32_16x16x32_bf16 v[152:155], a[100:103], v[136:139], v[152:155]
    v_mfma_f32_16x16x32_bf16 v[156:159], a[20:23], v[132:135], v[156:159]
    v_mfma_f32_16x16x32_bf16 v[160:163], a[20:23], v[136:139], v[160:163]
    ds_read_b128 v[132:135], v11 offset:16384
    ds_read_b128 v[136:139], v11 offset:18432
    s_waitcnt lgkmcnt(4)
    v_mfma_f32_16x16x32_bf16 v[140:143], a[184:187], v[116:119], v[140:143]
    v_mfma_f32_16x16x32_bf16 v[144:147], a[184:187], v[120:123], v[144:147]
    buffer_load_dwordx4 v10, s[24:27], s49 offen offset:128 lds
    s_add_u32 m0, m0, 3968
    v_mfma_f32_16x16x32_bf16 v[148:151], a[104:107], v[116:119], v[148:151]
    v_mfma_f32_16x16x32_bf16 v[152:155], a[104:107], v[120:123], v[152:155]
    v_mfma_f32_16x16x32_bf16 v[156:159], a[24:27], v[116:119], v[156:159]
    v_mfma_f32_16x16x32_bf16 v[160:163], a[24:27], v[120:123], v[160:163]
    ds_read_b128 v[116:119], v12 offset:16384
    ds_read_b128 v[120:123], v12 offset:18432
    s_waitcnt lgkmcnt(4)
    v_mfma_f32_16x16x32_bf16 v[140:143], a[188:191], v[124:127], v[140:143]
    v_mfma_f32_16x16x32_bf16 v[144:147], a[188:191], v[128:131], v[144:147]
    buffer_load_dwordx4 v10, s[24:27], s49 offen offset:256 lds
    s_add_u32 m0, m0, 3968
    v_mfma_f32_16x16x32_bf16 v[148:151], a[108:111], v[124:127], v[148:151]
    v_mfma_f32_16x16x32_bf16 v[152:155], a[108:111], v[128:131], v[152:155]
    v_mfma_f32_16x16x32_bf16 v[156:159], a[28:31], v[124:127], v[156:159]
    v_mfma_f32_16x16x32_bf16 v[160:163], a[28:31], v[128:131], v[160:163]
    ds_read_b128 v[124:127], v11 offset:20480
    ds_read_b128 v[128:131], v11 offset:22528
    s_waitcnt lgkmcnt(4)
    v_mfma_f32_16x16x32_bf16 v[140:143], a[192:195], v[132:135], v[140:143]
    v_mfma_f32_16x16x32_bf16 v[144:147], a[192:195], v[136:139], v[144:147]
    buffer_load_dwordx4 v10, s[24:27], s49 offen offset:384 lds
    s_add_u32 m0, m0, 3968
    v_mfma_f32_16x16x32_bf16 v[148:151], a[112:115], v[132:135], v[148:151]
    v_mfma_f32_16x16x32_bf16 v[152:155], a[112:115], v[136:139], v[152:155]
    v_mfma_f32_16x16x32_bf16 v[156:159], a[32:35], v[132:135], v[156:159]
    v_mfma_f32_16x16x32_bf16 v[160:163], a[32:35], v[136:139], v[160:163]
    ds_read_b128 v[132:135], v12 offset:20480
    ds_read_b128 v[136:139], v12 offset:22528
    s_waitcnt lgkmcnt(4)
    v_mfma_f32_16x16x32_bf16 v[140:143], a[196:199], v[116:119], v[140:143]
    v_mfma_f32_16x16x32_bf16 v[144:147], a[196:199], v[120:123], v[144:147]
    buffer_load_dwordx4 v10, s[24:27], s49 offen offset:512 lds
    s_add_u32 m0, m0, 3968
    v_mfma_f32_16x16x32_bf16 v[148:151], a[116:119], v[116:119], v[148:151]
    v_mfma_f32_16x16x32_bf16 v[152:155], a[116:119], v[120:123], v[152:155]
    v_mfma_f32_16x16x32_bf16 v[156:159], a[36:39], v[116:119], v[156:159]
    v_mfma_f32_16x16x32_bf16 v[160:163], a[36:39], v[120:123], v[160:163]
    ds_read_b128 v[116:119], v11 offset:24576
    ds_read_b128 v[120:123], v11 offset:26624
    s_waitcnt lgkmcnt(4)
    v_mfma_f32_16x16x32_bf16 v[140:143], a[200:203], v[124:127], v[140:143]
    v_mfma_f32_16x16x32_bf16 v[144:147], a[200:203], v[128:131], v[144:147]
    buffer_load_dwordx4 v10, s[24:27], s49 offen offset:640 lds
    s_add_u32 m0, m0, 3968
    v_mfma_f32_16x16x32_bf16 v[148:151], a[120:123], v[124:127], v[148:151]
    v_mfma_f32_16x16x32_bf16 v[152:155], a[120:123], v[128:131], v[152:155]
    v_mfma_f32_16x16x32_bf16 v[156:159], a[40:43], v[124:127], v[156:159]
    v_mfma_f32_16x16x32_bf16 v[160:163], a[40:43], v[128:131], v[160:163]
    ds_read_b128 v[124:127], v12 offset:24576
    ds_read_b128 v[128:131], v12 offset:26624
    s_waitcnt lgkmcnt(4)
    v_mfma_f32_16x16x32_bf16 v[140:143], a[204:207], v[132:135], v[140:143]
    v_mfma_f32_16x16x32_bf16 v[144:147], a[204:207], v[136:139], v[144:147]
    buffer_load_dwordx4 v10, s[24:27], s49 offen offset:768 lds
    s_add_u32 m0, m0, 3968
    v_mfma_f32_16x16x32_bf16 v[148:151], a[124:127], v[132:135], v[148:151]
    v_mfma_f32_16x16x32_bf16 v[152:155], a[124:127], v[136:139], v[152:155]
    v_mfma_f32_16x16x32_bf16 v[156:159], a[44:47], v[132:135], v[156:159]
    v_mfma_f32_16x16x32_bf16 v[160:163], a[44:47], v[136:139], v[160:163]
    ds_read_b128 v[132:135], v11 offset:28672
    ds_read_b128 v[136:139], v11 offset:30720
    s_waitcnt lgkmcnt(4)
    v_mfma_f32_16x16x32_bf16 v[140:143], a[208:211], v[116:119], v[140:143]
    v_mfma_f32_16x16x32_bf16 v[144:147], a[208:211], v[120:123], v[144:147]
    buffer_load_dwordx4 v10, s[24:27], s49 offen offset:896 lds
    s_add_u32 m0, m0, 3968
    v_mfma_f32_16x16x32_bf16 v[148:151], a[128:131], v[116:119], v[148:151]
    v_mfma_f32_16x16x32_bf16 v[152:155], a[128:131], v[120:123], v[152:155]
    v_mfma_f32_16x16x32_bf16 v[156:159], a[48:51], v[116:119], v[156:159]
    v_mfma_f32_16x16x32_bf16 v[160:163], a[48:51], v[120:123], v[160:163]
    ds_read_b128 v[116:119], v12 offset:28672
    ds_read_b128 v[120:123], v12 offset:30720
    s_waitcnt lgkmcnt(4)
    v_mfma_f32_16x16x32_bf16 v[140:143], a[212:215], v[124:127], v[140:143]
    v_mfma_f32_16x16x32_bf16 v[144:147], a[212:215], v[128:131], v[144:147]
    buffer_load_dwordx4 v10, s[24:27], s49 offen offset:1024 lds
    s_add_u32 m0, m0, 3968
    v_mfma_f32_16x16x32_bf16 v[148:151], a[132:135], v[124:127], v[148:151]
    v_mfma_f32_16x16x32_bf16 v[152:155], a[132:135], v[128:131], v[152:155]
    v_mfma_f32_16x16x32_bf16 v[156:159], a[52:55], v[124:127], v[156:159]
    v_mfma_f32_16x16x32_bf16 v[160:163], a[52:55], v[128:131], v[160:163]
    ds_read_b128 v[124:127], v11 offset:32768
    ds_read_b128 v[128:131], v11 offset:34816
    s_waitcnt lgkmcnt(4)
    v_mfma_f32_16x16x32_bf16 v[140:143], a[216:219], v[132:135], v[140:143]
    v_mfma_f32_16x16x32_bf16 v[144:147], a[216:219], v[136:139], v[144:147]
    buffer_load_dwordx4 v10, s[24:27], s49 offen offset:1152 lds
    v_mfma_f32_16x16x32_bf16 v[148:151], a[136:139], v[132:135], v[148:151]
    v_mfma_f32_16x16x32_bf16 v[152:155], a[136:139], v[136:139], v[152:155]
    v_mfma_f32_16x16x32_bf16 v[156:159], a[56:59], v[132:135], v[156:159]
    v_mfma_f32_16x16x32_bf16 v[160:163], a[56:59], v[136:139], v[160:163]
    ds_read_b128 v[132:135], v12 offset:32768
    ds_read_b128 v[136:139], v12 offset:34816
    s_waitcnt lgkmcnt(4)
    v_mfma_f32_16x16x32_bf16 v[140:143], a[220:223], v[116:119], v[140:143]
    v_mfma_f32_16x16x32_bf16 v[144:147], a[220:223], v[120:123], v[144:147]
    v_mfma_f32_16x16x32_bf16 v[148:151], a[140:143], v[116:119], v[148:151]
    v_mfma_f32_16x16x32_bf16 v[152:155], a[140:143], v[120:123], v[152:155]
    v_mfma_f32_16x16x32_bf16 v[156:159], a[60:63], v[116:119], v[156:159]
    v_mfma_f32_16x16x32_bf16 v[160:163], a[60:63], v[120:123], v[160:163]
    ds_read_b128 v[116:119], v11 offset:36864
    ds_read_b128 v[120:123], v11 offset:38912
    s_waitcnt lgkmcnt(4)
    v_mfma_f32_16x16x32_bf16 v[140:143], a[224:227], v[124:127], v[140:143]
    v_mfma_f32_16x16x32_bf16 v[144:147], a[224:227], v[128:131], v[144:147]
    v_mfma_f32_16x16x32_bf16 v[148:151], a[144:147], v[124:127], v[148:151]
    v_mfma_f32_16x16x32_bf16 v[152:155], a[144:147], v[128:131], v[152:155]
    v_mfma_f32_16x16x32_bf16 v[156:159], a[64:67], v[124:127], v[156:159]
    v_mfma_f32_16x16x32_bf16 v[160:163], a[64:67], v[128:131], v[160:163]
    ds_read_b128 v[124:127], v12 offset:36864
    ds_read_b128 v[128:131], v12 offset:38912
    s_waitcnt lgkmcnt(4)
    v_mfma_f32_16x16x32_bf16 v[140:143], a[228:231], v[132:135], v[140:143]
    v_mfma_f32_16x16x32_bf16 v[144:147], a[228:231], v[136:139], v[144:147]
    v_mfma_f32_16x16x32_bf16 v[148:151], a[148:151], v[132:135], v[148:151]
    v_mfma_f32_16x16x32_bf16 v[152:155], a[148:151], v[136:139], v[152:155]
    v_mfma_f32_16x16x32_bf16 v[156:159], a[68:71], v[132:135], v[156:159]
    v_mfma_f32_16x16x32_bf16 v[160:163], a[68:71], v[136:139], v[160:163]
    s_waitcnt lgkmcnt(2)
    v_mfma_f32_16x16x32_bf16 v[140:143], a[232:235], v[116:119], v[140:143]
    v_mfma_f32_16x16x32_bf16 v[144:147], a[232:235], v[120:123], v[144:147]
    v_mfma_f32_16x16x32_bf16 v[148:151], a[152:155], v[116:119], v[148:151]
    v_mfma_f32_16x16x32_bf16 v[152:155], a[152:155], v[120:123], v[152:155]
    v_mfma_f32_16x16x32_bf16 v[156:159], a[72:75], v[116:119], v[156:159]
    v_mfma_f32_16x16x32_bf16 v[160:163], a[72:75], v[120:123], v[160:163]
    s_waitcnt lgkmcnt(0)
    v_mfma_f32_16x16x32_bf16 v[140:143], a[236:239], v[124:127], v[140:143]
    v_mfma_f32_16x16x32_bf16 v[144:147], a[236:239], v[128:131], v[144:147]
    v_mfma_f32_16x16x32_bf16 v[148:151], a[156:159], v[124:127], v[148:151]
    v_mfma_f32_16x16x32_bf16 v[152:155], a[156:159], v[128:131], v[152:155]
    v_mfma_f32_16x16x32_bf16 v[156:159], a[76:79], v[124:127], v[156:159]
    v_mfma_f32_16x16x32_bf16 v[160:163], a[76:79], v[128:131], v[160:163]
    s_nop 2
    v_cvt_pk_bf16_f32 v164, v140, v141
    v_cvt_pk_bf16_f32 v165, v142, v143
    v_cvt_pk_bf16_f32 v166, v144, v145
    v_cvt_pk_bf16_f32 v167, v146, v147
    s_add_u32 s90, s48, 1179648
    v_permlane16_swap_b32 v164, v166
    v_permlane16_swap_b32 v165, v167
    buffer_store_dwordx4 v[164:167], v29, s[4:7], s90 offen
    v_cvt_pk_bf16_f32 v168, v148, v149
    v_cvt_pk_bf16_f32 v169, v150, v151
    v_cvt_pk_bf16_f32 v170, v152, v153
    v_cvt_pk_bf16_f32 v171, v154, v155
    s_add_u32 s90, s48, 786432
    v_permlane16_swap_b32 v168, v170
    v_permlane16_swap_b32 v169, v171
    buffer_store_dwordx4 v[168:171], v29, s[4:7], s90 offen
    ds_write_b128 v34, v[168:171]
    v_cvt_pk_bf16_f32 v172, v156, v157
    v_cvt_pk_bf16_f32 v173, v158, v159
    v_cvt_pk_bf16_f32 v174, v160, v161
    v_cvt_pk_bf16_f32 v175, v162, v163
    s_add_u32 s90, s48, 393216
    v_permlane16_swap_b32 v172, v174
    v_permlane16_swap_b32 v173, v175
    buffer_store_dwordx4 v[172:175], v29, s[4:7], s90 offen
    v_add_u32 v11, s52, v11
    v_add_u32 v12, s52, v12
    s_sub_u32 s50, s50, s52
    s_sub_u32 s52, 0, s52
L_next_15:
    s_add_u32 s37, s37, 1
    s_branch L_qkv_loop_f
L_skip_14:
    s_waitcnt vmcnt(0)
    buffer_store_dword v32, v31, s[4:7], s38 offen
    s_cmp_lt_u32 s37, 63
    s_cbranch_scc1 L_next_15
    s_endpgm
L_nan_9:
    s_nop 7
    v_lshlrev_b32 v1, 4, v0
    v_add_u32 v1, 122880, v1
    v_mov_b32 v2, 0
    ds_read_b128 v[4:7], v1 offset:0
    s_waitcnt lgkmcnt(0)
    v_max3_u32 v2, v2, v4, v5
    v_max3_u32 v2, v2, v6, v7
    ds_read_b128 v[4:7], v1 offset:1024
    s_waitcnt lgkmcnt(0)
    v_max3_u32 v2, v2, v4, v5
    v_max3_u32 v2, v2, v6, v7
    ds_read_b128 v[4:7], v1 offset:2048
    s_waitcnt lgkmcnt(0)
    v_max3_u32 v2, v2, v4, v5
    v_max3_u32 v2, v2, v6, v7
    ds_read_b128 v[4:7], v1 offset:3072
    s_waitcnt lgkmcnt(0)
    v_max3_u32 v2, v2, v4, v5
    v_max3_u32 v2, v2, v6, v7
    ds_read_b128 v[4:7], v1 offset:4096
    s_waitcnt lgkmcnt(0)
    v_max3_u32 v2, v2, v4, v5
    v_max3_u32 v2, v2, v6, v7
    ds_read_b128 v[4:7], v1 offset:5120
    s_waitcnt lgkmcnt(0)
    v_max3_u32 v2, v2, v4, v5
    v_max3_u32 v2, v2, v6, v7
    ds_read_b128 v[4:7], v1 offset:6144
    s_waitcnt lgkmcnt(0)
    v_max3_u32 v2, v2, v4, v5
    v_max3_u32 v2, v2, v6, v7
    ds_read_b128 v[4:7], v1 offset:7168
    s_waitcnt lgkmcnt(0)
    v_max3_u32 v2, v2, v4, v5
    v_max3_u32 v2, v2, v6, v7
    ds_read_b128 v[4:7], v1 offset:8192
    s_waitcnt lgkmcnt(0)
    v_max3_u32 v2, v2, v4, v5
    v_max3_u32 v2, v2, v6, v7
    ds_read_b128 v[4:7], v1 offset:9216
    s_waitcnt lgkmcnt(0)
    v_max3_u32 v2, v2, v4, v5
    v_max3_u32 v2, v2, v6, v7
    v_cmp_eq_u32 vcc, -1, v2
    s_cbranch_vccz L_cont_10
    s_barrier
    v_mov_b32 v80, 0
    v_mov_b32 v81, 0
    v_mov_b32 v82, 0
    v_mov_b32 v83, 0
    v_mov_b32 v84, 0
    v_mov_b32 v85, 0
    v_mov_b32 v86, 0
    v_mov_b32 v87, 0
    v_mov_b32 v88, 0
    v_mov_b32 v89, 0
    v_mov_b32 v90, 0
    v_mov_b32 v91, 0
    s_branch L_poll_8
L_wo_f:
    s_mov_b32 s12, s80
    s_and_b32 s13, s81, 0xffff
    s_mov_b32 s14, 7864320
    s_mov_b32 s15, 0x20000
    s_mov_b32 s16, s72
    s_and_b32 s17, s73, 0xffff
    s_mov_b32 s18, 10240
    s_mov_b32 s19, 0x20000
    s_sub_u32 s40, s35, 12
    v_and_b32 v1, 15, v0
    v_lshrrev_b32 v2, 4, v0
    v_lshrrev_b32 v3, 3, v0
    v_and_b32 v4, 7, v0
    v_and_b32 v6, 2, v3
    v_xor_b32 v6, v6, v4
    v_lshlrev_b32 v6, 4, v6
    v_mul_u32_u24 v7, 1280, v3
    s_lshl_b32 s90, s34, 2
    s_add_u32 s90, s90, s32
    s_mul_i32 s90, s90, 245760
    s_lshl_b32 s91, s40, 7
    s_add_u32 s90, s90, s91
    v_add3_u32 v176, v6, v7, s90
    v_xor_b32 v177, 64, v176
    s_lshl_b32 s90, s40, 14
    s_lshl_b32 s91, s32, 11
    s_add_u32 s90, s90, s91
    s_lshl_b32 s91, s34, 8
    s_add_u32 s91, s91, s90
    v_lshlrev_b32 v6, 4, v1
    v_lshl_add_u32 v6, v2, 2, v6
    v_add_u32 v14, s91, v6
    v_add_u32 v15, 8192, v14
    s_lshl_b32 s92, s32, 10
    s_add_u32 s92, s92, 122880
    v_add_u32 v19, s92, v6
    v_lshlrev_b32 v12, 4, v0
    v_lshlrev_b32 v13, 2, v0
    v_add_u32 v16, s90, v12
    v_add_u32 v17, 1024, v16
    v_cmp_ne_u32 vcc, s34, v2
    v_mov_b32 v9, 2146435072
    s_nop 0
    v_cndmask_b32 v16, v9, v16, vcc
    v_add_u32 v3, 4, v2
    v_cmp_ne_u32 vcc, s34, v3
    v_mov_b32 v9, 2146435072
    s_nop 0
    v_cndmask_b32 v17, v9, v17, vcc
    v_lshrrev_b32 v3, 2, v1
    v_lshlrev_b32 v6, 6, v3
    v_and_b32 v7, 1, v1
    v_lshl_add_u32 v6, v7, 5, v6
    v_lshl_add_u32 v6, v2, 3, v6
    v_and_b32 v7, 2, v1
    v_lshl_add_u32 v6, v7, 1, v6
    s_and_b32 s90, s32, 1
    s_lshl_b32 s90, s90, 7
    v_xor_b32 v6, s90, v6
    s_lshl_b32 s90, s40, 2
    s_add_u32 s90, s90, s32
    s_lshl_b32 s91, s90, 8
    v_add_u32 v18, s91, v6
    v_mov_b32 v43, -1
    s_lshl_b32 s91, s90, 5
    v_mul_u32_u24 v6, 2560, v2
    v_lshl_add_u32 v6, v1, 1, v6
    v_add_u32 v6, s91, v6
    buffer_load_ushort v4, v6, s[16:19], 0 offen
    buffer_load_ushort v5, v6, s[16:19], 0 offen offset:1280
    s_mov_b32 s90, 0
    buffer_store_dword v43, v14, s[4:7], s90 offen sc1
    buffer_store_dword v43, v15, s[4:7], s90 offen sc1
    s_mov_b32 s90, 163840
    buffer_store_dword v43, v14, s[4:7], s90 offen sc1
    buffer_store_dword v43, v15, s[4:7], s90 offen sc1
    s_mov_b32 s90, 327680
    buffer_store_dword v43, v14, s[4:7], s90 offen sc1
    buffer_store_dword v43, v15, s[4:7], s90 offen sc1
    s_mov_b32 s90, 491520
    buffer_store_dword v43, v14, s[4:7], s90 offen sc1
    buffer_store_dword v43, v15, s[4:7], s90 offen sc1
    s_add_u32 s90, s38, 10240
    buffer_store_dword v43, v18, s[4:7], s90 offen
    s_add_u32 s90, s38, 20480
    buffer_store_dword v43, v18, s[4:7], s90 offen
    s_add_u32 s90, s38, 30720
    buffer_store_dword v43, v18, s[4:7], s90 offen
    s_mul_i32 s90, s32, 24576
    s_mov_b32 m0, s90
    s_mov_b32 s91, 0
    buffer_load_dwordx4 v176, s[12:15], s91 offen lds
    s_add_u32 m0, m0, 1024
    s_add_u32 s91, s91, 10240
    buffer_load_dwordx4 v177, s[12:15], s91 offen lds
    s_add_u32 m0, m0, 1024
    s_add_u32 s91, s91, 10240
    buffer_load_dwordx4 v176, s[12:15], s91 offen lds
    s_add_u32 m0, m0, 1024
    s_add_u32 s91, s91, 10240
    buffer_load_dwordx4 v177, s[12:15], s91 offen lds
    s_add_u32 m0, m0, 1024
    s_add_u32 s91, s91, 10240
    buffer_load_dwordx4 v176, s[12:15], s91 offen lds
    s_add_u32 m0, m0, 1024
    s_add_u32 s91, s91, 10240
    buffer_load_dwordx4 v177, s[12:15], s91 offen lds
    s_add_u32 m0, m0, 1024
    s_add_u32 s91, s91, 10240
    buffer_load_dwordx4 v176, s[12:15], s91 offen lds
    s_add_u32 m0, m0, 1024
    s_add_u32 s91, s91, 10240
    buffer_load_dwordx4 v177, s[12:15], s91 offen lds
    s_add_u32 m0, m0, 1024
    s_add_u32 s91, s91, 10240
    buffer_load_dwordx4 v176, s[12:15], s91 offen lds
    s_add_u32 m0, m0, 1024
    s_add_u32 s91, s91, 10240
    buffer_load_dwordx4 v177, s[12:15], s91 offen lds
    s_add_u32 m0, m0, 1024
    s_add_u32 s91, s91, 10240
    buffer_load_dwordx4 v176, s[12:15], s91 offen lds
    s_add_u32 m0, m0, 1024
    s_add_u32 s91, s91, 10240
    buffer_load_dwordx4 v177, s[12:15], s91 offen lds
    s_add_u32 m0, m0, 1024
    s_add_u32 s91, s91, 10240
    buffer_load_dwordx4 v176, s[12:15], s91 offen lds
    s_add_u32 m0, m0, 1024
    s_add_u32 s91, s91, 10240
    buffer_load_dwordx4 v177, s[12:15], s91 offen lds
    s_add_u32 m0, m0, 1024
    s_add_u32 s91, s91, 10240
    buffer_load_dwordx4 v176, s[12:15], s91 offen lds
    s_add_u32 m0, m0, 1024
    s_add_u32 s91, s91, 10240
    buffer_load_dwordx4 v177, s[12:15], s91 offen lds
    s_add_u32 m0, m0, 1024
    s_add_u32 s91, s91, 10240
    buffer_load_dwordx4 v176, s[12:15], s91 offen lds
    s_add_u32 m0, m0, 1024
    s_add_u32 s91, s91, 10240
    buffer_load_dwordx4 v177, s[12:15], s91 offen lds
    s_add_u32 m0, m0, 1024
    s_add_u32 s91, s91, 10240
    buffer_load_dwordx4 v176, s[12:15], s91 offen lds
    s_add_u32 m0, m0, 1024
    s_add_u32 s91, s91, 10240
    buffer_load_dwordx4 v177, s[12:15], s91 offen lds
    s_add_u32 m0, m0, 1024
    s_add_u32 s91, s91, 10240
    buffer_load_dwordx4 v176, s[12:15], s91 offen lds
    s_add_u32 m0, m0, 1024
    s_add_u32 s91, s91, 10240
    buffer_load_dwordx4 v177, s[12:15], s91 offen lds
    s_add_u32 m0, m0, 1024
    s_add_u32 s91, s91, 10240
    buffer_load_dwordx4 v176, s[12:15], s91 offen lds
    s_add_u32 m0, m0, 1024
    s_add_u32 s91, s91, 10240
    buffer_load_dwordx4 v177, s[12:15], s91 offen lds
    s_waitcnt vmcnt(35)
    v_lshl_or_b32 v4, v5, 16, v4
    v_min_u32 v4, -2, v4
    buffer_store_dword v4, v18, s[4:7], s38 offen
    v_and_b32 v7, 2, v1
    v_cmp_ne_u32 vcc, 0, v7
    v_mov_b32 v5, 0x4444
    v_mov_b32 v6, 0xeeee
    v_cndmask_b32 v10, v5, v6, vcc
    v_mov_b32 v5, 0xe484
    v_mov_b32 v6, 0xee9e
    v_cndmask_b32 v7, v5, v6, vcc
    v_mov_b32 v5, 0x84e4
    v_mov_b32 v6, 0x9eee
    v_cndmask_b32 v8, v5, v6, vcc
    v_cmp_gt_u32 vcc, 2, v2
    s_nop 1
    v_cndmask_b32 v11, v8, v7, vcc
    v_mov_b32 v84, 1065369472
    v_mov_b32 v85, 1065369472
    v_mov_b32 v86, 1065369472
    v_mov_b32 v87, 0
    v_mov_b32 v88, 1065369472
    v_mov_b32 v89, 1065369472
    v_mov_b32 v90, 1065369472
    v_mov_b32 v91, 0
    v_mov_b32 v51, 0
    v_mov_b32 v55, 0
    v_mov_b32 v59, 0
    v_mov_b32 v63, 0
    v_mov_b32 v67, 0
    v_mov_b32 v71, 0
    v_mov_b32 v75, 0
    v_mov_b32 v79, 0
    v_mov_b32 v206, 0
    v_mov_b32 v207, 0
    v_mov_b32 v214, 0
    v_mov_b32 v215, 0
    v_and_b32 v7, 1, v1
    v_cmp_ne_u32 vcc, 0, v7
    v_mov_b32 v5, 0x3f80
    v_mov_b32 v6, 0x3f800000
    v_cndmask_b32 v5, v5, v6, vcc
    v_cmp_eq_u32 vcc, 0, v3
    s_nop 1
    v_cndmask_b32 v92, 0, v5, vcc
    v_cmp_eq_u32 vcc, 1, v3
    s_nop 1
    v_cndmask_b32 v93, 0, v5, vcc
    v_cmp_eq_u32 vcc, 2, v3
    s_nop 1
    v_cndmask_b32 v94, 0, v5, vcc
    v_cmp_eq_u32 vcc, 3, v3
    s_nop 1
    v_cndmask_b32 v95, 0, v5, vcc
    v_mov_b32 v240, 0x3dd53b95
    v_mov_b32 v241, 0x3dd53b95
    s_lshl_b32 s90, s32, 8
    s_add_u32 s90, s90, 122880
    v_lshlrev_b32 v6, 4, v1
    v_lshl_add_u32 v6, v2, 10, v6
    v_add_u32 v20, s90, v6
    s_mul_i32 s90, s32, 1536
    v_add_u32 v21, s90, v12
    s_add_u32 s90, s90, 1024
    v_lshl_add_u32 v22, v0, 3, s90
    s_mul_i32 s90, s32, 6144
    v_add_u32 v23, s90, v12
    s_add_u32 s90, s90, 1024
    v_lshl_add_u32 v24, v0, 3, s90
    v_add_u32 v30, 98304, v12
    s_mul_i32 s90, s32, 3072
    v_add_u32 v39, s90, v12
    s_add_u32 s54, s90, 98304
    s_mul_i32 s90, s32, 3840
    v_add_u32 v40, s90, v12
    s_add_u32 s90, s90, 1024
    v_add_u32 v41, s90, v13
    s_mul_i32 s90, s32, 12288
    v_add_u32 v42, s90, v12
    s_lshl_b32 s90, s40, 16
    s_lshl_b32 s91, s34, 8
    s_add_u32 s91, s91, s90
    s_lshl_b32 s92, s32, 6
    s_add_u32 s91, s91, s92
    v_lshlrev_b32 v6, 11, v1
    v_lshl_add_u32 v6, v2, 4, v6
    v_add_u32 v32, s91, v6
    s_lshl_b32 s91, s34, 2
    s_add_u32 s91, s91, s32
    s_lshl_b32 s92, s91, 11
    s_add_u32 s92, s92, s90
    v_add_u32 v33, s92, v12
    s_mul_i32 s91, s91, 2560
    s_lshl_b32 s92, s40, 7
    s_add_u32 s91, s91, s92
    s_add_u32 s91, s91, 1280
    v_lshlrev_b32 v6, 3, v1
    v_lshl_add_u32 v6, v2, 1, v6
    v_add_u32 v34, s91, v6
    s_lshl_b32 s90, s32, 7
    v_add_u32 v5, s90, v13
    v_add_u32 v6, 151552, v5
    v_add_u32 v7, 152528, v5
    v_cmp_gt_u32 vcc, 12, v0
    s_nop 1
    v_cndmask_b32 v35, v7, v6, vcc
    v_mov_b32 v5, -2
    v_cndmask_b32 v36, v5, 2, vcc
    v_cmp_gt_u32 vcc, 14, v0
    v_mov_b32 v9, 2146435072
    s_nop 0
    v_cndmask_b32 v35, v9, v35, vcc
    v_mov_b32 v5, -1000
    v_cndmask_b32 v36, v5, v36, vcc
    v_and_b32 v4, 3, v1
    v_and_b32 v5, 1, v2
    v_lshl_add_u32 v6, v2, 3, v3
    v_lshlrev_b32 v6, 7, v6
    v_and_b32 v7, 2, v3
    v_lshl_or_b32 v7, v5, 2, v7
    v_lshrrev_b32 v8, 1, v4
    v_xor_b32 v7, v7, v8
    v_lshl_add_u32 v6, v7, 4, v6
    v_and_b32 v7, 1, v4
    v_lshl_add_u32 v6, v7, 3, v6
    s_mul_i32 s90, s32, 24576
    v_add_u32 v6, s90, v6
    v_xor_b32 v178, 0, v6
    v_xor_b32 v179, 32, v6
    v_xor_b32 v180, 64, v6
    v_xor_b32 v181, 96, v6
    s_waitcnt vmcnt(0)
    ds_read_b64_tr_b16 a[0:1], v178 offset:0
    ds_read_b64_tr_b16 a[2:3], v178 offset:512
    ds_read_b64_tr_b16 a[4:5], v178 offset:4096
    ds_read_b64_tr_b16 a[6:7], v178 offset:4608
    ds_read_b64_tr_b16 a[8:9], v178 offset:8192
    ds_read_b64_tr_b16 a[10:11], v178 offset:8704
    ds_read_b64_tr_b16 a[12:13], v178 offset:12288
    ds_read_b64_tr_b16 a[14:15], v178 offset:12800
    ds_read_b64_tr_b16 a[16:17], v178 offset:16384
    ds_read_b64_tr_b16 a[18:19], v178 offset:16896
    ds_read_b64_tr_b16 a[20:21], v178 offset:20480
    ds_read_b64_tr_b16 a[22:23], v178 offset:20992
    ds_read_b64_tr_b16 a[24:25], v179 offset:0
    ds_read_b64_tr_b16 a[26:27], v179 offset:512
    ds_read_b64_tr_b16 a[28:29], v179 offset:4096
    ds_read_b64_tr_b16 a[30:31], v179 offset:4608
    ds_read_b64_tr_b16 a[32:33], v179 offset:8192
    ds_read_b64_tr_b16 a[34:35], v179 offset:8704
    ds_read_b64_tr_b16 a[36:37], v179 offset:12288
    ds_read_b64_tr_b16 a[38:39], v179 offset:12800
    ds_read_b64_tr_b16 a[40:41], v179 offset:16384
    ds_read_b64_tr_b16 a[42:43], v179 offset:16896
    ds_read_b64_tr_b16 a[44:45], v179 offset:20480
    ds_read_b64_tr_b16 a[46:47], v179 offset:20992
    ds_read_b64_tr_b16 a[48:49], v180 offset:0
    ds_read_b64_tr_b16 a[50:51], v180 offset:512
    ds_read_b64_tr_b16 a[52:53], v180 offset:4096
    ds_read_b64_tr_b16 a[54:55], v180 offset:4608
    ds_read_b64_tr_b16 a[56:57], v180 offset:8192
    ds_read_b64_tr_b16 a[58:59], v180 offset:8704
    ds_read_b64_tr_b16 a[60:61], v180 offset:12288
    ds_read_b64_tr_b16 a[62:63], v180 offset:12800
    ds_read_b64_tr_b16 a[64:65], v180 offset:16384
    ds_read_b64_tr_b16 a[66:67], v180 offset:16896
    ds_read_b64_tr_b16 a[68:69], v180 offset:20480
    ds_read_b64_tr_b16 a[70:71], v180 offset:20992
    ds_read_b64_tr_b16 a[72:73], v181 offset:0
    ds_read_b64_tr_b16 a[74:75], v181 offset:512
    ds_read_b64_tr_b16 a[76:77], v181 offset:4096
    ds_read_b64_tr_b16 a[78:79], v181 offset:4608
    ds_read_b64_tr_b16 a[80:81], v181 offset:8192
    ds_read_b64_tr_b16 a[82:83], v181 offset:8704
    ds_read_b64_tr_b16 a[84:85], v181 offset:12288
    ds_read_b64_tr_b16 a[86:87], v181 offset:12800
    ds_read_b64_tr_b16 a[88:89], v181 offset:16384
    ds_read_b64_tr_b16 a[90:91], v181 offset:16896
    ds_read_b64_tr_b16 a[92:93], v181 offset:20480
    ds_read_b64_tr_b16 a[94:95], v181 offset:20992
    v_mov_b32 v4, 126976
    v_mov_b32 v5, 0
    ds_write_b32 v4, v5
    s_waitcnt lgkmcnt(0)
    s_barrier
    s_cmp_lg_u32 s32, 0
    s_cbranch_scc1 L_arr_16
    s_and_b32 s90, s33, 4
    s_lshl_b32 s90, s90, 5
    s_add_u32 s90, s90, 64
    v_mov_b32 v1, s90
    v_mov_b32 v2, 1
    s_mov_b64 exec, 1
    buffer_atomic_add v2, v1, s[8:11], 0 offen sc1
    s_mov_b64 exec, -1
L_arr_16:
    s_mul_i32 s90, s34, 10
    s_add_u32 s90, s90, s40
    s_lshl_b32 s90, s90, 14
    s_and_b32 s91, s32, 1
    s_lshl_b32 s92, s91, 13
    s_add_u32 s90, s90, s92
    s_lshr_b32 s92, s32, 1
    s_lshl_b32 s92, s92, 12
    s_add_u32 s90, s90, s92
    s_add_u32 s90, s90, 655360
    v_mov_b32 v6, s90
    s_mov_b32 s92, 0
    s_waitcnt vmcnt(0)
    s_barrier
L_race_17:
    buffer_load_dword v7, v6, s[4:7], s92 offen sc1
    s_add_u32 s92, s92, 384
    s_cmp_lt_u32 s92, 3840
    s_waitcnt vmcnt(0)
    s_cbranch_scc1 L_race_17
    s_add_u32 s91, s91, 1
    v_mov_b32 v6, s91
    ds_cmpst_b32 v4, v5, v6
    s_waitcnt lgkmcnt(0)
    s_barrier
    ds_read_b32 v6, v4
    s_waitcnt lgkmcnt(0)
    v_readfirstlane_b32 s53, v6
    s_nop 0
    s_sub_u32 s53, s53, 1
    s_and_b32 s53, s53, 1
    s_lshl_b32 s90, s53, 13
    v_add_u32 v16, s90, v16
    v_add_u32 v17, s90, v17
    v_lshlrev_b32 v1, 2, v0
L_gw_18:
    buffer_load_dword v2, v1, s[8:11], 0 offen sc1
    s_sub_u32 s36, s36, 1
    s_cbranch_scc1 L_exit
    s_waitcnt vmcnt(0)
    v_readlane_b32 s90, v2, 16
    v_readlane_b32 s91, v2, 48
    s_nop 0
    s_add_u32 s90, s90, s91
    s_cmp_lg_u32 s90, 256
    s_cbranch_scc1 L_gw_18
    v_cmp_eq_u32 s[90:91], 32, v2
    s_nop 0
    s_and_b32 s90, s90, s91
    s_and_b32 s90, s90, 15
    s_cmp_lg_u32 s90, 15
    s_cbranch_scc1 L_slow
    s_mov_b32 s37, 0
    v_add_u32 v37, -1, v36
    s_add_u32 s47, s38, 1179648
    v_mov_b32 v25, v21
    v_mov_b32 v26, v22
    buffer_load_dword v38, v35, s[4:7], s38 offen sc1
    s_waitcnt vmcnt(0)
    v_cmp_lt_i32 vcc, v38, v37
    s_cbranch_vccz L_fok_20
L_fw_19:
    buffer_load_dword v38, v35, s[4:7], s38 offen sc1
    s_sub_u32 s36, s36, 1
    s_cbranch_scc1 L_exit
    s_waitcnt vmcnt(0)
    v_cmp_lt_i32 vcc, v38, v37
    s_cbranch_vccnz L_fw_19
L_fok_20:
    buffer_load_dwordx4 a[96:99], v42, s[4:7], s47 offen offset:0 sc1
    buffer_load_dwordx4 a[100:103], v42, s[4:7], s47 offen offset:1024 sc1
    buffer_load_dwordx4 a[104:107], v42, s[4:7], s47 offen offset:2048 sc1
    buffer_load_dwordx4 a[108:111], v42, s[4:7], s47 offen offset:3072 sc1
    s_add_u32 s47, s47, 4096
    buffer_load_dwordx4 a[112:115], v42, s[4:7], s47 offen offset:0 sc1
    buffer_load_dwordx4 a[116:119], v42, s[4:7], s47 offen offset:1024 sc1
    buffer_load_dwordx4 a[120:123], v42, s[4:7], s47 offen offset:2048 sc1
    buffer_load_dwordx4 a[124:127], v42, s[4:7], s47 offen offset:3072 sc1
    s_add_u32 s47, s47, 4096
    buffer_load_dwordx4 a[128:131], v42, s[4:7], s47 offen offset:0 sc1
    buffer_load_dwordx4 a[132:135], v42, s[4:7], s47 offen offset:1024 sc1
    buffer_load_dwordx4 a[136:139], v42, s[4:7], s47 offen offset:2048 sc1
    buffer_load_dwordx4 a[140:143], v42, s[4:7], s47 offen offset:3072 sc1
    s_waitcnt vmcnt(0)
    v_mfma_f32_16x16x32_bf16 v[144:147], a[96:99], a[0:3], 0
    v_mfma_f32_16x16x32_bf16 v[148:151], a[120:123], a[0:3], 0
    v_mfma_f32_16x16x32_bf16 v[144:147], a[100:103], a[4:7], v[144:147]
    v_mfma_f32_16x16x32_bf16 v[148:151], a[124:127], a[4:7], v[148:151]
    v_mfma_f32_16x16x32_bf16 v[144:147], a[104:107], a[8:11], v[144:147]
    v_mfma_f32_16x16x32_bf16 v[148:151], a[128:131], a[8:11], v[148:151]
    v_mfma_f32_16x16x32_bf16 v[144:147], a[108:111], a[12:15], v[144:147]
    v_mfma_f32_16x16x32_bf16 v[148:151], a[132:135], a[12:15], v[148:151]
    v_mfma_f32_16x16x32_bf16 v[144:147], a[112:115], a[16:19], v[144:147]
    v_mfma_f32_16x16x32_bf16 v[148:151], a[136:139], a[16:19], v[148:151]
    v_mfma_f32_16x16x32_bf16 v[144:147], a[116:119], a[20:23], v[144:147]
    v_mfma_f32_16x16x32_bf16 v[148:151], a[140:143], a[20:23], v[148:151]
    v_mfma_f32_16x16x32_bf16 v[152:155], a[96:99], a[24:27], 0
    v_mfma_f32_16x16x32_bf16 v[156:159], a[120:123], a[24:27], 0
    v_mfma_f32_16x16x32_bf16 v[152:155], a[100:103], a[28:31], v[152:155]
    v_mfma_f32_16x16x32_bf16 v[156:159], a[124:127], a[28:31], v[156:159]
    v_mfma_f32_16x16x32_bf16 v[152:155], a[104:107], a[32:35], v[152:155]
    v_mfma_f32_16x16x32_bf16 v[156:159], a[128:131], a[32:35], v[156:159]
    v_mfma_f32_16x16x32_bf16 v[152:155], a[108:111], a[36:39], v[152:155]
    v_mfma_f32_16x16x32_bf16 v[156:159], a[132:135], a[36:39], v[156:159]
    v_cvt_pk_bf16_f32 v48, v144, v145
    v_cvt_pk_bf16_f32 v49, v146, v147
    v_mfma_f32_16x16x32_bf16 v[152:155], a[112:115], a[40:43], v[152:155]
    v_cvt_pk_bf16_f32 v52, v148, v149
    v_cvt_pk_bf16_f32 v53, v150, v151
    v_mfma_f32_16x16x32_bf16 v[156:159], a[136:139], a[40:43], v[156:159]
    ds_write_b64 v25, v[48:49] offset:0
    ds_write_b64 v26, v[52:53] offset:0
    v_mfma_f32_16x16x32_bf16 v[152:155], a[116:119], a[44:47], v[152:155]
    v_mfma_f32_16x16x32_bf16 v[156:159], a[140:143], a[44:47], v[156:159]
    v_mfma_f32_16x16x32_bf16 v[144:147], a[96:99], a[48:51], 0
    v_mfma_f32_16x16x32_bf16 v[148:151], a[120:123], a[48:51], 0
    v_mfma_f32_16x16x32_bf16 v[144:147], a[100:103], a[52:55], v[144:147]
    v_mfma_f32_16x16x32_bf16 v[148:151], a[124:127], a[52:55], v[148:151]
    v_mfma_f32_16x16x32_bf16 v[144:147], a[104:107], a[56:59], v[144:147]
    v_mfma_f32_16x16x32_bf16 v[148:151], a[128:131], a[56:59], v[148:151]
    v_mfma_f32_16x16x32_bf16 v[144:147], a[108:111], a[60:63], v[144:147]
    v_mfma_f32_16x16x32_bf16 v[148:151], a[132:135], a[60:63], v[148:151]
    v_cvt_pk_bf16_f32 v56, v152, v153
    v_cvt_pk_bf16_f32 v57, v154, v155
    v_mfma_f32_16x16x32_bf16 v[144:147], a[112:115], a[64:67], v[144:147]
    v_cvt_pk_bf16_f32 v60, v156, v157
    v_cvt_pk_bf16_f32 v61, v158, v159
    v_mfma_f32_16x16x32_bf16 v[148:151], a[136:139], a[64:67], v[148:151]
    ds_write_b64 v25, v[56:57] offset:6144
    ds_write_b64 v26, v[60:61] offset:6144
    v_mfma_f32_16x16x32_bf16 v[144:147], a[116:119], a[68:71], v[144:147]
    v_mfma_f32_16x16x32_bf16 v[148:151], a[140:143], a[68:71], v[148:151]
    v_mfma_f32_16x16x32_bf16 v[152:155], a[96:99], a[72:75], 0
    v_mfma_f32_16x16x32_bf16 v[156:159], a[120:123], a[72:75], 0
    v_mfma_f32_16x16x32_bf16 v[152:155], a[100:103], a[76:79], v[152:155]
    v_mfma_f32_16x16x32_bf16 v[156:159], a[124:127], a[76:79], v[156:159]
    v_mfma_f32_16x16x32_bf16 v[152:155], a[104:107], a[80:83], v[152:155]
    v_mfma_f32_16x16x32_bf16 v[156:159], a[128:131], a[80:83], v[156:159]
    v_mfma_f32_16x16x32_bf16 v[152:155], a[108:111], a[84:87], v[152:155]
    v_mfma_f32_16x16x32_bf16 v[156:159], a[132:135], a[84:87], v[156:159]
    v_cvt_pk_bf16_f32 v64, v144, v145
    v_cvt_pk_bf16_f32 v65, v146, v147
    v_mfma_f32_16x16x32_bf16 v[152:155], a[112:115], a[88:91], v[152:155]
    v_cvt_pk_bf16_f32 v68, v148, v149
    v_cvt_pk_bf16_f32 v69, v150, v151
    v_mfma_f32_16x16x32_bf16 v[156:159], a[136:139], a[88:91], v[156:159]
    ds_write_b64 v25, v[64:65] offset:12288
    ds_write_b64 v26, v[68:69] offset:12288
    v_mfma_f32_16x16x32_bf16 v[152:155], a[116:119], a[92:95], v[152:155]
    v_mfma_f32_16x16x32_bf16 v[156:159], a[140:143], a[92:95], v[156:159]
    s_nop 6
    v_cvt_pk_bf16_f32 v72, v152, v153
    v_cvt_pk_bf16_f32 v73, v154, v155
    v_cvt_pk_bf16_f32 v76, v156, v157
    v_cvt_pk_bf16_f32 v77, v158, v159
    ds_write_b64 v25, v[72:73] offset:18432
    ds_write_b64 v26, v[76:77] offset:18432
L_wo_loop_f:
    buffer_load_dword v38, v35, s[4:7], s38 offen sc1
    s_min_u32 s90, s37, 62
    v_add_u32 v37, s90, v36
    s_and_b32 s90, s37, 1
    s_add_u32 s90, s90, 12
    s_sub_u32 s91, s37, 1
    s_mov_b32 m0, s90
    v_writelane_b32 v37, s91, m0
    s_max_u32 s93, s37, 5
    s_sub_u32 s93, s93, 5
    s_and_b32 s90, s93, 7
    s_mul_i32 s90, s90, 655360
    s_add_u32 s51, s90, 2097152
    s_mul_i32 s52, s93, 81920
    buffer_load_dwordx4 v[224:227], v33, s[4:7], s51 offen sc1
    buffer_load_dwordx4 v[228:231], v33, s[4:7], s51 offen offset:1024 sc1
    s_and_b32 s90, s37, 3
    s_mul_i32 s91, s90, 163840
    s_add_u32 s41, s91, 0
    s_mul_i32 s91, s90, 15360
    s_add_u32 s91, s91, 40960
    s_add_u32 s45, s38, s91
    s_mul_i32 s91, s90, 12288
    s_add_u32 s91, s91, 102400
    s_add_u32 s46, s38, s91
    s_mul_i32 s91, s90, 10240
    s_add_u32 s44, s38, s91
    s_mul_i32 s91, s90, 24576
    v_add_u32 v27, s91, v21
    s_xor_b32 s90, s90, 2
    s_mul_i32 s91, s90, 163840
    s_add_u32 s42, s91, 0
    s_add_u32 s92, s37, 1
    s_and_b32 s90, s92, 3
    s_mul_i32 s91, s90, 10240
    s_add_u32 s43, s38, s91
    s_mul_i32 s91, s90, 24576
    v_add_u32 v25, s91, v21
    v_add_u32 v26, s91, v22
    s_and_b32 s90, s92, 7
    s_mul_i32 s91, s90, 49152
    s_add_u32 s91, s91, 1179648
    s_add_u32 s47, s38, s91
    s_add_u32 s93, s37, 5
    s_and_b32 s90, s93, 3
    s_mul_i32 s90, s90, 24576
    v_add_u32 v28, s90, v23
    v_add_u32 v29, s90, v24
    s_and_b32 s90, s93, 1
    s_mul_i32 s90, s90, 12288
    v_add_u32 v31, s90, v30
    s_and_b32 s90, s93, 7
    s_mul_i32 s90, s90, 655360
    s_add_u32 s49, s90, 2097152
    s_add_u32 s50, s49, 32768
    s_add_u32 s93, s37, 6
    s_and_b32 s90, s93, 7
    s_mul_i32 s90, s90, 12288
    s_add_u32 s90, s90, 253952
    s_add_u32 s48, s38, s90
    s_and_b32 s90, s93, 1
    s_mul_i32 s90, s90, 12288
    s_add_u32 m0, s54, s90
    ds_read_b128 v[200:203], v28 offset:0
    ds_read_b128 v[176:179], v31 offset:0
    ds_read_b128 v[180:183], v31 offset:1024
    ds_read_b64 v[204:205], v29 offset:0
    ds_read_b128 v[184:187], v31 offset:2048
    ds_read_b128 v[208:211], v28 offset:1536
    ds_read_b128 v[188:191], v31 offset:3072
    ds_read_b128 v[192:195], v31 offset:4096
    ds_read_b64 v[212:213], v29 offset:1536
    ds_read_b128 v[196:199], v31 offset:5120
    s_waitcnt vmcnt(2)
    v_cmp_lt_i32 vcc, v38, v37
    s_cbranch_vccz L_fok_26
L_fw_25:
    buffer_load_dword v38, v35, s[4:7], s38 offen sc1
    s_sub_u32 s36, s36, 1
    s_cbranch_scc1 L_exit
    s_waitcnt vmcnt(0)
    v_cmp_lt_i32 vcc, v38, v37
    s_cbranch_vccnz L_fw_25
L_fok_26:
    buffer_load_dwordx4 v39, s[4:7], s48 offen offset:0 sc1 lds
    buffer_load_dwordx4 v39, s[4:7], s48 offen offset:1024 sc1 lds
    buffer_load_dwordx4 v39, s[4:7], s48 offen offset:2048 sc1 lds
    buffer_load_dwordx4 a[96:99], v42, s[4:7], s47 offen offset:0 sc1
    buffer_load_dwordx4 a[100:103], v42, s[4:7], s47 offen offset:1024 sc1
    buffer_load_dwordx4 a[104:107], v42, s[4:7], s47 offen offset:2048 sc1
    s_waitcnt lgkmcnt(5)
    v_mfma_f32_16x16x32_bf16 v[216:219], v[200:203], v[176:179], 0
    v_mfma_f32_16x16x32_bf16 v[220:223], v[200:203], v[180:183], 0
    v_mfma_f32_16x16x32_bf16 v[220:223], v[204:207], v[184:187], v[220:223]
    ds_read_b128 v[200:203], v28 offset:3072
    ds_read_b128 v[176:179], v31 offset:6144
    ds_read_b128 v[180:183], v31 offset:7168
    ds_read_b64 v[204:205], v29 offset:3072
    ds_read_b128 v[184:187], v31 offset:8192
    buffer_load_dwordx4 a[108:111], v42, s[4:7], s47 offen offset:3072 sc1
    s_add_u32 s47, s47, 4096
    buffer_load_dwordx4 a[112:115], v42, s[4:7], s47 offen offset:0 sc1
    buffer_load_dwordx4 a[116:119], v42, s[4:7], s47 offen offset:1024 sc1
    s_waitcnt lgkmcnt(5)
    v_mfma_f32_16x16x32_bf16 v[216:219], v[208:211], v[188:191], v[216:219]
    v_mfma_f32_16x16x32_bf16 v[220:223], v[208:211], v[192:195], v[220:223]
    v_mfma_f32_16x16x32_bf16 v[220:223], v[212:215], v[196:199], v[220:223]
    ds_read_b128 v[208:211], v28 offset:4608
    ds_read_b128 v[188:191], v31 offset:9216
    ds_read_b128 v[192:195], v31 offset:10240
    ds_read_b64 v[212:213], v29 offset:4608
    ds_read_b128 v[196:199], v31 offset:11264
    buffer_load_dwordx4 a[120:123], v42, s[4:7], s47 offen offset:2048 sc1
    buffer_load_dwordx4 a[124:127], v42, s[4:7], s47 offen offset:3072 sc1
    s_add_u32 s47, s47, 4096
    buffer_load_dwordx4 a[128:131], v42, s[4:7], s47 offen offset:0 sc1
    s_waitcnt lgkmcnt(5)
    v_mfma_f32_16x16x32_bf16 v[216:219], v[200:203], v[176:179], v[216:219]
    v_mfma_f32_16x16x32_bf16 v[220:223], v[200:203], v[180:183], v[220:223]
    v_mfma_f32_16x16x32_bf16 v[220:223], v[204:207], v[184:187], v[220:223]
    buffer_load_dwordx4 a[132:135], v42, s[4:7], s47 offen offset:1024 sc1
    buffer_load_dwordx4 a[136:139], v42, s[4:7], s47 offen offset:2048 sc1
    buffer_load_dwordx4 a[140:143], v42, s[4:7], s47 offen offset:3072 sc1
    s_waitcnt lgkmcnt(0)
    v_mfma_f32_16x16x32_bf16 v[216:219], v[208:211], v[188:191], v[216:219]
    v_mfma_f32_16x16x32_bf16 v[220:223], v[208:211], v[192:195], v[220:223]
    v_mfma_f32_16x16x32_bf16 v[220:223], v[212:215], v[196:199], v[220:223]
    s_cmp_lt_u32 s37, 5
    s_cbranch_scc1 L_g_21
    s_waitcnt vmcnt(15)
    v_pk_add_f32 v[224:225], v[224:225], v[228:229]
    v_pk_add_f32 v[226:227], v[226:227], v[230:231]
    s_nop 1
    v_permlane32_swap_b32 v224, v226
    v_permlane32_swap_b32 v225, v227
    v_pk_add_f32 v[224:225], v[224:225], v[226:227]
    s_nop 1
    v_permlane16_swap_b32 v224, v225
    v_add_f32 v224, v224, v225
    v_cvt_pk_bf16_f32 v224, v224, v224
    buffer_store_short v224, v34, s[28:31], s52 offen
L_g_21:
    v_mov_b32 v144, 0
    v_mov_b32 v145, 0
    v_mov_b32 v146, 0
    v_mov_b32 v147, 0
    v_mov_b32 v148, 0
    v_mov_b32 v149, 0
    v_mov_b32 v150, 0
    v_mov_b32 v151, 0
    v_mov_b32 v152, 0
    v_mov_b32 v153, 0
    v_mov_b32 v154, 0
    v_mov_b32 v155, 0
    v_mov_b32 v156, 0
    v_mov_b32 v157, 0
    v_mov_b32 v158, 0
    v_mov_b32 v159, 0
    v_mov_b32 v112, 0
    v_mov_b32 v113, 0
    v_mov_b32 v114, 0
    v_mov_b32 v115, 0
    v_mov_b32 v116, 0
    v_mov_b32 v117, 0
    v_mov_b32 v118, 0
    v_mov_b32 v119, 0
    v_mov_b32 v120, 0
    v_mov_b32 v121, 0
    v_mov_b32 v122, 0
    v_mov_b32 v123, 0
    v_mov_b32 v124, 0
    v_mov_b32 v125, 0
    v_mov_b32 v126, 0
    v_mov_b32 v127, 0
    v_mov_b32 v128, 0
    v_mov_b32 v129, 0
    v_mov_b32 v130, 0
    v_mov_b32 v131, 0
L_vm_27:
    buffer_load_dwordx4 v[132:135], v39, s[4:7], s46 offen offset:0 sc1
    buffer_load_dwordx4 v[136:139], v39, s[4:7], s46 offen offset:1024 sc1
    buffer_load_dwordx4 v[140:143], v39, s[4:7], s46 offen offset:2048 sc1
    s_sub_u32 s36, s36, 1
    s_cbranch_scc1 L_exit
    s_waitcnt vmcnt(0)
    v_max3_u32 v44, v132, v133, v134
    v_max3_u32 v45, v135, v136, v137
    v_max3_u32 v44, v44, v138, v139
    v_max3_u32 v45, v45, v140, v141
    v_max3_u32 v44, v44, v142, v143
    v_max_u32 v44, v44, v45
    v_cmp_eq_u32 vcc, -1, v44
    s_cbranch_vccnz L_vm_27
    v_smfmac_f32_16x16x64_bf16 v[144:147], v[132:135], a[0:7], v10
    v_smfmac_f32_16x16x64_bf16 v[144:147], v[136:139], a[8:15], v10
    v_smfmac_f32_16x16x64_bf16 v[144:147], v[140:143], a[16:23], v10
    v_smfmac_f32_16x16x64_bf16 v[148:151], v[132:135], a[24:31], v10
    v_smfmac_f32_16x16x64_bf16 v[148:151], v[136:139], a[32:39], v10
    v_smfmac_f32_16x16x64_bf16 v[148:151], v[140:143], a[40:47], v10
    v_smfmac_f32_16x16x64_bf16 v[152:155], v[132:135], a[48:55], v10
    v_smfmac_f32_16x16x64_bf16 v[152:155], v[136:139], a[56:63], v10
    v_smfmac_f32_16x16x64_bf16 v[152:155], v[140:143], a[64:71], v10
    v_smfmac_f32_16x16x64_bf16 v[156:159], v[132:135], a[72:79], v10
    v_smfmac_f32_16x16x64_bf16 v[156:159], v[136:139], a[80:87], v10
    v_smfmac_f32_16x16x64_bf16 v[156:159], v[140:143], a[88:95], v10
    buffer_load_dwordx4 v[96:99], v40, s[4:7], s45 offen offset:0 sc1
    buffer_load_dword v108, v41, s[4:7], s45 offen offset:0 sc1
    buffer_load_dwordx4 v[100:103], v40, s[4:7], s45 offen offset:1280 sc1
    buffer_load_dword v109, v41, s[4:7], s45 offen offset:1280 sc1
    buffer_load_dwordx4 v[104:107], v40, s[4:7], s45 offen offset:2560 sc1
    buffer_load_dword v110, v41, s[4:7], s45 offen offset:2560 sc1
    v_pk_add_f32 v[144:145], v[144:145], v[146:147]
    v_cvt_pk_bf16_f32 v50, v144, v145
    v_cvt_pk_bf16_f32 v54, v144, v145
    ds_write_b32 v27, v50 offset:8
    v_pk_add_f32 v[148:149], v[148:149], v[150:151]
    v_cvt_pk_bf16_f32 v58, v148, v149
    v_cvt_pk_bf16_f32 v62, v148, v149
    ds_write_b32 v27, v58 offset:6152
    v_pk_add_f32 v[152:153], v[152:153], v[154:155]
    v_cvt_pk_bf16_f32 v66, v152, v153
    v_cvt_pk_bf16_f32 v70, v152, v153
    ds_write_b32 v27, v66 offset:12296
    v_pk_add_f32 v[156:157], v[156:157], v[158:159]
    v_cvt_pk_bf16_f32 v74, v156, v157
    v_cvt_pk_bf16_f32 v78, v156, v157
    ds_write_b32 v27, v74 offset:18440
    s_cmp_eq_u32 s37, 63
    s_cbranch_scc1 L_wo_tail_f
L_sc_28:
    s_waitcnt vmcnt(0)
    v_pk_add_f32 v[232:233], v[96:97], v[100:101]
    v_pk_add_f32 v[234:235], v[98:99], v[102:103]
    v_add_f32 v46, v108, v109
    v_pk_add_f32 v[232:233], v[232:233], v[104:105]
    v_pk_add_f32 v[234:235], v[234:235], v[106:107]
    v_add_f32 v46, v46, v110
    v_max3_f32 v44, v232, v233, v234
    v_max3_f32 v44, v44, v235, v46
    v_pk_add_f32 v[242:243], v[232:233], v[234:235]
    v_add_f32 v242, v242, v46
    v_max_f32_dpp v45, v44, v44 quad_perm:[2,3,0,1] row_mask:0xf bank_mask:0xf
    v_max_f32_dpp v44, v44, v44 quad_perm:[2,3,0,1] row_mask:0xf bank_mask:0xf
    v_cmp_u_f32 vcc, v242, v243
    s_nop 0
    v_permlane16_swap_b32 v44, v45
    v_max_f32 v44, v44, v45
    v_mov_b32 v45, v44
    s_cbranch_vccnz L_sp_29
L_sg_30:
    s_nop 0
    v_permlane32_swap_b32 v44, v45
    v_max_f32 v44, v44, v45
    v_mul_f32 v242, 0xbdd53b95, v44
    v_pk_fma_f32 v[232:233], v[232:233], v[240:241], v[242:243] op_sel_hi:[1,1,0]
    v_pk_fma_f32 v[234:235], v[234:235], v[240:241], v[242:243] op_sel_hi:[1,1,0]
    v_fma_f32 v46, v46, v240, v242
    v_exp_f32 v232, v232
    v_exp_f32 v233, v233
    v_exp_f32 v234, v234
    v_exp_f32 v235, v235
    v_exp_f32 v46, v46
    v_cvt_pk_bf16_f32 v80, v232, v233
    v_cvt_pk_bf16_f32 v82, v234, v235
    v_cvt_pk_bf16_f32 v81, v46, 0
    v_cvt_pk_bf16_f32 v83, v46, 0
    s_nop 1
    v_smfmac_f32_16x16x64_bf16 v[112:115], v[80:83], v[84:91], v11
    v_smfmac_f32_16x16x64_bf16 v[116:119], v[80:83], v[48:55], v11
    v_smfmac_f32_16x16x64_bf16 v[120:123], v[80:83], v[56:63], v11
    v_smfmac_f32_16x16x64_bf16 v[124:127], v[80:83], v[64:71], v11
    v_smfmac_f32_16x16x64_bf16 v[128:131], v[80:83], v[72:79], v11
    s_nop 3
    v_pk_add_f32 v[112:113], v[112:113], v[114:115]
    v_rcp_f32 v112, v112
    v_rcp_f32 v113, v113
    v_pk_add_f32 v[116:117], v[116:117], v[118:119]
    v_pk_add_f32 v[120:121], v[120:121], v[122:123]
    v_pk_add_f32 v[124:125], v[124:125], v[126:127]
    v_pk_add_f32 v[128:129], v[128:129], v[130:131]
    v_pk_mul_f32 v[116:117], v[116:117], v[112:113]
    v_cvt_pk_bf16_f32 v232, v116, v117
    v_pk_mul_f32 v[120:121], v[120:121], v[112:113]
    v_cvt_pk_bf16_f32 v233, v120, v121
    ds_write2st64_b32 v19, v232, v233 offset0:0 offset1:1
    v_pk_mul_f32 v[124:125], v[124:125], v[112:113]
    v_cvt_pk_bf16_f32 v234, v124, v125
    v_pk_mul_f32 v[128:129], v[128:129], v[112:113]
    v_cvt_pk_bf16_f32 v235, v128, v129
    ds_write2st64_b32 v19, v234, v235 offset0:2 offset1:3
    s_waitcnt lgkmcnt(0)
    s_barrier
    ds_read_b128 v[236:239], v20
    s_waitcnt lgkmcnt(0)
    v_mfma_f32_16x16x32_bf16 v[168:171], v[92:95], v[236:239], 0
    s_nop 7
    v_cvt_pk_bf16_f32 v46, v168, v169
    buffer_store_dword v46, v14, s[4:7], s41 offen sc1
    buffer_store_dword v46, v15, s[4:7], s41 offen sc1
    buffer_store_dword v43, v14, s[4:7], s42 offen sc1
    buffer_store_dword v43, v15, s[4:7], s42 offen sc1
    buffer_store_dwordx4 v[216:219], v32, s[4:7], s49 offen sc1
    buffer_store_dwordx4 v[220:223], v32, s[4:7], s50 offen sc1
    v_mfma_f32_16x16x32_bf16 v[144:147], a[96:99], a[0:3], 0
    v_mfma_f32_16x16x32_bf16 v[148:151], a[120:123], a[0:3], 0
    v_mfma_f32_16x16x32_bf16 v[144:147], a[100:103], a[4:7], v[144:147]
    v_mfma_f32_16x16x32_bf16 v[148:151], a[124:127], a[4:7], v[148:151]
    v_mfma_f32_16x16x32_bf16 v[144:147], a[104:107], a[8:11], v[144:147]
    v_mfma_f32_16x16x32_bf16 v[148:151], a[128:131], a[8:11], v[148:151]
    v_mfma_f32_16x16x32_bf16 v[144:147], a[108:111], a[12:15], v[144:147]
    v_mfma_f32_16x16x32_bf16 v[148:151], a[132:135], a[12:15], v[148:151]
    v_mfma_f32_16x16x32_bf16 v[144:147], a[112:115], a[16:19], v[144:147]
    v_mfma_f32_16x16x32_bf16 v[148:151], a[136:139], a[16:19], v[148:151]
    v_mfma_f32_16x16x32_bf16 v[144:147], a[116:119], a[20:23], v[144:147]
    v_mfma_f32_16x16x32_bf16 v[148:151], a[140:143], a[20:23], v[148:151]
    v_mfma_f32_16x16x32_bf16 v[152:155], a[96:99], a[24:27], 0
    v_mfma_f32_16x16x32_bf16 v[156:159], a[120:123], a[24:27], 0
    v_mfma_f32_16x16x32_bf16 v[152:155], a[100:103], a[28:31], v[152:155]
    v_mfma_f32_16x16x32_bf16 v[156:159], a[124:127], a[28:31], v[156:159]
    v_mfma_f32_16x16x32_bf16 v[152:155], a[104:107], a[32:35], v[152:155]
    v_mfma_f32_16x16x32_bf16 v[156:159], a[128:131], a[32:35], v[156:159]
    v_mfma_f32_16x16x32_bf16 v[152:155], a[108:111], a[36:39], v[152:155]
    v_mfma_f32_16x16x32_bf16 v[156:159], a[132:135], a[36:39], v[156:159]
    v_cvt_pk_bf16_f32 v48, v144, v145
    v_cvt_pk_bf16_f32 v49, v146, v147
    v_mfma_f32_16x16x32_bf16 v[152:155], a[112:115], a[40:43], v[152:155]
    v_cvt_pk_bf16_f32 v52, v148, v149
    v_cvt_pk_bf16_f32 v53, v150, v151
    v_mfma_f32_16x16x32_bf16 v[156:159], a[136:139], a[40:43], v[156:159]
    ds_write_b64 v25, v[48:49] offset:0
    ds_write_b64 v26, v[52:53] offset:0
    v_mfma_f32_16x16x32_bf16 v[152:155], a[116:119], a[44:47], v[152:155]
    v_mfma_f32_16x16x32_bf16 v[156:159], a[140:143], a[44:47], v[156:159]
    v_mfma_f32_16x16x32_bf16 v[144:147], a[96:99], a[48:51], 0
    v_mfma_f32_16x16x32_bf16 v[148:151], a[120:123], a[48:51], 0
    v_mfma_f32_16x16x32_bf16 v[144:147], a[100:103], a[52:55], v[144:147]
    v_mfma_f32_16x16x32_bf16 v[148:151], a[124:127], a[52:55], v[148:151]
    v_mfma_f32_16x16x32_bf16 v[144:147], a[104:107], a[56:59], v[144:147]
    v_mfma_f32_16x16x32_bf16 v[148:151], a[128:131], a[56:59], v[148:151]
    buffer_load_dwordx4 v[160:163], v16, s[4:7], s41 offen sc1
    buffer_load_dwordx4 v[164:167], v17, s[4:7], s41 offen sc1
    v_mfma_f32_16x16x32_bf16 v[144:147], a[108:111], a[60:63], v[144:147]
    v_mfma_f32_16x16x32_bf16 v[148:151], a[132:135], a[60:63], v[148:151]
    v_cvt_pk_bf16_f32 v56, v152, v153
    v_cvt_pk_bf16_f32 v57, v154, v155
    v_mfma_f32_16x16x32_bf16 v[144:147], a[112:115], a[64:67], v[144:147]
    v_cvt_pk_bf16_f32 v60, v156, v157
    v_cvt_pk_bf16_f32 v61, v158, v159
    v_mfma_f32_16x16x32_bf16 v[148:151], a[136:139], a[64:67], v[148:151]
    ds_write_b64 v25, v[56:57] offset:6144
    ds_write_b64 v26, v[60:61] offset:6144
    v_mfma_f32_16x16x32_bf16 v[144:147], a[116:119], a[68:71], v[144:147]
    v_mfma_f32_16x16x32_bf16 v[148:151], a[140:143], a[68:71], v[148:151]
    v_mfma_f32_16x16x32_bf16 v[152:155], a[96:99], a[72:75], 0
    v_mfma_f32_16x16x32_bf16 v[156:159], a[120:123], a[72:75], 0
    v_mfma_f32_16x16x32_bf16 v[152:155], a[100:103], a[76:79], v[152:155]
    v_mfma_f32_16x16x32_bf16 v[156:159], a[124:127], a[76:79], v[156:159]
    v_mfma_f32_16x16x32_bf16 v[152:155], a[104:107], a[80:83], v[152:155]
    v_mfma_f32_16x16x32_bf16 v[156:159], a[128:131], a[80:83], v[156:159]
    v_mfma_f32_16x16x32_bf16 v[152:155], a[108:111], a[84:87], v[152:155]
    v_mfma_f32_16x16x32_bf16 v[156:159], a[132:135], a[84:87], v[156:159]
    v_cvt_pk_bf16_f32 v64, v144, v145
    v_cvt_pk_bf16_f32 v65, v146, v147
    v_mfma_f32_16x16x32_bf16 v[152:155], a[112:115], a[88:91], v[152:155]
    v_cvt_pk_bf16_f32 v68, v148, v149
    v_cvt_pk_bf16_f32 v69, v150, v151
    v_mfma_f32_16x16x32_bf16 v[156:159], a[136:139], a[88:91], v[156:159]
    ds_write_b64 v25, v[64:65] offset:12288
    ds_write_b64 v26, v[68:69] offset:12288
    v_mfma_f32_16x16x32_bf16 v[152:155], a[116:119], a[92:95], v[152:155]
    v_mfma_f32_16x16x32_bf16 v[156:159], a[140:143], a[92:95], v[156:159]
    s_nop 6
    v_cvt_pk_bf16_f32 v72, v152, v153
    v_cvt_pk_bf16_f32 v73, v154, v155
    v_cvt_pk_bf16_f32 v76, v156, v157
    v_cvt_pk_bf16_f32 v77, v158, v159
    ds_write_b64 v25, v[72:73] offset:18432
    ds_write_b64 v26, v[76:77] offset:18432
L_pc_32:
    s_waitcnt vmcnt(0)
    v_mfma_f32_16x16x32_bf16 v[172:175], v[92:95], v[160:163], v[168:171]
    v_mfma_f32_16x16x32_bf16 v[172:175], v[92:95], v[164:167], v[172:175]
    v_max3_u32 v44, v160, v161, v162
    v_max3_u32 v45, v163, v164, v165
    v_max3_u32 v44, v44, v166, v167
    v_max_u32 v44, v44, v45
    v_cmp_eq_u32 vcc, -1, v44
    s_cbranch_vccnz L_pp_31
    s_nop 1
    v_cvt_pk_bf16_f32 v46, v172, v173
    buffer_store_dword v46, v18, s[4:7], s43 offen
    buffer_store_dword v43, v18, s[4:7], s44 offen
    s_add_u32 s37, s37, 1
    s_branch L_wo_loop_f
L_wo_tail_f:
    buffer_store_dwordx4 v[216:219], v32, s[4:7], s49 offen sc1
    buffer_store_dwordx4 v[220:223], v32, s[4:7], s50 offen sc1
    s_waitcnt vmcnt(0) lgkmcnt(0)
    s_barrier
    v_mov_b32 v37, -1000
    s_mov_b32 s91, 63
    v_writelane_b32 v37, s91, 12
    buffer_load_dword v38, v35, s[4:7], s38 offen sc1
    s_mov_b32 s93, 61
    s_and_b32 s90, s93, 3
    s_mul_i32 s90, s90, 24576
    v_add_u32 v28, s90, v23
    v_add_u32 v29, s90, v24
    s_and_b32 s90, s93, 1
    s_mul_i32 s90, s90, 12288
    v_add_u32 v31, s90, v30
    s_and_b32 s90, s93, 7
    s_mul_i32 s90, s90, 655360
    s_add_u32 s49, s90, 2097152
    s_add_u32 s50, s49, 32768
    ds_read_b128 v[200:203], v28 offset:0
    ds_read_b128 v[176:179], v31 offset:0
    ds_read_b128 v[180:183], v31 offset:1024
    ds_read_b64 v[204:205], v29 offset:0
    ds_read_b128 v[184:187], v31 offset:2048
    ds_read_b128 v[208:211], v28 offset:1536
    ds_read_b128 v[188:191], v31 offset:3072
    ds_read_b128 v[192:195], v31 offset:4096
    ds_read_b64 v[212:213], v29 offset:1536
    ds_read_b128 v[196:199], v31 offset:5120
    s_waitcnt lgkmcnt(5)
    v_mfma_f32_16x16x32_bf16 v[216:219], v[200:203], v[176:179], 0
    v_mfma_f32_16x16x32_bf16 v[220:223], v[200:203], v[180:183], 0
    v_mfma_f32_16x16x32_bf16 v[220:223], v[204:207], v[184:187], v[220:223]
    ds_read_b128 v[200:203], v28 offset:3072
    ds_read_b128 v[176:179], v31 offset:6144
    ds_read_b128 v[180:183], v31 offset:7168
    ds_read_b64 v[204:205], v29 offset:3072
    ds_read_b128 v[184:187], v31 offset:8192
    s_waitcnt lgkmcnt(5)
    v_mfma_f32_16x16x32_bf16 v[216:219], v[208:211], v[188:191], v[216:219]
    v_mfma_f32_16x16x32_bf16 v[220:223], v[208:211], v[192:195], v[220:223]
    v_mfma_f32_16x16x32_bf16 v[220:223], v[212:215], v[196:199], v[220:223]
    ds_read_b128 v[208:211], v28 offset:4608
    ds_read_b128 v[188:191], v31 offset:9216
    ds_read_b128 v[192:195], v31 offset:10240
    ds_read_b64 v[212:213], v29 offset:4608
    ds_read_b128 v[196:199], v31 offset:11264
    s_waitcnt lgkmcnt(5)
    v_mfma_f32_16x16x32_bf16 v[216:219], v[200:203], v[176:179], v[216:219]
    v_mfma_f32_16x16x32_bf16 v[220:223], v[200:203], v[180:183], v[220:223]
    v_mfma_f32_16x16x32_bf16 v[220:223], v[204:207], v[184:187], v[220:223]
    s_waitcnt lgkmcnt(0)
    v_mfma_f32_16x16x32_bf16 v[216:219], v[208:211], v[188:191], v[216:219]
    v_mfma_f32_16x16x32_bf16 v[220:223], v[208:211], v[192:195], v[220:223]
    v_mfma_f32_16x16x32_bf16 v[220:223], v[212:215], v[196:199], v[220:223]
    s_nop 5
    buffer_store_dwordx4 v[216:219], v32, s[4:7], s49 offen sc1
    s_nop 0
    buffer_store_dwordx4 v[220:223], v32, s[4:7], s50 offen sc1
    s_mov_b32 s93, 62
    s_and_b32 s90, s93, 7
    s_mul_i32 s90, s90, 12288
    s_add_u32 s90, s90, 253952
    s_add_u32 s48, s38, s90
    s_and_b32 s90, s93, 1
    s_mul_i32 s90, s90, 12288
    s_add_u32 m0, s54, s90
    s_waitcnt vmcnt(2)
    v_cmp_lt_i32 vcc, v38, v37
    s_cbranch_vccz L_fok_36
L_fw_35:
    buffer_load_dword v38, v35, s[4:7], s38 offen sc1
    s_sub_u32 s36, s36, 1
    s_cbranch_scc1 L_exit
    s_waitcnt vmcnt(0)
    v_cmp_lt_i32 vcc, v38, v37
    s_cbranch_vccnz L_fw_35
L_fok_36:
    buffer_load_dwordx4 v39, s[4:7], s48 offen offset:0 sc1 lds
    buffer_load_dwordx4 v39, s[4:7], s48 offen offset:1024 sc1 lds
    buffer_load_dwordx4 v39, s[4:7], s48 offen offset:2048 sc1 lds
    s_waitcnt vmcnt(0) lgkmcnt(0)
    s_barrier
    v_mov_b32 v37, -1000
    s_mov_b32 s91, 64
    v_writelane_b32 v37, s91, 13
    buffer_load_dword v38, v35, s[4:7], s38 offen sc1
    s_mov_b32 s93, 62
    s_and_b32 s90, s93, 3
    s_mul_i32 s90, s90, 24576
    v_add_u32 v28, s90, v23
    v_add_u32 v29, s90, v24
    s_and_b32 s90, s93, 1
    s_mul_i32 s90, s90, 12288
    v_add_u32 v31, s90, v30
    s_and_b32 s90, s93, 7
    s_mul_i32 s90, s90, 655360
    s_add_u32 s49, s90, 2097152
    s_add_u32 s50, s49, 32768
    ds_read_b128 v[200:203], v28 offset:0
    ds_read_b128 v[176:179], v31 offset:0
    ds_read_b128 v[180:183], v31 offset:1024
    ds_read_b64 v[204:205], v29 offset:0
    ds_read_b128 v[184:187], v31 offset:2048
    ds_read_b128 v[208:211], v28 offset:1536
    ds_read_b128 v[188:191], v31 offset:3072
    ds_read_b128 v[192:195], v31 offset:4096
    ds_read_b64 v[212:213], v29 offset:1536
    ds_read_b128 v[196:199], v31 offset:5120
    s_waitcnt lgkmcnt(5)
    v_mfma_f32_16x16x32_bf16 v[216:219], v[200:203], v[176:179], 0
    v_mfma_f32_16x16x32_bf16 v[220:223], v[200:203], v[180:183], 0
    v_mfma_f32_16x16x32_bf16 v[220:223], v[204:207], v[184:187], v[220:223]
    ds_read_b128 v[200:203], v28 offset:3072
    ds_read_b128 v[176:179], v31 offset:6144
    ds_read_b128 v[180:183], v31 offset:7168
    ds_read_b64 v[204:205], v29 offset:3072
    ds_read_b128 v[184:187], v31 offset:8192
    s_waitcnt lgkmcnt(5)
    v_mfma_f32_16x16x32_bf16 v[216:219], v[208:211], v[188:191], v[216:219]
    v_mfma_f32_16x16x32_bf16 v[220:223], v[208:211], v[192:195], v[220:223]
    v_mfma_f32_16x16x32_bf16 v[220:223], v[212:215], v[196:199], v[220:223]
    ds_read_b128 v[208:211], v28 offset:4608
    ds_read_b128 v[188:191], v31 offset:9216
    ds_read_b128 v[192:195], v31 offset:10240
    ds_read_b64 v[212:213], v29 offset:4608
    ds_read_b128 v[196:199], v31 offset:11264
    s_waitcnt lgkmcnt(5)
    v_mfma_f32_16x16x32_bf16 v[216:219], v[200:203], v[176:179], v[216:219]
    v_mfma_f32_16x16x32_bf16 v[220:223], v[200:203], v[180:183], v[220:223]
    v_mfma_f32_16x16x32_bf16 v[220:223], v[204:207], v[184:187], v[220:223]
    s_waitcnt lgkmcnt(0)
    v_mfma_f32_16x16x32_bf16 v[216:219], v[208:211], v[188:191], v[216:219]
    v_mfma_f32_16x16x32_bf16 v[220:223], v[208:211], v[192:195], v[220:223]
    v_mfma_f32_16x16x32_bf16 v[220:223], v[212:215], v[196:199], v[220:223]
    s_nop 5
    buffer_store_dwordx4 v[216:219], v32, s[4:7], s49 offen sc1
    s_nop 0
    buffer_store_dwordx4 v[220:223], v32, s[4:7], s50 offen sc1
    s_mov_b32 s93, 63
    s_and_b32 s90, s93, 7
    s_mul_i32 s90, s90, 12288
    s_add_u32 s90, s90, 253952
    s_add_u32 s48, s38, s90
    s_and_b32 s90, s93, 1
    s_mul_i32 s90, s90, 12288
    s_add_u32 m0, s54, s90
    s_waitcnt vmcnt(2)
    v_cmp_lt_i32 vcc, v38, v37
    s_cbranch_vccz L_fok_38
L_fw_37:
    buffer_load_dword v38, v35, s[4:7], s38 offen sc1
    s_sub_u32 s36, s36, 1
    s_cbranch_scc1 L_exit
    s_waitcnt vmcnt(0)
    v_cmp_lt_i32 vcc, v38, v37
    s_cbranch_vccnz L_fw_37
L_fok_38:
    buffer_load_dwordx4 v39, s[4:7], s48 offen offset:0 sc1 lds
    buffer_load_dwordx4 v39, s[4:7], s48 offen offset:1024 sc1 lds
    buffer_load_dwordx4 v39, s[4:7], s48 offen offset:2048 sc1 lds
    s_waitcnt vmcnt(0) lgkmcnt(0)
    s_barrier
    s_mov_b32 s93, 63
    s_and_b32 s90, s93, 3
    s_mul_i32 s90, s90, 24576
    v_add_u32 v28, s90, v23
    v_add_u32 v29, s90, v24
    s_and_b32 s90, s93, 1
    s_mul_i32 s90, s90, 12288
    v_add_u32 v31, s90, v30
    s_and_b32 s90, s93, 7
    s_mul_i32 s90, s90, 655360
    s_add_u32 s49, s90, 2097152
    s_add_u32 s50, s49, 32768
    ds_read_b128 v[200:203], v28 offset:0
    ds_read_b128 v[176:179], v31 offset:0
    ds_read_b128 v[180:183], v31 offset:1024
    ds_read_b64 v[204:205], v29 offset:0
    ds_read_b128 v[184:187], v31 offset:2048
    ds_read_b128 v[208:211], v28 offset:1536
    ds_read_b128 v[188:191], v31 offset:3072
    ds_read_b128 v[192:195], v31 offset:4096
    ds_read_b64 v[212:213], v29 offset:1536
    ds_read_b128 v[196:199], v31 offset:5120
    s_waitcnt lgkmcnt(5)
    v_mfma_f32_16x16x32_bf16 v[216:219], v[200:203], v[176:179], 0
    v_mfma_f32_16x16x32_bf16 v[220:223], v[200:203], v[180:183], 0
    v_mfma_f32_16x16x32_bf16 v[220:223], v[204:207], v[184:187], v[220:223]
    ds_read_b128 v[200:203], v28 offset:3072
    ds_read_b128 v[176:179], v31 offset:6144
    ds_read_b128 v[180:183], v31 offset:7168
    ds_read_b64 v[204:205], v29 offset:3072
    ds_read_b128 v[184:187], v31 offset:8192
    s_waitcnt lgkmcnt(5)
    v_mfma_f32_16x16x32_bf16 v[216:219], v[208:211], v[188:191], v[216:219]
    v_mfma_f32_16x16x32_bf16 v[220:223], v[208:211], v[192:195], v[220:223]
    v_mfma_f32_16x16x32_bf16 v[220:223], v[212:215], v[196:199], v[220:223]
    ds_read_b128 v[208:211], v28 offset:4608
    ds_read_b128 v[188:191], v31 offset:9216
    ds_read_b128 v[192:195], v31 offset:10240
    ds_read_b64 v[212:213], v29 offset:4608
    ds_read_b128 v[196:199], v31 offset:11264
    s_waitcnt lgkmcnt(5)
    v_mfma_f32_16x16x32_bf16 v[216:219], v[200:203], v[176:179], v[216:219]
    v_mfma_f32_16x16x32_bf16 v[220:223], v[200:203], v[180:183], v[220:223]
    v_mfma_f32_16x16x32_bf16 v[220:223], v[204:207], v[184:187], v[220:223]
    s_waitcnt lgkmcnt(0)
    v_mfma_f32_16x16x32_bf16 v[216:219], v[208:211], v[188:191], v[216:219]
    v_mfma_f32_16x16x32_bf16 v[220:223], v[208:211], v[192:195], v[220:223]
    v_mfma_f32_16x16x32_bf16 v[220:223], v[212:215], v[196:199], v[220:223]
    s_nop 5
    buffer_store_dwordx4 v[216:219], v32, s[4:7], s49 offen sc1
    s_nop 0
    buffer_store_dwordx4 v[220:223], v32, s[4:7], s50 offen sc1
    s_waitcnt vmcnt(0)
    s_barrier
    v_mov_b32 v46, 0
    buffer_store_dword v46, v14, s[4:7], s41 offen sc1
    buffer_store_dword v46, v15, s[4:7], s41 offen sc1
    s_waitcnt vmcnt(0)
    buffer_load_dwordx4 v[160:163], v16, s[4:7], s41 offen sc1
    buffer_load_dwordx4 v[164:167], v17, s[4:7], s41 offen sc1
L_pc_40:
    s_waitcnt vmcnt(0)
    v_mfma_f32_16x16x32_bf16 v[172:175], v[92:95], v[160:163], v[168:171]
    v_mfma_f32_16x16x32_bf16 v[172:175], v[92:95], v[164:167], v[172:175]
    v_max3_u32 v44, v160, v161, v162
    v_max3_u32 v45, v163, v164, v165
    v_max3_u32 v44, v44, v166, v167
    v_max_u32 v44, v44, v45
    v_cmp_eq_u32 vcc, -1, v44
    s_cbranch_vccnz L_pp_39
    s_mov_b32 s93, 59
    s_and_b32 s90, s93, 7
    s_mul_i32 s90, s90, 655360
    s_add_u32 s51, s90, 2097152
    s_mul_i32 s52, s93, 81920
    buffer_load_dwordx4 v[224:227], v33, s[4:7], s51 offen sc1
    buffer_load_dwordx4 v[228:231], v33, s[4:7], s51 offen offset:1024 sc1
    s_waitcnt vmcnt(0)
    v_pk_add_f32 v[224:225], v[224:225], v[228:229]
    v_pk_add_f32 v[226:227], v[226:227], v[230:231]
    s_nop 1
    v_permlane32_swap_b32 v224, v226
    v_permlane32_swap_b32 v225, v227
    v_pk_add_f32 v[224:225], v[224:225], v[226:227]
    s_nop 1
    v_permlane16_swap_b32 v224, v225
    v_add_f32 v224, v224, v225
    v_cvt_pk_bf16_f32 v224, v224, v224
    buffer_store_short v224, v34, s[28:31], s52 offen
    s_mov_b32 s93, 60
    s_and_b32 s90, s93, 7
    s_mul_i32 s90, s90, 655360
    s_add_u32 s51, s90, 2097152
    s_mul_i32 s52, s93, 81920
    buffer_load_dwordx4 v[224:227], v33, s[4:7], s51 offen sc1
    buffer_load_dwordx4 v[228:231], v33, s[4:7], s51 offen offset:1024 sc1
    s_waitcnt vmcnt(0)
    v_pk_add_f32 v[224:225], v[224:225], v[228:229]
    v_pk_add_f32 v[226:227], v[226:227], v[230:231]
    s_nop 1
    v_permlane32_swap_b32 v224, v226
    v_permlane32_swap_b32 v225, v227
    v_pk_add_f32 v[224:225], v[224:225], v[226:227]
    s_nop 1
    v_permlane16_swap_b32 v224, v225
    v_add_f32 v224, v224, v225
    v_cvt_pk_bf16_f32 v224, v224, v224
    buffer_store_short v224, v34, s[28:31], s52 offen
    s_mov_b32 s93, 61
    s_and_b32 s90, s93, 7
    s_mul_i32 s90, s90, 655360
    s_add_u32 s51, s90, 2097152
    s_mul_i32 s52, s93, 81920
    buffer_load_dwordx4 v[224:227], v33, s[4:7], s51 offen sc1
    buffer_load_dwordx4 v[228:231], v33, s[4:7], s51 offen offset:1024 sc1
    s_waitcnt vmcnt(0)
    v_pk_add_f32 v[224:225], v[224:225], v[228:229]
    v_pk_add_f32 v[226:227], v[226:227], v[230:231]
    s_nop 1
    v_permlane32_swap_b32 v224, v226
    v_permlane32_swap_b32 v225, v227
    v_pk_add_f32 v[224:225], v[224:225], v[226:227]
    s_nop 1
    v_permlane16_swap_b32 v224, v225
    v_add_f32 v224, v224, v225
    v_cvt_pk_bf16_f32 v224, v224, v224
    buffer_store_short v224, v34, s[28:31], s52 offen
    s_mov_b32 s93, 62
    s_and_b32 s90, s93, 7
    s_mul_i32 s90, s90, 655360
    s_add_u32 s51, s90, 2097152
    s_mul_i32 s52, s93, 81920
    buffer_load_dwordx4 v[224:227], v33, s[4:7], s51 offen sc1
    buffer_load_dwordx4 v[228:231], v33, s[4:7], s51 offen offset:1024 sc1
    s_waitcnt vmcnt(0)
    v_pk_add_f32 v[224:225], v[224:225], v[228:229]
    v_pk_add_f32 v[226:227], v[226:227], v[230:231]
    s_nop 1
    v_permlane32_swap_b32 v224, v226
    v_permlane32_swap_b32 v225, v227
    v_pk_add_f32 v[224:225], v[224:225], v[226:227]
    s_nop 1
    v_permlane16_swap_b32 v224, v225
    v_add_f32 v224, v224, v225
    v_cvt_pk_bf16_f32 v224, v224, v224
    buffer_store_short v224, v34, s[28:31], s52 offen
    s_mov_b32 s93, 63
    s_and_b32 s90, s93, 7
    s_mul_i32 s90, s90, 655360
    s_add_u32 s51, s90, 2097152
    s_mul_i32 s52, s93, 81920
    buffer_load_dwordx4 v[224:227], v33, s[4:7], s51 offen sc1
    buffer_load_dwordx4 v[228:231], v33, s[4:7], s51 offen offset:1024 sc1
    s_waitcnt vmcnt(0)
    v_pk_add_f32 v[224:225], v[224:225], v[228:229]
    v_pk_add_f32 v[226:227], v[226:227], v[230:231]
    s_nop 1
    v_permlane32_swap_b32 v224, v226
    v_permlane32_swap_b32 v225, v227
    v_pk_add_f32 v[224:225], v[224:225], v[226:227]
    s_nop 1
    v_permlane16_swap_b32 v224, v225
    v_add_f32 v224, v224, v225
    v_cvt_pk_bf16_f32 v224, v224, v224
    buffer_store_short v224, v34, s[28:31], s52 offen
    s_endpgm
L_sp_29:
    v_max3_u32 v4, v108, v109, v110
    v_max3_u32 v4, v4, v96, v97
    v_max3_u32 v4, v4, v98, v99
    v_max3_u32 v4, v4, v100, v101
    v_max3_u32 v4, v4, v102, v103
    v_max3_u32 v4, v4, v104, v105
    v_max3_u32 v4, v4, v106, v107
    v_cmp_eq_u32 vcc, -1, v4
    s_cbranch_vccz L_sg_30
    buffer_load_dwordx4 v[96:99], v40, s[4:7], s45 offen offset:0 sc1
    buffer_load_dword v108, v41, s[4:7], s45 offen offset:0 sc1
    buffer_load_dwordx4 v[100:103], v40, s[4:7], s45 offen offset:1280 sc1
    buffer_load_dword v109, v41, s[4:7], s45 offen offset:1280 sc1
    buffer_load_dwordx4 v[104:107], v40, s[4:7], s45 offen offset:2560 sc1
    buffer_load_dword v110, v41, s[4:7], s45 offen offset:2560 sc1
    s_sub_u32 s36, s36, 1
    s_cbranch_scc1 L_exit
    s_branch L_sc_28
L_pp_31:
    buffer_load_dwordx4 v[160:163], v16, s[4:7], s41 offen sc1
    buffer_load_dwordx4 v[164:167], v17, s[4:7], s41 offen sc1
    s_sub_u32 s36, s36, 1
    s_cbranch_scc1 L_exit
    s_branch L_pc_32
L_pp_39:
    buffer_load_dwordx4 v[160:163], v16, s[4:7], s41 offen sc1
    buffer_load_dwordx4 v[164:167], v17, s[4:7], s41 offen sc1
    s_sub_u32 s36, s36, 1
    s_cbranch_scc1 L_exit
    s_branch L_pc_40
L_px_f:
    s_sub_u32 s40, s35, 22
    v_and_b32 v1, 15, v0
    v_lshrrev_b32 v2, 4, v0
    s_mul_i32 s90, s32, 12288
    v_lshl_add_u32 v10, v0, 4, s90
    s_mul_i32 s90, s32, 3072
    v_lshl_add_u32 v12, v0, 4, s90
    v_lshrrev_b32 v3, 2, v1
    v_lshlrev_b32 v3, 1, v3
    v_and_b32 v4, 1, v1
    v_or_b32 v3, v3, v4
    v_lshl_add_u32 v3, v2, 3, v3
    v_lshl_add_u32 v11, v3, 4, s90
    s_lshl_b32 s90, s32, 7
    v_min_u32 v3, 11, v0
    v_lshl_add_u32 v3, v3, 2, s90
    v_add_u32 v13, 151552, v3
    v_min_u32 v3, 2, v0
    v_lshl_add_u32 v3, v3, 2, s90
    v_add_u32 v14, 152064, v3
    s_lshl_b32 s91, s40, 2
    s_add_u32 s90, s90, s91
    s_add_u32 s90, s90, 152576
    v_mov_b32 v15, s90
    v_cmp_eq_u32 vcc, 0, v0
    v_mov_b32 v9, 2146435072
    s_nop 0
    v_cndmask_b32 v15, v9, v15, vcc
    v_mov_b32 v22, 0
    buffer_store_dword v22, v15, s[4:7], s38 offen
    v_mov_b32 v21, 0xd04e79ff
    s_mov_b32 s44, 0x3dd53b95
    v_lshl_add_u32 v3, v2, 2, 0
    v_cmp_le_u32 s[48:49], v3, v1
    v_lshl_add_u32 v3, v2, 2, 1
    v_cmp_le_u32 s[50:51], v3, v1
    v_lshl_add_u32 v3, v2, 2, 2
    v_cmp_le_u32 s[52:53], v3, v1
    v_lshl_add_u32 v3, v2, 2, 3
    v_cmp_le_u32 s[54:55], v3, v1
    v_mov_b32 v167, 0
    v_mov_b32 v171, 0
    v_mov_b32 v174, 0
    v_mov_b32 v175, 0
    s_waitcnt vmcnt(0)
    s_barrier
    s_cmp_lg_u32 s32, 0
    s_cbranch_scc1 L_arr_43
    s_and_b32 s90, s33, 4
    s_lshl_b32 s90, s90, 5
    s_add_u32 s90, s90, 64
    v_mov_b32 v1, s90
    v_mov_b32 v2, 1
    s_mov_b64 exec, 1
    buffer_atomic_add v2, v1, s[8:11], 0 offen sc1
    s_mov_b64 exec, -1
L_arr_43:
    v_lshlrev_b32 v1, 2, v0
L_gw_44:
    buffer_load_dword v2, v1, s[8:11], 0 offen sc1
    s_sub_u32 s36, s36, 1
    s_cbranch_scc1 L_exit
    s_waitcnt vmcnt(0)
    v_readlane_b32 s90, v2, 16
    v_readlane_b32 s91, v2, 48
    s_nop 0
    s_add_u32 s90, s90, s91
    s_cmp_lg_u32 s90, 256
    s_cbranch_scc1 L_gw_44
    v_cmp_eq_u32 s[90:91], 32, v2
    s_nop 0
    s_and_b32 s90, s90, s91
    s_and_b32 s90, s90, 15
    s_cmp_lg_u32 s90, 15
    s_cbranch_scc1 L_slow
    s_mov_b32 s37, s40
L_px_loop_f:
    s_and_b32 s90, s37, 7
    s_mul_i32 s91, s90, 49152
    s_add_u32 s41, s38, s91
    s_mul_i32 s91, s90, 12288
    s_add_u32 s91, s91, s38
    s_add_u32 s42, s91, 155648
    s_add_u32 s43, s91, 253952
    s_add_u32 s90, s37, 1
    v_mov_b32 v17, s90
L_pf_45:
    buffer_load_dword v16, v13, s[4:7], s38 offen sc1
    s_sub_u32 s36, s36, 1
    s_cbranch_scc1 L_exit
    s_waitcnt vmcnt(0)
    v_cmp_ge_u32 vcc, s37, v16
    s_cbranch_vccnz L_pf_45
    s_add_u32 s90, s41, 393216
    buffer_load_dwordx4 v[24:27], v10, s[4:7], s90 offen offset:0 sc1
    buffer_load_dwordx4 v[28:31], v10, s[4:7], s90 offen offset:1024 sc1
    buffer_load_dwordx4 v[32:35], v10, s[4:7], s90 offen offset:2048 sc1
    buffer_load_dwordx4 v[36:39], v10, s[4:7], s90 offen offset:3072 sc1
    s_add_u32 s90, s41, 397312
    buffer_load_dwordx4 v[40:43], v10, s[4:7], s90 offen offset:0 sc1
    buffer_load_dwordx4 v[44:47], v10, s[4:7], s90 offen offset:1024 sc1
    buffer_load_dwordx4 v[48:51], v10, s[4:7], s90 offen offset:2048 sc1
    buffer_load_dwordx4 v[52:55], v10, s[4:7], s90 offen offset:3072 sc1
    s_add_u32 s90, s41, 401408
    buffer_load_dwordx4 v[56:59], v10, s[4:7], s90 offen offset:0 sc1
    buffer_load_dwordx4 v[60:63], v10, s[4:7], s90 offen offset:1024 sc1
    buffer_load_dwordx4 v[64:67], v10, s[4:7], s90 offen offset:2048 sc1
    buffer_load_dwordx4 v[68:71], v10, s[4:7], s90 offen offset:3072 sc1
    s_add_u32 s90, s41, 786432
    buffer_load_dwordx4 v[72:75], v10, s[4:7], s90 offen offset:0 sc1
    buffer_load_dwordx4 v[76:79], v10, s[4:7], s90 offen offset:1024 sc1
    buffer_load_dwordx4 v[80:83], v10, s[4:7], s90 offen offset:2048 sc1
    buffer_load_dwordx4 v[84:87], v10, s[4:7], s90 offen offset:3072 sc1
    s_add_u32 s90, s41, 790528
    buffer_load_dwordx4 v[88:91], v10, s[4:7], s90 offen offset:0 sc1
    buffer_load_dwordx4 v[92:95], v10, s[4:7], s90 offen offset:1024 sc1
    buffer_load_dwordx4 v[96:99], v10, s[4:7], s90 offen offset:2048 sc1
    buffer_load_dwordx4 v[100:103], v10, s[4:7], s90 offen offset:3072 sc1
    s_add_u32 s90, s41, 794624
    buffer_load_dwordx4 v[104:107], v10, s[4:7], s90 offen offset:0 sc1
    buffer_load_dwordx4 v[108:111], v10, s[4:7], s90 offen offset:1024 sc1
    buffer_load_dwordx4 v[112:115], v10, s[4:7], s90 offen offset:2048 sc1
    buffer_load_dwordx4 v[116:119], v10, s[4:7], s90 offen offset:3072 sc1
    s_waitcnt vmcnt(0)
    v_mfma_f32_16x16x32_bf16 v[144:147], v[72:75], v[24:27], 0
    v_mfma_f32_16x16x32_bf16 v[152:155], v[72:75], v[48:51], 0
    v_mfma_f32_16x16x32_bf16 v[156:159], v[96:99], v[48:51], 0
    v_mfma_f32_16x16x32_bf16 v[144:147], v[76:79], v[28:31], v[144:147]
    v_mfma_f32_16x16x32_bf16 v[152:155], v[76:79], v[52:55], v[152:155]
    v_mfma_f32_16x16x32_bf16 v[156:159], v[100:103], v[52:55], v[156:159]
    v_mfma_f32_16x16x32_bf16 v[144:147], v[80:83], v[32:35], v[144:147]
    v_mfma_f32_16x16x32_bf16 v[152:155], v[80:83], v[56:59], v[152:155]
    v_mfma_f32_16x16x32_bf16 v[156:159], v[104:107], v[56:59], v[156:159]
    v_mfma_f32_16x16x32_bf16 v[144:147], v[84:87], v[36:39], v[144:147]
    v_mfma_f32_16x16x32_bf16 v[152:155], v[84:87], v[60:63], v[152:155]
    v_mfma_f32_16x16x32_bf16 v[156:159], v[108:111], v[60:63], v[156:159]
    v_mfma_f32_16x16x32_bf16 v[144:147], v[88:91], v[40:43], v[144:147]
    v_mfma_f32_16x16x32_bf16 v[152:155], v[88:91], v[64:67], v[152:155]
    v_mfma_f32_16x16x32_bf16 v[156:159], v[112:115], v[64:67], v[156:159]
    v_mfma_f32_16x16x32_bf16 v[144:147], v[92:95], v[44:47], v[144:147]
    v_mfma_f32_16x16x32_bf16 v[152:155], v[92:95], v[68:71], v[152:155]
    v_mfma_f32_16x16x32_bf16 v[156:159], v[116:119], v[68:71], v[156:159]
    s_nop 5
    v_cndmask_b32 v144, v21, v144, s[48:49]
    v_cndmask_b32 v145, v21, v145, s[50:51]
    v_cndmask_b32 v146, v21, v146, s[52:53]
    v_cndmask_b32 v147, v21, v147, s[54:55]
    v_cndmask_b32 v156, v21, v156, s[48:49]
    v_cndmask_b32 v157, v21, v157, s[50:51]
    v_cndmask_b32 v158, v21, v158, s[52:53]
    v_cndmask_b32 v159, v21, v159, s[54:55]
L_pf_46:
    buffer_load_dword v16, v14, s[4:7], s38 offen sc1
    s_sub_u32 s36, s36, 1
    s_cbranch_scc1 L_exit
    s_waitcnt vmcnt(0)
    v_cmp_ge_u32 vcc, s37, v16
    s_cbranch_vccnz L_pf_46
    buffer_load_dwordx4 v[120:123], v11, s[4:7], s42 offen offset:0 sc1
    buffer_load_dwordx4 v[124:127], v11, s[4:7], s42 offen offset:512 sc1
    buffer_load_dwordx4 v[128:131], v11, s[4:7], s42 offen offset:1024 sc1
    buffer_load_dwordx4 v[132:135], v11, s[4:7], s42 offen offset:1536 sc1
    buffer_load_dwordx4 v[136:139], v11, s[4:7], s42 offen offset:2048 sc1
    buffer_load_dwordx4 v[140:143], v11, s[4:7], s42 offen offset:2560 sc1
    s_waitcnt vmcnt(5)
    v_mfma_f32_16x16x32_bf16 v[148:151], v[120:123], v[24:27], 0
    v_mfma_f32_16x16x32_bf16 v[160:163], v[120:123], v[48:51], 0
    s_waitcnt vmcnt(4)
    v_mfma_f32_16x16x32_bf16 v[148:151], v[124:127], v[28:31], v[148:151]
    v_mfma_f32_16x16x32_bf16 v[160:163], v[124:127], v[52:55], v[160:163]
    s_waitcnt vmcnt(3)
    v_mfma_f32_16x16x32_bf16 v[148:151], v[128:131], v[32:35], v[148:151]
    v_mfma_f32_16x16x32_bf16 v[160:163], v[128:131], v[56:59], v[160:163]
    s_waitcnt vmcnt(2)
    v_mfma_f32_16x16x32_bf16 v[148:151], v[132:135], v[36:39], v[148:151]
    v_mfma_f32_16x16x32_bf16 v[160:163], v[132:135], v[60:63], v[160:163]
    s_waitcnt vmcnt(1)
    v_mfma_f32_16x16x32_bf16 v[148:151], v[136:139], v[40:43], v[148:151]
    v_mfma_f32_16x16x32_bf16 v[160:163], v[136:139], v[64:67], v[160:163]
    s_waitcnt vmcnt(0)
    v_mfma_f32_16x16x32_bf16 v[148:151], v[140:143], v[44:47], v[148:151]
    v_mfma_f32_16x16x32_bf16 v[160:163], v[140:143], v[68:71], v[160:163]
    v_max_f32 v18, v144, v145
    v_max3_f32 v18, v18, v146, v147
    s_nop 4
    v_max3_f32 v18, v18, v148, v149
    v_mov_b32 v19, v18
    s_nop 1
    v_permlane16_swap_b32 v18, v19
    v_max_f32 v18, v18, v19
    v_mov_b32 v19, v18
    s_nop 1
    v_permlane32_swap_b32 v18, v19
    v_max_f32 v18, v18, v19
    v_mul_f32 v18, 0xbdd53b95, v18
    v_fma_f32 v144, v144, s44, v18
    v_fma_f32 v145, v145, s44, v18
    v_fma_f32 v146, v146, s44, v18
    v_fma_f32 v147, v147, s44, v18
    v_fma_f32 v148, v148, s44, v18
    v_fma_f32 v149, v149, s44, v18
    v_exp_f32 v144, v144
    v_exp_f32 v145, v145
    v_exp_f32 v146, v146
    v_exp_f32 v147, v147
    v_exp_f32 v148, v148
    v_exp_f32 v149, v149
    v_add_f32 v20, v144, v145
    v_add_f32 v20, v20, v146
    v_add_f32 v20, v20, v147
    v_add_f32 v20, v20, v148
    v_add_f32 v20, v20, v149
    v_mov_b32 v19, v20
    s_nop 1
    v_permlane16_swap_b32 v20, v19
    v_add_f32 v20, v20, v19
    v_mov_b32 v19, v20
    s_nop 1
    v_permlane32_swap_b32 v20, v19
    v_add_f32 v20, v20, v19
    v_rcp_f32 v20, v20
    s_nop 0
    v_mul_f32 v144, v144, v20
    v_mul_f32 v145, v145, v20
    v_mul_f32 v146, v146, v20
    v_mul_f32 v147, v147, v20
    v_mul_f32 v148, v148, v20
    v_mul_f32 v149, v149, v20
    v_cvt_pk_bf16_f32 v164, v144, v145
    v_cvt_pk_bf16_f32 v165, v146, v147
    v_cvt_pk_bf16_f32 v166, v148, v149
    v_max_f32 v18, v152, v153
    v_max3_f32 v18, v18, v154, v155
    v_max3_f32 v18, v18, v160, v161
    v_max3_f32 v18, v18, v156, v157
    v_max3_f32 v18, v18, v158, v159
    v_mov_b32 v19, v18
    s_nop 1
    v_permlane16_swap_b32 v18, v19
    v_max_f32 v18, v18, v19
    v_mov_b32 v19, v18
    s_nop 1
    v_permlane32_swap_b32 v18, v19
    v_max_f32 v18, v18, v19
    v_mul_f32 v18, 0xbdd53b95, v18
    v_fma_f32 v152, v152, s44, v18
    v_fma_f32 v153, v153, s44, v18
    v_fma_f32 v154, v154, s44, v18
    v_fma_f32 v155, v155, s44, v18
    v_fma_f32 v160, v160, s44, v18
    v_fma_f32 v161, v161, s44, v18
    v_fma_f32 v156, v156, s44, v18
    v_fma_f32 v157, v157, s44, v18
    v_fma_f32 v158, v158, s44, v18
    v_fma_f32 v159, v159, s44, v18
    v_exp_f32 v152, v152
    v_exp_f32 v153, v153
    v_exp_f32 v154, v154
    v_exp_f32 v155, v155
    v_exp_f32 v160, v160
    v_exp_f32 v161, v161
    v_exp_f32 v156, v156
    v_exp_f32 v157, v157
    v_exp_f32 v158, v158
    v_exp_f32 v159, v159
    v_add_f32 v20, v152, v153
    v_add_f32 v20, v20, v154
    v_add_f32 v20, v20, v155
    v_add_f32 v20, v20, v160
    v_add_f32 v20, v20, v161
    v_add_f32 v20, v20, v156
    v_add_f32 v20, v20, v157
    v_add_f32 v20, v20, v158
    v_add_f32 v20, v20, v159
    v_mov_b32 v19, v20
    s_nop 1
    v_permlane16_swap_b32 v20, v19
    v_add_f32 v20, v20, v19
    v_mov_b32 v19, v20
    s_nop 1
    v_permlane32_swap_b32 v20, v19
    v_add_f32 v20, v20, v19
    v_rcp_f32 v20, v20
    s_nop 0
    v_mul_f32 v152, v152, v20
    v_mul_f32 v153, v153, v20
    v_mul_f32 v154, v154, v20
    v_mul_f32 v155, v155, v20
    v_mul_f32 v160, v160, v20
    v_mul_f32 v161, v161, v20
    v_mul_f32 v156, v156, v20
    v_mul_f32 v157, v157, v20
    v_mul_f32 v158, v158, v20
    v_mul_f32 v159, v159, v20
    v_cvt_pk_bf16_f32 v168, v152, v153
    v_cvt_pk_bf16_f32 v169, v154, v155
    v_cvt_pk_bf16_f32 v170, v160, v161
    v_cvt_pk_bf16_f32 v172, v156, v157
    v_cvt_pk_bf16_f32 v173, v158, v159
    buffer_store_dwordx4 v[164:167], v12, s[4:7], s43 offen offset:0
    buffer_store_dwordx4 v[168:171], v12, s[4:7], s43 offen offset:1024
    buffer_store_dwordx4 v[172:175], v12, s[4:7], s43 offen offset:2048
    s_waitcnt vmcnt(0)
    buffer_store_dword v17, v15, s[4:7], s38 offen
    s_add_u32 s37, s37, 2
    s_cmp_lt_u32 s37, 64
    s_cbranch_scc1 L_px_loop_f
    s_endpgm
L_pa_f:
    s_cmp_lg_u32 s32, 0
    s_cbranch_scc1 L_arr_47
    s_and_b32 s90, s33, 4
    s_lshl_b32 s90, s90, 5
    s_add_u32 s90, s90, 64
    v_mov_b32 v1, s90
    v_mov_b32 v2, 1
    s_mov_b64 exec, 1
    buffer_atomic_add v2, v1, s[8:11], 0 offen sc1
    s_mov_b64 exec, -1
L_arr_47:
    v_lshlrev_b32 v1, 2, v0
L_gw_48:
    buffer_load_dword v2, v1, s[8:11], 0 offen sc1
    s_sub_u32 s36, s36, 1
    s_cbranch_scc1 L_exit
    s_waitcnt vmcnt(0)
    v_readlane_b32 s90, v2, 16
    v_readlane_b32 s91, v2, 48
    s_nop 0
    s_add_u32 s90, s90, s91
    s_cmp_lg_u32 s90, 256
    s_cbranch_scc1 L_gw_48
    v_cmp_eq_u32 s[90:91], 32, v2
    s_nop 0
    s_and_b32 s90, s90, s91
    s_and_b32 s90, s90, 15
    s_cmp_lg_u32 s90, 15
    s_cbranch_scc1 L_slow
    s_branch L_pa_body
L_pa_body:
    s_mov_b32 s12, s64
    s_and_b32 s13, s65, 0xffff
    s_mov_b32 s14, 2621440
    s_mov_b32 s15, 0x20000
    s_mov_b32 s16, s66
    s_and_b32 s17, s67, 0xffff
    s_mov_b32 s18, 2457600
    s_mov_b32 s19, 0x20000
    s_mov_b32 s20, s68
    s_and_b32 s21, s69, 0xffff
    s_mov_b32 s22, 819200
    s_mov_b32 s23, 0x20000
    v_and_b32 v1, 15, v0
    v_lshrrev_b32 v2, 4, v0
    s_lshl_b32 s40, s34, 3
    s_add_u32 s40, s40, s35
    s_sub_u32 s40, s40, 24
    s_lshl_b32 s40, s40, 5
    s_add_u32 s90, s40, -16
    v_add_u32 v3, s90, v1
    v_cmp_le_i32 vcc, 0, v3
    v_mul_u32_u24 v3, 1280, v3
    v_lshl_add_u32 v3, v2, 4, v3
    v_mov_b32 v4, 2146435072
    v_cndmask_b32 v3, v4, v3, vcc
    buffer_load_dwordx4 a[0:3], v3, s[12:15], 0 offen offset:0
    buffer_load_dwordx4 a[4:7], v3, s[12:15], 0 offen offset:64
    buffer_load_dwordx4 a[8:11], v3, s[12:15], 0 offen offset:128
    buffer_load_dwordx4 a[12:15], v3, s[12:15], 0 offen offset:192
    buffer_load_dwordx4 a[16:19], v3, s[12:15], 0 offen offset:256
    buffer_load_dwordx4 a[20:23], v3, s[12:15], 0 offen offset:320
    buffer_load_dwordx4 a[24:27], v3, s[12:15], 0 offen offset:384
    buffer_load_dwordx4 a[28:31], v3, s[12:15], 0 offen offset:448
    buffer_load_dwordx4 a[32:35], v3, s[12:15], 0 offen offset:512
    buffer_load_dwordx4 a[36:39], v3, s[12:15], 0 offen offset:576
    buffer_load_dwordx4 a[40:43], v3, s[12:15], 0 offen offset:640
    buffer_load_dwordx4 a[44:47], v3, s[12:15], 0 offen offset:704
    buffer_load_dwordx4 a[48:51], v3, s[12:15], 0 offen offset:768
    buffer_load_dwordx4 a[52:55], v3, s[12:15], 0 offen offset:832
    buffer_load_dwordx4 a[56:59], v3, s[12:15], 0 offen offset:896
    buffer_load_dwordx4 a[60:63], v3, s[12:15], 0 offen offset:960
    buffer_load_dwordx4 a[64:67], v3, s[12:15], 0 offen offset:1024
    buffer_load_dwordx4 a[68:71], v3, s[12:15], 0 offen offset:1088
    buffer_load_dwordx4 a[72:75], v3, s[12:15], 0 offen offset:1152
    buffer_load_dwordx4 a[76:79], v3, s[12:15], 0 offen offset:1216
    s_add_u32 s90, s40, 0
    v_add_u32 v3, s90, v1
    v_cmp_le_i32 vcc, 0, v3
    v_mul_u32_u24 v3, 1280, v3
    v_lshl_add_u32 v3, v2, 4, v3
    v_mov_b32 v4, 2146435072
    v_cndmask_b32 v3, v4, v3, vcc
    buffer_load_dwordx4 a[80:83], v3, s[12:15], 0 offen offset:0
    buffer_load_dwordx4 a[84:87], v3, s[12:15], 0 offen offset:64
    buffer_load_dwordx4 a[88:91], v3, s[12:15], 0 offen offset:128
    buffer_load_dwordx4 a[92:95], v3, s[12:15], 0 offen offset:192
    buffer_load_dwordx4 a[96:99], v3, s[12:15], 0 offen offset:256
    buffer_load_dwordx4 a[100:103], v3, s[12:15], 0 offen offset:320
    buffer_load_dwordx4 a[104:107], v3, s[12:15], 0 offen offset:384
    buffer_load_dwordx4 a[108:111], v3, s[12:15], 0 offen offset:448
    buffer_load_dwordx4 a[112:115], v3, s[12:15], 0 offen offset:512
    buffer_load_dwordx4 a[116:119], v3, s[12:15], 0 offen offset:576
    buffer_load_dwordx4 a[120:123], v3, s[12:15], 0 offen offset:640
    buffer_load_dwordx4 a[124:127], v3, s[12:15], 0 offen offset:704
    buffer_load_dwordx4 a[128:131], v3, s[12:15], 0 offen offset:768
    buffer_load_dwordx4 a[132:135], v3, s[12:15], 0 offen offset:832
    buffer_load_dwordx4 a[136:139], v3, s[12:15], 0 offen offset:896
    buffer_load_dwordx4 a[140:143], v3, s[12:15], 0 offen offset:960
    buffer_load_dwordx4 a[144:147], v3, s[12:15], 0 offen offset:1024
    buffer_load_dwordx4 a[148:151], v3, s[12:15], 0 offen offset:1088
    buffer_load_dwordx4 a[152:155], v3, s[12:15], 0 offen offset:1152
    buffer_load_dwordx4 a[156:159], v3, s[12:15], 0 offen offset:1216
    s_add_u32 s90, s40, 16
    v_add_u32 v3, s90, v1
    v_cmp_le_i32 vcc, 0, v3
    v_mul_u32_u24 v3, 1280, v3
    v_lshl_add_u32 v3, v2, 4, v3
    v_mov_b32 v4, 2146435072
    v_cndmask_b32 v3, v4, v3, vcc
    buffer_load_dwordx4 a[160:163], v3, s[12:15], 0 offen offset:0
    buffer_load_dwordx4 a[164:167], v3, s[12:15], 0 offen offset:64
    buffer_load_dwordx4 a[168:171], v3, s[12:15], 0 offen offset:128
    buffer_load_dwordx4 a[172:175], v3, s[12:15], 0 offen offset:192
    buffer_load_dwordx4 a[176:179], v3, s[12:15], 0 offen offset:256
    buffer_load_dwordx4 a[180:183], v3, s[12:15], 0 offen offset:320
    buffer_load_dwordx4 a[184:187], v3, s[12:15], 0 offen offset:384
    buffer_load_dwordx4 a[188:191], v3, s[12:15], 0 offen offset:448
    buffer_load_dwordx4 a[192:195], v3, s[12:15], 0 offen offset:512
    buffer_load_dwordx4 a[196:199], v3, s[12:15], 0 offen offset:576
    buffer_load_dwordx4 a[200:203], v3, s[12:15], 0 offen offset:640
    buffer_load_dwordx4 a[204:207], v3, s[12:15], 0 offen offset:704
    buffer_load_dwordx4 a[208:211], v3, s[12:15], 0 offen offset:768
    buffer_load_dwordx4 a[212:215], v3, s[12:15], 0 offen offset:832
    buffer_load_dwordx4 a[216:219], v3, s[12:15], 0 offen offset:896
    buffer_load_dwordx4 a[220:223], v3, s[12:15], 0 offen offset:960
    buffer_load_dwordx4 a[224:227], v3, s[12:15], 0 offen offset:1024
    buffer_load_dwordx4 a[228:231], v3, s[12:15], 0 offen offset:1088
    buffer_load_dwordx4 a[232:235], v3, s[12:15], 0 offen offset:1152
    buffer_load_dwordx4 a[236:239], v3, s[12:15], 0 offen offset:1216
    v_lshrrev_b32 v3, 3, v0
    v_and_b32 v4, 7, v0
    s_lshl_b32 s90, s32, 3
    v_add_u32 v5, s90, v3
    s_and_b32 s91, s32, 1
    s_lshl_b32 s91, s91, 2
    v_and_b32 v6, 2, v3
    v_or_b32 v6, s91, v6
    v_xor_b32 v6, v6, v4
    v_lshlrev_b32 v6, 4, v6
    v_mul_u32_u24 v7, 3840, v5
    v_add_u32 v10, v6, v7
    v_mul_u32_u24 v7, 1280, v5
    v_add_u32 v11, v6, v7
    v_lshrrev_b32 v3, 2, v1
    v_and_b32 v4, 3, v1
    v_and_b32 v5, 1, v2
    v_lshl_add_u32 v6, v2, 3, v3
    v_lshlrev_b32 v6, 7, v6
    v_and_b32 v7, 2, v3
    v_lshl_or_b32 v7, v5, 2, v7
    v_lshrrev_b32 v8, 1, v4
    s_lshl_b32 s90, s32, 1
    v_or_b32 v8, s90, v8
    v_xor_b32 v7, v7, v8
    v_lshl_add_u32 v6, v7, 4, v6
    v_and_b32 v7, 1, v4
    v_lshl_add_u32 v12, v7, 3, v6
    s_lshl_b32 s90, s32, 5
    v_lshl_add_u32 v6, v2, 3, s90
    v_mul_u32_u24 v7, 1296, v1
    v_add_u32 v14, v6, v7
    v_add_u32 v14, 49152, v14
    v_lshl_add_u32 v26, v2, 4, v7
    v_add_u32 v26, 49152, v26
    v_mul_u32_u24 v7, 648, v1
    v_add_u32 v15, v6, v7
    v_add_u32 v15, 90624, v15
    v_lshl_add_u32 v6, v5, 4, v1
    v_add_u32 v6, s40, v6
    v_mul_u32_u24 v6, 2560, v6
    v_lshrrev_b32 v7, 1, v2
    v_lshl_add_u32 v6, v7, 4, v6
    v_add_u32 v17, s90, v6
    v_and_b32 v3, 31, v0
    v_add_u32 v22, s40, v3
    v_lshrrev_b32 v4, 5, v0
    s_lshl_b32 s90, s32, 2
    v_add_u32 v4, s90, v4
    v_mul_u32_u24 v4, 40, v4
    v_mul_u32_u24 v5, 1296, v3
    v_add_u32 v5, v5, v4
    v_add_u32 v18, 49152, v5
    v_mul_u32_u24 v5, 648, v3
    v_add_u32 v5, v5, v4
    v_add_u32 v19, 91920, v5
    v_mov_b32 v25, 0xcf8547b1
    s_mov_b32 s47, 0x3ea52b5c
    s_mov_b32 s46, 0
L_pa_half:
    s_mul_i32 s42, s46, 640
    s_waitcnt vmcnt(0) lgkmcnt(0)
    s_barrier
    s_mov_b32 s44, 0
    s_mov_b32 s45, 0
    s_mov_b32 s41, 0
    s_lshl_b32 s90, s32, 10
    s_add_u32 m0, s90, s45
    s_add_u32 s91, s42, 0
    buffer_load_dwordx4 v10, s[16:19], s91 offen lds
    s_add_u32 m0, m0, 4096
    s_add_u32 s91, s91, 122880
    buffer_load_dwordx4 v10, s[16:19], s91 offen lds
    s_add_u32 m0, m0, 4096
    s_add_u32 s91, s91, 122880
    buffer_load_dwordx4 v10, s[16:19], s91 offen lds
    s_add_u32 m0, m0, 4096
    s_add_u32 s91, s91, 122880
    buffer_load_dwordx4 v10, s[16:19], s91 offen lds
    s_add_u32 s45, s45, 16384
    s_cmp_eq_u32 s45, 49152
    s_cselect_b32 s45, 0, s45
    s_lshl_b32 s90, s32, 10
    s_add_u32 m0, s90, s45
    s_add_u32 s91, s42, 491520
    buffer_load_dwordx4 v10, s[16:19], s91 offen lds
    s_add_u32 m0, m0, 4096
    s_add_u32 s91, s91, 122880
    buffer_load_dwordx4 v10, s[16:19], s91 offen lds
    s_add_u32 m0, m0, 4096
    s_add_u32 s91, s91, 122880
    buffer_load_dwordx4 v10, s[16:19], s91 offen lds
    s_add_u32 m0, m0, 4096
    s_add_u32 s91, s91, 122880
    buffer_load_dwordx4 v10, s[16:19], s91 offen lds
    s_add_u32 s45, s45, 16384
    s_cmp_eq_u32 s45, 49152
    s_cselect_b32 s45, 0, s45
L_pa_blk:
    s_add_u32 s43, s42, 128
    s_add_u32 s90, s42, 768
    s_cmp_eq_u32 s41, 4
    s_cselect_b32 s43, s90, s43
    s_cmp_eq_u32 s41, 9
    s_cselect_b32 s43, s90, s43
    s_cmp_eq_u32 s41, 14
    s_cselect_b32 s43, s42, s43
    v_add_u32 v13, s44, v12
    s_waitcnt vmcnt(4)
    s_barrier
    ds_read_b64_tr_b16 v[28:29], v13 offset:0
    ds_read_b64_tr_b16 v[30:31], v13 offset:512
    ds_read_b64_tr_b16 v[32:33], v13 offset:4096
    ds_read_b64_tr_b16 v[34:35], v13 offset:4608
    ds_read_b64_tr_b16 v[36:37], v13 offset:8192
    ds_read_b64_tr_b16 v[38:39], v13 offset:8704
    ds_read_b64_tr_b16 v[40:41], v13 offset:12288
    ds_read_b64_tr_b16 v[42:43], v13 offset:12800
    s_lshl_b32 s90, s32, 10
    s_add_u32 m0, s90, s45
    s_add_u32 s91, s42, 983040
    buffer_load_dwordx4 v10, s[16:19], s91 offen lds
    s_add_u32 m0, m0, 4096
    s_add_u32 s91, s91, 122880
    buffer_load_dwordx4 v10, s[16:19], s91 offen lds
    s_add_u32 m0, m0, 4096
    s_add_u32 s91, s91, 122880
    buffer_load_dwordx4 v10, s[16:19], s91 offen lds
    s_add_u32 m0, m0, 4096
    s_add_u32 s91, s91, 122880
    buffer_load_dwordx4 v10, s[16:19], s91 offen lds
    s_add_u32 s45, s45, 16384
    s_cmp_eq_u32 s45, 49152
    s_cselect_b32 s45, 0, s45
    s_add_u32 s44, s44, 16384
    s_cmp_eq_u32 s44, 49152
    s_cselect_b32 s44, 0, s44
    s_waitcnt lgkmcnt(6)
    v_mfma_f32_16x16x32_bf16 v[44:47], v[28:31], a[0:3], 0
    v_mfma_f32_16x16x32_bf16 v[48:51], v[28:31], a[80:83], 0
    v_mfma_f32_16x16x32_bf16 v[52:55], v[28:31], a[160:163], 0
    s_waitcnt lgkmcnt(4)
    v_mfma_f32_16x16x32_bf16 v[44:47], v[32:35], a[4:7], v[44:47]
    v_mfma_f32_16x16x32_bf16 v[48:51], v[32:35], a[84:87], v[48:51]
    v_mfma_f32_16x16x32_bf16 v[52:55], v[32:35], a[164:167], v[52:55]
    s_waitcnt lgkmcnt(2)
    v_mfma_f32_16x16x32_bf16 v[44:47], v[36:39], a[8:11], v[44:47]
    v_mfma_f32_16x16x32_bf16 v[48:51], v[36:39], a[88:91], v[48:51]
    v_mfma_f32_16x16x32_bf16 v[52:55], v[36:39], a[168:171], v[52:55]
    s_waitcnt lgkmcnt(0)
    v_mfma_f32_16x16x32_bf16 v[44:47], v[40:43], a[12:15], v[44:47]
    v_mfma_f32_16x16x32_bf16 v[48:51], v[40:43], a[92:95], v[48:51]
    v_mfma_f32_16x16x32_bf16 v[52:55], v[40:43], a[172:175], v[52:55]
    v_add_u32 v13, s44, v12
    s_waitcnt vmcnt(4)
    s_barrier
    ds_read_b64_tr_b16 v[28:29], v13 offset:0
    ds_read_b64_tr_b16 v[30:31], v13 offset:512
    ds_read_b64_tr_b16 v[32:33], v13 offset:4096
    ds_read_b64_tr_b16 v[34:35], v13 offset:4608
    ds_read_b64_tr_b16 v[36:37], v13 offset:8192
    ds_read_b64_tr_b16 v[38:39], v13 offset:8704
    ds_read_b64_tr_b16 v[40:41], v13 offset:12288
    ds_read_b64_tr_b16 v[42:43], v13 offset:12800
    s_lshl_b32 s90, s32, 10
    s_add_u32 m0, s90, s45
    s_add_u32 s91, s42, 1474560
    buffer_load_dwordx4 v10, s[16:19], s91 offen lds
    s_add_u32 m0, m0, 4096
    s_add_u32 s91, s91, 122880
    buffer_load_dwordx4 v10, s[16:19], s91 offen lds
    s_add_u32 m0, m0, 4096
    s_add_u32 s91, s91, 122880
    buffer_load_dwordx4 v10, s[16:19], s91 offen lds
    s_add_u32 m0, m0, 4096
    s_add_u32 s91, s91, 122880
    buffer_load_dwordx4 v10, s[16:19], s91 offen lds
    s_add_u32 s45, s45, 16384
    s_cmp_eq_u32 s45, 49152
    s_cselect_b32 s45, 0, s45
    s_add_u32 s44, s44, 16384
    s_cmp_eq_u32 s44, 49152
    s_cselect_b32 s44, 0, s44
    s_waitcnt lgkmcnt(6)
    v_mfma_f32_16x16x32_bf16 v[44:47], v[28:31], a[16:19], v[44:47]
    v_mfma_f32_16x16x32_bf16 v[48:51], v[28:31], a[96:99], v[48:51]
    v_mfma_f32_16x16x32_bf16 v[52:55], v[28:31], a[176:179], v[52:55]
    s_waitcnt lgkmcnt(4)
    v_mfma_f32_16x16x32_bf16 v[44:47], v[32:35], a[20:23], v[44:47]
    v_mfma_f32_16x16x32_bf16 v[48:51], v[32:35], a[100:103], v[48:51]
    v_mfma_f32_16x16x32_bf16 v[52:55], v[32:35], a[180:183], v[52:55]
    s_waitcnt lgkmcnt(2)
    v_mfma_f32_16x16x32_bf16 v[44:47], v[36:39], a[24:27], v[44:47]
    v_mfma_f32_16x16x32_bf16 v[48:51], v[36:39], a[104:107], v[48:51]
    v_mfma_f32_16x16x32_bf16 v[52:55], v[36:39], a[184:187], v[52:55]
    s_waitcnt lgkmcnt(0)
    v_mfma_f32_16x16x32_bf16 v[44:47], v[40:43], a[28:31], v[44:47]
    v_mfma_f32_16x16x32_bf16 v[48:51], v[40:43], a[108:111], v[48:51]
    v_mfma_f32_16x16x32_bf16 v[52:55], v[40:43], a[188:191], v[52:55]
    v_add_u32 v13, s44, v12
    s_waitcnt vmcnt(4)
    s_barrier
    ds_read_b64_tr_b16 v[28:29], v13 offset:0
    ds_read_b64_tr_b16 v[30:31], v13 offset:512
    ds_read_b64_tr_b16 v[32:33], v13 offset:4096
    ds_read_b64_tr_b16 v[34:35], v13 offset:4608
    ds_read_b64_tr_b16 v[36:37], v13 offset:8192
    ds_read_b64_tr_b16 v[38:39], v13 offset:8704
    ds_read_b64_tr_b16 v[40:41], v13 offset:12288
    ds_read_b64_tr_b16 v[42:43], v13 offset:12800
    s_lshl_b32 s90, s32, 10
    s_add_u32 m0, s90, s45
    s_add_u32 s91, s42, 1966080
    buffer_load_dwordx4 v10, s[16:19], s91 offen lds
    s_add_u32 m0, m0, 4096
    s_add_u32 s91, s91, 122880
    buffer_load_dwordx4 v10, s[16:19], s91 offen lds
    s_add_u32 m0, m0, 4096
    s_add_u32 s91, s91, 122880
    buffer_load_dwordx4 v10, s[16:19], s91 offen lds
    s_add_u32 m0, m0, 4096
    s_add_u32 s91, s91, 122880
    buffer_load_dwordx4 v10, s[16:19], s91 offen lds
    s_add_u32 s45, s45, 16384
    s_cmp_eq_u32 s45, 49152
    s_cselect_b32 s45, 0, s45
    s_add_u32 s44, s44, 16384
    s_cmp_eq_u32 s44, 49152
    s_cselect_b32 s44, 0, s44
    s_waitcnt lgkmcnt(6)
    v_mfma_f32_16x16x32_bf16 v[44:47], v[28:31], a[32:35], v[44:47]
    v_mfma_f32_16x16x32_bf16 v[48:51], v[28:31], a[112:115], v[48:51]
    v_mfma_f32_16x16x32_bf16 v[52:55], v[28:31], a[192:195], v[52:55]
    s_waitcnt lgkmcnt(4)
    v_mfma_f32_16x16x32_bf16 v[44:47], v[32:35], a[36:39], v[44:47]
    v_mfma_f32_16x16x32_bf16 v[48:51], v[32:35], a[116:119], v[48:51]
    v_mfma_f32_16x16x32_bf16 v[52:55], v[32:35], a[196:199], v[52:55]
    s_waitcnt lgkmcnt(2)
    v_mfma_f32_16x16x32_bf16 v[44:47], v[36:39], a[40:43], v[44:47]
    v_mfma_f32_16x16x32_bf16 v[48:51], v[36:39], a[120:123], v[48:51]
    v_mfma_f32_16x16x32_bf16 v[52:55], v[36:39], a[200:203], v[52:55]
    s_waitcnt lgkmcnt(0)
    v_mfma_f32_16x16x32_bf16 v[44:47], v[40:43], a[44:47], v[44:47]
    v_mfma_f32_16x16x32_bf16 v[48:51], v[40:43], a[124:127], v[48:51]
    v_mfma_f32_16x16x32_bf16 v[52:55], v[40:43], a[204:207], v[52:55]
    v_add_u32 v13, s44, v12
    s_waitcnt vmcnt(4)
    s_barrier
    ds_read_b64_tr_b16 v[28:29], v13 offset:0
    ds_read_b64_tr_b16 v[30:31], v13 offset:512
    ds_read_b64_tr_b16 v[32:33], v13 offset:4096
    ds_read_b64_tr_b16 v[34:35], v13 offset:4608
    ds_read_b64_tr_b16 v[36:37], v13 offset:8192
    ds_read_b64_tr_b16 v[38:39], v13 offset:8704
    ds_read_b64_tr_b16 v[40:41], v13 offset:12288
    ds_read_b64_tr_b16 v[42:43], v13 offset:12800
    s_lshl_b32 s90, s32, 10
    s_add_u32 m0, s90, s45
    s_add_u32 s91, s43, 0
    buffer_load_dwordx4 v10, s[16:19], s91 offen lds
    s_add_u32 m0, m0, 4096
    s_add_u32 s91, s91, 122880
    buffer_load_dwordx4 v10, s[16:19], s91 offen lds
    s_add_u32 m0, m0, 4096
    s_add_u32 s91, s91, 122880
    buffer_load_dwordx4 v10, s[16:19], s91 offen lds
    s_add_u32 m0, m0, 4096
    s_add_u32 s91, s91, 122880
    buffer_load_dwordx4 v10, s[16:19], s91 offen lds
    s_add_u32 s45, s45, 16384
    s_cmp_eq_u32 s45, 49152
    s_cselect_b32 s45, 0, s45
    s_add_u32 s44, s44, 16384
    s_cmp_eq_u32 s44, 49152
    s_cselect_b32 s44, 0, s44
    s_waitcnt lgkmcnt(6)
    v_mfma_f32_16x16x32_bf16 v[44:47], v[28:31], a[48:51], v[44:47]
    v_mfma_f32_16x16x32_bf16 v[48:51], v[28:31], a[128:131], v[48:51]
    v_mfma_f32_16x16x32_bf16 v[52:55], v[28:31], a[208:211], v[52:55]
    s_waitcnt lgkmcnt(4)
    v_mfma_f32_16x16x32_bf16 v[44:47], v[32:35], a[52:55], v[44:47]
    v_mfma_f32_16x16x32_bf16 v[48:51], v[32:35], a[132:135], v[48:51]
    v_mfma_f32_16x16x32_bf16 v[52:55], v[32:35], a[212:215], v[52:55]
    s_waitcnt lgkmcnt(2)
    v_mfma_f32_16x16x32_bf16 v[44:47], v[36:39], a[56:59], v[44:47]
    v_mfma_f32_16x16x32_bf16 v[48:51], v[36:39], a[136:139], v[48:51]
    v_mfma_f32_16x16x32_bf16 v[52:55], v[36:39], a[216:219], v[52:55]
    s_waitcnt lgkmcnt(0)
    v_mfma_f32_16x16x32_bf16 v[44:47], v[40:43], a[60:63], v[44:47]
    v_mfma_f32_16x16x32_bf16 v[48:51], v[40:43], a[140:143], v[48:51]
    v_mfma_f32_16x16x32_bf16 v[52:55], v[40:43], a[220:223], v[52:55]
    v_add_u32 v13, s44, v12
    s_waitcnt vmcnt(4)
    s_barrier
    ds_read_b64_tr_b16 v[28:29], v13 offset:0
    ds_read_b64_tr_b16 v[30:31], v13 offset:512
    ds_read_b64_tr_b16 v[32:33], v13 offset:4096
    ds_read_b64_tr_b16 v[34:35], v13 offset:4608
    ds_read_b64_tr_b16 v[36:37], v13 offset:8192
    ds_read_b64_tr_b16 v[38:39], v13 offset:8704
    ds_read_b64_tr_b16 v[40:41], v13 offset:12288
    ds_read_b64_tr_b16 v[42:43], v13 offset:12800
    s_lshl_b32 s90, s32, 10
    s_add_u32 m0, s90, s45
    s_add_u32 s91, s43, 491520
    buffer_load_dwordx4 v10, s[16:19], s91 offen lds
    s_add_u32 m0, m0, 4096
    s_add_u32 s91, s91, 122880
    buffer_load_dwordx4 v10, s[16:19], s91 offen lds
    s_add_u32 m0, m0, 4096
    s_add_u32 s91, s91, 122880
    buffer_load_dwordx4 v10, s[16:19], s91 offen lds
    s_add_u32 m0, m0, 4096
    s_add_u32 s91, s91, 122880
    buffer_load_dwordx4 v10, s[16:19], s91 offen lds
    s_add_u32 s45, s45, 16384
    s_cmp_eq_u32 s45, 49152
    s_cselect_b32 s45, 0, s45
    s_add_u32 s44, s44, 16384
    s_cmp_eq_u32 s44, 49152
    s_cselect_b32 s44, 0, s44
    s_waitcnt lgkmcnt(6)
    v_mfma_f32_16x16x32_bf16 v[44:47], v[28:31], a[64:67], v[44:47]
    v_mfma_f32_16x16x32_bf16 v[48:51], v[28:31], a[144:147], v[48:51]
    v_mfma_f32_16x16x32_bf16 v[52:55], v[28:31], a[224:227], v[52:55]
    s_waitcnt lgkmcnt(4)
    v_mfma_f32_16x16x32_bf16 v[44:47], v[32:35], a[68:71], v[44:47]
    v_mfma_f32_16x16x32_bf16 v[48:51], v[32:35], a[148:151], v[48:51]
    v_mfma_f32_16x16x32_bf16 v[52:55], v[32:35], a[228:231], v[52:55]
    s_waitcnt lgkmcnt(2)
    v_mfma_f32_16x16x32_bf16 v[44:47], v[36:39], a[72:75], v[44:47]
    v_mfma_f32_16x16x32_bf16 v[48:51], v[36:39], a[152:155], v[48:51]
    v_mfma_f32_16x16x32_bf16 v[52:55], v[36:39], a[232:235], v[52:55]
    s_waitcnt lgkmcnt(0)
    v_mfma_f32_16x16x32_bf16 v[44:47], v[40:43], a[76:79], v[44:47]
    v_mfma_f32_16x16x32_bf16 v[48:51], v[40:43], a[156:159], v[48:51]
    v_mfma_f32_16x16x32_bf16 v[52:55], v[40:43], a[236:239], v[52:55]
    s_nop 5
    v_cvt_pk_bf16_f32 v56, v44, v45
    v_cvt_pk_bf16_f32 v57, v46, v47
    v_cvt_pk_bf16_f32 v58, v48, v49
    v_cvt_pk_bf16_f32 v59, v50, v51
    v_cvt_pk_bf16_f32 v60, v52, v53
    v_cvt_pk_bf16_f32 v61, v54, v55
    s_cmp_ge_u32 s41, 5
    s_cbranch_scc1 L_pa_kv
    v_add_u32 v16, s42, v14
    ds_write_b64 v16, v[58:59]
    ds_write_b64 v16, v[60:61] offset:20736
    s_branch L_pa_wr
L_pa_kv:
    s_sub_u32 s90, s41, 5
    s_lshl_b32 s90, s90, 7
    s_add_u32 s91, s90, 30464
    s_cmp_ge_u32 s41, 10
    s_cselect_b32 s90, s91, s90
    v_add_u32 v16, s90, v15
    ds_write_b64 v16, v[56:57]
    ds_write_b64 v16, v[58:59] offset:10368
    ds_write_b64 v16, v[60:61] offset:20736
L_pa_wr:
    s_waitcnt lgkmcnt(0)
    s_mov_b32 s42, s43
    s_add_u32 s41, s41, 1
    s_cmp_lt_u32 s41, 15
    s_cbranch_scc1 L_pa_blk
    s_barrier
    s_mov_b32 s48, 0
L_pa_att:
    s_mul_i32 s90, s48, 80
    v_add_u32 v21, s90, v19
    s_mul_i32 s91, s46, 640
    s_add_u32 s90, s90, s91
    v_add_u32 v20, s90, v18
    ds_read_b64 v[62:63], v20 offset:0
    ds_read_b64 v[64:65], v20 offset:8
    ds_read_b64 v[66:67], v20 offset:16
    ds_read_b64 v[68:69], v20 offset:24
    ds_read_b64 v[70:71], v20 offset:32
    ds_read_b64 v[72:73], v21 offset:9072
    ds_read_b64 v[74:75], v21 offset:9080
    ds_read_b64 v[76:77], v21 offset:9088
    ds_read_b64 v[78:79], v21 offset:9096
    ds_read_b64 v[80:81], v21 offset:9104
    ds_read_b64 v[82:83], v21 offset:7776
    ds_read_b64 v[84:85], v21 offset:7784
    ds_read_b64 v[86:87], v21 offset:7792
    ds_read_b64 v[88:89], v21 offset:7800
    ds_read_b64 v[90:91], v21 offset:7808
    s_waitcnt lgkmcnt(5)
    v_dot2_f32_bf16 v92, v62, v72, 0
    v_dot2_f32_bf16 v92, v63, v73, v92
    v_dot2_f32_bf16 v92, v64, v74, v92
    v_dot2_f32_bf16 v92, v65, v75, v92
    v_dot2_f32_bf16 v92, v66, v76, v92
    v_dot2_f32_bf16 v92, v67, v77, v92
    v_dot2_f32_bf16 v92, v68, v78, v92
    v_dot2_f32_bf16 v92, v69, v79, v92
    v_dot2_f32_bf16 v92, v70, v80, v92
    v_dot2_f32_bf16 v92, v71, v81, v92
    ds_read_b64 v[72:73], v21 offset:6480
    ds_read_b64 v[74:75], v21 offset:6488
    ds_read_b64 v[76:77], v21 offset:6496
    ds_read_b64 v[78:79], v21 offset:6504
    ds_read_b64 v[80:81], v21 offset:6512
    s_waitcnt lgkmcnt(5)
    v_dot2_f32_bf16 v93, v62, v82, 0
    v_dot2_f32_bf16 v93, v63, v83, v93
    v_dot2_f32_bf16 v93, v64, v84, v93
    v_dot2_f32_bf16 v93, v65, v85, v93
    v_dot2_f32_bf16 v93, v66, v86, v93
    v_dot2_f32_bf16 v93, v67, v87, v93
    v_dot2_f32_bf16 v93, v68, v88, v93
    v_dot2_f32_bf16 v93, v69, v89, v93
    v_dot2_f32_bf16 v93, v70, v90, v93
    v_dot2_f32_bf16 v93, v71, v91, v93
    ds_read_b64 v[82:83], v21 offset:5184
    ds_read_b64 v[84:85], v21 offset:5192
    ds_read_b64 v[86:87], v21 offset:5200
    ds_read_b64 v[88:89], v21 offset:5208
    ds_read_b64 v[90:91], v21 offset:5216
    s_waitcnt lgkmcnt(5)
    v_dot2_f32_bf16 v94, v62, v72, 0
    v_dot2_f32_bf16 v94, v63, v73, v94
    v_dot2_f32_bf16 v94, v64, v74, v94
    v_dot2_f32_bf16 v94, v65, v75, v94
    v_dot2_f32_bf16 v94, v66, v76, v94
    v_dot2_f32_bf16 v94, v67, v77, v94
    v_dot2_f32_bf16 v94, v68, v78, v94
    v_dot2_f32_bf16 v94, v69, v79, v94
    v_dot2_f32_bf16 v94, v70, v80, v94
    v_dot2_f32_bf16 v94, v71, v81, v94
    ds_read_b64 v[72:73], v21 offset:3888
    ds_read_b64 v[74:75], v21 offset:3896
    ds_read_b64 v[76:77], v21 offset:3904
    ds_read_b64 v[78:79], v21 offset:3912
    ds_read_b64 v[80:81], v21 offset:3920
    s_waitcnt lgkmcnt(5)
    v_dot2_f32_bf16 v95, v62, v82, 0
    v_dot2_f32_bf16 v95, v63, v83, v95
    v_dot2_f32_bf16 v95, v64, v84, v95
    v_dot2_f32_bf16 v95, v65, v85, v95
    v_dot2_f32_bf16 v95, v66, v86, v95
    v_dot2_f32_bf16 v95, v67, v87, v95
    v_dot2_f32_bf16 v95, v68, v88, v95
    v_dot2_f32_bf16 v95, v69, v89, v95
    v_dot2_f32_bf16 v95, v70, v90, v95
    v_dot2_f32_bf16 v95, v71, v91, v95
    ds_read_b64 v[82:83], v21 offset:2592
    ds_read_b64 v[84:85], v21 offset:2600
    ds_read_b64 v[86:87], v21 offset:2608
    ds_read_b64 v[88:89], v21 offset:2616
    ds_read_b64 v[90:91], v21 offset:2624
    s_waitcnt lgkmcnt(5)
    v_dot2_f32_bf16 v96, v62, v72, 0
    v_dot2_f32_bf16 v96, v63, v73, v96
    v_dot2_f32_bf16 v96, v64, v74, v96
    v_dot2_f32_bf16 v96, v65, v75, v96
    v_dot2_f32_bf16 v96, v66, v76, v96
    v_dot2_f32_bf16 v96, v67, v77, v96
    v_dot2_f32_bf16 v96, v68, v78, v96
    v_dot2_f32_bf16 v96, v69, v79, v96
    v_dot2_f32_bf16 v96, v70, v80, v96
    v_dot2_f32_bf16 v96, v71, v81, v96
    ds_read_b64 v[72:73], v21 offset:1296
    ds_read_b64 v[74:75], v21 offset:1304
    ds_read_b64 v[76:77], v21 offset:1312
    ds_read_b64 v[78:79], v21 offset:1320
    ds_read_b64 v[80:81], v21 offset:1328
    s_waitcnt lgkmcnt(5)
    v_dot2_f32_bf16 v97, v62, v82, 0
    v_dot2_f32_bf16 v97, v63, v83, v97
    v_dot2_f32_bf16 v97, v64, v84, v97
    v_dot2_f32_bf16 v97, v65, v85, v97
    v_dot2_f32_bf16 v97, v66, v86, v97
    v_dot2_f32_bf16 v97, v67, v87, v97
    v_dot2_f32_bf16 v97, v68, v88, v97
    v_dot2_f32_bf16 v97, v69, v89, v97
    v_dot2_f32_bf16 v97, v70, v90, v97
    v_dot2_f32_bf16 v97, v71, v91, v97
    ds_read_b64 v[82:83], v21 offset:0
    ds_read_b64 v[84:85], v21 offset:8
    ds_read_b64 v[86:87], v21 offset:16
    ds_read_b64 v[88:89], v21 offset:24
    ds_read_b64 v[90:91], v21 offset:32
    s_waitcnt lgkmcnt(5)
    v_dot2_f32_bf16 v98, v62, v72, 0
    v_dot2_f32_bf16 v98, v63, v73, v98
    v_dot2_f32_bf16 v98, v64, v74, v98
    v_dot2_f32_bf16 v98, v65, v75, v98
    v_dot2_f32_bf16 v98, v66, v76, v98
    v_dot2_f32_bf16 v98, v67, v77, v98
    v_dot2_f32_bf16 v98, v68, v78, v98
    v_dot2_f32_bf16 v98, v69, v79, v98
    v_dot2_f32_bf16 v98, v70, v80, v98
    v_dot2_f32_bf16 v98, v71, v81, v98
    ds_read_b64 v[72:73], v21 offset:40176
    ds_read_b64 v[74:75], v21 offset:40184
    ds_read_b64 v[76:77], v21 offset:40192
    ds_read_b64 v[78:79], v21 offset:40200
    ds_read_b64 v[80:81], v21 offset:40208
    s_waitcnt lgkmcnt(5)
    v_dot2_f32_bf16 v99, v62, v82, 0
    v_dot2_f32_bf16 v99, v63, v83, v99
    v_dot2_f32_bf16 v99, v64, v84, v99
    v_dot2_f32_bf16 v99, v65, v85, v99
    v_dot2_f32_bf16 v99, v66, v86, v99
    v_dot2_f32_bf16 v99, v67, v87, v99
    v_dot2_f32_bf16 v99, v68, v88, v99
    v_dot2_f32_bf16 v99, v69, v89, v99
    v_dot2_f32_bf16 v99, v70, v90, v99
    v_dot2_f32_bf16 v99, v71, v91, v99
    v_cmp_le_u32 vcc, 2, v22
    s_nop 1
    v_cndmask_b32 v93, v25, v93, vcc
    v_cmp_le_u32 vcc, 4, v22
    s_nop 1
    v_cndmask_b32 v94, v25, v94, vcc
    v_cmp_le_u32 vcc, 6, v22
    s_nop 1
    v_cndmask_b32 v95, v25, v95, vcc
    v_cmp_le_u32 vcc, 8, v22
    s_nop 1
    v_cndmask_b32 v96, v25, v96, vcc
    v_cmp_le_u32 vcc, 10, v22
    s_nop 1
    v_cndmask_b32 v97, v25, v97, vcc
    v_cmp_le_u32 vcc, 12, v22
    s_nop 1
    v_cndmask_b32 v98, v25, v98, vcc
    v_cmp_le_u32 vcc, 14, v22
    s_nop 1
    v_cndmask_b32 v99, v25, v99, vcc
    v_max_f32 v23, v92, v93
    v_max3_f32 v23, v23, v94, v95
    v_max3_f32 v23, v23, v96, v97
    v_max3_f32 v23, v23, v98, v99
    v_mul_f32 v23, 0xbea52b5c, v23
    v_fma_f32 v92, v92, s47, v23
    v_fma_f32 v93, v93, s47, v23
    v_fma_f32 v94, v94, s47, v23
    v_fma_f32 v95, v95, s47, v23
    v_fma_f32 v96, v96, s47, v23
    v_fma_f32 v97, v97, s47, v23
    v_fma_f32 v98, v98, s47, v23
    v_fma_f32 v99, v99, s47, v23
    v_exp_f32 v92, v92
    v_exp_f32 v93, v93
    v_exp_f32 v94, v94
    v_exp_f32 v95, v95
    v_exp_f32 v96, v96
    v_exp_f32 v97, v97
    v_exp_f32 v98, v98
    v_exp_f32 v99, v99
    v_add_f32 v24, v92, v93
    v_add_f32 v24, v24, v94
    v_add_f32 v24, v24, v95
    v_add_f32 v24, v24, v96
    v_add_f32 v24, v24, v97
    v_add_f32 v24, v24, v98
    v_add_f32 v24, v24, v99
    v_rcp_f32 v24, v24
    s_nop 0
    v_mul_f32 v92, v92, v24
    v_cvt_pk_bf16_f32 v100, v92, 0
    v_cvt_pk_bf16_f32 v101, 0, v92
    v_mul_f32 v93, v93, v24
    v_cvt_pk_bf16_f32 v102, v93, 0
    v_cvt_pk_bf16_f32 v103, 0, v93
    v_mul_f32 v94, v94, v24
    v_cvt_pk_bf16_f32 v104, v94, 0
    v_cvt_pk_bf16_f32 v105, 0, v94
    v_mul_f32 v95, v95, v24
    v_cvt_pk_bf16_f32 v106, v95, 0
    v_cvt_pk_bf16_f32 v107, 0, v95
    v_mul_f32 v96, v96, v24
    v_cvt_pk_bf16_f32 v108, v96, 0
    v_cvt_pk_bf16_f32 v109, 0, v96
    v_mul_f32 v97, v97, v24
    v_cvt_pk_bf16_f32 v110, v97, 0
    v_cvt_pk_bf16_f32 v111, 0, v97
    v_mul_f32 v98, v98, v24
    v_cvt_pk_bf16_f32 v112, v98, 0
    v_cvt_pk_bf16_f32 v113, 0, v98
    v_mul_f32 v99, v99, v24
    v_cvt_pk_bf16_f32 v114, v99, 0
    v_cvt_pk_bf16_f32 v115, 0, v99
    ds_read_b64 v[82:83], v21 offset:38880
    ds_read_b64 v[84:85], v21 offset:38888
    ds_read_b64 v[86:87], v21 offset:38896
    ds_read_b64 v[88:89], v21 offset:38904
    ds_read_b64 v[90:91], v21 offset:38912
    s_waitcnt lgkmcnt(5)
    v_dot2_f32_bf16 v116, v72, v100, 0
    v_dot2_f32_bf16 v117, v72, v101, 0
    v_dot2_f32_bf16 v118, v73, v100, 0
    v_dot2_f32_bf16 v119, v73, v101, 0
    v_dot2_f32_bf16 v120, v74, v100, 0
    v_dot2_f32_bf16 v121, v74, v101, 0
    v_dot2_f32_bf16 v122, v75, v100, 0
    v_dot2_f32_bf16 v123, v75, v101, 0
    v_dot2_f32_bf16 v124, v76, v100, 0
    v_dot2_f32_bf16 v125, v76, v101, 0
    v_dot2_f32_bf16 v126, v77, v100, 0
    v_dot2_f32_bf16 v127, v77, v101, 0
    v_dot2_f32_bf16 v128, v78, v100, 0
    v_dot2_f32_bf16 v129, v78, v101, 0
    v_dot2_f32_bf16 v130, v79, v100, 0
    v_dot2_f32_bf16 v131, v79, v101, 0
    v_dot2_f32_bf16 v132, v80, v100, 0
    v_dot2_f32_bf16 v133, v80, v101, 0
    v_dot2_f32_bf16 v134, v81, v100, 0
    v_dot2_f32_bf16 v135, v81, v101, 0
    ds_read_b64 v[72:73], v21 offset:37584
    ds_read_b64 v[74:75], v21 offset:37592
    ds_read_b64 v[76:77], v21 offset:37600
    ds_read_b64 v[78:79], v21 offset:37608
    ds_read_b64 v[80:81], v21 offset:37616
    s_waitcnt lgkmcnt(5)
    v_dot2_f32_bf16 v116, v82, v102, v116
    v_dot2_f32_bf16 v117, v82, v103, v117
    v_dot2_f32_bf16 v118, v83, v102, v118
    v_dot2_f32_bf16 v119, v83, v103, v119
    v_dot2_f32_bf16 v120, v84, v102, v120
    v_dot2_f32_bf16 v121, v84, v103, v121
    v_dot2_f32_bf16 v122, v85, v102, v122
    v_dot2_f32_bf16 v123, v85, v103, v123
    v_dot2_f32_bf16 v124, v86, v102, v124
    v_dot2_f32_bf16 v125, v86, v103, v125
    v_dot2_f32_bf16 v126, v87, v102, v126
    v_dot2_f32_bf16 v127, v87, v103, v127
    v_dot2_f32_bf16 v128, v88, v102, v128
    v_dot2_f32_bf16 v129, v88, v103, v129
    v_dot2_f32_bf16 v130, v89, v102, v130
    v_dot2_f32_bf16 v131, v89, v103, v131
    v_dot2_f32_bf16 v132, v90, v102, v132
    v_dot2_f32_bf16 v133, v90, v103, v133
    v_dot2_f32_bf16 v134, v91, v102, v134
    v_dot2_f32_bf16 v135, v91, v103, v135
    ds_read_b64 v[82:83], v21 offset:36288
    ds_read_b64 v[84:85], v21 offset:36296
    ds_read_b64 v[86:87], v21 offset:36304
    ds_read_b64 v[88:89], v21 offset:36312
    ds_read_b64 v[90:91], v21 offset:36320
    s_waitcnt lgkmcnt(5)
    v_dot2_f32_bf16 v116, v72, v104, v116
    v_dot2_f32_bf16 v117, v72, v105, v117
    v_dot2_f32_bf16 v118, v73, v104, v118
    v_dot2_f32_bf16 v119, v73, v105, v119
    v_dot2_f32_bf16 v120, v74, v104, v120
    v_dot2_f32_bf16 v121, v74, v105, v121
    v_dot2_f32_bf16 v122, v75, v104, v122
    v_dot2_f32_bf16 v123, v75, v105, v123
    v_dot2_f32_bf16 v124, v76, v104, v124
    v_dot2_f32_bf16 v125, v76, v105, v125
    v_dot2_f32_bf16 v126, v77, v104, v126
    v_dot2_f32_bf16 v127, v77, v105, v127
    v_dot2_f32_bf16 v128, v78, v104, v128
    v_dot2_f32_bf16 v129, v78, v105, v129
    v_dot2_f32_bf16 v130, v79, v104, v130
    v_dot2_f32_bf16 v131, v79, v105, v131
    v_dot2_f32_bf16 v132, v80, v104, v132
    v_dot2_f32_bf16 v133, v80, v105, v133
    v_dot2_f32_bf16 v134, v81, v104, v134
    v_dot2_f32_bf16 v135, v81, v105, v135
    ds_read_b64 v[72:73], v21 offset:34992
    ds_read_b64 v[74:75], v21 offset:35000
    ds_read_b64 v[76:77], v21 offset:35008
    ds_read_b64 v[78:79], v21 offset:35016
    ds_read_b64 v[80:81], v21 offset:35024
    s_waitcnt lgkmcnt(5)
    v_dot2_f32_bf16 v116, v82, v106, v116
    v_dot2_f32_bf16 v117, v82, v107, v117
    v_dot2_f32_bf16 v118, v83, v106, v118
    v_dot2_f32_bf16 v119, v83, v107, v119
    v_dot2_f32_bf16 v120, v84, v106, v120
    v_dot2_f32_bf16 v121, v84, v107, v121
    v_dot2_f32_bf16 v122, v85, v106, v122
    v_dot2_f32_bf16 v123, v85, v107, v123
    v_dot2_f32_bf16 v124, v86, v106, v124
    v_dot2_f32_bf16 v125, v86, v107, v125
    v_dot2_f32_bf16 v126, v87, v106, v126
    v_dot2_f32_bf16 v127, v87, v107, v127
    v_dot2_f32_bf16 v128, v88, v106, v128
    v_dot2_f32_bf16 v129, v88, v107, v129
    v_dot2_f32_bf16 v130, v89, v106, v130
    v_dot2_f32_bf16 v131, v89, v107, v131
    v_dot2_f32_bf16 v132, v90, v106, v132
    v_dot2_f32_bf16 v133, v90, v107, v133
    v_dot2_f32_bf16 v134, v91, v106, v134
    v_dot2_f32_bf16 v135, v91, v107, v135
    ds_read_b64 v[82:83], v21 offset:33696
    ds_read_b64 v[84:85], v21 offset:33704
    ds_read_b64 v[86:87], v21 offset:33712
    ds_read_b64 v[88:89], v21 offset:33720
    ds_read_b64 v[90:91], v21 offset:33728
    s_waitcnt lgkmcnt(5)
    v_dot2_f32_bf16 v116, v72, v108, v116
    v_dot2_f32_bf16 v117, v72, v109, v117
    v_dot2_f32_bf16 v118, v73, v108, v118
    v_dot2_f32_bf16 v119, v73, v109, v119
    v_dot2_f32_bf16 v120, v74, v108, v120
    v_dot2_f32_bf16 v121, v74, v109, v121
    v_dot2_f32_bf16 v122, v75, v108, v122
    v_dot2_f32_bf16 v123, v75, v109, v123
    v_dot2_f32_bf16 v124, v76, v108, v124
    v_dot2_f32_bf16 v125, v76, v109, v125
    v_dot2_f32_bf16 v126, v77, v108, v126
    v_dot2_f32_bf16 v127, v77, v109, v127
    v_dot2_f32_bf16 v128, v78, v108, v128
    v_dot2_f32_bf16 v129, v78, v109, v129
    v_dot2_f32_bf16 v130, v79, v108, v130
    v_dot2_f32_bf16 v131, v79, v109, v131
    v_dot2_f32_bf16 v132, v80, v108, v132
    v_dot2_f32_bf16 v133, v80, v109, v133
    v_dot2_f32_bf16 v134, v81, v108, v134
    v_dot2_f32_bf16 v135, v81, v109, v135
    ds_read_b64 v[72:73], v21 offset:32400
    ds_read_b64 v[74:75], v21 offset:32408
    ds_read_b64 v[76:77], v21 offset:32416
    ds_read_b64 v[78:79], v21 offset:32424
    ds_read_b64 v[80:81], v21 offset:32432
    s_waitcnt lgkmcnt(5)
    v_dot2_f32_bf16 v116, v82, v110, v116
    v_dot2_f32_bf16 v117, v82, v111, v117
    v_dot2_f32_bf16 v118, v83, v110, v118
    v_dot2_f32_bf16 v119, v83, v111, v119
    v_dot2_f32_bf16 v120, v84, v110, v120
    v_dot2_f32_bf16 v121, v84, v111, v121
    v_dot2_f32_bf16 v122, v85, v110, v122
    v_dot2_f32_bf16 v123, v85, v111, v123
    v_dot2_f32_bf16 v124, v86, v110, v124
    v_dot2_f32_bf16 v125, v86, v111, v125
    v_dot2_f32_bf16 v126, v87, v110, v126
    v_dot2_f32_bf16 v127, v87, v111, v127
    v_dot2_f32_bf16 v128, v88, v110, v128
    v_dot2_f32_bf16 v129, v88, v111, v129
    v_dot2_f32_bf16 v130, v89, v110, v130
    v_dot2_f32_bf16 v131, v89, v111, v131
    v_dot2_f32_bf16 v132, v90, v110, v132
    v_dot2_f32_bf16 v133, v90, v111, v133
    v_dot2_f32_bf16 v134, v91, v110, v134
    v_dot2_f32_bf16 v135, v91, v111, v135
    ds_read_b64 v[82:83], v21 offset:31104
    ds_read_b64 v[84:85], v21 offset:31112
    ds_read_b64 v[86:87], v21 offset:31120
    ds_read_b64 v[88:89], v21 offset:31128
    ds_read_b64 v[90:91], v21 offset:31136
    s_waitcnt lgkmcnt(5)
    v_dot2_f32_bf16 v116, v72, v112, v116
    v_dot2_f32_bf16 v117, v72, v113, v117
    v_dot2_f32_bf16 v118, v73, v112, v118
    v_dot2_f32_bf16 v119, v73, v113, v119
    v_dot2_f32_bf16 v120, v74, v112, v120
    v_dot2_f32_bf16 v121, v74, v113, v121
    v_dot2_f32_bf16 v122, v75, v112, v122
    v_dot2_f32_bf16 v123, v75, v113, v123
    v_dot2_f32_bf16 v124, v76, v112, v124
    v_dot2_f32_bf16 v125, v76, v113, v125
    v_dot2_f32_bf16 v126, v77, v112, v126
    v_dot2_f32_bf16 v127, v77, v113, v127
    v_dot2_f32_bf16 v128, v78, v112, v128
    v_dot2_f32_bf16 v129, v78, v113, v129
    v_dot2_f32_bf16 v130, v79, v112, v130
    v_dot2_f32_bf16 v131, v79, v113, v131
    v_dot2_f32_bf16 v132, v80, v112, v132
    v_dot2_f32_bf16 v133, v80, v113, v133
    v_dot2_f32_bf16 v134, v81, v112, v134
    v_dot2_f32_bf16 v135, v81, v113, v135
    s_waitcnt lgkmcnt(0)
    v_dot2_f32_bf16 v116, v82, v114, v116
    v_dot2_f32_bf16 v117, v82, v115, v117
    v_dot2_f32_bf16 v118, v83, v114, v118
    v_dot2_f32_bf16 v119, v83, v115, v119
    v_dot2_f32_bf16 v120, v84, v114, v120
    v_dot2_f32_bf16 v121, v84, v115, v121
    v_dot2_f32_bf16 v122, v85, v114, v122
    v_dot2_f32_bf16 v123, v85, v115, v123
    v_dot2_f32_bf16 v124, v86, v114, v124
    v_dot2_f32_bf16 v125, v86, v115, v125
    v_dot2_f32_bf16 v126, v87, v114, v126
    v_dot2_f32_bf16 v127, v87, v115, v127
    v_dot2_f32_bf16 v128, v88, v114, v128
    v_dot2_f32_bf16 v129, v88, v115, v129
    v_dot2_f32_bf16 v130, v89, v114, v130
    v_dot2_f32_bf16 v131, v89, v115, v131
    v_dot2_f32_bf16 v132, v90, v114, v132
    v_dot2_f32_bf16 v133, v90, v115, v133
    v_dot2_f32_bf16 v134, v91, v114, v134
    v_dot2_f32_bf16 v135, v91, v115, v135
    v_cvt_pk_bf16_f32 v62, v116, v117
    v_cvt_pk_bf16_f32 v63, v118, v119
    v_cvt_pk_bf16_f32 v64, v120, v121
    v_cvt_pk_bf16_f32 v65, v122, v123
    v_cvt_pk_bf16_f32 v66, v124, v125
    v_cvt_pk_bf16_f32 v67, v126, v127
    v_cvt_pk_bf16_f32 v68, v128, v129
    v_cvt_pk_bf16_f32 v69, v130, v131
    v_cvt_pk_bf16_f32 v70, v132, v133
    v_cvt_pk_bf16_f32 v71, v134, v135
    ds_write_b64 v20, v[62:63] offset:0
    ds_write_b64 v20, v[64:65] offset:8
    ds_write_b64 v20, v[66:67] offset:16
    ds_write_b64 v20, v[68:69] offset:24
    ds_write_b64 v20, v[70:71] offset:32
    s_waitcnt lgkmcnt(0)
    s_add_u32 s48, s48, 1
    s_cmp_lt_u32 s48, 2
    s_cbranch_scc1 L_pa_att
    s_add_u32 s46, s46, 1
    s_cmp_lt_u32 s46, 2
    s_cbranch_scc1 L_pa_half
    s_mov_b32 s42, 0
    s_waitcnt vmcnt(0) lgkmcnt(0)
    s_barrier
    s_mov_b32 s44, 0
    s_mov_b32 s45, 0
    s_mov_b32 s41, 0
    s_lshl_b32 s90, s32, 10
    s_add_u32 m0, s90, s45
    s_add_u32 s91, s42, 0
    buffer_load_dwordx4 v11, s[20:23], s91 offen lds
    s_add_u32 m0, m0, 4096
    s_add_u32 s91, s91, 40960
    buffer_load_dwordx4 v11, s[20:23], s91 offen lds
    s_add_u32 m0, m0, 4096
    s_add_u32 s91, s91, 40960
    buffer_load_dwordx4 v11, s[20:23], s91 offen lds
    s_add_u32 m0, m0, 4096
    s_add_u32 s91, s91, 40960
    buffer_load_dwordx4 v11, s[20:23], s91 offen lds
    s_add_u32 s45, s45, 16384
    s_cmp_eq_u32 s45, 49152
    s_cselect_b32 s45, 0, s45
    s_lshl_b32 s90, s32, 10
    s_add_u32 m0, s90, s45
    s_add_u32 s91, s42, 163840
    buffer_load_dwordx4 v11, s[20:23], s91 offen lds
    s_add_u32 m0, m0, 4096
    s_add_u32 s91, s91, 40960
    buffer_load_dwordx4 v11, s[20:23], s91 offen lds
    s_add_u32 m0, m0, 4096
    s_add_u32 s91, s91, 40960
    buffer_load_dwordx4 v11, s[20:23], s91 offen lds
    s_add_u32 m0, m0, 4096
    s_add_u32 s91, s91, 40960
    buffer_load_dwordx4 v11, s[20:23], s91 offen lds
    s_add_u32 s45, s45, 16384
    s_cmp_eq_u32 s45, 49152
    s_cselect_b32 s45, 0, s45
    ds_read_b128 a[0:3], v26 offset:0
    ds_read_b128 a[4:7], v26 offset:64
    ds_read_b128 a[8:11], v26 offset:128
    ds_read_b128 a[12:15], v26 offset:192
    ds_read_b128 a[16:19], v26 offset:256
    ds_read_b128 a[20:23], v26 offset:320
    ds_read_b128 a[24:27], v26 offset:384
    ds_read_b128 a[28:31], v26 offset:448
    ds_read_b128 a[32:35], v26 offset:512
    ds_read_b128 a[36:39], v26 offset:576
    ds_read_b128 a[40:43], v26 offset:640
    ds_read_b128 a[44:47], v26 offset:704
    ds_read_b128 a[48:51], v26 offset:768
    ds_read_b128 a[52:55], v26 offset:832
    ds_read_b128 a[56:59], v26 offset:896
    ds_read_b128 a[60:63], v26 offset:960
    ds_read_b128 a[64:67], v26 offset:1024
    ds_read_b128 a[68:71], v26 offset:1088
    ds_read_b128 a[72:75], v26 offset:1152
    ds_read_b128 a[76:79], v26 offset:1216
    ds_read_b128 a[80:83], v26 offset:20736
    ds_read_b128 a[84:87], v26 offset:20800
    ds_read_b128 a[88:91], v26 offset:20864
    ds_read_b128 a[92:95], v26 offset:20928
    ds_read_b128 a[96:99], v26 offset:20992
    ds_read_b128 a[100:103], v26 offset:21056
    ds_read_b128 a[104:107], v26 offset:21120
    ds_read_b128 a[108:111], v26 offset:21184
    ds_read_b128 a[112:115], v26 offset:21248
    ds_read_b128 a[116:119], v26 offset:21312
    ds_read_b128 a[120:123], v26 offset:21376
    ds_read_b128 a[124:127], v26 offset:21440
    ds_read_b128 a[128:131], v26 offset:21504
    ds_read_b128 a[132:135], v26 offset:21568
    ds_read_b128 a[136:139], v26 offset:21632
    ds_read_b128 a[140:143], v26 offset:21696
    ds_read_b128 a[144:147], v26 offset:21760
    ds_read_b128 a[148:151], v26 offset:21824
    ds_read_b128 a[152:155], v26 offset:21888
    ds_read_b128 a[156:159], v26 offset:21952
    s_waitcnt lgkmcnt(0)
L_pa_oblk:
    s_add_u32 s43, s42, 128
    s_cmp_eq_u32 s41, 9
    s_cselect_b32 s43, s42, s43
    v_add_u32 v13, s44, v12
    s_waitcnt vmcnt(4)
    s_barrier
    ds_read_b64_tr_b16 v[28:29], v13 offset:0
    ds_read_b64_tr_b16 v[30:31], v13 offset:512
    ds_read_b64_tr_b16 v[32:33], v13 offset:4096
    ds_read_b64_tr_b16 v[34:35], v13 offset:4608
    ds_read_b64_tr_b16 v[36:37], v13 offset:8192
    ds_read_b64_tr_b16 v[38:39], v13 offset:8704
    ds_read_b64_tr_b16 v[40:41], v13 offset:12288
    ds_read_b64_tr_b16 v[42:43], v13 offset:12800
    s_lshl_b32 s90, s32, 10
    s_add_u32 m0, s90, s45
    s_add_u32 s91, s42, 327680
    buffer_load_dwordx4 v11, s[20:23], s91 offen lds
    s_add_u32 m0, m0, 4096
    s_add_u32 s91, s91, 40960
    buffer_load_dwordx4 v11, s[20:23], s91 offen lds
    s_add_u32 m0, m0, 4096
    s_add_u32 s91, s91, 40960
    buffer_load_dwordx4 v11, s[20:23], s91 offen lds
    s_add_u32 m0, m0, 4096
    s_add_u32 s91, s91, 40960
    buffer_load_dwordx4 v11, s[20:23], s91 offen lds
    s_add_u32 s45, s45, 16384
    s_cmp_eq_u32 s45, 49152
    s_cselect_b32 s45, 0, s45
    s_add_u32 s44, s44, 16384
    s_cmp_eq_u32 s44, 49152
    s_cselect_b32 s44, 0, s44
    s_waitcnt lgkmcnt(6)
    v_mfma_f32_16x16x32_bf16 v[44:47], v[28:31], a[0:3], 0
    v_mfma_f32_16x16x32_bf16 v[48:51], v[28:31], a[80:83], 0
    s_waitcnt lgkmcnt(4)
    v_mfma_f32_16x16x32_bf16 v[44:47], v[32:35], a[4:7], v[44:47]
    v_mfma_f32_16x16x32_bf16 v[48:51], v[32:35], a[84:87], v[48:51]
    s_waitcnt lgkmcnt(2)
    v_mfma_f32_16x16x32_bf16 v[44:47], v[36:39], a[8:11], v[44:47]
    v_mfma_f32_16x16x32_bf16 v[48:51], v[36:39], a[88:91], v[48:51]
    s_waitcnt lgkmcnt(0)
    v_mfma_f32_16x16x32_bf16 v[44:47], v[40:43], a[12:15], v[44:47]
    v_mfma_f32_16x16x32_bf16 v[48:51], v[40:43], a[92:95], v[48:51]
    v_add_u32 v13, s44, v12
    s_waitcnt vmcnt(4)
    s_barrier
    ds_read_b64_tr_b16 v[28:29], v13 offset:0
    ds_read_b64_tr_b16 v[30:31], v13 offset:512
    ds_read_b64_tr_b16 v[32:33], v13 offset:4096
    ds_read_b64_tr_b16 v[34:35], v13 offset:4608
    ds_read_b64_tr_b16 v[36:37], v13 offset:8192
    ds_read_b64_tr_b16 v[38:39], v13 offset:8704
    ds_read_b64_tr_b16 v[40:41], v13 offset:12288
    ds_read_b64_tr_b16 v[42:43], v13 offset:12800
    s_lshl_b32 s90, s32, 10
    s_add_u32 m0, s90, s45
    s_add_u32 s91, s42, 491520
    buffer_load_dwordx4 v11, s[20:23], s91 offen lds
    s_add_u32 m0, m0, 4096
    s_add_u32 s91, s91, 40960
    buffer_load_dwordx4 v11, s[20:23], s91 offen lds
    s_add_u32 m0, m0, 4096
    s_add_u32 s91, s91, 40960
    buffer_load_dwordx4 v11, s[20:23], s91 offen lds
    s_add_u32 m0, m0, 4096
    s_add_u32 s91, s91, 40960
    buffer_load_dwordx4 v11, s[20:23], s91 offen lds
    s_add_u32 s45, s45, 16384
    s_cmp_eq_u32 s45, 49152
    s_cselect_b32 s45, 0, s45
    s_add_u32 s44, s44, 16384
    s_cmp_eq_u32 s44, 49152
    s_cselect_b32 s44, 0, s44
    s_waitcnt lgkmcnt(6)
    v_mfma_f32_16x16x32_bf16 v[44:47], v[28:31], a[16:19], v[44:47]
    v_mfma_f32_16x16x32_bf16 v[48:51], v[28:31], a[96:99], v[48:51]
    s_waitcnt lgkmcnt(4)
    v_mfma_f32_16x16x32_bf16 v[44:47], v[32:35], a[20:23], v[44:47]
    v_mfma_f32_16x16x32_bf16 v[48:51], v[32:35], a[100:103], v[48:51]
    s_waitcnt lgkmcnt(2)
    v_mfma_f32_16x16x32_bf16 v[44:47], v[36:39], a[24:27], v[44:47]
    v_mfma_f32_16x16x32_bf16 v[48:51], v[36:39], a[104:107], v[48:51]
    s_waitcnt lgkmcnt(0)
    v_mfma_f32_16x16x32_bf16 v[44:47], v[40:43], a[28:31], v[44:47]
    v_mfma_f32_16x16x32_bf16 v[48:51], v[40:43], a[108:111], v[48:51]
    v_add_u32 v13, s44, v12
    s_waitcnt vmcnt(4)
    s_barrier
    ds_read_b64_tr_b16 v[28:29], v13 offset:0
    ds_read_b64_tr_b16 v[30:31], v13 offset:512
    ds_read_b64_tr_b16 v[32:33], v13 offset:4096
    ds_read_b64_tr_b16 v[34:35], v13 offset:4608
    ds_read_b64_tr_b16 v[36:37], v13 offset:8192
    ds_read_b64_tr_b16 v[38:39], v13 offset:8704
    ds_read_b64_tr_b16 v[40:41], v13 offset:12288
    ds_read_b64_tr_b16 v[42:43], v13 offset:12800
    s_lshl_b32 s90, s32, 10
    s_add_u32 m0, s90, s45
    s_add_u32 s91, s42, 655360
    buffer_load_dwordx4 v11, s[20:23], s91 offen lds
    s_add_u32 m0, m0, 4096
    s_add_u32 s91, s91, 40960
    buffer_load_dwordx4 v11, s[20:23], s91 offen lds
    s_add_u32 m0, m0, 4096
    s_add_u32 s91, s91, 40960
    buffer_load_dwordx4 v11, s[20:23], s91 offen lds
    s_add_u32 m0, m0, 4096
    s_add_u32 s91, s91, 40960
    buffer_load_dwordx4 v11, s[20:23], s91 offen lds
    s_add_u32 s45, s45, 16384
    s_cmp_eq_u32 s45, 49152
    s_cselect_b32 s45, 0, s45
    s_add_u32 s44, s44, 16384
    s_cmp_eq_u32 s44, 49152
    s_cselect_b32 s44, 0, s44
    s_waitcnt lgkmcnt(6)
    v_mfma_f32_16x16x32_bf16 v[44:47], v[28:31], a[32:35], v[44:47]
    v_mfma_f32_16x16x32_bf16 v[48:51], v[28:31], a[112:115], v[48:51]
    s_waitcnt lgkmcnt(4)
    v_mfma_f32_16x16x32_bf16 v[44:47], v[32:35], a[36:39], v[44:47]
    v_mfma_f32_16x16x32_bf16 v[48:51], v[32:35], a[116:119], v[48:51]
    s_waitcnt lgkmcnt(2)
    v_mfma_f32_16x16x32_bf16 v[44:47], v[36:39], a[40:43], v[44:47]
    v_mfma_f32_16x16x32_bf16 v[48:51], v[36:39], a[120:123], v[48:51]
    s_waitcnt lgkmcnt(0)
    v_mfma_f32_16x16x32_bf16 v[44:47], v[40:43], a[44:47], v[44:47]
    v_mfma_f32_16x16x32_bf16 v[48:51], v[40:43], a[124:127], v[48:51]
    v_add_u32 v13, s44, v12
    s_waitcnt vmcnt(4)
    s_barrier
    ds_read_b64_tr_b16 v[28:29], v13 offset:0
    ds_read_b64_tr_b16 v[30:31], v13 offset:512
    ds_read_b64_tr_b16 v[32:33], v13 offset:4096
    ds_read_b64_tr_b16 v[34:35], v13 offset:4608
    ds_read_b64_tr_b16 v[36:37], v13 offset:8192
    ds_read_b64_tr_b16 v[38:39], v13 offset:8704
    ds_read_b64_tr_b16 v[40:41], v13 offset:12288
    ds_read_b64_tr_b16 v[42:43], v13 offset:12800
    s_lshl_b32 s90, s32, 10
    s_add_u32 m0, s90, s45
    s_add_u32 s91, s43, 0
    buffer_load_dwordx4 v11, s[20:23], s91 offen lds
    s_add_u32 m0, m0, 4096
    s_add_u32 s91, s91, 40960
    buffer_load_dwordx4 v11, s[20:23], s91 offen lds
    s_add_u32 m0, m0, 4096
    s_add_u32 s91, s91, 40960
    buffer_load_dwordx4 v11, s[20:23], s91 offen lds
    s_add_u32 m0, m0, 4096
    s_add_u32 s91, s91, 40960
    buffer_load_dwordx4 v11, s[20:23], s91 offen lds
    s_add_u32 s45, s45, 16384
    s_cmp_eq_u32 s45, 49152
    s_cselect_b32 s45, 0, s45
    s_add_u32 s44, s44, 16384
    s_cmp_eq_u32 s44, 49152
    s_cselect_b32 s44, 0, s44
    s_waitcnt lgkmcnt(6)
    v_mfma_f32_16x16x32_bf16 v[44:47], v[28:31], a[48:51], v[44:47]
    v_mfma_f32_16x16x32_bf16 v[48:51], v[28:31], a[128:131], v[48:51]
    s_waitcnt lgkmcnt(4)
    v_mfma_f32_16x16x32_bf16 v[44:47], v[32:35], a[52:55], v[44:47]
    v_mfma_f32_16x16x32_bf16 v[48:51], v[32:35], a[132:135], v[48:51]
    s_waitcnt lgkmcnt(2)
    v_mfma_f32_16x16x32_bf16 v[44:47], v[36:39], a[56:59], v[44:47]
    v_mfma_f32_16x16x32_bf16 v[48:51], v[36:39], a[136:139], v[48:51]
    s_waitcnt lgkmcnt(0)
    v_mfma_f32_16x16x32_bf16 v[44:47], v[40:43], a[60:63], v[44:47]
    v_mfma_f32_16x16x32_bf16 v[48:51], v[40:43], a[140:143], v[48:51]
    v_add_u32 v13, s44, v12
    s_waitcnt vmcnt(4)
    s_barrier
    ds_read_b64_tr_b16 v[28:29], v13 offset:0
    ds_read_b64_tr_b16 v[30:31], v13 offset:512
    ds_read_b64_tr_b16 v[32:33], v13 offset:4096
    ds_read_b64_tr_b16 v[34:35], v13 offset:4608
    ds_read_b64_tr_b16 v[36:37], v13 offset:8192
    ds_read_b64_tr_b16 v[38:39], v13 offset:8704
    ds_read_b64_tr_b16 v[40:41], v13 offset:12288
    ds_read_b64_tr_b16 v[42:43], v13 offset:12800
    s_lshl_b32 s90, s32, 10
    s_add_u32 m0, s90, s45
    s_add_u32 s91, s43, 163840
    buffer_load_dwordx4 v11, s[20:23], s91 offen lds
    s_add_u32 m0, m0, 4096
    s_add_u32 s91, s91, 40960
    buffer_load_dwordx4 v11, s[20:23], s91 offen lds
    s_add_u32 m0, m0, 4096
    s_add_u32 s91, s91, 40960
    buffer_load_dwordx4 v11, s[20:23], s91 offen lds
    s_add_u32 m0, m0, 4096
    s_add_u32 s91, s91, 40960
    buffer_load_dwordx4 v11, s[20:23], s91 offen lds
    s_add_u32 s45, s45, 16384
    s_cmp_eq_u32 s45, 49152
    s_cselect_b32 s45, 0, s45
    s_add_u32 s44, s44, 16384
    s_cmp_eq_u32 s44, 49152
    s_cselect_b32 s44, 0, s44
    s_waitcnt lgkmcnt(6)
    v_mfma_f32_16x16x32_bf16 v[44:47], v[28:31], a[64:67], v[44:47]
    v_mfma_f32_16x16x32_bf16 v[48:51], v[28:31], a[144:147], v[48:51]
    s_waitcnt lgkmcnt(4)
    v_mfma_f32_16x16x32_bf16 v[44:47], v[32:35], a[68:71], v[44:47]
    v_mfma_f32_16x16x32_bf16 v[48:51], v[32:35], a[148:151], v[48:51]
    s_waitcnt lgkmcnt(2)
    v_mfma_f32_16x16x32_bf16 v[44:47], v[36:39], a[72:75], v[44:47]
    v_mfma_f32_16x16x32_bf16 v[48:51], v[36:39], a[152:155], v[48:51]
    s_waitcnt lgkmcnt(0)
    v_mfma_f32_16x16x32_bf16 v[44:47], v[40:43], a[76:79], v[44:47]
    v_mfma_f32_16x16x32_bf16 v[48:51], v[40:43], a[156:159], v[48:51]
    s_nop 6
    v_cvt_pk_bf16_f32 v56, v44, v45
    v_cvt_pk_bf16_f32 v57, v46, v47
    v_cvt_pk_bf16_f32 v58, v48, v49
    v_cvt_pk_bf16_f32 v59, v50, v51
    s_nop 0
    v_permlane16_swap_b32 v56, v58
    v_permlane16_swap_b32 v57, v59
    buffer_store_dwordx4 v[56:59], v17, s[28:31], s42 offen
    s_mov_b32 s42, s43
    s_add_u32 s41, s41, 1
    s_cmp_lt_u32 s41, 10
    s_cbranch_scc1 L_pa_oblk
    s_waitcnt vmcnt(0)
    s_endpgm
L_slow:
    s_waitcnt vmcnt(0) lgkmcnt(0)
    s_barrier
    s_and_b32 s34, s2, 7
    s_lshr_b32 s35, s2, 3
    s_add_u32 s4, s88, 33554432
    s_addc_u32 s5, s89, 0
    s_and_b32 s5, s5, 0xffff
    s_lshl_b32 s38, s34, 21
    s_add_u32 s38, s38, 8388608
    s_cmp_lt_u32 s35, 12
    s_cbranch_scc1 L_qkv_s
    s_cmp_lt_u32 s35, 22
    s_cbranch_scc1 L_wo_s
    s_cmp_lt_u32 s35, 24
    s_cbranch_scc1 L_px_s
    s_branch L_pa_s
L_qkv_s:
    s_mov_b32 s12, s74
    s_and_b32 s13, s75, 0xffff
    s_mov_b32 s14, 7864320
    s_mov_b32 s15, 0x20000
    s_mov_b32 s16, s76
    s_and_b32 s17, s77, 0xffff
    s_mov_b32 s18, 7864320
    s_mov_b32 s19, 0x20000
    s_mov_b32 s20, s78
    s_and_b32 s21, s79, 0xffff
    s_mov_b32 s22, 7864320
    s_mov_b32 s23, 0x20000
    s_mov_b32 s24, s70
    s_and_b32 s25, s71, 0xffff
    s_mov_b32 s26, 2621440
    s_mov_b32 s27, 0x20000
    s_mul_i32 s40, s35, 86
    s_lshr_b32 s40, s40, 8
    s_mul_i32 s90, s40, 3
    s_sub_u32 s41, s35, s90
    v_and_b32 v1, 15, v0
    v_lshrrev_b32 v2, 4, v0
    v_lshrrev_b32 v3, 3, v0
    v_and_b32 v4, 7, v0
    s_lshl_b32 s90, s32, 3
    v_add_u32 v5, s90, v3
    s_and_b32 s91, s32, 1
    s_lshl_b32 s91, s91, 2
    v_and_b32 v6, 2, v3
    v_or_b32 v6, s91, v6
    v_xor_b32 v6, v6, v4
    v_lshlrev_b32 v6, 4, v6
    v_mul_u32_u24 v7, 12288, v5
    s_lshl_b32 s92, s34, 2
    s_add_u32 s92, s92, s40
    s_mul_i32 s92, s92, 384
    s_lshl_b32 s93, s41, 7
    s_add_u32 s92, s92, s93
    v_add3_u32 v164, v6, v7, s92
    v_lshrrev_b32 v6, 1, v3
    v_or_b32 v6, s91, v6
    v_xor_b32 v6, v6, v4
    v_lshlrev_b32 v6, 4, v6
    v_mul_u32_u24 v7, 1280, v5
    v_add_u32 v10, v6, v7
    s_mul_i32 s90, s40, 3072
    s_lshl_b32 s91, s41, 10
    s_add_u32 s90, s90, s91
    s_lshl_b32 s91, s32, 8
    s_add_u32 s91, s91, s90
    v_lshl_add_u32 v21, v1, 4, s91
    v_cmp_eq_u32 vcc, 0, v2
    v_mov_b32 v9, 2146435072
    s_nop 0
    v_cndmask_b32 v21, v9, v21, vcc
    v_lshrrev_b32 v3, 2, v1
    v_lshlrev_b32 v3, 1, v3
    v_and_b32 v4, 1, v1
    v_or_b32 v3, v3, v4
    v_lshl_add_u32 v3, v2, 3, v3
    v_lshl_add_u32 v26, v3, 4, s90
    v_and_b32 v4, 2, v1
    v_cmp_ne_u32 vcc, 0, v4
    v_mov_b32 v9, 2146435072
    s_nop 0
    v_cndmask_b32 v26, v9, v26, vcc
    s_mul_i32 s90, s40, 3840
    s_mul_i32 s91, s41, 1280
    s_add_u32 s90, s90, s91
    v_lshrrev_b32 v3, 1, v2
    v_and_b32 v5, 1, v2
    v_lshlrev_b32 v6, 1, v5
    v_or_b32 v7, v6, v3
    v_lshl_add_u32 v7, v7, 4, v1
    v_lshlrev_b32 v7, 2, v7
    v_add_u32 v7, 1024, v7
    v_or_b32 v6, v6, v1
    v_lshl_add_u32 v6, v3, 4, v6
    v_lshlrev_b32 v6, 4, v6
    s_sub_u32 s91, s32, 1
    s_lshl_b32 s91, s91, 9
    v_add_u32 v6, s91, v6
    s_cmp_eq_u32 s32, 0
    s_cselect_b64 vcc, -1, 0
    v_cndmask_b32 v6, v6, v7, vcc
    v_add_u32 v25, s90, v6
    v_cmp_eq_u32 vcc, 0, v4
    v_mov_b32 v9, 2146435072
    s_nop 0
    v_cndmask_b32 v25, v9, v25, vcc
    s_and_b32 s90, s32, 1
    s_lshl_b32 s90, s90, 9
    s_lshr_b32 s91, s32, 1
    s_lshl_b32 s91, s91, 10
    s_add_u32 s90, s90, s91
    v_lshlrev_b32 v6, 4, v1
    v_lshl_add_u32 v6, v3, 8, v6
    v_add_u32 v6, s90, v6
    v_lshl_add_u32 v27, v5, 11, v6
    v_add_u32 v27, 136192, v27
    s_mul_i32 s90, s40, 12288
    s_lshl_b32 s91, s41, 11
    s_add_u32 s90, s90, s91
    v_mul_u32_u24 v7, 6144, v5
    v_add3_u32 v29, v6, v7, s90
    v_and_b32 v6, 9, v1
    v_and_b32 v7, 2, v1
    v_lshl_or_b32 v6, v7, 1, v6
    v_and_b32 v7, 4, v1
    v_lshrrev_b32 v7, 1, v7
    v_or_b32 v6, v6, v7
    v_lshlrev_b32 v6, 4, v6
    v_lshl_add_u32 v6, v2, 8, v6
    s_cmp_eq_u32 s32, 2
    s_cselect_b32 s90, 2048, 0
    s_add_u32 s90, s90, 136192
    v_add_u32 v28, s90, v6
    s_lshl_b32 s90, s40, 7
    s_lshl_b32 s91, s41, 2
    s_add_u32 s92, s91, s32
    s_lshl_b32 s92, s92, 2
    s_add_u32 s92, s92, s90
    s_add_u32 s92, s92, 151552
    v_mov_b32 v30, s92
    s_add_u32 s91, s91, s90
    s_add_u32 s91, s91, 152064
    s_cmp_eq_u32 s32, 3
    s_cselect_b32 s91, s91, 2146435072
    v_mov_b32 v31, s91
    v_cmp_eq_u32 vcc, 0, v0
    v_mov_b32 v9, 2146435072
    s_nop 0
    v_cndmask_b32 v30, v9, v30, vcc
    v_cndmask_b32 v31, v9, v31, vcc
    v_mov_b32 v36, -1
    v_mov_b32 v37, -1
    v_mov_b32 v38, -1
    v_mov_b32 v39, -1
    v_mov_b32 v32, 0
    buffer_store_dword v32, v30, s[4:7], s38 offen sc1
    buffer_store_dword v32, v31, s[4:7], s38 offen sc1
    s_add_u32 s90, s38, 102400
    buffer_store_dwordx4 v[36:39], v21, s[4:7], s90 offen sc1
    s_add_u32 s90, s38, 114688
    buffer_store_dwordx4 v[36:39], v21, s[4:7], s90 offen sc1
    s_add_u32 s90, s38, 126976
    buffer_store_dwordx4 v[36:39], v21, s[4:7], s90 offen sc1
    s_add_u32 s90, s38, 139264
    buffer_store_dwordx4 v[36:39], v21, s[4:7], s90 offen sc1
    s_cmp_eq_u32 s32, 3
    s_cbranch_scc1 L_i1_50
    s_cmp_eq_u32 s32, 0
    s_cbranch_scc1 L_i0_49
    s_add_u32 s90, s38, 40960
    buffer_store_dwordx4 v[36:39], v25, s[4:7], s90 offen sc1
    s_add_u32 s90, s38, 56320
    buffer_store_dwordx4 v[36:39], v25, s[4:7], s90 offen sc1
    s_add_u32 s90, s38, 71680
    buffer_store_dwordx4 v[36:39], v25, s[4:7], s90 offen sc1
    s_add_u32 s90, s38, 87040
    buffer_store_dwordx4 v[36:39], v25, s[4:7], s90 offen sc1
    s_branch L_i1_50
L_i0_49:
    s_add_u32 s90, s38, 40960
    buffer_store_dword v38, v25, s[4:7], s90 offen sc1
    buffer_store_dword v39, v25, s[4:7], s90 offen offset:8 sc1
    s_add_u32 s90, s38, 56320
    buffer_store_dword v38, v25, s[4:7], s90 offen sc1
    buffer_store_dword v39, v25, s[4:7], s90 offen offset:8 sc1
    s_add_u32 s90, s38, 71680
    buffer_store_dword v38, v25, s[4:7], s90 offen sc1
    buffer_store_dword v39, v25, s[4:7], s90 offen offset:8 sc1
    s_add_u32 s90, s38, 87040
    buffer_store_dword v38, v25, s[4:7], s90 offen sc1
    buffer_store_dword v39, v25, s[4:7], s90 offen offset:8 sc1
L_i1_50:
    s_lshl_b32 s90, s32, 10
    s_add_u32 m0, s90, 40960
    s_mov_b32 s91, 0
    buffer_load_dwordx4 v164, s[20:23], s91 offen lds
    s_add_u32 m0, m0, 4096
    s_add_u32 s91, s91, 393216
    buffer_load_dwordx4 v164, s[20:23], s91 offen lds
    s_add_u32 m0, m0, 4096
    s_add_u32 s91, s91, 393216
    buffer_load_dwordx4 v164, s[20:23], s91 offen lds
    s_add_u32 m0, m0, 4096
    s_add_u32 s91, s91, 393216
    buffer_load_dwordx4 v164, s[20:23], s91 offen lds
    s_add_u32 m0, m0, 4096
    s_add_u32 s91, s91, 393216
    buffer_load_dwordx4 v164, s[20:23], s91 offen lds
    s_add_u32 m0, m0, 4096
    s_add_u32 s91, s91, 393216
    buffer_load_dwordx4 v164, s[20:23], s91 offen lds
    s_add_u32 m0, m0, 4096
    s_add_u32 s91, s91, 393216
    buffer_load_dwordx4 v164, s[20:23], s91 offen lds
    s_add_u32 m0, m0, 4096
    s_add_u32 s91, s91, 393216
    buffer_load_dwordx4 v164, s[20:23], s91 offen lds
    s_add_u32 m0, m0, 4096
    s_add_u32 s91, s91, 393216
    buffer_load_dwordx4 v164, s[20:23], s91 offen lds
    s_add_u32 m0, m0, 4096
    s_add_u32 s91, s91, 393216
    buffer_load_dwordx4 v164, s[20:23], s91 offen lds
    s_lshl_b32 s90, s32, 10
    s_add_u32 m0, s90, 81920
    s_mov_b32 s91, 3932160
    buffer_load_dwordx4 v164, s[20:23], s91 offen lds
    s_add_u32 m0, m0, 4096
    s_add_u32 s91, s91, 393216
    buffer_load_dwordx4 v164, s[20:23], s91 offen lds
    s_add_u32 m0, m0, 4096
    s_add_u32 s91, s91, 393216
    buffer_load_dwordx4 v164, s[20:23], s91 offen lds
    s_add_u32 m0, m0, 4096
    s_add_u32 s91, s91, 393216
    buffer_load_dwordx4 v164, s[20:23], s91 offen lds
    s_add_u32 m0, m0, 4096
    s_add_u32 s91, s91, 393216
    buffer_load_dwordx4 v164, s[20:23], s91 offen lds
    s_add_u32 m0, m0, 4096
    s_add_u32 s91, s91, 393216
    buffer_load_dwordx4 v164, s[20:23], s91 offen lds
    s_add_u32 m0, m0, 4096
    s_add_u32 s91, s91, 393216
    buffer_load_dwordx4 v164, s[20:23], s91 offen lds
    s_add_u32 m0, m0, 4096
    s_add_u32 s91, s91, 393216
    buffer_load_dwordx4 v164, s[20:23], s91 offen lds
    s_add_u32 m0, m0, 4096
    s_add_u32 s91, s91, 393216
    buffer_load_dwordx4 v164, s[20:23], s91 offen lds
    s_add_u32 m0, m0, 4096
    s_add_u32 s91, s91, 393216
    buffer_load_dwordx4 v164, s[20:23], s91 offen lds
    s_lshl_b32 s90, s32, 10
    s_add_u32 m0, s90, 122880
    s_mov_b32 s91, 0
    buffer_load_dwordx4 v164, s[16:19], s91 offen lds
    s_add_u32 m0, m0, 4096
    s_add_u32 s91, s91, 393216
    buffer_load_dwordx4 v164, s[16:19], s91 offen lds
    s_add_u32 m0, m0, 4096
    s_add_u32 s91, s91, 393216
    buffer_load_dwordx4 v164, s[16:19], s91 offen lds
    s_add_u32 m0, m0, 4096
    s_add_u32 s91, s91, 393216
    buffer_load_dwordx4 v164, s[16:19], s91 offen lds
    s_add_u32 m0, m0, 4096
    s_add_u32 s91, s91, 393216
    buffer_load_dwordx4 v164, s[16:19], s91 offen lds
    s_add_u32 m0, m0, 4096
    s_add_u32 s91, s91, 393216
    buffer_load_dwordx4 v164, s[16:19], s91 offen lds
    s_add_u32 m0, m0, 4096
    s_add_u32 s91, s91, 393216
    buffer_load_dwordx4 v164, s[16:19], s91 offen lds
    s_add_u32 m0, m0, 4096
    s_add_u32 s91, s91, 393216
    buffer_load_dwordx4 v164, s[16:19], s91 offen lds
    s_add_u32 m0, m0, 4096
    s_add_u32 s91, s91, 393216
    buffer_load_dwordx4 v164, s[16:19], s91 offen lds
    s_add_u32 m0, m0, 4096
    s_add_u32 s91, s91, 393216
    buffer_load_dwordx4 v164, s[16:19], s91 offen lds
    s_mov_b32 s49, 0
    s_lshl_b32 s90, s32, 10
    s_add_u32 m0, s90, 0
    s_nop 0
    buffer_load_dwordx4 v10, s[24:27], s49 offen offset:0 lds
    s_add_u32 m0, m0, 3968
    s_nop 0
    buffer_load_dwordx4 v10, s[24:27], s49 offen offset:128 lds
    s_add_u32 m0, m0, 3968
    s_nop 0
    buffer_load_dwordx4 v10, s[24:27], s49 offen offset:256 lds
    s_add_u32 m0, m0, 3968
    s_nop 0
    buffer_load_dwordx4 v10, s[24:27], s49 offen offset:384 lds
    s_add_u32 m0, m0, 3968
    s_nop 0
    buffer_load_dwordx4 v10, s[24:27], s49 offen offset:512 lds
    s_add_u32 m0, m0, 3968
    s_nop 0
    buffer_load_dwordx4 v10, s[24:27], s49 offen offset:640 lds
    s_add_u32 m0, m0, 3968
    s_nop 0
    buffer_load_dwordx4 v10, s[24:27], s49 offen offset:768 lds
    s_add_u32 m0, m0, 3968
    s_nop 0
    buffer_load_dwordx4 v10, s[24:27], s49 offen offset:896 lds
    s_add_u32 m0, m0, 3968
    s_nop 0
    buffer_load_dwordx4 v10, s[24:27], s49 offen offset:1024 lds
    s_add_u32 m0, m0, 3968
    s_nop 0
    buffer_load_dwordx4 v10, s[24:27], s49 offen offset:1152 lds
    v_lshrrev_b32 v3, 2, v1
    v_and_b32 v4, 3, v1
    v_and_b32 v5, 1, v2
    v_lshl_add_u32 v6, v2, 3, v3
    v_lshlrev_b32 v6, 7, v6
    v_and_b32 v7, 2, v3
    v_lshl_or_b32 v7, v5, 2, v7
    v_lshrrev_b32 v8, 1, v4
    s_lshl_b32 s90, s32, 1
    v_or_b32 v8, s90, v8
    v_xor_b32 v7, v7, v8
    v_lshl_add_u32 v6, v7, 4, v6
    v_and_b32 v7, 1, v4
    v_lshl_add_u32 v6, v7, 3, v6
    v_add_u32 v165, 40960, v6
    v_add_u32 v166, 81920, v6
    v_add_u32 v167, 122880, v6
    v_xor_b32 v6, 0, v5
    v_lshl_add_u32 v6, v6, 2, v3
    v_lshl_add_u32 v6, v2, 3, v6
    v_lshlrev_b32 v6, 5, v6
    v_lshl_or_b32 v7, v5, 1, 0
    v_xor_b32 v7, v7, v4
    v_lshl_add_u32 v6, v7, 3, v6
    v_add_u32 v23, 133120, v6
    v_xor_b32 v6, 1, v5
    v_lshl_add_u32 v6, v6, 2, v3
    v_lshl_add_u32 v6, v2, 3, v6
    v_lshlrev_b32 v6, 5, v6
    v_lshl_or_b32 v7, v5, 1, 1
    v_xor_b32 v7, v7, v4
    v_lshl_add_u32 v6, v7, 3, v6
    v_add_u32 v24, 133120, v6
    v_lshrrev_b32 v6, 3, v1
    v_lshlrev_b32 v6, 2, v6
    v_xor_b32 v6, v6, v1
    v_lshlrev_b32 v6, 5, v6
    v_xor_b32 v7, v2, v3
    v_lshl_add_u32 v6, v7, 3, v6
    s_lshl_b32 s90, s32, 9
    s_add_u32 s90, s90, 133120
    v_add_u32 v22, s90, v6
    v_lshlrev_b32 v6, 6, v3
    v_and_b32 v7, 1, v1
    v_lshl_add_u32 v6, v7, 5, v6
    v_lshl_add_u32 v6, v2, 3, v6
    v_and_b32 v7, 2, v1
    v_lshl_add_u32 v6, v7, 1, v6
    s_lshl_b32 s90, s32, 8
    s_add_u32 s90, s90, 135168
    v_add_u32 v19, s90, v6
    v_lshl_add_u32 v20, v1, 3, s90
    v_cmp_ne_u32 vcc, 0, v7
    v_mov_b32 v6, 0x4444
    v_mov_b32 v8, 0xeeee
    v_cndmask_b32 v18, v6, v8, vcc
    v_lshlrev_b32 v6, 3, v1
    v_lshl_add_u32 v6, v5, 7, v6
    v_lshl_add_u32 v6, v2, 8, v6
    v_add_u32 v16, 122880, v6
    v_xor_b32 v17, 128, v16
    s_mul_i32 s90, s32, 2560
    v_lshl_add_u32 v13, v0, 4, s90
    v_lshl_add_u32 v14, v0, 2, s90
    s_add_u32 s51, s90, 122880
    v_mul_u32_u24 v6, 40, v0
    v_add_u32 v15, s51, v6
    v_lshrrev_b32 v6, 3, v1
    v_lshlrev_b32 v6, 10, v6
    v_and_b32 v7, 7, v1
    v_lshl_add_u32 v6, v7, 7, v6
    v_lshrrev_b32 v7, 1, v1
    v_xor_b32 v7, v7, v2
    v_lshl_add_u32 v11, v7, 4, v6
    v_xor_b32 v12, 64, v11
    s_waitcnt vmcnt(30)
    s_barrier
    ds_read_b64_tr_b16 a[160:161], v165 offset:0
    ds_read_b64_tr_b16 a[162:163], v165 offset:512
    ds_read_b64_tr_b16 a[164:165], v165 offset:4096
    ds_read_b64_tr_b16 a[166:167], v165 offset:4608
    ds_read_b64_tr_b16 a[168:169], v165 offset:8192
    ds_read_b64_tr_b16 a[170:171], v165 offset:8704
    ds_read_b64_tr_b16 a[172:173], v165 offset:12288
    ds_read_b64_tr_b16 a[174:175], v165 offset:12800
    ds_read_b64_tr_b16 a[176:177], v165 offset:16384
    ds_read_b64_tr_b16 a[178:179], v165 offset:16896
    ds_read_b64_tr_b16 a[180:181], v165 offset:20480
    ds_read_b64_tr_b16 a[182:183], v165 offset:20992
    ds_read_b64_tr_b16 a[184:185], v165 offset:24576
    ds_read_b64_tr_b16 a[186:187], v165 offset:25088
    ds_read_b64_tr_b16 a[188:189], v165 offset:28672
    ds_read_b64_tr_b16 a[190:191], v165 offset:29184
    ds_read_b64_tr_b16 a[192:193], v165 offset:32768
    ds_read_b64_tr_b16 a[194:195], v165 offset:33280
    ds_read_b64_tr_b16 a[196:197], v165 offset:36864
    ds_read_b64_tr_b16 a[198:199], v165 offset:37376
    s_waitcnt lgkmcnt(0)
    s_barrier
    s_lshl_b32 s90, s32, 10
    s_add_u32 m0, s90, 40960
    s_mov_b32 s91, 3932160
    buffer_load_dwordx4 v164, s[16:19], s91 offen lds
    s_add_u32 m0, m0, 4096
    s_add_u32 s91, s91, 393216
    buffer_load_dwordx4 v164, s[16:19], s91 offen lds
    s_add_u32 m0, m0, 4096
    s_add_u32 s91, s91, 393216
    buffer_load_dwordx4 v164, s[16:19], s91 offen lds
    s_add_u32 m0, m0, 4096
    s_add_u32 s91, s91, 393216
    buffer_load_dwordx4 v164, s[16:19], s91 offen lds
    s_add_u32 m0, m0, 4096
    s_add_u32 s91, s91, 393216
    buffer_load_dwordx4 v164, s[16:19], s91 offen lds
    s_add_u32 m0, m0, 4096
    s_add_u32 s91, s91, 393216
    buffer_load_dwordx4 v164, s[16:19], s91 offen lds
    s_add_u32 m0, m0, 4096
    s_add_u32 s91, s91, 393216
    buffer_load_dwordx4 v164, s[16:19], s91 offen lds
    s_add_u32 m0, m0, 4096
    s_add_u32 s91, s91, 393216
    buffer_load_dwordx4 v164, s[16:19], s91 offen lds
    s_add_u32 m0, m0, 4096
    s_add_u32 s91, s91, 393216
    buffer_load_dwordx4 v164, s[16:19], s91 offen lds
    s_add_u32 m0, m0, 4096
    s_add_u32 s91, s91, 393216
    buffer_load_dwordx4 v164, s[16:19], s91 offen lds
    s_cmp_lg_u32 s32, 0
    s_cbranch_scc1 L_arr_51
    v_mov_b32 v1, 68
    v_mov_b32 v2, 1
    s_mov_b64 exec, 1
    buffer_atomic_add v2, v1, s[8:11], 0 offen sc1
    s_mov_b64 exec, -1
L_arr_51:
    s_waitcnt vmcnt(30)
    s_barrier
    ds_read_b64_tr_b16 a[200:201], v166 offset:0
    ds_read_b64_tr_b16 a[202:203], v166 offset:512
    ds_read_b64_tr_b16 a[204:205], v166 offset:4096
    ds_read_b64_tr_b16 a[206:207], v166 offset:4608
    ds_read_b64_tr_b16 a[208:209], v166 offset:8192
    ds_read_b64_tr_b16 a[210:211], v166 offset:8704
    ds_read_b64_tr_b16 a[212:213], v166 offset:12288
    ds_read_b64_tr_b16 a[214:215], v166 offset:12800
    ds_read_b64_tr_b16 a[216:217], v166 offset:16384
    ds_read_b64_tr_b16 a[218:219], v166 offset:16896
    ds_read_b64_tr_b16 a[220:221], v166 offset:20480
    ds_read_b64_tr_b16 a[222:223], v166 offset:20992
    ds_read_b64_tr_b16 a[224:225], v166 offset:24576
    ds_read_b64_tr_b16 a[226:227], v166 offset:25088
    ds_read_b64_tr_b16 a[228:229], v166 offset:28672
    ds_read_b64_tr_b16 a[230:231], v166 offset:29184
    ds_read_b64_tr_b16 a[232:233], v166 offset:32768
    ds_read_b64_tr_b16 a[234:235], v166 offset:33280
    ds_read_b64_tr_b16 a[236:237], v166 offset:36864
    ds_read_b64_tr_b16 a[238:239], v166 offset:37376
    s_waitcnt lgkmcnt(0)
    s_barrier
    s_lshl_b32 s90, s32, 10
    s_add_u32 m0, s90, 81920
    s_mov_b32 s91, 0
    buffer_load_dwordx4 v164, s[12:15], s91 offen lds
    s_add_u32 m0, m0, 4096
    s_add_u32 s91, s91, 393216
    buffer_load_dwordx4 v164, s[12:15], s91 offen lds
    s_add_u32 m0, m0, 4096
    s_add_u32 s91, s91, 393216
    buffer_load_dwordx4 v164, s[12:15], s91 offen lds
    s_add_u32 m0, m0, 4096
    s_add_u32 s91, s91, 393216
    buffer_load_dwordx4 v164, s[12:15], s91 offen lds
    s_add_u32 m0, m0, 4096
    s_add_u32 s91, s91, 393216
    buffer_load_dwordx4 v164, s[12:15], s91 offen lds
    s_add_u32 m0, m0, 4096
    s_add_u32 s91, s91, 393216
    buffer_load_dwordx4 v164, s[12:15], s91 offen lds
    s_add_u32 m0, m0, 4096
    s_add_u32 s91, s91, 393216
    buffer_load_dwordx4 v164, s[12:15], s91 offen lds
    s_add_u32 m0, m0, 4096
    s_add_u32 s91, s91, 393216
    buffer_load_dwordx4 v164, s[12:15], s91 offen lds
    s_add_u32 m0, m0, 4096
    s_add_u32 s91, s91, 393216
    buffer_load_dwordx4 v164, s[12:15], s91 offen lds
    s_add_u32 m0, m0, 4096
    s_add_u32 s91, s91, 393216
    buffer_load_dwordx4 v164, s[12:15], s91 offen lds
    s_waitcnt vmcnt(30)
    s_barrier
    ds_read_b64_tr_b16 a[80:81], v167 offset:0
    ds_read_b64_tr_b16 a[82:83], v167 offset:512
    ds_read_b64_tr_b16 a[84:85], v167 offset:4096
    ds_read_b64_tr_b16 a[86:87], v167 offset:4608
    ds_read_b64_tr_b16 a[88:89], v167 offset:8192
    ds_read_b64_tr_b16 a[90:91], v167 offset:8704
    ds_read_b64_tr_b16 a[92:93], v167 offset:12288
    ds_read_b64_tr_b16 a[94:95], v167 offset:12800
    ds_read_b64_tr_b16 a[96:97], v167 offset:16384
    ds_read_b64_tr_b16 a[98:99], v167 offset:16896
    ds_read_b64_tr_b16 a[100:101], v167 offset:20480
    ds_read_b64_tr_b16 a[102:103], v167 offset:20992
    ds_read_b64_tr_b16 a[104:105], v167 offset:24576
    ds_read_b64_tr_b16 a[106:107], v167 offset:25088
    ds_read_b64_tr_b16 a[108:109], v167 offset:28672
    ds_read_b64_tr_b16 a[110:111], v167 offset:29184
    ds_read_b64_tr_b16 a[112:113], v167 offset:32768
    ds_read_b64_tr_b16 a[114:115], v167 offset:33280
    ds_read_b64_tr_b16 a[116:117], v167 offset:36864
    ds_read_b64_tr_b16 a[118:119], v167 offset:37376
    s_waitcnt lgkmcnt(0)
    s_barrier
    s_lshl_b32 s90, s32, 10
    s_add_u32 m0, s90, 122880
    s_mov_b32 s91, 3932160
    buffer_load_dwordx4 v164, s[12:15], s91 offen lds
    s_add_u32 m0, m0, 4096
    s_add_u32 s91, s91, 393216
    buffer_load_dwordx4 v164, s[12:15], s91 offen lds
    s_add_u32 m0, m0, 4096
    s_add_u32 s91, s91, 393216
    buffer_load_dwordx4 v164, s[12:15], s91 offen lds
    s_add_u32 m0, m0, 4096
    s_add_u32 s91, s91, 393216
    buffer_load_dwordx4 v164, s[12:15], s91 offen lds
    s_add_u32 m0, m0, 4096
    s_add_u32 s91, s91, 393216
    buffer_load_dwordx4 v164, s[12:15], s91 offen lds
    s_add_u32 m0, m0, 4096
    s_add_u32 s91, s91, 393216
    buffer_load_dwordx4 v164, s[12:15], s91 offen lds
    s_add_u32 m0, m0, 4096
    s_add_u32 s91, s91, 393216
    buffer_load_dwordx4 v164, s[12:15], s91 offen lds
    s_add_u32 m0, m0, 4096
    s_add_u32 s91, s91, 393216
    buffer_load_dwordx4 v164, s[12:15], s91 offen lds
    s_add_u32 m0, m0, 4096
    s_add_u32 s91, s91, 393216
    buffer_load_dwordx4 v164, s[12:15], s91 offen lds
    s_add_u32 m0, m0, 4096
    s_add_u32 s91, s91, 393216
    buffer_load_dwordx4 v164, s[12:15], s91 offen lds
    s_waitcnt vmcnt(20)
    s_barrier
    ds_read_b64_tr_b16 a[120:121], v165 offset:0
    ds_read_b64_tr_b16 a[122:123], v165 offset:512
    ds_read_b64_tr_b16 a[124:125], v165 offset:4096
    ds_read_b64_tr_b16 a[126:127], v165 offset:4608
    ds_read_b64_tr_b16 a[128:129], v165 offset:8192
    ds_read_b64_tr_b16 a[130:131], v165 offset:8704
    ds_read_b64_tr_b16 a[132:133], v165 offset:12288
    ds_read_b64_tr_b16 a[134:135], v165 offset:12800
    ds_read_b64_tr_b16 a[136:137], v165 offset:16384
    ds_read_b64_tr_b16 a[138:139], v165 offset:16896
    ds_read_b64_tr_b16 a[140:141], v165 offset:20480
    ds_read_b64_tr_b16 a[142:143], v165 offset:20992
    ds_read_b64_tr_b16 a[144:145], v165 offset:24576
    ds_read_b64_tr_b16 a[146:147], v165 offset:25088
    ds_read_b64_tr_b16 a[148:149], v165 offset:28672
    ds_read_b64_tr_b16 a[150:151], v165 offset:29184
    ds_read_b64_tr_b16 a[152:153], v165 offset:32768
    ds_read_b64_tr_b16 a[154:155], v165 offset:33280
    ds_read_b64_tr_b16 a[156:157], v165 offset:36864
    ds_read_b64_tr_b16 a[158:159], v165 offset:37376
    s_waitcnt lgkmcnt(0)
    s_barrier
    s_mov_b32 s49, 40960
    s_lshl_b32 s90, s32, 10
    s_add_u32 m0, s90, 40960
    s_nop 0
    buffer_load_dwordx4 v10, s[24:27], s49 offen offset:0 lds
    s_add_u32 m0, m0, 3968
    s_nop 0
    buffer_load_dwordx4 v10, s[24:27], s49 offen offset:128 lds
    s_add_u32 m0, m0, 3968
    s_nop 0
    buffer_load_dwordx4 v10, s[24:27], s49 offen offset:256 lds
    s_add_u32 m0, m0, 3968
    s_nop 0
    buffer_load_dwordx4 v10, s[24:27], s49 offen offset:384 lds
    s_add_u32 m0, m0, 3968
    s_nop 0
    buffer_load_dwordx4 v10, s[24:27], s49 offen offset:512 lds
    s_add_u32 m0, m0, 3968
    s_nop 0
    buffer_load_dwordx4 v10, s[24:27], s49 offen offset:640 lds
    s_add_u32 m0, m0, 3968
    s_nop 0
    buffer_load_dwordx4 v10, s[24:27], s49 offen offset:768 lds
    s_add_u32 m0, m0, 3968
    s_nop 0
    buffer_load_dwordx4 v10, s[24:27], s49 offen offset:896 lds
    s_add_u32 m0, m0, 3968
    s_nop 0
    buffer_load_dwordx4 v10, s[24:27], s49 offen offset:1024 lds
    s_add_u32 m0, m0, 3968
    s_nop 0
    buffer_load_dwordx4 v10, s[24:27], s49 offen offset:1152 lds
    s_waitcnt vmcnt(20)
    s_barrier
    ds_read_b64_tr_b16 a[0:1], v166 offset:0
    ds_read_b64_tr_b16 a[2:3], v166 offset:512
    ds_read_b64_tr_b16 a[4:5], v166 offset:4096
    ds_read_b64_tr_b16 a[6:7], v166 offset:4608
    ds_read_b64_tr_b16 a[8:9], v166 offset:8192
    ds_read_b64_tr_b16 a[10:11], v166 offset:8704
    ds_read_b64_tr_b16 a[12:13], v166 offset:12288
    ds_read_b64_tr_b16 a[14:15], v166 offset:12800
    ds_read_b64_tr_b16 a[16:17], v166 offset:16384
    ds_read_b64_tr_b16 a[18:19], v166 offset:16896
    ds_read_b64_tr_b16 a[20:21], v166 offset:20480
    ds_read_b64_tr_b16 a[22:23], v166 offset:20992
    ds_read_b64_tr_b16 a[24:25], v166 offset:24576
    ds_read_b64_tr_b16 a[26:27], v166 offset:25088
    ds_read_b64_tr_b16 a[28:29], v166 offset:28672
    ds_read_b64_tr_b16 a[30:31], v166 offset:29184
    ds_read_b64_tr_b16 a[32:33], v166 offset:32768
    ds_read_b64_tr_b16 a[34:35], v166 offset:33280
    ds_read_b64_tr_b16 a[36:37], v166 offset:36864
    ds_read_b64_tr_b16 a[38:39], v166 offset:37376
    s_waitcnt lgkmcnt(0)
    s_barrier
    s_waitcnt vmcnt(10)
    s_barrier
    ds_read_b64_tr_b16 a[40:41], v167 offset:0
    ds_read_b64_tr_b16 a[42:43], v167 offset:512
    ds_read_b64_tr_b16 a[44:45], v167 offset:4096
    ds_read_b64_tr_b16 a[46:47], v167 offset:4608
    ds_read_b64_tr_b16 a[48:49], v167 offset:8192
    ds_read_b64_tr_b16 a[50:51], v167 offset:8704
    ds_read_b64_tr_b16 a[52:53], v167 offset:12288
    ds_read_b64_tr_b16 a[54:55], v167 offset:12800
    ds_read_b64_tr_b16 a[56:57], v167 offset:16384
    ds_read_b64_tr_b16 a[58:59], v167 offset:16896
    ds_read_b64_tr_b16 a[60:61], v167 offset:20480
    ds_read_b64_tr_b16 a[62:63], v167 offset:20992
    ds_read_b64_tr_b16 a[64:65], v167 offset:24576
    ds_read_b64_tr_b16 a[66:67], v167 offset:25088
    ds_read_b64_tr_b16 a[68:69], v167 offset:28672
    ds_read_b64_tr_b16 a[70:71], v167 offset:29184
    ds_read_b64_tr_b16 a[72:73], v167 offset:32768
    ds_read_b64_tr_b16 a[74:75], v167 offset:33280
    ds_read_b64_tr_b16 a[76:77], v167 offset:36864
    ds_read_b64_tr_b16 a[78:79], v167 offset:37376
    s_waitcnt lgkmcnt(0)
    s_barrier
    s_mov_b32 s52, 40960
    s_mov_b32 s50, 40960
    s_mov_b32 s48, s38
    v_mov_b32 v34, v27
    ds_read_b128 v[116:119], v11 offset:0
    ds_read_b128 v[120:123], v11 offset:2048
    ds_read_b128 v[124:127], v12 offset:0
    ds_read_b128 v[128:131], v12 offset:2048
    ds_read_b128 v[132:135], v11 offset:4096
    ds_read_b128 v[136:139], v11 offset:6144
    s_waitcnt lgkmcnt(4)
    v_mfma_f32_16x16x32_bf16 v[140:143], a[160:163], v[116:119], 0
    v_mfma_f32_16x16x32_bf16 v[144:147], a[160:163], v[120:123], 0
    v_mfma_f32_16x16x32_bf16 v[148:151], a[80:83], v[116:119], 0
    v_mfma_f32_16x16x32_bf16 v[152:155], a[80:83], v[120:123], 0
    v_mfma_f32_16x16x32_bf16 v[156:159], a[0:3], v[116:119], 0
    v_mfma_f32_16x16x32_bf16 v[160:163], a[0:3], v[120:123], 0
    ds_read_b128 v[116:119], v12 offset:4096
    ds_read_b128 v[120:123], v12 offset:6144
    s_waitcnt lgkmcnt(4)
    v_mfma_f32_16x16x32_bf16 v[140:143], a[164:167], v[124:127], v[140:143]
    v_mfma_f32_16x16x32_bf16 v[144:147], a[164:167], v[128:131], v[144:147]
    v_mfma_f32_16x16x32_bf16 v[148:151], a[84:87], v[124:127], v[148:151]
    v_mfma_f32_16x16x32_bf16 v[152:155], a[84:87], v[128:131], v[152:155]
    v_mfma_f32_16x16x32_bf16 v[156:159], a[4:7], v[124:127], v[156:159]
    v_mfma_f32_16x16x32_bf16 v[160:163], a[4:7], v[128:131], v[160:163]
    ds_read_b128 v[124:127], v11 offset:8192
    ds_read_b128 v[128:131], v11 offset:10240
    s_waitcnt lgkmcnt(4)
    v_mfma_f32_16x16x32_bf16 v[140:143], a[168:171], v[132:135], v[140:143]
    v_mfma_f32_16x16x32_bf16 v[144:147], a[168:171], v[136:139], v[144:147]
    v_mfma_f32_16x16x32_bf16 v[148:151], a[88:91], v[132:135], v[148:151]
    v_mfma_f32_16x16x32_bf16 v[152:155], a[88:91], v[136:139], v[152:155]
    v_mfma_f32_16x16x32_bf16 v[156:159], a[8:11], v[132:135], v[156:159]
    v_mfma_f32_16x16x32_bf16 v[160:163], a[8:11], v[136:139], v[160:163]
    ds_read_b128 v[132:135], v12 offset:8192
    ds_read_b128 v[136:139], v12 offset:10240
    s_waitcnt lgkmcnt(4)
    v_mfma_f32_16x16x32_bf16 v[140:143], a[172:175], v[116:119], v[140:143]
    v_mfma_f32_16x16x32_bf16 v[144:147], a[172:175], v[120:123], v[144:147]
    v_mfma_f32_16x16x32_bf16 v[148:151], a[92:95], v[116:119], v[148:151]
    v_mfma_f32_16x16x32_bf16 v[152:155], a[92:95], v[120:123], v[152:155]
    v_mfma_f32_16x16x32_bf16 v[156:159], a[12:15], v[116:119], v[156:159]
    v_mfma_f32_16x16x32_bf16 v[160:163], a[12:15], v[120:123], v[160:163]
    ds_read_b128 v[116:119], v11 offset:12288
    ds_read_b128 v[120:123], v11 offset:14336
    s_waitcnt lgkmcnt(4)
    s_waitcnt vmcnt(0)
    buffer_store_dword v32, v30, s[4:7], s38 offen sc1
    v_mfma_f32_16x16x32_bf16 v[140:143], a[176:179], v[124:127], v[140:143]
    v_mfma_f32_16x16x32_bf16 v[144:147], a[176:179], v[128:131], v[144:147]
    v_mfma_f32_16x16x32_bf16 v[148:151], a[96:99], v[124:127], v[148:151]
    v_mfma_f32_16x16x32_bf16 v[152:155], a[96:99], v[128:131], v[152:155]
    v_mfma_f32_16x16x32_bf16 v[156:159], a[16:19], v[124:127], v[156:159]
    v_mfma_f32_16x16x32_bf16 v[160:163], a[16:19], v[128:131], v[160:163]
    ds_read_b128 v[124:127], v12 offset:12288
    ds_read_b128 v[128:131], v12 offset:14336
    s_waitcnt lgkmcnt(4)
    v_mfma_f32_16x16x32_bf16 v[140:143], a[180:183], v[132:135], v[140:143]
    v_mfma_f32_16x16x32_bf16 v[144:147], a[180:183], v[136:139], v[144:147]
    v_mfma_f32_16x16x32_bf16 v[148:151], a[100:103], v[132:135], v[148:151]
    v_mfma_f32_16x16x32_bf16 v[152:155], a[100:103], v[136:139], v[152:155]
    v_mfma_f32_16x16x32_bf16 v[156:159], a[20:23], v[132:135], v[156:159]
    v_mfma_f32_16x16x32_bf16 v[160:163], a[20:23], v[136:139], v[160:163]
    ds_read_b128 v[132:135], v11 offset:16384
    ds_read_b128 v[136:139], v11 offset:18432
    s_waitcnt lgkmcnt(4)
    v_mfma_f32_16x16x32_bf16 v[140:143], a[184:187], v[116:119], v[140:143]
    v_mfma_f32_16x16x32_bf16 v[144:147], a[184:187], v[120:123], v[144:147]
    v_mfma_f32_16x16x32_bf16 v[148:151], a[104:107], v[116:119], v[148:151]
    v_mfma_f32_16x16x32_bf16 v[152:155], a[104:107], v[120:123], v[152:155]
    v_mfma_f32_16x16x32_bf16 v[156:159], a[24:27], v[116:119], v[156:159]
    v_mfma_f32_16x16x32_bf16 v[160:163], a[24:27], v[120:123], v[160:163]
    ds_read_b128 v[116:119], v12 offset:16384
    ds_read_b128 v[120:123], v12 offset:18432
    s_waitcnt lgkmcnt(4)
    v_mfma_f32_16x16x32_bf16 v[140:143], a[188:191], v[124:127], v[140:143]
    v_mfma_f32_16x16x32_bf16 v[144:147], a[188:191], v[128:131], v[144:147]
    v_mfma_f32_16x16x32_bf16 v[148:151], a[108:111], v[124:127], v[148:151]
    v_mfma_f32_16x16x32_bf16 v[152:155], a[108:111], v[128:131], v[152:155]
    v_mfma_f32_16x16x32_bf16 v[156:159], a[28:31], v[124:127], v[156:159]
    v_mfma_f32_16x16x32_bf16 v[160:163], a[28:31], v[128:131], v[160:163]
    ds_read_b128 v[124:127], v11 offset:20480
    ds_read_b128 v[128:131], v11 offset:22528
    s_waitcnt lgkmcnt(4)
    v_mfma_f32_16x16x32_bf16 v[140:143], a[192:195], v[132:135], v[140:143]
    v_mfma_f32_16x16x32_bf16 v[144:147], a[192:195], v[136:139], v[144:147]
    v_mfma_f32_16x16x32_bf16 v[148:151], a[112:115], v[132:135], v[148:151]
    v_mfma_f32_16x16x32_bf16 v[152:155], a[112:115], v[136:139], v[152:155]
    v_mfma_f32_16x16x32_bf16 v[156:159], a[32:35], v[132:135], v[156:159]
    v_mfma_f32_16x16x32_bf16 v[160:163], a[32:35], v[136:139], v[160:163]
    ds_read_b128 v[132:135], v12 offset:20480
    ds_read_b128 v[136:139], v12 offset:22528
    s_waitcnt lgkmcnt(4)
    v_mfma_f32_16x16x32_bf16 v[140:143], a[196:199], v[116:119], v[140:143]
    v_mfma_f32_16x16x32_bf16 v[144:147], a[196:199], v[120:123], v[144:147]
    v_mfma_f32_16x16x32_bf16 v[148:151], a[116:119], v[116:119], v[148:151]
    v_mfma_f32_16x16x32_bf16 v[152:155], a[116:119], v[120:123], v[152:155]
    v_mfma_f32_16x16x32_bf16 v[156:159], a[36:39], v[116:119], v[156:159]
    v_mfma_f32_16x16x32_bf16 v[160:163], a[36:39], v[120:123], v[160:163]
    ds_read_b128 v[116:119], v11 offset:24576
    ds_read_b128 v[120:123], v11 offset:26624
    s_waitcnt lgkmcnt(4)
    v_mfma_f32_16x16x32_bf16 v[140:143], a[200:203], v[124:127], v[140:143]
    v_mfma_f32_16x16x32_bf16 v[144:147], a[200:203], v[128:131], v[144:147]
    v_mfma_f32_16x16x32_bf16 v[148:151], a[120:123], v[124:127], v[148:151]
    v_mfma_f32_16x16x32_bf16 v[152:155], a[120:123], v[128:131], v[152:155]
    v_mfma_f32_16x16x32_bf16 v[156:159], a[40:43], v[124:127], v[156:159]
    v_mfma_f32_16x16x32_bf16 v[160:163], a[40:43], v[128:131], v[160:163]
    ds_read_b128 v[124:127], v12 offset:24576
    ds_read_b128 v[128:131], v12 offset:26624
    s_waitcnt lgkmcnt(4)
    v_mfma_f32_16x16x32_bf16 v[140:143], a[204:207], v[132:135], v[140:143]
    v_mfma_f32_16x16x32_bf16 v[144:147], a[204:207], v[136:139], v[144:147]
    v_mfma_f32_16x16x32_bf16 v[148:151], a[124:127], v[132:135], v[148:151]
    v_mfma_f32_16x16x32_bf16 v[152:155], a[124:127], v[136:139], v[152:155]
    v_mfma_f32_16x16x32_bf16 v[156:159], a[44:47], v[132:135], v[156:159]
    v_mfma_f32_16x16x32_bf16 v[160:163], a[44:47], v[136:139], v[160:163]
    ds_read_b128 v[132:135], v11 offset:28672
    ds_read_b128 v[136:139], v11 offset:30720
    s_waitcnt lgkmcnt(4)
    v_mfma_f32_16x16x32_bf16 v[140:143], a[208:211], v[116:119], v[140:143]
    v_mfma_f32_16x16x32_bf16 v[144:147], a[208:211], v[120:123], v[144:147]
    v_mfma_f32_16x16x32_bf16 v[148:151], a[128:131], v[116:119], v[148:151]
    v_mfma_f32_16x16x32_bf16 v[152:155], a[128:131], v[120:123], v[152:155]
    v_mfma_f32_16x16x32_bf16 v[156:159], a[48:51], v[116:119], v[156:159]
    v_mfma_f32_16x16x32_bf16 v[160:163], a[48:51], v[120:123], v[160:163]
    ds_read_b128 v[116:119], v12 offset:28672
    ds_read_b128 v[120:123], v12 offset:30720
    s_waitcnt lgkmcnt(4)
    v_mfma_f32_16x16x32_bf16 v[140:143], a[212:215], v[124:127], v[140:143]
    v_mfma_f32_16x16x32_bf16 v[144:147], a[212:215], v[128:131], v[144:147]
    v_mfma_f32_16x16x32_bf16 v[148:151], a[132:135], v[124:127], v[148:151]
    v_mfma_f32_16x16x32_bf16 v[152:155], a[132:135], v[128:131], v[152:155]
    v_mfma_f32_16x16x32_bf16 v[156:159], a[52:55], v[124:127], v[156:159]
    v_mfma_f32_16x16x32_bf16 v[160:163], a[52:55], v[128:131], v[160:163]
    ds_read_b128 v[124:127], v11 offset:32768
    ds_read_b128 v[128:131], v11 offset:34816
    s_waitcnt lgkmcnt(4)
    v_mfma_f32_16x16x32_bf16 v[140:143], a[216:219], v[132:135], v[140:143]
    v_mfma_f32_16x16x32_bf16 v[144:147], a[216:219], v[136:139], v[144:147]
    v_mfma_f32_16x16x32_bf16 v[148:151], a[136:139], v[132:135], v[148:151]
    v_mfma_f32_16x16x32_bf16 v[152:155], a[136:139], v[136:139], v[152:155]
    v_mfma_f32_16x16x32_bf16 v[156:159], a[56:59], v[132:135], v[156:159]
    v_mfma_f32_16x16x32_bf16 v[160:163], a[56:59], v[136:139], v[160:163]
    ds_read_b128 v[132:135], v12 offset:32768
    ds_read_b128 v[136:139], v12 offset:34816
    s_waitcnt lgkmcnt(4)
    v_mfma_f32_16x16x32_bf16 v[140:143], a[220:223], v[116:119], v[140:143]
    v_mfma_f32_16x16x32_bf16 v[144:147], a[220:223], v[120:123], v[144:147]
    v_mfma_f32_16x16x32_bf16 v[148:151], a[140:143], v[116:119], v[148:151]
    v_mfma_f32_16x16x32_bf16 v[152:155], a[140:143], v[120:123], v[152:155]
    v_mfma_f32_16x16x32_bf16 v[156:159], a[60:63], v[116:119], v[156:159]
    v_mfma_f32_16x16x32_bf16 v[160:163], a[60:63], v[120:123], v[160:163]
    ds_read_b128 v[116:119], v11 offset:36864
    ds_read_b128 v[120:123], v11 offset:38912
    s_waitcnt lgkmcnt(4)
    v_mfma_f32_16x16x32_bf16 v[140:143], a[224:227], v[124:127], v[140:143]
    v_mfma_f32_16x16x32_bf16 v[144:147], a[224:227], v[128:131], v[144:147]
    v_mfma_f32_16x16x32_bf16 v[148:151], a[144:147], v[124:127], v[148:151]
    v_mfma_f32_16x16x32_bf16 v[152:155], a[144:147], v[128:131], v[152:155]
    v_mfma_f32_16x16x32_bf16 v[156:159], a[64:67], v[124:127], v[156:159]
    v_mfma_f32_16x16x32_bf16 v[160:163], a[64:67], v[128:131], v[160:163]
    ds_read_b128 v[124:127], v12 offset:36864
    ds_read_b128 v[128:131], v12 offset:38912
    s_waitcnt lgkmcnt(4)
    v_mfma_f32_16x16x32_bf16 v[140:143], a[228:231], v[132:135], v[140:143]
    v_mfma_f32_16x16x32_bf16 v[144:147], a[228:231], v[136:139], v[144:147]
    v_mfma_f32_16x16x32_bf16 v[148:151], a[148:151], v[132:135], v[148:151]
    v_mfma_f32_16x16x32_bf16 v[152:155], a[148:151], v[136:139], v[152:155]
    v_mfma_f32_16x16x32_bf16 v[156:159], a[68:71], v[132:135], v[156:159]
    v_mfma_f32_16x16x32_bf16 v[160:163], a[68:71], v[136:139], v[160:163]
    s_waitcnt lgkmcnt(2)
    v_mfma_f32_16x16x32_bf16 v[140:143], a[232:235], v[116:119], v[140:143]
    v_mfma_f32_16x16x32_bf16 v[144:147], a[232:235], v[120:123], v[144:147]
    v_mfma_f32_16x16x32_bf16 v[148:151], a[152:155], v[116:119], v[148:151]
    v_mfma_f32_16x16x32_bf16 v[152:155], a[152:155], v[120:123], v[152:155]
    v_mfma_f32_16x16x32_bf16 v[156:159], a[72:75], v[116:119], v[156:159]
    v_mfma_f32_16x16x32_bf16 v[160:163], a[72:75], v[120:123], v[160:163]
    s_waitcnt lgkmcnt(0)
    v_mfma_f32_16x16x32_bf16 v[140:143], a[236:239], v[124:127], v[140:143]
    v_mfma_f32_16x16x32_bf16 v[144:147], a[236:239], v[128:131], v[144:147]
    v_mfma_f32_16x16x32_bf16 v[148:151], a[156:159], v[124:127], v[148:151]
    v_mfma_f32_16x16x32_bf16 v[152:155], a[156:159], v[128:131], v[152:155]
    v_mfma_f32_16x16x32_bf16 v[156:159], a[76:79], v[124:127], v[156:159]
    v_mfma_f32_16x16x32_bf16 v[160:163], a[76:79], v[128:131], v[160:163]
    s_nop 2
    v_cvt_pk_bf16_f32 v164, v140, v141
    v_cvt_pk_bf16_f32 v165, v142, v143
    v_cvt_pk_bf16_f32 v166, v144, v145
    v_cvt_pk_bf16_f32 v167, v146, v147
    s_add_u32 s90, s48, 1179648
    v_permlane16_swap_b32 v164, v166
    v_permlane16_swap_b32 v165, v167
    buffer_store_dwordx4 v[164:167], v29, s[4:7], s90 offen sc1
    v_cvt_pk_bf16_f32 v168, v148, v149
    v_cvt_pk_bf16_f32 v169, v150, v151
    v_cvt_pk_bf16_f32 v170, v152, v153
    v_cvt_pk_bf16_f32 v171, v154, v155
    s_add_u32 s90, s48, 786432
    v_permlane16_swap_b32 v168, v170
    v_permlane16_swap_b32 v169, v171
    buffer_store_dwordx4 v[168:171], v29, s[4:7], s90 offen sc1
    ds_write_b128 v34, v[168:171]
    v_cvt_pk_bf16_f32 v172, v156, v157
    v_cvt_pk_bf16_f32 v173, v158, v159
    v_cvt_pk_bf16_f32 v174, v160, v161
    v_cvt_pk_bf16_f32 v175, v162, v163
    s_add_u32 s90, s48, 393216
    v_permlane16_swap_b32 v172, v174
    v_permlane16_swap_b32 v173, v175
    buffer_store_dwordx4 v[172:175], v29, s[4:7], s90 offen sc1
    v_add_u32 v11, s52, v11
    v_add_u32 v12, s52, v12
    s_sub_u32 s50, s50, s52
    s_sub_u32 s52, 0, s52
    s_barrier
    s_add_u32 s48, s38, 49152
    v_add_u32 v34, 4096, v27
    v_mov_b32 v32, 1
    s_mov_b32 s49, 81920
    ds_read_b128 v[116:119], v11 offset:0
    ds_read_b128 v[120:123], v11 offset:2048
    ds_read_b128 v[124:127], v12 offset:0
    ds_read_b128 v[128:131], v12 offset:2048
    ds_read_b128 v[132:135], v11 offset:4096
    ds_read_b128 v[136:139], v11 offset:6144
    s_waitcnt lgkmcnt(4)
    v_mfma_f32_16x16x32_bf16 v[140:143], a[160:163], v[116:119], 0
    v_mfma_f32_16x16x32_bf16 v[144:147], a[160:163], v[120:123], 0
    v_mfma_f32_16x16x32_bf16 v[148:151], a[80:83], v[116:119], 0
    v_mfma_f32_16x16x32_bf16 v[152:155], a[80:83], v[120:123], 0
    v_mfma_f32_16x16x32_bf16 v[156:159], a[0:3], v[116:119], 0
    v_mfma_f32_16x16x32_bf16 v[160:163], a[0:3], v[120:123], 0
    ds_read_b128 v[116:119], v12 offset:4096
    ds_read_b128 v[120:123], v12 offset:6144
    s_waitcnt lgkmcnt(4)
    v_mfma_f32_16x16x32_bf16 v[140:143], a[164:167], v[124:127], v[140:143]
    v_mfma_f32_16x16x32_bf16 v[144:147], a[164:167], v[128:131], v[144:147]
    v_mfma_f32_16x16x32_bf16 v[148:151], a[84:87], v[124:127], v[148:151]
    v_mfma_f32_16x16x32_bf16 v[152:155], a[84:87], v[128:131], v[152:155]
    v_mfma_f32_16x16x32_bf16 v[156:159], a[4:7], v[124:127], v[156:159]
    v_mfma_f32_16x16x32_bf16 v[160:163], a[4:7], v[128:131], v[160:163]
    ds_read_b128 v[124:127], v11 offset:8192
    ds_read_b128 v[128:131], v11 offset:10240
    s_waitcnt lgkmcnt(4)
    v_mfma_f32_16x16x32_bf16 v[140:143], a[168:171], v[132:135], v[140:143]
    v_mfma_f32_16x16x32_bf16 v[144:147], a[168:171], v[136:139], v[144:147]
    v_mfma_f32_16x16x32_bf16 v[148:151], a[88:91], v[132:135], v[148:151]
    v_mfma_f32_16x16x32_bf16 v[152:155], a[88:91], v[136:139], v[152:155]
    v_mfma_f32_16x16x32_bf16 v[156:159], a[8:11], v[132:135], v[156:159]
    v_mfma_f32_16x16x32_bf16 v[160:163], a[8:11], v[136:139], v[160:163]
    ds_read_b128 v[132:135], v12 offset:8192
    ds_read_b128 v[136:139], v12 offset:10240
    s_waitcnt lgkmcnt(4)
    v_mfma_f32_16x16x32_bf16 v[140:143], a[172:175], v[116:119], v[140:143]
    v_mfma_f32_16x16x32_bf16 v[144:147], a[172:175], v[120:123], v[144:147]
    v_mfma_f32_16x16x32_bf16 v[148:151], a[92:95], v[116:119], v[148:151]
    v_mfma_f32_16x16x32_bf16 v[152:155], a[92:95], v[120:123], v[152:155]
    v_mfma_f32_16x16x32_bf16 v[156:159], a[12:15], v[116:119], v[156:159]
    v_mfma_f32_16x16x32_bf16 v[160:163], a[12:15], v[120:123], v[160:163]
    ds_read_b128 v[116:119], v11 offset:12288
    ds_read_b128 v[120:123], v11 offset:14336
    s_waitcnt lgkmcnt(4)
    s_waitcnt vmcnt(0)
    buffer_store_dword v32, v30, s[4:7], s38 offen sc1
    s_lshl_b32 s90, s32, 10
    s_add_u32 m0, s90, s50
    v_mfma_f32_16x16x32_bf16 v[140:143], a[176:179], v[124:127], v[140:143]
    v_mfma_f32_16x16x32_bf16 v[144:147], a[176:179], v[128:131], v[144:147]
    v_mfma_f32_16x16x32_bf16 v[148:151], a[96:99], v[124:127], v[148:151]
    v_mfma_f32_16x16x32_bf16 v[152:155], a[96:99], v[128:131], v[152:155]
    v_mfma_f32_16x16x32_bf16 v[156:159], a[16:19], v[124:127], v[156:159]
    v_mfma_f32_16x16x32_bf16 v[160:163], a[16:19], v[128:131], v[160:163]
    ds_read_b128 v[124:127], v12 offset:12288
    ds_read_b128 v[128:131], v12 offset:14336
    s_waitcnt lgkmcnt(4)
    v_mfma_f32_16x16x32_bf16 v[140:143], a[180:183], v[132:135], v[140:143]
    v_mfma_f32_16x16x32_bf16 v[144:147], a[180:183], v[136:139], v[144:147]
    buffer_load_dwordx4 v10, s[24:27], s49 offen offset:0 lds
    s_add_u32 m0, m0, 3968
    v_mfma_f32_16x16x32_bf16 v[148:151], a[100:103], v[132:135], v[148:151]
    v_mfma_f32_16x16x32_bf16 v[152:155], a[100:103], v[136:139], v[152:155]
    v_mfma_f32_16x16x32_bf16 v[156:159], a[20:23], v[132:135], v[156:159]
    v_mfma_f32_16x16x32_bf16 v[160:163], a[20:23], v[136:139], v[160:163]
    ds_read_b128 v[132:135], v11 offset:16384
    ds_read_b128 v[136:139], v11 offset:18432
    s_waitcnt lgkmcnt(4)
    v_mfma_f32_16x16x32_bf16 v[140:143], a[184:187], v[116:119], v[140:143]
    v_mfma_f32_16x16x32_bf16 v[144:147], a[184:187], v[120:123], v[144:147]
    buffer_load_dwordx4 v10, s[24:27], s49 offen offset:128 lds
    s_add_u32 m0, m0, 3968
    v_mfma_f32_16x16x32_bf16 v[148:151], a[104:107], v[116:119], v[148:151]
    v_mfma_f32_16x16x32_bf16 v[152:155], a[104:107], v[120:123], v[152:155]
    v_mfma_f32_16x16x32_bf16 v[156:159], a[24:27], v[116:119], v[156:159]
    v_mfma_f32_16x16x32_bf16 v[160:163], a[24:27], v[120:123], v[160:163]
    ds_read_b128 v[116:119], v12 offset:16384
    ds_read_b128 v[120:123], v12 offset:18432
    s_waitcnt lgkmcnt(4)
    v_mfma_f32_16x16x32_bf16 v[140:143], a[188:191], v[124:127], v[140:143]
    v_mfma_f32_16x16x32_bf16 v[144:147], a[188:191], v[128:131], v[144:147]
    buffer_load_dwordx4 v10, s[24:27], s49 offen offset:256 lds
    s_add_u32 m0, m0, 3968
    v_mfma_f32_16x16x32_bf16 v[148:151], a[108:111], v[124:127], v[148:151]
    v_mfma_f32_16x16x32_bf16 v[152:155], a[108:111], v[128:131], v[152:155]
    v_mfma_f32_16x16x32_bf16 v[156:159], a[28:31], v[124:127], v[156:159]
    v_mfma_f32_16x16x32_bf16 v[160:163], a[28:31], v[128:131], v[160:163]
    ds_read_b128 v[124:127], v11 offset:20480
    ds_read_b128 v[128:131], v11 offset:22528
    s_waitcnt lgkmcnt(4)
    v_mfma_f32_16x16x32_bf16 v[140:143], a[192:195], v[132:135], v[140:143]
    v_mfma_f32_16x16x32_bf16 v[144:147], a[192:195], v[136:139], v[144:147]
    buffer_load_dwordx4 v10, s[24:27], s49 offen offset:384 lds
    s_add_u32 m0, m0, 3968
    v_mfma_f32_16x16x32_bf16 v[148:151], a[112:115], v[132:135], v[148:151]
    v_mfma_f32_16x16x32_bf16 v[152:155], a[112:115], v[136:139], v[152:155]
    v_mfma_f32_16x16x32_bf16 v[156:159], a[32:35], v[132:135], v[156:159]
    v_mfma_f32_16x16x32_bf16 v[160:163], a[32:35], v[136:139], v[160:163]
    ds_read_b128 v[132:135], v12 offset:20480
    ds_read_b128 v[136:139], v12 offset:22528
    s_waitcnt lgkmcnt(4)
    v_mfma_f32_16x16x32_bf16 v[140:143], a[196:199], v[116:119], v[140:143]
    v_mfma_f32_16x16x32_bf16 v[144:147], a[196:199], v[120:123], v[144:147]
    buffer_load_dwordx4 v10, s[24:27], s49 offen offset:512 lds
    s_add_u32 m0, m0, 3968
    v_mfma_f32_16x16x32_bf16 v[148:151], a[116:119], v[116:119], v[148:151]
    v_mfma_f32_16x16x32_bf16 v[152:155], a[116:119], v[120:123], v[152:155]
    v_mfma_f32_16x16x32_bf16 v[156:159], a[36:39], v[116:119], v[156:159]
    v_mfma_f32_16x16x32_bf16 v[160:163], a[36:39], v[120:123], v[160:163]
    ds_read_b128 v[116:119], v11 offset:24576
    ds_read_b128 v[120:123], v11 offset:26624
    s_waitcnt lgkmcnt(4)
    v_mfma_f32_16x16x32_bf16 v[140:143], a[200:203], v[124:127], v[140:143]
    v_mfma_f32_16x16x32_bf16 v[144:147], a[200:203], v[128:131], v[144:147]
    buffer_load_dwordx4 v10, s[24:27], s49 offen offset:640 lds
    s_add_u32 m0, m0, 3968
    v_mfma_f32_16x16x32_bf16 v[148:151], a[120:123], v[124:127], v[148:151]
    v_mfma_f32_16x16x32_bf16 v[152:155], a[120:123], v[128:131], v[152:155]
    v_mfma_f32_16x16x32_bf16 v[156:159], a[40:43], v[124:127], v[156:159]
    v_mfma_f32_16x16x32_bf16 v[160:163], a[40:43], v[128:131], v[160:163]
    ds_read_b128 v[124:127], v12 offset:24576
    ds_read_b128 v[128:131], v12 offset:26624
    s_waitcnt lgkmcnt(4)
    v_mfma_f32_16x16x32_bf16 v[140:143], a[204:207], v[132:135], v[140:143]
    v_mfma_f32_16x16x32_bf16 v[144:147], a[204:207], v[136:139], v[144:147]
    buffer_load_dwordx4 v10, s[24:27], s49 offen offset:768 lds
    s_add_u32 m0, m0, 3968
    v_mfma_f32_16x16x32_bf16 v[148:151], a[124:127], v[132:135], v[148:151]
    v_mfma_f32_16x16x32_bf16 v[152:155], a[124:127], v[136:139], v[152:155]
    v_mfma_f32_16x16x32_bf16 v[156:159], a[44:47], v[132:135], v[156:159]
    v_mfma_f32_16x16x32_bf16 v[160:163], a[44:47], v[136:139], v[160:163]
    ds_read_b128 v[132:135], v11 offset:28672
    ds_read_b128 v[136:139], v11 offset:30720
    s_waitcnt lgkmcnt(4)
    v_mfma_f32_16x16x32_bf16 v[140:143], a[208:211], v[116:119], v[140:143]
    v_mfma_f32_16x16x32_bf16 v[144:147], a[208:211], v[120:123], v[144:147]
    buffer_load_dwordx4 v10, s[24:27], s49 offen offset:896 lds
    s_add_u32 m0, m0, 3968
    v_mfma_f32_16x16x32_bf16 v[148:151], a[128:131], v[116:119], v[148:151]
    v_mfma_f32_16x16x32_bf16 v[152:155], a[128:131], v[120:123], v[152:155]
    v_mfma_f32_16x16x32_bf16 v[156:159], a[48:51], v[116:119], v[156:159]
    v_mfma_f32_16x16x32_bf16 v[160:163], a[48:51], v[120:123], v[160:163]
    ds_read_b128 v[116:119], v12 offset:28672
    ds_read_b128 v[120:123], v12 offset:30720
    s_waitcnt lgkmcnt(4)
    v_mfma_f32_16x16x32_bf16 v[140:143], a[212:215], v[124:127], v[140:143]
    v_mfma_f32_16x16x32_bf16 v[144:147], a[212:215], v[128:131], v[144:147]
    buffer_load_dwordx4 v10, s[24:27], s49 offen offset:1024 lds
    s_add_u32 m0, m0, 3968
    v_mfma_f32_16x16x32_bf16 v[148:151], a[132:135], v[124:127], v[148:151]
    v_mfma_f32_16x16x32_bf16 v[152:155], a[132:135], v[128:131], v[152:155]
    v_mfma_f32_16x16x32_bf16 v[156:159], a[52:55], v[124:127], v[156:159]
    v_mfma_f32_16x16x32_bf16 v[160:163], a[52:55], v[128:131], v[160:163]
    ds_read_b128 v[124:127], v11 offset:32768
    ds_read_b128 v[128:131], v11 offset:34816
    s_waitcnt lgkmcnt(4)
    v_mfma_f32_16x16x32_bf16 v[140:143], a[216:219], v[132:135], v[140:143]
    v_mfma_f32_16x16x32_bf16 v[144:147], a[216:219], v[136:139], v[144:147]
    buffer_load_dwordx4 v10, s[24:27], s49 offen offset:1152 lds
    v_mfma_f32_16x16x32_bf16 v[148:151], a[136:139], v[132:135], v[148:151]
    v_mfma_f32_16x16x32_bf16 v[152:155], a[136:139], v[136:139], v[152:155]
    v_mfma_f32_16x16x32_bf16 v[156:159], a[56:59], v[132:135], v[156:159]
    v_mfma_f32_16x16x32_bf16 v[160:163], a[56:59], v[136:139], v[160:163]
    ds_read_b128 v[132:135], v12 offset:32768
    ds_read_b128 v[136:139], v12 offset:34816
    s_waitcnt lgkmcnt(4)
    v_mfma_f32_16x16x32_bf16 v[140:143], a[220:223], v[116:119], v[140:143]
    v_mfma_f32_16x16x32_bf16 v[144:147], a[220:223], v[120:123], v[144:147]
    v_mfma_f32_16x16x32_bf16 v[148:151], a[140:143], v[116:119], v[148:151]
    v_mfma_f32_16x16x32_bf16 v[152:155], a[140:143], v[120:123], v[152:155]
    v_mfma_f32_16x16x32_bf16 v[156:159], a[60:63], v[116:119], v[156:159]
    v_mfma_f32_16x16x32_bf16 v[160:163], a[60:63], v[120:123], v[160:163]
    ds_read_b128 v[116:119], v11 offset:36864
    ds_read_b128 v[120:123], v11 offset:38912
    s_waitcnt lgkmcnt(4)
    v_mfma_f32_16x16x32_bf16 v[140:143], a[224:227], v[124:127], v[140:143]
    v_mfma_f32_16x16x32_bf16 v[144:147], a[224:227], v[128:131], v[144:147]
    v_mfma_f32_16x16x32_bf16 v[148:151], a[144:147], v[124:127], v[148:151]
    v_mfma_f32_16x16x32_bf16 v[152:155], a[144:147], v[128:131], v[152:155]
    v_mfma_f32_16x16x32_bf16 v[156:159], a[64:67], v[124:127], v[156:159]
    v_mfma_f32_16x16x32_bf16 v[160:163], a[64:67], v[128:131], v[160:163]
    ds_read_b128 v[124:127], v12 offset:36864
    ds_read_b128 v[128:131], v12 offset:38912
    s_waitcnt lgkmcnt(4)
    v_mfma_f32_16x16x32_bf16 v[140:143], a[228:231], v[132:135], v[140:143]
    v_mfma_f32_16x16x32_bf16 v[144:147], a[228:231], v[136:139], v[144:147]
    v_mfma_f32_16x16x32_bf16 v[148:151], a[148:151], v[132:135], v[148:151]
    v_mfma_f32_16x16x32_bf16 v[152:155], a[148:151], v[136:139], v[152:155]
    v_mfma_f32_16x16x32_bf16 v[156:159], a[68:71], v[132:135], v[156:159]
    v_mfma_f32_16x16x32_bf16 v[160:163], a[68:71], v[136:139], v[160:163]
    s_waitcnt lgkmcnt(2)
    v_mfma_f32_16x16x32_bf16 v[140:143], a[232:235], v[116:119], v[140:143]
    v_mfma_f32_16x16x32_bf16 v[144:147], a[232:235], v[120:123], v[144:147]
    v_mfma_f32_16x16x32_bf16 v[148:151], a[152:155], v[116:119], v[148:151]
    v_mfma_f32_16x16x32_bf16 v[152:155], a[152:155], v[120:123], v[152:155]
    v_mfma_f32_16x16x32_bf16 v[156:159], a[72:75], v[116:119], v[156:159]
    v_mfma_f32_16x16x32_bf16 v[160:163], a[72:75], v[120:123], v[160:163]
    s_waitcnt lgkmcnt(0)
    v_mfma_f32_16x16x32_bf16 v[140:143], a[236:239], v[124:127], v[140:143]
    v_mfma_f32_16x16x32_bf16 v[144:147], a[236:239], v[128:131], v[144:147]
    v_mfma_f32_16x16x32_bf16 v[148:151], a[156:159], v[124:127], v[148:151]
    v_mfma_f32_16x16x32_bf16 v[152:155], a[156:159], v[128:131], v[152:155]
    v_mfma_f32_16x16x32_bf16 v[156:159], a[76:79], v[124:127], v[156:159]
    v_mfma_f32_16x16x32_bf16 v[160:163], a[76:79], v[128:131], v[160:163]
    s_nop 2
    v_cvt_pk_bf16_f32 v164, v140, v141
    v_cvt_pk_bf16_f32 v165, v142, v143
    v_cvt_pk_bf16_f32 v166, v144, v145
    v_cvt_pk_bf16_f32 v167, v146, v147
    s_add_u32 s90, s48, 1179648
    v_permlane16_swap_b32 v164, v166
    v_permlane16_swap_b32 v165, v167
    buffer_store_dwordx4 v[164:167], v29, s[4:7], s90 offen sc1
    v_cvt_pk_bf16_f32 v168, v148, v149
    v_cvt_pk_bf16_f32 v169, v150, v151
    v_cvt_pk_bf16_f32 v170, v152, v153
    v_cvt_pk_bf16_f32 v171, v154, v155
    s_add_u32 s90, s48, 786432
    v_permlane16_swap_b32 v168, v170
    v_permlane16_swap_b32 v169, v171
    buffer_store_dwordx4 v[168:171], v29, s[4:7], s90 offen sc1
    ds_write_b128 v34, v[168:171]
    v_cvt_pk_bf16_f32 v172, v156, v157
    v_cvt_pk_bf16_f32 v173, v158, v159
    v_cvt_pk_bf16_f32 v174, v160, v161
    v_cvt_pk_bf16_f32 v175, v162, v163
    s_add_u32 s90, s48, 393216
    v_permlane16_swap_b32 v172, v174
    v_permlane16_swap_b32 v173, v175
    buffer_store_dwordx4 v[172:175], v29, s[4:7], s90 offen sc1
    v_add_u32 v11, s52, v11
    v_add_u32 v12, s52, v12
    s_sub_u32 s50, s50, s52
    s_sub_u32 s52, 0, s52
    s_waitcnt lgkmcnt(0)
    s_barrier
    v_lshlrev_b32 v1, 2, v0
L_gw_52:
    buffer_load_dword v2, v1, s[8:11], 0 offen sc1
    s_sub_u32 s36, s36, 1
    s_cbranch_scc1 L_exit
    s_waitcnt vmcnt(0)
    v_readlane_b32 s90, v2, 17
    s_nop 0
    s_cmp_lg_u32 s90, 256
    s_cbranch_scc1 L_gw_52
    s_mov_b32 s37, 0
L_qkv_loop_s:
    s_and_b32 s90, s37, 3
    s_lshl_b32 s91, s90, 12
    v_add_u32 v35, s91, v28
    s_xor_b32 s91, s91, 8192
    v_add_u32 v34, s91, v27
    s_mul_i32 s91, s90, 10240
    s_add_u32 s42, s38, s91
    s_mov_b32 m0, s51
    ds_read_b128 v[100:103], v35
    ds_read_b128 v[104:107], v35 offset:1024
    buffer_load_dwordx4 v13, s[4:7], s42 offen sc1 lds
    buffer_load_dwordx4 v13, s[4:7], s42 offen offset:1024 sc1 lds
    buffer_load_dword v14, s[4:7], s42 offen offset:2048 sc1 lds
    buffer_load_dword v14, s[4:7], s42 offen offset:2304 sc1 lds
    s_mul_i32 s91, s90, 15360
    s_add_u32 s91, s91, 40960
    s_add_u32 s43, s38, s91
    s_mul_i32 s91, s90, 12288
    s_add_u32 s91, s91, 102400
    s_add_u32 s44, s38, s91
    s_add_u32 s90, s37, 3
    s_min_u32 s92, s90, 63
    s_mul_i32 s49, s92, 40960
    s_and_b32 s90, s90, 3
    s_mul_i32 s91, s90, 15360
    s_add_u32 s91, s91, 40960
    s_add_u32 s45, s38, s91
    s_mul_i32 s91, s90, 12288
    s_add_u32 s91, s91, 102400
    s_add_u32 s46, s38, s91
    s_and_b32 s90, s37, 7
    s_mul_i32 s91, s90, 12288
    s_add_u32 s91, s91, 155648
    s_add_u32 s47, s38, s91
    s_add_u32 s90, s37, 2
    v_mov_b32 v32, s90
    s_and_b32 s90, s90, 7
    s_mul_i32 s91, s90, 49152
    s_add_u32 s48, s38, s91
    v_mov_b32 v80, 0
    v_mov_b32 v81, 0
    v_mov_b32 v82, 0
    v_mov_b32 v83, 0
    v_mov_b32 v84, 0
    v_mov_b32 v85, 0
    v_mov_b32 v86, 0
    v_mov_b32 v87, 0
    v_mov_b32 v88, 0
    v_mov_b32 v89, 0
    v_mov_b32 v90, 0
    v_mov_b32 v91, 0
    s_waitcnt vmcnt(0)
    ds_read_b32 v33, v15
    buffer_store_dword v32, v30, s[4:7], s38 offen sc1
    s_add_u32 s90, s37, 1
    s_waitcnt lgkmcnt(0)
    v_cmp_eq_u32 vcc, -1, v33
    v_mov_b32 v32, s90
    s_cbranch_vccz L_got_53
L_poll_54:
    buffer_load_dwordx4 v13, s[4:7], s42 offen sc1 lds
    buffer_load_dwordx4 v13, s[4:7], s42 offen offset:1024 sc1 lds
    buffer_load_dword v14, s[4:7], s42 offen offset:2048 sc1 lds
    buffer_load_dword v14, s[4:7], s42 offen offset:2304 sc1 lds
    s_sub_u32 s36, s36, 1
    s_cbranch_scc1 L_exit
    s_waitcnt vmcnt(0)
    ds_read_b32 v33, v15
    s_waitcnt lgkmcnt(0)
    v_cmp_eq_u32 vcc, -1, v33
    s_cbranch_vccnz L_poll_54
L_got_53:
    s_barrier
    ds_read_b64_tr_b16 v[40:41], v16 offset:0
    ds_read_b64_tr_b16 v[42:43], v17 offset:0
    ds_read_b64_tr_b16 v[44:45], v16 offset:1024
    ds_read_b64_tr_b16 v[46:47], v17 offset:1024
    ds_read_b64_tr_b16 v[48:49], v16 offset:2048
    ds_read_b64_tr_b16 v[50:51], v17 offset:2048
    ds_read_b64_tr_b16 v[52:53], v16 offset:3072
    ds_read_b64_tr_b16 v[54:55], v17 offset:3072
    ds_read_b64_tr_b16 v[56:57], v16 offset:4096
    ds_read_b64_tr_b16 v[58:59], v17 offset:4096
    ds_read_b64_tr_b16 v[60:61], v16 offset:5120
    ds_read_b64_tr_b16 v[62:63], v17 offset:5120
    ds_read_b64_tr_b16 v[64:65], v16 offset:6144
    ds_read_b64_tr_b16 v[66:67], v17 offset:6144
    s_waitcnt lgkmcnt(12)
    v_smfmac_f32_16x16x64_bf16 v[80:83], v[40:43], a[160:167], v18
    ds_read_b64_tr_b16 v[68:69], v16 offset:7168
    ds_read_b64_tr_b16 v[70:71], v17 offset:7168
    s_waitcnt lgkmcnt(12)
    v_smfmac_f32_16x16x64_bf16 v[80:83], v[44:47], a[168:175], v18
    ds_read_b64_tr_b16 v[72:73], v16 offset:8192
    ds_read_b64_tr_b16 v[74:75], v17 offset:8192
    s_waitcnt lgkmcnt(12)
    v_smfmac_f32_16x16x64_bf16 v[80:83], v[48:51], a[176:183], v18
    ds_read_b64_tr_b16 v[76:77], v16 offset:9216
    ds_read_b64_tr_b16 v[78:79], v17 offset:9216
    s_waitcnt lgkmcnt(12)
    v_smfmac_f32_16x16x64_bf16 v[80:83], v[52:55], a[184:191], v18
    s_waitcnt lgkmcnt(10)
    v_smfmac_f32_16x16x64_bf16 v[80:83], v[56:59], a[192:199], v18
    s_waitcnt lgkmcnt(8)
    v_smfmac_f32_16x16x64_bf16 v[80:83], v[60:63], a[200:207], v18
    s_waitcnt lgkmcnt(6)
    v_smfmac_f32_16x16x64_bf16 v[80:83], v[64:67], a[208:215], v18
    s_waitcnt lgkmcnt(4)
    v_smfmac_f32_16x16x64_bf16 v[80:83], v[68:71], a[216:223], v18
    s_waitcnt lgkmcnt(2)
    v_smfmac_f32_16x16x64_bf16 v[80:83], v[72:75], a[224:231], v18
    s_waitcnt lgkmcnt(0)
    v_smfmac_f32_16x16x64_bf16 v[80:83], v[76:79], a[232:239], v18
    v_smfmac_f32_16x16x64_bf16 v[84:87], v[40:43], a[0:7], v18
    v_smfmac_f32_16x16x64_bf16 v[88:91], v[40:43], a[80:87], v18
    v_smfmac_f32_16x16x64_bf16 v[84:87], v[44:47], a[8:15], v18
    v_smfmac_f32_16x16x64_bf16 v[88:91], v[44:47], a[88:95], v18
    v_smfmac_f32_16x16x64_bf16 v[84:87], v[48:51], a[16:23], v18
    v_smfmac_f32_16x16x64_bf16 v[88:91], v[48:51], a[96:103], v18
    v_smfmac_f32_16x16x64_bf16 v[84:87], v[52:55], a[24:31], v18
    v_smfmac_f32_16x16x64_bf16 v[88:91], v[52:55], a[104:111], v18
    v_pk_add_f32 v[80:81], v[80:81], v[82:83]
    v_smfmac_f32_16x16x64_bf16 v[84:87], v[56:59], a[32:39], v18
    v_cmp_u_f32 vcc, v80, v81
    v_cvt_pk_bf16_f32 v112, v80, v81
    v_smfmac_f32_16x16x64_bf16 v[88:91], v[56:59], a[112:119], v18
    ds_write_b32 v19, v112
    v_smfmac_f32_16x16x64_bf16 v[84:87], v[60:63], a[40:47], v18
    s_cbranch_vccnz L_nan_55
L_cont_56:
    v_smfmac_f32_16x16x64_bf16 v[88:91], v[60:63], a[120:127], v18
    ds_read_b64_tr_b16 v[112:113], v20
    ds_read_b64_tr_b16 v[114:115], v20 offset:128
    v_smfmac_f32_16x16x64_bf16 v[84:87], v[64:67], a[48:55], v18
    v_smfmac_f32_16x16x64_bf16 v[88:91], v[64:67], a[128:135], v18
    v_smfmac_f32_16x16x64_bf16 v[84:87], v[68:71], a[56:63], v18
    v_smfmac_f32_16x16x64_bf16 v[88:91], v[68:71], a[136:143], v18
    v_smfmac_f32_16x16x64_bf16 v[84:87], v[72:75], a[64:71], v18
    v_smfmac_f32_16x16x64_bf16 v[88:91], v[72:75], a[144:151], v18
    s_waitcnt lgkmcnt(0)
    buffer_store_dwordx4 v[112:115], v21, s[4:7], s44 offen sc1
    v_smfmac_f32_16x16x64_bf16 v[84:87], v[76:79], a[72:79], v18
    v_smfmac_f32_16x16x64_bf16 v[88:91], v[76:79], a[152:159], v18
    s_cmp_eq_u32 s32, 0
    s_nop 4
    s_cbranch_scc1 L_w0_57
    s_cmp_eq_u32 s32, 3
    s_nop 2
    s_cbranch_scc1 L_w3_58
    s_nop 2
    v_pk_add_f32 v[84:85], v[84:85], v[86:87]
    v_pk_add_f32 v[88:89], v[88:89], v[90:91]
    v_cvt_pk_bf16_f32 v176, v84, v85
    v_cvt_pk_bf16_f32 v177, v88, v89
    ds_write_b64 v22, v[176:177]
    s_waitcnt lgkmcnt(0)
    s_barrier
    ds_read_b64_tr_b16 v[92:93], v23 offset:0
    ds_read_b64_tr_b16 v[94:95], v24 offset:0
    ds_read_b64_tr_b16 v[96:97], v23 offset:1024
    ds_read_b64_tr_b16 v[98:99], v24 offset:1024
    s_waitcnt lgkmcnt(2)
    v_mfma_f32_16x16x32_bf16 v[108:111], v[100:103], v[92:95], 0
    s_waitcnt lgkmcnt(0)
    v_mfma_f32_16x16x32_bf16 v[108:111], v[104:107], v[96:99], v[108:111]
    s_nop 7
    buffer_store_dwordx4 v[108:111], v25, s[4:7], s43 offen sc1
    buffer_store_dwordx4 v[36:39], v25, s[4:7], s45 offen sc1
    s_branch L_join_59
L_w0_57:
    v_pk_add_f32 v[84:85], v[84:85], v[86:87]
    v_pk_add_f32 v[88:89], v[88:89], v[90:91]
    v_cvt_pk_bf16_f32 v176, v84, v85
    v_cvt_pk_bf16_f32 v177, v88, v89
    ds_write_b64 v22, v[176:177]
    s_waitcnt lgkmcnt(0)
    s_barrier
    ds_read_b64_tr_b16 v[92:93], v23 offset:0
    ds_read_b64_tr_b16 v[94:95], v24 offset:0
    ds_read_b64_tr_b16 v[96:97], v23 offset:1024
    ds_read_b64_tr_b16 v[98:99], v24 offset:1024
    s_waitcnt lgkmcnt(2)
    v_mfma_f32_16x16x32_bf16 v[108:111], v[92:95], v[92:95], 0
    s_waitcnt lgkmcnt(0)
    v_mfma_f32_16x16x32_bf16 v[108:111], v[96:99], v[96:99], v[108:111]
    s_nop 7
    buffer_store_dword v110, v25, s[4:7], s43 offen sc1
    buffer_store_dword v111, v25, s[4:7], s43 offen offset:8 sc1
    buffer_store_dword v38, v25, s[4:7], s45 offen sc1
    buffer_store_dword v39, v25, s[4:7], s45 offen offset:8 sc1
    s_branch L_join_59
L_w3_58:
    v_pk_add_f32 v[84:85], v[84:85], v[86:87]
    v_pk_add_f32 v[88:89], v[88:89], v[90:91]
    v_cvt_pk_bf16_f32 v176, v84, v85
    v_cvt_pk_bf16_f32 v177, v88, v89
    ds_write_b64 v22, v[176:177]
    s_waitcnt lgkmcnt(0)
    s_barrier
    ds_read_b64_tr_b16 v[92:93], v23 offset:0
    ds_read_b64_tr_b16 v[94:95], v24 offset:0
    ds_read_b64_tr_b16 v[96:97], v23 offset:1024
    ds_read_b64_tr_b16 v[98:99], v24 offset:1024
    s_waitcnt lgkmcnt(2)
    buffer_store_dwordx4 v[92:95], v26, s[4:7], s47 offen sc1
    s_waitcnt lgkmcnt(0)
    buffer_store_dwordx4 v[96:99], v26, s[4:7], s47 offen offset:512 sc1
L_join_59:
    buffer_store_dwordx4 v[36:39], v21, s[4:7], s46 offen sc1
    s_cmp_ge_u32 s37, 62
    s_cbranch_scc1 L_skip_60
    ds_read_b128 v[116:119], v11 offset:0
    ds_read_b128 v[120:123], v11 offset:2048
    ds_read_b128 v[124:127], v12 offset:0
    ds_read_b128 v[128:131], v12 offset:2048
    ds_read_b128 v[132:135], v11 offset:4096
    ds_read_b128 v[136:139], v11 offset:6144
    s_waitcnt lgkmcnt(4)
    v_mfma_f32_16x16x32_bf16 v[140:143], a[160:163], v[116:119], 0
    v_mfma_f32_16x16x32_bf16 v[144:147], a[160:163], v[120:123], 0
    v_mfma_f32_16x16x32_bf16 v[148:151], a[80:83], v[116:119], 0
    v_mfma_f32_16x16x32_bf16 v[152:155], a[80:83], v[120:123], 0
    v_mfma_f32_16x16x32_bf16 v[156:159], a[0:3], v[116:119], 0
    v_mfma_f32_16x16x32_bf16 v[160:163], a[0:3], v[120:123], 0
    ds_read_b128 v[116:119], v12 offset:4096
    ds_read_b128 v[120:123], v12 offset:6144
    s_waitcnt lgkmcnt(4)
    v_mfma_f32_16x16x32_bf16 v[140:143], a[164:167], v[124:127], v[140:143]
    v_mfma_f32_16x16x32_bf16 v[144:147], a[164:167], v[128:131], v[144:147]
    v_mfma_f32_16x16x32_bf16 v[148:151], a[84:87], v[124:127], v[148:151]
    v_mfma_f32_16x16x32_bf16 v[152:155], a[84:87], v[128:131], v[152:155]
    v_mfma_f32_16x16x32_bf16 v[156:159], a[4:7], v[124:127], v[156:159]
    v_mfma_f32_16x16x32_bf16 v[160:163], a[4:7], v[128:131], v[160:163]
    ds_read_b128 v[124:127], v11 offset:8192
    ds_read_b128 v[128:131], v11 offset:10240
    s_waitcnt lgkmcnt(4)
    v_mfma_f32_16x16x32_bf16 v[140:143], a[168:171], v[132:135], v[140:143]
    v_mfma_f32_16x16x32_bf16 v[144:147], a[168:171], v[136:139], v[144:147]
    v_mfma_f32_16x16x32_bf16 v[148:151], a[88:91], v[132:135], v[148:151]
    v_mfma_f32_16x16x32_bf16 v[152:155], a[88:91], v[136:139], v[152:155]
    v_mfma_f32_16x16x32_bf16 v[156:159], a[8:11], v[132:135], v[156:159]
    v_mfma_f32_16x16x32_bf16 v[160:163], a[8:11], v[136:139], v[160:163]
    ds_read_b128 v[132:135], v12 offset:8192
    ds_read_b128 v[136:139], v12 offset:10240
    s_waitcnt lgkmcnt(4)
    v_mfma_f32_16x16x32_bf16 v[140:143], a[172:175], v[116:119], v[140:143]
    v_mfma_f32_16x16x32_bf16 v[144:147], a[172:175], v[120:123], v[144:147]
    v_mfma_f32_16x16x32_bf16 v[148:151], a[92:95], v[116:119], v[148:151]
    v_mfma_f32_16x16x32_bf16 v[152:155], a[92:95], v[120:123], v[152:155]
    v_mfma_f32_16x16x32_bf16 v[156:159], a[12:15], v[116:119], v[156:159]
    v_mfma_f32_16x16x32_bf16 v[160:163], a[12:15], v[120:123], v[160:163]
    ds_read_b128 v[116:119], v11 offset:12288
    ds_read_b128 v[120:123], v11 offset:14336
    s_waitcnt lgkmcnt(4)
    s_waitcnt vmcnt(0)
    buffer_store_dword v32, v31, s[4:7], s38 offen sc1
    s_lshl_b32 s90, s32, 10
    s_add_u32 m0, s90, s50
    v_mfma_f32_16x16x32_bf16 v[140:143], a[176:179], v[124:127], v[140:143]
    v_mfma_f32_16x16x32_bf16 v[144:147], a[176:179], v[128:131], v[144:147]
    v_mfma_f32_16x16x32_bf16 v[148:151], a[96:99], v[124:127], v[148:151]
    v_mfma_f32_16x16x32_bf16 v[152:155], a[96:99], v[128:131], v[152:155]
    v_mfma_f32_16x16x32_bf16 v[156:159], a[16:19], v[124:127], v[156:159]
    v_mfma_f32_16x16x32_bf16 v[160:163], a[16:19], v[128:131], v[160:163]
    ds_read_b128 v[124:127], v12 offset:12288
    ds_read_b128 v[128:131], v12 offset:14336
    s_waitcnt lgkmcnt(4)
    v_mfma_f32_16x16x32_bf16 v[140:143], a[180:183], v[132:135], v[140:143]
    v_mfma_f32_16x16x32_bf16 v[144:147], a[180:183], v[136:139], v[144:147]
    buffer_load_dwordx4 v10, s[24:27], s49 offen offset:0 lds
    s_add_u32 m0, m0, 3968
    v_mfma_f32_16x16x32_bf16 v[148:151], a[100:103], v[132:135], v[148:151]
    v_mfma_f32_16x16x32_bf16 v[152:155], a[100:103], v[136:139], v[152:155]
    v_mfma_f32_16x16x32_bf16 v[156:159], a[20:23], v[132:135], v[156:159]
    v_mfma_f32_16x16x32_bf16 v[160:163], a[20:23], v[136:139], v[160:163]
    ds_read_b128 v[132:135], v11 offset:16384
    ds_read_b128 v[136:139], v11 offset:18432
    s_waitcnt lgkmcnt(4)
    v_mfma_f32_16x16x32_bf16 v[140:143], a[184:187], v[116:119], v[140:143]
    v_mfma_f32_16x16x32_bf16 v[144:147], a[184:187], v[120:123], v[144:147]
    buffer_load_dwordx4 v10, s[24:27], s49 offen offset:128 lds
    s_add_u32 m0, m0, 3968
    v_mfma_f32_16x16x32_bf16 v[148:151], a[104:107], v[116:119], v[148:151]
    v_mfma_f32_16x16x32_bf16 v[152:155], a[104:107], v[120:123], v[152:155]
    v_mfma_f32_16x16x32_bf16 v[156:159], a[24:27], v[116:119], v[156:159]
    v_mfma_f32_16x16x32_bf16 v[160:163], a[24:27], v[120:123], v[160:163]
    ds_read_b128 v[116:119], v12 offset:16384
    ds_read_b128 v[120:123], v12 offset:18432
    s_waitcnt lgkmcnt(4)
    v_mfma_f32_16x16x32_bf16 v[140:143], a[188:191], v[124:127], v[140:143]
    v_mfma_f32_16x16x32_bf16 v[144:147], a[188:191], v[128:131], v[144:147]
    buffer_load_dwordx4 v10, s[24:27], s49 offen offset:256 lds
    s_add_u32 m0, m0, 3968
    v_mfma_f32_16x16x32_bf16 v[148:151], a[108:111], v[124:127], v[148:151]
    v_mfma_f32_16x16x32_bf16 v[152:155], a[108:111], v[128:131], v[152:155]
    v_mfma_f32_16x16x32_bf16 v[156:159], a[28:31], v[124:127], v[156:159]
    v_mfma_f32_16x16x32_bf16 v[160:163], a[28:31], v[128:131], v[160:163]
    ds_read_b128 v[124:127], v11 offset:20480
    ds_read_b128 v[128:131], v11 offset:22528
    s_waitcnt lgkmcnt(4)
    v_mfma_f32_16x16x32_bf16 v[140:143], a[192:195], v[132:135], v[140:143]
    v_mfma_f32_16x16x32_bf16 v[144:147], a[192:195], v[136:139], v[144:147]
    buffer_load_dwordx4 v10, s[24:27], s49 offen offset:384 lds
    s_add_u32 m0, m0, 3968
    v_mfma_f32_16x16x32_bf16 v[148:151], a[112:115], v[132:135], v[148:151]
    v_mfma_f32_16x16x32_bf16 v[152:155], a[112:115], v[136:139], v[152:155]
    v_mfma_f32_16x16x32_bf16 v[156:159], a[32:35], v[132:135], v[156:159]
    v_mfma_f32_16x16x32_bf16 v[160:163], a[32:35], v[136:139], v[160:163]
    ds_read_b128 v[132:135], v12 offset:20480
    ds_read_b128 v[136:139], v12 offset:22528
    s_waitcnt lgkmcnt(4)
    v_mfma_f32_16x16x32_bf16 v[140:143], a[196:199], v[116:119], v[140:143]
    v_mfma_f32_16x16x32_bf16 v[144:147], a[196:199], v[120:123], v[144:147]
    buffer_load_dwordx4 v10, s[24:27], s49 offen offset:512 lds
    s_add_u32 m0, m0, 3968
    v_mfma_f32_16x16x32_bf16 v[148:151], a[116:119], v[116:119], v[148:151]
    v_mfma_f32_16x16x32_bf16 v[152:155], a[116:119], v[120:123], v[152:155]
    v_mfma_f32_16x16x32_bf16 v[156:159], a[36:39], v[116:119], v[156:159]
    v_mfma_f32_16x16x32_bf16 v[160:163], a[36:39], v[120:123], v[160:163]
    ds_read_b128 v[116:119], v11 offset:24576
    ds_read_b128 v[120:123], v11 offset:26624
    s_waitcnt lgkmcnt(4)
    v_mfma_f32_16x16x32_bf16 v[140:143], a[200:203], v[124:127], v[140:143]
    v_mfma_f32_16x16x32_bf16 v[144:147], a[200:203], v[128:131], v[144:147]
    buffer_load_dwordx4 v10, s[24:27], s49 offen offset:640 lds
    s_add_u32 m0, m0, 3968
    v_mfma_f32_16x16x32_bf16 v[148:151], a[120:123], v[124:127], v[148:151]
    v_mfma_f32_16x16x32_bf16 v[152:155], a[120:123], v[128:131], v[152:155]
    v_mfma_f32_16x16x32_bf16 v[156:159], a[40:43], v[124:127], v[156:159]
    v_mfma_f32_16x16x32_bf16 v[160:163], a[40:43], v[128:131], v[160:163]
    ds_read_b128 v[124:127], v12 offset:24576
    ds_read_b128 v[128:131], v12 offset:26624
    s_waitcnt lgkmcnt(4)
    v_mfma_f32_16x16x32_bf16 v[140:143], a[204:207], v[132:135], v[140:143]
    v_mfma_f32_16x16x32_bf16 v[144:147], a[204:207], v[136:139], v[144:147]
    buffer_load_dwordx4 v10, s[24:27], s49 offen offset:768 lds
    s_add_u32 m0, m0, 3968
    v_mfma_f32_16x16x32_bf16 v[148:151], a[124:127], v[132:135], v[148:151]
    v_mfma_f32_16x16x32_bf16 v[152:155], a[124:127], v[136:139], v[152:155]
    v_mfma_f32_16x16x32_bf16 v[156:159], a[44:47], v[132:135], v[156:159]
    v_mfma_f32_16x16x32_bf16 v[160:163], a[44:47], v[136:139], v[160:163]
    ds_read_b128 v[132:135], v11 offset:28672
    ds_read_b128 v[136:139], v11 offset:30720
    s_waitcnt lgkmcnt(4)
    v_mfma_f32_16x16x32_bf16 v[140:143], a[208:211], v[116:119], v[140:143]
    v_mfma_f32_16x16x32_bf16 v[144:147], a[208:211], v[120:123], v[144:147]
    buffer_load_dwordx4 v10, s[24:27], s49 offen offset:896 lds
    s_add_u32 m0, m0, 3968
    v_mfma_f32_16x16x32_bf16 v[148:151], a[128:131], v[116:119], v[148:151]
    v_mfma_f32_16x16x32_bf16 v[152:155], a[128:131], v[120:123], v[152:155]
    v_mfma_f32_16x16x32_bf16 v[156:159], a[48:51], v[116:119], v[156:159]
    v_mfma_f32_16x16x32_bf16 v[160:163], a[48:51], v[120:123], v[160:163]
    ds_read_b128 v[116:119], v12 offset:28672
    ds_read_b128 v[120:123], v12 offset:30720
    s_waitcnt lgkmcnt(4)
    v_mfma_f32_16x16x32_bf16 v[140:143], a[212:215], v[124:127], v[140:143]
    v_mfma_f32_16x16x32_bf16 v[144:147], a[212:215], v[128:131], v[144:147]
    buffer_load_dwordx4 v10, s[24:27], s49 offen offset:1024 lds
    s_add_u32 m0, m0, 3968
    v_mfma_f32_16x16x32_bf16 v[148:151], a[132:135], v[124:127], v[148:151]
    v_mfma_f32_16x16x32_bf16 v[152:155], a[132:135], v[128:131], v[152:155]
    v_mfma_f32_16x16x32_bf16 v[156:159], a[52:55], v[124:127], v[156:159]
    v_mfma_f32_16x16x32_bf16 v[160:163], a[52:55], v[128:131], v[160:163]
    ds_read_b128 v[124:127], v11 offset:32768
    ds_read_b128 v[128:131], v11 offset:34816
    s_waitcnt lgkmcnt(4)
    v_mfma_f32_16x16x32_bf16 v[140:143], a[216:219], v[132:135], v[140:143]
    v_mfma_f32_16x16x32_bf16 v[144:147], a[216:219], v[136:139], v[144:147]
    buffer_load_dwordx4 v10, s[24:27], s49 offen offset:1152 lds
    v_mfma_f32_16x16x32_bf16 v[148:151], a[136:139], v[132:135], v[148:151]
    v_mfma_f32_16x16x32_bf16 v[152:155], a[136:139], v[136:139], v[152:155]
    v_mfma_f32_16x16x32_bf16 v[156:159], a[56:59], v[132:135], v[156:159]
    v_mfma_f32_16x16x32_bf16 v[160:163], a[56:59], v[136:139], v[160:163]
    ds_read_b128 v[132:135], v12 offset:32768
    ds_read_b128 v[136:139], v12 offset:34816
    s_waitcnt lgkmcnt(4)
    v_mfma_f32_16x16x32_bf16 v[140:143], a[220:223], v[116:119], v[140:143]
    v_mfma_f32_16x16x32_bf16 v[144:147], a[220:223], v[120:123], v[144:147]
    v_mfma_f32_16x16x32_bf16 v[148:151], a[140:143], v[116:119], v[148:151]
    v_mfma_f32_16x16x32_bf16 v[152:155], a[140:143], v[120:123], v[152:155]
    v_mfma_f32_16x16x32_bf16 v[156:159], a[60:63], v[116:119], v[156:159]
    v_mfma_f32_16x16x32_bf16 v[160:163], a[60:63], v[120:123], v[160:163]
    ds_read_b128 v[116:119], v11 offset:36864
    ds_read_b128 v[120:123], v11 offset:38912
    s_waitcnt lgkmcnt(4)
    v_mfma_f32_16x16x32_bf16 v[140:143], a[224:227], v[124:127], v[140:143]
    v_mfma_f32_16x16x32_bf16 v[144:147], a[224:227], v[128:131], v[144:147]
    v_mfma_f32_16x16x32_bf16 v[148:151], a[144:147], v[124:127], v[148:151]
    v_mfma_f32_16x16x32_bf16 v[152:155], a[144:147], v[128:131], v[152:155]
    v_mfma_f32_16x16x32_bf16 v[156:159], a[64:67], v[124:127], v[156:159]
    v_mfma_f32_16x16x32_bf16 v[160:163], a[64:67], v[128:131], v[160:163]
    ds_read_b128 v[124:127], v12 offset:36864
    ds_read_b128 v[128:131], v12 offset:38912
    s_waitcnt lgkmcnt(4)
    v_mfma_f32_16x16x32_bf16 v[140:143], a[228:231], v[132:135], v[140:143]
    v_mfma_f32_16x16x32_bf16 v[144:147], a[228:231], v[136:139], v[144:147]
    v_mfma_f32_16x16x32_bf16 v[148:151], a[148:151], v[132:135], v[148:151]
    v_mfma_f32_16x16x32_bf16 v[152:155], a[148:151], v[136:139], v[152:155]
    v_mfma_f32_16x16x32_bf16 v[156:159], a[68:71], v[132:135], v[156:159]
    v_mfma_f32_16x16x32_bf16 v[160:163], a[68:71], v[136:139], v[160:163]
    s_waitcnt lgkmcnt(2)
    v_mfma_f32_16x16x32_bf16 v[140:143], a[232:235], v[116:119], v[140:143]
    v_mfma_f32_16x16x32_bf16 v[144:147], a[232:235], v[120:123], v[144:147]
    v_mfma_f32_16x16x32_bf16 v[148:151], a[152:155], v[116:119], v[148:151]
    v_mfma_f32_16x16x32_bf16 v[152:155], a[152:155], v[120:123], v[152:155]
    v_mfma_f32_16x16x32_bf16 v[156:159], a[72:75], v[116:119], v[156:159]
    v_mfma_f32_16x16x32_bf16 v[160:163], a[72:75], v[120:123], v[160:163]
    s_waitcnt lgkmcnt(0)
    v_mfma_f32_16x16x32_bf16 v[140:143], a[236:239], v[124:127], v[140:143]
    v_mfma_f32_16x16x32_bf16 v[144:147], a[236:239], v[128:131], v[144:147]
    v_mfma_f32_16x16x32_bf16 v[148:151], a[156:159], v[124:127], v[148:151]
    v_mfma_f32_16x16x32_bf16 v[152:155], a[156:159], v[128:131], v[152:155]
    v_mfma_f32_16x16x32_bf16 v[156:159], a[76:79], v[124:127], v[156:159]
    v_mfma_f32_16x16x32_bf16 v[160:163], a[76:79], v[128:131], v[160:163]
    s_nop 2
    v_cvt_pk_bf16_f32 v164, v140, v141
    v_cvt_pk_bf16_f32 v165, v142, v143
    v_cvt_pk_bf16_f32 v166, v144, v145
    v_cvt_pk_bf16_f32 v167, v146, v147
    s_add_u32 s90, s48, 1179648
    v_permlane16_swap_b32 v164, v166
    v_permlane16_swap_b32 v165, v167
    buffer_store_dwordx4 v[164:167], v29, s[4:7], s90 offen sc1
    v_cvt_pk_bf16_f32 v168, v148, v149
    v_cvt_pk_bf16_f32 v169, v150, v151
    v_cvt_pk_bf16_f32 v170, v152, v153
    v_cvt_pk_bf16_f32 v171, v154, v155
    s_add_u32 s90, s48, 786432
    v_permlane16_swap_b32 v168, v170
    v_permlane16_swap_b32 v169, v171
    buffer_store_dwordx4 v[168:171], v29, s[4:7], s90 offen sc1
    ds_write_b128 v34, v[168:171]
    v_cvt_pk_bf16_f32 v172, v156, v157
    v_cvt_pk_bf16_f32 v173, v158, v159
    v_cvt_pk_bf16_f32 v174, v160, v161
    v_cvt_pk_bf16_f32 v175, v162, v163
    s_add_u32 s90, s48, 393216
    v_permlane16_swap_b32 v172, v174
    v_permlane16_swap_b32 v173, v175
    buffer_store_dwordx4 v[172:175], v29, s[4:7], s90 offen sc1
    v_add_u32 v11, s52, v11
    v_add_u32 v12, s52, v12
    s_sub_u32 s50, s50, s52
    s_sub_u32 s52, 0, s52
L_next_61:
    s_add_u32 s37, s37, 1
    s_branch L_qkv_loop_s
L_skip_60:
    s_waitcnt vmcnt(0)
    buffer_store_dword v32, v31, s[4:7], s38 offen sc1
    s_cmp_lt_u32 s37, 63
    s_cbranch_scc1 L_next_61
    s_endpgm
L_nan_55:
    s_nop 7
    v_lshlrev_b32 v1, 4, v0
    v_add_u32 v1, 122880, v1
    v_mov_b32 v2, 0
    ds_read_b128 v[4:7], v1 offset:0
    s_waitcnt lgkmcnt(0)
    v_max3_u32 v2, v2, v4, v5
    v_max3_u32 v2, v2, v6, v7
    ds_read_b128 v[4:7], v1 offset:1024
    s_waitcnt lgkmcnt(0)
    v_max3_u32 v2, v2, v4, v5
    v_max3_u32 v2, v2, v6, v7
    ds_read_b128 v[4:7], v1 offset:2048
    s_waitcnt lgkmcnt(0)
    v_max3_u32 v2, v2, v4, v5
    v_max3_u32 v2, v2, v6, v7
    ds_read_b128 v[4:7], v1 offset:3072
    s_waitcnt lgkmcnt(0)
    v_max3_u32 v2, v2, v4, v5
    v_max3_u32 v2, v2, v6, v7
    ds_read_b128 v[4:7], v1 offset:4096
    s_waitcnt lgkmcnt(0)
    v_max3_u32 v2, v2, v4, v5
    v_max3_u32 v2, v2, v6, v7
    ds_read_b128 v[4:7], v1 offset:5120
    s_waitcnt lgkmcnt(0)
    v_max3_u32 v2, v2, v4, v5
    v_max3_u32 v2, v2, v6, v7
    ds_read_b128 v[4:7], v1 offset:6144
    s_waitcnt lgkmcnt(0)
    v_max3_u32 v2, v2, v4, v5
    v_max3_u32 v2, v2, v6, v7
    ds_read_b128 v[4:7], v1 offset:7168
    s_waitcnt lgkmcnt(0)
    v_max3_u32 v2, v2, v4, v5
    v_max3_u32 v2, v2, v6, v7
    ds_read_b128 v[4:7], v1 offset:8192
    s_waitcnt lgkmcnt(0)
    v_max3_u32 v2, v2, v4, v5
    v_max3_u32 v2, v2, v6, v7
    ds_read_b128 v[4:7], v1 offset:9216
    s_waitcnt lgkmcnt(0)
    v_max3_u32 v2, v2, v4, v5
    v_max3_u32 v2, v2, v6, v7
    v_cmp_eq_u32 vcc, -1, v2
    s_cbranch_vccz L_cont_56
    s_barrier
    v_mov_b32 v80, 0
    v_mov_b32 v81, 0
    v_mov_b32 v82, 0
    v_mov_b32 v83, 0
    v_mov_b32 v84, 0
    v_mov_b32 v85, 0
    v_mov_b32 v86, 0
    v_mov_b32 v87, 0
    v_mov_b32 v88, 0
    v_mov_b32 v89, 0
    v_mov_b32 v90, 0
    v_mov_b32 v91, 0
    s_branch L_poll_54
L_wo_s:
    s_mov_b32 s12, s80
    s_and_b32 s13, s81, 0xffff
    s_mov_b32 s14, 7864320
    s_mov_b32 s15, 0x20000
    s_mov_b32 s16, s72
    s_and_b32 s17, s73, 0xffff
    s_mov_b32 s18, 10240
    s_mov_b32 s19, 0x20000
    s_sub_u32 s40, s35, 12
    v_and_b32 v1, 15, v0
    v_lshrrev_b32 v2, 4, v0
    v_lshrrev_b32 v3, 3, v0
    v_and_b32 v4, 7, v0
    v_and_b32 v6, 2, v3
    v_xor_b32 v6, v6, v4
    v_lshlrev_b32 v6, 4, v6
    v_mul_u32_u24 v7, 1280, v3
    s_lshl_b32 s90, s34, 2
    s_add_u32 s90, s90, s32
    s_mul_i32 s90, s90, 245760
    s_lshl_b32 s91, s40, 7
    s_add_u32 s90, s90, s91
    v_add3_u32 v176, v6, v7, s90
    v_xor_b32 v177, 64, v176
    s_lshl_b32 s90, s40, 14
    s_lshl_b32 s91, s32, 11
    s_add_u32 s90, s90, s91
    s_lshl_b32 s91, s34, 8
    s_add_u32 s91, s91, s90
    v_lshlrev_b32 v6, 4, v1
    v_lshl_add_u32 v6, v2, 2, v6
    v_add_u32 v14, s91, v6
    v_add_u32 v15, 8192, v14
    s_lshl_b32 s92, s32, 10
    s_add_u32 s92, s92, 122880
    v_add_u32 v19, s92, v6
    v_lshlrev_b32 v12, 4, v0
    v_lshlrev_b32 v13, 2, v0
    v_add_u32 v16, s90, v12
    v_add_u32 v17, 1024, v16
    v_cmp_ne_u32 vcc, s34, v2
    v_mov_b32 v9, 2146435072
    s_nop 0
    v_cndmask_b32 v16, v9, v16, vcc
    v_add_u32 v3, 4, v2
    v_cmp_ne_u32 vcc, s34, v3
    v_mov_b32 v9, 2146435072
    s_nop 0
    v_cndmask_b32 v17, v9, v17, vcc
    v_lshrrev_b32 v3, 2, v1
    v_lshlrev_b32 v6, 6, v3
    v_and_b32 v7, 1, v1
    v_lshl_add_u32 v6, v7, 5, v6
    v_lshl_add_u32 v6, v2, 3, v6
    v_and_b32 v7, 2, v1
    v_lshl_add_u32 v6, v7, 1, v6
    s_and_b32 s90, s32, 1
    s_lshl_b32 s90, s90, 7
    v_xor_b32 v6, s90, v6
    s_lshl_b32 s90, s40, 2
    s_add_u32 s90, s90, s32
    s_lshl_b32 s91, s90, 8
    v_add_u32 v18, s91, v6
    v_mov_b32 v43, -1
    s_lshl_b32 s91, s90, 5
    v_mul_u32_u24 v6, 2560, v2
    v_lshl_add_u32 v6, v1, 1, v6
    v_add_u32 v6, s91, v6
    buffer_load_ushort v4, v6, s[16:19], 0 offen
    buffer_load_ushort v5, v6, s[16:19], 0 offen offset:1280
    s_mov_b32 s90, 0
    buffer_store_dword v43, v14, s[4:7], s90 offen sc1
    buffer_store_dword v43, v15, s[4:7], s90 offen sc1
    s_mov_b32 s90, 163840
    buffer_store_dword v43, v14, s[4:7], s90 offen sc1
    buffer_store_dword v43, v15, s[4:7], s90 offen sc1
    s_mov_b32 s90, 327680
    buffer_store_dword v43, v14, s[4:7], s90 offen sc1
    buffer_store_dword v43, v15, s[4:7], s90 offen sc1
    s_mov_b32 s90, 491520
    buffer_store_dword v43, v14, s[4:7], s90 offen sc1
    buffer_store_dword v43, v15, s[4:7], s90 offen sc1
    s_add_u32 s90, s38, 10240
    buffer_store_dword v43, v18, s[4:7], s90 offen sc1
    s_add_u32 s90, s38, 20480
    buffer_store_dword v43, v18, s[4:7], s90 offen sc1
    s_add_u32 s90, s38, 30720
    buffer_store_dword v43, v18, s[4:7], s90 offen sc1
    s_mul_i32 s90, s32, 24576
    s_mov_b32 m0, s90
    s_mov_b32 s91, 0
    buffer_load_dwordx4 v176, s[12:15], s91 offen lds
    s_add_u32 m0, m0, 1024
    s_add_u32 s91, s91, 10240
    buffer_load_dwordx4 v177, s[12:15], s91 offen lds
    s_add_u32 m0, m0, 1024
    s_add_u32 s91, s91, 10240
    buffer_load_dwordx4 v176, s[12:15], s91 offen lds
    s_add_u32 m0, m0, 1024
    s_add_u32 s91, s91, 10240
    buffer_load_dwordx4 v177, s[12:15], s91 offen lds
    s_add_u32 m0, m0, 1024
    s_add_u32 s91, s91, 10240
    buffer_load_dwordx4 v176, s[12:15], s91 offen lds
    s_add_u32 m0, m0, 1024
    s_add_u32 s91, s91, 10240
    buffer_load_dwordx4 v177, s[12:15], s91 offen lds
    s_add_u32 m0, m0, 1024
    s_add_u32 s91, s91, 10240
    buffer_load_dwordx4 v176, s[12:15], s91 offen lds
    s_add_u32 m0, m0, 1024
    s_add_u32 s91, s91, 10240
    buffer_load_dwordx4 v177, s[12:15], s91 offen lds
    s_add_u32 m0, m0, 1024
    s_add_u32 s91, s91, 10240
    buffer_load_dwordx4 v176, s[12:15], s91 offen lds
    s_add_u32 m0, m0, 1024
    s_add_u32 s91, s91, 10240
    buffer_load_dwordx4 v177, s[12:15], s91 offen lds
    s_add_u32 m0, m0, 1024
    s_add_u32 s91, s91, 10240
    buffer_load_dwordx4 v176, s[12:15], s91 offen lds
    s_add_u32 m0, m0, 1024
    s_add_u32 s91, s91, 10240
    buffer_load_dwordx4 v177, s[12:15], s91 offen lds
    s_add_u32 m0, m0, 1024
    s_add_u32 s91, s91, 10240
    buffer_load_dwordx4 v176, s[12:15], s91 offen lds
    s_add_u32 m0, m0, 1024
    s_add_u32 s91, s91, 10240
    buffer_load_dwordx4 v177, s[12:15], s91 offen lds
    s_add_u32 m0, m0, 1024
    s_add_u32 s91, s91, 10240
    buffer_load_dwordx4 v176, s[12:15], s91 offen lds
    s_add_u32 m0, m0, 1024
    s_add_u32 s91, s91, 10240
    buffer_load_dwordx4 v177, s[12:15], s91 offen lds
    s_add_u32 m0, m0, 1024
    s_add_u32 s91, s91, 10240
    buffer_load_dwordx4 v176, s[12:15], s91 offen lds
    s_add_u32 m0, m0, 1024
    s_add_u32 s91, s91, 10240
    buffer_load_dwordx4 v177, s[12:15], s91 offen lds
    s_add_u32 m0, m0, 1024
    s_add_u32 s91, s91, 10240
    buffer_load_dwordx4 v176, s[12:15], s91 offen lds
    s_add_u32 m0, m0, 1024
    s_add_u32 s91, s91, 10240
    buffer_load_dwordx4 v177, s[12:15], s91 offen lds
    s_add_u32 m0, m0, 1024
    s_add_u32 s91, s91, 10240
    buffer_load_dwordx4 v176, s[12:15], s91 offen lds
    s_add_u32 m0, m0, 1024
    s_add_u32 s91, s91, 10240
    buffer_load_dwordx4 v177, s[12:15], s91 offen lds
    s_add_u32 m0, m0, 1024
    s_add_u32 s91, s91, 10240
    buffer_load_dwordx4 v176, s[12:15], s91 offen lds
    s_add_u32 m0, m0, 1024
    s_add_u32 s91, s91, 10240
    buffer_load_dwordx4 v177, s[12:15], s91 offen lds
    s_waitcnt vmcnt(35)
    v_lshl_or_b32 v4, v5, 16, v4
    v_min_u32 v4, -2, v4
    buffer_store_dword v4, v18, s[4:7], s38 offen sc1
    v_and_b32 v7, 2, v1
    v_cmp_ne_u32 vcc, 0, v7
    v_mov_b32 v5, 0x4444
    v_mov_b32 v6, 0xeeee
    v_cndmask_b32 v10, v5, v6, vcc
    v_mov_b32 v5, 0xe484
    v_mov_b32 v6, 0xee9e
    v_cndmask_b32 v7, v5, v6, vcc
    v_mov_b32 v5, 0x84e4
    v_mov_b32 v6, 0x9eee
    v_cndmask_b32 v8, v5, v6, vcc
    v_cmp_gt_u32 vcc, 2, v2
    s_nop 1
    v_cndmask_b32 v11, v8, v7, vcc
    v_mov_b32 v84, 1065369472
    v_mov_b32 v85, 1065369472
    v_mov_b32 v86, 1065369472
    v_mov_b32 v87, 0
    v_mov_b32 v88, 1065369472
    v_mov_b32 v89, 1065369472
    v_mov_b32 v90, 1065369472
    v_mov_b32 v91, 0
    v_mov_b32 v51, 0
    v_mov_b32 v55, 0
    v_mov_b32 v59, 0
    v_mov_b32 v63, 0
    v_mov_b32 v67, 0
    v_mov_b32 v71, 0
    v_mov_b32 v75, 0
    v_mov_b32 v79, 0
    v_mov_b32 v206, 0
    v_mov_b32 v207, 0
    v_mov_b32 v214, 0
    v_mov_b32 v215, 0
    v_and_b32 v7, 1, v1
    v_cmp_ne_u32 vcc, 0, v7
    v_mov_b32 v5, 0x3f80
    v_mov_b32 v6, 0x3f800000
    v_cndmask_b32 v5, v5, v6, vcc
    v_cmp_eq_u32 vcc, 0, v3
    s_nop 1
    v_cndmask_b32 v92, 0, v5, vcc
    v_cmp_eq_u32 vcc, 1, v3
    s_nop 1
    v_cndmask_b32 v93, 0, v5, vcc
    v_cmp_eq_u32 vcc, 2, v3
    s_nop 1
    v_cndmask_b32 v94, 0, v5, vcc
    v_cmp_eq_u32 vcc, 3, v3
    s_nop 1
    v_cndmask_b32 v95, 0, v5, vcc
    v_mov_b32 v240, 0x3dd53b95
    v_mov_b32 v241, 0x3dd53b95
    s_lshl_b32 s90, s32, 8
    s_add_u32 s90, s90, 122880
    v_lshlrev_b32 v6, 4, v1
    v_lshl_add_u32 v6, v2, 10, v6
    v_add_u32 v20, s90, v6
    s_mul_i32 s90, s32, 1536
    v_add_u32 v21, s90, v12
    s_add_u32 s90, s90, 1024
    v_lshl_add_u32 v22, v0, 3, s90
    s_mul_i32 s90, s32, 6144
    v_add_u32 v23, s90, v12
    s_add_u32 s90, s90, 1024
    v_lshl_add_u32 v24, v0, 3, s90
    v_add_u32 v30, 98304, v12
    s_mul_i32 s90, s32, 3072
    v_add_u32 v39, s90, v12
    s_add_u32 s54, s90, 98304
    s_mul_i32 s90, s32, 3840
    v_add_u32 v40, s90, v12
    s_add_u32 s90, s90, 1024
    v_add_u32 v41, s90, v13
    s_mul_i32 s90, s32, 12288
    v_add_u32 v42, s90, v12
    s_lshl_b32 s90, s40, 16
    s_lshl_b32 s91, s34, 8
    s_add_u32 s91, s91, s90
    s_lshl_b32 s92, s32, 6
    s_add_u32 s91, s91, s92
    v_lshlrev_b32 v6, 11, v1
    v_lshl_add_u32 v6, v2, 4, v6
    v_add_u32 v32, s91, v6
    s_lshl_b32 s91, s34, 2
    s_add_u32 s91, s91, s32
    s_lshl_b32 s92, s91, 11
    s_add_u32 s92, s92, s90
    v_add_u32 v33, s92, v12
    s_mul_i32 s91, s91, 2560
    s_lshl_b32 s92, s40, 7
    s_add_u32 s91, s91, s92
    s_add_u32 s91, s91, 1280
    v_lshlrev_b32 v6, 3, v1
    v_lshl_add_u32 v6, v2, 1, v6
    v_add_u32 v34, s91, v6
    s_lshl_b32 s90, s32, 7
    v_add_u32 v5, s90, v13
    v_add_u32 v6, 151552, v5
    v_add_u32 v7, 152528, v5
    v_cmp_gt_u32 vcc, 12, v0
    s_nop 1
    v_cndmask_b32 v35, v7, v6, vcc
    v_mov_b32 v5, -2
    v_cndmask_b32 v36, v5, 2, vcc
    v_cmp_gt_u32 vcc, 14, v0
    v_mov_b32 v9, 2146435072
    s_nop 0
    v_cndmask_b32 v35, v9, v35, vcc
    v_mov_b32 v5, -1000
    v_cndmask_b32 v36, v5, v36, vcc
    v_and_b32 v4, 3, v1
    v_and_b32 v5, 1, v2
    v_lshl_add_u32 v6, v2, 3, v3
    v_lshlrev_b32 v6, 7, v6
    v_and_b32 v7, 2, v3
    v_lshl_or_b32 v7, v5, 2, v7
    v_lshrrev_b32 v8, 1, v4
    v_xor_b32 v7, v7, v8
    v_lshl_add_u32 v6, v7, 4, v6
    v_and_b32 v7, 1, v4
    v_lshl_add_u32 v6, v7, 3, v6
    s_mul_i32 s90, s32, 24576
    v_add_u32 v6, s90, v6
    v_xor_b32 v178, 0, v6
    v_xor_b32 v179, 32, v6
    v_xor_b32 v180, 64, v6
    v_xor_b32 v181, 96, v6
    s_waitcnt vmcnt(0)
    ds_read_b64_tr_b16 a[0:1], v178 offset:0
    ds_read_b64_tr_b16 a[2:3], v178 offset:512
    ds_read_b64_tr_b16 a[4:5], v178 offset:4096
    ds_read_b64_tr_b16 a[6:7], v178 offset:4608
    ds_read_b64_tr_b16 a[8:9], v178 offset:8192
    ds_read_b64_tr_b16 a[10:11], v178 offset:8704
    ds_read_b64_tr_b16 a[12:13], v178 offset:12288
    ds_read_b64_tr_b16 a[14:15], v178 offset:12800
    ds_read_b64_tr_b16 a[16:17], v178 offset:16384
    ds_read_b64_tr_b16 a[18:19], v178 offset:16896
    ds_read_b64_tr_b16 a[20:21], v178 offset:20480
    ds_read_b64_tr_b16 a[22:23], v178 offset:20992
    ds_read_b64_tr_b16 a[24:25], v179 offset:0
    ds_read_b64_tr_b16 a[26:27], v179 offset:512
    ds_read_b64_tr_b16 a[28:29], v179 offset:4096
    ds_read_b64_tr_b16 a[30:31], v179 offset:4608
    ds_read_b64_tr_b16 a[32:33], v179 offset:8192
    ds_read_b64_tr_b16 a[34:35], v179 offset:8704
    ds_read_b64_tr_b16 a[36:37], v179 offset:12288
    ds_read_b64_tr_b16 a[38:39], v179 offset:12800
    ds_read_b64_tr_b16 a[40:41], v179 offset:16384
    ds_read_b64_tr_b16 a[42:43], v179 offset:16896
    ds_read_b64_tr_b16 a[44:45], v179 offset:20480
    ds_read_b64_tr_b16 a[46:47], v179 offset:20992
    ds_read_b64_tr_b16 a[48:49], v180 offset:0
    ds_read_b64_tr_b16 a[50:51], v180 offset:512
    ds_read_b64_tr_b16 a[52:53], v180 offset:4096
    ds_read_b64_tr_b16 a[54:55], v180 offset:4608
    ds_read_b64_tr_b16 a[56:57], v180 offset:8192
    ds_read_b64_tr_b16 a[58:59], v180 offset:8704
    ds_read_b64_tr_b16 a[60:61], v180 offset:12288
    ds_read_b64_tr_b16 a[62:63], v180 offset:12800
    ds_read_b64_tr_b16 a[64:65], v180 offset:16384
    ds_read_b64_tr_b16 a[66:67], v180 offset:16896
    ds_read_b64_tr_b16 a[68:69], v180 offset:20480
    ds_read_b64_tr_b16 a[70:71], v180 offset:20992
    ds_read_b64_tr_b16 a[72:73], v181 offset:0
    ds_read_b64_tr_b16 a[74:75], v181 offset:512
    ds_read_b64_tr_b16 a[76:77], v181 offset:4096
    ds_read_b64_tr_b16 a[78:79], v181 offset:4608
    ds_read_b64_tr_b16 a[80:81], v181 offset:8192
    ds_read_b64_tr_b16 a[82:83], v181 offset:8704
    ds_read_b64_tr_b16 a[84:85], v181 offset:12288
    ds_read_b64_tr_b16 a[86:87], v181 offset:12800
    ds_read_b64_tr_b16 a[88:89], v181 offset:16384
    ds_read_b64_tr_b16 a[90:91], v181 offset:16896
    ds_read_b64_tr_b16 a[92:93], v181 offset:20480
    ds_read_b64_tr_b16 a[94:95], v181 offset:20992
    v_mov_b32 v4, 126976
    v_mov_b32 v5, 0
    ds_write_b32 v4, v5
    s_waitcnt lgkmcnt(0)
    s_barrier
    s_cmp_lg_u32 s32, 0
    s_cbranch_scc1 L_arr_62
    v_mov_b32 v1, 68
    v_mov_b32 v2, 1
    s_mov_b64 exec, 1
    buffer_atomic_add v2, v1, s[8:11], 0 offen sc1
    s_mov_b64 exec, -1
L_arr_62:
    s_mul_i32 s90, s34, 10
    s_add_u32 s90, s90, s40
    s_lshl_b32 s90, s90, 14
    s_and_b32 s91, s32, 1
    s_lshl_b32 s92, s91, 13
    s_add_u32 s90, s90, s92
    s_lshr_b32 s92, s32, 1
    s_lshl_b32 s92, s92, 12
    s_add_u32 s90, s90, s92
    s_add_u32 s90, s90, 655360
    v_mov_b32 v6, s90
    s_mov_b32 s92, 0
    s_waitcnt vmcnt(0)
    s_barrier
L_race_63:
    buffer_load_dword v7, v6, s[4:7], s92 offen sc1
    s_add_u32 s92, s92, 384
    s_cmp_lt_u32 s92, 3840
    s_waitcnt vmcnt(0)
    s_cbranch_scc1 L_race_63
    s_add_u32 s91, s91, 1
    v_mov_b32 v6, s91
    ds_cmpst_b32 v4, v5, v6
    s_waitcnt lgkmcnt(0)
    s_barrier
    ds_read_b32 v6, v4
    s_waitcnt lgkmcnt(0)
    v_readfirstlane_b32 s53, v6
    s_nop 0
    s_sub_u32 s53, s53, 1
    s_and_b32 s53, s53, 1
    s_lshl_b32 s90, s53, 13
    v_add_u32 v16, s90, v16
    v_add_u32 v17, s90, v17
    v_lshlrev_b32 v1, 2, v0
L_gw_64:
    buffer_load_dword v2, v1, s[8:11], 0 offen sc1
    s_sub_u32 s36, s36, 1
    s_cbranch_scc1 L_exit
    s_waitcnt vmcnt(0)
    v_readlane_b32 s90, v2, 17
    s_nop 0
    s_cmp_lg_u32 s90, 256
    s_cbranch_scc1 L_gw_64
    s_mov_b32 s37, 0
    v_add_u32 v37, -1, v36
    s_add_u32 s47, s38, 1179648
    v_mov_b32 v25, v21
    v_mov_b32 v26, v22
    buffer_load_dword v38, v35, s[4:7], s38 offen sc1
    s_waitcnt vmcnt(0)
    v_cmp_lt_i32 vcc, v38, v37
    s_cbranch_vccz L_fok_66
L_fw_65:
    buffer_load_dword v38, v35, s[4:7], s38 offen sc1
    s_sub_u32 s36, s36, 1
    s_cbranch_scc1 L_exit
    s_waitcnt vmcnt(0)
    v_cmp_lt_i32 vcc, v38, v37
    s_cbranch_vccnz L_fw_65
L_fok_66:
    buffer_load_dwordx4 a[96:99], v42, s[4:7], s47 offen offset:0 sc1
    buffer_load_dwordx4 a[100:103], v42, s[4:7], s47 offen offset:1024 sc1
    buffer_load_dwordx4 a[104:107], v42, s[4:7], s47 offen offset:2048 sc1
    buffer_load_dwordx4 a[108:111], v42, s[4:7], s47 offen offset:3072 sc1
    s_add_u32 s47, s47, 4096
    buffer_load_dwordx4 a[112:115], v42, s[4:7], s47 offen offset:0 sc1
    buffer_load_dwordx4 a[116:119], v42, s[4:7], s47 offen offset:1024 sc1
    buffer_load_dwordx4 a[120:123], v42, s[4:7], s47 offen offset:2048 sc1
    buffer_load_dwordx4 a[124:127], v42, s[4:7], s47 offen offset:3072 sc1
    s_add_u32 s47, s47, 4096
    buffer_load_dwordx4 a[128:131], v42, s[4:7], s47 offen offset:0 sc1
    buffer_load_dwordx4 a[132:135], v42, s[4:7], s47 offen offset:1024 sc1
    buffer_load_dwordx4 a[136:139], v42, s[4:7], s47 offen offset:2048 sc1
    buffer_load_dwordx4 a[140:143], v42, s[4:7], s47 offen offset:3072 sc1
    s_waitcnt vmcnt(0)
    v_mfma_f32_16x16x32_bf16 v[144:147], a[96:99], a[0:3], 0
    v_mfma_f32_16x16x32_bf16 v[148:151], a[120:123], a[0:3], 0
    v_mfma_f32_16x16x32_bf16 v[144:147], a[100:103], a[4:7], v[144:147]
    v_mfma_f32_16x16x32_bf16 v[148:151], a[124:127], a[4:7], v[148:151]
    v_mfma_f32_16x16x32_bf16 v[144:147], a[104:107], a[8:11], v[144:147]
    v_mfma_f32_16x16x32_bf16 v[148:151], a[128:131], a[8:11], v[148:151]
    v_mfma_f32_16x16x32_bf16 v[144:147], a[108:111], a[12:15], v[144:147]
    v_mfma_f32_16x16x32_bf16 v[148:151], a[132:135], a[12:15], v[148:151]
    v_mfma_f32_16x16x32_bf16 v[144:147], a[112:115], a[16:19], v[144:147]
    v_mfma_f32_16x16x32_bf16 v[148:151], a[136:139], a[16:19], v[148:151]
    v_mfma_f32_16x16x32_bf16 v[144:147], a[116:119], a[20:23], v[144:147]
    v_mfma_f32_16x16x32_bf16 v[148:151], a[140:143], a[20:23], v[148:151]
    v_mfma_f32_16x16x32_bf16 v[152:155], a[96:99], a[24:27], 0
    v_mfma_f32_16x16x32_bf16 v[156:159], a[120:123], a[24:27], 0
    v_mfma_f32_16x16x32_bf16 v[152:155], a[100:103], a[28:31], v[152:155]
    v_mfma_f32_16x16x32_bf16 v[156:159], a[124:127], a[28:31], v[156:159]
    v_mfma_f32_16x16x32_bf16 v[152:155], a[104:107], a[32:35], v[152:155]
    v_mfma_f32_16x16x32_bf16 v[156:159], a[128:131], a[32:35], v[156:159]
    v_mfma_f32_16x16x32_bf16 v[152:155], a[108:111], a[36:39], v[152:155]
    v_mfma_f32_16x16x32_bf16 v[156:159], a[132:135], a[36:39], v[156:159]
    v_cvt_pk_bf16_f32 v48, v144, v145
    v_cvt_pk_bf16_f32 v49, v146, v147
    v_mfma_f32_16x16x32_bf16 v[152:155], a[112:115], a[40:43], v[152:155]
    v_cvt_pk_bf16_f32 v52, v148, v149
    v_cvt_pk_bf16_f32 v53, v150, v151
    v_mfma_f32_16x16x32_bf16 v[156:159], a[136:139], a[40:43], v[156:159]
    ds_write_b64 v25, v[48:49] offset:0
    ds_write_b64 v26, v[52:53] offset:0
    v_mfma_f32_16x16x32_bf16 v[152:155], a[116:119], a[44:47], v[152:155]
    v_mfma_f32_16x16x32_bf16 v[156:159], a[140:143], a[44:47], v[156:159]
    v_mfma_f32_16x16x32_bf16 v[144:147], a[96:99], a[48:51], 0
    v_mfma_f32_16x16x32_bf16 v[148:151], a[120:123], a[48:51], 0
    v_mfma_f32_16x16x32_bf16 v[144:147], a[100:103], a[52:55], v[144:147]
    v_mfma_f32_16x16x32_bf16 v[148:151], a[124:127], a[52:55], v[148:151]
    v_mfma_f32_16x16x32_bf16 v[144:147], a[104:107], a[56:59], v[144:147]
    v_mfma_f32_16x16x32_bf16 v[148:151], a[128:131], a[56:59], v[148:151]
    v_mfma_f32_16x16x32_bf16 v[144:147], a[108:111], a[60:63], v[144:147]
    v_mfma_f32_16x16x32_bf16 v[148:151], a[132:135], a[60:63], v[148:151]
    v_cvt_pk_bf16_f32 v56, v152, v153
    v_cvt_pk_bf16_f32 v57, v154, v155
    v_mfma_f32_16x16x32_bf16 v[144:147], a[112:115], a[64:67], v[144:147]
    v_cvt_pk_bf16_f32 v60, v156, v157
    v_cvt_pk_bf16_f32 v61, v158, v159
    v_mfma_f32_16x16x32_bf16 v[148:151], a[136:139], a[64:67], v[148:151]
    ds_write_b64 v25, v[56:57] offset:6144
    ds_write_b64 v26, v[60:61] offset:6144
    v_mfma_f32_16x16x32_bf16 v[144:147], a[116:119], a[68:71], v[144:147]
    v_mfma_f32_16x16x32_bf16 v[148:151], a[140:143], a[68:71], v[148:151]
    v_mfma_f32_16x16x32_bf16 v[152:155], a[96:99], a[72:75], 0
    v_mfma_f32_16x16x32_bf16 v[156:159], a[120:123], a[72:75], 0
    v_mfma_f32_16x16x32_bf16 v[152:155], a[100:103], a[76:79], v[152:155]
    v_mfma_f32_16x16x32_bf16 v[156:159], a[124:127], a[76:79], v[156:159]
    v_mfma_f32_16x16x32_bf16 v[152:155], a[104:107], a[80:83], v[152:155]
    v_mfma_f32_16x16x32_bf16 v[156:159], a[128:131], a[80:83], v[156:159]
    v_mfma_f32_16x16x32_bf16 v[152:155], a[108:111], a[84:87], v[152:155]
    v_mfma_f32_16x16x32_bf16 v[156:159], a[132:135], a[84:87], v[156:159]
    v_cvt_pk_bf16_f32 v64, v144, v145
    v_cvt_pk_bf16_f32 v65, v146, v147
    v_mfma_f32_16x16x32_bf16 v[152:155], a[112:115], a[88:91], v[152:155]
    v_cvt_pk_bf16_f32 v68, v148, v149
    v_cvt_pk_bf16_f32 v69, v150, v151
    v_mfma_f32_16x16x32_bf16 v[156:159], a[136:139], a[88:91], v[156:159]
    ds_write_b64 v25, v[64:65] offset:12288
    ds_write_b64 v26, v[68:69] offset:12288
    v_mfma_f32_16x16x32_bf16 v[152:155], a[116:119], a[92:95], v[152:155]
    v_mfma_f32_16x16x32_bf16 v[156:159], a[140:143], a[92:95], v[156:159]
    s_nop 6
    v_cvt_pk_bf16_f32 v72, v152, v153
    v_cvt_pk_bf16_f32 v73, v154, v155
    v_cvt_pk_bf16_f32 v76, v156, v157
    v_cvt_pk_bf16_f32 v77, v158, v159
    ds_write_b64 v25, v[72:73] offset:18432
    ds_write_b64 v26, v[76:77] offset:18432
L_wo_loop_s:
    buffer_load_dword v38, v35, s[4:7], s38 offen sc1
    s_min_u32 s90, s37, 62
    v_add_u32 v37, s90, v36
    s_and_b32 s90, s37, 1
    s_add_u32 s90, s90, 12
    s_sub_u32 s91, s37, 1
    s_mov_b32 m0, s90
    v_writelane_b32 v37, s91, m0
    s_max_u32 s93, s37, 5
    s_sub_u32 s93, s93, 5
    s_and_b32 s90, s93, 7
    s_mul_i32 s90, s90, 655360
    s_add_u32 s51, s90, 2097152
    s_mul_i32 s52, s93, 81920
    buffer_load_dwordx4 v[224:227], v33, s[4:7], s51 offen sc1
    buffer_load_dwordx4 v[228:231], v33, s[4:7], s51 offen offset:1024 sc1
    s_and_b32 s90, s37, 3
    s_mul_i32 s91, s90, 163840
    s_add_u32 s41, s91, 0
    s_mul_i32 s91, s90, 15360
    s_add_u32 s91, s91, 40960
    s_add_u32 s45, s38, s91
    s_mul_i32 s91, s90, 12288
    s_add_u32 s91, s91, 102400
    s_add_u32 s46, s38, s91
    s_mul_i32 s91, s90, 10240
    s_add_u32 s44, s38, s91
    s_mul_i32 s91, s90, 24576
    v_add_u32 v27, s91, v21
    s_xor_b32 s90, s90, 2
    s_mul_i32 s91, s90, 163840
    s_add_u32 s42, s91, 0
    s_add_u32 s92, s37, 1
    s_and_b32 s90, s92, 3
    s_mul_i32 s91, s90, 10240
    s_add_u32 s43, s38, s91
    s_mul_i32 s91, s90, 24576
    v_add_u32 v25, s91, v21
    v_add_u32 v26, s91, v22
    s_and_b32 s90, s92, 7
    s_mul_i32 s91, s90, 49152
    s_add_u32 s91, s91, 1179648
    s_add_u32 s47, s38, s91
    s_add_u32 s93, s37, 5
    s_and_b32 s90, s93, 3
    s_mul_i32 s90, s90, 24576
    v_add_u32 v28, s90, v23
    v_add_u32 v29, s90, v24
    s_and_b32 s90, s93, 1
    s_mul_i32 s90, s90, 12288
    v_add_u32 v31, s90, v30
    s_and_b32 s90, s93, 7
    s_mul_i32 s90, s90, 655360
    s_add_u32 s49, s90, 2097152
    s_add_u32 s50, s49, 32768
    s_add_u32 s93, s37, 6
    s_and_b32 s90, s93, 7
    s_mul_i32 s90, s90, 12288
    s_add_u32 s90, s90, 253952
    s_add_u32 s48, s38, s90
    s_and_b32 s90, s93, 1
    s_mul_i32 s90, s90, 12288
    s_add_u32 m0, s54, s90
    ds_read_b128 v[200:203], v28 offset:0
    ds_read_b128 v[176:179], v31 offset:0
    ds_read_b128 v[180:183], v31 offset:1024
    ds_read_b64 v[204:205], v29 offset:0
    ds_read_b128 v[184:187], v31 offset:2048
    ds_read_b128 v[208:211], v28 offset:1536
    ds_read_b128 v[188:191], v31 offset:3072
    ds_read_b128 v[192:195], v31 offset:4096
    ds_read_b64 v[212:213], v29 offset:1536
    ds_read_b128 v[196:199], v31 offset:5120
    s_waitcnt vmcnt(2)
    v_cmp_lt_i32 vcc, v38, v37
    s_cbranch_vccz L_fok_72
L_fw_71:
    buffer_load_dword v38, v35, s[4:7], s38 offen sc1
    s_sub_u32 s36, s36, 1
    s_cbranch_scc1 L_exit
    s_waitcnt vmcnt(0)
    v_cmp_lt_i32 vcc, v38, v37
    s_cbranch_vccnz L_fw_71
L_fok_72:
    buffer_load_dwordx4 v39, s[4:7], s48 offen offset:0 sc1 lds
    buffer_load_dwordx4 v39, s[4:7], s48 offen offset:1024 sc1 lds
    buffer_load_dwordx4 v39, s[4:7], s48 offen offset:2048 sc1 lds
    buffer_load_dwordx4 a[96:99], v42, s[4:7], s47 offen offset:0 sc1
    buffer_load_dwordx4 a[100:103], v42, s[4:7], s47 offen offset:1024 sc1
    buffer_load_dwordx4 a[104:107], v42, s[4:7], s47 offen offset:2048 sc1
    s_waitcnt lgkmcnt(5)
    v_mfma_f32_16x16x32_bf16 v[216:219], v[200:203], v[176:179], 0
    v_mfma_f32_16x16x32_bf16 v[220:223], v[200:203], v[180:183], 0
    v_mfma_f32_16x16x32_bf16 v[220:223], v[204:207], v[184:187], v[220:223]
    ds_read_b128 v[200:203], v28 offset:3072
    ds_read_b128 v[176:179], v31 offset:6144
    ds_read_b128 v[180:183], v31 offset:7168
    ds_read_b64 v[204:205], v29 offset:3072
    ds_read_b128 v[184:187], v31 offset:8192
    buffer_load_dwordx4 a[108:111], v42, s[4:7], s47 offen offset:3072 sc1
    s_add_u32 s47, s47, 4096
    buffer_load_dwordx4 a[112:115], v42, s[4:7], s47 offen offset:0 sc1
    buffer_load_dwordx4 a[116:119], v42, s[4:7], s47 offen offset:1024 sc1
    s_waitcnt lgkmcnt(5)
    v_mfma_f32_16x16x32_bf16 v[216:219], v[208:211], v[188:191], v[216:219]
    v_mfma_f32_16x16x32_bf16 v[220:223], v[208:211], v[192:195], v[220:223]
    v_mfma_f32_16x16x32_bf16 v[220:223], v[212:215], v[196:199], v[220:223]
    ds_read_b128 v[208:211], v28 offset:4608
    ds_read_b128 v[188:191], v31 offset:9216
    ds_read_b128 v[192:195], v31 offset:10240
    ds_read_b64 v[212:213], v29 offset:4608
    ds_read_b128 v[196:199], v31 offset:11264
    buffer_load_dwordx4 a[120:123], v42, s[4:7], s47 offen offset:2048 sc1
    buffer_load_dwordx4 a[124:127], v42, s[4:7], s47 offen offset:3072 sc1
    s_add_u32 s47, s47, 4096
    buffer_load_dwordx4 a[128:131], v42, s[4:7], s47 offen offset:0 sc1
    s_waitcnt lgkmcnt(5)
    v_mfma_f32_16x16x32_bf16 v[216:219], v[200:203], v[176:179], v[216:219]
    v_mfma_f32_16x16x32_bf16 v[220:223], v[200:203], v[180:183], v[220:223]
    v_mfma_f32_16x16x32_bf16 v[220:223], v[204:207], v[184:187], v[220:223]
    buffer_load_dwordx4 a[132:135], v42, s[4:7], s47 offen offset:1024 sc1
    buffer_load_dwordx4 a[136:139], v42, s[4:7], s47 offen offset:2048 sc1
    buffer_load_dwordx4 a[140:143], v42, s[4:7], s47 offen offset:3072 sc1
    s_waitcnt lgkmcnt(0)
    v_mfma_f32_16x16x32_bf16 v[216:219], v[208:211], v[188:191], v[216:219]
    v_mfma_f32_16x16x32_bf16 v[220:223], v[208:211], v[192:195], v[220:223]
    v_mfma_f32_16x16x32_bf16 v[220:223], v[212:215], v[196:199], v[220:223]
    s_cmp_lt_u32 s37, 5
    s_cbranch_scc1 L_g_67
    s_waitcnt vmcnt(15)
    v_pk_add_f32 v[224:225], v[224:225], v[228:229]
    v_pk_add_f32 v[226:227], v[226:227], v[230:231]
    s_nop 1
    v_permlane32_swap_b32 v224, v226
    v_permlane32_swap_b32 v225, v227
    v_pk_add_f32 v[224:225], v[224:225], v[226:227]
    s_nop 1
    v_permlane16_swap_b32 v224, v225
    v_add_f32 v224, v224, v225
    v_cvt_pk_bf16_f32 v224, v224, v224
    buffer_store_short v224, v34, s[28:31], s52 offen
L_g_67:
    v_mov_b32 v144, 0
    v_mov_b32 v145, 0
    v_mov_b32 v146, 0
    v_mov_b32 v147, 0
    v_mov_b32 v148, 0
    v_mov_b32 v149, 0
    v_mov_b32 v150, 0
    v_mov_b32 v151, 0
    v_mov_b32 v152, 0
    v_mov_b32 v153, 0
    v_mov_b32 v154, 0
    v_mov_b32 v155, 0
    v_mov_b32 v156, 0
    v_mov_b32 v157, 0
    v_mov_b32 v158, 0
    v_mov_b32 v159, 0
    v_mov_b32 v112, 0
    v_mov_b32 v113, 0
    v_mov_b32 v114, 0
    v_mov_b32 v115, 0
    v_mov_b32 v116, 0
    v_mov_b32 v117, 0
    v_mov_b32 v118, 0
    v_mov_b32 v119, 0
    v_mov_b32 v120, 0
    v_mov_b32 v121, 0
    v_mov_b32 v122, 0
    v_mov_b32 v123, 0
    v_mov_b32 v124, 0
    v_mov_b32 v125, 0
    v_mov_b32 v126, 0
    v_mov_b32 v127, 0
    v_mov_b32 v128, 0
    v_mov_b32 v129, 0
    v_mov_b32 v130, 0
    v_mov_b32 v131, 0
L_vm_73:
    buffer_load_dwordx4 v[132:135], v39, s[4:7], s46 offen offset:0 sc1
    buffer_load_dwordx4 v[136:139], v39, s[4:7], s46 offen offset:1024 sc1
    buffer_load_dwordx4 v[140:143], v39, s[4:7], s46 offen offset:2048 sc1
    s_sub_u32 s36, s36, 1
    s_cbranch_scc1 L_exit
    s_waitcnt vmcnt(0)
    v_max3_u32 v44, v132, v133, v134
    v_max3_u32 v45, v135, v136, v137
    v_max3_u32 v44, v44, v138, v139
    v_max3_u32 v45, v45, v140, v141
    v_max3_u32 v44, v44, v142, v143
    v_max_u32 v44, v44, v45
    v_cmp_eq_u32 vcc, -1, v44
    s_cbranch_vccnz L_vm_73
    v_smfmac_f32_16x16x64_bf16 v[144:147], v[132:135], a[0:7], v10
    v_smfmac_f32_16x16x64_bf16 v[144:147], v[136:139], a[8:15], v10
    v_smfmac_f32_16x16x64_bf16 v[144:147], v[140:143], a[16:23], v10
    v_smfmac_f32_16x16x64_bf16 v[148:151], v[132:135], a[24:31], v10
    v_smfmac_f32_16x16x64_bf16 v[148:151], v[136:139], a[32:39], v10
    v_smfmac_f32_16x16x64_bf16 v[148:151], v[140:143], a[40:47], v10
    v_smfmac_f32_16x16x64_bf16 v[152:155], v[132:135], a[48:55], v10
    v_smfmac_f32_16x16x64_bf16 v[152:155], v[136:139], a[56:63], v10
    v_smfmac_f32_16x16x64_bf16 v[152:155], v[140:143], a[64:71], v10
    v_smfmac_f32_16x16x64_bf16 v[156:159], v[132:135], a[72:79], v10
    v_smfmac_f32_16x16x64_bf16 v[156:159], v[136:139], a[80:87], v10
    v_smfmac_f32_16x16x64_bf16 v[156:159], v[140:143], a[88:95], v10
    buffer_load_dwordx4 v[96:99], v40, s[4:7], s45 offen offset:0 sc1
    buffer_load_dword v108, v41, s[4:7], s45 offen offset:0 sc1
    buffer_load_dwordx4 v[100:103], v40, s[4:7], s45 offen offset:1280 sc1
    buffer_load_dword v109, v41, s[4:7], s45 offen offset:1280 sc1
    buffer_load_dwordx4 v[104:107], v40, s[4:7], s45 offen offset:2560 sc1
    buffer_load_dword v110, v41, s[4:7], s45 offen offset:2560 sc1
    v_pk_add_f32 v[144:145], v[144:145], v[146:147]
    v_cvt_pk_bf16_f32 v50, v144, v145
    v_cvt_pk_bf16_f32 v54, v144, v145
    ds_write_b32 v27, v50 offset:8
    v_pk_add_f32 v[148:149], v[148:149], v[150:151]
    v_cvt_pk_bf16_f32 v58, v148, v149
    v_cvt_pk_bf16_f32 v62, v148, v149
    ds_write_b32 v27, v58 offset:6152
    v_pk_add_f32 v[152:153], v[152:153], v[154:155]
    v_cvt_pk_bf16_f32 v66, v152, v153
    v_cvt_pk_bf16_f32 v70, v152, v153
    ds_write_b32 v27, v66 offset:12296
    v_pk_add_f32 v[156:157], v[156:157], v[158:159]
    v_cvt_pk_bf16_f32 v74, v156, v157
    v_cvt_pk_bf16_f32 v78, v156, v157
    ds_write_b32 v27, v74 offset:18440
    s_cmp_eq_u32 s37, 63
    s_cbranch_scc1 L_wo_tail_s
L_sc_74:
    s_waitcnt vmcnt(0)
    v_pk_add_f32 v[232:233], v[96:97], v[100:101]
    v_pk_add_f32 v[234:235], v[98:99], v[102:103]
    v_add_f32 v46, v108, v109
    v_pk_add_f32 v[232:233], v[232:233], v[104:105]
    v_pk_add_f32 v[234:235], v[234:235], v[106:107]
    v_add_f32 v46, v46, v110
    v_max3_f32 v44, v232, v233, v234
    v_max3_f32 v44, v44, v235, v46
    v_pk_add_f32 v[242:243], v[232:233], v[234:235]
    v_add_f32 v242, v242, v46
    v_max_f32_dpp v45, v44, v44 quad_perm:[2,3,0,1] row_mask:0xf bank_mask:0xf
    v_max_f32_dpp v44, v44, v44 quad_perm:[2,3,0,1] row_mask:0xf bank_mask:0xf
    v_cmp_u_f32 vcc, v242, v243
    s_nop 0
    v_permlane16_swap_b32 v44, v45
    v_max_f32 v44, v44, v45
    v_mov_b32 v45, v44
    s_cbranch_vccnz L_sp_75
L_sg_76:
    s_nop 0
    v_permlane32_swap_b32 v44, v45
    v_max_f32 v44, v44, v45
    v_mul_f32 v242, 0xbdd53b95, v44
    v_pk_fma_f32 v[232:233], v[232:233], v[240:241], v[242:243] op_sel_hi:[1,1,0]
    v_pk_fma_f32 v[234:235], v[234:235], v[240:241], v[242:243] op_sel_hi:[1,1,0]
    v_fma_f32 v46, v46, v240, v242
    v_exp_f32 v232, v232
    v_exp_f32 v233, v233
    v_exp_f32 v234, v234
    v_exp_f32 v235, v235
    v_exp_f32 v46, v46
    v_cvt_pk_bf16_f32 v80, v232, v233
    v_cvt_pk_bf16_f32 v82, v234, v235
    v_cvt_pk_bf16_f32 v81, v46, 0
    v_cvt_pk_bf16_f32 v83, v46, 0
    s_nop 1
    v_smfmac_f32_16x16x64_bf16 v[112:115], v[80:83], v[84:91], v11
    v_smfmac_f32_16x16x64_bf16 v[116:119], v[80:83], v[48:55], v11
    v_smfmac_f32_16x16x64_bf16 v[120:123], v[80:83], v[56:63], v11
    v_smfmac_f32_16x16x64_bf16 v[124:127], v[80:83], v[64:71], v11
    v_smfmac_f32_16x16x64_bf16 v[128:131], v[80:83], v[72:79], v11
    s_nop 3
    v_pk_add_f32 v[112:113], v[112:113], v[114:115]
    v_rcp_f32 v112, v112
    v_rcp_f32 v113, v113
    v_pk_add_f32 v[116:117], v[116:117], v[118:119]
    v_pk_add_f32 v[120:121], v[120:121], v[122:123]
    v_pk_add_f32 v[124:125], v[124:125], v[126:127]
    v_pk_add_f32 v[128:129], v[128:129], v[130:131]
    v_pk_mul_f32 v[116:117], v[116:117], v[112:113]
    v_cvt_pk_bf16_f32 v232, v116, v117
    v_pk_mul_f32 v[120:121], v[120:121], v[112:113]
    v_cvt_pk_bf16_f32 v233, v120, v121
    ds_write2st64_b32 v19, v232, v233 offset0:0 offset1:1
    v_pk_mul_f32 v[124:125], v[124:125], v[112:113]
    v_cvt_pk_bf16_f32 v234, v124, v125
    v_pk_mul_f32 v[128:129], v[128:129], v[112:113]
    v_cvt_pk_bf16_f32 v235, v128, v129
    ds_write2st64_b32 v19, v234, v235 offset0:2 offset1:3
    s_waitcnt lgkmcnt(0)
    s_barrier
    ds_read_b128 v[236:239], v20
    s_waitcnt lgkmcnt(0)
    v_mfma_f32_16x16x32_bf16 v[168:171], v[92:95], v[236:239], 0
    s_nop 7
    v_cvt_pk_bf16_f32 v46, v168, v169
    buffer_store_dword v46, v14, s[4:7], s41 offen sc1
    buffer_store_dword v46, v15, s[4:7], s41 offen sc1
    buffer_store_dword v43, v14, s[4:7], s42 offen sc1
    buffer_store_dword v43, v15, s[4:7], s42 offen sc1
    buffer_store_dwordx4 v[216:219], v32, s[4:7], s49 offen sc1
    buffer_store_dwordx4 v[220:223], v32, s[4:7], s50 offen sc1
    v_mfma_f32_16x16x32_bf16 v[144:147], a[96:99], a[0:3], 0
    v_mfma_f32_16x16x32_bf16 v[148:151], a[120:123], a[0:3], 0
    v_mfma_f32_16x16x32_bf16 v[144:147], a[100:103], a[4:7], v[144:147]
    v_mfma_f32_16x16x32_bf16 v[148:151], a[124:127], a[4:7], v[148:151]
    v_mfma_f32_16x16x32_bf16 v[144:147], a[104:107], a[8:11], v[144:147]
    v_mfma_f32_16x16x32_bf16 v[148:151], a[128:131], a[8:11], v[148:151]
    v_mfma_f32_16x16x32_bf16 v[144:147], a[108:111], a[12:15], v[144:147]
    v_mfma_f32_16x16x32_bf16 v[148:151], a[132:135], a[12:15], v[148:151]
    v_mfma_f32_16x16x32_bf16 v[144:147], a[112:115], a[16:19], v[144:147]
    v_mfma_f32_16x16x32_bf16 v[148:151], a[136:139], a[16:19], v[148:151]
    v_mfma_f32_16x16x32_bf16 v[144:147], a[116:119], a[20:23], v[144:147]
    v_mfma_f32_16x16x32_bf16 v[148:151], a[140:143], a[20:23], v[148:151]
    v_mfma_f32_16x16x32_bf16 v[152:155], a[96:99], a[24:27], 0
    v_mfma_f32_16x16x32_bf16 v[156:159], a[120:123], a[24:27], 0
    v_mfma_f32_16x16x32_bf16 v[152:155], a[100:103], a[28:31], v[152:155]
    v_mfma_f32_16x16x32_bf16 v[156:159], a[124:127], a[28:31], v[156:159]
    v_mfma_f32_16x16x32_bf16 v[152:155], a[104:107], a[32:35], v[152:155]
    v_mfma_f32_16x16x32_bf16 v[156:159], a[128:131], a[32:35], v[156:159]
    v_mfma_f32_16x16x32_bf16 v[152:155], a[108:111], a[36:39], v[152:155]
    v_mfma_f32_16x16x32_bf16 v[156:159], a[132:135], a[36:39], v[156:159]
    v_cvt_pk_bf16_f32 v48, v144, v145
    v_cvt_pk_bf16_f32 v49, v146, v147
    v_mfma_f32_16x16x32_bf16 v[152:155], a[112:115], a[40:43], v[152:155]
    v_cvt_pk_bf16_f32 v52, v148, v149
    v_cvt_pk_bf16_f32 v53, v150, v151
    v_mfma_f32_16x16x32_bf16 v[156:159], a[136:139], a[40:43], v[156:159]
    ds_write_b64 v25, v[48:49] offset:0
    ds_write_b64 v26, v[52:53] offset:0
    v_mfma_f32_16x16x32_bf16 v[152:155], a[116:119], a[44:47], v[152:155]
    v_mfma_f32_16x16x32_bf16 v[156:159], a[140:143], a[44:47], v[156:159]
    v_mfma_f32_16x16x32_bf16 v[144:147], a[96:99], a[48:51], 0
    v_mfma_f32_16x16x32_bf16 v[148:151], a[120:123], a[48:51], 0
    v_mfma_f32_16x16x32_bf16 v[144:147], a[100:103], a[52:55], v[144:147]
    v_mfma_f32_16x16x32_bf16 v[148:151], a[124:127], a[52:55], v[148:151]
    v_mfma_f32_16x16x32_bf16 v[144:147], a[104:107], a[56:59], v[144:147]
    v_mfma_f32_16x16x32_bf16 v[148:151], a[128:131], a[56:59], v[148:151]
    buffer_load_dwordx4 v[160:163], v16, s[4:7], s41 offen sc1
    buffer_load_dwordx4 v[164:167], v17, s[4:7], s41 offen sc1
    v_mfma_f32_16x16x32_bf16 v[144:147], a[108:111], a[60:63], v[144:147]
    v_mfma_f32_16x16x32_bf16 v[148:151], a[132:135], a[60:63], v[148:151]
    v_cvt_pk_bf16_f32 v56, v152, v153
    v_cvt_pk_bf16_f32 v57, v154, v155
    v_mfma_f32_16x16x32_bf16 v[144:147], a[112:115], a[64:67], v[144:147]
    v_cvt_pk_bf16_f32 v60, v156, v157
    v_cvt_pk_bf16_f32 v61, v158, v159
    v_mfma_f32_16x16x32_bf16 v[148:151], a[136:139], a[64:67], v[148:151]
    ds_write_b64 v25, v[56:57] offset:6144
    ds_write_b64 v26, v[60:61] offset:6144
    v_mfma_f32_16x16x32_bf16 v[144:147], a[116:119], a[68:71], v[144:147]
    v_mfma_f32_16x16x32_bf16 v[148:151], a[140:143], a[68:71], v[148:151]
    v_mfma_f32_16x16x32_bf16 v[152:155], a[96:99], a[72:75], 0
    v_mfma_f32_16x16x32_bf16 v[156:159], a[120:123], a[72:75], 0
    v_mfma_f32_16x16x32_bf16 v[152:155], a[100:103], a[76:79], v[152:155]
    v_mfma_f32_16x16x32_bf16 v[156:159], a[124:127], a[76:79], v[156:159]
    v_mfma_f32_16x16x32_bf16 v[152:155], a[104:107], a[80:83], v[152:155]
    v_mfma_f32_16x16x32_bf16 v[156:159], a[128:131], a[80:83], v[156:159]
    v_mfma_f32_16x16x32_bf16 v[152:155], a[108:111], a[84:87], v[152:155]
    v_mfma_f32_16x16x32_bf16 v[156:159], a[132:135], a[84:87], v[156:159]
    v_cvt_pk_bf16_f32 v64, v144, v145
    v_cvt_pk_bf16_f32 v65, v146, v147
    v_mfma_f32_16x16x32_bf16 v[152:155], a[112:115], a[88:91], v[152:155]
    v_cvt_pk_bf16_f32 v68, v148, v149
    v_cvt_pk_bf16_f32 v69, v150, v151
    v_mfma_f32_16x16x32_bf16 v[156:159], a[136:139], a[88:91], v[156:159]
    ds_write_b64 v25, v[64:65] offset:12288
    ds_write_b64 v26, v[68:69] offset:12288
    v_mfma_f32_16x16x32_bf16 v[152:155], a[116:119], a[92:95], v[152:155]
    v_mfma_f32_16x16x32_bf16 v[156:159], a[140:143], a[92:95], v[156:159]
    s_nop 6
    v_cvt_pk_bf16_f32 v72, v152, v153
    v_cvt_pk_bf16_f32 v73, v154, v155
    v_cvt_pk_bf16_f32 v76, v156, v157
    v_cvt_pk_bf16_f32 v77, v158, v159
    ds_write_b64 v25, v[72:73] offset:18432
    ds_write_b64 v26, v[76:77] offset:18432
L_pc_78:
    s_waitcnt vmcnt(0)
    v_mfma_f32_16x16x32_bf16 v[172:175], v[92:95], v[160:163], v[168:171]
    v_mfma_f32_16x16x32_bf16 v[172:175], v[92:95], v[164:167], v[172:175]
    v_max3_u32 v44, v160, v161, v162
    v_max3_u32 v45, v163, v164, v165
    v_max3_u32 v44, v44, v166, v167
    v_max_u32 v44, v44, v45
    v_cmp_eq_u32 vcc, -1, v44
    s_cbranch_vccnz L_pp_77
    s_nop 1
    v_cvt_pk_bf16_f32 v46, v172, v173
    buffer_store_dword v46, v18, s[4:7], s43 offen sc1
    buffer_store_dword v43, v18, s[4:7], s44 offen sc1
    s_add_u32 s37, s37, 1
    s_branch L_wo_loop_s
L_wo_tail_s:
    buffer_store_dwordx4 v[216:219], v32, s[4:7], s49 offen sc1
    buffer_store_dwordx4 v[220:223], v32, s[4:7], s50 offen sc1
    s_waitcnt vmcnt(0) lgkmcnt(0)
    s_barrier
    v_mov_b32 v37, -1000
    s_mov_b32 s91, 63
    v_writelane_b32 v37, s91, 12
    buffer_load_dword v38, v35, s[4:7], s38 offen sc1
    s_mov_b32 s93, 61
    s_and_b32 s90, s93, 3
    s_mul_i32 s90, s90, 24576
    v_add_u32 v28, s90, v23
    v_add_u32 v29, s90, v24
    s_and_b32 s90, s93, 1
    s_mul_i32 s90, s90, 12288
    v_add_u32 v31, s90, v30
    s_and_b32 s90, s93, 7
    s_mul_i32 s90, s90, 655360
    s_add_u32 s49, s90, 2097152
    s_add_u32 s50, s49, 32768
    ds_read_b128 v[200:203], v28 offset:0
    ds_read_b128 v[176:179], v31 offset:0
    ds_read_b128 v[180:183], v31 offset:1024
    ds_read_b64 v[204:205], v29 offset:0
    ds_read_b128 v[184:187], v31 offset:2048
    ds_read_b128 v[208:211], v28 offset:1536
    ds_read_b128 v[188:191], v31 offset:3072
    ds_read_b128 v[192:195], v31 offset:4096
    ds_read_b64 v[212:213], v29 offset:1536
    ds_read_b128 v[196:199], v31 offset:5120
    s_waitcnt lgkmcnt(5)
    v_mfma_f32_16x16x32_bf16 v[216:219], v[200:203], v[176:179], 0
    v_mfma_f32_16x16x32_bf16 v[220:223], v[200:203], v[180:183], 0
    v_mfma_f32_16x16x32_bf16 v[220:223], v[204:207], v[184:187], v[220:223]
    ds_read_b128 v[200:203], v28 offset:3072
    ds_read_b128 v[176:179], v31 offset:6144
    ds_read_b128 v[180:183], v31 offset:7168
    ds_read_b64 v[204:205], v29 offset:3072
    ds_read_b128 v[184:187], v31 offset:8192
    s_waitcnt lgkmcnt(5)
    v_mfma_f32_16x16x32_bf16 v[216:219], v[208:211], v[188:191], v[216:219]
    v_mfma_f32_16x16x32_bf16 v[220:223], v[208:211], v[192:195], v[220:223]
    v_mfma_f32_16x16x32_bf16 v[220:223], v[212:215], v[196:199], v[220:223]
    ds_read_b128 v[208:211], v28 offset:4608
    ds_read_b128 v[188:191], v31 offset:9216
    ds_read_b128 v[192:195], v31 offset:10240
    ds_read_b64 v[212:213], v29 offset:4608
    ds_read_b128 v[196:199], v31 offset:11264
    s_waitcnt lgkmcnt(5)
    v_mfma_f32_16x16x32_bf16 v[216:219], v[200:203], v[176:179], v[216:219]
    v_mfma_f32_16x16x32_bf16 v[220:223], v[200:203], v[180:183], v[220:223]
    v_mfma_f32_16x16x32_bf16 v[220:223], v[204:207], v[184:187], v[220:223]
    s_waitcnt lgkmcnt(0)
    v_mfma_f32_16x16x32_bf16 v[216:219], v[208:211], v[188:191], v[216:219]
    v_mfma_f32_16x16x32_bf16 v[220:223], v[208:211], v[192:195], v[220:223]
    v_mfma_f32_16x16x32_bf16 v[220:223], v[212:215], v[196:199], v[220:223]
    s_nop 5
    buffer_store_dwordx4 v[216:219], v32, s[4:7], s49 offen sc1
    s_nop 0
    buffer_store_dwordx4 v[220:223], v32, s[4:7], s50 offen sc1
    s_mov_b32 s93, 62
    s_and_b32 s90, s93, 7
    s_mul_i32 s90, s90, 12288
    s_add_u32 s90, s90, 253952
    s_add_u32 s48, s38, s90
    s_and_b32 s90, s93, 1
    s_mul_i32 s90, s90, 12288
    s_add_u32 m0, s54, s90
    s_waitcnt vmcnt(2)
    v_cmp_lt_i32 vcc, v38, v37
    s_cbranch_vccz L_fok_82
L_fw_81:
    buffer_load_dword v38, v35, s[4:7], s38 offen sc1
    s_sub_u32 s36, s36, 1
    s_cbranch_scc1 L_exit
    s_waitcnt vmcnt(0)
    v_cmp_lt_i32 vcc, v38, v37
    s_cbranch_vccnz L_fw_81
L_fok_82:
    buffer_load_dwordx4 v39, s[4:7], s48 offen offset:0 sc1 lds
    buffer_load_dwordx4 v39, s[4:7], s48 offen offset:1024 sc1 lds
    buffer_load_dwordx4 v39, s[4:7], s48 offen offset:2048 sc1 lds
    s_waitcnt vmcnt(0) lgkmcnt(0)
    s_barrier
    v_mov_b32 v37, -1000
    s_mov_b32 s91, 64
    v_writelane_b32 v37, s91, 13
    buffer_load_dword v38, v35, s[4:7], s38 offen sc1
    s_mov_b32 s93, 62
    s_and_b32 s90, s93, 3
    s_mul_i32 s90, s90, 24576
    v_add_u32 v28, s90, v23
    v_add_u32 v29, s90, v24
    s_and_b32 s90, s93, 1
    s_mul_i32 s90, s90, 12288
    v_add_u32 v31, s90, v30
    s_and_b32 s90, s93, 7
    s_mul_i32 s90, s90, 655360
    s_add_u32 s49, s90, 2097152
    s_add_u32 s50, s49, 32768
    ds_read_b128 v[200:203], v28 offset:0
    ds_read_b128 v[176:179], v31 offset:0
    ds_read_b128 v[180:183], v31 offset:1024
    ds_read_b64 v[204:205], v29 offset:0
    ds_read_b128 v[184:187], v31 offset:2048
    ds_read_b128 v[208:211], v28 offset:1536
    ds_read_b128 v[188:191], v31 offset:3072
    ds_read_b128 v[192:195], v31 offset:4096
    ds_read_b64 v[212:213], v29 offset:1536
    ds_read_b128 v[196:199], v31 offset:5120
    s_waitcnt lgkmcnt(5)
    v_mfma_f32_16x16x32_bf16 v[216:219], v[200:203], v[176:179], 0
    v_mfma_f32_16x16x32_bf16 v[220:223], v[200:203], v[180:183], 0
    v_mfma_f32_16x16x32_bf16 v[220:223], v[204:207], v[184:187], v[220:223]
    ds_read_b128 v[200:203], v28 offset:3072
    ds_read_b128 v[176:179], v31 offset:6144
    ds_read_b128 v[180:183], v31 offset:7168
    ds_read_b64 v[204:205], v29 offset:3072
    ds_read_b128 v[184:187], v31 offset:8192
    s_waitcnt lgkmcnt(5)
    v_mfma_f32_16x16x32_bf16 v[216:219], v[208:211], v[188:191], v[216:219]
    v_mfma_f32_16x16x32_bf16 v[220:223], v[208:211], v[192:195], v[220:223]
    v_mfma_f32_16x16x32_bf16 v[220:223], v[212:215], v[196:199], v[220:223]
    ds_read_b128 v[208:211], v28 offset:4608
    ds_read_b128 v[188:191], v31 offset:9216
    ds_read_b128 v[192:195], v31 offset:10240
    ds_read_b64 v[212:213], v29 offset:4608
    ds_read_b128 v[196:199], v31 offset:11264
    s_waitcnt lgkmcnt(5)
    v_mfma_f32_16x16x32_bf16 v[216:219], v[200:203], v[176:179], v[216:219]
    v_mfma_f32_16x16x32_bf16 v[220:223], v[200:203], v[180:183], v[220:223]
    v_mfma_f32_16x16x32_bf16 v[220:223], v[204:207], v[184:187], v[220:223]
    s_waitcnt lgkmcnt(0)
    v_mfma_f32_16x16x32_bf16 v[216:219], v[208:211], v[188:191], v[216:219]
    v_mfma_f32_16x16x32_bf16 v[220:223], v[208:211], v[192:195], v[220:223]
    v_mfma_f32_16x16x32_bf16 v[220:223], v[212:215], v[196:199], v[220:223]
    s_nop 5
    buffer_store_dwordx4 v[216:219], v32, s[4:7], s49 offen sc1
    s_nop 0
    buffer_store_dwordx4 v[220:223], v32, s[4:7], s50 offen sc1
    s_mov_b32 s93, 63
    s_and_b32 s90, s93, 7
    s_mul_i32 s90, s90, 12288
    s_add_u32 s90, s90, 253952
    s_add_u32 s48, s38, s90
    s_and_b32 s90, s93, 1
    s_mul_i32 s90, s90, 12288
    s_add_u32 m0, s54, s90
    s_waitcnt vmcnt(2)
    v_cmp_lt_i32 vcc, v38, v37
    s_cbranch_vccz L_fok_84
L_fw_83:
    buffer_load_dword v38, v35, s[4:7], s38 offen sc1
    s_sub_u32 s36, s36, 1
    s_cbranch_scc1 L_exit
    s_waitcnt vmcnt(0)
    v_cmp_lt_i32 vcc, v38, v37
    s_cbranch_vccnz L_fw_83
L_fok_84:
    buffer_load_dwordx4 v39, s[4:7], s48 offen offset:0 sc1 lds
    buffer_load_dwordx4 v39, s[4:7], s48 offen offset:1024 sc1 lds
    buffer_load_dwordx4 v39, s[4:7], s48 offen offset:2048 sc1 lds
    s_waitcnt vmcnt(0) lgkmcnt(0)
    s_barrier
    s_mov_b32 s93, 63
    s_and_b32 s90, s93, 3
    s_mul_i32 s90, s90, 24576
    v_add_u32 v28, s90, v23
    v_add_u32 v29, s90, v24
    s_and_b32 s90, s93, 1
    s_mul_i32 s90, s90, 12288
    v_add_u32 v31, s90, v30
    s_and_b32 s90, s93, 7
    s_mul_i32 s90, s90, 655360
    s_add_u32 s49, s90, 2097152
    s_add_u32 s50, s49, 32768
    ds_read_b128 v[200:203], v28 offset:0
    ds_read_b128 v[176:179], v31 offset:0
    ds_read_b128 v[180:183], v31 offset:1024
    ds_read_b64 v[204:205], v29 offset:0
    ds_read_b128 v[184:187], v31 offset:2048
    ds_read_b128 v[208:211], v28 offset:1536
    ds_read_b128 v[188:191], v31 offset:3072
    ds_read_b128 v[192:195], v31 offset:4096
    ds_read_b64 v[212:213], v29 offset:1536
    ds_read_b128 v[196:199], v31 offset:5120
    s_waitcnt lgkmcnt(5)
    v_mfma_f32_16x16x32_bf16 v[216:219], v[200:203], v[176:179], 0
    v_mfma_f32_16x16x32_bf16 v[220:223], v[200:203], v[180:183], 0
    v_mfma_f32_16x16x32_bf16 v[220:223], v[204:207], v[184:187], v[220:223]
    ds_read_b128 v[200:203], v28 offset:3072
    ds_read_b128 v[176:179], v31 offset:6144
    ds_read_b128 v[180:183], v31 offset:7168
    ds_read_b64 v[204:205], v29 offset:3072
    ds_read_b128 v[184:187], v31 offset:8192
    s_waitcnt lgkmcnt(5)
    v_mfma_f32_16x16x32_bf16 v[216:219], v[208:211], v[188:191], v[216:219]
    v_mfma_f32_16x16x32_bf16 v[220:223], v[208:211], v[192:195], v[220:223]
    v_mfma_f32_16x16x32_bf16 v[220:223], v[212:215], v[196:199], v[220:223]
    ds_read_b128 v[208:211], v28 offset:4608
    ds_read_b128 v[188:191], v31 offset:9216
    ds_read_b128 v[192:195], v31 offset:10240
    ds_read_b64 v[212:213], v29 offset:4608
    ds_read_b128 v[196:199], v31 offset:11264
    s_waitcnt lgkmcnt(5)
    v_mfma_f32_16x16x32_bf16 v[216:219], v[200:203], v[176:179], v[216:219]
    v_mfma_f32_16x16x32_bf16 v[220:223], v[200:203], v[180:183], v[220:223]
    v_mfma_f32_16x16x32_bf16 v[220:223], v[204:207], v[184:187], v[220:223]
    s_waitcnt lgkmcnt(0)
    v_mfma_f32_16x16x32_bf16 v[216:219], v[208:211], v[188:191], v[216:219]
    v_mfma_f32_16x16x32_bf16 v[220:223], v[208:211], v[192:195], v[220:223]
    v_mfma_f32_16x16x32_bf16 v[220:223], v[212:215], v[196:199], v[220:223]
    s_nop 5
    buffer_store_dwordx4 v[216:219], v32, s[4:7], s49 offen sc1
    s_nop 0
    buffer_store_dwordx4 v[220:223], v32, s[4:7], s50 offen sc1
    s_waitcnt vmcnt(0)
    s_barrier
    v_mov_b32 v46, 0
    buffer_store_dword v46, v14, s[4:7], s41 offen sc1
    buffer_store_dword v46, v15, s[4:7], s41 offen sc1
    s_waitcnt vmcnt(0)
    buffer_load_dwordx4 v[160:163], v16, s[4:7], s41 offen sc1
    buffer_load_dwordx4 v[164:167], v17, s[4:7], s41 offen sc1
L_pc_86:
    s_waitcnt vmcnt(0)
    v_mfma_f32_16x16x32_bf16 v[172:175], v[92:95], v[160:163], v[168:171]
    v_mfma_f32_16x16x32_bf16 v[172:175], v[92:95], v[164:167], v[172:175]
    v_max3_u32 v44, v160, v161, v162
    v_max3_u32 v45, v163, v164, v165
    v_max3_u32 v44, v44, v166, v167
    v_max_u32 v44, v44, v45
    v_cmp_eq_u32 vcc, -1, v44
    s_cbranch_vccnz L_pp_85
    s_mov_b32 s93, 59
    s_and_b32 s90, s93, 7
    s_mul_i32 s90, s90, 655360
    s_add_u32 s51, s90, 2097152
    s_mul_i32 s52, s93, 81920
    buffer_load_dwordx4 v[224:227], v33, s[4:7], s51 offen sc1
    buffer_load_dwordx4 v[228:231], v33, s[4:7], s51 offen offset:1024 sc1
    s_waitcnt vmcnt(0)
    v_pk_add_f32 v[224:225], v[224:225], v[228:229]
    v_pk_add_f32 v[226:227], v[226:227], v[230:231]
    s_nop 1
    v_permlane32_swap_b32 v224, v226
    v_permlane32_swap_b32 v225, v227
    v_pk_add_f32 v[224:225], v[224:225], v[226:227]
    s_nop 1
    v_permlane16_swap_b32 v224, v225
    v_add_f32 v224, v224, v225
    v_cvt_pk_bf16_f32 v224, v224, v224
    buffer_store_short v224, v34, s[28:31], s52 offen
    s_mov_b32 s93, 60
    s_and_b32 s90, s93, 7
    s_mul_i32 s90, s90, 655360
    s_add_u32 s51, s90, 2097152
    s_mul_i32 s52, s93, 81920
    buffer_load_dwordx4 v[224:227], v33, s[4:7], s51 offen sc1
    buffer_load_dwordx4 v[228:231], v33, s[4:7], s51 offen offset:1024 sc1
    s_waitcnt vmcnt(0)
    v_pk_add_f32 v[224:225], v[224:225], v[228:229]
    v_pk_add_f32 v[226:227], v[226:227], v[230:231]
    s_nop 1
    v_permlane32_swap_b32 v224, v226
    v_permlane32_swap_b32 v225, v227
    v_pk_add_f32 v[224:225], v[224:225], v[226:227]
    s_nop 1
    v_permlane16_swap_b32 v224, v225
    v_add_f32 v224, v224, v225
    v_cvt_pk_bf16_f32 v224, v224, v224
    buffer_store_short v224, v34, s[28:31], s52 offen
    s_mov_b32 s93, 61
    s_and_b32 s90, s93, 7
    s_mul_i32 s90, s90, 655360
    s_add_u32 s51, s90, 2097152
    s_mul_i32 s52, s93, 81920
    buffer_load_dwordx4 v[224:227], v33, s[4:7], s51 offen sc1
    buffer_load_dwordx4 v[228:231], v33, s[4:7], s51 offen offset:1024 sc1
    s_waitcnt vmcnt(0)
    v_pk_add_f32 v[224:225], v[224:225], v[228:229]
    v_pk_add_f32 v[226:227], v[226:227], v[230:231]
    s_nop 1
    v_permlane32_swap_b32 v224, v226
    v_permlane32_swap_b32 v225, v227
    v_pk_add_f32 v[224:225], v[224:225], v[226:227]
    s_nop 1
    v_permlane16_swap_b32 v224, v225
    v_add_f32 v224, v224, v225
    v_cvt_pk_bf16_f32 v224, v224, v224
    buffer_store_short v224, v34, s[28:31], s52 offen
    s_mov_b32 s93, 62
    s_and_b32 s90, s93, 7
    s_mul_i32 s90, s90, 655360
    s_add_u32 s51, s90, 2097152
    s_mul_i32 s52, s93, 81920
    buffer_load_dwordx4 v[224:227], v33, s[4:7], s51 offen sc1
    buffer_load_dwordx4 v[228:231], v33, s[4:7], s51 offen offset:1024 sc1
    s_waitcnt vmcnt(0)
    v_pk_add_f32 v[224:225], v[224:225], v[228:229]
    v_pk_add_f32 v[226:227], v[226:227], v[230:231]
    s_nop 1
    v_permlane32_swap_b32 v224, v226
    v_permlane32_swap_b32 v225, v227
    v_pk_add_f32 v[224:225], v[224:225], v[226:227]
    s_nop 1
    v_permlane16_swap_b32 v224, v225
    v_add_f32 v224, v224, v225
    v_cvt_pk_bf16_f32 v224, v224, v224
    buffer_store_short v224, v34, s[28:31], s52 offen
    s_mov_b32 s93, 63
    s_and_b32 s90, s93, 7
    s_mul_i32 s90, s90, 655360
    s_add_u32 s51, s90, 2097152
    s_mul_i32 s52, s93, 81920
    buffer_load_dwordx4 v[224:227], v33, s[4:7], s51 offen sc1
    buffer_load_dwordx4 v[228:231], v33, s[4:7], s51 offen offset:1024 sc1
    s_waitcnt vmcnt(0)
    v_pk_add_f32 v[224:225], v[224:225], v[228:229]
    v_pk_add_f32 v[226:227], v[226:227], v[230:231]
    s_nop 1
    v_permlane32_swap_b32 v224, v226
    v_permlane32_swap_b32 v225, v227
    v_pk_add_f32 v[224:225], v[224:225], v[226:227]
    s_nop 1
    v_permlane16_swap_b32 v224, v225
    v_add_f32 v224, v224, v225
    v_cvt_pk_bf16_f32 v224, v224, v224
    buffer_store_short v224, v34, s[28:31], s52 offen
    s_endpgm
L_sp_75:
    v_max3_u32 v4, v108, v109, v110
    v_max3_u32 v4, v4, v96, v97
    v_max3_u32 v4, v4, v98, v99
    v_max3_u32 v4, v4, v100, v101
    v_max3_u32 v4, v4, v102, v103
    v_max3_u32 v4, v4, v104, v105
    v_max3_u32 v4, v4, v106, v107
    v_cmp_eq_u32 vcc, -1, v4
    s_cbranch_vccz L_sg_76
    buffer_load_dwordx4 v[96:99], v40, s[4:7], s45 offen offset:0 sc1
    buffer_load_dword v108, v41, s[4:7], s45 offen offset:0 sc1
    buffer_load_dwordx4 v[100:103], v40, s[4:7], s45 offen offset:1280 sc1
    buffer_load_dword v109, v41, s[4:7], s45 offen offset:1280 sc1
    buffer_load_dwordx4 v[104:107], v40, s[4:7], s45 offen offset:2560 sc1
    buffer_load_dword v110, v41, s[4:7], s45 offen offset:2560 sc1
    s_sub_u32 s36, s36, 1
    s_cbranch_scc1 L_exit
    s_branch L_sc_74
L_pp_77:
    buffer_load_dwordx4 v[160:163], v16, s[4:7], s41 offen sc1
    buffer_load_dwordx4 v[164:167], v17, s[4:7], s41 offen sc1
    s_sub_u32 s36, s36, 1
    s_cbranch_scc1 L_exit
    s_branch L_pc_78
L_pp_85:
    buffer_load_dwordx4 v[160:163], v16, s[4:7], s41 offen sc1
    buffer_load_dwordx4 v[164:167], v17, s[4:7], s41 offen sc1
    s_sub_u32 s36, s36, 1
    s_cbranch_scc1 L_exit
    s_branch L_pc_86
L_px_s:
    s_sub_u32 s40, s35, 22
    v_and_b32 v1, 15, v0
    v_lshrrev_b32 v2, 4, v0
    s_mul_i32 s90, s32, 12288
    v_lshl_add_u32 v10, v0, 4, s90
    s_mul_i32 s90, s32, 3072
    v_lshl_add_u32 v12, v0, 4, s90
    v_lshrrev_b32 v3, 2, v1
    v_lshlrev_b32 v3, 1, v3
    v_and_b32 v4, 1, v1
    v_or_b32 v3, v3, v4
    v_lshl_add_u32 v3, v2, 3, v3
    v_lshl_add_u32 v11, v3, 4, s90
    s_lshl_b32 s90, s32, 7
    v_min_u32 v3, 11, v0
    v_lshl_add_u32 v3, v3, 2, s90
    v_add_u32 v13, 151552, v3
    v_min_u32 v3, 2, v0
    v_lshl_add_u32 v3, v3, 2, s90
    v_add_u32 v14, 152064, v3
    s_lshl_b32 s91, s40, 2
    s_add_u32 s90, s90, s91
    s_add_u32 s90, s90, 152576
    v_mov_b32 v15, s90
    v_cmp_eq_u32 vcc, 0, v0
    v_mov_b32 v9, 2146435072
    s_nop 0
    v_cndmask_b32 v15, v9, v15, vcc
    v_mov_b32 v22, 0
    buffer_store_dword v22, v15, s[4:7], s38 offen sc1
    v_mov_b32 v21, 0xd04e79ff
    s_mov_b32 s44, 0x3dd53b95
    v_lshl_add_u32 v3, v2, 2, 0
    v_cmp_le_u32 s[48:49], v3, v1
    v_lshl_add_u32 v3, v2, 2, 1
    v_cmp_le_u32 s[50:51], v3, v1
    v_lshl_add_u32 v3, v2, 2, 2
    v_cmp_le_u32 s[52:53], v3, v1
    v_lshl_add_u32 v3, v2, 2, 3
    v_cmp_le_u32 s[54:55], v3, v1
    v_mov_b32 v167, 0
    v_mov_b32 v171, 0
    v_mov_b32 v174, 0
    v_mov_b32 v175, 0
    s_waitcnt vmcnt(0)
    s_barrier
    s_cmp_lg_u32 s32, 0
    s_cbranch_scc1 L_arr_89
    v_mov_b32 v1, 68
    v_mov_b32 v2, 1
    s_mov_b64 exec, 1
    buffer_atomic_add v2, v1, s[8:11], 0 offen sc1
    s_mov_b64 exec, -1
L_arr_89:
    v_lshlrev_b32 v1, 2, v0
L_gw_90:
    buffer_load_dword v2, v1, s[8:11], 0 offen sc1
    s_sub_u32 s36, s36, 1
    s_cbranch_scc1 L_exit
    s_waitcnt vmcnt(0)
    v_readlane_b32 s90, v2, 17
    s_nop 0
    s_cmp_lg_u32 s90, 256
    s_cbranch_scc1 L_gw_90
    s_mov_b32 s37, s40
L_px_loop_s:
    s_and_b32 s90, s37, 7
    s_mul_i32 s91, s90, 49152
    s_add_u32 s41, s38, s91
    s_mul_i32 s91, s90, 12288
    s_add_u32 s91, s91, s38
    s_add_u32 s42, s91, 155648
    s_add_u32 s43, s91, 253952
    s_add_u32 s90, s37, 1
    v_mov_b32 v17, s90
L_pf_91:
    buffer_load_dword v16, v13, s[4:7], s38 offen sc1
    s_sub_u32 s36, s36, 1
    s_cbranch_scc1 L_exit
    s_waitcnt vmcnt(0)
    v_cmp_ge_u32 vcc, s37, v16
    s_cbranch_vccnz L_pf_91
    s_add_u32 s90, s41, 393216
    buffer_load_dwordx4 v[24:27], v10, s[4:7], s90 offen offset:0 sc1
    buffer_load_dwordx4 v[28:31], v10, s[4:7], s90 offen offset:1024 sc1
    buffer_load_dwordx4 v[32:35], v10, s[4:7], s90 offen offset:2048 sc1
    buffer_load_dwordx4 v[36:39], v10, s[4:7], s90 offen offset:3072 sc1
    s_add_u32 s90, s41, 397312
    buffer_load_dwordx4 v[40:43], v10, s[4:7], s90 offen offset:0 sc1
    buffer_load_dwordx4 v[44:47], v10, s[4:7], s90 offen offset:1024 sc1
    buffer_load_dwordx4 v[48:51], v10, s[4:7], s90 offen offset:2048 sc1
    buffer_load_dwordx4 v[52:55], v10, s[4:7], s90 offen offset:3072 sc1
    s_add_u32 s90, s41, 401408
    buffer_load_dwordx4 v[56:59], v10, s[4:7], s90 offen offset:0 sc1
    buffer_load_dwordx4 v[60:63], v10, s[4:7], s90 offen offset:1024 sc1
    buffer_load_dwordx4 v[64:67], v10, s[4:7], s90 offen offset:2048 sc1
    buffer_load_dwordx4 v[68:71], v10, s[4:7], s90 offen offset:3072 sc1
    s_add_u32 s90, s41, 786432
    buffer_load_dwordx4 v[72:75], v10, s[4:7], s90 offen offset:0 sc1
    buffer_load_dwordx4 v[76:79], v10, s[4:7], s90 offen offset:1024 sc1
    buffer_load_dwordx4 v[80:83], v10, s[4:7], s90 offen offset:2048 sc1
    buffer_load_dwordx4 v[84:87], v10, s[4:7], s90 offen offset:3072 sc1
    s_add_u32 s90, s41, 790528
    buffer_load_dwordx4 v[88:91], v10, s[4:7], s90 offen offset:0 sc1
    buffer_load_dwordx4 v[92:95], v10, s[4:7], s90 offen offset:1024 sc1
    buffer_load_dwordx4 v[96:99], v10, s[4:7], s90 offen offset:2048 sc1
    buffer_load_dwordx4 v[100:103], v10, s[4:7], s90 offen offset:3072 sc1
    s_add_u32 s90, s41, 794624
    buffer_load_dwordx4 v[104:107], v10, s[4:7], s90 offen offset:0 sc1
    buffer_load_dwordx4 v[108:111], v10, s[4:7], s90 offen offset:1024 sc1
    buffer_load_dwordx4 v[112:115], v10, s[4:7], s90 offen offset:2048 sc1
    buffer_load_dwordx4 v[116:119], v10, s[4:7], s90 offen offset:3072 sc1
    s_waitcnt vmcnt(0)
    v_mfma_f32_16x16x32_bf16 v[144:147], v[72:75], v[24:27], 0
    v_mfma_f32_16x16x32_bf16 v[152:155], v[72:75], v[48:51], 0
    v_mfma_f32_16x16x32_bf16 v[156:159], v[96:99], v[48:51], 0
    v_mfma_f32_16x16x32_bf16 v[144:147], v[76:79], v[28:31], v[144:147]
    v_mfma_f32_16x16x32_bf16 v[152:155], v[76:79], v[52:55], v[152:155]
    v_mfma_f32_16x16x32_bf16 v[156:159], v[100:103], v[52:55], v[156:159]
    v_mfma_f32_16x16x32_bf16 v[144:147], v[80:83], v[32:35], v[144:147]
    v_mfma_f32_16x16x32_bf16 v[152:155], v[80:83], v[56:59], v[152:155]
    v_mfma_f32_16x16x32_bf16 v[156:159], v[104:107], v[56:59], v[156:159]
    v_mfma_f32_16x16x32_bf16 v[144:147], v[84:87], v[36:39], v[144:147]
    v_mfma_f32_16x16x32_bf16 v[152:155], v[84:87], v[60:63], v[152:155]
    v_mfma_f32_16x16x32_bf16 v[156:159], v[108:111], v[60:63], v[156:159]
    v_mfma_f32_16x16x32_bf16 v[144:147], v[88:91], v[40:43], v[144:147]
    v_mfma_f32_16x16x32_bf16 v[152:155], v[88:91], v[64:67], v[152:155]
    v_mfma_f32_16x16x32_bf16 v[156:159], v[112:115], v[64:67], v[156:159]
    v_mfma_f32_16x16x32_bf16 v[144:147], v[92:95], v[44:47], v[144:147]
    v_mfma_f32_16x16x32_bf16 v[152:155], v[92:95], v[68:71], v[152:155]
    v_mfma_f32_16x16x32_bf16 v[156:159], v[116:119], v[68:71], v[156:159]
    s_nop 5
    v_cndmask_b32 v144, v21, v144, s[48:49]
    v_cndmask_b32 v145, v21, v145, s[50:51]
    v_cndmask_b32 v146, v21, v146, s[52:53]
    v_cndmask_b32 v147, v21, v147, s[54:55]
    v_cndmask_b32 v156, v21, v156, s[48:49]
    v_cndmask_b32 v157, v21, v157, s[50:51]
    v_cndmask_b32 v158, v21, v158, s[52:53]
    v_cndmask_b32 v159, v21, v159, s[54:55]
L_pf_92:
    buffer_load_dword v16, v14, s[4:7], s38 offen sc1
    s_sub_u32 s36, s36, 1
    s_cbranch_scc1 L_exit
    s_waitcnt vmcnt(0)
    v_cmp_ge_u32 vcc, s37, v16
    s_cbranch_vccnz L_pf_92
    buffer_load_dwordx4 v[120:123], v11, s[4:7], s42 offen offset:0 sc1
    buffer_load_dwordx4 v[124:127], v11, s[4:7], s42 offen offset:512 sc1
    buffer_load_dwordx4 v[128:131], v11, s[4:7], s42 offen offset:1024 sc1
    buffer_load_dwordx4 v[132:135], v11, s[4:7], s42 offen offset:1536 sc1
    buffer_load_dwordx4 v[136:139], v11, s[4:7], s42 offen offset:2048 sc1
    buffer_load_dwordx4 v[140:143], v11, s[4:7], s42 offen offset:2560 sc1
    s_waitcnt vmcnt(5)
    v_mfma_f32_16x16x32_bf16 v[148:151], v[120:123], v[24:27], 0
    v_mfma_f32_16x16x32_bf16 v[160:163], v[120:123], v[48:51], 0
    s_waitcnt vmcnt(4)
    v_mfma_f32_16x16x32_bf16 v[148:151], v[124:127], v[28:31], v[148:151]
    v_mfma_f32_16x16x32_bf16 v[160:163], v[124:127], v[52:55], v[160:163]
    s_waitcnt vmcnt(3)
    v_mfma_f32_16x16x32_bf16 v[148:151], v[128:131], v[32:35], v[148:151]
    v_mfma_f32_16x16x32_bf16 v[160:163], v[128:131], v[56:59], v[160:163]
    s_waitcnt vmcnt(2)
    v_mfma_f32_16x16x32_bf16 v[148:151], v[132:135], v[36:39], v[148:151]
    v_mfma_f32_16x16x32_bf16 v[160:163], v[132:135], v[60:63], v[160:163]
    s_waitcnt vmcnt(1)
    v_mfma_f32_16x16x32_bf16 v[148:151], v[136:139], v[40:43], v[148:151]
    v_mfma_f32_16x16x32_bf16 v[160:163], v[136:139], v[64:67], v[160:163]
    s_waitcnt vmcnt(0)
    v_mfma_f32_16x16x32_bf16 v[148:151], v[140:143], v[44:47], v[148:151]
    v_mfma_f32_16x16x32_bf16 v[160:163], v[140:143], v[68:71], v[160:163]
    v_max_f32 v18, v144, v145
    v_max3_f32 v18, v18, v146, v147
    s_nop 4
    v_max3_f32 v18, v18, v148, v149
    v_mov_b32 v19, v18
    s_nop 1
    v_permlane16_swap_b32 v18, v19
    v_max_f32 v18, v18, v19
    v_mov_b32 v19, v18
    s_nop 1
    v_permlane32_swap_b32 v18, v19
    v_max_f32 v18, v18, v19
    v_mul_f32 v18, 0xbdd53b95, v18
    v_fma_f32 v144, v144, s44, v18
    v_fma_f32 v145, v145, s44, v18
    v_fma_f32 v146, v146, s44, v18
    v_fma_f32 v147, v147, s44, v18
    v_fma_f32 v148, v148, s44, v18
    v_fma_f32 v149, v149, s44, v18
    v_exp_f32 v144, v144
    v_exp_f32 v145, v145
    v_exp_f32 v146, v146
    v_exp_f32 v147, v147
    v_exp_f32 v148, v148
    v_exp_f32 v149, v149
    v_add_f32 v20, v144, v145
    v_add_f32 v20, v20, v146
    v_add_f32 v20, v20, v147
    v_add_f32 v20, v20, v148
    v_add_f32 v20, v20, v149
    v_mov_b32 v19, v20
    s_nop 1
    v_permlane16_swap_b32 v20, v19
    v_add_f32 v20, v20, v19
    v_mov_b32 v19, v20
    s_nop 1
    v_permlane32_swap_b32 v20, v19
    v_add_f32 v20, v20, v19
    v_rcp_f32 v20, v20
    s_nop 0
    v_mul_f32 v144, v144, v20
    v_mul_f32 v145, v145, v20
    v_mul_f32 v146, v146, v20
    v_mul_f32 v147, v147, v20
    v_mul_f32 v148, v148, v20
    v_mul_f32 v149, v149, v20
    v_cvt_pk_bf16_f32 v164, v144, v145
    v_cvt_pk_bf16_f32 v165, v146, v147
    v_cvt_pk_bf16_f32 v166, v148, v149
    v_max_f32 v18, v152, v153
    v_max3_f32 v18, v18, v154, v155
    v_max3_f32 v18, v18, v160, v161
    v_max3_f32 v18, v18, v156, v157
    v_max3_f32 v18, v18, v158, v159
    v_mov_b32 v19, v18
    s_nop 1
    v_permlane16_swap_b32 v18, v19
    v_max_f32 v18, v18, v19
    v_mov_b32 v19, v18
    s_nop 1
    v_permlane32_swap_b32 v18, v19
    v_max_f32 v18, v18, v19
    v_mul_f32 v18, 0xbdd53b95, v18
    v_fma_f32 v152, v152, s44, v18
    v_fma_f32 v153, v153, s44, v18
    v_fma_f32 v154, v154, s44, v18
    v_fma_f32 v155, v155, s44, v18
    v_fma_f32 v160, v160, s44, v18
    v_fma_f32 v161, v161, s44, v18
    v_fma_f32 v156, v156, s44, v18
    v_fma_f32 v157, v157, s44, v18
    v_fma_f32 v158, v158, s44, v18
    v_fma_f32 v159, v159, s44, v18
    v_exp_f32 v152, v152
    v_exp_f32 v153, v153
    v_exp_f32 v154, v154
    v_exp_f32 v155, v155
    v_exp_f32 v160, v160
    v_exp_f32 v161, v161
    v_exp_f32 v156, v156
    v_exp_f32 v157, v157
    v_exp_f32 v158, v158
    v_exp_f32 v159, v159
    v_add_f32 v20, v152, v153
    v_add_f32 v20, v20, v154
    v_add_f32 v20, v20, v155
    v_add_f32 v20, v20, v160
    v_add_f32 v20, v20, v161
    v_add_f32 v20, v20, v156
    v_add_f32 v20, v20, v157
    v_add_f32 v20, v20, v158
    v_add_f32 v20, v20, v159
    v_mov_b32 v19, v20
    s_nop 1
    v_permlane16_swap_b32 v20, v19
    v_add_f32 v20, v20, v19
    v_mov_b32 v19, v20
    s_nop 1
    v_permlane32_swap_b32 v20, v19
    v_add_f32 v20, v20, v19
    v_rcp_f32 v20, v20
    s_nop 0
    v_mul_f32 v152, v152, v20
    v_mul_f32 v153, v153, v20
    v_mul_f32 v154, v154, v20
    v_mul_f32 v155, v155, v20
    v_mul_f32 v160, v160, v20
    v_mul_f32 v161, v161, v20
    v_mul_f32 v156, v156, v20
    v_mul_f32 v157, v157, v20
    v_mul_f32 v158, v158, v20
    v_mul_f32 v159, v159, v20
    v_cvt_pk_bf16_f32 v168, v152, v153
    v_cvt_pk_bf16_f32 v169, v154, v155
    v_cvt_pk_bf16_f32 v170, v160, v161
    v_cvt_pk_bf16_f32 v172, v156, v157
    v_cvt_pk_bf16_f32 v173, v158, v159
    buffer_store_dwordx4 v[164:167], v12, s[4:7], s43 offen offset:0 sc1
    buffer_store_dwordx4 v[168:171], v12, s[4:7], s43 offen offset:1024 sc1
    buffer_store_dwordx4 v[172:175], v12, s[4:7], s43 offen offset:2048 sc1
    s_waitcnt vmcnt(0)
    buffer_store_dword v17, v15, s[4:7], s38 offen sc1
    s_add_u32 s37, s37, 2
    s_cmp_lt_u32 s37, 64
    s_cbranch_scc1 L_px_loop_s
    s_endpgm
L_pa_s:
    s_cmp_lg_u32 s32, 0
    s_cbranch_scc1 L_arr_93
    v_mov_b32 v1, 68
    v_mov_b32 v2, 1
    s_mov_b64 exec, 1
    buffer_atomic_add v2, v1, s[8:11], 0 offen sc1
    s_mov_b64 exec, -1
L_arr_93:
    v_lshlrev_b32 v1, 2, v0
L_gw_94:
    buffer_load_dword v2, v1, s[8:11], 0 offen sc1
    s_sub_u32 s36, s36, 1
    s_cbranch_scc1 L_exit
    s_waitcnt vmcnt(0)
    v_readlane_b32 s90, v2, 17
    s_nop 0
    s_cmp_lg_u32 s90, 256
    s_cbranch_scc1 L_gw_94
    s_branch L_pa_body
.section .rodata,"a"
.p2align 6
.amdhsa_kernel concat_heads__sliding_local_dilated__memory_aug_recurrent_mem_tr__prompt_kernel
  .amdhsa_next_free_vgpr 512
  .amdhsa_next_free_sgpr 102
  .amdhsa_accum_offset 256
  .amdhsa_group_segment_fixed_size 0
  .amdhsa_kernarg_size 104
  .amdhsa_user_sgpr_count 2
  .amdhsa_user_sgpr_kernarg_segment_ptr 1
  .amdhsa_system_sgpr_workgroup_id_x 1
  .amdhsa_float_denorm_mode_32 3
.end_amdhsa_kernel
```

```asm
; @launch grid=(256,1,1) block=(256,1,1) lds=163840
.amdgcn_target "amdgcn-amd-amdhsa--gfx950"
.text
.globl concat_heads__sliding_local_dilated__memory_aug_recurrent_mem_tr__prompt_kernel
.p2align 8
.type concat_heads__sliding_local_dilated__memory_aug_recurrent_mem_tr__prompt_kernel,@function
concat_heads__sliding_local_dilated__memory_aug_recurrent_mem_tr__prompt_kernel:
    s_cmp_ge_u32 s2, 256
    s_cbranch_scc1 L_exit
    s_load_dwordx16 s[64:79], s[0:1], 0
    s_load_dwordx8 s[80:87], s[0:1], 64
    s_load_dwordx2 s[88:89], s[0:1], 96
    s_getreg_b32 s33, hwreg(HW_REG_XCC_ID, 0, 4)
    v_lshrrev_b32 v1, 6, v0
    v_and_b32 v0, 63, v0
    v_readfirstlane_b32 s32, v1
    s_mov_b32 s36, 0x100000
    s_mov_b32 s96, 0
    s_mov_b32 s97, 0
    s_and_b32 s90, s33, 4
    s_lshl_b32 s90, s90, 5
    s_and_b32 s91, s33, 3
    s_lshl_b32 s91, s91, 2
    s_add_u32 s90, s90, s91
    s_lshr_b32 s91, s33, 3
    s_lshl_b32 s91, s91, 4
    s_add_u32 s90, s90, s91
    v_mov_b32 v1, s90
    v_mov_b32 v2, 1
    v_mov_b32 v3, 0
    s_waitcnt lgkmcnt(0)
    s_mov_b32 s8, s86
    s_and_b32 s9, s87, 0xffff
    s_mov_b32 s10, 256
    s_mov_b32 s11, 0x20000
    s_mov_b32 s4, s88
    s_and_b32 s5, s89, 0xffff
    s_mov_b32 s6, 33554432
    s_mov_b32 s7, 0x20000
    s_mov_b32 s28, s84
    s_and_b32 s29, s85, 0xffff
    s_mov_b32 s30, 5242880
    s_mov_b32 s31, 0x20000
    s_cmp_lg_u32 s32, 0
    s_cbranch_scc1 L_norank
    s_mov_b64 exec, 1
    buffer_atomic_add v2, v1, s[8:11], 0 offen sc0 sc1
    s_waitcnt vmcnt(0)
    ds_write_b32 v3, v2
    s_waitcnt lgkmcnt(0)
    s_mov_b64 exec, -1
    s_branch L_rank
L_norank:
    s_and_b32 s34, s33, 7
    s_lshr_b32 s93, s2, 3
    s_mul_i32 s93, s93, 3
    s_add_u32 s93, s93, s32
    s_sub_u32 s93, s93, 1
    v_add_u32 v4, 0, v0
    v_cmp_le_u32 vcc, 96, v4
    v_subrev_u32 v5, 96, v4
    s_nop 0
    v_cndmask_b32 v4, v4, v5, vcc
    v_lshlrev_b32 v4, 4, v4
    v_mov_b32 v5, 12288
    v_cndmask_b32 v5, 0, v5, vcc
    s_mul_i32 s90, s34, 1536
    v_add3_u32 v6, v4, v5, s90
    v_add_u32 v4, 64, v0
    v_cmp_le_u32 vcc, 96, v4
    v_subrev_u32 v5, 96, v4
    s_nop 0
    v_cndmask_b32 v4, v4, v5, vcc
    v_lshlrev_b32 v4, 4, v4
    v_mov_b32 v5, 12288
    v_cndmask_b32 v5, 0, v5, vcc
    s_mul_i32 s90, s34, 1536
    v_add3_u32 v7, v4, v5, s90
    v_add_u32 v4, 128, v0
    v_cmp_le_u32 vcc, 96, v4
    v_subrev_u32 v5, 96, v4
    s_nop 0
    v_cndmask_b32 v4, v4, v5, vcc
    v_lshlrev_b32 v4, 4, v4
    v_mov_b32 v5, 12288
    v_cndmask_b32 v5, 0, v5, vcc
    s_mul_i32 s90, s34, 1536
    v_add3_u32 v8, v4, v5, s90
    s_cmp_lt_u32 s93, 64
    s_cselect_b32 s12, s78, s76
    s_cselect_b32 s13, s79, s77
    s_cselect_b32 s91, 2, 0
    s_cmp_lt_u32 s93, 32
    s_cselect_b32 s12, s78, s12
    s_cselect_b32 s13, s79, s13
    s_cselect_b32 s91, 2, s91
    s_and_b32 s13, s13, 0xffff
    s_mov_b32 s14, 7864320
    s_mov_b32 s15, 0x20000
    s_mul_i32 s91, s91, 320
    s_mul_i32 s90, s93, 10
    s_add_u32 s90, s90, s91
    s_sub_u32 s90, s90, 640
    s_mul_i32 s90, s90, 12288
    buffer_load_dwordx4 v[248:251], v6, s[12:15], s90 offen
    buffer_load_dwordx4 v[248:251], v7, s[12:15], s90 offen
    buffer_load_dwordx4 v[248:251], v8, s[12:15], s90 offen
    s_add_u32 s90, s90, 24576
    buffer_load_dwordx4 v[248:251], v6, s[12:15], s90 offen
    buffer_load_dwordx4 v[248:251], v7, s[12:15], s90 offen
    buffer_load_dwordx4 v[248:251], v8, s[12:15], s90 offen
    s_add_u32 s90, s90, 24576
    buffer_load_dwordx4 v[248:251], v6, s[12:15], s90 offen
    buffer_load_dwordx4 v[248:251], v7, s[12:15], s90 offen
    buffer_load_dwordx4 v[248:251], v8, s[12:15], s90 offen
    s_add_u32 s90, s90, 24576
    buffer_load_dwordx4 v[248:251], v6, s[12:15], s90 offen
    buffer_load_dwordx4 v[248:251], v7, s[12:15], s90 offen
    buffer_load_dwordx4 v[248:251], v8, s[12:15], s90 offen
    s_add_u32 s90, s90, 24576
    buffer_load_dwordx4 v[248:251], v6, s[12:15], s90 offen
    buffer_load_dwordx4 v[248:251], v7, s[12:15], s90 offen
    buffer_load_dwordx4 v[248:251], v8, s[12:15], s90 offen
    s_add_u32 s90, s90, 24576
L_rank:
    s_barrier
    ds_read_b32 v2, v3
    s_waitcnt lgkmcnt(0)
    v_readfirstlane_b32 s35, v2
    s_mov_b32 s34, s33
    s_barrier
    s_cmp_ge_u32 s33, 8
    s_cbranch_scc1 L_norole
    s_cmp_ge_u32 s35, 32
    s_cbranch_scc1 L_norole
    s_lshl_b32 s38, s34, 21
    s_add_u32 s38, s38, 8388608
    s_cmp_lt_u32 s35, 12
    s_cbranch_scc1 L_qkv_f
    s_cmp_lt_u32 s35, 22
    s_cbranch_scc1 L_wo_f
    s_cmp_lt_u32 s35, 24
    s_cbranch_scc1 L_px_f
    s_branch L_pa_f
L_norole:
    v_mov_b32 v1, 192
    v_mov_b32 v2, 2
    s_mov_b64 exec, 1
    buffer_store_dword v2, v1, s[8:11], 0 offen sc1
    s_mov_b64 exec, -1
    s_branch L_slow
L_exit:
    s_endpgm
L_qkv_f:
    s_mov_b32 s12, s74
    s_and_b32 s13, s75, 0xffff
    s_mov_b32 s14, 7864320
    s_mov_b32 s15, 0x20000
    s_mov_b32 s16, s76
    s_and_b32 s17, s77, 0xffff
    s_mov_b32 s18, 7864320
    s_mov_b32 s19, 0x20000
    s_mov_b32 s20, s78
    s_and_b32 s21, s79, 0xffff
    s_mov_b32 s22, 7864320
    s_mov_b32 s23, 0x20000
    s_mov_b32 s24, s70
    s_and_b32 s25, s71, 0xffff
    s_mov_b32 s26, 2621440
    s_mov_b32 s27, 0x20000
    s_mul_i32 s40, s35, 86
    s_lshr_b32 s40, s40, 8
    s_mul_i32 s90, s40, 3
    s_sub_u32 s41, s35, s90
    v_and_b32 v1, 15, v0
    v_lshrrev_b32 v2, 4, v0
    v_lshrrev_b32 v3, 3, v0
    v_and_b32 v4, 7, v0
    s_lshl_b32 s90, s32, 3
    v_add_u32 v5, s90, v3
    s_and_b32 s91, s32, 1
    s_lshl_b32 s91, s91, 2
    v_and_b32 v6, 2, v3
    v_or_b32 v6, s91, v6
    v_xor_b32 v6, v6, v4
    v_lshlrev_b32 v6, 4, v6
    v_mul_u32_u24 v7, 12288, v5
    s_lshl_b32 s92, s34, 2
    s_add_u32 s92, s92, s40
    s_mul_i32 s92, s92, 384
    s_lshl_b32 s93, s41, 7
    s_add_u32 s92, s92, s93
    v_add3_u32 v164, v6, v7, s92
    v_lshrrev_b32 v6, 1, v3
    v_or_b32 v6, s91, v6
    v_xor_b32 v6, v6, v4
    v_lshlrev_b32 v6, 4, v6
    v_mul_u32_u24 v7, 1280, v5
    v_add_u32 v10, v6, v7
    s_lshl_b32 s90, s32, 10
    s_add_u32 m0, s90, 40960
    s_mov_b32 s91, 0
    buffer_load_dwordx4 v164, s[20:23], s91 offen lds
    s_add_u32 m0, m0, 4096
    s_add_u32 s91, s91, 393216
    buffer_load_dwordx4 v164, s[20:23], s91 offen lds
    s_add_u32 m0, m0, 4096
    s_add_u32 s91, s91, 393216
    buffer_load_dwordx4 v164, s[20:23], s91 offen lds
    s_add_u32 m0, m0, 4096
    s_add_u32 s91, s91, 393216
    buffer_load_dwordx4 v164, s[20:23], s91 offen lds
    s_add_u32 m0, m0, 4096
    s_add_u32 s91, s91, 393216
    buffer_load_dwordx4 v164, s[20:23], s91 offen lds
    s_add_u32 m0, m0, 4096
    s_add_u32 s91, s91, 393216
    buffer_load_dwordx4 v164, s[20:23], s91 offen lds
    s_add_u32 m0, m0, 4096
    s_add_u32 s91, s91, 393216
    buffer_load_dwordx4 v164, s[20:23], s91 offen lds
    s_add_u32 m0, m0, 4096
    s_add_u32 s91, s91, 393216
    buffer_load_dwordx4 v164, s[20:23], s91 offen lds
    s_add_u32 m0, m0, 4096
    s_add_u32 s91, s91, 393216
    buffer_load_dwordx4 v164, s[20:23], s91 offen lds
    s_add_u32 m0, m0, 4096
    s_add_u32 s91, s91, 393216
    buffer_load_dwordx4 v164, s[20:23], s91 offen lds
    s_lshl_b32 s90, s32, 10
    s_add_u32 m0, s90, 81920
    s_mov_b32 s91, 3932160
    buffer_load_dwordx4 v164, s[20:23], s91 offen lds
    s_add_u32 m0, m0, 4096
    s_add_u32 s91, s91, 393216
    buffer_load_dwordx4 v164, s[20:23], s91 offen lds
    s_add_u32 m0, m0, 4096
    s_add_u32 s91, s91, 393216
    buffer_load_dwordx4 v164, s[20:23], s91 offen lds
    s_add_u32 m0, m0, 4096
    s_add_u32 s91, s91, 393216
    buffer_load_dwordx4 v164, s[20:23], s91 offen lds
    s_add_u32 m0, m0, 4096
    s_add_u32 s91, s91, 393216
    buffer_load_dwordx4 v164, s[20:23], s91 offen lds
    s_add_u32 m0, m0, 4096
    s_add_u32 s91, s91, 393216
    buffer_load_dwordx4 v164, s[20:23], s91 offen lds
    s_add_u32 m0, m0, 4096
    s_add_u32 s91, s91, 393216
    buffer_load_dwordx4 v164, s[20:23], s91 offen lds
    s_add_u32 m0, m0, 4096
    s_add_u32 s91, s91, 393216
    buffer_load_dwordx4 v164, s[20:23], s91 offen lds
    s_add_u32 m0, m0, 4096
    s_add_u32 s91, s91, 393216
    buffer_load_dwordx4 v164, s[20:23], s91 offen lds
    s_add_u32 m0, m0, 4096
    s_add_u32 s91, s91, 393216
    buffer_load_dwordx4 v164, s[20:23], s91 offen lds
    s_lshl_b32 s90, s32, 10
    s_add_u32 m0, s90, 122880
    s_mov_b32 s91, 0
    buffer_load_dwordx4 v164, s[16:19], s91 offen lds
    s_add_u32 m0, m0, 4096
    s_add_u32 s91, s91, 393216
    buffer_load_dwordx4 v164, s[16:19], s91 offen lds
    s_add_u32 m0, m0, 4096
    s_add_u32 s91, s91, 393216
    buffer_load_dwordx4 v164, s[16:19], s91 offen lds
    s_add_u32 m0, m0, 4096
    s_add_u32 s91, s91, 393216
    buffer_load_dwordx4 v164, s[16:19], s91 offen lds
    s_add_u32 m0, m0, 4096
    s_add_u32 s91, s91, 393216
    buffer_load_dwordx4 v164, s[16:19], s91 offen lds
    s_add_u32 m0, m0, 4096
    s_add_u32 s91, s91, 393216
    buffer_load_dwordx4 v164, s[16:19], s91 offen lds
    s_add_u32 m0, m0, 4096
    s_add_u32 s91, s91, 393216
    buffer_load_dwordx4 v164, s[16:19], s91 offen lds
    s_add_u32 m0, m0, 4096
    s_add_u32 s91, s91, 393216
    buffer_load_dwordx4 v164, s[16:19], s91 offen lds
    s_add_u32 m0, m0, 4096
    s_add_u32 s91, s91, 393216
    buffer_load_dwordx4 v164, s[16:19], s91 offen lds
    s_add_u32 m0, m0, 4096
    s_add_u32 s91, s91, 393216
    buffer_load_dwordx4 v164, s[16:19], s91 offen lds
    s_mov_b32 s46, 0
    s_lshl_b32 s90, s32, 10
    s_add_u32 m0, s90, 0
    s_nop 0
    buffer_load_dwordx4 v10, s[24:27], s46 offen offset:0 lds
    s_add_u32 m0, m0, 3968
    s_nop 0
    buffer_load_dwordx4 v10, s[24:27], s46 offen offset:128 lds
    s_add_u32 m0, m0, 3968
    s_nop 0
    buffer_load_dwordx4 v10, s[24:27], s46 offen offset:256 lds
    s_add_u32 m0, m0, 3968
    s_nop 0
    buffer_load_dwordx4 v10, s[24:27], s46 offen offset:384 lds
    s_add_u32 m0, m0, 3968
    s_nop 0
    buffer_load_dwordx4 v10, s[24:27], s46 offen offset:512 lds
    s_add_u32 m0, m0, 3968
    s_nop 0
    buffer_load_dwordx4 v10, s[24:27], s46 offen offset:640 lds
    s_add_u32 m0, m0, 3968
    s_nop 0
    buffer_load_dwordx4 v10, s[24:27], s46 offen offset:768 lds
    s_add_u32 m0, m0, 3968
    s_nop 0
    buffer_load_dwordx4 v10, s[24:27], s46 offen offset:896 lds
    s_add_u32 m0, m0, 3968
    s_nop 0
    buffer_load_dwordx4 v10, s[24:27], s46 offen offset:1024 lds
    s_add_u32 m0, m0, 3968
    s_nop 0
    buffer_load_dwordx4 v10, s[24:27], s46 offen offset:1152 lds
    s_mul_i32 s90, s40, 3072
    s_lshl_b32 s91, s41, 10
    s_add_u32 s90, s90, s91
    s_lshl_b32 s91, s32, 8
    s_add_u32 s91, s91, s90
    s_add_u32 s91, s91, 25600
    v_lshl_add_u32 v21, v1, 4, s91
    v_cmp_eq_u32 vcc, 0, v2
    v_mov_b32 v9, 2146435072
    s_nop 0
    v_cndmask_b32 v21, v9, v21, vcc
    v_lshrrev_b32 v3, 2, v1
    v_lshlrev_b32 v3, 1, v3
    v_and_b32 v4, 1, v1
    v_or_b32 v3, v3, v4
    v_lshl_add_u32 v3, v2, 3, v3
    v_lshl_add_u32 v26, v3, 4, s90
    v_and_b32 v4, 2, v1
    v_cmp_ne_u32 vcc, 0, v4
    v_mov_b32 v9, 2146435072
    s_nop 0
    v_cndmask_b32 v26, v9, v26, vcc
    s_mul_i32 s90, s40, 3840
    s_mul_i32 s91, s41, 1280
    s_add_u32 s90, s90, s91
    s_add_u32 s90, s90, 10240
    v_lshrrev_b32 v3, 1, v2
    v_and_b32 v5, 1, v2
    v_lshlrev_b32 v6, 1, v5
    v_or_b32 v7, v6, v3
    v_lshl_add_u32 v7, v7, 4, v1
    v_lshlrev_b32 v7, 2, v7
    v_add_u32 v7, 1024, v7
    v_or_b32 v6, v6, v1
    v_lshl_add_u32 v6, v3, 4, v6
    v_lshlrev_b32 v6, 4, v6
    s_sub_u32 s91, s32, 1
    s_lshl_b32 s91, s91, 9
    v_add_u32 v6, s91, v6
    s_cmp_eq_u32 s32, 0
    s_cselect_b64 vcc, -1, 0
    v_cndmask_b32 v6, v6, v7, vcc
    v_add_u32 v25, s90, v6
    v_cmp_eq_u32 vcc, 0, v4
    v_mov_b32 v9, 2146435072
    s_nop 0
    v_cndmask_b32 v25, v9, v25, vcc
    s_and_b32 s90, s32, 1
    s_lshl_b32 s90, s90, 9
    s_lshr_b32 s91, s32, 1
    s_lshl_b32 s91, s91, 10
    s_add_u32 s90, s90, s91
    v_lshlrev_b32 v6, 4, v1
    v_lshl_add_u32 v6, v3, 8, v6
    v_add_u32 v6, s90, v6
    v_lshl_add_u32 v27, v5, 11, v6
    v_add_u32 v27, 136192, v27
    s_mul_i32 s90, s40, 12288
    s_lshl_b32 s91, s41, 11
    s_add_u32 s90, s90, s91
    v_mul_u32_u24 v7, 6144, v5
    v_add3_u32 v29, v6, v7, s90
    v_and_b32 v6, 9, v1
    v_and_b32 v7, 2, v1
    v_lshl_or_b32 v6, v7, 1, v6
    v_and_b32 v7, 4, v1
    v_lshrrev_b32 v7, 1, v7
    v_or_b32 v6, v6, v7
    v_lshlrev_b32 v6, 4, v6
    v_lshl_add_u32 v6, v2, 8, v6
    s_cmp_eq_u32 s32, 2
    s_cselect_b32 s90, 2048, 0
    s_add_u32 s90, s90, 136192
    v_add_u32 v28, s90, v6
    s_lshl_b32 s90, s40, 7
    s_lshl_b32 s91, s41, 2
    s_add_u32 s92, s91, s32
    s_lshl_b32 s92, s92, 2
    s_add_u32 s92, s92, s90
    s_add_u32 s92, s92, 163840
    v_mov_b32 v30, s92
    s_add_u32 s91, s91, s90
    s_add_u32 s91, s91, 164352
    s_cmp_eq_u32 s32, 3
    s_cselect_b32 s91, s91, 2146435072
    v_mov_b32 v31, s91
    v_cmp_eq_u32 vcc, 0, v0
    v_mov_b32 v9, 2146435072
    s_nop 0
    v_cndmask_b32 v30, v9, v30, vcc
    v_cndmask_b32 v220, 1, 3, vcc
    v_cmp_eq_u32 vcc, 1, v0
    s_nop 1
    v_cndmask_b32 v31, v30, v31, vcc
    v_mov_b32 v36, -1
    v_mov_b32 v37, -1
    v_mov_b32 v38, -1
    v_mov_b32 v39, -1
    s_mul_i32 s90, s35, 49152
    s_lshl_b32 s91, s32, 11
    s_add_u32 s90, s90, s91
    s_lshl_b32 s92, s35, 10
    s_lshl_b32 s91, s32, 8
    s_add_u32 s92, s92, s91
    s_cmp_lt_u32 s35, 10
    s_cselect_b32 s90, s90, 2146435072
    s_cselect_b32 s92, s92, 2146435072
    v_lshl_add_u32 v214, v0, 4, s90
    v_add_u32 v215, 1024, v214
    s_min_u32 s90, s35, 9
    s_lshl_b32 s90, s90, 7
    s_add_u32 s90, s90, 165888
    v_and_b32 v3, 3, v0
    v_lshl_add_u32 v216, v3, 2, s90
    v_lshl_add_u32 v219, v0, 2, s92
    v_lshl_add_u32 v218, v1, 4, s92
    v_cmp_eq_u32 vcc, 0, v2
    v_mov_b32 v9, 2146435072
    s_nop 0
    v_cndmask_b32 v218, v9, v218, vcc
    v_and_b32 v7, 1, v1
    v_cmp_ne_u32 vcc, 0, v7
    v_mov_b32 v5, 0x3f80
    v_mov_b32 v6, 0x3f800000
    v_cndmask_b32 v5, v5, v6, vcc
    v_bfe_u32 v6, v1, 1, 1
    v_cmp_eq_u32 vcc, 0, v6
    s_nop 1
    v_cndmask_b32 v210, 0, v5, vcc
    v_mov_b32 v208, 0
    v_mov_b32 v212, 0
    v_cmp_eq_u32 vcc, 1, v6
    s_nop 1
    v_cndmask_b32 v211, 0, v5, vcc
    v_mov_b32 v209, 0
    v_mov_b32 v213, 0
    v_lshrrev_b32 v3, 2, v1
    v_and_b32 v4, 3, v1
    v_and_b32 v5, 1, v2
    v_lshl_add_u32 v6, v2, 3, v3
    v_lshlrev_b32 v6, 7, v6
    v_and_b32 v7, 2, v3
    v_lshl_or_b32 v7, v5, 2, v7
    v_lshrrev_b32 v8, 1, v4
    s_lshl_b32 s90, s32, 1
    v_or_b32 v8, s90, v8
    v_xor_b32 v7, v7, v8
    v_lshl_add_u32 v6, v7, 4, v6
    v_and_b32 v7, 1, v4
    v_lshl_add_u32 v6, v7, 3, v6
    v_add_u32 v165, 40960, v6
    v_add_u32 v166, 81920, v6
    v_add_u32 v167, 122880, v6
    v_xor_b32 v6, 0, v5
    v_lshl_add_u32 v6, v6, 2, v3
    v_lshl_add_u32 v6, v2, 3, v6
    v_lshlrev_b32 v6, 5, v6
    v_lshl_or_b32 v7, v5, 1, 0
    v_xor_b32 v7, v7, v4
    v_lshl_add_u32 v6, v7, 3, v6
    v_add_u32 v23, 133120, v6
    v_xor_b32 v6, 1, v5
    v_lshl_add_u32 v6, v6, 2, v3
    v_lshl_add_u32 v6, v2, 3, v6
    v_lshlrev_b32 v6, 5, v6
    v_lshl_or_b32 v7, v5, 1, 1
    v_xor_b32 v7, v7, v4
    v_lshl_add_u32 v6, v7, 3, v6
    v_add_u32 v24, 133120, v6
    v_lshrrev_b32 v6, 3, v1
    v_lshlrev_b32 v6, 2, v6
    v_xor_b32 v6, v6, v1
    v_lshlrev_b32 v6, 5, v6
    v_xor_b32 v7, v2, v3
    v_lshl_add_u32 v6, v7, 3, v6
    s_lshl_b32 s90, s32, 9
    s_add_u32 s90, s90, 133120
    v_add_u32 v22, s90, v6
    v_lshlrev_b32 v6, 6, v3
    v_and_b32 v7, 1, v1
    v_lshl_add_u32 v6, v7, 5, v6
    v_lshl_add_u32 v6, v2, 3, v6
    v_and_b32 v7, 2, v1
    v_lshl_add_u32 v6, v7, 1, v6
    s_lshl_b32 s90, s32, 8
    s_add_u32 s90, s90, 135168
    v_add_u32 v19, s90, v6
    v_lshl_add_u32 v20, v1, 3, s90
    v_cmp_ne_u32 vcc, 0, v7
    v_mov_b32 v6, 0x4444
    v_mov_b32 v8, 0xeeee
    v_cndmask_b32 v18, v6, v8, vcc
    v_lshlrev_b32 v6, 4, v0
    v_add_u32 v16, 122880, v6
    s_mul_i32 s90, s32, 2560
    v_lshl_add_u32 v13, v0, 4, s90
    v_lshl_add_u32 v14, v0, 2, s90
    s_add_u32 s48, s90, 122880
    v_mul_u32_u24 v6, 40, v0
    v_add_u32 v15, s48, v6
    v_lshrrev_b32 v6, 3, v1
    v_lshlrev_b32 v6, 10, v6
    v_and_b32 v7, 7, v1
    v_lshl_add_u32 v6, v7, 7, v6
    v_lshrrev_b32 v7, 1, v1
    v_xor_b32 v7, v7, v2
    v_lshl_add_u32 v11, v7, 4, v6
    v_xor_b32 v12, 64, v11
    s_waitcnt vmcnt(30)
    s_barrier
    ds_read_b64_tr_b16 a[160:161], v165 offset:0
    ds_read_b64_tr_b16 a[162:163], v165 offset:512
    ds_read_b64_tr_b16 a[164:165], v165 offset:4096
    ds_read_b64_tr_b16 a[166:167], v165 offset:4608
    ds_read_b64_tr_b16 a[168:169], v165 offset:8192
    ds_read_b64_tr_b16 a[170:171], v165 offset:8704
    ds_read_b64_tr_b16 a[172:173], v165 offset:12288
    ds_read_b64_tr_b16 a[174:175], v165 offset:12800
    ds_read_b64_tr_b16 a[176:177], v165 offset:16384
    ds_read_b64_tr_b16 a[178:179], v165 offset:16896
    ds_read_b64_tr_b16 a[180:181], v165 offset:20480
    ds_read_b64_tr_b16 a[182:183], v165 offset:20992
    ds_read_b64_tr_b16 a[184:185], v165 offset:24576
    ds_read_b64_tr_b16 a[186:187], v165 offset:25088
    ds_read_b64_tr_b16 a[188:189], v165 offset:28672
    ds_read_b64_tr_b16 a[190:191], v165 offset:29184
    ds_read_b64_tr_b16 a[192:193], v165 offset:32768
    ds_read_b64_tr_b16 a[194:195], v165 offset:33280
    ds_read_b64_tr_b16 a[196:197], v165 offset:36864
    ds_read_b64_tr_b16 a[198:199], v165 offset:37376
    s_waitcnt lgkmcnt(0)
    s_barrier
    s_lshl_b32 s90, s32, 10
    s_add_u32 m0, s90, 40960
    s_mov_b32 s91, 3932160
    buffer_load_dwordx4 v164, s[16:19], s91 offen lds
    s_add_u32 m0, m0, 4096
    s_add_u32 s91, s91, 393216
    buffer_load_dwordx4 v164, s[16:19], s91 offen lds
    s_add_u32 m0, m0, 4096
    s_add_u32 s91, s91, 393216
    buffer_load_dwordx4 v164, s[16:19], s91 offen lds
    s_add_u32 m0, m0, 4096
    s_add_u32 s91, s91, 393216
    buffer_load_dwordx4 v164, s[16:19], s91 offen lds
    s_add_u32 m0, m0, 4096
    s_add_u32 s91, s91, 393216
    buffer_load_dwordx4 v164, s[16:19], s91 offen lds
    s_add_u32 m0, m0, 4096
    s_add_u32 s91, s91, 393216
    buffer_load_dwordx4 v164, s[16:19], s91 offen lds
    s_add_u32 m0, m0, 4096
    s_add_u32 s91, s91, 393216
    buffer_load_dwordx4 v164, s[16:19], s91 offen lds
    s_add_u32 m0, m0, 4096
    s_add_u32 s91, s91, 393216
    buffer_load_dwordx4 v164, s[16:19], s91 offen lds
    s_add_u32 m0, m0, 4096
    s_add_u32 s91, s91, 393216
    buffer_load_dwordx4 v164, s[16:19], s91 offen lds
    s_add_u32 m0, m0, 4096
    s_add_u32 s91, s91, 393216
    buffer_load_dwordx4 v164, s[16:19], s91 offen lds
    s_waitcnt vmcnt(30)
    s_barrier
    ds_read_b64_tr_b16 a[200:201], v166 offset:0
    ds_read_b64_tr_b16 a[202:203], v166 offset:512
    ds_read_b64_tr_b16 a[204:205], v166 offset:4096
    ds_read_b64_tr_b16 a[206:207], v166 offset:4608
    ds_read_b64_tr_b16 a[208:209], v166 offset:8192
    ds_read_b64_tr_b16 a[210:211], v166 offset:8704
    ds_read_b64_tr_b16 a[212:213], v166 offset:12288
    ds_read_b64_tr_b16 a[214:215], v166 offset:12800
    ds_read_b64_tr_b16 a[216:217], v166 offset:16384
    ds_read_b64_tr_b16 a[218:219], v166 offset:16896
    ds_read_b64_tr_b16 a[220:221], v166 offset:20480
    ds_read_b64_tr_b16 a[222:223], v166 offset:20992
    ds_read_b64_tr_b16 a[224:225], v166 offset:24576
    ds_read_b64_tr_b16 a[226:227], v166 offset:25088
    ds_read_b64_tr_b16 a[228:229], v166 offset:28672
    ds_read_b64_tr_b16 a[230:231], v166 offset:29184
    ds_read_b64_tr_b16 a[232:233], v166 offset:32768
    ds_read_b64_tr_b16 a[234:235], v166 offset:33280
    ds_read_b64_tr_b16 a[236:237], v166 offset:36864
    ds_read_b64_tr_b16 a[238:239], v166 offset:37376
    s_waitcnt lgkmcnt(0)
    s_barrier
    s_lshl_b32 s90, s32, 10
    s_add_u32 m0, s90, 81920
    s_mov_b32 s91, 0
    buffer_load_dwordx4 v164, s[12:15], s91 offen lds
    s_add_u32 m0, m0, 4096
    s_add_u32 s91, s91, 393216
    buffer_load_dwordx4 v164, s[12:15], s91 offen lds
    s_add_u32 m0, m0, 4096
    s_add_u32 s91, s91, 393216
    buffer_load_dwordx4 v164, s[12:15], s91 offen lds
    s_add_u32 m0, m0, 4096
    s_add_u32 s91, s91, 393216
    buffer_load_dwordx4 v164, s[12:15], s91 offen lds
    s_add_u32 m0, m0, 4096
    s_add_u32 s91, s91, 393216
    buffer_load_dwordx4 v164, s[12:15], s91 offen lds
    s_add_u32 m0, m0, 4096
    s_add_u32 s91, s91, 393216
    buffer_load_dwordx4 v164, s[12:15], s91 offen lds
    s_add_u32 m0, m0, 4096
    s_add_u32 s91, s91, 393216
    buffer_load_dwordx4 v164, s[12:15], s91 offen lds
    s_add_u32 m0, m0, 4096
    s_add_u32 s91, s91, 393216
    buffer_load_dwordx4 v164, s[12:15], s91 offen lds
    s_add_u32 m0, m0, 4096
    s_add_u32 s91, s91, 393216
    buffer_load_dwordx4 v164, s[12:15], s91 offen lds
    s_add_u32 m0, m0, 4096
    s_add_u32 s91, s91, 393216
    buffer_load_dwordx4 v164, s[12:15], s91 offen lds
    s_waitcnt vmcnt(30)
    s_barrier
    ds_read_b64_tr_b16 a[80:81], v167 offset:0
    ds_read_b64_tr_b16 a[82:83], v167 offset:512
    ds_read_b64_tr_b16 a[84:85], v167 offset:4096
    ds_read_b64_tr_b16 a[86:87], v167 offset:4608
    ds_read_b64_tr_b16 a[88:89], v167 offset:8192
    ds_read_b64_tr_b16 a[90:91], v167 offset:8704
    ds_read_b64_tr_b16 a[92:93], v167 offset:12288
    ds_read_b64_tr_b16 a[94:95], v167 offset:12800
    ds_read_b64_tr_b16 a[96:97], v167 offset:16384
    ds_read_b64_tr_b16 a[98:99], v167 offset:16896
    ds_read_b64_tr_b16 a[100:101], v167 offset:20480
    ds_read_b64_tr_b16 a[102:103], v167 offset:20992
    ds_read_b64_tr_b16 a[104:105], v167 offset:24576
    ds_read_b64_tr_b16 a[106:107], v167 offset:25088
    ds_read_b64_tr_b16 a[108:109], v167 offset:28672
    ds_read_b64_tr_b16 a[110:111], v167 offset:29184
    ds_read_b64_tr_b16 a[112:113], v167 offset:32768
    ds_read_b64_tr_b16 a[114:115], v167 offset:33280
    ds_read_b64_tr_b16 a[116:117], v167 offset:36864
    ds_read_b64_tr_b16 a[118:119], v167 offset:37376
    s_waitcnt lgkmcnt(0)
    s_barrier
    s_lshl_b32 s90, s32, 10
    s_add_u32 m0, s90, 122880
    s_mov_b32 s91, 3932160
    buffer_load_dwordx4 v164, s[12:15], s91 offen lds
    s_add_u32 m0, m0, 4096
    s_add_u32 s91, s91, 393216
    buffer_load_dwordx4 v164, s[12:15], s91 offen lds
    s_add_u32 m0, m0, 4096
    s_add_u32 s91, s91, 393216
    buffer_load_dwordx4 v164, s[12:15], s91 offen lds
    s_add_u32 m0, m0, 4096
    s_add_u32 s91, s91, 393216
    buffer_load_dwordx4 v164, s[12:15], s91 offen lds
    s_add_u32 m0, m0, 4096
    s_add_u32 s91, s91, 393216
    buffer_load_dwordx4 v164, s[12:15], s91 offen lds
    s_add_u32 m0, m0, 4096
    s_add_u32 s91, s91, 393216
    buffer_load_dwordx4 v164, s[12:15], s91 offen lds
    s_add_u32 m0, m0, 4096
    s_add_u32 s91, s91, 393216
    buffer_load_dwordx4 v164, s[12:15], s91 offen lds
    s_add_u32 m0, m0, 4096
    s_add_u32 s91, s91, 393216
    buffer_load_dwordx4 v164, s[12:15], s91 offen lds
    s_add_u32 m0, m0, 4096
    s_add_u32 s91, s91, 393216
    buffer_load_dwordx4 v164, s[12:15], s91 offen lds
    s_add_u32 m0, m0, 4096
    s_add_u32 s91, s91, 393216
    buffer_load_dwordx4 v164, s[12:15], s91 offen lds
    s_waitcnt vmcnt(20)
    s_barrier
    ds_read_b64_tr_b16 a[120:121], v165 offset:0
    ds_read_b64_tr_b16 a[122:123], v165 offset:512
    ds_read_b64_tr_b16 a[124:125], v165 offset:4096
    ds_read_b64_tr_b16 a[126:127], v165 offset:4608
    ds_read_b64_tr_b16 a[128:129], v165 offset:8192
    ds_read_b64_tr_b16 a[130:131], v165 offset:8704
    ds_read_b64_tr_b16 a[132:133], v165 offset:12288
    ds_read_b64_tr_b16 a[134:135], v165 offset:12800
    ds_read_b64_tr_b16 a[136:137], v165 offset:16384
    ds_read_b64_tr_b16 a[138:139], v165 offset:16896
    ds_read_b64_tr_b16 a[140:141], v165 offset:20480
    ds_read_b64_tr_b16 a[142:143], v165 offset:20992
    ds_read_b64_tr_b16 a[144:145], v165 offset:24576
    ds_read_b64_tr_b16 a[146:147], v165 offset:25088
    ds_read_b64_tr_b16 a[148:149], v165 offset:28672
    ds_read_b64_tr_b16 a[150:151], v165 offset:29184
    ds_read_b64_tr_b16 a[152:153], v165 offset:32768
    ds_read_b64_tr_b16 a[154:155], v165 offset:33280
    ds_read_b64_tr_b16 a[156:157], v165 offset:36864
    ds_read_b64_tr_b16 a[158:159], v165 offset:37376
    s_waitcnt lgkmcnt(0)
    s_barrier
    s_mov_b32 s46, 40960
    s_lshl_b32 s90, s32, 10
    s_add_u32 m0, s90, 40960
    s_nop 0
    buffer_load_dwordx4 v10, s[24:27], s46 offen offset:0 lds
    s_add_u32 m0, m0, 3968
    s_nop 0
    buffer_load_dwordx4 v10, s[24:27], s46 offen offset:128 lds
    s_add_u32 m0, m0, 3968
    s_nop 0
    buffer_load_dwordx4 v10, s[24:27], s46 offen offset:256 lds
    s_add_u32 m0, m0, 3968
    s_nop 0
    buffer_load_dwordx4 v10, s[24:27], s46 offen offset:384 lds
    s_add_u32 m0, m0, 3968
    s_nop 0
    buffer_load_dwordx4 v10, s[24:27], s46 offen offset:512 lds
    s_add_u32 m0, m0, 3968
    s_nop 0
    buffer_load_dwordx4 v10, s[24:27], s46 offen offset:640 lds
    s_add_u32 m0, m0, 3968
    s_nop 0
    buffer_load_dwordx4 v10, s[24:27], s46 offen offset:768 lds
    s_add_u32 m0, m0, 3968
    s_nop 0
    buffer_load_dwordx4 v10, s[24:27], s46 offen offset:896 lds
    s_add_u32 m0, m0, 3968
    s_nop 0
    buffer_load_dwordx4 v10, s[24:27], s46 offen offset:1024 lds
    s_add_u32 m0, m0, 3968
    s_nop 0
    buffer_load_dwordx4 v10, s[24:27], s46 offen offset:1152 lds
    s_waitcnt vmcnt(20)
    s_barrier
    ds_read_b64_tr_b16 a[0:1], v166 offset:0
    ds_read_b64_tr_b16 a[2:3], v166 offset:512
    ds_read_b64_tr_b16 a[4:5], v166 offset:4096
    ds_read_b64_tr_b16 a[6:7], v166 offset:4608
    ds_read_b64_tr_b16 a[8:9], v166 offset:8192
    ds_read_b64_tr_b16 a[10:11], v166 offset:8704
    ds_read_b64_tr_b16 a[12:13], v166 offset:12288
    ds_read_b64_tr_b16 a[14:15], v166 offset:12800
    ds_read_b64_tr_b16 a[16:17], v166 offset:16384
    ds_read_b64_tr_b16 a[18:19], v166 offset:16896
    ds_read_b64_tr_b16 a[20:21], v166 offset:20480
    ds_read_b64_tr_b16 a[22:23], v166 offset:20992
    ds_read_b64_tr_b16 a[24:25], v166 offset:24576
    ds_read_b64_tr_b16 a[26:27], v166 offset:25088
    ds_read_b64_tr_b16 a[28:29], v166 offset:28672
    ds_read_b64_tr_b16 a[30:31], v166 offset:29184
    ds_read_b64_tr_b16 a[32:33], v166 offset:32768
    ds_read_b64_tr_b16 a[34:35], v166 offset:33280
    ds_read_b64_tr_b16 a[36:37], v166 offset:36864
    ds_read_b64_tr_b16 a[38:39], v166 offset:37376
    s_waitcnt lgkmcnt(0)
    s_barrier
    s_waitcnt vmcnt(10)
    s_barrier
    ds_read_b64_tr_b16 a[40:41], v167 offset:0
    ds_read_b64_tr_b16 a[42:43], v167 offset:512
    ds_read_b64_tr_b16 a[44:45], v167 offset:4096
    ds_read_b64_tr_b16 a[46:47], v167 offset:4608
    ds_read_b64_tr_b16 a[48:49], v167 offset:8192
    ds_read_b64_tr_b16 a[50:51], v167 offset:8704
    ds_read_b64_tr_b16 a[52:53], v167 offset:12288
    ds_read_b64_tr_b16 a[54:55], v167 offset:12800
    ds_read_b64_tr_b16 a[56:57], v167 offset:16384
    ds_read_b64_tr_b16 a[58:59], v167 offset:16896
    ds_read_b64_tr_b16 a[60:61], v167 offset:20480
    ds_read_b64_tr_b16 a[62:63], v167 offset:20992
    ds_read_b64_tr_b16 a[64:65], v167 offset:24576
    ds_read_b64_tr_b16 a[66:67], v167 offset:25088
    ds_read_b64_tr_b16 a[68:69], v167 offset:28672
    ds_read_b64_tr_b16 a[70:71], v167 offset:29184
    ds_read_b64_tr_b16 a[72:73], v167 offset:32768
    ds_read_b64_tr_b16 a[74:75], v167 offset:33280
    ds_read_b64_tr_b16 a[76:77], v167 offset:36864
    ds_read_b64_tr_b16 a[78:79], v167 offset:37376
    s_waitcnt lgkmcnt(0)
    s_barrier
    s_mov_b32 s49, 40960
    s_mov_b32 s47, 40960
    s_add_u32 s45, s38, 221184
    s_add_u32 s50, s45, 49152
    s_add_u32 s51, s45, 98304
    v_add_u32 v34, 0, v27
    s_mov_b32 s46, 40960
    ds_read_b128 v[116:119], v11 offset:0
    ds_read_b128 v[120:123], v11 offset:2048
    ds_read_b128 v[124:127], v12 offset:0
    ds_read_b128 v[128:131], v12 offset:2048
    s_waitcnt lgkmcnt(2)
    v_mfma_f32_16x16x32_bf16 v[140:143], a[160:163], v[116:119], 0
    ds_read_b128 v[132:135], v11 offset:4096
    v_mfma_f32_16x16x32_bf16 v[144:147], a[160:163], v[120:123], 0
    ds_read_b128 v[136:139], v11 offset:6144
    v_mfma_f32_16x16x32_bf16 v[148:151], a[80:83], v[116:119], 0
    v_mfma_f32_16x16x32_bf16 v[152:155], a[80:83], v[120:123], 0
    v_mfma_f32_16x16x32_bf16 v[156:159], a[0:3], v[116:119], 0
    v_mfma_f32_16x16x32_bf16 v[160:163], a[0:3], v[120:123], 0
    s_waitcnt lgkmcnt(2)
    v_mfma_f32_16x16x32_bf16 v[140:143], a[164:167], v[124:127], v[140:143]
    ds_read_b128 v[116:119], v12 offset:4096
    v_mfma_f32_16x16x32_bf16 v[144:147], a[164:167], v[128:131], v[144:147]
    ds_read_b128 v[120:123], v12 offset:6144
    v_mfma_f32_16x16x32_bf16 v[148:151], a[84:87], v[124:127], v[148:151]
    v_mfma_f32_16x16x32_bf16 v[152:155], a[84:87], v[128:131], v[152:155]
    v_mfma_f32_16x16x32_bf16 v[156:159], a[4:7], v[124:127], v[156:159]
    v_mfma_f32_16x16x32_bf16 v[160:163], a[4:7], v[128:131], v[160:163]
    s_waitcnt lgkmcnt(2)
    v_mfma_f32_16x16x32_bf16 v[140:143], a[168:171], v[132:135], v[140:143]
    ds_read_b128 v[124:127], v11 offset:8192
    v_mfma_f32_16x16x32_bf16 v[144:147], a[168:171], v[136:139], v[144:147]
    ds_read_b128 v[128:131], v11 offset:10240
    v_mfma_f32_16x16x32_bf16 v[148:151], a[88:91], v[132:135], v[148:151]
    v_mfma_f32_16x16x32_bf16 v[152:155], a[88:91], v[136:139], v[152:155]
    v_mfma_f32_16x16x32_bf16 v[156:159], a[8:11], v[132:135], v[156:159]
    v_mfma_f32_16x16x32_bf16 v[160:163], a[8:11], v[136:139], v[160:163]
    s_waitcnt lgkmcnt(2)
    v_mfma_f32_16x16x32_bf16 v[140:143], a[172:175], v[116:119], v[140:143]
    ds_read_b128 v[132:135], v12 offset:8192
    v_mfma_f32_16x16x32_bf16 v[144:147], a[172:175], v[120:123], v[144:147]
    ds_read_b128 v[136:139], v12 offset:10240
    v_mfma_f32_16x16x32_bf16 v[148:151], a[92:95], v[116:119], v[148:151]
    v_mfma_f32_16x16x32_bf16 v[152:155], a[92:95], v[120:123], v[152:155]
    v_mfma_f32_16x16x32_bf16 v[156:159], a[12:15], v[116:119], v[156:159]
    v_mfma_f32_16x16x32_bf16 v[160:163], a[12:15], v[120:123], v[160:163]
    s_waitcnt lgkmcnt(2)
    v_mfma_f32_16x16x32_bf16 v[140:143], a[176:179], v[124:127], v[140:143]
    ds_read_b128 v[116:119], v11 offset:12288
    v_mfma_f32_16x16x32_bf16 v[144:147], a[176:179], v[128:131], v[144:147]
    ds_read_b128 v[120:123], v11 offset:14336
    v_mfma_f32_16x16x32_bf16 v[148:151], a[96:99], v[124:127], v[148:151]
    v_mfma_f32_16x16x32_bf16 v[152:155], a[96:99], v[128:131], v[152:155]
    v_mfma_f32_16x16x32_bf16 v[156:159], a[16:19], v[124:127], v[156:159]
    v_mfma_f32_16x16x32_bf16 v[160:163], a[16:19], v[128:131], v[160:163]
    s_waitcnt lgkmcnt(2)
    v_mfma_f32_16x16x32_bf16 v[140:143], a[180:183], v[132:135], v[140:143]
    ds_read_b128 v[124:127], v12 offset:12288
    v_mfma_f32_16x16x32_bf16 v[144:147], a[180:183], v[136:139], v[144:147]
    ds_read_b128 v[128:131], v12 offset:14336
    v_mfma_f32_16x16x32_bf16 v[148:151], a[100:103], v[132:135], v[148:151]
    v_mfma_f32_16x16x32_bf16 v[152:155], a[100:103], v[136:139], v[152:155]
    v_mfma_f32_16x16x32_bf16 v[156:159], a[20:23], v[132:135], v[156:159]
    v_mfma_f32_16x16x32_bf16 v[160:163], a[20:23], v[136:139], v[160:163]
    s_waitcnt lgkmcnt(2)
    v_mfma_f32_16x16x32_bf16 v[140:143], a[184:187], v[116:119], v[140:143]
    ds_read_b128 v[132:135], v11 offset:16384
    v_mfma_f32_16x16x32_bf16 v[144:147], a[184:187], v[120:123], v[144:147]
    ds_read_b128 v[136:139], v11 offset:18432
    v_mfma_f32_16x16x32_bf16 v[148:151], a[104:107], v[116:119], v[148:151]
    v_mfma_f32_16x16x32_bf16 v[152:155], a[104:107], v[120:123], v[152:155]
    v_mfma_f32_16x16x32_bf16 v[156:159], a[24:27], v[116:119], v[156:159]
    v_mfma_f32_16x16x32_bf16 v[160:163], a[24:27], v[120:123], v[160:163]
    s_waitcnt lgkmcnt(2)
    v_mfma_f32_16x16x32_bf16 v[140:143], a[188:191], v[124:127], v[140:143]
    ds_read_b128 v[116:119], v12 offset:16384
    v_mfma_f32_16x16x32_bf16 v[144:147], a[188:191], v[128:131], v[144:147]
    ds_read_b128 v[120:123], v12 offset:18432
    v_mfma_f32_16x16x32_bf16 v[148:151], a[108:111], v[124:127], v[148:151]
    v_mfma_f32_16x16x32_bf16 v[152:155], a[108:111], v[128:131], v[152:155]
    v_mfma_f32_16x16x32_bf16 v[156:159], a[28:31], v[124:127], v[156:159]
    v_mfma_f32_16x16x32_bf16 v[160:163], a[28:31], v[128:131], v[160:163]
    s_waitcnt lgkmcnt(2)
    v_mfma_f32_16x16x32_bf16 v[140:143], a[192:195], v[132:135], v[140:143]
    ds_read_b128 v[124:127], v11 offset:20480
    v_mfma_f32_16x16x32_bf16 v[144:147], a[192:195], v[136:139], v[144:147]
    ds_read_b128 v[128:131], v11 offset:22528
    v_mfma_f32_16x16x32_bf16 v[148:151], a[112:115], v[132:135], v[148:151]
    v_mfma_f32_16x16x32_bf16 v[152:155], a[112:115], v[136:139], v[152:155]
    v_mfma_f32_16x16x32_bf16 v[156:159], a[32:35], v[132:135], v[156:159]
    v_mfma_f32_16x16x32_bf16 v[160:163], a[32:35], v[136:139], v[160:163]
    s_waitcnt lgkmcnt(2)
    v_mfma_f32_16x16x32_bf16 v[140:143], a[196:199], v[116:119], v[140:143]
    ds_read_b128 v[132:135], v12 offset:20480
    v_mfma_f32_16x16x32_bf16 v[144:147], a[196:199], v[120:123], v[144:147]
    ds_read_b128 v[136:139], v12 offset:22528
    v_mfma_f32_16x16x32_bf16 v[148:151], a[116:119], v[116:119], v[148:151]
    v_mfma_f32_16x16x32_bf16 v[152:155], a[116:119], v[120:123], v[152:155]
    v_mfma_f32_16x16x32_bf16 v[156:159], a[36:39], v[116:119], v[156:159]
    v_mfma_f32_16x16x32_bf16 v[160:163], a[36:39], v[120:123], v[160:163]
    s_waitcnt lgkmcnt(2)
    v_mfma_f32_16x16x32_bf16 v[140:143], a[200:203], v[124:127], v[140:143]
    ds_read_b128 v[116:119], v11 offset:24576
    v_mfma_f32_16x16x32_bf16 v[144:147], a[200:203], v[128:131], v[144:147]
    ds_read_b128 v[120:123], v11 offset:26624
    v_mfma_f32_16x16x32_bf16 v[148:151], a[120:123], v[124:127], v[148:151]
    v_mfma_f32_16x16x32_bf16 v[152:155], a[120:123], v[128:131], v[152:155]
    v_mfma_f32_16x16x32_bf16 v[156:159], a[40:43], v[124:127], v[156:159]
    v_mfma_f32_16x16x32_bf16 v[160:163], a[40:43], v[128:131], v[160:163]
    s_waitcnt lgkmcnt(2)
    v_mfma_f32_16x16x32_bf16 v[140:143], a[204:207], v[132:135], v[140:143]
    ds_read_b128 v[124:127], v12 offset:24576
    v_mfma_f32_16x16x32_bf16 v[144:147], a[204:207], v[136:139], v[144:147]
    ds_read_b128 v[128:131], v12 offset:26624
    v_mfma_f32_16x16x32_bf16 v[148:151], a[124:127], v[132:135], v[148:151]
    v_mfma_f32_16x16x32_bf16 v[152:155], a[124:127], v[136:139], v[152:155]
    v_mfma_f32_16x16x32_bf16 v[156:159], a[44:47], v[132:135], v[156:159]
    v_mfma_f32_16x16x32_bf16 v[160:163], a[44:47], v[136:139], v[160:163]
    s_waitcnt lgkmcnt(2)
    v_mfma_f32_16x16x32_bf16 v[140:143], a[208:211], v[116:119], v[140:143]
    ds_read_b128 v[132:135], v11 offset:28672
    v_mfma_f32_16x16x32_bf16 v[144:147], a[208:211], v[120:123], v[144:147]
    ds_read_b128 v[136:139], v11 offset:30720
    v_mfma_f32_16x16x32_bf16 v[148:151], a[128:131], v[116:119], v[148:151]
    v_mfma_f32_16x16x32_bf16 v[152:155], a[128:131], v[120:123], v[152:155]
    v_mfma_f32_16x16x32_bf16 v[156:159], a[48:51], v[116:119], v[156:159]
    v_mfma_f32_16x16x32_bf16 v[160:163], a[48:51], v[120:123], v[160:163]
    s_waitcnt lgkmcnt(2)
    v_mfma_f32_16x16x32_bf16 v[140:143], a[212:215], v[124:127], v[140:143]
    ds_read_b128 v[116:119], v12 offset:28672
    v_mfma_f32_16x16x32_bf16 v[144:147], a[212:215], v[128:131], v[144:147]
    ds_read_b128 v[120:123], v12 offset:30720
    v_mfma_f32_16x16x32_bf16 v[148:151], a[132:135], v[124:127], v[148:151]
    v_mfma_f32_16x16x32_bf16 v[152:155], a[132:135], v[128:131], v[152:155]
    v_mfma_f32_16x16x32_bf16 v[156:159], a[52:55], v[124:127], v[156:159]
    v_mfma_f32_16x16x32_bf16 v[160:163], a[52:55], v[128:131], v[160:163]
    s_waitcnt lgkmcnt(2)
    v_mfma_f32_16x16x32_bf16 v[140:143], a[216:219], v[132:135], v[140:143]
    ds_read_b128 v[124:127], v11 offset:32768
    v_mfma_f32_16x16x32_bf16 v[144:147], a[216:219], v[136:139], v[144:147]
    ds_read_b128 v[128:131], v11 offset:34816
    v_mfma_f32_16x16x32_bf16 v[148:151], a[136:139], v[132:135], v[148:151]
    v_mfma_f32_16x16x32_bf16 v[152:155], a[136:139], v[136:139], v[152:155]
    v_mfma_f32_16x16x32_bf16 v[156:159], a[56:59], v[132:135], v[156:159]
    v_mfma_f32_16x16x32_bf16 v[160:163], a[56:59], v[136:139], v[160:163]
    s_waitcnt lgkmcnt(2)
    v_mfma_f32_16x16x32_bf16 v[140:143], a[220:223], v[116:119], v[140:143]
    ds_read_b128 v[132:135], v12 offset:32768
    v_mfma_f32_16x16x32_bf16 v[144:147], a[220:223], v[120:123], v[144:147]
    ds_read_b128 v[136:139], v12 offset:34816
    v_mfma_f32_16x16x32_bf16 v[148:151], a[140:143], v[116:119], v[148:151]
    v_mfma_f32_16x16x32_bf16 v[152:155], a[140:143], v[120:123], v[152:155]
    v_mfma_f32_16x16x32_bf16 v[156:159], a[60:63], v[116:119], v[156:159]
    v_mfma_f32_16x16x32_bf16 v[160:163], a[60:63], v[120:123], v[160:163]
    s_waitcnt lgkmcnt(2)
    v_mfma_f32_16x16x32_bf16 v[140:143], a[224:227], v[124:127], v[140:143]
    ds_read_b128 v[116:119], v11 offset:36864
    v_mfma_f32_16x16x32_bf16 v[144:147], a[224:227], v[128:131], v[144:147]
    ds_read_b128 v[120:123], v11 offset:38912
    v_mfma_f32_16x16x32_bf16 v[148:151], a[144:147], v[124:127], v[148:151]
    v_mfma_f32_16x16x32_bf16 v[152:155], a[144:147], v[128:131], v[152:155]
    v_mfma_f32_16x16x32_bf16 v[156:159], a[64:67], v[124:127], v[156:159]
    v_mfma_f32_16x16x32_bf16 v[160:163], a[64:67], v[128:131], v[160:163]
    s_waitcnt lgkmcnt(2)
    v_mfma_f32_16x16x32_bf16 v[140:143], a[228:231], v[132:135], v[140:143]
    ds_read_b128 v[124:127], v12 offset:36864
    v_mfma_f32_16x16x32_bf16 v[144:147], a[228:231], v[136:139], v[144:147]
    ds_read_b128 v[128:131], v12 offset:38912
    v_mfma_f32_16x16x32_bf16 v[148:151], a[148:151], v[132:135], v[148:151]
    v_mfma_f32_16x16x32_bf16 v[152:155], a[148:151], v[136:139], v[152:155]
    v_mfma_f32_16x16x32_bf16 v[156:159], a[68:71], v[132:135], v[156:159]
    v_mfma_f32_16x16x32_bf16 v[160:163], a[68:71], v[136:139], v[160:163]
    s_waitcnt lgkmcnt(0)
    v_mfma_f32_16x16x32_bf16 v[140:143], a[232:235], v[116:119], v[140:143]
    v_mfma_f32_16x16x32_bf16 v[144:147], a[232:235], v[120:123], v[144:147]
    v_mfma_f32_16x16x32_bf16 v[140:143], a[236:239], v[124:127], v[140:143]
    v_mfma_f32_16x16x32_bf16 v[144:147], a[236:239], v[128:131], v[144:147]
    v_mfma_f32_16x16x32_bf16 v[148:151], a[152:155], v[116:119], v[148:151]
    v_add_u32 v11, s49, v11
    v_add_u32 v12, s49, v12
    v_mfma_f32_16x16x32_bf16 v[152:155], a[152:155], v[120:123], v[152:155]
    s_sub_u32 s47, s47, s49
    s_sub_u32 s49, 0, s49
    v_mfma_f32_16x16x32_bf16 v[148:151], a[156:159], v[124:127], v[148:151]
    v_mfma_f32_16x16x32_bf16 v[152:155], a[156:159], v[128:131], v[152:155]
    v_mfma_f32_16x16x32_bf16 v[156:159], a[72:75], v[116:119], v[156:159]
    v_cvt_pk_bf16_f32 v164, v140, v141
    v_cvt_pk_bf16_f32 v165, v142, v143
    v_mfma_f32_16x16x32_bf16 v[160:163], a[72:75], v[120:123], v[160:163]
    v_cvt_pk_bf16_f32 v166, v144, v145
    v_cvt_pk_bf16_f32 v167, v146, v147
    v_mfma_f32_16x16x32_bf16 v[156:159], a[76:79], v[124:127], v[156:159]
    v_permlane16_swap_b32 v164, v166
    v_permlane16_swap_b32 v165, v167
    v_mfma_f32_16x16x32_bf16 v[160:163], a[76:79], v[128:131], v[160:163]
    v_cvt_pk_bf16_f32 v168, v148, v149
    v_cvt_pk_bf16_f32 v169, v150, v151
    v_cvt_pk_bf16_f32 v170, v152, v153
    v_cvt_pk_bf16_f32 v171, v154, v155
    s_nop 0
    v_permlane16_swap_b32 v168, v170
    v_permlane16_swap_b32 v169, v171
    ds_write_b128 v34, v[168:171]
    v_cvt_pk_bf16_f32 v172, v156, v157
    v_cvt_pk_bf16_f32 v173, v158, v159
    v_cvt_pk_bf16_f32 v174, v160, v161
    v_cvt_pk_bf16_f32 v175, v162, v163
    s_nop 0
    v_permlane16_swap_b32 v172, v174
    v_permlane16_swap_b32 v173, v175
    buffer_store_dwordx4 v[164:167], v29, s[4:7], s51 offen
    buffer_store_dwordx4 v[168:171], v29, s[4:7], s50 offen
    buffer_store_dwordx4 v[172:175], v29, s[4:7], s45 offen
    v_mov_b32 v1, 192
L_gw_1:
    buffer_load_dword v2, v1, s[8:11], 0 offen sc1
    s_sub_u32 s36, s36, 1
    s_cbranch_scc1 L_exit
    s_waitcnt vmcnt(0)
    v_readfirstlane_b32 s90, v2
    s_nop 0
    s_cmp_eq_u32 s90, 0
    s_cbranch_scc1 L_gw_1
    s_cmp_lg_u32 s90, 1
    s_cbranch_scc1 L_slow
    v_mov_b32 v32, 1
    buffer_store_dword v32, v30, s[4:7], s38 offen
    s_waitcnt lgkmcnt(0)
    s_barrier
    s_add_u32 s45, s38, 393216
    s_add_u32 s50, s45, 49152
    s_add_u32 s51, s45, 98304
    v_add_u32 v34, 4096, v27
    s_mov_b32 s46, 81920
    ds_read_b128 v[116:119], v11 offset:0
    ds_read_b128 v[120:123], v11 offset:2048
    ds_read_b128 v[124:127], v12 offset:0
    ds_read_b128 v[128:131], v12 offset:2048
    s_lshl_b32 s90, s32, 10
    s_add_u32 m0, s90, s47
    s_waitcnt lgkmcnt(2)
    v_mfma_f32_16x16x32_bf16 v[140:143], a[160:163], v[116:119], 0
    ds_read_b128 v[132:135], v11 offset:4096
    v_mfma_f32_16x16x32_bf16 v[144:147], a[160:163], v[120:123], 0
    ds_read_b128 v[136:139], v11 offset:6144
    v_mfma_f32_16x16x32_bf16 v[148:151], a[80:83], v[116:119], 0
    buffer_load_dwordx4 v10, s[24:27], s46 offen offset:0 lds
    s_add_u32 m0, m0, 3968
    v_mfma_f32_16x16x32_bf16 v[152:155], a[80:83], v[120:123], 0
    v_mfma_f32_16x16x32_bf16 v[156:159], a[0:3], v[116:119], 0
    buffer_load_dwordx4 v10, s[24:27], s46 offen offset:128 lds
    s_add_u32 m0, m0, 3968
    v_mfma_f32_16x16x32_bf16 v[160:163], a[0:3], v[120:123], 0
    s_waitcnt lgkmcnt(2)
    v_mfma_f32_16x16x32_bf16 v[140:143], a[164:167], v[124:127], v[140:143]
    ds_read_b128 v[116:119], v12 offset:4096
    v_mfma_f32_16x16x32_bf16 v[144:147], a[164:167], v[128:131], v[144:147]
    ds_read_b128 v[120:123], v12 offset:6144
    v_mfma_f32_16x16x32_bf16 v[148:151], a[84:87], v[124:127], v[148:151]
    buffer_load_dwordx4 v10, s[24:27], s46 offen offset:256 lds
    s_add_u32 m0, m0, 3968
    v_mfma_f32_16x16x32_bf16 v[152:155], a[84:87], v[128:131], v[152:155]
    v_mfma_f32_16x16x32_bf16 v[156:159], a[4:7], v[124:127], v[156:159]
    buffer_load_dwordx4 v10, s[24:27], s46 offen offset:384 lds
    s_add_u32 m0, m0, 3968
    v_mfma_f32_16x16x32_bf16 v[160:163], a[4:7], v[128:131], v[160:163]
    s_waitcnt lgkmcnt(2)
    v_mfma_f32_16x16x32_bf16 v[140:143], a[168:171], v[132:135], v[140:143]
    ds_read_b128 v[124:127], v11 offset:8192
    v_mfma_f32_16x16x32_bf16 v[144:147], a[168:171], v[136:139], v[144:147]
    ds_read_b128 v[128:131], v11 offset:10240
    v_mfma_f32_16x16x32_bf16 v[148:151], a[88:91], v[132:135], v[148:151]
    buffer_load_dwordx4 v10, s[24:27], s46 offen offset:512 lds
    s_add_u32 m0, m0, 3968
    v_mfma_f32_16x16x32_bf16 v[152:155], a[88:91], v[136:139], v[152:155]
    v_mfma_f32_16x16x32_bf16 v[156:159], a[8:11], v[132:135], v[156:159]
    buffer_load_dwordx4 v10, s[24:27], s46 offen offset:640 lds
    s_add_u32 m0, m0, 3968
    v_mfma_f32_16x16x32_bf16 v[160:163], a[8:11], v[136:139], v[160:163]
    s_waitcnt lgkmcnt(2)
    v_mfma_f32_16x16x32_bf16 v[140:143], a[172:175], v[116:119], v[140:143]
    ds_read_b128 v[132:135], v12 offset:8192
    v_mfma_f32_16x16x32_bf16 v[144:147], a[172:175], v[120:123], v[144:147]
    ds_read_b128 v[136:139], v12 offset:10240
    v_mfma_f32_16x16x32_bf16 v[148:151], a[92:95], v[116:119], v[148:151]
    buffer_load_dwordx4 v10, s[24:27], s46 offen offset:768 lds
    s_add_u32 m0, m0, 3968
    v_mfma_f32_16x16x32_bf16 v[152:155], a[92:95], v[120:123], v[152:155]
    v_mfma_f32_16x16x32_bf16 v[156:159], a[12:15], v[116:119], v[156:159]
    buffer_load_dwordx4 v10, s[24:27], s46 offen offset:896 lds
    s_add_u32 m0, m0, 3968
    v_mfma_f32_16x16x32_bf16 v[160:163], a[12:15], v[120:123], v[160:163]
    s_waitcnt lgkmcnt(2)
    v_mfma_f32_16x16x32_bf16 v[140:143], a[176:179], v[124:127], v[140:143]
    ds_read_b128 v[116:119], v11 offset:12288
    v_mfma_f32_16x16x32_bf16 v[144:147], a[176:179], v[128:131], v[144:147]
    ds_read_b128 v[120:123], v11 offset:14336
    v_mfma_f32_16x16x32_bf16 v[148:151], a[96:99], v[124:127], v[148:151]
    buffer_load_dwordx4 v10, s[24:27], s46 offen offset:1024 lds
    s_add_u32 m0, m0, 3968
    v_mfma_f32_16x16x32_bf16 v[152:155], a[96:99], v[128:131], v[152:155]
    v_mfma_f32_16x16x32_bf16 v[156:159], a[16:19], v[124:127], v[156:159]
    buffer_load_dwordx4 v10, s[24:27], s46 offen offset:1152 lds
    v_mfma_f32_16x16x32_bf16 v[160:163], a[16:19], v[128:131], v[160:163]
    s_waitcnt lgkmcnt(2)
    v_mfma_f32_16x16x32_bf16 v[140:143], a[180:183], v[132:135], v[140:143]
    ds_read_b128 v[124:127], v12 offset:12288
    v_mfma_f32_16x16x32_bf16 v[144:147], a[180:183], v[136:139], v[144:147]
    ds_read_b128 v[128:131], v12 offset:14336
    v_mfma_f32_16x16x32_bf16 v[148:151], a[100:103], v[132:135], v[148:151]
    v_mfma_f32_16x16x32_bf16 v[152:155], a[100:103], v[136:139], v[152:155]
    v_mfma_f32_16x16x32_bf16 v[156:159], a[20:23], v[132:135], v[156:159]
    v_mfma_f32_16x16x32_bf16 v[160:163], a[20:23], v[136:139], v[160:163]
    s_waitcnt lgkmcnt(2)
    v_mfma_f32_16x16x32_bf16 v[140:143], a[184:187], v[116:119], v[140:143]
    ds_read_b128 v[132:135], v11 offset:16384
    v_mfma_f32_16x16x32_bf16 v[144:147], a[184:187], v[120:123], v[144:147]
    ds_read_b128 v[136:139], v11 offset:18432
    v_mfma_f32_16x16x32_bf16 v[148:151], a[104:107], v[116:119], v[148:151]
    v_mfma_f32_16x16x32_bf16 v[152:155], a[104:107], v[120:123], v[152:155]
    v_mfma_f32_16x16x32_bf16 v[156:159], a[24:27], v[116:119], v[156:159]
    v_mfma_f32_16x16x32_bf16 v[160:163], a[24:27], v[120:123], v[160:163]
    s_waitcnt lgkmcnt(2)
    v_mfma_f32_16x16x32_bf16 v[140:143], a[188:191], v[124:127], v[140:143]
    ds_read_b128 v[116:119], v12 offset:16384
    v_mfma_f32_16x16x32_bf16 v[144:147], a[188:191], v[128:131], v[144:147]
    ds_read_b128 v[120:123], v12 offset:18432
    v_mfma_f32_16x16x32_bf16 v[148:151], a[108:111], v[124:127], v[148:151]
    v_mfma_f32_16x16x32_bf16 v[152:155], a[108:111], v[128:131], v[152:155]
    v_mfma_f32_16x16x32_bf16 v[156:159], a[28:31], v[124:127], v[156:159]
    v_mfma_f32_16x16x32_bf16 v[160:163], a[28:31], v[128:131], v[160:163]
    s_waitcnt lgkmcnt(2)
    v_mfma_f32_16x16x32_bf16 v[140:143], a[192:195], v[132:135], v[140:143]
    ds_read_b128 v[124:127], v11 offset:20480
    v_mfma_f32_16x16x32_bf16 v[144:147], a[192:195], v[136:139], v[144:147]
    ds_read_b128 v[128:131], v11 offset:22528
    v_mfma_f32_16x16x32_bf16 v[148:151], a[112:115], v[132:135], v[148:151]
    v_mfma_f32_16x16x32_bf16 v[152:155], a[112:115], v[136:139], v[152:155]
    v_mfma_f32_16x16x32_bf16 v[156:159], a[32:35], v[132:135], v[156:159]
    v_mfma_f32_16x16x32_bf16 v[160:163], a[32:35], v[136:139], v[160:163]
    s_waitcnt lgkmcnt(2)
    v_mfma_f32_16x16x32_bf16 v[140:143], a[196:199], v[116:119], v[140:143]
    ds_read_b128 v[132:135], v12 offset:20480
    v_mfma_f32_16x16x32_bf16 v[144:147], a[196:199], v[120:123], v[144:147]
    ds_read_b128 v[136:139], v12 offset:22528
    v_mfma_f32_16x16x32_bf16 v[148:151], a[116:119], v[116:119], v[148:151]
    v_mfma_f32_16x16x32_bf16 v[152:155], a[116:119], v[120:123], v[152:155]
    v_mfma_f32_16x16x32_bf16 v[156:159], a[36:39], v[116:119], v[156:159]
    v_mfma_f32_16x16x32_bf16 v[160:163], a[36:39], v[120:123], v[160:163]
    s_waitcnt lgkmcnt(2)
    v_mfma_f32_16x16x32_bf16 v[140:143], a[200:203], v[124:127], v[140:143]
    ds_read_b128 v[116:119], v11 offset:24576
    v_mfma_f32_16x16x32_bf16 v[144:147], a[200:203], v[128:131], v[144:147]
    ds_read_b128 v[120:123], v11 offset:26624
    v_mfma_f32_16x16x32_bf16 v[148:151], a[120:123], v[124:127], v[148:151]
    v_mfma_f32_16x16x32_bf16 v[152:155], a[120:123], v[128:131], v[152:155]
    v_mfma_f32_16x16x32_bf16 v[156:159], a[40:43], v[124:127], v[156:159]
    v_mfma_f32_16x16x32_bf16 v[160:163], a[40:43], v[128:131], v[160:163]
    s_waitcnt lgkmcnt(2)
    v_mfma_f32_16x16x32_bf16 v[140:143], a[204:207], v[132:135], v[140:143]
    ds_read_b128 v[124:127], v12 offset:24576
    v_mfma_f32_16x16x32_bf16 v[144:147], a[204:207], v[136:139], v[144:147]
    ds_read_b128 v[128:131], v12 offset:26624
    v_mfma_f32_16x16x32_bf16 v[148:151], a[124:127], v[132:135], v[148:151]
    v_mfma_f32_16x16x32_bf16 v[152:155], a[124:127], v[136:139], v[152:155]
    v_mfma_f32_16x16x32_bf16 v[156:159], a[44:47], v[132:135], v[156:159]
    v_mfma_f32_16x16x32_bf16 v[160:163], a[44:47], v[136:139], v[160:163]
    s_waitcnt lgkmcnt(2)
    v_mfma_f32_16x16x32_bf16 v[140:143], a[208:211], v[116:119], v[140:143]
    ds_read_b128 v[132:135], v11 offset:28672
    v_mfma_f32_16x16x32_bf16 v[144:147], a[208:211], v[120:123], v[144:147]
    ds_read_b128 v[136:139], v11 offset:30720
    v_mfma_f32_16x16x32_bf16 v[148:151], a[128:131], v[116:119], v[148:151]
    v_mfma_f32_16x16x32_bf16 v[152:155], a[128:131], v[120:123], v[152:155]
    v_mfma_f32_16x16x32_bf16 v[156:159], a[48:51], v[116:119], v[156:159]
    v_mfma_f32_16x16x32_bf16 v[160:163], a[48:51], v[120:123], v[160:163]
    s_waitcnt lgkmcnt(2)
    v_mfma_f32_16x16x32_bf16 v[140:143], a[212:215], v[124:127], v[140:143]
    ds_read_b128 v[116:119], v12 offset:28672
    v_mfma_f32_16x16x32_bf16 v[144:147], a[212:215], v[128:131], v[144:147]
    ds_read_b128 v[120:123], v12 offset:30720
    v_mfma_f32_16x16x32_bf16 v[148:151], a[132:135], v[124:127], v[148:151]
    v_mfma_f32_16x16x32_bf16 v[152:155], a[132:135], v[128:131], v[152:155]
    v_mfma_f32_16x16x32_bf16 v[156:159], a[52:55], v[124:127], v[156:159]
    v_mfma_f32_16x16x32_bf16 v[160:163], a[52:55], v[128:131], v[160:163]
    s_waitcnt lgkmcnt(2)
    v_mfma_f32_16x16x32_bf16 v[140:143], a[216:219], v[132:135], v[140:143]
    ds_read_b128 v[124:127], v11 offset:32768
    v_mfma_f32_16x16x32_bf16 v[144:147], a[216:219], v[136:139], v[144:147]
    ds_read_b128 v[128:131], v11 offset:34816
    v_mfma_f32_16x16x32_bf16 v[148:151], a[136:139], v[132:135], v[148:151]
    v_mfma_f32_16x16x32_bf16 v[152:155], a[136:139], v[136:139], v[152:155]
    v_mfma_f32_16x16x32_bf16 v[156:159], a[56:59], v[132:135], v[156:159]
    v_mfma_f32_16x16x32_bf16 v[160:163], a[56:59], v[136:139], v[160:163]
    s_waitcnt lgkmcnt(2)
    v_mfma_f32_16x16x32_bf16 v[140:143], a[220:223], v[116:119], v[140:143]
    ds_read_b128 v[132:135], v12 offset:32768
    v_mfma_f32_16x16x32_bf16 v[144:147], a[220:223], v[120:123], v[144:147]
    ds_read_b128 v[136:139], v12 offset:34816
    v_mfma_f32_16x16x32_bf16 v[148:151], a[140:143], v[116:119], v[148:151]
    v_mfma_f32_16x16x32_bf16 v[152:155], a[140:143], v[120:123], v[152:155]
    v_mfma_f32_16x16x32_bf16 v[156:159], a[60:63], v[116:119], v[156:159]
    v_mfma_f32_16x16x32_bf16 v[160:163], a[60:63], v[120:123], v[160:163]
    s_waitcnt lgkmcnt(2)
    v_mfma_f32_16x16x32_bf16 v[140:143], a[224:227], v[124:127], v[140:143]
    ds_read_b128 v[116:119], v11 offset:36864
    v_mfma_f32_16x16x32_bf16 v[144:147], a[224:227], v[128:131], v[144:147]
    ds_read_b128 v[120:123], v11 offset:38912
    v_mfma_f32_16x16x32_bf16 v[148:151], a[144:147], v[124:127], v[148:151]
    v_mfma_f32_16x16x32_bf16 v[152:155], a[144:147], v[128:131], v[152:155]
    v_mfma_f32_16x16x32_bf16 v[156:159], a[64:67], v[124:127], v[156:159]
    v_mfma_f32_16x16x32_bf16 v[160:163], a[64:67], v[128:131], v[160:163]
    s_waitcnt lgkmcnt(2)
    v_mfma_f32_16x16x32_bf16 v[140:143], a[228:231], v[132:135], v[140:143]
    ds_read_b128 v[124:127], v12 offset:36864
    v_mfma_f32_16x16x32_bf16 v[144:147], a[228:231], v[136:139], v[144:147]
    ds_read_b128 v[128:131], v12 offset:38912
    v_mfma_f32_16x16x32_bf16 v[148:151], a[148:151], v[132:135], v[148:151]
    v_mfma_f32_16x16x32_bf16 v[152:155], a[148:151], v[136:139], v[152:155]
    v_mfma_f32_16x16x32_bf16 v[156:159], a[68:71], v[132:135], v[156:159]
    v_mfma_f32_16x16x32_bf16 v[160:163], a[68:71], v[136:139], v[160:163]
    s_waitcnt lgkmcnt(0)
    v_mfma_f32_16x16x32_bf16 v[140:143], a[232:235], v[116:119], v[140:143]
    v_mfma_f32_16x16x32_bf16 v[144:147], a[232:235], v[120:123], v[144:147]
    v_mfma_f32_16x16x32_bf16 v[140:143], a[236:239], v[124:127], v[140:143]
    v_mfma_f32_16x16x32_bf16 v[144:147], a[236:239], v[128:131], v[144:147]
    v_mfma_f32_16x16x32_bf16 v[148:151], a[152:155], v[116:119], v[148:151]
    v_add_u32 v11, s49, v11
    v_add_u32 v12, s49, v12
    v_mfma_f32_16x16x32_bf16 v[152:155], a[152:155], v[120:123], v[152:155]
    s_sub_u32 s47, s47, s49
    s_sub_u32 s49, 0, s49
    v_mfma_f32_16x16x32_bf16 v[148:151], a[156:159], v[124:127], v[148:151]
    v_mfma_f32_16x16x32_bf16 v[152:155], a[156:159], v[128:131], v[152:155]
    v_mfma_f32_16x16x32_bf16 v[156:159], a[72:75], v[116:119], v[156:159]
    v_cvt_pk_bf16_f32 v164, v140, v141
    v_cvt_pk_bf16_f32 v165, v142, v143
    v_mfma_f32_16x16x32_bf16 v[160:163], a[72:75], v[120:123], v[160:163]
    v_cvt_pk_bf16_f32 v166, v144, v145
    v_cvt_pk_bf16_f32 v167, v146, v147
    v_mfma_f32_16x16x32_bf16 v[156:159], a[76:79], v[124:127], v[156:159]
    v_permlane16_swap_b32 v164, v166
    v_permlane16_swap_b32 v165, v167
    v_mfma_f32_16x16x32_bf16 v[160:163], a[76:79], v[128:131], v[160:163]
    v_cvt_pk_bf16_f32 v168, v148, v149
    v_cvt_pk_bf16_f32 v169, v150, v151
    v_cvt_pk_bf16_f32 v170, v152, v153
    v_cvt_pk_bf16_f32 v171, v154, v155
    s_nop 0
    v_permlane16_swap_b32 v168, v170
    v_permlane16_swap_b32 v169, v171
    ds_write_b128 v34, v[168:171]
    v_cvt_pk_bf16_f32 v172, v156, v157
    v_cvt_pk_bf16_f32 v173, v158, v159
    v_cvt_pk_bf16_f32 v174, v160, v161
    v_cvt_pk_bf16_f32 v175, v162, v163
    s_nop 0
    v_permlane16_swap_b32 v172, v174
    v_permlane16_swap_b32 v173, v175
    buffer_store_dwordx4 v[164:167], v29, s[4:7], s51 offen
    buffer_store_dwordx4 v[168:171], v29, s[4:7], s50 offen
    buffer_store_dwordx4 v[172:175], v29, s[4:7], s45 offen
    v_mov_b32 v3, 165376
L_pf_2:
    buffer_load_dword v4, v3, s[4:7], s38 offen sc1
    s_sub_u32 s36, s36, 1
    s_cbranch_scc1 L_exit
    s_waitcnt vmcnt(0) lgkmcnt(0)
    v_readfirstlane_b32 s90, v4
    s_nop 0
    s_cmp_eq_u32 s90, 0
    s_cbranch_scc1 L_pf_2
    v_mov_b32 v32, 2
    buffer_store_dword v32, v30, s[4:7], s38 offen
    s_barrier
    s_and_b32 s90, s90, 2
    s_lshl_b32 s90, s90, 12
    v_mov_b32 v3, s90
    v_add_u32 v6, 16384, v3
    v_mov_b32 v4, 32768
    v_lshrrev_b32 v2, 4, v0
    v_cmp_eq_u32 vcc, s34, v2
    s_nop 1
    v_cndmask_b32 v5, v6, v4, vcc
    v_add_u32 v223, v5, v214
    v_cndmask_b32 v5, v3, v4, vcc
    v_add_u32 v214, v5, v214
    v_add_u32 v2, 4, v2
    v_cmp_eq_u32 vcc, s34, v2
    s_nop 1
    v_cndmask_b32 v5, v6, v4, vcc
    v_add_u32 v224, v5, v215
    v_cndmask_b32 v5, v3, v4, vcc
    v_add_u32 v215, v5, v215
    s_mov_b32 s37, -1
    s_add_u32 s42, s38, 122880
    s_add_u32 s45, s38, 565248
    s_add_u32 s50, s45, 49152
    s_add_u32 s51, s45, 98304
    v_add_u32 v34, 8192, v27
    s_mov_b32 s46, 122880
    ds_read_b128 v[116:119], v11 offset:0
    ds_read_b128 v[120:123], v11 offset:2048
    ds_read_b128 v[124:127], v12 offset:0
    ds_read_b128 v[128:131], v12 offset:2048
    s_lshl_b32 s90, s32, 10
    s_add_u32 m0, s90, s47
    s_waitcnt lgkmcnt(2)
    v_mfma_f32_16x16x32_bf16 v[140:143], a[160:163], v[116:119], 0
    ds_read_b128 v[132:135], v11 offset:4096
    v_mfma_f32_16x16x32_bf16 v[144:147], a[160:163], v[120:123], 0
    ds_read_b128 v[136:139], v11 offset:6144
    v_mfma_f32_16x16x32_bf16 v[148:151], a[80:83], v[116:119], 0
    buffer_load_dwordx4 v10, s[24:27], s46 offen offset:0 lds
    s_add_u32 m0, m0, 3968
    v_mfma_f32_16x16x32_bf16 v[152:155], a[80:83], v[120:123], 0
    v_mfma_f32_16x16x32_bf16 v[156:159], a[0:3], v[116:119], 0
    buffer_load_dwordx4 v10, s[24:27], s46 offen offset:128 lds
    s_add_u32 m0, m0, 3968
    v_mfma_f32_16x16x32_bf16 v[160:163], a[0:3], v[120:123], 0
    s_waitcnt lgkmcnt(2)
    v_mfma_f32_16x16x32_bf16 v[140:143], a[164:167], v[124:127], v[140:143]
    ds_read_b128 v[116:119], v12 offset:4096
    v_mfma_f32_16x16x32_bf16 v[144:147], a[164:167], v[128:131], v[144:147]
    ds_read_b128 v[120:123], v12 offset:6144
    v_mfma_f32_16x16x32_bf16 v[148:151], a[84:87], v[124:127], v[148:151]
    buffer_load_dwordx4 v10, s[24:27], s46 offen offset:256 lds
    s_add_u32 m0, m0, 3968
    v_mfma_f32_16x16x32_bf16 v[152:155], a[84:87], v[128:131], v[152:155]
    v_mfma_f32_16x16x32_bf16 v[156:159], a[4:7], v[124:127], v[156:159]
    buffer_load_dwordx4 v10, s[24:27], s46 offen offset:384 lds
    s_add_u32 m0, m0, 3968
    v_mfma_f32_16x16x32_bf16 v[160:163], a[4:7], v[128:131], v[160:163]
    s_waitcnt lgkmcnt(2)
    v_mfma_f32_16x16x32_bf16 v[140:143], a[168:171], v[132:135], v[140:143]
    ds_read_b128 v[124:127], v11 offset:8192
    v_mfma_f32_16x16x32_bf16 v[144:147], a[168:171], v[136:139], v[144:147]
    ds_read_b128 v[128:131], v11 offset:10240
    v_mfma_f32_16x16x32_bf16 v[148:151], a[88:91], v[132:135], v[148:151]
    buffer_load_dwordx4 v10, s[24:27], s46 offen offset:512 lds
    s_add_u32 m0, m0, 3968
    v_mfma_f32_16x16x32_bf16 v[152:155], a[88:91], v[136:139], v[152:155]
    v_mfma_f32_16x16x32_bf16 v[156:159], a[8:11], v[132:135], v[156:159]
    buffer_load_dwordx4 v10, s[24:27], s46 offen offset:640 lds
    s_add_u32 m0, m0, 3968
    v_mfma_f32_16x16x32_bf16 v[160:163], a[8:11], v[136:139], v[160:163]
    s_waitcnt lgkmcnt(2)
    v_mfma_f32_16x16x32_bf16 v[140:143], a[172:175], v[116:119], v[140:143]
    ds_read_b128 v[132:135], v12 offset:8192
    v_mfma_f32_16x16x32_bf16 v[144:147], a[172:175], v[120:123], v[144:147]
    ds_read_b128 v[136:139], v12 offset:10240
    v_mfma_f32_16x16x32_bf16 v[148:151], a[92:95], v[116:119], v[148:151]
    buffer_load_dwordx4 v10, s[24:27], s46 offen offset:768 lds
    s_add_u32 m0, m0, 3968
    v_mfma_f32_16x16x32_bf16 v[152:155], a[92:95], v[120:123], v[152:155]
    v_mfma_f32_16x16x32_bf16 v[156:159], a[12:15], v[116:119], v[156:159]
    buffer_load_dwordx4 v10, s[24:27], s46 offen offset:896 lds
    s_add_u32 m0, m0, 3968
    v_mfma_f32_16x16x32_bf16 v[160:163], a[12:15], v[120:123], v[160:163]
    s_waitcnt lgkmcnt(2)
    v_mfma_f32_16x16x32_bf16 v[140:143], a[176:179], v[124:127], v[140:143]
    ds_read_b128 v[116:119], v11 offset:12288
    v_mfma_f32_16x16x32_bf16 v[144:147], a[176:179], v[128:131], v[144:147]
    ds_read_b128 v[120:123], v11 offset:14336
    v_mfma_f32_16x16x32_bf16 v[148:151], a[96:99], v[124:127], v[148:151]
    buffer_load_dwordx4 v10, s[24:27], s46 offen offset:1024 lds
    s_add_u32 m0, m0, 3968
    v_mfma_f32_16x16x32_bf16 v[152:155], a[96:99], v[128:131], v[152:155]
    v_mfma_f32_16x16x32_bf16 v[156:159], a[16:19], v[124:127], v[156:159]
    buffer_load_dwordx4 v10, s[24:27], s46 offen offset:1152 lds
    v_mfma_f32_16x16x32_bf16 v[160:163], a[16:19], v[128:131], v[160:163]
    s_waitcnt lgkmcnt(2)
    v_mfma_f32_16x16x32_bf16 v[140:143], a[180:183], v[132:135], v[140:143]
    ds_read_b128 v[124:127], v12 offset:12288
    v_mfma_f32_16x16x32_bf16 v[144:147], a[180:183], v[136:139], v[144:147]
    ds_read_b128 v[128:131], v12 offset:14336
    v_mfma_f32_16x16x32_bf16 v[148:151], a[100:103], v[132:135], v[148:151]
    v_mfma_f32_16x16x32_bf16 v[152:155], a[100:103], v[136:139], v[152:155]
    v_mfma_f32_16x16x32_bf16 v[156:159], a[20:23], v[132:135], v[156:159]
    v_mfma_f32_16x16x32_bf16 v[160:163], a[20:23], v[136:139], v[160:163]
    s_waitcnt lgkmcnt(2)
    v_mfma_f32_16x16x32_bf16 v[140:143], a[184:187], v[116:119], v[140:143]
    ds_read_b128 v[132:135], v11 offset:16384
    s_and_b32 s52, s37, 3
    v_mfma_f32_16x16x32_bf16 v[144:147], a[184:187], v[120:123], v[144:147]
    ds_read_b128 v[136:139], v11 offset:18432
    s_mul_i32 s55, s52, 491520
    v_mfma_f32_16x16x32_bf16 v[148:151], a[104:107], v[116:119], v[148:151]
    s_add_u32 s37, s37, 1
    s_mov_b32 s43, s42
    v_mfma_f32_16x16x32_bf16 v[152:155], a[104:107], v[120:123], v[152:155]
    s_mov_b32 s54, 0
    s_and_b32 s52, s37, 3
    v_mfma_f32_16x16x32_bf16 v[156:159], a[24:27], v[116:119], v[156:159]
    s_mul_i32 s53, s52, 40960
    s_add_u32 s42, s38, s53
    v_mfma_f32_16x16x32_bf16 v[160:163], a[24:27], v[120:123], v[160:163]
    s_waitcnt lgkmcnt(2)
    s_lshl_b32 s52, s52, 12
    v_mfma_f32_16x16x32_bf16 v[140:143], a[188:191], v[124:127], v[140:143]
    ds_read_b128 v[116:119], v12 offset:16384
    v_add_u32 v35, s52, v28
    v_mfma_f32_16x16x32_bf16 v[144:147], a[188:191], v[128:131], v[144:147]
    ds_read_b128 v[120:123], v12 offset:18432
    s_xor_b32 s52, s52, 8192
    v_mfma_f32_16x16x32_bf16 v[148:151], a[108:111], v[124:127], v[148:151]
    v_add_u32 v34, s52, v27
    s_and_b32 s53, s37, 7
    v_mfma_f32_16x16x32_bf16 v[152:155], a[108:111], v[128:131], v[152:155]
    s_mul_i32 s53, s53, 172032
    s_add_u32 s53, s53, 196608
    v_mfma_f32_16x16x32_bf16 v[156:159], a[28:31], v[124:127], v[156:159]
    s_add_u32 s44, s38, s53
    s_add_u32 s53, s37, 2
    v_mfma_f32_16x16x32_bf16 v[160:163], a[28:31], v[128:131], v[160:163]
    s_waitcnt lgkmcnt(2)
    s_and_b32 s53, s53, 7
    v_mfma_f32_16x16x32_bf16 v[140:143], a[192:195], v[132:135], v[140:143]
    ds_read_b128 v[124:127], v11 offset:20480
    s_mul_i32 s53, s53, 172032
    v_mfma_f32_16x16x32_bf16 v[144:147], a[192:195], v[136:139], v[144:147]
    ds_read_b128 v[128:131], v11 offset:22528
    s_add_u32 s53, s53, 221184
    v_mfma_f32_16x16x32_bf16 v[148:151], a[112:115], v[132:135], v[148:151]
    s_add_u32 s45, s38, s53
    s_add_u32 s50, s45, 49152
    v_mfma_f32_16x16x32_bf16 v[152:155], a[112:115], v[136:139], v[152:155]
    s_add_u32 s51, s45, 98304
    v_add_u32 v32, s37, v220
    v_mfma_f32_16x16x32_bf16 v[156:159], a[32:35], v[132:135], v[156:159]
    v_mov_b32 v80, 0
    v_mov_b32 v81, 0
    v_mfma_f32_16x16x32_bf16 v[160:163], a[32:35], v[136:139], v[160:163]
    s_waitcnt lgkmcnt(2)
    v_mov_b32 v82, 0
    v_mfma_f32_16x16x32_bf16 v[140:143], a[196:199], v[116:119], v[140:143]
    ds_read_b128 v[132:135], v12 offset:20480
    v_mov_b32 v83, 0
    v_mfma_f32_16x16x32_bf16 v[144:147], a[196:199], v[120:123], v[144:147]
    ds_read_b128 v[136:139], v12 offset:22528
    v_mov_b32 v84, 0
    v_mfma_f32_16x16x32_bf16 v[148:151], a[116:119], v[116:119], v[148:151]
    v_mov_b32 v85, 0
    v_mov_b32 v86, 0
    v_mfma_f32_16x16x32_bf16 v[152:155], a[116:119], v[120:123], v[152:155]
    v_mov_b32 v87, 0
    v_mov_b32 v88, 0
    v_mfma_f32_16x16x32_bf16 v[156:159], a[36:39], v[116:119], v[156:159]
    v_mov_b32 v89, 0
    v_mov_b32 v90, 0
    v_mfma_f32_16x16x32_bf16 v[160:163], a[36:39], v[120:123], v[160:163]
    s_waitcnt lgkmcnt(2)
    v_mov_b32 v91, 0
    v_mfma_f32_16x16x32_bf16 v[140:143], a[200:203], v[124:127], v[140:143]
    ds_read_b128 v[116:119], v11 offset:24576
    v_mfma_f32_16x16x32_bf16 v[144:147], a[200:203], v[128:131], v[144:147]
    ds_read_b128 v[120:123], v11 offset:26624
    v_mfma_f32_16x16x32_bf16 v[148:151], a[120:123], v[124:127], v[148:151]
    v_mfma_f32_16x16x32_bf16 v[152:155], a[120:123], v[128:131], v[152:155]
    v_mfma_f32_16x16x32_bf16 v[156:159], a[40:43], v[124:127], v[156:159]
    v_mfma_f32_16x16x32_bf16 v[160:163], a[40:43], v[128:131], v[160:163]
    s_waitcnt lgkmcnt(2)
    v_mfma_f32_16x16x32_bf16 v[140:143], a[204:207], v[132:135], v[140:143]
    ds_read_b128 v[124:127], v12 offset:24576
    v_mfma_f32_16x16x32_bf16 v[144:147], a[204:207], v[136:139], v[144:147]
    ds_read_b128 v[128:131], v12 offset:26624
    v_mfma_f32_16x16x32_bf16 v[148:151], a[124:127], v[132:135], v[148:151]
    v_mfma_f32_16x16x32_bf16 v[152:155], a[124:127], v[136:139], v[152:155]
    v_mfma_f32_16x16x32_bf16 v[156:159], a[44:47], v[132:135], v[156:159]
    v_mfma_f32_16x16x32_bf16 v[160:163], a[44:47], v[136:139], v[160:163]
    s_waitcnt lgkmcnt(2)
    v_mfma_f32_16x16x32_bf16 v[140:143], a[208:211], v[116:119], v[140:143]
    ds_read_b128 v[132:135], v11 offset:28672
    v_mfma_f32_16x16x32_bf16 v[144:147], a[208:211], v[120:123], v[144:147]
    ds_read_b128 v[136:139], v11 offset:30720
    v_mfma_f32_16x16x32_bf16 v[148:151], a[128:131], v[116:119], v[148:151]
    v_mfma_f32_16x16x32_bf16 v[152:155], a[128:131], v[120:123], v[152:155]
    v_mfma_f32_16x16x32_bf16 v[156:159], a[48:51], v[116:119], v[156:159]
    v_mfma_f32_16x16x32_bf16 v[160:163], a[48:51], v[120:123], v[160:163]
    s_waitcnt lgkmcnt(2)
    v_mfma_f32_16x16x32_bf16 v[140:143], a[212:215], v[124:127], v[140:143]
    ds_read_b128 v[116:119], v12 offset:28672
    v_mfma_f32_16x16x32_bf16 v[144:147], a[212:215], v[128:131], v[144:147]
    ds_read_b128 v[120:123], v12 offset:30720
    v_mfma_f32_16x16x32_bf16 v[148:151], a[132:135], v[124:127], v[148:151]
    v_mfma_f32_16x16x32_bf16 v[152:155], a[132:135], v[128:131], v[152:155]
    v_mfma_f32_16x16x32_bf16 v[156:159], a[52:55], v[124:127], v[156:159]
    v_mfma_f32_16x16x32_bf16 v[160:163], a[52:55], v[128:131], v[160:163]
    s_waitcnt lgkmcnt(2)
    v_mfma_f32_16x16x32_bf16 v[140:143], a[216:219], v[132:135], v[140:143]
    ds_read_b128 v[124:127], v11 offset:32768
    v_mfma_f32_16x16x32_bf16 v[144:147], a[216:219], v[136:139], v[144:147]
    ds_read_b128 v[128:131], v11 offset:34816
    v_mfma_f32_16x16x32_bf16 v[148:151], a[136:139], v[132:135], v[148:151]
    v_mfma_f32_16x16x32_bf16 v[152:155], a[136:139], v[136:139], v[152:155]
    v_mfma_f32_16x16x32_bf16 v[156:159], a[56:59], v[132:135], v[156:159]
    v_mfma_f32_16x16x32_bf16 v[160:163], a[56:59], v[136:139], v[160:163]
    s_waitcnt lgkmcnt(2)
    v_mfma_f32_16x16x32_bf16 v[140:143], a[220:223], v[116:119], v[140:143]
    ds_read_b128 v[132:135], v12 offset:32768
    v_mfma_f32_16x16x32_bf16 v[144:147], a[220:223], v[120:123], v[144:147]
    ds_read_b128 v[136:139], v12 offset:34816
    v_mfma_f32_16x16x32_bf16 v[148:151], a[140:143], v[116:119], v[148:151]
    v_mfma_f32_16x16x32_bf16 v[152:155], a[140:143], v[120:123], v[152:155]
    v_mfma_f32_16x16x32_bf16 v[156:159], a[60:63], v[116:119], v[156:159]
    v_mfma_f32_16x16x32_bf16 v[160:163], a[60:63], v[120:123], v[160:163]
    s_waitcnt lgkmcnt(2)
    v_mfma_f32_16x16x32_bf16 v[140:143], a[224:227], v[124:127], v[140:143]
    ds_read_b128 v[116:119], v11 offset:36864
    v_mfma_f32_16x16x32_bf16 v[144:147], a[224:227], v[128:131], v[144:147]
    ds_read_b128 v[120:123], v11 offset:38912
    v_mfma_f32_16x16x32_bf16 v[148:151], a[144:147], v[124:127], v[148:151]
    v_mfma_f32_16x16x32_bf16 v[152:155], a[144:147], v[128:131], v[152:155]
    v_mfma_f32_16x16x32_bf16 v[156:159], a[64:67], v[124:127], v[156:159]
    v_mfma_f32_16x16x32_bf16 v[160:163], a[64:67], v[128:131], v[160:163]
    s_waitcnt lgkmcnt(2)
    v_mfma_f32_16x16x32_bf16 v[140:143], a[228:231], v[132:135], v[140:143]
    ds_read_b128 v[124:127], v12 offset:36864
    v_mfma_f32_16x16x32_bf16 v[144:147], a[228:231], v[136:139], v[144:147]
    ds_read_b128 v[128:131], v12 offset:38912
    v_mfma_f32_16x16x32_bf16 v[148:151], a[148:151], v[132:135], v[148:151]
    v_mfma_f32_16x16x32_bf16 v[152:155], a[148:151], v[136:139], v[152:155]
    v_mfma_f32_16x16x32_bf16 v[156:159], a[68:71], v[132:135], v[156:159]
    v_mfma_f32_16x16x32_bf16 v[160:163], a[68:71], v[136:139], v[160:163]
    s_waitcnt lgkmcnt(0)
    v_mfma_f32_16x16x32_bf16 v[140:143], a[232:235], v[116:119], v[140:143]
    v_mfma_f32_16x16x32_bf16 v[144:147], a[232:235], v[120:123], v[144:147]
    v_mfma_f32_16x16x32_bf16 v[140:143], a[236:239], v[124:127], v[140:143]
    v_mfma_f32_16x16x32_bf16 v[144:147], a[236:239], v[128:131], v[144:147]
    v_mfma_f32_16x16x32_bf16 v[148:151], a[152:155], v[116:119], v[148:151]
    v_add_u32 v11, s49, v11
    v_add_u32 v12, s49, v12
    v_mfma_f32_16x16x32_bf16 v[152:155], a[152:155], v[120:123], v[152:155]
    s_sub_u32 s47, s47, s49
    s_sub_u32 s49, 0, s49
    v_mfma_f32_16x16x32_bf16 v[148:151], a[156:159], v[124:127], v[148:151]
    v_mfma_f32_16x16x32_bf16 v[152:155], a[156:159], v[128:131], v[152:155]
    v_mfma_f32_16x16x32_bf16 v[156:159], a[72:75], v[116:119], v[156:159]
    v_cvt_pk_bf16_f32 v164, v140, v141
    v_cvt_pk_bf16_f32 v165, v142, v143
    v_mfma_f32_16x16x32_bf16 v[160:163], a[72:75], v[120:123], v[160:163]
    v_cvt_pk_bf16_f32 v166, v144, v145
    v_cvt_pk_bf16_f32 v167, v146, v147
    v_mfma_f32_16x16x32_bf16 v[156:159], a[76:79], v[124:127], v[156:159]
    v_permlane16_swap_b32 v164, v166
    v_permlane16_swap_b32 v165, v167
    v_mfma_f32_16x16x32_bf16 v[160:163], a[76:79], v[128:131], v[160:163]
    v_cvt_pk_bf16_f32 v168, v148, v149
    v_cvt_pk_bf16_f32 v169, v150, v151
    v_cvt_pk_bf16_f32 v170, v152, v153
    v_cvt_pk_bf16_f32 v171, v154, v155
    s_nop 0
    v_permlane16_swap_b32 v168, v170
    v_permlane16_swap_b32 v169, v171
    ds_write_b128 v34, v[168:171]
    v_cvt_pk_bf16_f32 v172, v156, v157
    v_cvt_pk_bf16_f32 v173, v158, v159
    v_cvt_pk_bf16_f32 v174, v160, v161
    v_cvt_pk_bf16_f32 v175, v162, v163
    s_nop 0
    v_permlane16_swap_b32 v172, v174
    v_permlane16_swap_b32 v173, v175
L_qkv_loop_f:
    s_mov_b32 m0, s48
    s_nop 0
    buffer_load_dwordx4 v13, s[4:7], s42 offen sc1 lds
    buffer_load_dwordx4 v13, s[4:7], s42 offen offset:1024 sc1 lds
    buffer_load_dword v14, s[4:7], s42 offen offset:2048 sc1 lds
    buffer_load_dword v14, s[4:7], s42 offen offset:2304 sc1 lds
    ds_read_b128 v[100:103], v35
    ds_read_b128 v[104:107], v35 offset:1024
    s_add_u32 s90, s37, 4
    s_min_u32 s90, s90, 63
    s_mul_i32 s46, s90, 40960
L_poll_4:
    buffer_load_dwordx4 v13, s[4:7], s42 offen sc1 lds
    buffer_load_dwordx4 v13, s[4:7], s42 offen offset:1024 sc1 lds
    buffer_load_dword v14, s[4:7], s42 offen offset:2048 sc1 lds
    buffer_load_dword v14, s[4:7], s42 offen offset:2304 sc1 lds
    s_sub_u32 s36, s36, 1
    s_cbranch_scc1 L_exit
    s_waitcnt vmcnt(4)
    ds_read_b32 v33, v15
    s_waitcnt lgkmcnt(0)
    v_cmp_eq_u32 vcc, -1, v33
    s_cbranch_vccnz L_poll_4
    s_barrier
    ds_read_b128 v[40:43], v16 offset:0
    ds_read_b128 v[44:47], v16 offset:1024
    ds_read_b128 v[48:51], v16 offset:2048
    ds_read_b128 v[52:55], v16 offset:3072
    ds_read_b128 v[56:59], v16 offset:4096
    ds_read_b128 v[60:63], v16 offset:5120
    ds_read_b128 v[64:67], v16 offset:6144
    ds_read_b128 v[68:71], v16 offset:7168
    ds_read_b128 v[72:75], v16 offset:8192
    ds_read_b128 v[76:79], v16 offset:9216
L_got_3r:
    s_waitcnt lgkmcnt(9)
    v_smfmac_f32_16x16x64_bf16 v[80:83], v[40:43], a[160:167], v18
    s_waitcnt lgkmcnt(8)
    v_smfmac_f32_16x16x64_bf16 v[80:83], v[44:47], a[168:175], v18
    s_waitcnt lgkmcnt(7)
    v_smfmac_f32_16x16x64_bf16 v[80:83], v[48:51], a[176:183], v18
    s_waitcnt lgkmcnt(6)
    v_smfmac_f32_16x16x64_bf16 v[80:83], v[52:55], a[184:191], v18
    s_waitcnt lgkmcnt(5)
    v_smfmac_f32_16x16x64_bf16 v[80:83], v[56:59], a[192:199], v18
    s_waitcnt lgkmcnt(4)
    v_smfmac_f32_16x16x64_bf16 v[80:83], v[60:63], a[200:207], v18
    s_waitcnt lgkmcnt(3)
    v_smfmac_f32_16x16x64_bf16 v[80:83], v[64:67], a[208:215], v18
    s_waitcnt lgkmcnt(2)
    v_smfmac_f32_16x16x64_bf16 v[80:83], v[68:71], a[216:223], v18
    s_waitcnt lgkmcnt(1)
    v_smfmac_f32_16x16x64_bf16 v[80:83], v[72:75], a[224:231], v18
    s_waitcnt lgkmcnt(0)
    v_smfmac_f32_16x16x64_bf16 v[80:83], v[76:79], a[232:239], v18
    v_smfmac_f32_16x16x64_bf16 v[84:87], v[40:43], a[0:7], v18
    v_smfmac_f32_16x16x64_bf16 v[88:91], v[40:43], a[80:87], v18
    v_smfmac_f32_16x16x64_bf16 v[84:87], v[44:47], a[8:15], v18
    v_pk_add_f32 v[80:81], v[80:81], v[82:83]
    v_cvt_pk_bf16_f32 v112, v80, v81
    v_smfmac_f32_16x16x64_bf16 v[88:91], v[44:47], a[88:95], v18
    ds_write_b32 v19, v112
    v_cmp_u_f32 vcc, v80, v81
    v_smfmac_f32_16x16x64_bf16 v[84:87], v[48:51], a[16:23], v18
    ds_read_b64_tr_b16 v[112:113], v20
    ds_read_b64_tr_b16 v[114:115], v20 offset:128
    v_smfmac_f32_16x16x64_bf16 v[88:91], v[48:51], a[96:103], v18
    v_smfmac_f32_16x16x64_bf16 v[84:87], v[52:55], a[24:31], v18
    s_cbranch_vccnz L_nan_5
L_cont_6:
    v_smfmac_f32_16x16x64_bf16 v[88:91], v[52:55], a[104:111], v18
    v_smfmac_f32_16x16x64_bf16 v[84:87], v[56:59], a[32:39], v18
    v_smfmac_f32_16x16x64_bf16 v[88:91], v[56:59], a[112:119], v18
    s_waitcnt lgkmcnt(0)
    buffer_store_dwordx4 v[112:115], v21, s[4:7], s42 offen
    v_smfmac_f32_16x16x64_bf16 v[84:87], v[60:63], a[40:47], v18
    v_smfmac_f32_16x16x64_bf16 v[88:91], v[60:63], a[120:127], v18
    v_smfmac_f32_16x16x64_bf16 v[84:87], v[64:67], a[48:55], v18
    v_smfmac_f32_16x16x64_bf16 v[88:91], v[64:67], a[128:135], v18
    v_smfmac_f32_16x16x64_bf16 v[84:87], v[68:71], a[56:63], v18
    v_smfmac_f32_16x16x64_bf16 v[88:91], v[68:71], a[136:143], v18
    v_smfmac_f32_16x16x64_bf16 v[84:87], v[72:75], a[64:71], v18
    v_smfmac_f32_16x16x64_bf16 v[88:91], v[72:75], a[144:151], v18
    v_smfmac_f32_16x16x64_bf16 v[84:87], v[76:79], a[72:79], v18
    v_smfmac_f32_16x16x64_bf16 v[88:91], v[76:79], a[152:159], v18
    s_cmp_eq_u32 s32, 0
    s_nop 4
    s_cbranch_scc1 L_w0_7
    s_cmp_eq_u32 s32, 3
    s_nop 2
    s_cbranch_scc1 L_w3_8
    s_nop 0
    v_pk_add_f32 v[84:85], v[84:85], v[86:87]
    s_nop 1
    v_pk_add_f32 v[88:89], v[88:89], v[90:91]
    v_cvt_pk_bf16_f32 v176, v84, v85
    v_cvt_pk_bf16_f32 v177, v88, v89
    ds_write_b64 v22, v[176:177]
    s_waitcnt lgkmcnt(0)
    s_barrier
    ds_read_b64_tr_b16 v[92:93], v23 offset:0
    ds_read_b64_tr_b16 v[94:95], v24 offset:0
    ds_read_b64_tr_b16 v[96:97], v23 offset:1024
    ds_read_b64_tr_b16 v[98:99], v24 offset:1024
    ds_read_b128 v[116:119], v11 offset:0
    ds_read_b128 v[120:123], v11 offset:2048
    ds_read_b128 v[124:127], v12 offset:0
    ds_read_b128 v[128:131], v12 offset:2048
    s_waitcnt lgkmcnt(6)
    v_mfma_f32_16x16x32_bf16 v[108:111], v[100:103], v[92:95], 0
    s_waitcnt lgkmcnt(4)
    v_mfma_f32_16x16x32_bf16 v[108:111], v[104:107], v[96:99], v[108:111]
    s_nop 7
    buffer_store_dwordx4 v[108:111], v25, s[4:7], s42 offen
    buffer_store_dwordx4 v[36:39], v25, s[4:7], s43 offen
    s_branch L_join_9
L_w0_7:
    v_pk_add_f32 v[84:85], v[84:85], v[86:87]
    v_pk_add_f32 v[88:89], v[88:89], v[90:91]
    v_cvt_pk_bf16_f32 v176, v84, v85
    v_cvt_pk_bf16_f32 v177, v88, v89
    ds_write_b64 v22, v[176:177]
    s_waitcnt lgkmcnt(0)
    s_barrier
    ds_read_b64_tr_b16 v[92:93], v23 offset:0
    ds_read_b64_tr_b16 v[94:95], v24 offset:0
    ds_read_b64_tr_b16 v[96:97], v23 offset:1024
    ds_read_b64_tr_b16 v[98:99], v24 offset:1024
    ds_read_b128 v[116:119], v11 offset:0
    ds_read_b128 v[120:123], v11 offset:2048
    ds_read_b128 v[124:127], v12 offset:0
    ds_read_b128 v[128:131], v12 offset:2048
    s_waitcnt lgkmcnt(6)
    v_mfma_f32_16x16x32_bf16 v[108:111], v[92:95], v[92:95], 0
    s_waitcnt lgkmcnt(4)
    v_mfma_f32_16x16x32_bf16 v[108:111], v[96:99], v[96:99], v[108:111]
    s_nop 7
    buffer_store_dword v110, v25, s[4:7], s42 offen
    buffer_store_dword v111, v25, s[4:7], s42 offen offset:8
    buffer_store_dword v38, v25, s[4:7], s43 offen
    buffer_store_dword v39, v25, s[4:7], s43 offen offset:8
    s_branch L_join_9
L_w3_8:
    v_pk_add_f32 v[84:85], v[84:85], v[86:87]
    v_pk_add_f32 v[88:89], v[88:89], v[90:91]
    v_cvt_pk_bf16_f32 v176, v84, v85
    v_cvt_pk_bf16_f32 v177, v88, v89
    ds_write_b64 v22, v[176:177]
    s_waitcnt lgkmcnt(0)
    s_barrier
    ds_read_b64_tr_b16 v[92:93], v23 offset:0
    ds_read_b64_tr_b16 v[94:95], v24 offset:0
    ds_read_b64_tr_b16 v[96:97], v23 offset:1024
    ds_read_b64_tr_b16 v[98:99], v24 offset:1024
    ds_read_b128 v[116:119], v11 offset:0
    ds_read_b128 v[120:123], v11 offset:2048
    ds_read_b128 v[124:127], v12 offset:0
    ds_read_b128 v[128:131], v12 offset:2048
    s_waitcnt lgkmcnt(6)
    buffer_store_dwordx4 v[92:95], v26, s[4:7], s44 offen
    s_waitcnt lgkmcnt(4)
    buffer_store_dwordx4 v[96:99], v26, s[4:7], s44 offen offset:512
L_join_9:
    s_cmp_eq_u32 s37, 63
    s_cbranch_scc1 L_skip_10
    s_lshl_b32 s90, s32, 10
    s_add_u32 m0, s90, s47
    s_waitcnt lgkmcnt(2)
    v_mfma_f32_16x16x32_bf16 v[140:143], a[160:163], v[116:119], 0
    ds_read_b128 v[132:135], v11 offset:4096
    v_mfma_f32_16x16x32_bf16 v[144:147], a[160:163], v[120:123], 0
    ds_read_b128 v[136:139], v11 offset:6144
    v_mfma_f32_16x16x32_bf16 v[148:151], a[80:83], v[116:119], 0
    buffer_store_dwordx4 v[164:167], v29, s[4:7], s51 offen
    v_mfma_f32_16x16x32_bf16 v[152:155], a[80:83], v[120:123], 0
    v_mfma_f32_16x16x32_bf16 v[156:159], a[0:3], v[116:119], 0
    buffer_store_dwordx4 v[168:171], v29, s[4:7], s50 offen
    v_mfma_f32_16x16x32_bf16 v[160:163], a[0:3], v[120:123], 0
    s_waitcnt lgkmcnt(2)
    v_mfma_f32_16x16x32_bf16 v[140:143], a[164:167], v[124:127], v[140:143]
    ds_read_b128 v[116:119], v12 offset:4096
    v_mfma_f32_16x16x32_bf16 v[144:147], a[164:167], v[128:131], v[144:147]
    ds_read_b128 v[120:123], v12 offset:6144
    v_mfma_f32_16x16x32_bf16 v[148:151], a[84:87], v[124:127], v[148:151]
    buffer_store_dwordx4 v[172:175], v29, s[4:7], s45 offen
    v_mfma_f32_16x16x32_bf16 v[152:155], a[84:87], v[128:131], v[152:155]
    v_mfma_f32_16x16x32_bf16 v[156:159], a[4:7], v[124:127], v[156:159]
    buffer_store_dwordx4 v[36:39], v21, s[4:7], s43 offen
    v_mfma_f32_16x16x32_bf16 v[160:163], a[4:7], v[128:131], v[160:163]
    s_waitcnt lgkmcnt(2)
    v_mfma_f32_16x16x32_bf16 v[140:143], a[168:171], v[132:135], v[140:143]
    ds_read_b128 v[124:127], v11 offset:8192
    v_mfma_f32_16x16x32_bf16 v[144:147], a[168:171], v[136:139], v[144:147]
    ds_read_b128 v[128:131], v11 offset:10240
    v_mfma_f32_16x16x32_bf16 v[148:151], a[88:91], v[132:135], v[148:151]
    buffer_store_dword v36, v219, s[4:7], s43 offen
    v_mfma_f32_16x16x32_bf16 v[152:155], a[88:91], v[136:139], v[152:155]
    v_mfma_f32_16x16x32_bf16 v[156:159], a[8:11], v[132:135], v[156:159]
    buffer_load_dwordx4 v10, s[24:27], s46 offen offset:0 lds
    s_add_u32 m0, m0, 3968
    v_mfma_f32_16x16x32_bf16 v[160:163], a[8:11], v[136:139], v[160:163]
    s_waitcnt lgkmcnt(2)
    v_mfma_f32_16x16x32_bf16 v[140:143], a[172:175], v[116:119], v[140:143]
    ds_read_b128 v[132:135], v12 offset:8192
    v_mfma_f32_16x16x32_bf16 v[144:147], a[172:175], v[120:123], v[144:147]
    ds_read_b128 v[136:139], v12 offset:10240
    v_mfma_f32_16x16x32_bf16 v[148:151], a[92:95], v[116:119], v[148:151]
    buffer_load_dwordx4 v10, s[24:27], s46 offen offset:128 lds
    s_add_u32 m0, m0, 3968
    v_mfma_f32_16x16x32_bf16 v[152:155], a[92:95], v[120:123], v[152:155]
    v_mfma_f32_16x16x32_bf16 v[156:159], a[12:15], v[116:119], v[156:159]
    buffer_load_dwordx4 v10, s[24:27], s46 offen offset:256 lds
    s_add_u32 m0, m0, 3968
    v_mfma_f32_16x16x32_bf16 v[160:163], a[12:15], v[120:123], v[160:163]
    s_waitcnt lgkmcnt(2)
    v_mfma_f32_16x16x32_bf16 v[140:143], a[176:179], v[124:127], v[140:143]
    ds_read_b128 v[116:119], v11 offset:12288
    v_mfma_f32_16x16x32_bf16 v[144:147], a[176:179], v[128:131], v[144:147]
    ds_read_b128 v[120:123], v11 offset:14336
    v_mfma_f32_16x16x32_bf16 v[148:151], a[96:99], v[124:127], v[148:151]
    buffer_load_dwordx4 v10, s[24:27], s46 offen offset:384 lds
    s_add_u32 m0, m0, 3968
    v_mfma_f32_16x16x32_bf16 v[152:155], a[96:99], v[128:131], v[152:155]
    v_mfma_f32_16x16x32_bf16 v[156:159], a[16:19], v[124:127], v[156:159]
    buffer_load_dwordx4 v10, s[24:27], s46 offen offset:512 lds
    s_add_u32 m0, m0, 3968
    v_mfma_f32_16x16x32_bf16 v[160:163], a[16:19], v[128:131], v[160:163]
    s_waitcnt lgkmcnt(2)
    v_mfma_f32_16x16x32_bf16 v[140:143], a[180:183], v[132:135], v[140:143]
    ds_read_b128 v[124:127], v12 offset:12288
    v_mfma_f32_16x16x32_bf16 v[144:147], a[180:183], v[136:139], v[144:147]
    ds_read_b128 v[128:131], v12 offset:14336
    v_mfma_f32_16x16x32_bf16 v[148:151], a[100:103], v[132:135], v[148:151]
    buffer_load_dwordx4 v10, s[24:27], s46 offen offset:640 lds
    s_add_u32 m0, m0, 3968
    v_mfma_f32_16x16x32_bf16 v[152:155], a[100:103], v[136:139], v[152:155]
    v_mfma_f32_16x16x32_bf16 v[156:159], a[20:23], v[132:135], v[156:159]
    s_waitcnt vmcnt(6)
    buffer_store_dword v32, v31, s[4:7], s38 offen
    v_mfma_f32_16x16x32_bf16 v[160:163], a[20:23], v[136:139], v[160:163]
    s_waitcnt lgkmcnt(2)
    v_mfma_f32_16x16x32_bf16 v[140:143], a[184:187], v[116:119], v[140:143]
    ds_read_b128 v[132:135], v11 offset:16384
    s_and_b32 s52, s37, 3
    v_mfma_f32_16x16x32_bf16 v[144:147], a[184:187], v[120:123], v[144:147]
    ds_read_b128 v[136:139], v11 offset:18432
    s_mul_i32 s55, s52, 491520
    v_mfma_f32_16x16x32_bf16 v[148:151], a[104:107], v[116:119], v[148:151]
    buffer_load_dwordx4 v10, s[24:27], s46 offen offset:768 lds
    s_add_u32 m0, m0, 3968
    v_mfma_f32_16x16x32_bf16 v[152:155], a[104:107], v[120:123], v[152:155]
    s_add_u32 s37, s37, 1
    s_mov_b32 s43, s42
    v_mfma_f32_16x16x32_bf16 v[156:159], a[24:27], v[116:119], v[156:159]
    buffer_load_dwordx4 v10, s[24:27], s46 offen offset:896 lds
    s_add_u32 m0, m0, 3968
    v_mfma_f32_16x16x32_bf16 v[160:163], a[24:27], v[120:123], v[160:163]
    s_waitcnt lgkmcnt(2)
    s_mov_b32 s54, 0
    v_mfma_f32_16x16x32_bf16 v[140:143], a[188:191], v[124:127], v[140:143]
    ds_read_b128 v[116:119], v12 offset:16384
    s_and_b32 s52, s37, 3
    v_mfma_f32_16x16x32_bf16 v[144:147], a[188:191], v[128:131], v[144:147]
    ds_read_b128 v[120:123], v12 offset:18432
    s_mul_i32 s53, s52, 40960
    v_mfma_f32_16x16x32_bf16 v[148:151], a[108:111], v[124:127], v[148:151]
    buffer_load_dwordx4 v10, s[24:27], s46 offen offset:1024 lds
    s_add_u32 m0, m0, 3968
    v_mfma_f32_16x16x32_bf16 v[152:155], a[108:111], v[128:131], v[152:155]
    s_add_u32 s42, s38, s53
    s_lshl_b32 s52, s52, 12
    v_mfma_f32_16x16x32_bf16 v[156:159], a[28:31], v[124:127], v[156:159]
    buffer_load_dwordx4 v10, s[24:27], s46 offen offset:1152 lds
    v_mfma_f32_16x16x32_bf16 v[160:163], a[28:31], v[128:131], v[160:163]
    s_waitcnt lgkmcnt(2)
    v_add_u32 v35, s52, v28
    v_mfma_f32_16x16x32_bf16 v[140:143], a[192:195], v[132:135], v[140:143]
    ds_read_b128 v[124:127], v11 offset:20480
    s_xor_b32 s52, s52, 8192
    v_mfma_f32_16x16x32_bf16 v[144:147], a[192:195], v[136:139], v[144:147]
    ds_read_b128 v[128:131], v11 offset:22528
    v_add_u32 v34, s52, v27
    v_mfma_f32_16x16x32_bf16 v[148:151], a[112:115], v[132:135], v[148:151]
    s_and_b32 s53, s37, 7
    s_mul_i32 s53, s53, 172032
    v_mfma_f32_16x16x32_bf16 v[152:155], a[112:115], v[136:139], v[152:155]
    s_add_u32 s53, s53, 196608
    s_add_u32 s44, s38, s53
    v_mfma_f32_16x16x32_bf16 v[156:159], a[32:35], v[132:135], v[156:159]
    s_add_u32 s53, s37, 2
    s_and_b32 s53, s53, 7
    v_mfma_f32_16x16x32_bf16 v[160:163], a[32:35], v[136:139], v[160:163]
    s_waitcnt lgkmcnt(2)
    s_mul_i32 s53, s53, 172032
    v_mfma_f32_16x16x32_bf16 v[140:143], a[196:199], v[116:119], v[140:143]
    ds_read_b128 v[132:135], v12 offset:20480
    s_add_u32 s53, s53, 221184
    v_mfma_f32_16x16x32_bf16 v[144:147], a[196:199], v[120:123], v[144:147]
    ds_read_b128 v[136:139], v12 offset:22528
    s_add_u32 s45, s38, s53
    v_mfma_f32_16x16x32_bf16 v[148:151], a[116:119], v[116:119], v[148:151]
    s_add_u32 s50, s45, 49152
    s_add_u32 s51, s45, 98304
    v_mfma_f32_16x16x32_bf16 v[152:155], a[116:119], v[120:123], v[152:155]
    v_add_u32 v32, s37, v220
    v_mov_b32 v80, 0
    v_mfma_f32_16x16x32_bf16 v[156:159], a[36:39], v[116:119], v[156:159]
    v_mov_b32 v81, 0
    v_mov_b32 v82, 0
    v_mfma_f32_16x16x32_bf16 v[160:163], a[36:39], v[120:123], v[160:163]
    s_waitcnt lgkmcnt(2)
    v_mov_b32 v83, 0
    v_mfma_f32_16x16x32_bf16 v[140:143], a[200:203], v[124:127], v[140:143]
    ds_read_b128 v[116:119], v11 offset:24576
    v_mov_b32 v84, 0
    v_mfma_f32_16x16x32_bf16 v[144:147], a[200:203], v[128:131], v[144:147]
    ds_read_b128 v[120:123], v11 offset:26624
    v_mov_b32 v85, 0
    v_mfma_f32_16x16x32_bf16 v[148:151], a[120:123], v[124:127], v[148:151]
    v_mov_b32 v86, 0
    v_mov_b32 v87, 0
    v_mfma_f32_16x16x32_bf16 v[152:155], a[120:123], v[128:131], v[152:155]
    v_mov_b32 v88, 0
    v_mov_b32 v89, 0
    v_mfma_f32_16x16x32_bf16 v[156:159], a[40:43], v[124:127], v[156:159]
    v_mov_b32 v90, 0
    v_mov_b32 v91, 0
    v_mfma_f32_16x16x32_bf16 v[160:163], a[40:43], v[128:131], v[160:163]
    s_waitcnt lgkmcnt(2)
    v_mfma_f32_16x16x32_bf16 v[140:143], a[204:207], v[132:135], v[140:143]
    ds_read_b128 v[124:127], v12 offset:24576
    v_mfma_f32_16x16x32_bf16 v[144:147], a[204:207], v[136:139], v[144:147]
    ds_read_b128 v[128:131], v12 offset:26624
    v_mfma_f32_16x16x32_bf16 v[148:151], a[124:127], v[132:135], v[148:151]
    v_mfma_f32_16x16x32_bf16 v[152:155], a[124:127], v[136:139], v[152:155]
    v_mfma_f32_16x16x32_bf16 v[156:159], a[44:47], v[132:135], v[156:159]
    v_mfma_f32_16x16x32_bf16 v[160:163], a[44:47], v[136:139], v[160:163]
    s_waitcnt lgkmcnt(2)
    v_mfma_f32_16x16x32_bf16 v[140:143], a[208:211], v[116:119], v[140:143]
    ds_read_b128 v[132:135], v11 offset:28672
    v_mfma_f32_16x16x32_bf16 v[144:147], a[208:211], v[120:123], v[144:147]
    ds_read_b128 v[136:139], v11 offset:30720
    v_mfma_f32_16x16x32_bf16 v[148:151], a[128:131], v[116:119], v[148:151]
    v_mfma_f32_16x16x32_bf16 v[152:155], a[128:131], v[120:123], v[152:155]
    buffer_load_dword v217, v216, s[4:7], s38 offen sc1
    v_mfma_f32_16x16x32_bf16 v[156:159], a[48:51], v[116:119], v[156:159]
    v_mfma_f32_16x16x32_bf16 v[160:163], a[48:51], v[120:123], v[160:163]
    s_waitcnt lgkmcnt(2)
    v_mfma_f32_16x16x32_bf16 v[140:143], a[212:215], v[124:127], v[140:143]
    ds_read_b128 v[116:119], v12 offset:28672
    v_mfma_f32_16x16x32_bf16 v[144:147], a[212:215], v[128:131], v[144:147]
    ds_read_b128 v[120:123], v12 offset:30720
    v_mfma_f32_16x16x32_bf16 v[148:151], a[132:135], v[124:127], v[148:151]
    v_mfma_f32_16x16x32_bf16 v[152:155], a[132:135], v[128:131], v[152:155]
    v_mfma_f32_16x16x32_bf16 v[156:159], a[52:55], v[124:127], v[156:159]
    v_mfma_f32_16x16x32_bf16 v[160:163], a[52:55], v[128:131], v[160:163]
    s_waitcnt lgkmcnt(2)
    v_mfma_f32_16x16x32_bf16 v[140:143], a[216:219], v[132:135], v[140:143]
    ds_read_b128 v[124:127], v11 offset:32768
    v_mfma_f32_16x16x32_bf16 v[144:147], a[216:219], v[136:139], v[144:147]
    ds_read_b128 v[128:131], v11 offset:34816
    v_mfma_f32_16x16x32_bf16 v[148:151], a[136:139], v[132:135], v[148:151]
    v_mfma_f32_16x16x32_bf16 v[152:155], a[136:139], v[136:139], v[152:155]
    v_mfma_f32_16x16x32_bf16 v[156:159], a[56:59], v[132:135], v[156:159]
    v_mfma_f32_16x16x32_bf16 v[160:163], a[56:59], v[136:139], v[160:163]
    s_waitcnt lgkmcnt(2)
    s_waitcnt vmcnt(0)
    v_cmp_gt_u32 vcc, s37, v217
    s_cbranch_vccnz L_tw_11
L_tok_12:
    s_barrier
    buffer_load_dwordx4 v[180:183], v214, s[4:7], s55 offen sc1
    buffer_load_dwordx4 v[184:187], v215, s[4:7], s55 offen sc1
    v_mfma_f32_16x16x32_bf16 v[140:143], a[220:223], v[116:119], v[140:143]
    ds_read_b128 v[132:135], v12 offset:32768
    v_mfma_f32_16x16x32_bf16 v[144:147], a[220:223], v[120:123], v[144:147]
    ds_read_b128 v[136:139], v12 offset:34816
    v_mfma_f32_16x16x32_bf16 v[148:151], a[140:143], v[116:119], v[148:151]
    v_mfma_f32_16x16x32_bf16 v[152:155], a[140:143], v[120:123], v[152:155]
    v_mfma_f32_16x16x32_bf16 v[156:159], a[60:63], v[116:119], v[156:159]
    v_mfma_f32_16x16x32_bf16 v[160:163], a[60:63], v[120:123], v[160:163]
    s_waitcnt lgkmcnt(2)
    v_mfma_f32_16x16x32_bf16 v[140:143], a[224:227], v[124:127], v[140:143]
    ds_read_b128 v[116:119], v11 offset:36864
    v_mfma_f32_16x16x32_bf16 v[144:147], a[224:227], v[128:131], v[144:147]
    ds_read_b128 v[120:123], v11 offset:38912
    v_mfma_f32_16x16x32_bf16 v[148:151], a[144:147], v[124:127], v[148:151]
    v_mfma_f32_16x16x32_bf16 v[152:155], a[144:147], v[128:131], v[152:155]
    v_mfma_f32_16x16x32_bf16 v[156:159], a[64:67], v[124:127], v[156:159]
    v_mfma_f32_16x16x32_bf16 v[160:163], a[64:67], v[128:131], v[160:163]
    s_waitcnt lgkmcnt(2)
    buffer_load_dwordx4 v[188:191], v223, s[4:7], s55 offen sc1
    buffer_load_dwordx4 v[192:195], v224, s[4:7], s55 offen sc1
    v_mfma_f32_16x16x32_bf16 v[140:143], a[228:231], v[132:135], v[140:143]
    ds_read_b128 v[124:127], v12 offset:36864
    v_mfma_f32_16x16x32_bf16 v[144:147], a[228:231], v[136:139], v[144:147]
    ds_read_b128 v[128:131], v12 offset:38912
    v_mfma_f32_16x16x32_bf16 v[148:151], a[148:151], v[132:135], v[148:151]
    v_mfma_f32_16x16x32_bf16 v[152:155], a[148:151], v[136:139], v[152:155]
    v_mfma_f32_16x16x32_bf16 v[156:159], a[68:71], v[132:135], v[156:159]
    v_mfma_f32_16x16x32_bf16 v[160:163], a[68:71], v[136:139], v[160:163]
    s_waitcnt lgkmcnt(0)
    v_mfma_f32_16x16x32_bf16 v[140:143], a[232:235], v[116:119], v[140:143]
    v_mfma_f32_16x16x32_bf16 v[144:147], a[232:235], v[120:123], v[144:147]
    v_mfma_f32_16x16x32_bf16 v[140:143], a[236:239], v[124:127], v[140:143]
    v_mfma_f32_16x16x32_bf16 v[144:147], a[236:239], v[128:131], v[144:147]
    v_mfma_f32_16x16x32_bf16 v[148:151], a[152:155], v[116:119], v[148:151]
    v_add_u32 v11, s49, v11
    v_add_u32 v12, s49, v12
    v_mfma_f32_16x16x32_bf16 v[152:155], a[152:155], v[120:123], v[152:155]
    s_sub_u32 s47, s47, s49
    s_sub_u32 s49, 0, s49
    v_mfma_f32_16x16x32_bf16 v[148:151], a[156:159], v[124:127], v[148:151]
    v_mfma_f32_16x16x32_bf16 v[152:155], a[156:159], v[128:131], v[152:155]
    v_mfma_f32_16x16x32_bf16 v[156:159], a[72:75], v[116:119], v[156:159]
    v_cvt_pk_bf16_f32 v164, v140, v141
    v_cvt_pk_bf16_f32 v165, v142, v143
    v_mfma_f32_16x16x32_bf16 v[160:163], a[72:75], v[120:123], v[160:163]
    v_cvt_pk_bf16_f32 v166, v144, v145
    v_cvt_pk_bf16_f32 v167, v146, v147
    v_mfma_f32_16x16x32_bf16 v[156:159], a[76:79], v[124:127], v[156:159]
    v_permlane16_swap_b32 v164, v166
    v_permlane16_swap_b32 v165, v167
    v_mfma_f32_16x16x32_bf16 v[160:163], a[76:79], v[128:131], v[160:163]
    v_cvt_pk_bf16_f32 v168, v148, v149
    v_cvt_pk_bf16_f32 v169, v150, v151
    v_cvt_pk_bf16_f32 v170, v152, v153
    v_cvt_pk_bf16_f32 v171, v154, v155
    s_nop 0
    v_permlane16_swap_b32 v168, v170
    v_permlane16_swap_b32 v169, v171
    ds_write_b128 v34, v[168:171]
    v_cvt_pk_bf16_f32 v172, v156, v157
    v_cvt_pk_bf16_f32 v173, v158, v159
    v_cvt_pk_bf16_f32 v174, v160, v161
    v_cvt_pk_bf16_f32 v175, v162, v163
    s_nop 0
    v_permlane16_swap_b32 v172, v174
    v_permlane16_swap_b32 v173, v175
    s_waitcnt vmcnt(3)
    v_mfma_f32_16x16x32_bf16 v[196:199], v[210:213], v[180:183], 0
    v_mfma_f32_16x16x32_bf16 v[200:203], v[208:211], v[180:183], 0
    v_max3_u32 v221, v180, v181, v182
    s_waitcnt vmcnt(2)
    v_mfma_f32_16x16x32_bf16 v[196:199], v[210:213], v[184:187], v[196:199]
    v_max3_u32 v222, v183, v184, v185
    v_max3_u32 v221, v221, v186, v187
    v_mfma_f32_16x16x32_bf16 v[200:203], v[208:211], v[184:187], v[200:203]
    v_max_u32 v221, v221, v222
    v_cmp_eq_u32 vcc, -1, v221
    s_nop 2
    v_cvt_pk_bf16_f32 v204, v196, v197
    v_cvt_pk_bf16_f32 v205, v198, v199
    s_cbranch_vccnz L_pp_13
    v_cvt_pk_bf16_f32 v206, v200, v201
    v_cvt_pk_bf16_f32 v207, v202, v203
    buffer_store_dwordx4 v[204:207], v218, s[4:7], s42 offen
L_pc_14:
    s_branch L_qkv_loop_f
L_skip_10:
    s_waitcnt vmcnt(0) lgkmcnt(0)
    buffer_store_dword v32, v31, s[4:7], s38 offen
    s_endpgm
L_nan_5:
    s_cmp_eq_u32 s54, 1
    s_cbranch_scc1 L_cont_6
    v_lshlrev_b32 v1, 4, v0
L_nan_5r:
    s_mov_b32 s90, s42
    v_mov_b32 v2, 0
    buffer_load_dwordx4 v[40:43], v1, s[4:7], s90 offen sc1
    s_add_u32 s90, s90, 1024
    buffer_load_dwordx4 v[44:47], v1, s[4:7], s90 offen sc1
    s_add_u32 s90, s90, 1024
    buffer_load_dwordx4 v[48:51], v1, s[4:7], s90 offen sc1
    s_add_u32 s90, s90, 1024
    buffer_load_dwordx4 v[52:55], v1, s[4:7], s90 offen sc1
    s_add_u32 s90, s90, 1024
    buffer_load_dwordx4 v[56:59], v1, s[4:7], s90 offen sc1
    s_add_u32 s90, s90, 1024
    buffer_load_dwordx4 v[60:63], v1, s[4:7], s90 offen sc1
    s_add_u32 s90, s90, 1024
    buffer_load_dwordx4 v[64:67], v1, s[4:7], s90 offen sc1
    s_add_u32 s90, s90, 1024
    buffer_load_dwordx4 v[68:71], v1, s[4:7], s90 offen sc1
    s_add_u32 s90, s90, 1024
    buffer_load_dwordx4 v[72:75], v1, s[4:7], s90 offen sc1
    s_add_u32 s90, s90, 1024
    buffer_load_dwordx4 v[76:79], v1, s[4:7], s90 offen sc1
    s_add_u32 s90, s90, 1024
    s_sub_u32 s36, s36, 1
    s_cbranch_scc1 L_exit
    s_waitcnt vmcnt(0) lgkmcnt(0)
    v_max3_u32 v2, v2, v40, v41
    v_max3_u32 v2, v2, v42, v43
    v_max3_u32 v2, v2, v44, v45
    v_max3_u32 v2, v2, v46, v47
    v_max3_u32 v2, v2, v48, v49
    v_max3_u32 v2, v2, v50, v51
    v_max3_u32 v2, v2, v52, v53
    v_max3_u32 v2, v2, v54, v55
    v_max3_u32 v2, v2, v56, v57
    v_max3_u32 v2, v2, v58, v59
    v_max3_u32 v2, v2, v60, v61
    v_max3_u32 v2, v2, v62, v63
    v_max3_u32 v2, v2, v64, v65
    v_max3_u32 v2, v2, v66, v67
    v_max3_u32 v2, v2, v68, v69
    v_max3_u32 v2, v2, v70, v71
    v_max3_u32 v2, v2, v72, v73
    v_max3_u32 v2, v2, v74, v75
    v_max3_u32 v2, v2, v76, v77
    v_max3_u32 v2, v2, v78, v79
    v_cmp_eq_u32 vcc, -1, v2
    s_cbranch_vccnz L_nan_5r
    s_mov_b32 s54, 1
    v_mov_b32 v80, 0
    v_mov_b32 v81, 0
    v_mov_b32 v82, 0
    v_mov_b32 v83, 0
    v_mov_b32 v84, 0
    v_mov_b32 v85, 0
    v_mov_b32 v86, 0
    v_mov_b32 v87, 0
    v_mov_b32 v88, 0
    v_mov_b32 v89, 0
    v_mov_b32 v90, 0
    v_mov_b32 v91, 0
    s_branch L_got_3r
L_tw_11:
    buffer_load_dword v217, v216, s[4:7], s38 offen sc1
    buffer_load_dword v217, v216, s[4:7], s38 offen sc1
L_tw_11a:
    buffer_load_dword v217, v216, s[4:7], s38 offen sc1
    s_sub_u32 s36, s36, 1
    s_cbranch_scc1 L_exit
    s_waitcnt vmcnt(2)
    v_cmp_gt_u32 vcc, s37, v217
    s_cbranch_vccz L_tok_12
    s_branch L_tw_11a
L_pp_13:
L_pp_13a:
    s_waitcnt vmcnt(1)
    v_mfma_f32_16x16x32_bf16 v[196:199], v[210:213], v[188:191], 0
    v_mfma_f32_16x16x32_bf16 v[200:203], v[208:211], v[188:191], 0
    v_max3_u32 v221, v188, v189, v190
    s_waitcnt vmcnt(0)
    v_mfma_f32_16x16x32_bf16 v[196:199], v[210:213], v[192:195], v[196:199]
    v_max3_u32 v222, v191, v192, v193
    v_max3_u32 v221, v221, v194, v195
    v_mfma_f32_16x16x32_bf16 v[200:203], v[208:211], v[192:195], v[200:203]
    v_max_u32 v221, v221, v222
    v_cmp_eq_u32 vcc, -1, v221
    s_nop 2
    v_cvt_pk_bf16_f32 v204, v196, v197
    v_cvt_pk_bf16_f32 v205, v198, v199
    s_cbranch_vccnz L_pp_13b
    v_cvt_pk_bf16_f32 v206, v200, v201
    v_cvt_pk_bf16_f32 v207, v202, v203
    buffer_store_dwordx4 v[204:207], v218, s[4:7], s42 offen
    s_branch L_pc_14
L_pp_13b:
    buffer_load_dwordx4 v[188:191], v214, s[4:7], s55 offen sc1
    buffer_load_dwordx4 v[192:195], v215, s[4:7], s55 offen sc1
    s_sub_u32 s36, s36, 1
    s_cbranch_scc1 L_exit
    s_branch L_pp_13a
L_wo_f:
    s_mov_b32 s12, s80
    s_and_b32 s13, s81, 0xffff
    s_mov_b32 s14, 7864320
    s_mov_b32 s15, 0x20000
    s_mov_b32 s16, s72
    s_and_b32 s17, s73, 0xffff
    s_mov_b32 s18, 10240
    s_mov_b32 s19, 0x20000
    s_sub_u32 s40, s35, 12
    v_and_b32 v1, 15, v0
    v_lshrrev_b32 v2, 4, v0
    v_lshrrev_b32 v3, 3, v0
    v_and_b32 v4, 7, v0
    v_and_b32 v6, 2, v3
    v_xor_b32 v6, v6, v4
    v_lshlrev_b32 v6, 4, v6
    v_mul_u32_u24 v7, 1280, v3
    s_lshl_b32 s90, s34, 2
    s_add_u32 s90, s90, s32
    s_mul_i32 s90, s90, 245760
    s_lshl_b32 s91, s40, 7
    s_add_u32 s90, s90, s91
    v_add3_u32 v180, v6, v7, s90
    v_xor_b32 v181, 64, v180
    s_mul_i32 s90, s40, 49152
    s_lshl_b32 s91, s32, 11
    s_add_u32 s90, s90, s91
    s_lshl_b32 s91, s34, 8
    s_add_u32 s91, s91, s90
    v_lshlrev_b32 v6, 4, v1
    v_lshl_add_u32 v7, v2, 13, v6
    v_add_u32 v14, s91, v7
    v_lshlrev_b32 v12, 4, v0
    v_lshlrev_b32 v13, 2, v0
    v_add_u32 v46, s91, v13
    v_add_u32 v15, s90, v12
    v_add_u32 v16, 1024, v15
    v_add_u32 v45, 32768, v14
    v_add_u32 v46, 32768, v46
    v_cmp_eq_u32 vcc, 0, v2
    v_mov_b32 v9, 2146435072
    s_nop 0
    v_cndmask_b32 v45, v9, v45, vcc
    s_lshl_b32 s92, s40, 7
    s_lshl_b32 s93, s32, 2
    s_add_u32 s92, s92, s93
    s_add_u32 s92, s92, 165888
    v_mov_b32 v244, s92
    v_cmp_eq_u32 vcc, 0, v0
    v_mov_b32 v9, 2146435072
    s_nop 0
    v_cndmask_b32 v244, v9, v244, vcc
    v_cmp_ne_u32 vcc, s34, v2
    v_mov_b32 v9, 2146435072
    s_nop 0
    v_cndmask_b32 v15, v9, v15, vcc
    v_add_u32 v3, 4, v2
    v_cmp_ne_u32 vcc, s34, v3
    v_mov_b32 v9, 2146435072
    s_nop 0
    v_cndmask_b32 v16, v9, v16, vcc
    s_lshl_b32 s90, s40, 2
    s_add_u32 s90, s90, s32
    s_lshl_b32 s91, s90, 8
    v_add_u32 v17, s91, v6
    v_cmp_eq_u32 vcc, 0, v2
    v_mov_b32 v9, 2146435072
    s_nop 0
    v_cndmask_b32 v17, v9, v17, vcc
    v_lshrrev_b32 v3, 2, v1
    v_and_b32 v7, 1, v1
    v_lshl_or_b32 v4, v3, 1, v7
    v_mul_u32_u24 v4, 1280, v4
    v_and_b32 v5, 2, v1
    v_lshl_add_u32 v4, v5, 1, v4
    s_lshl_b32 s91, s90, 5
    v_add_u32 v4, s91, v4
    v_lshlrev_b32 v6, 6, v3
    v_lshl_add_u32 v6, v7, 5, v6
    v_lshl_add_u32 v6, v2, 3, v6
    v_lshl_add_u32 v6, v5, 1, v6
    s_mul_i32 s92, s32, 1152
    s_add_u32 s92, s92, 122880
    v_add_u32 v18, s92, v6
    buffer_load_dword v164, v4, s[16:19], 0 offen offset:0
    buffer_load_dword v165, v4, s[16:19], 0 offen offset:8
    buffer_load_dword v166, v4, s[16:19], 0 offen offset:16
    buffer_load_dword v167, v4, s[16:19], 0 offen offset:24
    v_mov_b32 v168, -1
    v_mov_b32 v169, -1
    v_mov_b32 v170, -1
    v_mov_b32 v171, -1
    s_mul_i32 s90, s32, 24576
    s_mov_b32 m0, s90
    s_mov_b32 s91, 0
    buffer_load_dwordx4 v180, s[12:15], s91 offen lds
    s_add_u32 m0, m0, 1024
    s_add_u32 s91, s91, 10240
    buffer_load_dwordx4 v181, s[12:15], s91 offen lds
    s_add_u32 m0, m0, 1024
    s_add_u32 s91, s91, 10240
    buffer_load_dwordx4 v180, s[12:15], s91 offen lds
    s_add_u32 m0, m0, 1024
    s_add_u32 s91, s91, 10240
    buffer_load_dwordx4 v181, s[12:15], s91 offen lds
    s_add_u32 m0, m0, 1024
    s_add_u32 s91, s91, 10240
    buffer_load_dwordx4 v180, s[12:15], s91 offen lds
    s_add_u32 m0, m0, 1024
    s_add_u32 s91, s91, 10240
    buffer_load_dwordx4 v181, s[12:15], s91 offen lds
    s_add_u32 m0, m0, 1024
    s_add_u32 s91, s91, 10240
    buffer_load_dwordx4 v180, s[12:15], s91 offen lds
    s_add_u32 m0, m0, 1024
    s_add_u32 s91, s91, 10240
    buffer_load_dwordx4 v181, s[12:15], s91 offen lds
    s_add_u32 m0, m0, 1024
    s_add_u32 s91, s91, 10240
    buffer_load_dwordx4 v180, s[12:15], s91 offen lds
    s_add_u32 m0, m0, 1024
    s_add_u32 s91, s91, 10240
    buffer_load_dwordx4 v181, s[12:15], s91 offen lds
    s_add_u32 m0, m0, 1024
    s_add_u32 s91, s91, 10240
    buffer_load_dwordx4 v180, s[12:15], s91 offen lds
    s_add_u32 m0, m0, 1024
    s_add_u32 s91, s91, 10240
    buffer_load_dwordx4 v181, s[12:15], s91 offen lds
    s_add_u32 m0, m0, 1024
    s_add_u32 s91, s91, 10240
    buffer_load_dwordx4 v180, s[12:15], s91 offen lds
    s_add_u32 m0, m0, 1024
    s_add_u32 s91, s91, 10240
    buffer_load_dwordx4 v181, s[12:15], s91 offen lds
    s_add_u32 m0, m0, 1024
    s_add_u32 s91, s91, 10240
    buffer_load_dwordx4 v180, s[12:15], s91 offen lds
    s_add_u32 m0, m0, 1024
    s_add_u32 s91, s91, 10240
    buffer_load_dwordx4 v181, s[12:15], s91 offen lds
    s_add_u32 m0, m0, 1024
    s_add_u32 s91, s91, 10240
    buffer_load_dwordx4 v180, s[12:15], s91 offen lds
    s_add_u32 m0, m0, 1024
    s_add_u32 s91, s91, 10240
    buffer_load_dwordx4 v181, s[12:15], s91 offen lds
    s_add_u32 m0, m0, 1024
    s_add_u32 s91, s91, 10240
    buffer_load_dwordx4 v180, s[12:15], s91 offen lds
    s_add_u32 m0, m0, 1024
    s_add_u32 s91, s91, 10240
    buffer_load_dwordx4 v181, s[12:15], s91 offen lds
    s_add_u32 m0, m0, 1024
    s_add_u32 s91, s91, 10240
    buffer_load_dwordx4 v180, s[12:15], s91 offen lds
    s_add_u32 m0, m0, 1024
    s_add_u32 s91, s91, 10240
    buffer_load_dwordx4 v181, s[12:15], s91 offen lds
    s_add_u32 m0, m0, 1024
    s_add_u32 s91, s91, 10240
    buffer_load_dwordx4 v180, s[12:15], s91 offen lds
    s_add_u32 m0, m0, 1024
    s_add_u32 s91, s91, 10240
    buffer_load_dwordx4 v181, s[12:15], s91 offen lds
    s_waitcnt vmcnt(24)
    v_min_u32 v164, -2, v164
    v_min_u32 v165, -2, v165
    v_min_u32 v166, -2, v166
    v_min_u32 v167, -2, v167
    v_and_b32 v7, 2, v1
    v_cmp_ne_u32 vcc, 0, v7
    v_mov_b32 v5, 0x4444
    v_mov_b32 v6, 0xeeee
    v_cndmask_b32 v10, v5, v6, vcc
    v_mov_b32 v5, 0xe484
    v_mov_b32 v6, 0xee9e
    v_cndmask_b32 v7, v5, v6, vcc
    v_mov_b32 v5, 0x84e4
    v_mov_b32 v6, 0x9eee
    v_cndmask_b32 v8, v5, v6, vcc
    v_cmp_gt_u32 vcc, 2, v2
    s_nop 1
    v_cndmask_b32 v11, v8, v7, vcc
    v_mov_b32 v84, 1065369472
    v_mov_b32 v85, 1065369472
    v_mov_b32 v86, 1065369472
    v_mov_b32 v87, 0
    v_mov_b32 v88, 1065369472
    v_mov_b32 v89, 1065369472
    v_mov_b32 v90, 1065369472
    v_mov_b32 v91, 0
    v_mov_b32 v51, 0
    v_mov_b32 v55, 0
    v_mov_b32 v59, 0
    v_mov_b32 v63, 0
    v_mov_b32 v67, 0
    v_mov_b32 v71, 0
    v_mov_b32 v75, 0
    v_mov_b32 v79, 0
    v_mov_b32 v210, 0
    v_mov_b32 v211, 0
    v_mov_b32 v218, 0
    v_mov_b32 v219, 0
    v_and_b32 v7, 1, v1
    v_cmp_ne_u32 vcc, 0, v7
    v_mov_b32 v5, 0x3f80
    v_mov_b32 v6, 0x3f800000
    v_cndmask_b32 v5, v5, v6, vcc
    v_bfe_u32 v6, v1, 1, 1
    v_cmp_eq_u32 vcc, 0, v6
    s_nop 1
    v_cndmask_b32 v110, 0, v5, vcc
    v_mov_b32 v108, 0
    v_mov_b32 v112, 0
    v_cmp_eq_u32 vcc, 1, v6
    s_nop 1
    v_cndmask_b32 v111, 0, v5, vcc
    v_mov_b32 v109, 0
    v_mov_b32 v113, 0
    v_mov_b32 v240, 0x3dd53b95
    v_mov_b32 v241, 0x3dd53b95
    s_lshl_b32 s90, s32, 8
    s_add_u32 s90, s90, 122880
    v_mul_u32_u24 v6, 1152, v2
    v_lshl_add_u32 v6, v1, 3, v6
    v_add_u32 v19, s90, v6
    s_mul_i32 s90, s32, 1536
    v_add_u32 v20, s90, v12
    s_add_u32 s90, s90, 1024
    v_lshl_add_u32 v21, v0, 3, s90
    s_mul_i32 s90, s32, 6144
    v_add_u32 v22, s90, v12
    s_add_u32 s90, s90, 1024
    v_lshl_add_u32 v23, v0, 3, s90
    v_add_u32 v28, 98304, v12
    s_mul_i32 s90, s32, 3072
    v_add_u32 v37, s90, v12
    v_add_u32 v44, 25600, v37
    s_add_u32 s54, s90, 98304
    s_mul_i32 s90, s32, 3840
    s_add_u32 s90, s90, 10240
    v_add_u32 v38, s90, v12
    s_add_u32 s90, s90, 1024
    v_add_u32 v39, s90, v13
    s_mul_i32 s90, s32, 12288
    v_add_u32 v40, s90, v12
    s_lshl_b32 s90, s40, 16
    s_lshl_b32 s92, s32, 11
    s_add_u32 s90, s90, s92
    s_lshl_b32 s91, s34, 8
    s_add_u32 s91, s91, s90
    v_lshlrev_b32 v6, 4, v1
    v_lshl_add_u32 v6, v2, 13, v6
    v_add_u32 v30, s91, v6
    s_lshl_b32 s91, s34, 13
    s_add_u32 s91, s91, s90
    v_add_u32 v31, s91, v12
    s_mul_i32 s91, s34, 10240
    s_lshl_b32 s92, s40, 7
    s_add_u32 s91, s91, s92
    s_lshl_b32 s92, s32, 5
    s_add_u32 s91, s91, s92
    s_add_u32 s91, s91, 1280
    v_mul_u32_u24 v6, 2560, v2
    v_lshl_add_u32 v6, v1, 1, v6
    v_add_u32 v32, s91, v6
    s_lshl_b32 s90, s32, 7
    v_add_u32 v5, s90, v13
    v_add_u32 v6, 163840, v5
    v_add_u32 v7, 164816, v5
    v_cmp_gt_u32 vcc, 12, v0
    s_nop 1
    v_cndmask_b32 v33, v7, v6, vcc
    v_mov_b32 v5, -2
    v_cndmask_b32 v34, v5, 3, vcc
    v_cmp_gt_u32 vcc, 14, v0
    v_mov_b32 v9, 2146435072
    s_nop 0
    v_cndmask_b32 v33, v9, v33, vcc
    v_mov_b32 v5, -1000
    v_cndmask_b32 v34, v5, v34, vcc
    v_and_b32 v4, 3, v1
    v_and_b32 v5, 1, v2
    v_lshl_add_u32 v6, v2, 3, v3
    v_lshlrev_b32 v6, 7, v6
    v_and_b32 v7, 2, v3
    v_lshl_or_b32 v7, v5, 2, v7
    v_lshrrev_b32 v8, 1, v4
    v_xor_b32 v7, v7, v8
    v_lshl_add_u32 v6, v7, 4, v6
    v_and_b32 v7, 1, v4
    v_lshl_add_u32 v6, v7, 3, v6
    s_mul_i32 s90, s32, 24576
    v_add_u32 v6, s90, v6
    v_xor_b32 v182, 0, v6
    v_xor_b32 v183, 32, v6
    v_xor_b32 v184, 64, v6
    v_xor_b32 v185, 96, v6
    s_waitcnt vmcnt(0)
    ds_read_b64_tr_b16 a[0:1], v182 offset:0
    ds_read_b64_tr_b16 a[2:3], v182 offset:512
    ds_read_b64_tr_b16 a[4:5], v182 offset:4096
    ds_read_b64_tr_b16 a[6:7], v182 offset:4608
    ds_read_b64_tr_b16 a[8:9], v182 offset:8192
    ds_read_b64_tr_b16 a[10:11], v182 offset:8704
    ds_read_b64_tr_b16 a[12:13], v182 offset:12288
    ds_read_b64_tr_b16 a[14:15], v182 offset:12800
    ds_read_b64_tr_b16 a[16:17], v182 offset:16384
    ds_read_b64_tr_b16 a[18:19], v182 offset:16896
    ds_read_b64_tr_b16 a[20:21], v182 offset:20480
    ds_read_b64_tr_b16 a[22:23], v182 offset:20992
    ds_read_b64_tr_b16 a[24:25], v183 offset:0
    ds_read_b64_tr_b16 a[26:27], v183 offset:512
    ds_read_b64_tr_b16 a[28:29], v183 offset:4096
    ds_read_b64_tr_b16 a[30:31], v183 offset:4608
    ds_read_b64_tr_b16 a[32:33], v183 offset:8192
    ds_read_b64_tr_b16 a[34:35], v183 offset:8704
    ds_read_b64_tr_b16 a[36:37], v183 offset:12288
    ds_read_b64_tr_b16 a[38:39], v183 offset:12800
    ds_read_b64_tr_b16 a[40:41], v183 offset:16384
    ds_read_b64_tr_b16 a[42:43], v183 offset:16896
    ds_read_b64_tr_b16 a[44:45], v183 offset:20480
    ds_read_b64_tr_b16 a[46:47], v183 offset:20992
    ds_read_b64_tr_b16 a[48:49], v184 offset:0
    ds_read_b64_tr_b16 a[50:51], v184 offset:512
    ds_read_b64_tr_b16 a[52:53], v184 offset:4096
    ds_read_b64_tr_b16 a[54:55], v184 offset:4608
    ds_read_b64_tr_b16 a[56:57], v184 offset:8192
    ds_read_b64_tr_b16 a[58:59], v184 offset:8704
    ds_read_b64_tr_b16 a[60:61], v184 offset:12288
    ds_read_b64_tr_b16 a[62:63], v184 offset:12800
    ds_read_b64_tr_b16 a[64:65], v184 offset:16384
    ds_read_b64_tr_b16 a[66:67], v184 offset:16896
    ds_read_b64_tr_b16 a[68:69], v184 offset:20480
    ds_read_b64_tr_b16 a[70:71], v184 offset:20992
    ds_read_b64_tr_b16 a[72:73], v185 offset:0
    ds_read_b64_tr_b16 a[74:75], v185 offset:512
    ds_read_b64_tr_b16 a[76:77], v185 offset:4096
    ds_read_b64_tr_b16 a[78:79], v185 offset:4608
    ds_read_b64_tr_b16 a[80:81], v185 offset:8192
    ds_read_b64_tr_b16 a[82:83], v185 offset:8704
    ds_read_b64_tr_b16 a[84:85], v185 offset:12288
    ds_read_b64_tr_b16 a[86:87], v185 offset:12800
    ds_read_b64_tr_b16 a[88:89], v185 offset:16384
    ds_read_b64_tr_b16 a[90:91], v185 offset:16896
    ds_read_b64_tr_b16 a[92:93], v185 offset:20480
    ds_read_b64_tr_b16 a[94:95], v185 offset:20992
    s_waitcnt lgkmcnt(0)
    s_barrier
    v_mov_b32 v1, 192
L_gw_15:
    buffer_load_dword v2, v1, s[8:11], 0 offen sc1
    s_sub_u32 s36, s36, 1
    s_cbranch_scc1 L_exit
    s_waitcnt vmcnt(0)
    v_readfirstlane_b32 s90, v2
    s_nop 0
    s_cmp_eq_u32 s90, 0
    s_cbranch_scc1 L_gw_15
    s_cmp_lg_u32 s90, 1
    s_cbranch_scc1 L_slow
    buffer_store_dwordx4 v[164:167], v17, s[4:7], s38 offen
    s_mov_b32 s37, -1
    v_add_u32 v35, -2, v34
    s_add_u32 s45, s38, 319488
    s_add_u32 s46, s45, 4096
    s_add_u32 s47, s45, 8192
    v_mov_b32 v24, v20
    v_mov_b32 v25, v21
    buffer_load_dword v36, v33, s[4:7], s38 offen sc1
    s_waitcnt vmcnt(0)
    v_cmp_lt_i32 vcc, v36, v35
    s_cbranch_vccz L_fok_17
L_fw_16:
    buffer_load_dword v36, v33, s[4:7], s38 offen sc1
    s_sub_u32 s36, s36, 1
    s_cbranch_scc1 L_exit
    s_waitcnt vmcnt(0)
    v_cmp_lt_i32 vcc, v36, v35
    s_cbranch_vccnz L_fw_16
L_fok_17:
    buffer_load_dwordx4 a[96:99], v40, s[4:7], s45 offen offset:0 sc1
    buffer_load_dwordx4 a[100:103], v40, s[4:7], s45 offen offset:1024 sc1
    buffer_load_dwordx4 a[104:107], v40, s[4:7], s45 offen offset:2048 sc1
    buffer_load_dwordx4 a[108:111], v40, s[4:7], s45 offen offset:3072 sc1
    buffer_load_dwordx4 a[112:115], v40, s[4:7], s46 offen offset:0 sc1
    buffer_load_dwordx4 a[116:119], v40, s[4:7], s46 offen offset:1024 sc1
    buffer_load_dwordx4 a[120:123], v40, s[4:7], s46 offen offset:2048 sc1
    buffer_load_dwordx4 a[124:127], v40, s[4:7], s46 offen offset:3072 sc1
    buffer_load_dwordx4 a[128:131], v40, s[4:7], s47 offen offset:0 sc1
    buffer_load_dwordx4 a[132:135], v40, s[4:7], s47 offen offset:1024 sc1
    buffer_load_dwordx4 a[136:139], v40, s[4:7], s47 offen offset:2048 sc1
    buffer_load_dwordx4 a[140:143], v40, s[4:7], s47 offen offset:3072 sc1
    s_waitcnt vmcnt(0)
    v_mfma_f32_16x16x32_bf16 v[148:151], a[96:99], a[0:3], 0
    v_mfma_f32_16x16x32_bf16 v[152:155], a[120:123], a[0:3], 0
    v_mfma_f32_16x16x32_bf16 v[148:151], a[100:103], a[4:7], v[148:151]
    v_mfma_f32_16x16x32_bf16 v[152:155], a[124:127], a[4:7], v[152:155]
    v_mfma_f32_16x16x32_bf16 v[148:151], a[104:107], a[8:11], v[148:151]
    v_mfma_f32_16x16x32_bf16 v[152:155], a[128:131], a[8:11], v[152:155]
    v_mfma_f32_16x16x32_bf16 v[148:151], a[108:111], a[12:15], v[148:151]
    v_mfma_f32_16x16x32_bf16 v[152:155], a[132:135], a[12:15], v[152:155]
    v_mfma_f32_16x16x32_bf16 v[148:151], a[112:115], a[16:19], v[148:151]
    v_mfma_f32_16x16x32_bf16 v[152:155], a[136:139], a[16:19], v[152:155]
    v_mfma_f32_16x16x32_bf16 v[148:151], a[116:119], a[20:23], v[148:151]
    v_mfma_f32_16x16x32_bf16 v[152:155], a[140:143], a[20:23], v[152:155]
    v_mfma_f32_16x16x32_bf16 v[156:159], a[96:99], a[24:27], 0
    v_mfma_f32_16x16x32_bf16 v[160:163], a[120:123], a[24:27], 0
    v_mfma_f32_16x16x32_bf16 v[156:159], a[100:103], a[28:31], v[156:159]
    v_mfma_f32_16x16x32_bf16 v[160:163], a[124:127], a[28:31], v[160:163]
    v_cvt_pk_bf16_f32 v48, v148, v149
    v_cvt_pk_bf16_f32 v49, v150, v151
    v_mfma_f32_16x16x32_bf16 v[156:159], a[104:107], a[32:35], v[156:159]
    v_cvt_pk_bf16_f32 v52, v152, v153
    v_cvt_pk_bf16_f32 v53, v154, v155
    v_mfma_f32_16x16x32_bf16 v[160:163], a[128:131], a[32:35], v[160:163]
    ds_write_b64 v24, v[48:49] offset:0
    ds_write_b64 v25, v[52:53] offset:0
    v_mfma_f32_16x16x32_bf16 v[156:159], a[108:111], a[36:39], v[156:159]
    v_mfma_f32_16x16x32_bf16 v[160:163], a[132:135], a[36:39], v[160:163]
    v_mfma_f32_16x16x32_bf16 v[156:159], a[112:115], a[40:43], v[156:159]
    v_mfma_f32_16x16x32_bf16 v[160:163], a[136:139], a[40:43], v[160:163]
    v_mfma_f32_16x16x32_bf16 v[156:159], a[116:119], a[44:47], v[156:159]
    v_mfma_f32_16x16x32_bf16 v[160:163], a[140:143], a[44:47], v[160:163]
    v_mfma_f32_16x16x32_bf16 v[148:151], a[96:99], a[48:51], 0
    v_mfma_f32_16x16x32_bf16 v[152:155], a[120:123], a[48:51], 0
    v_mfma_f32_16x16x32_bf16 v[148:151], a[100:103], a[52:55], v[148:151]
    v_mfma_f32_16x16x32_bf16 v[152:155], a[124:127], a[52:55], v[152:155]
    v_cvt_pk_bf16_f32 v56, v156, v157
    v_cvt_pk_bf16_f32 v57, v158, v159
    v_mfma_f32_16x16x32_bf16 v[148:151], a[104:107], a[56:59], v[148:151]
    v_cvt_pk_bf16_f32 v60, v160, v161
    v_cvt_pk_bf16_f32 v61, v162, v163
    v_mfma_f32_16x16x32_bf16 v[152:155], a[128:131], a[56:59], v[152:155]
    ds_write_b64 v24, v[56:57] offset:6144
    ds_write_b64 v25, v[60:61] offset:6144
    v_mfma_f32_16x16x32_bf16 v[148:151], a[108:111], a[60:63], v[148:151]
    v_mfma_f32_16x16x32_bf16 v[152:155], a[132:135], a[60:63], v[152:155]
    v_mfma_f32_16x16x32_bf16 v[148:151], a[112:115], a[64:67], v[148:151]
    v_mfma_f32_16x16x32_bf16 v[152:155], a[136:139], a[64:67], v[152:155]
    v_mfma_f32_16x16x32_bf16 v[148:151], a[116:119], a[68:71], v[148:151]
    v_mfma_f32_16x16x32_bf16 v[152:155], a[140:143], a[68:71], v[152:155]
    v_mfma_f32_16x16x32_bf16 v[156:159], a[96:99], a[72:75], 0
    v_mfma_f32_16x16x32_bf16 v[160:163], a[120:123], a[72:75], 0
    v_mfma_f32_16x16x32_bf16 v[156:159], a[100:103], a[76:79], v[156:159]
    v_mfma_f32_16x16x32_bf16 v[160:163], a[124:127], a[76:79], v[160:163]
    v_cvt_pk_bf16_f32 v64, v148, v149
    v_cvt_pk_bf16_f32 v65, v150, v151
    v_mfma_f32_16x16x32_bf16 v[156:159], a[104:107], a[80:83], v[156:159]
    v_cvt_pk_bf16_f32 v68, v152, v153
    v_cvt_pk_bf16_f32 v69, v154, v155
    v_mfma_f32_16x16x32_bf16 v[160:163], a[128:131], a[80:83], v[160:163]
    ds_write_b64 v24, v[64:65] offset:12288
    ds_write_b64 v25, v[68:69] offset:12288
    v_mfma_f32_16x16x32_bf16 v[156:159], a[108:111], a[84:87], v[156:159]
    v_mfma_f32_16x16x32_bf16 v[160:163], a[132:135], a[84:87], v[160:163]
    v_mfma_f32_16x16x32_bf16 v[156:159], a[112:115], a[88:91], v[156:159]
    v_mfma_f32_16x16x32_bf16 v[160:163], a[136:139], a[88:91], v[160:163]
    v_mfma_f32_16x16x32_bf16 v[156:159], a[116:119], a[92:95], v[156:159]
    v_mfma_f32_16x16x32_bf16 v[160:163], a[140:143], a[92:95], v[160:163]
    s_nop 4
    v_cvt_pk_bf16_f32 v72, v156, v157
    v_cvt_pk_bf16_f32 v73, v158, v159
    s_nop 0
    v_cvt_pk_bf16_f32 v76, v160, v161
    v_cvt_pk_bf16_f32 v77, v162, v163
    ds_write_b64 v24, v[72:73] offset:18432
    ds_write_b64 v25, v[76:77] offset:18432
    s_add_u32 s56, s37, 2
    s_and_b32 s55, s56, 7
    s_mul_i32 s55, s55, 172032
    s_add_u32 s55, s55, 319488
    s_add_u32 s45, s38, s55
    s_add_u32 s46, s45, 4096
    s_add_u32 s47, s45, 8192
    s_add_u32 s56, s37, -2
    s_and_b32 s55, s56, 3
    s_mul_i32 s55, s55, 24576
    v_add_u32 v26, s55, v22
    v_add_u32 v27, s55, v23
    s_and_b32 s55, s56, 1
    s_mul_i32 s55, s55, 12288
    v_add_u32 v29, s55, v28
    s_add_u32 s56, s37, -1
    s_and_b32 s55, s56, 7
    s_mul_i32 s55, s55, 172032
    s_add_u32 s55, s55, 208896
    s_add_u32 s48, s38, s55
    s_and_b32 s55, s56, 1
    s_add_u32 m0, s55, 12
    s_add_u32 s56, s56, 1
    v_add_u32 v35, s37, v34
    v_writelane_b32 v35, s56, m0
    s_mul_i32 s55, s55, 12288
    s_add_u32 m0, s54, s55
    buffer_load_dword v36, v33, s[4:7], s38 offen sc1
    s_waitcnt vmcnt(0)
    v_cmp_lt_i32 vcc, v36, v35
    s_cbranch_vccz L_fok_19
L_fw_18:
    buffer_load_dword v36, v33, s[4:7], s38 offen sc1
    s_sub_u32 s36, s36, 1
    s_cbranch_scc1 L_exit
    s_waitcnt vmcnt(0)
    v_cmp_lt_i32 vcc, v36, v35
    s_cbranch_vccnz L_fw_18
L_fok_19:
    buffer_load_dwordx4 a[96:99], v40, s[4:7], s45 offen offset:0 sc1
    buffer_load_dwordx4 a[100:103], v40, s[4:7], s45 offen offset:1024 sc1
    buffer_load_dwordx4 a[104:107], v40, s[4:7], s45 offen offset:2048 sc1
    buffer_load_dwordx4 a[108:111], v40, s[4:7], s45 offen offset:3072 sc1
    buffer_load_dwordx4 a[112:115], v40, s[4:7], s46 offen offset:0 sc1
    buffer_load_dwordx4 a[116:119], v40, s[4:7], s46 offen offset:1024 sc1
    buffer_load_dwordx4 a[120:123], v40, s[4:7], s46 offen offset:2048 sc1
    buffer_load_dwordx4 a[124:127], v40, s[4:7], s46 offen offset:3072 sc1
    buffer_load_dwordx4 a[128:131], v40, s[4:7], s47 offen offset:0 sc1
    buffer_load_dwordx4 a[132:135], v40, s[4:7], s47 offen offset:1024 sc1
    buffer_load_dwordx4 a[136:139], v40, s[4:7], s47 offen offset:2048 sc1
    buffer_load_dwordx4 a[140:143], v40, s[4:7], s47 offen offset:3072 sc1
    s_add_u32 s37, s37, 1
    s_and_b32 s55, s37, 3
    s_mul_i32 s56, s55, 40960
    s_add_u32 s43, s38, s56
    s_mul_i32 s41, s55, 491520
    s_xor_b32 s55, s55, 2
    s_mul_i32 s42, s55, 491520
    v_mov_b32 v47, v24
    s_add_u32 s56, s37, 1
    v_mov_b32 v107, s56
    s_and_b32 s55, s56, 3
    s_mul_i32 s55, s55, 24576
    v_add_u32 v24, s55, v20
    v_add_u32 v25, s55, v21
    s_add_u32 s56, s37, -3
    s_and_b32 s55, s56, 7
    s_mul_i32 s55, s55, 655360
    s_add_u32 s49, s55, 2097152
    s_add_u32 s50, s49, 32768
    s_add_u32 s56, s37, -5
    s_and_b32 s55, s56, 7
    s_mul_i32 s55, s55, 655360
    s_add_u32 s51, s55, 2097152
    s_mul_i32 s52, s56, 81920
    v_pk_mul_f32 v[148:149], v[210:211], v[210:211]
    v_pk_mul_f32 v[150:151], v[210:211], v[210:211]
    v_pk_mul_f32 v[152:153], v[210:211], v[210:211]
    v_pk_mul_f32 v[154:155], v[210:211], v[210:211]
    v_pk_mul_f32 v[156:157], v[210:211], v[210:211]
    v_pk_mul_f32 v[158:159], v[210:211], v[210:211]
    v_pk_mul_f32 v[160:161], v[210:211], v[210:211]
    v_pk_mul_f32 v[162:163], v[210:211], v[210:211]
    v_pk_mul_f32 v[116:117], v[210:211], v[210:211]
    v_pk_mul_f32 v[118:119], v[210:211], v[210:211]
    v_pk_mul_f32 v[120:121], v[210:211], v[210:211]
    v_pk_mul_f32 v[122:123], v[210:211], v[210:211]
    v_pk_mul_f32 v[124:125], v[210:211], v[210:211]
    v_pk_mul_f32 v[126:127], v[210:211], v[210:211]
    v_pk_mul_f32 v[128:129], v[210:211], v[210:211]
    v_pk_mul_f32 v[130:131], v[210:211], v[210:211]
    v_pk_mul_f32 v[132:133], v[210:211], v[210:211]
    v_pk_mul_f32 v[134:135], v[210:211], v[210:211]
L_wo_loop_f:
    buffer_load_dwordx4 v[136:139], v44, s[4:7], s43 offen offset:0 sc1
    buffer_load_dwordx4 v[140:143], v44, s[4:7], s43 offen offset:1024 sc1
    buffer_load_dwordx4 v[144:147], v44, s[4:7], s43 offen offset:2048 sc1
L_vm_20:
    buffer_load_dwordx4 v[136:139], v44, s[4:7], s43 offen offset:0 sc1
    buffer_load_dwordx4 v[140:143], v44, s[4:7], s43 offen offset:1024 sc1
    buffer_load_dwordx4 v[144:147], v44, s[4:7], s43 offen offset:2048 sc1
    s_sub_u32 s36, s36, 1
    s_cbranch_scc1 L_exit
    s_waitcnt vmcnt(3)
    v_max3_u32 v41, v136, v137, v138
    v_max3_u32 v42, v139, v140, v141
    v_max3_u32 v41, v41, v142, v143
    v_max3_u32 v42, v42, v144, v145
    v_max3_u32 v41, v41, v146, v147
    v_max_u32 v41, v41, v42
    v_cmp_eq_u32 vcc, -1, v41
    s_cbranch_vccnz L_vm_20
    v_smfmac_f32_16x16x64_bf16 v[148:151], v[136:139], a[0:7], v10
    v_smfmac_f32_16x16x64_bf16 v[148:151], v[140:143], a[8:15], v10
    v_smfmac_f32_16x16x64_bf16 v[148:151], v[144:147], a[16:23], v10
    v_smfmac_f32_16x16x64_bf16 v[152:155], v[136:139], a[24:31], v10
    v_smfmac_f32_16x16x64_bf16 v[152:155], v[140:143], a[32:39], v10
    v_smfmac_f32_16x16x64_bf16 v[152:155], v[144:147], a[40:47], v10
    v_smfmac_f32_16x16x64_bf16 v[156:159], v[136:139], a[48:55], v10
    v_smfmac_f32_16x16x64_bf16 v[156:159], v[140:143], a[56:63], v10
    v_smfmac_f32_16x16x64_bf16 v[156:159], v[144:147], a[64:71], v10
    v_smfmac_f32_16x16x64_bf16 v[160:163], v[136:139], a[72:79], v10
    v_smfmac_f32_16x16x64_bf16 v[160:163], v[140:143], a[80:87], v10
    v_smfmac_f32_16x16x64_bf16 v[160:163], v[144:147], a[88:95], v10
    buffer_load_dwordx4 v[92:95], v38, s[4:7], s43 offen offset:0 sc1
    buffer_load_dword v104, v39, s[4:7], s43 offen offset:0 sc1
    buffer_load_dwordx4 v[96:99], v38, s[4:7], s43 offen offset:1280 sc1
    buffer_load_dword v105, v39, s[4:7], s43 offen offset:1280 sc1
    buffer_load_dwordx4 v[100:103], v38, s[4:7], s43 offen offset:2560 sc1
    buffer_load_dword v106, v39, s[4:7], s43 offen offset:2560 sc1
    v_pk_add_f32 v[148:149], v[148:149], v[150:151]
    v_cvt_pk_bf16_f32 v50, v148, v149
    v_cvt_pk_bf16_f32 v54, v148, v149
    ds_write_b32 v47, v50 offset:8
    v_pk_add_f32 v[152:153], v[152:153], v[154:155]
    v_cvt_pk_bf16_f32 v58, v152, v153
    v_cvt_pk_bf16_f32 v62, v152, v153
    ds_write_b32 v47, v58 offset:6152
    v_pk_add_f32 v[156:157], v[156:157], v[158:159]
    v_cvt_pk_bf16_f32 v66, v156, v157
    v_cvt_pk_bf16_f32 v70, v156, v157
    ds_write_b32 v47, v66 offset:12296
    v_pk_add_f32 v[160:161], v[160:161], v[162:163]
    v_cvt_pk_bf16_f32 v74, v160, v161
    v_cvt_pk_bf16_f32 v78, v160, v161
    ds_write_b32 v47, v74 offset:18440
    s_cmp_eq_u32 s37, 63
    s_cbranch_scc1 L_wo_tail_f
    buffer_load_dwordx4 v[92:95], v38, s[4:7], s43 offen offset:0 sc1
    buffer_load_dword v104, v39, s[4:7], s43 offen offset:0 sc1
    buffer_load_dwordx4 v[96:99], v38, s[4:7], s43 offen offset:1280 sc1
    buffer_load_dword v105, v39, s[4:7], s43 offen offset:1280 sc1
    buffer_load_dwordx4 v[100:103], v38, s[4:7], s43 offen offset:2560 sc1
    buffer_load_dword v106, v39, s[4:7], s43 offen offset:2560 sc1
L_sc_21:
    s_waitcnt vmcnt(6)
    v_pk_add_f32 v[236:237], v[92:93], v[96:97]
    v_pk_add_f32 v[238:239], v[94:95], v[98:99]
    v_add_f32 v43, v104, v105
    v_pk_add_f32 v[236:237], v[236:237], v[100:101]
    v_pk_add_f32 v[238:239], v[238:239], v[102:103]
    v_add_f32 v43, v43, v106
    v_max3_f32 v41, v236, v237, v238
    v_max3_f32 v41, v41, v239, v43
    v_pk_add_f32 v[242:243], v[236:237], v[238:239]
    v_add_f32 v242, v242, v43
    v_max_f32_dpp v42, v41, v41 quad_perm:[2,3,0,1] row_mask:0xf bank_mask:0xf
    v_max_f32_dpp v41, v41, v41 quad_perm:[2,3,0,1] row_mask:0xf bank_mask:0xf
    v_cmp_u_f32 vcc, v242, v243
    s_nop 0
    v_permlane16_swap_b32 v41, v42
    v_max_f32 v41, v41, v42
    v_mov_b32 v42, v41
    s_cbranch_vccnz L_sp_22
L_sg_23:
    s_nop 0
    v_permlane32_swap_b32 v41, v42
    v_max_f32 v41, v41, v42
    v_mul_f32 v242, 0xbdd53b95, v41
    v_pk_fma_f32 v[236:237], v[236:237], v[240:241], v[242:243] op_sel_hi:[1,1,0]
    v_pk_fma_f32 v[238:239], v[238:239], v[240:241], v[242:243] op_sel_hi:[1,1,0]
    v_fma_f32 v43, v43, v240, v242
    v_exp_f32 v236, v236
    v_exp_f32 v237, v237
    v_exp_f32 v238, v238
    v_exp_f32 v239, v239
    v_exp_f32 v43, v43
    v_cvt_pk_bf16_f32 v80, v236, v237
    v_cvt_pk_bf16_f32 v82, v238, v239
    v_cvt_pk_bf16_f32 v81, v43, 0
    v_cvt_pk_bf16_f32 v83, v43, 0
    s_nop 1
    v_smfmac_f32_16x16x64_bf16 v[116:119], v[80:83], v[84:91], v11
    v_smfmac_f32_16x16x64_bf16 v[120:123], v[80:83], v[48:55], v11
    v_smfmac_f32_16x16x64_bf16 v[124:127], v[80:83], v[56:63], v11
    v_smfmac_f32_16x16x64_bf16 v[128:131], v[80:83], v[64:71], v11
    v_smfmac_f32_16x16x64_bf16 v[132:135], v[80:83], v[72:79], v11
    v_pk_add_f32 v[116:117], v[116:117], v[118:119]
    v_rcp_f32 v116, v116
    v_rcp_f32 v117, v117
    v_pk_add_f32 v[120:121], v[120:121], v[122:123]
    v_pk_add_f32 v[124:125], v[124:125], v[126:127]
    v_pk_add_f32 v[128:129], v[128:129], v[130:131]
    s_nop 1
    v_pk_add_f32 v[132:133], v[132:133], v[134:135]
    v_pk_mul_f32 v[120:121], v[120:121], v[116:117]
    v_cvt_pk_bf16_f32 v236, v120, v121
    v_pk_mul_f32 v[124:125], v[124:125], v[116:117]
    v_cvt_pk_bf16_f32 v237, v124, v125
    ds_write2st64_b32 v18, v236, v237 offset0:0 offset1:1
    v_pk_mul_f32 v[128:129], v[128:129], v[116:117]
    v_cvt_pk_bf16_f32 v238, v128, v129
    v_pk_mul_f32 v[132:133], v[132:133], v[116:117]
    v_cvt_pk_bf16_f32 v239, v132, v133
    ds_write2st64_b32 v18, v238, v239 offset0:2 offset1:3
    s_waitcnt lgkmcnt(0)
    s_barrier
    ds_read_b64_tr_b16 v[80:81], v19
    ds_read_b64_tr_b16 v[82:83], v19 offset:128
    s_waitcnt lgkmcnt(0)
    v_mfma_f32_16x16x32_bf16 v[172:175], v[110:113], v[80:83], 0
    v_mfma_f32_16x16x32_bf16 v[176:179], v[108:111], v[80:83], 0
    buffer_store_dword v107, v244, s[4:7], s38 offen
    s_nop 3
    v_cvt_pk_bf16_f32 v236, v172, v173
    v_cvt_pk_bf16_f32 v237, v174, v175
    s_nop 0
    v_cvt_pk_bf16_f32 v238, v176, v177
    v_cvt_pk_bf16_f32 v239, v178, v179
    buffer_store_dwordx4 v[236:239], v45, s[4:7], s41 offen
    buffer_store_dwordx4 v[236:239], v14, s[4:7], s41 offen sc1
    v_mfma_f32_16x16x32_bf16 v[148:151], a[96:99], a[0:3], 0
    buffer_load_dword v36, v33, s[4:7], s38 offen sc1
    v_mfma_f32_16x16x32_bf16 v[152:155], a[120:123], a[0:3], 0
    s_add_u32 s56, s37, 2
    v_mfma_f32_16x16x32_bf16 v[148:151], a[100:103], a[4:7], v[148:151]
    buffer_load_dwordx4 v[228:231], v31, s[4:7], s51 offen sc1
    buffer_load_dwordx4 v[232:235], v31, s[4:7], s51 offen offset:1024 sc1
    v_mfma_f32_16x16x32_bf16 v[152:155], a[124:127], a[4:7], v[152:155]
    s_and_b32 s55, s56, 7
    v_mfma_f32_16x16x32_bf16 v[148:151], a[104:107], a[8:11], v[148:151]
    s_mul_i32 s55, s55, 172032
    v_mfma_f32_16x16x32_bf16 v[152:155], a[128:131], a[8:11], v[152:155]
    buffer_store_dwordx4 v[220:223], v30, s[4:7], s49 offen sc1
    buffer_store_dwordx4 v[224:227], v30, s[4:7], s50 offen sc1
    v_mfma_f32_16x16x32_bf16 v[148:151], a[108:111], a[12:15], v[148:151]
    s_add_u32 s55, s55, 319488
    v_mfma_f32_16x16x32_bf16 v[152:155], a[132:135], a[12:15], v[152:155]
    s_add_u32 s45, s38, s55
    v_mfma_f32_16x16x32_bf16 v[148:151], a[112:115], a[16:19], v[148:151]
    buffer_store_dwordx4 v[168:171], v14, s[4:7], s42 offen sc1
    buffer_store_dword v168, v46, s[4:7], s42 offen
    v_mfma_f32_16x16x32_bf16 v[152:155], a[136:139], a[16:19], v[152:155]
    s_add_u32 s46, s45, 4096
    v_mfma_f32_16x16x32_bf16 v[148:151], a[116:119], a[20:23], v[148:151]
    s_add_u32 s47, s45, 8192
    v_mfma_f32_16x16x32_bf16 v[152:155], a[140:143], a[20:23], v[152:155]
    s_add_u32 s56, s37, -2
    v_mfma_f32_16x16x32_bf16 v[156:159], a[96:99], a[24:27], 0
    s_and_b32 s55, s56, 3
    v_mfma_f32_16x16x32_bf16 v[160:163], a[120:123], a[24:27], 0
    s_mul_i32 s55, s55, 24576
    v_mfma_f32_16x16x32_bf16 v[156:159], a[100:103], a[28:31], v[156:159]
    v_add_u32 v26, s55, v22
    v_mfma_f32_16x16x32_bf16 v[160:163], a[124:127], a[28:31], v[160:163]
    v_cvt_pk_bf16_f32 v48, v148, v149
    v_cvt_pk_bf16_f32 v49, v150, v151
    v_mfma_f32_16x16x32_bf16 v[156:159], a[104:107], a[32:35], v[156:159]
    v_cvt_pk_bf16_f32 v52, v152, v153
    v_cvt_pk_bf16_f32 v53, v154, v155
    v_mfma_f32_16x16x32_bf16 v[160:163], a[128:131], a[32:35], v[160:163]
    ds_write_b64 v24, v[48:49] offset:0
    ds_write_b64 v25, v[52:53] offset:0
    v_mfma_f32_16x16x32_bf16 v[156:159], a[108:111], a[36:39], v[156:159]
    v_add_u32 v27, s55, v23
    v_mfma_f32_16x16x32_bf16 v[160:163], a[132:135], a[36:39], v[160:163]
    s_and_b32 s55, s56, 1
    v_mfma_f32_16x16x32_bf16 v[156:159], a[112:115], a[40:43], v[156:159]
    s_mul_i32 s55, s55, 12288
    v_mfma_f32_16x16x32_bf16 v[160:163], a[136:139], a[40:43], v[160:163]
    v_add_u32 v29, s55, v28
    v_mfma_f32_16x16x32_bf16 v[156:159], a[116:119], a[44:47], v[156:159]
    s_add_u32 s56, s37, -1
    v_mfma_f32_16x16x32_bf16 v[160:163], a[140:143], a[44:47], v[160:163]
    s_and_b32 s55, s56, 7
    v_mfma_f32_16x16x32_bf16 v[148:151], a[96:99], a[48:51], 0
    s_mul_i32 s55, s55, 172032
    v_mfma_f32_16x16x32_bf16 v[152:155], a[120:123], a[48:51], 0
    s_add_u32 s55, s55, 208896
    v_mfma_f32_16x16x32_bf16 v[148:151], a[100:103], a[52:55], v[148:151]
    s_add_u32 s48, s38, s55
    v_mfma_f32_16x16x32_bf16 v[152:155], a[124:127], a[52:55], v[152:155]
    v_cvt_pk_bf16_f32 v56, v156, v157
    v_cvt_pk_bf16_f32 v57, v158, v159
    v_mfma_f32_16x16x32_bf16 v[148:151], a[104:107], a[56:59], v[148:151]
    v_cvt_pk_bf16_f32 v60, v160, v161
    v_cvt_pk_bf16_f32 v61, v162, v163
    v_mfma_f32_16x16x32_bf16 v[152:155], a[128:131], a[56:59], v[152:155]
    ds_write_b64 v24, v[56:57] offset:6144
    ds_write_b64 v25, v[60:61] offset:6144
    v_mfma_f32_16x16x32_bf16 v[148:151], a[108:111], a[60:63], v[148:151]
    s_and_b32 s55, s56, 1
    v_mfma_f32_16x16x32_bf16 v[152:155], a[132:135], a[60:63], v[152:155]
    s_add_u32 m0, s55, 12
    v_mfma_f32_16x16x32_bf16 v[148:151], a[112:115], a[64:67], v[148:151]
    s_add_u32 s56, s56, 1
    v_mfma_f32_16x16x32_bf16 v[152:155], a[136:139], a[64:67], v[152:155]
    v_add_u32 v35, s37, v34
    v_mfma_f32_16x16x32_bf16 v[148:151], a[116:119], a[68:71], v[148:151]
    v_writelane_b32 v35, s56, m0
    v_mfma_f32_16x16x32_bf16 v[152:155], a[140:143], a[68:71], v[152:155]
    s_mul_i32 s55, s55, 12288
    v_mfma_f32_16x16x32_bf16 v[156:159], a[96:99], a[72:75], 0
    s_add_u32 m0, s54, s55
    v_mfma_f32_16x16x32_bf16 v[160:163], a[120:123], a[72:75], 0
    v_mfma_f32_16x16x32_bf16 v[156:159], a[100:103], a[76:79], v[156:159]
    v_mfma_f32_16x16x32_bf16 v[160:163], a[124:127], a[76:79], v[160:163]
    v_cvt_pk_bf16_f32 v64, v148, v149
    v_cvt_pk_bf16_f32 v65, v150, v151
    v_mfma_f32_16x16x32_bf16 v[156:159], a[104:107], a[80:83], v[156:159]
    v_cvt_pk_bf16_f32 v68, v152, v153
    v_cvt_pk_bf16_f32 v69, v154, v155
    v_mfma_f32_16x16x32_bf16 v[160:163], a[128:131], a[80:83], v[160:163]
    ds_write_b64 v24, v[64:65] offset:12288
    ds_write_b64 v25, v[68:69] offset:12288
    v_mfma_f32_16x16x32_bf16 v[156:159], a[108:111], a[84:87], v[156:159]
    v_mfma_f32_16x16x32_bf16 v[160:163], a[132:135], a[84:87], v[160:163]
    v_mfma_f32_16x16x32_bf16 v[156:159], a[112:115], a[88:91], v[156:159]
    v_mfma_f32_16x16x32_bf16 v[160:163], a[136:139], a[88:91], v[160:163]
    v_mfma_f32_16x16x32_bf16 v[156:159], a[116:119], a[92:95], v[156:159]
    v_mfma_f32_16x16x32_bf16 v[160:163], a[140:143], a[92:95], v[160:163]
    s_nop 4
    v_cvt_pk_bf16_f32 v72, v156, v157
    v_cvt_pk_bf16_f32 v73, v158, v159
    s_nop 0
    v_cvt_pk_bf16_f32 v76, v160, v161
    v_cvt_pk_bf16_f32 v77, v162, v163
    ds_write_b64 v24, v[72:73] offset:18432
    ds_write_b64 v25, v[76:77] offset:18432
    s_waitcnt vmcnt(6)
    v_cmp_lt_i32 vcc, v36, v35
    s_cbranch_vccz L_fok_26
L_fw_25:
    buffer_load_dword v36, v33, s[4:7], s38 offen sc1
    s_sub_u32 s36, s36, 1
    s_cbranch_scc1 L_exit
    s_waitcnt vmcnt(0)
    v_cmp_lt_i32 vcc, v36, v35
    s_cbranch_vccnz L_fw_25
L_fok_26:
    buffer_load_dwordx4 v37, s[4:7], s48 offen offset:0 sc1 lds
    buffer_load_dwordx4 v37, s[4:7], s48 offen offset:1024 sc1 lds
    buffer_load_dwordx4 v37, s[4:7], s48 offen offset:2048 sc1 lds
    s_cmp_lt_u32 s37, 5
    s_cbranch_scc1 L_g_24
    s_waitcnt vmcnt(7)
    v_pk_add_f32 v[228:229], v[228:229], v[232:233]
    v_pk_add_f32 v[230:231], v[230:231], v[234:235]
    s_nop 1
    v_permlane32_swap_b32 v228, v230
    v_permlane32_swap_b32 v229, v231
    v_pk_add_f32 v[228:229], v[228:229], v[230:231]
    s_nop 1
    v_permlane16_swap_b32 v228, v229
    v_add_f32 v228, v228, v229
    v_cvt_pk_bf16_f32 v228, v228, v228
    buffer_store_short v228, v32, s[28:31], s52 offen
L_g_24:
    ds_read_b128 v[204:207], v26 offset:0
    ds_read_b128 v[180:183], v29 offset:0
    ds_read_b128 v[184:187], v29 offset:1024
    ds_read_b64 v[208:209], v27 offset:0
    ds_read_b128 v[188:191], v29 offset:2048
    ds_read_b128 v[212:215], v26 offset:1536
    ds_read_b128 v[192:195], v29 offset:3072
    ds_read_b128 v[196:199], v29 offset:4096
    ds_read_b64 v[216:217], v27 offset:1536
    ds_read_b128 v[200:203], v29 offset:5120
    buffer_load_dwordx4 a[96:99], v40, s[4:7], s45 offen offset:0 sc1
    buffer_load_dwordx4 a[100:103], v40, s[4:7], s45 offen offset:1024 sc1
    buffer_load_dwordx4 a[104:107], v40, s[4:7], s45 offen offset:2048 sc1
    s_add_u32 s37, s37, 1
    s_and_b32 s55, s37, 3
    s_mul_i32 s56, s55, 40960
    s_add_u32 s43, s38, s56
    s_mul_i32 s41, s55, 491520
    s_xor_b32 s55, s55, 2
    s_mul_i32 s42, s55, 491520
    v_mov_b32 v47, v24
    s_add_u32 s56, s37, 1
    v_mov_b32 v107, s56
    s_and_b32 s55, s56, 3
    s_waitcnt lgkmcnt(5)
    v_mfma_f32_16x16x32_bf16 v[220:223], v[180:183], v[204:207], 0
    v_mfma_f32_16x16x32_bf16 v[224:227], v[184:187], v[204:207], 0
    v_mfma_f32_16x16x32_bf16 v[224:227], v[188:191], v[208:211], v[224:227]
    ds_read_b128 v[204:207], v26 offset:3072
    ds_read_b128 v[180:183], v29 offset:6144
    ds_read_b128 v[184:187], v29 offset:7168
    ds_read_b64 v[208:209], v27 offset:3072
    ds_read_b128 v[188:191], v29 offset:8192
    buffer_load_dwordx4 a[108:111], v40, s[4:7], s45 offen offset:3072 sc1
    buffer_load_dwordx4 a[112:115], v40, s[4:7], s46 offen offset:0 sc1
    buffer_load_dwordx4 a[116:119], v40, s[4:7], s46 offen offset:1024 sc1
    s_mul_i32 s55, s55, 24576
    v_add_u32 v24, s55, v20
    v_add_u32 v25, s55, v21
    s_add_u32 s56, s37, -3
    s_and_b32 s55, s56, 7
    s_mul_i32 s55, s55, 655360
    s_add_u32 s49, s55, 2097152
    s_add_u32 s50, s49, 32768
    s_add_u32 s56, s37, -5
    s_and_b32 s55, s56, 7
    s_mul_i32 s55, s55, 655360
    s_waitcnt lgkmcnt(5)
    v_mfma_f32_16x16x32_bf16 v[220:223], v[192:195], v[212:215], v[220:223]
    v_mfma_f32_16x16x32_bf16 v[224:227], v[196:199], v[212:215], v[224:227]
    v_mfma_f32_16x16x32_bf16 v[224:227], v[200:203], v[216:219], v[224:227]
    ds_read_b128 v[212:215], v26 offset:4608
    ds_read_b128 v[192:195], v29 offset:9216
    ds_read_b128 v[196:199], v29 offset:10240
    ds_read_b64 v[216:217], v27 offset:4608
    ds_read_b128 v[200:203], v29 offset:11264
    buffer_load_dwordx4 a[120:123], v40, s[4:7], s46 offen offset:2048 sc1
    buffer_load_dwordx4 a[124:127], v40, s[4:7], s46 offen offset:3072 sc1
    buffer_load_dwordx4 a[128:131], v40, s[4:7], s47 offen offset:0 sc1
    s_add_u32 s51, s55, 2097152
    s_mul_i32 s52, s56, 81920
    v_pk_mul_f32 v[148:149], v[210:211], v[210:211]
    v_pk_mul_f32 v[150:151], v[210:211], v[210:211]
    v_pk_mul_f32 v[152:153], v[210:211], v[210:211]
    v_pk_mul_f32 v[154:155], v[210:211], v[210:211]
    v_pk_mul_f32 v[156:157], v[210:211], v[210:211]
    v_pk_mul_f32 v[158:159], v[210:211], v[210:211]
    v_pk_mul_f32 v[160:161], v[210:211], v[210:211]
    v_pk_mul_f32 v[162:163], v[210:211], v[210:211]
    v_pk_mul_f32 v[116:117], v[210:211], v[210:211]
    s_waitcnt lgkmcnt(5)
    v_mfma_f32_16x16x32_bf16 v[220:223], v[180:183], v[204:207], v[220:223]
    v_mfma_f32_16x16x32_bf16 v[224:227], v[184:187], v[204:207], v[224:227]
    v_mfma_f32_16x16x32_bf16 v[224:227], v[188:191], v[208:211], v[224:227]
    buffer_load_dwordx4 a[132:135], v40, s[4:7], s47 offen offset:1024 sc1
    buffer_load_dwordx4 a[136:139], v40, s[4:7], s47 offen offset:2048 sc1
    buffer_load_dwordx4 a[140:143], v40, s[4:7], s47 offen offset:3072 sc1
    v_pk_mul_f32 v[118:119], v[210:211], v[210:211]
    v_pk_mul_f32 v[120:121], v[210:211], v[210:211]
    v_pk_mul_f32 v[122:123], v[210:211], v[210:211]
    v_pk_mul_f32 v[124:125], v[210:211], v[210:211]
    v_pk_mul_f32 v[126:127], v[210:211], v[210:211]
    v_pk_mul_f32 v[128:129], v[210:211], v[210:211]
    v_pk_mul_f32 v[130:131], v[210:211], v[210:211]
    v_pk_mul_f32 v[132:133], v[210:211], v[210:211]
    v_pk_mul_f32 v[134:135], v[210:211], v[210:211]
    s_waitcnt lgkmcnt(0)
    v_mfma_f32_16x16x32_bf16 v[220:223], v[192:195], v[212:215], v[220:223]
    v_mfma_f32_16x16x32_bf16 v[224:227], v[196:199], v[212:215], v[224:227]
    v_mfma_f32_16x16x32_bf16 v[224:227], v[200:203], v[216:219], v[224:227]
    s_branch L_wo_loop_f
L_wo_tail_f:
    buffer_store_dwordx4 v[220:223], v30, s[4:7], s49 offen sc1
    buffer_store_dwordx4 v[224:227], v30, s[4:7], s50 offen sc1
    s_waitcnt vmcnt(0) lgkmcnt(0)
    s_barrier
    s_add_u32 s56, s37, -1
    s_and_b32 s55, s56, 7
    s_mul_i32 s55, s55, 172032
    s_add_u32 s55, s55, 208896
    s_add_u32 s48, s38, s55
    s_and_b32 s55, s56, 1
    s_add_u32 m0, s55, 12
    s_add_u32 s56, s56, 1
    v_mov_b32 v35, -16
    v_writelane_b32 v35, s56, m0
    s_mul_i32 s55, s55, 12288
    s_add_u32 m0, s54, s55
    buffer_load_dword v36, v33, s[4:7], s38 offen sc1
    s_add_u32 s56, s37, -2
    s_and_b32 s55, s56, 3
    s_mul_i32 s55, s55, 24576
    v_add_u32 v26, s55, v22
    v_add_u32 v27, s55, v23
    s_and_b32 s55, s56, 1
    s_mul_i32 s55, s55, 12288
    v_add_u32 v29, s55, v28
    s_add_u32 s56, s37, -2
    s_and_b32 s55, s56, 7
    s_mul_i32 s55, s55, 655360
    s_add_u32 s49, s55, 2097152
    s_add_u32 s50, s49, 32768
    ds_read_b128 v[204:207], v26 offset:0
    ds_read_b128 v[180:183], v29 offset:0
    ds_read_b128 v[184:187], v29 offset:1024
    ds_read_b64 v[208:209], v27 offset:0
    ds_read_b128 v[188:191], v29 offset:2048
    ds_read_b128 v[212:215], v26 offset:1536
    ds_read_b128 v[192:195], v29 offset:3072
    ds_read_b128 v[196:199], v29 offset:4096
    ds_read_b64 v[216:217], v27 offset:1536
    ds_read_b128 v[200:203], v29 offset:5120
    s_waitcnt lgkmcnt(5)
    v_mfma_f32_16x16x32_bf16 v[220:223], v[180:183], v[204:207], 0
    v_mfma_f32_16x16x32_bf16 v[224:227], v[184:187], v[204:207], 0
    v_mfma_f32_16x16x32_bf16 v[224:227], v[188:191], v[208:211], v[224:227]
    ds_read_b128 v[204:207], v26 offset:3072
    ds_read_b128 v[180:183], v29 offset:6144
    ds_read_b128 v[184:187], v29 offset:7168
    ds_read_b64 v[208:209], v27 offset:3072
    ds_read_b128 v[188:191], v29 offset:8192
    s_waitcnt lgkmcnt(5)
    v_mfma_f32_16x16x32_bf16 v[220:223], v[192:195], v[212:215], v[220:223]
    v_mfma_f32_16x16x32_bf16 v[224:227], v[196:199], v[212:215], v[224:227]
    v_mfma_f32_16x16x32_bf16 v[224:227], v[200:203], v[216:219], v[224:227]
    ds_read_b128 v[212:215], v26 offset:4608
    ds_read_b128 v[192:195], v29 offset:9216
    ds_read_b128 v[196:199], v29 offset:10240
    ds_read_b64 v[216:217], v27 offset:4608
    ds_read_b128 v[200:203], v29 offset:11264
    s_waitcnt lgkmcnt(5)
    v_mfma_f32_16x16x32_bf16 v[220:223], v[180:183], v[204:207], v[220:223]
    v_mfma_f32_16x16x32_bf16 v[224:227], v[184:187], v[204:207], v[224:227]
    v_mfma_f32_16x16x32_bf16 v[224:227], v[188:191], v[208:211], v[224:227]
    s_waitcnt lgkmcnt(0)
    v_mfma_f32_16x16x32_bf16 v[220:223], v[192:195], v[212:215], v[220:223]
    v_mfma_f32_16x16x32_bf16 v[224:227], v[196:199], v[212:215], v[224:227]
    v_mfma_f32_16x16x32_bf16 v[224:227], v[200:203], v[216:219], v[224:227]
    s_nop 0
    buffer_store_dwordx4 v[220:223], v30, s[4:7], s49 offen sc1
    s_nop 5
    buffer_store_dwordx4 v[224:227], v30, s[4:7], s50 offen sc1
    s_waitcnt vmcnt(2)
    v_cmp_lt_i32 vcc, v36, v35
    s_cbranch_vccz L_fok_28
L_fw_27:
    buffer_load_dword v36, v33, s[4:7], s38 offen sc1
    s_sub_u32 s36, s36, 1
    s_cbranch_scc1 L_exit
    s_waitcnt vmcnt(0)
    v_cmp_lt_i32 vcc, v36, v35
    s_cbranch_vccnz L_fw_27
L_fok_28:
    buffer_load_dwordx4 v37, s[4:7], s48 offen offset:0 sc1 lds
    buffer_load_dwordx4 v37, s[4:7], s48 offen offset:1024 sc1 lds
    buffer_load_dwordx4 v37, s[4:7], s48 offen offset:2048 sc1 lds
    s_waitcnt vmcnt(0) lgkmcnt(0)
    s_barrier
    s_add_u32 s56, s37, 0
    s_and_b32 s55, s56, 7
    s_mul_i32 s55, s55, 172032
    s_add_u32 s55, s55, 208896
    s_add_u32 s48, s38, s55
    s_and_b32 s55, s56, 1
    s_add_u32 m0, s55, 12
    s_add_u32 s56, s56, 1
    v_mov_b32 v35, -16
    v_writelane_b32 v35, s56, m0
    s_mul_i32 s55, s55, 12288
    s_add_u32 m0, s54, s55
    buffer_load_dword v36, v33, s[4:7], s38 offen sc1
    s_add_u32 s56, s37, -1
    s_and_b32 s55, s56, 3
    s_mul_i32 s55, s55, 24576
    v_add_u32 v26, s55, v22
    v_add_u32 v27, s55, v23
    s_and_b32 s55, s56, 1
    s_mul_i32 s55, s55, 12288
    v_add_u32 v29, s55, v28
    s_add_u32 s56, s37, -1
    s_and_b32 s55, s56, 7
    s_mul_i32 s55, s55, 655360
    s_add_u32 s49, s55, 2097152
    s_add_u32 s50, s49, 32768
    ds_read_b128 v[204:207], v26 offset:0
    ds_read_b128 v[180:183], v29 offset:0
    ds_read_b128 v[184:187], v29 offset:1024
    ds_read_b64 v[208:209], v27 offset:0
    ds_read_b128 v[188:191], v29 offset:2048
    ds_read_b128 v[212:215], v26 offset:1536
    ds_read_b128 v[192:195], v29 offset:3072
    ds_read_b128 v[196:199], v29 offset:4096
    ds_read_b64 v[216:217], v27 offset:1536
    ds_read_b128 v[200:203], v29 offset:5120
    s_waitcnt lgkmcnt(5)
    v_mfma_f32_16x16x32_bf16 v[220:223], v[180:183], v[204:207], 0
    v_mfma_f32_16x16x32_bf16 v[224:227], v[184:187], v[204:207], 0
    v_mfma_f32_16x16x32_bf16 v[224:227], v[188:191], v[208:211], v[224:227]
    ds_read_b128 v[204:207], v26 offset:3072
    ds_read_b128 v[180:183], v29 offset:6144
    ds_read_b128 v[184:187], v29 offset:7168
    ds_read_b64 v[208:209], v27 offset:3072
    ds_read_b128 v[188:191], v29 offset:8192
    s_waitcnt lgkmcnt(5)
    v_mfma_f32_16x16x32_bf16 v[220:223], v[192:195], v[212:215], v[220:223]
    v_mfma_f32_16x16x32_bf16 v[224:227], v[196:199], v[212:215], v[224:227]
    v_mfma_f32_16x16x32_bf16 v[224:227], v[200:203], v[216:219], v[224:227]
    ds_read_b128 v[212:215], v26 offset:4608
    ds_read_b128 v[192:195], v29 offset:9216
    ds_read_b128 v[196:199], v29 offset:10240
    ds_read_b64 v[216:217], v27 offset:4608
    ds_read_b128 v[200:203], v29 offset:11264
    s_waitcnt lgkmcnt(5)
    v_mfma_f32_16x16x32_bf16 v[220:223], v[180:183], v[204:207], v[220:223]
    v_mfma_f32_16x16x32_bf16 v[224:227], v[184:187], v[204:207], v[224:227]
    v_mfma_f32_16x16x32_bf16 v[224:227], v[188:191], v[208:211], v[224:227]
    s_waitcnt lgkmcnt(0)
    v_mfma_f32_16x16x32_bf16 v[220:223], v[192:195], v[212:215], v[220:223]
    v_mfma_f32_16x16x32_bf16 v[224:227], v[196:199], v[212:215], v[224:227]
    v_mfma_f32_16x16x32_bf16 v[224:227], v[200:203], v[216:219], v[224:227]
    s_nop 0
    buffer_store_dwordx4 v[220:223], v30, s[4:7], s49 offen sc1
    s_nop 5
    buffer_store_dwordx4 v[224:227], v30, s[4:7], s50 offen sc1
    s_waitcnt vmcnt(2)
    v_cmp_lt_i32 vcc, v36, v35
    s_cbranch_vccz L_fok_30
L_fw_29:
    buffer_load_dword v36, v33, s[4:7], s38 offen sc1
    s_sub_u32 s36, s36, 1
    s_cbranch_scc1 L_exit
    s_waitcnt vmcnt(0)
    v_cmp_lt_i32 vcc, v36, v35
    s_cbranch_vccnz L_fw_29
L_fok_30:
    buffer_load_dwordx4 v37, s[4:7], s48 offen offset:0 sc1 lds
    buffer_load_dwordx4 v37, s[4:7], s48 offen offset:1024 sc1 lds
    buffer_load_dwordx4 v37, s[4:7], s48 offen offset:2048 sc1 lds
    s_waitcnt vmcnt(0) lgkmcnt(0)
    s_barrier
    s_add_u32 s56, s37, 0
    s_and_b32 s55, s56, 3
    s_mul_i32 s55, s55, 24576
    v_add_u32 v26, s55, v22
    v_add_u32 v27, s55, v23
    s_and_b32 s55, s56, 1
    s_mul_i32 s55, s55, 12288
    v_add_u32 v29, s55, v28
    s_add_u32 s56, s37, 0
    s_and_b32 s55, s56, 7
    s_mul_i32 s55, s55, 655360
    s_add_u32 s49, s55, 2097152
    s_add_u32 s50, s49, 32768
    ds_read_b128 v[204:207], v26 offset:0
    ds_read_b128 v[180:183], v29 offset:0
    ds_read_b128 v[184:187], v29 offset:1024
    ds_read_b64 v[208:209], v27 offset:0
    ds_read_b128 v[188:191], v29 offset:2048
    ds_read_b128 v[212:215], v26 offset:1536
    ds_read_b128 v[192:195], v29 offset:3072
    ds_read_b128 v[196:199], v29 offset:4096
    ds_read_b64 v[216:217], v27 offset:1536
    ds_read_b128 v[200:203], v29 offset:5120
    s_waitcnt lgkmcnt(5)
    v_mfma_f32_16x16x32_bf16 v[220:223], v[180:183], v[204:207], 0
    v_mfma_f32_16x16x32_bf16 v[224:227], v[184:187], v[204:207], 0
    v_mfma_f32_16x16x32_bf16 v[224:227], v[188:191], v[208:211], v[224:227]
    ds_read_b128 v[204:207], v26 offset:3072
    ds_read_b128 v[180:183], v29 offset:6144
    ds_read_b128 v[184:187], v29 offset:7168
    ds_read_b64 v[208:209], v27 offset:3072
    ds_read_b128 v[188:191], v29 offset:8192
    s_waitcnt lgkmcnt(5)
    v_mfma_f32_16x16x32_bf16 v[220:223], v[192:195], v[212:215], v[220:223]
    v_mfma_f32_16x16x32_bf16 v[224:227], v[196:199], v[212:215], v[224:227]
    v_mfma_f32_16x16x32_bf16 v[224:227], v[200:203], v[216:219], v[224:227]
    ds_read_b128 v[212:215], v26 offset:4608
    ds_read_b128 v[192:195], v29 offset:9216
    ds_read_b128 v[196:199], v29 offset:10240
    ds_read_b64 v[216:217], v27 offset:4608
    ds_read_b128 v[200:203], v29 offset:11264
    s_waitcnt lgkmcnt(5)
    v_mfma_f32_16x16x32_bf16 v[220:223], v[180:183], v[204:207], v[220:223]
    v_mfma_f32_16x16x32_bf16 v[224:227], v[184:187], v[204:207], v[224:227]
    v_mfma_f32_16x16x32_bf16 v[224:227], v[188:191], v[208:211], v[224:227]
    s_waitcnt lgkmcnt(0)
    v_mfma_f32_16x16x32_bf16 v[220:223], v[192:195], v[212:215], v[220:223]
    v_mfma_f32_16x16x32_bf16 v[224:227], v[196:199], v[212:215], v[224:227]
    v_mfma_f32_16x16x32_bf16 v[224:227], v[200:203], v[216:219], v[224:227]
    s_nop 0
    buffer_store_dwordx4 v[220:223], v30, s[4:7], s49 offen sc1
    s_nop 5
    buffer_store_dwordx4 v[224:227], v30, s[4:7], s50 offen sc1
    s_waitcnt vmcnt(0)
    s_barrier
    buffer_store_dwordx4 v[84:87], v14, s[4:7], s41 offen sc1
    s_waitcnt vmcnt(0)
L_pc_31:
    buffer_load_dwordx4 v[164:167], v15, s[4:7], s41 offen sc1
    buffer_load_dwordx4 v[168:171], v16, s[4:7], s41 offen sc1
    s_sub_u32 s36, s36, 1
    s_cbranch_scc1 L_exit
    s_waitcnt vmcnt(0)
    v_max_u32 v41, v164, v168
    v_cmp_eq_u32 vcc, -1, v41
    s_cbranch_vccnz L_pc_31
    s_add_u32 s56, s37, -5
    s_and_b32 s55, s56, 7
    s_mul_i32 s55, s55, 655360
    s_add_u32 s51, s55, 2097152
    s_mul_i32 s52, s56, 81920
    buffer_load_dwordx4 v[228:231], v31, s[4:7], s51 offen sc1
    buffer_load_dwordx4 v[232:235], v31, s[4:7], s51 offen offset:1024 sc1
    s_waitcnt vmcnt(0)
    v_pk_add_f32 v[228:229], v[228:229], v[232:233]
    v_pk_add_f32 v[230:231], v[230:231], v[234:235]
    s_nop 1
    v_permlane32_swap_b32 v228, v230
    v_permlane32_swap_b32 v229, v231
    v_pk_add_f32 v[228:229], v[228:229], v[230:231]
    s_nop 1
    v_permlane16_swap_b32 v228, v229
    v_add_f32 v228, v228, v229
    v_cvt_pk_bf16_f32 v228, v228, v228
    buffer_store_short v228, v32, s[28:31], s52 offen
    s_add_u32 s56, s37, -4
    s_and_b32 s55, s56, 7
    s_mul_i32 s55, s55, 655360
    s_add_u32 s51, s55, 2097152
    s_mul_i32 s52, s56, 81920
    buffer_load_dwordx4 v[228:231], v31, s[4:7], s51 offen sc1
    buffer_load_dwordx4 v[232:235], v31, s[4:7], s51 offen offset:1024 sc1
    s_waitcnt vmcnt(0)
    v_pk_add_f32 v[228:229], v[228:229], v[232:233]
    v_pk_add_f32 v[230:231], v[230:231], v[234:235]
    s_nop 1
    v_permlane32_swap_b32 v228, v230
    v_permlane32_swap_b32 v229, v231
    v_pk_add_f32 v[228:229], v[228:229], v[230:231]
    s_nop 1
    v_permlane16_swap_b32 v228, v229
    v_add_f32 v228, v228, v229
    v_cvt_pk_bf16_f32 v228, v228, v228
    buffer_store_short v228, v32, s[28:31], s52 offen
    s_add_u32 s56, s37, -3
    s_and_b32 s55, s56, 7
    s_mul_i32 s55, s55, 655360
    s_add_u32 s51, s55, 2097152
    s_mul_i32 s52, s56, 81920
    buffer_load_dwordx4 v[228:231], v31, s[4:7], s51 offen sc1
    buffer_load_dwordx4 v[232:235], v31, s[4:7], s51 offen offset:1024 sc1
    s_waitcnt vmcnt(0)
    v_pk_add_f32 v[228:229], v[228:229], v[232:233]
    v_pk_add_f32 v[230:231], v[230:231], v[234:235]
    s_nop 1
    v_permlane32_swap_b32 v228, v230
    v_permlane32_swap_b32 v229, v231
    v_pk_add_f32 v[228:229], v[228:229], v[230:231]
    s_nop 1
    v_permlane16_swap_b32 v228, v229
    v_add_f32 v228, v228, v229
    v_cvt_pk_bf16_f32 v228, v228, v228
    buffer_store_short v228, v32, s[28:31], s52 offen
    s_add_u32 s56, s37, -2
    s_and_b32 s55, s56, 7
    s_mul_i32 s55, s55, 655360
    s_add_u32 s51, s55, 2097152
    s_mul_i32 s52, s56, 81920
    buffer_load_dwordx4 v[228:231], v31, s[4:7], s51 offen sc1
    buffer_load_dwordx4 v[232:235], v31, s[4:7], s51 offen offset:1024 sc1
    s_waitcnt vmcnt(0)
    v_pk_add_f32 v[228:229], v[228:229], v[232:233]
    v_pk_add_f32 v[230:231], v[230:231], v[234:235]
    s_nop 1
    v_permlane32_swap_b32 v228, v230
    v_permlane32_swap_b32 v229, v231
    v_pk_add_f32 v[228:229], v[228:229], v[230:231]
    s_nop 1
    v_permlane16_swap_b32 v228, v229
    v_add_f32 v228, v228, v229
    v_cvt_pk_bf16_f32 v228, v228, v228
    buffer_store_short v228, v32, s[28:31], s52 offen
    s_add_u32 s56, s37, -1
    s_and_b32 s55, s56, 7
    s_mul_i32 s55, s55, 655360
    s_add_u32 s51, s55, 2097152
    s_mul_i32 s52, s56, 81920
    buffer_load_dwordx4 v[228:231], v31, s[4:7], s51 offen sc1
    buffer_load_dwordx4 v[232:235], v31, s[4:7], s51 offen offset:1024 sc1
    s_waitcnt vmcnt(0)
    v_pk_add_f32 v[228:229], v[228:229], v[232:233]
    v_pk_add_f32 v[230:231], v[230:231], v[234:235]
    s_nop 1
    v_permlane32_swap_b32 v228, v230
    v_permlane32_swap_b32 v229, v231
    v_pk_add_f32 v[228:229], v[228:229], v[230:231]
    s_nop 1
    v_permlane16_swap_b32 v228, v229
    v_add_f32 v228, v228, v229
    v_cvt_pk_bf16_f32 v228, v228, v228
    buffer_store_short v228, v32, s[28:31], s52 offen
    s_add_u32 s56, s37, 0
    s_and_b32 s55, s56, 7
    s_mul_i32 s55, s55, 655360
    s_add_u32 s51, s55, 2097152
    s_mul_i32 s52, s56, 81920
    buffer_load_dwordx4 v[228:231], v31, s[4:7], s51 offen sc1
    buffer_load_dwordx4 v[232:235], v31, s[4:7], s51 offen offset:1024 sc1
    s_waitcnt vmcnt(0)
    v_pk_add_f32 v[228:229], v[228:229], v[232:233]
    v_pk_add_f32 v[230:231], v[230:231], v[234:235]
    s_nop 1
    v_permlane32_swap_b32 v228, v230
    v_permlane32_swap_b32 v229, v231
    v_pk_add_f32 v[228:229], v[228:229], v[230:231]
    s_nop 1
    v_permlane16_swap_b32 v228, v229
    v_add_f32 v228, v228, v229
    v_cvt_pk_bf16_f32 v228, v228, v228
    buffer_store_short v228, v32, s[28:31], s52 offen
    s_endpgm
L_sp_22:
    s_cmp_eq_u32 s55, -1
    s_cbranch_scc1 L_sg_23
    v_max3_u32 v4, v104, v105, v106
    v_max3_u32 v4, v4, v92, v93
    v_max3_u32 v4, v4, v94, v95
    v_max3_u32 v4, v4, v96, v97
    v_max3_u32 v4, v4, v98, v99
    v_max3_u32 v4, v4, v100, v101
    v_max3_u32 v4, v4, v102, v103
    v_cmp_eq_u32 vcc, -1, v4
    s_cbranch_vccnz L_sr_32
    s_mov_b32 s55, -1
    s_branch L_sc_21
L_sr_32:
    buffer_load_dwordx4 v[92:95], v38, s[4:7], s43 offen offset:0 sc1
    buffer_load_dword v104, v39, s[4:7], s43 offen offset:0 sc1
    buffer_load_dwordx4 v[96:99], v38, s[4:7], s43 offen offset:1280 sc1
    buffer_load_dword v105, v39, s[4:7], s43 offen offset:1280 sc1
    buffer_load_dwordx4 v[100:103], v38, s[4:7], s43 offen offset:2560 sc1
    buffer_load_dword v106, v39, s[4:7], s43 offen offset:2560 sc1
    s_sub_u32 s36, s36, 1
    s_cbranch_scc1 L_exit
    s_branch L_sc_21
L_px_f:
    s_sub_u32 s40, s35, 22
    v_and_b32 v1, 15, v0
    v_lshrrev_b32 v2, 4, v0
    s_mul_i32 s90, s32, 12288
    v_lshl_add_u32 v10, v0, 4, s90
    s_mul_i32 s90, s32, 3072
    v_lshl_add_u32 v12, v0, 4, s90
    v_lshrrev_b32 v3, 2, v1
    v_lshlrev_b32 v3, 1, v3
    v_and_b32 v4, 1, v1
    v_or_b32 v3, v3, v4
    v_lshl_add_u32 v3, v2, 3, v3
    v_lshl_add_u32 v11, v3, 4, s90
    s_lshl_b32 s90, s32, 7
    v_min_u32 v3, 11, v0
    v_lshl_add_u32 v3, v3, 2, s90
    v_add_u32 v13, 163840, v3
    v_min_u32 v3, 2, v0
    v_lshl_add_u32 v3, v3, 2, s90
    v_add_u32 v14, 164352, v3
    s_lshl_b32 s91, s40, 2
    s_add_u32 s90, s90, s91
    s_add_u32 s90, s90, 164864
    v_mov_b32 v15, s90
    v_cmp_eq_u32 vcc, 0, v0
    v_mov_b32 v9, 2146435072
    s_nop 0
    v_cndmask_b32 v15, v9, v15, vcc
    v_mov_b32 v24, -1
    v_mov_b32 v28, 0
    v_mov_b32 v25, -1
    v_mov_b32 v29, 0
    v_mov_b32 v26, -1
    v_mov_b32 v30, 0
    v_mov_b32 v27, -1
    v_mov_b32 v31, 0
    v_lshlrev_b32 v3, 4, v0
    s_lshl_b32 s91, s40, 2
    s_add_u32 s91, s91, s32
    s_lshl_b32 s92, s34, 3
    s_add_u32 s92, s92, s91
    s_mul_i32 s92, s92, 30720
    buffer_store_dwordx4 v[24:27], v3, s[4:7], s92 offen sc1
    s_add_u32 s92, s92, 1024
    buffer_store_dwordx4 v[24:27], v3, s[4:7], s92 offen sc1
    s_add_u32 s92, s92, 1024
    buffer_store_dwordx4 v[24:27], v3, s[4:7], s92 offen sc1
    s_add_u32 s92, s92, 1024
    buffer_store_dwordx4 v[24:27], v3, s[4:7], s92 offen sc1
    s_add_u32 s92, s92, 1024
    buffer_store_dwordx4 v[24:27], v3, s[4:7], s92 offen sc1
    s_add_u32 s92, s92, 1024
    buffer_store_dwordx4 v[24:27], v3, s[4:7], s92 offen sc1
    s_add_u32 s92, s92, 1024
    buffer_store_dwordx4 v[24:27], v3, s[4:7], s92 offen sc1
    s_add_u32 s92, s92, 1024
    buffer_store_dwordx4 v[24:27], v3, s[4:7], s92 offen sc1
    s_add_u32 s92, s92, 1024
    buffer_store_dwordx4 v[24:27], v3, s[4:7], s92 offen sc1
    s_add_u32 s92, s92, 1024
    buffer_store_dwordx4 v[24:27], v3, s[4:7], s92 offen sc1
    s_add_u32 s92, s92, 1024
    buffer_store_dwordx4 v[24:27], v3, s[4:7], s92 offen sc1
    s_add_u32 s92, s92, 1024
    buffer_store_dwordx4 v[24:27], v3, s[4:7], s92 offen sc1
    s_add_u32 s92, s92, 1024
    buffer_store_dwordx4 v[24:27], v3, s[4:7], s92 offen sc1
    s_add_u32 s92, s92, 1024
    buffer_store_dwordx4 v[24:27], v3, s[4:7], s92 offen sc1
    s_add_u32 s92, s92, 1024
    buffer_store_dwordx4 v[24:27], v3, s[4:7], s92 offen sc1
    s_add_u32 s92, s92, 1024
    buffer_store_dwordx4 v[24:27], v3, s[4:7], s92 offen sc1
    s_add_u32 s92, s92, 1024
    buffer_store_dwordx4 v[24:27], v3, s[4:7], s92 offen sc1
    s_add_u32 s92, s92, 1024
    buffer_store_dwordx4 v[24:27], v3, s[4:7], s92 offen sc1
    s_add_u32 s92, s92, 1024
    buffer_store_dwordx4 v[24:27], v3, s[4:7], s92 offen sc1
    s_add_u32 s92, s92, 1024
    buffer_store_dwordx4 v[24:27], v3, s[4:7], s92 offen sc1
    s_add_u32 s92, s92, 1024
    buffer_store_dwordx4 v[24:27], v3, s[4:7], s92 offen sc1
    s_add_u32 s92, s92, 1024
    buffer_store_dwordx4 v[24:27], v3, s[4:7], s92 offen sc1
    s_add_u32 s92, s92, 1024
    buffer_store_dwordx4 v[24:27], v3, s[4:7], s92 offen sc1
    s_add_u32 s92, s92, 1024
    buffer_store_dwordx4 v[24:27], v3, s[4:7], s92 offen sc1
    s_add_u32 s92, s92, 1024
    buffer_store_dwordx4 v[24:27], v3, s[4:7], s92 offen sc1
    s_add_u32 s92, s92, 1024
    buffer_store_dwordx4 v[24:27], v3, s[4:7], s92 offen sc1
    s_add_u32 s92, s92, 1024
    buffer_store_dwordx4 v[24:27], v3, s[4:7], s92 offen sc1
    s_add_u32 s92, s92, 1024
    buffer_store_dwordx4 v[24:27], v3, s[4:7], s92 offen sc1
    s_add_u32 s92, s92, 1024
    buffer_store_dwordx4 v[24:27], v3, s[4:7], s92 offen sc1
    s_add_u32 s92, s92, 1024
    buffer_store_dwordx4 v[24:27], v3, s[4:7], s92 offen sc1
    s_add_u32 s92, s92, 1024
    s_waitcnt vmcnt(30)
    s_mul_i32 s92, s91, 20480
    s_add_u32 s92, s92, s38
    buffer_store_dwordx4 v[24:27], v3, s[4:7], s92 offen
    s_add_u32 s92, s92, 1024
    buffer_store_dwordx4 v[24:27], v3, s[4:7], s92 offen
    s_add_u32 s92, s92, 1024
    buffer_store_dwordx4 v[24:27], v3, s[4:7], s92 offen
    s_add_u32 s92, s92, 1024
    buffer_store_dwordx4 v[24:27], v3, s[4:7], s92 offen
    s_add_u32 s92, s92, 1024
    buffer_store_dwordx4 v[24:27], v3, s[4:7], s92 offen
    s_add_u32 s92, s92, 1024
    buffer_store_dwordx4 v[24:27], v3, s[4:7], s92 offen
    s_add_u32 s92, s92, 1024
    buffer_store_dwordx4 v[24:27], v3, s[4:7], s92 offen
    s_add_u32 s92, s92, 1024
    buffer_store_dwordx4 v[24:27], v3, s[4:7], s92 offen
    s_add_u32 s92, s92, 1024
    buffer_store_dwordx4 v[24:27], v3, s[4:7], s92 offen
    s_add_u32 s92, s92, 1024
    buffer_store_dwordx4 v[24:27], v3, s[4:7], s92 offen
    s_add_u32 s92, s92, 1024
    buffer_store_dwordx4 v[24:27], v3, s[4:7], s92 offen
    s_add_u32 s92, s92, 1024
    buffer_store_dwordx4 v[24:27], v3, s[4:7], s92 offen
    s_add_u32 s92, s92, 1024
    buffer_store_dwordx4 v[24:27], v3, s[4:7], s92 offen
    s_add_u32 s92, s92, 1024
    buffer_store_dwordx4 v[24:27], v3, s[4:7], s92 offen
    s_add_u32 s92, s92, 1024
    buffer_store_dwordx4 v[24:27], v3, s[4:7], s92 offen
    s_add_u32 s92, s92, 1024
    buffer_store_dwordx4 v[24:27], v3, s[4:7], s92 offen
    s_add_u32 s92, s92, 1024
    buffer_store_dwordx4 v[24:27], v3, s[4:7], s92 offen
    s_add_u32 s92, s92, 1024
    buffer_store_dwordx4 v[24:27], v3, s[4:7], s92 offen
    s_add_u32 s92, s92, 1024
    buffer_store_dwordx4 v[24:27], v3, s[4:7], s92 offen
    s_add_u32 s92, s92, 1024
    buffer_store_dwordx4 v[24:27], v3, s[4:7], s92 offen
    s_add_u32 s92, s92, 1024
    s_lshl_b32 s92, s91, 8
    s_add_u32 s92, s92, 163840
    s_add_u32 s92, s92, s38
    v_lshlrev_b32 v3, 2, v0
    buffer_store_dword v28, v3, s[4:7], s92 offen
    buffer_store_dword v28, v3, s[4:7], s92 offen offset:2048
    v_mov_b32 v21, 0xd04e79ff
    s_mov_b32 s44, 0x3dd53b95
    v_lshl_add_u32 v3, v2, 2, 0
    v_cmp_le_u32 s[48:49], v3, v1
    v_lshl_add_u32 v3, v2, 2, 1
    v_cmp_le_u32 s[50:51], v3, v1
    v_lshl_add_u32 v3, v2, 2, 2
    v_cmp_le_u32 s[52:53], v3, v1
    v_lshl_add_u32 v3, v2, 2, 3
    v_cmp_le_u32 s[54:55], v3, v1
    v_mov_b32 v167, 0
    v_mov_b32 v171, 0
    v_mov_b32 v174, 0
    v_mov_b32 v175, 0
    s_waitcnt vmcnt(0)
    s_barrier
    s_mov_b32 s24, s70
    s_and_b32 s25, s71, 0xffff
    s_mov_b32 s26, 2621440
    s_mov_b32 s27, 0x20000
    s_mul_i32 s90, s32, 10240
    v_lshl_add_u32 v22, v0, 4, s90
    s_mov_b32 s37, s40
    s_cmp_lg_u32 s32, 0
    s_cbranch_scc1 L_arr_33
    v_mov_b32 v1, 64
    v_mov_b32 v2, 1
    s_mov_b64 exec, 1
    buffer_atomic_add v2, v1, s[8:11], 0 offen sc0 sc1
    s_waitcnt vmcnt(0)
    v_readfirstlane_b32 s90, v2
    s_mov_b64 exec, -1
    s_cmp_lg_u32 s90, 15
    s_cbranch_scc1 L_arr_33
    v_lshlrev_b32 v1, 2, v0
L_arp_34:
    buffer_load_dword v2, v1, s[8:11], 0 offen sc1
    s_sub_u32 s36, s36, 1
    s_cbranch_scc1 L_exit
    s_waitcnt vmcnt(0)
    v_readlane_b32 s92, v2, 48
    v_cmp_eq_u32 s[90:91], 32, v2
    s_cmp_lg_u32 s92, 0
    s_cbranch_scc1 L_arr_33
    s_and_b32 s90, s90, s91
    s_and_b32 s90, s90, 15
    s_cmp_lg_u32 s90, 15
    s_cbranch_scc1 L_arp_34
    v_mov_b32 v1, 192
    v_mov_b32 v2, 1
    s_mov_b64 exec, 1
    buffer_store_dword v2, v1, s[8:11], 0 offen sc1
    s_mov_b64 exec, -1
L_arr_33:
    s_cmp_eq_u32 s40, 1
    s_cbranch_scc1 L_xp_35
    s_cmp_lg_u32 s32, 0
    s_cbranch_scc1 L_xg_36
    s_lshl_b32 s92, s34, 14
    s_add_u32 s92, s92, 1966080
    s_add_u32 s93, s92, 8192
    v_lshlrev_b32 v3, 4, v0
    buffer_store_dwordx4 v[24:27], v3, s[4:7], s92 offen sc1
    buffer_store_dwordx4 v[24:27], v3, s[4:7], s93 offen sc1
    v_mov_b32 v3, 0
    s_mov_b32 s56, -1
    s_mov_b32 s57, -1
    s_mov_b32 s62, 0
    s_waitcnt vmcnt(0)
L_pr_37:
    s_memtime s[58:59]
    s_waitcnt lgkmcnt(0)
    buffer_load_dword v4, v3, s[4:7], s92 offen sc1
    s_waitcnt vmcnt(0)
    s_memtime s[60:61]
    s_waitcnt lgkmcnt(0)
    s_sub_u32 s60, s60, s58
    s_min_u32 s56, s56, s60
    s_memtime s[58:59]
    s_waitcnt lgkmcnt(0)
    buffer_load_dword v4, v3, s[4:7], s93 offen sc1
    s_waitcnt vmcnt(0)
    s_memtime s[60:61]
    s_waitcnt lgkmcnt(0)
    s_sub_u32 s60, s60, s58
    s_min_u32 s57, s57, s60
    v_add_u32 v3, 128, v3
    s_add_u32 s62, s62, 1
    s_cmp_lt_u32 s62, 6
    s_cbranch_scc1 L_pr_37
    s_cmp_lt_u32 s57, s56
    s_cselect_b32 s62, 2, 1
L_xg_36:
    s_barrier
    s_branch L_xg_36x
L_xp_35:
    s_add_u32 s90, s37, 1
    s_min_u32 s90, s90, 63
    s_mul_i32 s90, s90, 40960
    buffer_load_dwordx4 v[248:251], v22, s[24:27], s90 offen offset:0
    buffer_load_dwordx4 v[248:251], v22, s[24:27], s90 offen offset:1024
    buffer_load_dwordx4 v[248:251], v22, s[24:27], s90 offen offset:2048
    buffer_load_dwordx4 v[248:251], v22, s[24:27], s90 offen offset:3072
    s_add_u32 s90, s90, 4096
    buffer_load_dwordx4 v[248:251], v22, s[24:27], s90 offen offset:0
    buffer_load_dwordx4 v[248:251], v22, s[24:27], s90 offen offset:1024
    buffer_load_dwordx4 v[248:251], v22, s[24:27], s90 offen offset:2048
    buffer_load_dwordx4 v[248:251], v22, s[24:27], s90 offen offset:3072
    s_add_u32 s90, s90, 4096
    buffer_load_dwordx4 v[248:251], v22, s[24:27], s90 offen offset:0
    buffer_load_dwordx4 v[248:251], v22, s[24:27], s90 offen offset:1024
    s_add_u32 s90, s37, 2
    s_min_u32 s90, s90, 63
    s_mul_i32 s90, s90, 40960
    buffer_load_dwordx4 v[248:251], v22, s[24:27], s90 offen offset:0
    buffer_load_dwordx4 v[248:251], v22, s[24:27], s90 offen offset:1024
    buffer_load_dwordx4 v[248:251], v22, s[24:27], s90 offen offset:2048
    buffer_load_dwordx4 v[248:251], v22, s[24:27], s90 offen offset:3072
    s_add_u32 s90, s90, 4096
    buffer_load_dwordx4 v[248:251], v22, s[24:27], s90 offen offset:0
    buffer_load_dwordx4 v[248:251], v22, s[24:27], s90 offen offset:1024
    buffer_load_dwordx4 v[248:251], v22, s[24:27], s90 offen offset:2048
    buffer_load_dwordx4 v[248:251], v22, s[24:27], s90 offen offset:3072
    s_add_u32 s90, s90, 4096
    buffer_load_dwordx4 v[248:251], v22, s[24:27], s90 offen offset:0
    buffer_load_dwordx4 v[248:251], v22, s[24:27], s90 offen offset:1024
    s_add_u32 s90, s37, 3
    s_min_u32 s90, s90, 63
    s_mul_i32 s90, s90, 40960
    buffer_load_dwordx4 v[248:251], v22, s[24:27], s90 offen offset:0
    buffer_load_dwordx4 v[248:251], v22, s[24:27], s90 offen offset:1024
    buffer_load_dwordx4 v[248:251], v22, s[24:27], s90 offen offset:2048
    buffer_load_dwordx4 v[248:251], v22, s[24:27], s90 offen offset:3072
    s_add_u32 s90, s90, 4096
    buffer_load_dwordx4 v[248:251], v22, s[24:27], s90 offen offset:0
    buffer_load_dwordx4 v[248:251], v22, s[24:27], s90 offen offset:1024
    buffer_load_dwordx4 v[248:251], v22, s[24:27], s90 offen offset:2048
    buffer_load_dwordx4 v[248:251], v22, s[24:27], s90 offen offset:3072
    s_add_u32 s90, s90, 4096
    buffer_load_dwordx4 v[248:251], v22, s[24:27], s90 offen offset:0
    buffer_load_dwordx4 v[248:251], v22, s[24:27], s90 offen offset:1024
    s_add_u32 s90, s37, 4
    s_min_u32 s90, s90, 63
    s_mul_i32 s90, s90, 40960
    buffer_load_dwordx4 v[248:251], v22, s[24:27], s90 offen offset:0
    buffer_load_dwordx4 v[248:251], v22, s[24:27], s90 offen offset:1024
    buffer_load_dwordx4 v[248:251], v22, s[24:27], s90 offen offset:2048
    buffer_load_dwordx4 v[248:251], v22, s[24:27], s90 offen offset:3072
    s_add_u32 s90, s90, 4096
    buffer_load_dwordx4 v[248:251], v22, s[24:27], s90 offen offset:0
    buffer_load_dwordx4 v[248:251], v22, s[24:27], s90 offen offset:1024
    buffer_load_dwordx4 v[248:251], v22, s[24:27], s90 offen offset:2048
    buffer_load_dwordx4 v[248:251], v22, s[24:27], s90 offen offset:3072
    s_add_u32 s90, s90, 4096
    buffer_load_dwordx4 v[248:251], v22, s[24:27], s90 offen offset:0
    buffer_load_dwordx4 v[248:251], v22, s[24:27], s90 offen offset:1024
    s_add_u32 s90, s37, 5
    s_min_u32 s90, s90, 63
    s_mul_i32 s90, s90, 40960
    buffer_load_dwordx4 v[248:251], v22, s[24:27], s90 offen offset:0
    buffer_load_dwordx4 v[248:251], v22, s[24:27], s90 offen offset:1024
    buffer_load_dwordx4 v[248:251], v22, s[24:27], s90 offen offset:2048
    buffer_load_dwordx4 v[248:251], v22, s[24:27], s90 offen offset:3072
    s_add_u32 s90, s90, 4096
    buffer_load_dwordx4 v[248:251], v22, s[24:27], s90 offen offset:0
    buffer_load_dwordx4 v[248:251], v22, s[24:27], s90 offen offset:1024
    buffer_load_dwordx4 v[248:251], v22, s[24:27], s90 offen offset:2048
    buffer_load_dwordx4 v[248:251], v22, s[24:27], s90 offen offset:3072
    s_add_u32 s90, s90, 4096
    buffer_load_dwordx4 v[248:251], v22, s[24:27], s90 offen offset:0
    buffer_load_dwordx4 v[248:251], v22, s[24:27], s90 offen offset:1024
    s_add_u32 s90, s37, 6
    s_min_u32 s90, s90, 63
    s_mul_i32 s90, s90, 40960
    buffer_load_dwordx4 v[248:251], v22, s[24:27], s90 offen offset:0
    buffer_load_dwordx4 v[248:251], v22, s[24:27], s90 offen offset:1024
    buffer_load_dwordx4 v[248:251], v22, s[24:27], s90 offen offset:2048
    buffer_load_dwordx4 v[248:251], v22, s[24:27], s90 offen offset:3072
    s_add_u32 s90, s90, 4096
    buffer_load_dwordx4 v[248:251], v22, s[24:27], s90 offen offset:0
    buffer_load_dwordx4 v[248:251], v22, s[24:27], s90 offen offset:1024
    buffer_load_dwordx4 v[248:251], v22, s[24:27], s90 offen offset:2048
    buffer_load_dwordx4 v[248:251], v22, s[24:27], s90 offen offset:3072
    s_add_u32 s90, s90, 4096
    buffer_load_dwordx4 v[248:251], v22, s[24:27], s90 offen offset:0
    buffer_load_dwordx4 v[248:251], v22, s[24:27], s90 offen offset:1024
L_xg_36x:
    v_mov_b32 v1, 192
L_gw_38:
    buffer_load_dword v2, v1, s[8:11], 0 offen sc1
    s_sub_u32 s36, s36, 1
    s_cbranch_scc1 L_exit
    s_waitcnt vmcnt(0)
    v_readfirstlane_b32 s90, v2
    s_nop 0
    s_cmp_eq_u32 s90, 0
    s_cbranch_scc1 L_gw_38
    s_cmp_lg_u32 s90, 1
    s_cbranch_scc1 L_slow
    s_or_b32 s90, s40, s32
    s_cbranch_scc1 L_xg_36y
    v_mov_b32 v3, 165376
    v_mov_b32 v4, s62
    buffer_store_dword v4, v3, s[4:7], s38 offen
L_xg_36y:
L_px_loop_f:
    s_and_b32 s90, s37, 7
    s_mul_i32 s91, s90, 172032
    s_add_u32 s91, s91, 196608
    s_add_u32 s41, s38, s91
    s_add_u32 s42, s41, 0
    s_add_u32 s43, s41, 12288
    s_add_u32 s90, s37, 1
    v_mov_b32 v17, s90
    s_add_u32 s90, s37, 8
    s_min_u32 s90, s90, 63
    s_mul_i32 s90, s90, 40960
    buffer_load_dwordx4 v[248:251], v22, s[24:27], s90 offen offset:0
    buffer_load_dwordx4 v[248:251], v22, s[24:27], s90 offen offset:1024
    buffer_load_dwordx4 v[248:251], v22, s[24:27], s90 offen offset:2048
    buffer_load_dwordx4 v[248:251], v22, s[24:27], s90 offen offset:3072
    s_add_u32 s90, s90, 4096
    buffer_load_dwordx4 v[248:251], v22, s[24:27], s90 offen offset:0
    buffer_load_dwordx4 v[248:251], v22, s[24:27], s90 offen offset:1024
    buffer_load_dwordx4 v[248:251], v22, s[24:27], s90 offen offset:2048
    buffer_load_dwordx4 v[248:251], v22, s[24:27], s90 offen offset:3072
    s_add_u32 s90, s90, 4096
    buffer_load_dwordx4 v[248:251], v22, s[24:27], s90 offen offset:0
    buffer_load_dwordx4 v[248:251], v22, s[24:27], s90 offen offset:1024
L_pf_39:
    buffer_load_dword v16, v13, s[4:7], s38 offen sc1
    s_sub_u32 s36, s36, 1
    s_cbranch_scc1 L_exit
    s_waitcnt vmcnt(0)
    v_cmp_ge_u32 vcc, s37, v16
    s_cbranch_vccnz L_pf_39
    s_add_u32 s90, s41, 24576
    buffer_load_dwordx4 v[24:27], v10, s[4:7], s90 offen offset:0 sc1
    buffer_load_dwordx4 v[28:31], v10, s[4:7], s90 offen offset:1024 sc1
    buffer_load_dwordx4 v[32:35], v10, s[4:7], s90 offen offset:2048 sc1
    buffer_load_dwordx4 v[36:39], v10, s[4:7], s90 offen offset:3072 sc1
    s_add_u32 s90, s41, 28672
    buffer_load_dwordx4 v[40:43], v10, s[4:7], s90 offen offset:0 sc1
    buffer_load_dwordx4 v[44:47], v10, s[4:7], s90 offen offset:1024 sc1
    buffer_load_dwordx4 v[48:51], v10, s[4:7], s90 offen offset:2048 sc1
    buffer_load_dwordx4 v[52:55], v10, s[4:7], s90 offen offset:3072 sc1
    s_add_u32 s90, s41, 32768
    buffer_load_dwordx4 v[56:59], v10, s[4:7], s90 offen offset:0 sc1
    buffer_load_dwordx4 v[60:63], v10, s[4:7], s90 offen offset:1024 sc1
    buffer_load_dwordx4 v[64:67], v10, s[4:7], s90 offen offset:2048 sc1
    buffer_load_dwordx4 v[68:71], v10, s[4:7], s90 offen offset:3072 sc1
    s_add_u32 s90, s41, 73728
    buffer_load_dwordx4 v[72:75], v10, s[4:7], s90 offen offset:0 sc1
    buffer_load_dwordx4 v[76:79], v10, s[4:7], s90 offen offset:1024 sc1
    buffer_load_dwordx4 v[80:83], v10, s[4:7], s90 offen offset:2048 sc1
    buffer_load_dwordx4 v[84:87], v10, s[4:7], s90 offen offset:3072 sc1
    s_add_u32 s90, s41, 77824
    buffer_load_dwordx4 v[88:91], v10, s[4:7], s90 offen offset:0 sc1
    buffer_load_dwordx4 v[92:95], v10, s[4:7], s90 offen offset:1024 sc1
    buffer_load_dwordx4 v[96:99], v10, s[4:7], s90 offen offset:2048 sc1
    buffer_load_dwordx4 v[100:103], v10, s[4:7], s90 offen offset:3072 sc1
    s_add_u32 s90, s41, 81920
    buffer_load_dwordx4 v[104:107], v10, s[4:7], s90 offen offset:0 sc1
    buffer_load_dwordx4 v[108:111], v10, s[4:7], s90 offen offset:1024 sc1
    buffer_load_dwordx4 v[112:115], v10, s[4:7], s90 offen offset:2048 sc1
    buffer_load_dwordx4 v[116:119], v10, s[4:7], s90 offen offset:3072 sc1
    s_waitcnt vmcnt(0)
    v_mfma_f32_16x16x32_bf16 v[144:147], v[72:75], v[24:27], 0
    v_mfma_f32_16x16x32_bf16 v[152:155], v[72:75], v[48:51], 0
    v_mfma_f32_16x16x32_bf16 v[156:159], v[96:99], v[48:51], 0
    v_mfma_f32_16x16x32_bf16 v[144:147], v[76:79], v[28:31], v[144:147]
    v_mfma_f32_16x16x32_bf16 v[152:155], v[76:79], v[52:55], v[152:155]
    v_mfma_f32_16x16x32_bf16 v[156:159], v[100:103], v[52:55], v[156:159]
    v_mfma_f32_16x16x32_bf16 v[144:147], v[80:83], v[32:35], v[144:147]
    v_mfma_f32_16x16x32_bf16 v[152:155], v[80:83], v[56:59], v[152:155]
    v_mfma_f32_16x16x32_bf16 v[156:159], v[104:107], v[56:59], v[156:159]
    v_mfma_f32_16x16x32_bf16 v[144:147], v[84:87], v[36:39], v[144:147]
    v_mfma_f32_16x16x32_bf16 v[152:155], v[84:87], v[60:63], v[152:155]
    v_mfma_f32_16x16x32_bf16 v[156:159], v[108:111], v[60:63], v[156:159]
    v_mfma_f32_16x16x32_bf16 v[144:147], v[88:91], v[40:43], v[144:147]
    v_mfma_f32_16x16x32_bf16 v[152:155], v[88:91], v[64:67], v[152:155]
    v_mfma_f32_16x16x32_bf16 v[156:159], v[112:115], v[64:67], v[156:159]
    v_mfma_f32_16x16x32_bf16 v[144:147], v[92:95], v[44:47], v[144:147]
    v_mfma_f32_16x16x32_bf16 v[152:155], v[92:95], v[68:71], v[152:155]
    v_mfma_f32_16x16x32_bf16 v[156:159], v[116:119], v[68:71], v[156:159]
    s_nop 0
    v_cndmask_b32 v144, v21, v144, s[48:49]
    v_cndmask_b32 v145, v21, v145, s[50:51]
    v_cndmask_b32 v146, v21, v146, s[52:53]
    v_cndmask_b32 v147, v21, v147, s[54:55]
    s_nop 2
    v_cndmask_b32 v156, v21, v156, s[48:49]
    v_cndmask_b32 v157, v21, v157, s[50:51]
    v_cndmask_b32 v158, v21, v158, s[52:53]
    v_cndmask_b32 v159, v21, v159, s[54:55]
L_pf_40:
    buffer_load_dword v16, v14, s[4:7], s38 offen sc1
    s_sub_u32 s36, s36, 1
    s_cbranch_scc1 L_exit
    s_waitcnt vmcnt(0)
    v_cmp_ge_u32 vcc, s37, v16
    s_cbranch_vccnz L_pf_40
    buffer_load_dwordx4 v[120:123], v11, s[4:7], s42 offen offset:0 sc1
    buffer_load_dwordx4 v[124:127], v11, s[4:7], s42 offen offset:512 sc1
    buffer_load_dwordx4 v[128:131], v11, s[4:7], s42 offen offset:1024 sc1
    buffer_load_dwordx4 v[132:135], v11, s[4:7], s42 offen offset:1536 sc1
    buffer_load_dwordx4 v[136:139], v11, s[4:7], s42 offen offset:2048 sc1
    buffer_load_dwordx4 v[140:143], v11, s[4:7], s42 offen offset:2560 sc1
    s_waitcnt vmcnt(5)
    v_mfma_f32_16x16x32_bf16 v[148:151], v[120:123], v[24:27], 0
    v_mfma_f32_16x16x32_bf16 v[160:163], v[120:123], v[48:51], 0
    s_waitcnt vmcnt(4)
    v_mfma_f32_16x16x32_bf16 v[148:151], v[124:127], v[28:31], v[148:151]
    v_mfma_f32_16x16x32_bf16 v[160:163], v[124:127], v[52:55], v[160:163]
    s_waitcnt vmcnt(3)
    v_mfma_f32_16x16x32_bf16 v[148:151], v[128:131], v[32:35], v[148:151]
    v_mfma_f32_16x16x32_bf16 v[160:163], v[128:131], v[56:59], v[160:163]
    s_waitcnt vmcnt(2)
    v_mfma_f32_16x16x32_bf16 v[148:151], v[132:135], v[36:39], v[148:151]
    v_mfma_f32_16x16x32_bf16 v[160:163], v[132:135], v[60:63], v[160:163]
    s_waitcnt vmcnt(1)
    v_mfma_f32_16x16x32_bf16 v[148:151], v[136:139], v[40:43], v[148:151]
    v_mfma_f32_16x16x32_bf16 v[160:163], v[136:139], v[64:67], v[160:163]
    s_waitcnt vmcnt(0)
    v_mfma_f32_16x16x32_bf16 v[148:151], v[140:143], v[44:47], v[148:151]
    v_mfma_f32_16x16x32_bf16 v[160:163], v[140:143], v[68:71], v[160:163]
    v_max_f32 v18, v144, v145
    v_max3_f32 v18, v18, v146, v147
    s_nop 2
    v_max3_f32 v18, v18, v148, v149
    v_mov_b32 v19, v18
    s_nop 1
    v_permlane16_swap_b32 v18, v19
    v_max_f32 v18, v18, v19
    v_mov_b32 v19, v18
    s_nop 1
    v_permlane32_swap_b32 v18, v19
    v_max_f32 v18, v18, v19
    v_mul_f32 v18, 0xbdd53b95, v18
    v_fma_f32 v144, v144, s44, v18
    v_fma_f32 v145, v145, s44, v18
    v_fma_f32 v146, v146, s44, v18
    v_fma_f32 v147, v147, s44, v18
    v_fma_f32 v148, v148, s44, v18
    v_fma_f32 v149, v149, s44, v18
    v_exp_f32 v144, v144
    v_exp_f32 v145, v145
    v_exp_f32 v146, v146
    v_exp_f32 v147, v147
    v_exp_f32 v148, v148
    v_exp_f32 v149, v149
    v_add_f32 v20, v144, v145
    v_add_f32 v20, v20, v146
    v_add_f32 v20, v20, v147
    v_add_f32 v20, v20, v148
    v_add_f32 v20, v20, v149
    v_mov_b32 v19, v20
    s_nop 1
    v_permlane16_swap_b32 v20, v19
    v_add_f32 v20, v20, v19
    v_mov_b32 v19, v20
    s_nop 1
    v_permlane32_swap_b32 v20, v19
    v_add_f32 v20, v20, v19
    v_rcp_f32 v20, v20
    s_nop 0
    v_mul_f32 v144, v144, v20
    v_mul_f32 v145, v145, v20
    v_mul_f32 v146, v146, v20
    v_mul_f32 v147, v147, v20
    v_mul_f32 v148, v148, v20
    v_mul_f32 v149, v149, v20
    v_cvt_pk_bf16_f32 v164, v144, v145
    v_cvt_pk_bf16_f32 v165, v146, v147
    v_cvt_pk_bf16_f32 v166, v148, v149
    v_max_f32 v18, v152, v153
    v_max3_f32 v18, v18, v154, v155
    v_max3_f32 v18, v18, v160, v161
    v_max3_f32 v18, v18, v156, v157
    v_max3_f32 v18, v18, v158, v159
    v_mov_b32 v19, v18
    s_nop 1
    v_permlane16_swap_b32 v18, v19
    v_max_f32 v18, v18, v19
    v_mov_b32 v19, v18
    s_nop 1
    v_permlane32_swap_b32 v18, v19
    v_max_f32 v18, v18, v19
    v_mul_f32 v18, 0xbdd53b95, v18
    v_fma_f32 v152, v152, s44, v18
    v_fma_f32 v153, v153, s44, v18
    v_fma_f32 v154, v154, s44, v18
    v_fma_f32 v155, v155, s44, v18
    v_fma_f32 v160, v160, s44, v18
    v_fma_f32 v161, v161, s44, v18
    v_fma_f32 v156, v156, s44, v18
    v_fma_f32 v157, v157, s44, v18
    v_fma_f32 v158, v158, s44, v18
    v_fma_f32 v159, v159, s44, v18
    v_exp_f32 v152, v152
    v_exp_f32 v153, v153
    v_exp_f32 v154, v154
    v_exp_f32 v155, v155
    v_exp_f32 v160, v160
    v_exp_f32 v161, v161
    v_exp_f32 v156, v156
    v_exp_f32 v157, v157
    v_exp_f32 v158, v158
    v_exp_f32 v159, v159
    v_add_f32 v20, v152, v153
    v_add_f32 v20, v20, v154
    v_add_f32 v20, v20, v155
    v_add_f32 v20, v20, v160
    v_add_f32 v20, v20, v161
    v_add_f32 v20, v20, v156
    v_add_f32 v20, v20, v157
    v_add_f32 v20, v20, v158
    v_add_f32 v20, v20, v159
    v_mov_b32 v19, v20
    s_nop 1
    v_permlane16_swap_b32 v20, v19
    v_add_f32 v20, v20, v19
    v_mov_b32 v19, v20
    s_nop 1
    v_permlane32_swap_b32 v20, v19
    v_add_f32 v20, v20, v19
    v_rcp_f32 v20, v20
    s_nop 0
    v_mul_f32 v152, v152, v20
    v_mul_f32 v153, v153, v20
    v_mul_f32 v154, v154, v20
    v_mul_f32 v155, v155, v20
    v_mul_f32 v160, v160, v20
    v_mul_f32 v161, v161, v20
    v_mul_f32 v156, v156, v20
    v_mul_f32 v157, v157, v20
    v_mul_f32 v158, v158, v20
    v_mul_f32 v159, v159, v20
    v_cvt_pk_bf16_f32 v168, v152, v153
    v_cvt_pk_bf16_f32 v169, v154, v155
    v_cvt_pk_bf16_f32 v170, v160, v161
    v_cvt_pk_bf16_f32 v172, v156, v157
    v_cvt_pk_bf16_f32 v173, v158, v159
    buffer_store_dwordx4 v[164:167], v12, s[4:7], s43 offen offset:0
    buffer_store_dwordx4 v[168:171], v12, s[4:7], s43 offen offset:1024
    buffer_store_dwordx4 v[172:175], v12, s[4:7], s43 offen offset:2048
    s_waitcnt vmcnt(0)
    buffer_store_dword v17, v15, s[4:7], s38 offen
    s_add_u32 s37, s37, 2
    s_cmp_lt_u32 s37, 64
    s_cbranch_scc1 L_px_loop_f
    s_endpgm
L_pa_f:
    s_sub_u32 s93, s35, 24
    s_lshl_b32 s93, s93, 2
    s_add_u32 s93, s93, s32
    s_add_u32 s93, s93, 0
    v_add_u32 v4, 0, v0
    v_cmp_le_u32 vcc, 96, v4
    v_subrev_u32 v5, 96, v4
    s_nop 0
    v_cndmask_b32 v4, v4, v5, vcc
    v_lshlrev_b32 v4, 4, v4
    v_mov_b32 v5, 12288
    v_cndmask_b32 v5, 0, v5, vcc
    s_mul_i32 s90, s34, 1536
    v_add3_u32 v6, v4, v5, s90
    v_add_u32 v4, 64, v0
    v_cmp_le_u32 vcc, 96, v4
    v_subrev_u32 v5, 96, v4
    s_nop 0
    v_cndmask_b32 v4, v4, v5, vcc
    v_lshlrev_b32 v4, 4, v4
    v_mov_b32 v5, 12288
    v_cndmask_b32 v5, 0, v5, vcc
    s_mul_i32 s90, s34, 1536
    v_add3_u32 v7, v4, v5, s90
    v_add_u32 v4, 128, v0
    v_cmp_le_u32 vcc, 96, v4
    v_subrev_u32 v5, 96, v4
    s_nop 0
    v_cndmask_b32 v4, v4, v5, vcc
    v_lshlrev_b32 v4, 4, v4
    v_mov_b32 v5, 12288
    v_cndmask_b32 v5, 0, v5, vcc
    s_mul_i32 s90, s34, 1536
    v_add3_u32 v8, v4, v5, s90
    s_cmp_lt_u32 s93, 64
    s_cselect_b32 s12, s74, s74
    s_cselect_b32 s13, s75, s75
    s_cselect_b32 s91, 1, 1
    s_cmp_lt_u32 s93, 32
    s_cselect_b32 s12, s76, s12
    s_cselect_b32 s13, s77, s13
    s_cselect_b32 s91, 3, s91
    s_and_b32 s13, s13, 0xffff
    s_mov_b32 s14, 7864320
    s_mov_b32 s15, 0x20000
    s_mul_i32 s91, s91, 320
    s_mul_i32 s90, s93, 10
    s_add_u32 s90, s90, s91
    s_sub_u32 s90, s90, 640
    s_mul_i32 s90, s90, 12288
    buffer_load_dwordx4 v[248:251], v6, s[12:15], s90 offen
    buffer_load_dwordx4 v[248:251], v7, s[12:15], s90 offen
    buffer_load_dwordx4 v[248:251], v8, s[12:15], s90 offen
    s_add_u32 s90, s90, 24576
    buffer_load_dwordx4 v[248:251], v6, s[12:15], s90 offen
    buffer_load_dwordx4 v[248:251], v7, s[12:15], s90 offen
    buffer_load_dwordx4 v[248:251], v8, s[12:15], s90 offen
    s_add_u32 s90, s90, 24576
    buffer_load_dwordx4 v[248:251], v6, s[12:15], s90 offen
    buffer_load_dwordx4 v[248:251], v7, s[12:15], s90 offen
    buffer_load_dwordx4 v[248:251], v8, s[12:15], s90 offen
    s_add_u32 s90, s90, 24576
    buffer_load_dwordx4 v[248:251], v6, s[12:15], s90 offen
    buffer_load_dwordx4 v[248:251], v7, s[12:15], s90 offen
    buffer_load_dwordx4 v[248:251], v8, s[12:15], s90 offen
    s_add_u32 s90, s90, 24576
    buffer_load_dwordx4 v[248:251], v6, s[12:15], s90 offen
    buffer_load_dwordx4 v[248:251], v7, s[12:15], s90 offen
    buffer_load_dwordx4 v[248:251], v8, s[12:15], s90 offen
    s_add_u32 s90, s90, 24576
    s_sub_u32 s93, s35, 24
    s_lshl_b32 s93, s93, 2
    s_add_u32 s93, s93, s32
    s_add_u32 s93, s93, 32
    v_add_u32 v4, 0, v0
    v_cmp_le_u32 vcc, 96, v4
    v_subrev_u32 v5, 96, v4
    s_nop 0
    v_cndmask_b32 v4, v4, v5, vcc
    v_lshlrev_b32 v4, 4, v4
    v_mov_b32 v5, 12288
    v_cndmask_b32 v5, 0, v5, vcc
    s_mul_i32 s90, s34, 1536
    v_add3_u32 v6, v4, v5, s90
    v_add_u32 v4, 64, v0
    v_cmp_le_u32 vcc, 96, v4
    v_subrev_u32 v5, 96, v4
    s_nop 0
    v_cndmask_b32 v4, v4, v5, vcc
    v_lshlrev_b32 v4, 4, v4
    v_mov_b32 v5, 12288
    v_cndmask_b32 v5, 0, v5, vcc
    s_mul_i32 s90, s34, 1536
    v_add3_u32 v7, v4, v5, s90
    v_add_u32 v4, 128, v0
    v_cmp_le_u32 vcc, 96, v4
    v_subrev_u32 v5, 96, v4
    s_nop 0
    v_cndmask_b32 v4, v4, v5, vcc
    v_lshlrev_b32 v4, 4, v4
    v_mov_b32 v5, 12288
    v_cndmask_b32 v5, 0, v5, vcc
    s_mul_i32 s90, s34, 1536
    v_add3_u32 v8, v4, v5, s90
    s_cmp_lt_u32 s93, 64
    s_cselect_b32 s12, s74, s74
    s_cselect_b32 s13, s75, s75
    s_cselect_b32 s91, 1, 1
    s_cmp_lt_u32 s93, 32
    s_cselect_b32 s12, s76, s12
    s_cselect_b32 s13, s77, s13
    s_cselect_b32 s91, 3, s91
    s_and_b32 s13, s13, 0xffff
    s_mov_b32 s14, 7864320
    s_mov_b32 s15, 0x20000
    s_mul_i32 s91, s91, 320
    s_mul_i32 s90, s93, 10
    s_add_u32 s90, s90, s91
    s_sub_u32 s90, s90, 640
    s_mul_i32 s90, s90, 12288
    buffer_load_dwordx4 v[248:251], v6, s[12:15], s90 offen
    buffer_load_dwordx4 v[248:251], v7, s[12:15], s90 offen
    buffer_load_dwordx4 v[248:251], v8, s[12:15], s90 offen
    s_add_u32 s90, s90, 24576
    buffer_load_dwordx4 v[248:251], v6, s[12:15], s90 offen
    buffer_load_dwordx4 v[248:251], v7, s[12:15], s90 offen
    buffer_load_dwordx4 v[248:251], v8, s[12:15], s90 offen
    s_add_u32 s90, s90, 24576
    buffer_load_dwordx4 v[248:251], v6, s[12:15], s90 offen
    buffer_load_dwordx4 v[248:251], v7, s[12:15], s90 offen
    buffer_load_dwordx4 v[248:251], v8, s[12:15], s90 offen
    s_add_u32 s90, s90, 24576
    buffer_load_dwordx4 v[248:251], v6, s[12:15], s90 offen
    buffer_load_dwordx4 v[248:251], v7, s[12:15], s90 offen
    buffer_load_dwordx4 v[248:251], v8, s[12:15], s90 offen
    s_add_u32 s90, s90, 24576
    buffer_load_dwordx4 v[248:251], v6, s[12:15], s90 offen
    buffer_load_dwordx4 v[248:251], v7, s[12:15], s90 offen
    buffer_load_dwordx4 v[248:251], v8, s[12:15], s90 offen
    s_add_u32 s90, s90, 24576
    s_sub_u32 s93, s35, 24
    s_lshl_b32 s93, s93, 2
    s_add_u32 s93, s93, s32
    s_add_u32 s93, s93, 64
    v_add_u32 v4, 0, v0
    v_cmp_le_u32 vcc, 96, v4
    v_subrev_u32 v5, 96, v4
    s_nop 0
    v_cndmask_b32 v4, v4, v5, vcc
    v_lshlrev_b32 v4, 4, v4
    v_mov_b32 v5, 12288
    v_cndmask_b32 v5, 0, v5, vcc
    s_mul_i32 s90, s34, 1536
    v_add3_u32 v6, v4, v5, s90
    v_add_u32 v4, 64, v0
    v_cmp_le_u32 vcc, 96, v4
    v_subrev_u32 v5, 96, v4
    s_nop 0
    v_cndmask_b32 v4, v4, v5, vcc
    v_lshlrev_b32 v4, 4, v4
    v_mov_b32 v5, 12288
    v_cndmask_b32 v5, 0, v5, vcc
    s_mul_i32 s90, s34, 1536
    v_add3_u32 v7, v4, v5, s90
    v_add_u32 v4, 128, v0
    v_cmp_le_u32 vcc, 96, v4
    v_subrev_u32 v5, 96, v4
    s_nop 0
    v_cndmask_b32 v4, v4, v5, vcc
    v_lshlrev_b32 v4, 4, v4
    v_mov_b32 v5, 12288
    v_cndmask_b32 v5, 0, v5, vcc
    s_mul_i32 s90, s34, 1536
    v_add3_u32 v8, v4, v5, s90
    s_cmp_lt_u32 s93, 64
    s_cselect_b32 s12, s74, s74
    s_cselect_b32 s13, s75, s75
    s_cselect_b32 s91, 1, 1
    s_cmp_lt_u32 s93, 32
    s_cselect_b32 s12, s76, s12
    s_cselect_b32 s13, s77, s13
    s_cselect_b32 s91, 3, s91
    s_and_b32 s13, s13, 0xffff
    s_mov_b32 s14, 7864320
    s_mov_b32 s15, 0x20000
    s_mul_i32 s91, s91, 320
    s_mul_i32 s90, s93, 10
    s_add_u32 s90, s90, s91
    s_sub_u32 s90, s90, 640
    s_mul_i32 s90, s90, 12288
    buffer_load_dwordx4 v[248:251], v6, s[12:15], s90 offen
    buffer_load_dwordx4 v[248:251], v7, s[12:15], s90 offen
    buffer_load_dwordx4 v[248:251], v8, s[12:15], s90 offen
    s_add_u32 s90, s90, 24576
    buffer_load_dwordx4 v[248:251], v6, s[12:15], s90 offen
    buffer_load_dwordx4 v[248:251], v7, s[12:15], s90 offen
    buffer_load_dwordx4 v[248:251], v8, s[12:15], s90 offen
    s_add_u32 s90, s90, 24576
    buffer_load_dwordx4 v[248:251], v6, s[12:15], s90 offen
    buffer_load_dwordx4 v[248:251], v7, s[12:15], s90 offen
    buffer_load_dwordx4 v[248:251], v8, s[12:15], s90 offen
    s_add_u32 s90, s90, 24576
    buffer_load_dwordx4 v[248:251], v6, s[12:15], s90 offen
    buffer_load_dwordx4 v[248:251], v7, s[12:15], s90 offen
    buffer_load_dwordx4 v[248:251], v8, s[12:15], s90 offen
    s_add_u32 s90, s90, 24576
    buffer_load_dwordx4 v[248:251], v6, s[12:15], s90 offen
    buffer_load_dwordx4 v[248:251], v7, s[12:15], s90 offen
    buffer_load_dwordx4 v[248:251], v8, s[12:15], s90 offen
    s_add_u32 s90, s90, 24576
    v_mov_b32 v1, 192
L_gw_41:
    buffer_load_dword v2, v1, s[8:11], 0 offen sc1
    s_sub_u32 s36, s36, 1
    s_cbranch_scc1 L_exit
    s_waitcnt vmcnt(0)
    v_readfirstlane_b32 s90, v2
    s_nop 0
    s_cmp_eq_u32 s90, 0
    s_cbranch_scc1 L_gw_41
    s_cmp_lg_u32 s90, 1
    s_cbranch_scc1 L_slow
    s_branch L_pa_body
L_pa_body:
    s_mov_b32 s12, s64
    s_and_b32 s13, s65, 0xffff
    s_mov_b32 s14, 2621440
    s_mov_b32 s15, 0x20000
    s_mov_b32 s16, s66
    s_and_b32 s17, s67, 0xffff
    s_mov_b32 s18, 2457600
    s_mov_b32 s19, 0x20000
    s_mov_b32 s20, s68
    s_and_b32 s21, s69, 0xffff
    s_mov_b32 s22, 819200
    s_mov_b32 s23, 0x20000
    v_and_b32 v1, 15, v0
    v_lshrrev_b32 v2, 4, v0
    s_lshl_b32 s40, s34, 3
    s_add_u32 s40, s40, s35
    s_sub_u32 s40, s40, 24
    s_lshl_b32 s40, s40, 5
    s_add_u32 s90, s40, -16
    v_add_u32 v3, s90, v1
    v_cmp_le_i32 vcc, 0, v3
    v_mul_u32_u24 v3, 1280, v3
    v_lshl_add_u32 v3, v2, 4, v3
    v_mov_b32 v4, 2146435072
    v_cndmask_b32 v3, v4, v3, vcc
    buffer_load_dwordx4 a[0:3], v3, s[12:15], 0 offen offset:0
    buffer_load_dwordx4 a[4:7], v3, s[12:15], 0 offen offset:64
    buffer_load_dwordx4 a[8:11], v3, s[12:15], 0 offen offset:128
    buffer_load_dwordx4 a[12:15], v3, s[12:15], 0 offen offset:192
    buffer_load_dwordx4 a[16:19], v3, s[12:15], 0 offen offset:256
    buffer_load_dwordx4 a[20:23], v3, s[12:15], 0 offen offset:320
    buffer_load_dwordx4 a[24:27], v3, s[12:15], 0 offen offset:384
    buffer_load_dwordx4 a[28:31], v3, s[12:15], 0 offen offset:448
    buffer_load_dwordx4 a[32:35], v3, s[12:15], 0 offen offset:512
    buffer_load_dwordx4 a[36:39], v3, s[12:15], 0 offen offset:576
    buffer_load_dwordx4 a[40:43], v3, s[12:15], 0 offen offset:640
    buffer_load_dwordx4 a[44:47], v3, s[12:15], 0 offen offset:704
    buffer_load_dwordx4 a[48:51], v3, s[12:15], 0 offen offset:768
    buffer_load_dwordx4 a[52:55], v3, s[12:15], 0 offen offset:832
    buffer_load_dwordx4 a[56:59], v3, s[12:15], 0 offen offset:896
    buffer_load_dwordx4 a[60:63], v3, s[12:15], 0 offen offset:960
    buffer_load_dwordx4 a[64:67], v3, s[12:15], 0 offen offset:1024
    buffer_load_dwordx4 a[68:71], v3, s[12:15], 0 offen offset:1088
    buffer_load_dwordx4 a[72:75], v3, s[12:15], 0 offen offset:1152
    buffer_load_dwordx4 a[76:79], v3, s[12:15], 0 offen offset:1216
    s_add_u32 s90, s40, 0
    v_add_u32 v3, s90, v1
    v_cmp_le_i32 vcc, 0, v3
    v_mul_u32_u24 v3, 1280, v3
    v_lshl_add_u32 v3, v2, 4, v3
    v_mov_b32 v4, 2146435072
    v_cndmask_b32 v3, v4, v3, vcc
    buffer_load_dwordx4 a[80:83], v3, s[12:15], 0 offen offset:0
    buffer_load_dwordx4 a[84:87], v3, s[12:15], 0 offen offset:64
    buffer_load_dwordx4 a[88:91], v3, s[12:15], 0 offen offset:128
    buffer_load_dwordx4 a[92:95], v3, s[12:15], 0 offen offset:192
    buffer_load_dwordx4 a[96:99], v3, s[12:15], 0 offen offset:256
    buffer_load_dwordx4 a[100:103], v3, s[12:15], 0 offen offset:320
    buffer_load_dwordx4 a[104:107], v3, s[12:15], 0 offen offset:384
    buffer_load_dwordx4 a[108:111], v3, s[12:15], 0 offen offset:448
    buffer_load_dwordx4 a[112:115], v3, s[12:15], 0 offen offset:512
    buffer_load_dwordx4 a[116:119], v3, s[12:15], 0 offen offset:576
    buffer_load_dwordx4 a[120:123], v3, s[12:15], 0 offen offset:640
    buffer_load_dwordx4 a[124:127], v3, s[12:15], 0 offen offset:704
    buffer_load_dwordx4 a[128:131], v3, s[12:15], 0 offen offset:768
    buffer_load_dwordx4 a[132:135], v3, s[12:15], 0 offen offset:832
    buffer_load_dwordx4 a[136:139], v3, s[12:15], 0 offen offset:896
    buffer_load_dwordx4 a[140:143], v3, s[12:15], 0 offen offset:960
    buffer_load_dwordx4 a[144:147], v3, s[12:15], 0 offen offset:1024
    buffer_load_dwordx4 a[148:151], v3, s[12:15], 0 offen offset:1088
    buffer_load_dwordx4 a[152:155], v3, s[12:15], 0 offen offset:1152
    buffer_load_dwordx4 a[156:159], v3, s[12:15], 0 offen offset:1216
    s_add_u32 s90, s40, 16
    v_add_u32 v3, s90, v1
    v_cmp_le_i32 vcc, 0, v3
    v_mul_u32_u24 v3, 1280, v3
    v_lshl_add_u32 v3, v2, 4, v3
    v_mov_b32 v4, 2146435072
    v_cndmask_b32 v3, v4, v3, vcc
    buffer_load_dwordx4 a[160:163], v3, s[12:15], 0 offen offset:0
    buffer_load_dwordx4 a[164:167], v3, s[12:15], 0 offen offset:64
    buffer_load_dwordx4 a[168:171], v3, s[12:15], 0 offen offset:128
    buffer_load_dwordx4 a[172:175], v3, s[12:15], 0 offen offset:192
    buffer_load_dwordx4 a[176:179], v3, s[12:15], 0 offen offset:256
    buffer_load_dwordx4 a[180:183], v3, s[12:15], 0 offen offset:320
    buffer_load_dwordx4 a[184:187], v3, s[12:15], 0 offen offset:384
    buffer_load_dwordx4 a[188:191], v3, s[12:15], 0 offen offset:448
    buffer_load_dwordx4 a[192:195], v3, s[12:15], 0 offen offset:512
    buffer_load_dwordx4 a[196:199], v3, s[12:15], 0 offen offset:576
    buffer_load_dwordx4 a[200:203], v3, s[12:15], 0 offen offset:640
    buffer_load_dwordx4 a[204:207], v3, s[12:15], 0 offen offset:704
    buffer_load_dwordx4 a[208:211], v3, s[12:15], 0 offen offset:768
    buffer_load_dwordx4 a[212:215], v3, s[12:15], 0 offen offset:832
    buffer_load_dwordx4 a[216:219], v3, s[12:15], 0 offen offset:896
    buffer_load_dwordx4 a[220:223], v3, s[12:15], 0 offen offset:960
    buffer_load_dwordx4 a[224:227], v3, s[12:15], 0 offen offset:1024
    buffer_load_dwordx4 a[228:231], v3, s[12:15], 0 offen offset:1088
    buffer_load_dwordx4 a[232:235], v3, s[12:15], 0 offen offset:1152
    buffer_load_dwordx4 a[236:239], v3, s[12:15], 0 offen offset:1216
    v_lshrrev_b32 v3, 3, v0
    v_and_b32 v4, 7, v0
    s_lshl_b32 s90, s32, 3
    v_add_u32 v5, s90, v3
    s_and_b32 s91, s32, 1
    s_lshl_b32 s91, s91, 2
    v_and_b32 v6, 2, v3
    v_or_b32 v6, s91, v6
    v_xor_b32 v6, v6, v4
    v_lshlrev_b32 v6, 4, v6
    v_mul_u32_u24 v7, 3840, v5
    v_add_u32 v10, v6, v7
    v_mul_u32_u24 v7, 1280, v5
    v_add_u32 v11, v6, v7
    v_lshrrev_b32 v3, 2, v1
    v_and_b32 v4, 3, v1
    v_and_b32 v5, 1, v2
    v_lshl_add_u32 v6, v2, 3, v3
    v_lshlrev_b32 v6, 7, v6
    v_and_b32 v7, 2, v3
    v_lshl_or_b32 v7, v5, 2, v7
    v_lshrrev_b32 v8, 1, v4
    s_lshl_b32 s90, s32, 1
    v_or_b32 v8, s90, v8
    v_xor_b32 v7, v7, v8
    v_lshl_add_u32 v6, v7, 4, v6
    v_and_b32 v7, 1, v4
    v_lshl_add_u32 v12, v7, 3, v6
    s_lshl_b32 s90, s32, 5
    v_lshl_add_u32 v6, v2, 3, s90
    v_mul_u32_u24 v7, 1296, v1
    v_add_u32 v14, v6, v7
    v_add_u32 v14, 49152, v14
    v_lshl_add_u32 v26, v2, 4, v7
    v_add_u32 v26, 49152, v26
    v_mul_u32_u24 v7, 648, v1
    v_add_u32 v15, v6, v7
    v_add_u32 v15, 90624, v15
    v_lshl_add_u32 v6, v5, 4, v1
    v_add_u32 v6, s40, v6
    v_mul_u32_u24 v6, 2560, v6
    v_lshrrev_b32 v7, 1, v2
    v_lshl_add_u32 v6, v7, 4, v6
    v_add_u32 v17, s90, v6
    v_and_b32 v3, 31, v0
    v_add_u32 v22, s40, v3
    v_lshrrev_b32 v4, 5, v0
    s_lshl_b32 s90, s32, 2
    v_add_u32 v4, s90, v4
    v_mul_u32_u24 v4, 40, v4
    v_mul_u32_u24 v5, 1296, v3
    v_add_u32 v5, v5, v4
    v_add_u32 v18, 49152, v5
    v_mul_u32_u24 v5, 648, v3
    v_add_u32 v5, v5, v4
    v_add_u32 v19, 91920, v5
    v_mov_b32 v25, 0xcf8547b1
    s_mov_b32 s47, 0x3ea52b5c
    s_mov_b32 s46, 0
L_pa_half:
    s_mul_i32 s42, s46, 640
    s_waitcnt vmcnt(0) lgkmcnt(0)
    s_barrier
    s_mov_b32 s44, 0
    s_mov_b32 s45, 0
    s_mov_b32 s41, 0
    s_lshl_b32 s90, s32, 10
    s_add_u32 m0, s90, s45
    s_add_u32 s91, s42, 0
    buffer_load_dwordx4 v10, s[16:19], s91 offen lds
    s_add_u32 m0, m0, 4096
    s_add_u32 s91, s91, 122880
    buffer_load_dwordx4 v10, s[16:19], s91 offen lds
    s_add_u32 m0, m0, 4096
    s_add_u32 s91, s91, 122880
    buffer_load_dwordx4 v10, s[16:19], s91 offen lds
    s_add_u32 m0, m0, 4096
    s_add_u32 s91, s91, 122880
    buffer_load_dwordx4 v10, s[16:19], s91 offen lds
    s_add_u32 s45, s45, 16384
    s_cmp_eq_u32 s45, 49152
    s_cselect_b32 s45, 0, s45
    s_lshl_b32 s90, s32, 10
    s_add_u32 m0, s90, s45
    s_add_u32 s91, s42, 491520
    buffer_load_dwordx4 v10, s[16:19], s91 offen lds
    s_add_u32 m0, m0, 4096
    s_add_u32 s91, s91, 122880
    buffer_load_dwordx4 v10, s[16:19], s91 offen lds
    s_add_u32 m0, m0, 4096
    s_add_u32 s91, s91, 122880
    buffer_load_dwordx4 v10, s[16:19], s91 offen lds
    s_add_u32 m0, m0, 4096
    s_add_u32 s91, s91, 122880
    buffer_load_dwordx4 v10, s[16:19], s91 offen lds
    s_add_u32 s45, s45, 16384
    s_cmp_eq_u32 s45, 49152
    s_cselect_b32 s45, 0, s45
L_pa_blk:
    s_add_u32 s43, s42, 128
    s_add_u32 s90, s42, 768
    s_cmp_eq_u32 s41, 4
    s_cselect_b32 s43, s90, s43
    s_cmp_eq_u32 s41, 9
    s_cselect_b32 s43, s90, s43
    s_cmp_eq_u32 s41, 14
    s_cselect_b32 s43, s42, s43
    v_add_u32 v13, s44, v12
    s_waitcnt vmcnt(4)
    s_barrier
    ds_read_b64_tr_b16 v[28:29], v13 offset:0
    ds_read_b64_tr_b16 v[30:31], v13 offset:512
    ds_read_b64_tr_b16 v[32:33], v13 offset:4096
    ds_read_b64_tr_b16 v[34:35], v13 offset:4608
    ds_read_b64_tr_b16 v[36:37], v13 offset:8192
    ds_read_b64_tr_b16 v[38:39], v13 offset:8704
    ds_read_b64_tr_b16 v[40:41], v13 offset:12288
    ds_read_b64_tr_b16 v[42:43], v13 offset:12800
    s_lshl_b32 s90, s32, 10
    s_add_u32 m0, s90, s45
    s_add_u32 s91, s42, 983040
    buffer_load_dwordx4 v10, s[16:19], s91 offen lds
    s_add_u32 m0, m0, 4096
    s_add_u32 s91, s91, 122880
    buffer_load_dwordx4 v10, s[16:19], s91 offen lds
    s_add_u32 m0, m0, 4096
    s_add_u32 s91, s91, 122880
    buffer_load_dwordx4 v10, s[16:19], s91 offen lds
    s_add_u32 m0, m0, 4096
    s_add_u32 s91, s91, 122880
    buffer_load_dwordx4 v10, s[16:19], s91 offen lds
    s_add_u32 s45, s45, 16384
    s_cmp_eq_u32 s45, 49152
    s_cselect_b32 s45, 0, s45
    s_add_u32 s44, s44, 16384
    s_cmp_eq_u32 s44, 49152
    s_cselect_b32 s44, 0, s44
    s_waitcnt lgkmcnt(6)
    v_mfma_f32_16x16x32_bf16 v[44:47], v[28:31], a[0:3], 0
    v_mfma_f32_16x16x32_bf16 v[48:51], v[28:31], a[80:83], 0
    v_mfma_f32_16x16x32_bf16 v[52:55], v[28:31], a[160:163], 0
    s_waitcnt lgkmcnt(4)
    v_mfma_f32_16x16x32_bf16 v[44:47], v[32:35], a[4:7], v[44:47]
    v_mfma_f32_16x16x32_bf16 v[48:51], v[32:35], a[84:87], v[48:51]
    v_mfma_f32_16x16x32_bf16 v[52:55], v[32:35], a[164:167], v[52:55]
    s_waitcnt lgkmcnt(2)
    v_mfma_f32_16x16x32_bf16 v[44:47], v[36:39], a[8:11], v[44:47]
    v_mfma_f32_16x16x32_bf16 v[48:51], v[36:39], a[88:91], v[48:51]
    v_mfma_f32_16x16x32_bf16 v[52:55], v[36:39], a[168:171], v[52:55]
    s_waitcnt lgkmcnt(0)
    v_mfma_f32_16x16x32_bf16 v[44:47], v[40:43], a[12:15], v[44:47]
    v_mfma_f32_16x16x32_bf16 v[48:51], v[40:43], a[92:95], v[48:51]
    v_mfma_f32_16x16x32_bf16 v[52:55], v[40:43], a[172:175], v[52:55]
    v_add_u32 v13, s44, v12
    s_waitcnt vmcnt(4)
    s_barrier
    ds_read_b64_tr_b16 v[28:29], v13 offset:0
    ds_read_b64_tr_b16 v[30:31], v13 offset:512
    ds_read_b64_tr_b16 v[32:33], v13 offset:4096
    ds_read_b64_tr_b16 v[34:35], v13 offset:4608
    ds_read_b64_tr_b16 v[36:37], v13 offset:8192
    ds_read_b64_tr_b16 v[38:39], v13 offset:8704
    ds_read_b64_tr_b16 v[40:41], v13 offset:12288
    ds_read_b64_tr_b16 v[42:43], v13 offset:12800
    s_lshl_b32 s90, s32, 10
    s_add_u32 m0, s90, s45
    s_add_u32 s91, s42, 1474560
    buffer_load_dwordx4 v10, s[16:19], s91 offen lds
    s_add_u32 m0, m0, 4096
    s_add_u32 s91, s91, 122880
    buffer_load_dwordx4 v10, s[16:19], s91 offen lds
    s_add_u32 m0, m0, 4096
    s_add_u32 s91, s91, 122880
    buffer_load_dwordx4 v10, s[16:19], s91 offen lds
    s_add_u32 m0, m0, 4096
    s_add_u32 s91, s91, 122880
    buffer_load_dwordx4 v10, s[16:19], s91 offen lds
    s_add_u32 s45, s45, 16384
    s_cmp_eq_u32 s45, 49152
    s_cselect_b32 s45, 0, s45
    s_add_u32 s44, s44, 16384
    s_cmp_eq_u32 s44, 49152
    s_cselect_b32 s44, 0, s44
    s_waitcnt lgkmcnt(6)
    v_mfma_f32_16x16x32_bf16 v[44:47], v[28:31], a[16:19], v[44:47]
    v_mfma_f32_16x16x32_bf16 v[48:51], v[28:31], a[96:99], v[48:51]
    v_mfma_f32_16x16x32_bf16 v[52:55], v[28:31], a[176:179], v[52:55]
    s_waitcnt lgkmcnt(4)
    v_mfma_f32_16x16x32_bf16 v[44:47], v[32:35], a[20:23], v[44:47]
    v_mfma_f32_16x16x32_bf16 v[48:51], v[32:35], a[100:103], v[48:51]
    v_mfma_f32_16x16x32_bf16 v[52:55], v[32:35], a[180:183], v[52:55]
    s_waitcnt lgkmcnt(2)
    v_mfma_f32_16x16x32_bf16 v[44:47], v[36:39], a[24:27], v[44:47]
    v_mfma_f32_16x16x32_bf16 v[48:51], v[36:39], a[104:107], v[48:51]
    v_mfma_f32_16x16x32_bf16 v[52:55], v[36:39], a[184:187], v[52:55]
    s_waitcnt lgkmcnt(0)
    v_mfma_f32_16x16x32_bf16 v[44:47], v[40:43], a[28:31], v[44:47]
    v_mfma_f32_16x16x32_bf16 v[48:51], v[40:43], a[108:111], v[48:51]
    v_mfma_f32_16x16x32_bf16 v[52:55], v[40:43], a[188:191], v[52:55]
    v_add_u32 v13, s44, v12
    s_waitcnt vmcnt(4)
    s_barrier
    ds_read_b64_tr_b16 v[28:29], v13 offset:0
    ds_read_b64_tr_b16 v[30:31], v13 offset:512
    ds_read_b64_tr_b16 v[32:33], v13 offset:4096
    ds_read_b64_tr_b16 v[34:35], v13 offset:4608
    ds_read_b64_tr_b16 v[36:37], v13 offset:8192
    ds_read_b64_tr_b16 v[38:39], v13 offset:8704
    ds_read_b64_tr_b16 v[40:41], v13 offset:12288
    ds_read_b64_tr_b16 v[42:43], v13 offset:12800
    s_lshl_b32 s90, s32, 10
    s_add_u32 m0, s90, s45
    s_add_u32 s91, s42, 1966080
    buffer_load_dwordx4 v10, s[16:19], s91 offen lds
    s_add_u32 m0, m0, 4096
    s_add_u32 s91, s91, 122880
    buffer_load_dwordx4 v10, s[16:19], s91 offen lds
    s_add_u32 m0, m0, 4096
    s_add_u32 s91, s91, 122880
    buffer_load_dwordx4 v10, s[16:19], s91 offen lds
    s_add_u32 m0, m0, 4096
    s_add_u32 s91, s91, 122880
    buffer_load_dwordx4 v10, s[16:19], s91 offen lds
    s_add_u32 s45, s45, 16384
    s_cmp_eq_u32 s45, 49152
    s_cselect_b32 s45, 0, s45
    s_add_u32 s44, s44, 16384
    s_cmp_eq_u32 s44, 49152
    s_cselect_b32 s44, 0, s44
    s_waitcnt lgkmcnt(6)
    v_mfma_f32_16x16x32_bf16 v[44:47], v[28:31], a[32:35], v[44:47]
    v_mfma_f32_16x16x32_bf16 v[48:51], v[28:31], a[112:115], v[48:51]
    v_mfma_f32_16x16x32_bf16 v[52:55], v[28:31], a[192:195], v[52:55]
    s_waitcnt lgkmcnt(4)
    v_mfma_f32_16x16x32_bf16 v[44:47], v[32:35], a[36:39], v[44:47]
    v_mfma_f32_16x16x32_bf16 v[48:51], v[32:35], a[116:119], v[48:51]
    v_mfma_f32_16x16x32_bf16 v[52:55], v[32:35], a[196:199], v[52:55]
    s_waitcnt lgkmcnt(2)
    v_mfma_f32_16x16x32_bf16 v[44:47], v[36:39], a[40:43], v[44:47]
    v_mfma_f32_16x16x32_bf16 v[48:51], v[36:39], a[120:123], v[48:51]
    v_mfma_f32_16x16x32_bf16 v[52:55], v[36:39], a[200:203], v[52:55]
    s_waitcnt lgkmcnt(0)
    v_mfma_f32_16x16x32_bf16 v[44:47], v[40:43], a[44:47], v[44:47]
    v_mfma_f32_16x16x32_bf16 v[48:51], v[40:43], a[124:127], v[48:51]
    v_mfma_f32_16x16x32_bf16 v[52:55], v[40:43], a[204:207], v[52:55]
    v_add_u32 v13, s44, v12
    s_waitcnt vmcnt(4)
    s_barrier
    ds_read_b64_tr_b16 v[28:29], v13 offset:0
    ds_read_b64_tr_b16 v[30:31], v13 offset:512
    ds_read_b64_tr_b16 v[32:33], v13 offset:4096
    ds_read_b64_tr_b16 v[34:35], v13 offset:4608
    ds_read_b64_tr_b16 v[36:37], v13 offset:8192
    ds_read_b64_tr_b16 v[38:39], v13 offset:8704
    ds_read_b64_tr_b16 v[40:41], v13 offset:12288
    ds_read_b64_tr_b16 v[42:43], v13 offset:12800
    s_lshl_b32 s90, s32, 10
    s_add_u32 m0, s90, s45
    s_add_u32 s91, s43, 0
    buffer_load_dwordx4 v10, s[16:19], s91 offen lds
    s_add_u32 m0, m0, 4096
    s_add_u32 s91, s91, 122880
    buffer_load_dwordx4 v10, s[16:19], s91 offen lds
    s_add_u32 m0, m0, 4096
    s_add_u32 s91, s91, 122880
    buffer_load_dwordx4 v10, s[16:19], s91 offen lds
    s_add_u32 m0, m0, 4096
    s_add_u32 s91, s91, 122880
    buffer_load_dwordx4 v10, s[16:19], s91 offen lds
    s_add_u32 s45, s45, 16384
    s_cmp_eq_u32 s45, 49152
    s_cselect_b32 s45, 0, s45
    s_add_u32 s44, s44, 16384
    s_cmp_eq_u32 s44, 49152
    s_cselect_b32 s44, 0, s44
    s_waitcnt lgkmcnt(6)
    v_mfma_f32_16x16x32_bf16 v[44:47], v[28:31], a[48:51], v[44:47]
    v_mfma_f32_16x16x32_bf16 v[48:51], v[28:31], a[128:131], v[48:51]
    v_mfma_f32_16x16x32_bf16 v[52:55], v[28:31], a[208:211], v[52:55]
    s_waitcnt lgkmcnt(4)
    v_mfma_f32_16x16x32_bf16 v[44:47], v[32:35], a[52:55], v[44:47]
    v_mfma_f32_16x16x32_bf16 v[48:51], v[32:35], a[132:135], v[48:51]
    v_mfma_f32_16x16x32_bf16 v[52:55], v[32:35], a[212:215], v[52:55]
    s_waitcnt lgkmcnt(2)
    v_mfma_f32_16x16x32_bf16 v[44:47], v[36:39], a[56:59], v[44:47]
    v_mfma_f32_16x16x32_bf16 v[48:51], v[36:39], a[136:139], v[48:51]
    v_mfma_f32_16x16x32_bf16 v[52:55], v[36:39], a[216:219], v[52:55]
    s_waitcnt lgkmcnt(0)
    v_mfma_f32_16x16x32_bf16 v[44:47], v[40:43], a[60:63], v[44:47]
    v_mfma_f32_16x16x32_bf16 v[48:51], v[40:43], a[140:143], v[48:51]
    v_mfma_f32_16x16x32_bf16 v[52:55], v[40:43], a[220:223], v[52:55]
    v_add_u32 v13, s44, v12
    s_waitcnt vmcnt(4)
    s_barrier
    ds_read_b64_tr_b16 v[28:29], v13 offset:0
    ds_read_b64_tr_b16 v[30:31], v13 offset:512
    ds_read_b64_tr_b16 v[32:33], v13 offset:4096
    ds_read_b64_tr_b16 v[34:35], v13 offset:4608
    ds_read_b64_tr_b16 v[36:37], v13 offset:8192
    ds_read_b64_tr_b16 v[38:39], v13 offset:8704
    ds_read_b64_tr_b16 v[40:41], v13 offset:12288
    ds_read_b64_tr_b16 v[42:43], v13 offset:12800
    s_lshl_b32 s90, s32, 10
    s_add_u32 m0, s90, s45
    s_add_u32 s91, s43, 491520
    buffer_load_dwordx4 v10, s[16:19], s91 offen lds
    s_add_u32 m0, m0, 4096
    s_add_u32 s91, s91, 122880
    buffer_load_dwordx4 v10, s[16:19], s91 offen lds
    s_add_u32 m0, m0, 4096
    s_add_u32 s91, s91, 122880
    buffer_load_dwordx4 v10, s[16:19], s91 offen lds
    s_add_u32 m0, m0, 4096
    s_add_u32 s91, s91, 122880
    buffer_load_dwordx4 v10, s[16:19], s91 offen lds
    s_add_u32 s45, s45, 16384
    s_cmp_eq_u32 s45, 49152
    s_cselect_b32 s45, 0, s45
    s_add_u32 s44, s44, 16384
    s_cmp_eq_u32 s44, 49152
    s_cselect_b32 s44, 0, s44
    s_waitcnt lgkmcnt(6)
    v_mfma_f32_16x16x32_bf16 v[44:47], v[28:31], a[64:67], v[44:47]
    v_mfma_f32_16x16x32_bf16 v[48:51], v[28:31], a[144:147], v[48:51]
    v_mfma_f32_16x16x32_bf16 v[52:55], v[28:31], a[224:227], v[52:55]
    s_waitcnt lgkmcnt(4)
    v_mfma_f32_16x16x32_bf16 v[44:47], v[32:35], a[68:71], v[44:47]
    v_mfma_f32_16x16x32_bf16 v[48:51], v[32:35], a[148:151], v[48:51]
    v_mfma_f32_16x16x32_bf16 v[52:55], v[32:35], a[228:231], v[52:55]
    s_waitcnt lgkmcnt(2)
    v_mfma_f32_16x16x32_bf16 v[44:47], v[36:39], a[72:75], v[44:47]
    v_mfma_f32_16x16x32_bf16 v[48:51], v[36:39], a[152:155], v[48:51]
    v_mfma_f32_16x16x32_bf16 v[52:55], v[36:39], a[232:235], v[52:55]
    s_waitcnt lgkmcnt(0)
    v_mfma_f32_16x16x32_bf16 v[44:47], v[40:43], a[76:79], v[44:47]
    v_mfma_f32_16x16x32_bf16 v[48:51], v[40:43], a[156:159], v[48:51]
    v_mfma_f32_16x16x32_bf16 v[52:55], v[40:43], a[236:239], v[52:55]
    s_nop 0
    v_cvt_pk_bf16_f32 v56, v44, v45
    v_cvt_pk_bf16_f32 v57, v46, v47
    s_nop 1
    v_cvt_pk_bf16_f32 v58, v48, v49
    v_cvt_pk_bf16_f32 v59, v50, v51
    s_nop 0
    v_cvt_pk_bf16_f32 v60, v52, v53
    v_cvt_pk_bf16_f32 v61, v54, v55
    s_cmp_ge_u32 s41, 5
    s_cbranch_scc1 L_pa_kv
    v_add_u32 v16, s42, v14
    ds_write_b64 v16, v[58:59]
    ds_write_b64 v16, v[60:61] offset:20736
    s_branch L_pa_wr
L_pa_kv:
    s_sub_u32 s90, s41, 5
    s_lshl_b32 s90, s90, 7
    s_add_u32 s91, s90, 30464
    s_cmp_ge_u32 s41, 10
    s_cselect_b32 s90, s91, s90
    v_add_u32 v16, s90, v15
    ds_write_b64 v16, v[56:57]
    ds_write_b64 v16, v[58:59] offset:10368
    ds_write_b64 v16, v[60:61] offset:20736
L_pa_wr:
    s_waitcnt lgkmcnt(0)
    s_mov_b32 s42, s43
    s_add_u32 s41, s41, 1
    s_cmp_lt_u32 s41, 15
    s_cbranch_scc1 L_pa_blk
    s_barrier
    s_mov_b32 s48, 0
L_pa_att:
    s_mul_i32 s90, s48, 80
    v_add_u32 v21, s90, v19
    s_mul_i32 s91, s46, 640
    s_add_u32 s90, s90, s91
    v_add_u32 v20, s90, v18
    ds_read_b64 v[62:63], v20 offset:0
    ds_read_b64 v[64:65], v20 offset:8
    ds_read_b64 v[66:67], v20 offset:16
    ds_read_b64 v[68:69], v20 offset:24
    ds_read_b64 v[70:71], v20 offset:32
    ds_read_b64 v[72:73], v21 offset:9072
    ds_read_b64 v[74:75], v21 offset:9080
    ds_read_b64 v[76:77], v21 offset:9088
    ds_read_b64 v[78:79], v21 offset:9096
    ds_read_b64 v[80:81], v21 offset:9104
    ds_read_b64 v[82:83], v21 offset:7776
    ds_read_b64 v[84:85], v21 offset:7784
    ds_read_b64 v[86:87], v21 offset:7792
    ds_read_b64 v[88:89], v21 offset:7800
    ds_read_b64 v[90:91], v21 offset:7808
    s_waitcnt lgkmcnt(5)
    v_dot2_f32_bf16 v92, v62, v72, 0
    v_dot2_f32_bf16 v92, v63, v73, v92
    v_dot2_f32_bf16 v92, v64, v74, v92
    v_dot2_f32_bf16 v92, v65, v75, v92
    v_dot2_f32_bf16 v92, v66, v76, v92
    v_dot2_f32_bf16 v92, v67, v77, v92
    v_dot2_f32_bf16 v92, v68, v78, v92
    v_dot2_f32_bf16 v92, v69, v79, v92
    v_dot2_f32_bf16 v92, v70, v80, v92
    v_dot2_f32_bf16 v92, v71, v81, v92
    ds_read_b64 v[72:73], v21 offset:6480
    ds_read_b64 v[74:75], v21 offset:6488
    ds_read_b64 v[76:77], v21 offset:6496
    ds_read_b64 v[78:79], v21 offset:6504
    ds_read_b64 v[80:81], v21 offset:6512
    s_waitcnt lgkmcnt(5)
    v_dot2_f32_bf16 v93, v62, v82, 0
    v_dot2_f32_bf16 v93, v63, v83, v93
    v_dot2_f32_bf16 v93, v64, v84, v93
    v_dot2_f32_bf16 v93, v65, v85, v93
    v_dot2_f32_bf16 v93, v66, v86, v93
    v_dot2_f32_bf16 v93, v67, v87, v93
    v_dot2_f32_bf16 v93, v68, v88, v93
    v_dot2_f32_bf16 v93, v69, v89, v93
    v_dot2_f32_bf16 v93, v70, v90, v93
    v_dot2_f32_bf16 v93, v71, v91, v93
    ds_read_b64 v[82:83], v21 offset:5184
    ds_read_b64 v[84:85], v21 offset:5192
    ds_read_b64 v[86:87], v21 offset:5200
    ds_read_b64 v[88:89], v21 offset:5208
    ds_read_b64 v[90:91], v21 offset:5216
    s_waitcnt lgkmcnt(5)
    v_dot2_f32_bf16 v94, v62, v72, 0
    v_dot2_f32_bf16 v94, v63, v73, v94
    v_dot2_f32_bf16 v94, v64, v74, v94
    v_dot2_f32_bf16 v94, v65, v75, v94
    v_dot2_f32_bf16 v94, v66, v76, v94
    v_dot2_f32_bf16 v94, v67, v77, v94
    v_dot2_f32_bf16 v94, v68, v78, v94
    v_dot2_f32_bf16 v94, v69, v79, v94
    v_dot2_f32_bf16 v94, v70, v80, v94
    v_dot2_f32_bf16 v94, v71, v81, v94
    ds_read_b64 v[72:73], v21 offset:3888
    ds_read_b64 v[74:75], v21 offset:3896
    ds_read_b64 v[76:77], v21 offset:3904
    ds_read_b64 v[78:79], v21 offset:3912
    ds_read_b64 v[80:81], v21 offset:3920
    s_waitcnt lgkmcnt(5)
    v_dot2_f32_bf16 v95, v62, v82, 0
    v_dot2_f32_bf16 v95, v63, v83, v95
    v_dot2_f32_bf16 v95, v64, v84, v95
    v_dot2_f32_bf16 v95, v65, v85, v95
    v_dot2_f32_bf16 v95, v66, v86, v95
    v_dot2_f32_bf16 v95, v67, v87, v95
    v_dot2_f32_bf16 v95, v68, v88, v95
    v_dot2_f32_bf16 v95, v69, v89, v95
    v_dot2_f32_bf16 v95, v70, v90, v95
    v_dot2_f32_bf16 v95, v71, v91, v95
    ds_read_b64 v[82:83], v21 offset:2592
    ds_read_b64 v[84:85], v21 offset:2600
    ds_read_b64 v[86:87], v21 offset:2608
    ds_read_b64 v[88:89], v21 offset:2616
    ds_read_b64 v[90:91], v21 offset:2624
    s_waitcnt lgkmcnt(5)
    v_dot2_f32_bf16 v96, v62, v72, 0
    v_dot2_f32_bf16 v96, v63, v73, v96
    v_dot2_f32_bf16 v96, v64, v74, v96
    v_dot2_f32_bf16 v96, v65, v75, v96
    v_dot2_f32_bf16 v96, v66, v76, v96
    v_dot2_f32_bf16 v96, v67, v77, v96
    v_dot2_f32_bf16 v96, v68, v78, v96
    v_dot2_f32_bf16 v96, v69, v79, v96
    v_dot2_f32_bf16 v96, v70, v80, v96
    v_dot2_f32_bf16 v96, v71, v81, v96
    ds_read_b64 v[72:73], v21 offset:1296
    ds_read_b64 v[74:75], v21 offset:1304
    ds_read_b64 v[76:77], v21 offset:1312
    ds_read_b64 v[78:79], v21 offset:1320
    ds_read_b64 v[80:81], v21 offset:1328
    s_waitcnt lgkmcnt(5)
    v_dot2_f32_bf16 v97, v62, v82, 0
    v_dot2_f32_bf16 v97, v63, v83, v97
    v_dot2_f32_bf16 v97, v64, v84, v97
    v_dot2_f32_bf16 v97, v65, v85, v97
    v_dot2_f32_bf16 v97, v66, v86, v97
    v_dot2_f32_bf16 v97, v67, v87, v97
    v_dot2_f32_bf16 v97, v68, v88, v97
    v_dot2_f32_bf16 v97, v69, v89, v97
    v_dot2_f32_bf16 v97, v70, v90, v97
    v_dot2_f32_bf16 v97, v71, v91, v97
    ds_read_b64 v[82:83], v21 offset:0
    ds_read_b64 v[84:85], v21 offset:8
    ds_read_b64 v[86:87], v21 offset:16
    ds_read_b64 v[88:89], v21 offset:24
    ds_read_b64 v[90:91], v21 offset:32
    s_waitcnt lgkmcnt(5)
    v_dot2_f32_bf16 v98, v62, v72, 0
    v_dot2_f32_bf16 v98, v63, v73, v98
    v_dot2_f32_bf16 v98, v64, v74, v98
    v_dot2_f32_bf16 v98, v65, v75, v98
    v_dot2_f32_bf16 v98, v66, v76, v98
    v_dot2_f32_bf16 v98, v67, v77, v98
    v_dot2_f32_bf16 v98, v68, v78, v98
    v_dot2_f32_bf16 v98, v69, v79, v98
    v_dot2_f32_bf16 v98, v70, v80, v98
    v_dot2_f32_bf16 v98, v71, v81, v98
    ds_read_b64 v[72:73], v21 offset:40176
    ds_read_b64 v[74:75], v21 offset:40184
    ds_read_b64 v[76:77], v21 offset:40192
    ds_read_b64 v[78:79], v21 offset:40200
    ds_read_b64 v[80:81], v21 offset:40208
    s_waitcnt lgkmcnt(5)
    v_dot2_f32_bf16 v99, v62, v82, 0
    v_dot2_f32_bf16 v99, v63, v83, v99
    v_dot2_f32_bf16 v99, v64, v84, v99
    v_dot2_f32_bf16 v99, v65, v85, v99
    v_dot2_f32_bf16 v99, v66, v86, v99
    v_dot2_f32_bf16 v99, v67, v87, v99
    v_dot2_f32_bf16 v99, v68, v88, v99
    v_dot2_f32_bf16 v99, v69, v89, v99
    v_dot2_f32_bf16 v99, v70, v90, v99
    v_dot2_f32_bf16 v99, v71, v91, v99
    v_cmp_le_u32 vcc, 2, v22
    s_nop 1
    v_cndmask_b32 v93, v25, v93, vcc
    v_cmp_le_u32 vcc, 4, v22
    s_nop 1
    v_cndmask_b32 v94, v25, v94, vcc
    v_cmp_le_u32 vcc, 6, v22
    s_nop 1
    v_cndmask_b32 v95, v25, v95, vcc
    v_cmp_le_u32 vcc, 8, v22
    s_nop 1
    v_cndmask_b32 v96, v25, v96, vcc
    v_cmp_le_u32 vcc, 10, v22
    s_nop 1
    v_cndmask_b32 v97, v25, v97, vcc
    v_cmp_le_u32 vcc, 12, v22
    s_nop 1
    v_cndmask_b32 v98, v25, v98, vcc
    v_cmp_le_u32 vcc, 14, v22
    s_nop 1
    v_cndmask_b32 v99, v25, v99, vcc
    v_max_f32 v23, v92, v93
    v_max3_f32 v23, v23, v94, v95
    v_max3_f32 v23, v23, v96, v97
    v_max3_f32 v23, v23, v98, v99
    v_mul_f32 v23, 0xbea52b5c, v23
    v_fma_f32 v92, v92, s47, v23
    v_fma_f32 v93, v93, s47, v23
    v_fma_f32 v94, v94, s47, v23
    v_fma_f32 v95, v95, s47, v23
    v_fma_f32 v96, v96, s47, v23
    v_fma_f32 v97, v97, s47, v23
    v_fma_f32 v98, v98, s47, v23
    v_fma_f32 v99, v99, s47, v23
    v_exp_f32 v92, v92
    v_exp_f32 v93, v93
    v_exp_f32 v94, v94
    v_exp_f32 v95, v95
    v_exp_f32 v96, v96
    v_exp_f32 v97, v97
    v_exp_f32 v98, v98
    v_exp_f32 v99, v99
    v_add_f32 v24, v92, v93
    v_add_f32 v24, v24, v94
    v_add_f32 v24, v24, v95
    v_add_f32 v24, v24, v96
    v_add_f32 v24, v24, v97
    v_add_f32 v24, v24, v98
    v_add_f32 v24, v24, v99
    v_rcp_f32 v24, v24
    s_nop 0
    v_mul_f32 v92, v92, v24
    v_cvt_pk_bf16_f32 v100, v92, 0
    v_cvt_pk_bf16_f32 v101, 0, v92
    v_mul_f32 v93, v93, v24
    v_cvt_pk_bf16_f32 v102, v93, 0
    v_cvt_pk_bf16_f32 v103, 0, v93
    v_mul_f32 v94, v94, v24
    v_cvt_pk_bf16_f32 v104, v94, 0
    v_cvt_pk_bf16_f32 v105, 0, v94
    v_mul_f32 v95, v95, v24
    v_cvt_pk_bf16_f32 v106, v95, 0
    v_cvt_pk_bf16_f32 v107, 0, v95
    v_mul_f32 v96, v96, v24
    v_cvt_pk_bf16_f32 v108, v96, 0
    v_cvt_pk_bf16_f32 v109, 0, v96
    v_mul_f32 v97, v97, v24
    v_cvt_pk_bf16_f32 v110, v97, 0
    v_cvt_pk_bf16_f32 v111, 0, v97
    v_mul_f32 v98, v98, v24
    v_cvt_pk_bf16_f32 v112, v98, 0
    v_cvt_pk_bf16_f32 v113, 0, v98
    v_mul_f32 v99, v99, v24
    v_cvt_pk_bf16_f32 v114, v99, 0
    v_cvt_pk_bf16_f32 v115, 0, v99
    ds_read_b64 v[82:83], v21 offset:38880
    ds_read_b64 v[84:85], v21 offset:38888
    ds_read_b64 v[86:87], v21 offset:38896
    ds_read_b64 v[88:89], v21 offset:38904
    ds_read_b64 v[90:91], v21 offset:38912
    s_waitcnt lgkmcnt(5)
    v_dot2_f32_bf16 v116, v72, v100, 0
    v_dot2_f32_bf16 v117, v72, v101, 0
    v_dot2_f32_bf16 v118, v73, v100, 0
    v_dot2_f32_bf16 v119, v73, v101, 0
    v_dot2_f32_bf16 v120, v74, v100, 0
    v_dot2_f32_bf16 v121, v74, v101, 0
    v_dot2_f32_bf16 v122, v75, v100, 0
    v_dot2_f32_bf16 v123, v75, v101, 0
    v_dot2_f32_bf16 v124, v76, v100, 0
    v_dot2_f32_bf16 v125, v76, v101, 0
    v_dot2_f32_bf16 v126, v77, v100, 0
    v_dot2_f32_bf16 v127, v77, v101, 0
    v_dot2_f32_bf16 v128, v78, v100, 0
    v_dot2_f32_bf16 v129, v78, v101, 0
    v_dot2_f32_bf16 v130, v79, v100, 0
    v_dot2_f32_bf16 v131, v79, v101, 0
    v_dot2_f32_bf16 v132, v80, v100, 0
    v_dot2_f32_bf16 v133, v80, v101, 0
    v_dot2_f32_bf16 v134, v81, v100, 0
    v_dot2_f32_bf16 v135, v81, v101, 0
    ds_read_b64 v[72:73], v21 offset:37584
    ds_read_b64 v[74:75], v21 offset:37592
    ds_read_b64 v[76:77], v21 offset:37600
    ds_read_b64 v[78:79], v21 offset:37608
    ds_read_b64 v[80:81], v21 offset:37616
    s_waitcnt lgkmcnt(5)
    v_dot2_f32_bf16 v116, v82, v102, v116
    v_dot2_f32_bf16 v117, v82, v103, v117
    v_dot2_f32_bf16 v118, v83, v102, v118
    v_dot2_f32_bf16 v119, v83, v103, v119
    v_dot2_f32_bf16 v120, v84, v102, v120
    v_dot2_f32_bf16 v121, v84, v103, v121
    v_dot2_f32_bf16 v122, v85, v102, v122
    v_dot2_f32_bf16 v123, v85, v103, v123
    v_dot2_f32_bf16 v124, v86, v102, v124
    v_dot2_f32_bf16 v125, v86, v103, v125
    v_dot2_f32_bf16 v126, v87, v102, v126
    v_dot2_f32_bf16 v127, v87, v103, v127
    v_dot2_f32_bf16 v128, v88, v102, v128
    v_dot2_f32_bf16 v129, v88, v103, v129
    v_dot2_f32_bf16 v130, v89, v102, v130
    v_dot2_f32_bf16 v131, v89, v103, v131
    v_dot2_f32_bf16 v132, v90, v102, v132
    v_dot2_f32_bf16 v133, v90, v103, v133
    v_dot2_f32_bf16 v134, v91, v102, v134
    v_dot2_f32_bf16 v135, v91, v103, v135
    ds_read_b64 v[82:83], v21 offset:36288
    ds_read_b64 v[84:85], v21 offset:36296
    ds_read_b64 v[86:87], v21 offset:36304
    ds_read_b64 v[88:89], v21 offset:36312
    ds_read_b64 v[90:91], v21 offset:36320
    s_waitcnt lgkmcnt(5)
    v_dot2_f32_bf16 v116, v72, v104, v116
    v_dot2_f32_bf16 v117, v72, v105, v117
    v_dot2_f32_bf16 v118, v73, v104, v118
    v_dot2_f32_bf16 v119, v73, v105, v119
    v_dot2_f32_bf16 v120, v74, v104, v120
    v_dot2_f32_bf16 v121, v74, v105, v121
    v_dot2_f32_bf16 v122, v75, v104, v122
    v_dot2_f32_bf16 v123, v75, v105, v123
    v_dot2_f32_bf16 v124, v76, v104, v124
    v_dot2_f32_bf16 v125, v76, v105, v125
    v_dot2_f32_bf16 v126, v77, v104, v126
    v_dot2_f32_bf16 v127, v77, v105, v127
    v_dot2_f32_bf16 v128, v78, v104, v128
    v_dot2_f32_bf16 v129, v78, v105, v129
    v_dot2_f32_bf16 v130, v79, v104, v130
    v_dot2_f32_bf16 v131, v79, v105, v131
    v_dot2_f32_bf16 v132, v80, v104, v132
    v_dot2_f32_bf16 v133, v80, v105, v133
    v_dot2_f32_bf16 v134, v81, v104, v134
    v_dot2_f32_bf16 v135, v81, v105, v135
    ds_read_b64 v[72:73], v21 offset:34992
    ds_read_b64 v[74:75], v21 offset:35000
    ds_read_b64 v[76:77], v21 offset:35008
    ds_read_b64 v[78:79], v21 offset:35016
    ds_read_b64 v[80:81], v21 offset:35024
    s_waitcnt lgkmcnt(5)
    v_dot2_f32_bf16 v116, v82, v106, v116
    v_dot2_f32_bf16 v117, v82, v107, v117
    v_dot2_f32_bf16 v118, v83, v106, v118
    v_dot2_f32_bf16 v119, v83, v107, v119
    v_dot2_f32_bf16 v120, v84, v106, v120
    v_dot2_f32_bf16 v121, v84, v107, v121
    v_dot2_f32_bf16 v122, v85, v106, v122
    v_dot2_f32_bf16 v123, v85, v107, v123
    v_dot2_f32_bf16 v124, v86, v106, v124
    v_dot2_f32_bf16 v125, v86, v107, v125
    v_dot2_f32_bf16 v126, v87, v106, v126
    v_dot2_f32_bf16 v127, v87, v107, v127
    v_dot2_f32_bf16 v128, v88, v106, v128
    v_dot2_f32_bf16 v129, v88, v107, v129
    v_dot2_f32_bf16 v130, v89, v106, v130
    v_dot2_f32_bf16 v131, v89, v107, v131
    v_dot2_f32_bf16 v132, v90, v106, v132
    v_dot2_f32_bf16 v133, v90, v107, v133
    v_dot2_f32_bf16 v134, v91, v106, v134
    v_dot2_f32_bf16 v135, v91, v107, v135
    ds_read_b64 v[82:83], v21 offset:33696
    ds_read_b64 v[84:85], v21 offset:33704
    ds_read_b64 v[86:87], v21 offset:33712
    ds_read_b64 v[88:89], v21 offset:33720
    ds_read_b64 v[90:91], v21 offset:33728
    s_waitcnt lgkmcnt(5)
    v_dot2_f32_bf16 v116, v72, v108, v116
    v_dot2_f32_bf16 v117, v72, v109, v117
    v_dot2_f32_bf16 v118, v73, v108, v118
    v_dot2_f32_bf16 v119, v73, v109, v119
    v_dot2_f32_bf16 v120, v74, v108, v120
    v_dot2_f32_bf16 v121, v74, v109, v121
    v_dot2_f32_bf16 v122, v75, v108, v122
    v_dot2_f32_bf16 v123, v75, v109, v123
    v_dot2_f32_bf16 v124, v76, v108, v124
    v_dot2_f32_bf16 v125, v76, v109, v125
    v_dot2_f32_bf16 v126, v77, v108, v126
    v_dot2_f32_bf16 v127, v77, v109, v127
    v_dot2_f32_bf16 v128, v78, v108, v128
    v_dot2_f32_bf16 v129, v78, v109, v129
    v_dot2_f32_bf16 v130, v79, v108, v130
    v_dot2_f32_bf16 v131, v79, v109, v131
    v_dot2_f32_bf16 v132, v80, v108, v132
    v_dot2_f32_bf16 v133, v80, v109, v133
    v_dot2_f32_bf16 v134, v81, v108, v134
    v_dot2_f32_bf16 v135, v81, v109, v135
    ds_read_b64 v[72:73], v21 offset:32400
    ds_read_b64 v[74:75], v21 offset:32408
    ds_read_b64 v[76:77], v21 offset:32416
    ds_read_b64 v[78:79], v21 offset:32424
    ds_read_b64 v[80:81], v21 offset:32432
    s_waitcnt lgkmcnt(5)
    v_dot2_f32_bf16 v116, v82, v110, v116
    v_dot2_f32_bf16 v117, v82, v111, v117
    v_dot2_f32_bf16 v118, v83, v110, v118
    v_dot2_f32_bf16 v119, v83, v111, v119
    v_dot2_f32_bf16 v120, v84, v110, v120
    v_dot2_f32_bf16 v121, v84, v111, v121
    v_dot2_f32_bf16 v122, v85, v110, v122
    v_dot2_f32_bf16 v123, v85, v111, v123
    v_dot2_f32_bf16 v124, v86, v110, v124
    v_dot2_f32_bf16 v125, v86, v111, v125
    v_dot2_f32_bf16 v126, v87, v110, v126
    v_dot2_f32_bf16 v127, v87, v111, v127
    v_dot2_f32_bf16 v128, v88, v110, v128
    v_dot2_f32_bf16 v129, v88, v111, v129
    v_dot2_f32_bf16 v130, v89, v110, v130
    v_dot2_f32_bf16 v131, v89, v111, v131
    v_dot2_f32_bf16 v132, v90, v110, v132
    v_dot2_f32_bf16 v133, v90, v111, v133
    v_dot2_f32_bf16 v134, v91, v110, v134
    v_dot2_f32_bf16 v135, v91, v111, v135
    ds_read_b64 v[82:83], v21 offset:31104
    ds_read_b64 v[84:85], v21 offset:31112
    ds_read_b64 v[86:87], v21 offset:31120
    ds_read_b64 v[88:89], v21 offset:31128
    ds_read_b64 v[90:91], v21 offset:31136
    s_waitcnt lgkmcnt(5)
    v_dot2_f32_bf16 v116, v72, v112, v116
    v_dot2_f32_bf16 v117, v72, v113, v117
    v_dot2_f32_bf16 v118, v73, v112, v118
    v_dot2_f32_bf16 v119, v73, v113, v119
    v_dot2_f32_bf16 v120, v74, v112, v120
    v_dot2_f32_bf16 v121, v74, v113, v121
    v_dot2_f32_bf16 v122, v75, v112, v122
    v_dot2_f32_bf16 v123, v75, v113, v123
    v_dot2_f32_bf16 v124, v76, v112, v124
    v_dot2_f32_bf16 v125, v76, v113, v125
    v_dot2_f32_bf16 v126, v77, v112, v126
    v_dot2_f32_bf16 v127, v77, v113, v127
    v_dot2_f32_bf16 v128, v78, v112, v128
    v_dot2_f32_bf16 v129, v78, v113, v129
    v_dot2_f32_bf16 v130, v79, v112, v130
    v_dot2_f32_bf16 v131, v79, v113, v131
    v_dot2_f32_bf16 v132, v80, v112, v132
    v_dot2_f32_bf16 v133, v80, v113, v133
    v_dot2_f32_bf16 v134, v81, v112, v134
    v_dot2_f32_bf16 v135, v81, v113, v135
    s_waitcnt lgkmcnt(0)
    v_dot2_f32_bf16 v116, v82, v114, v116
    v_dot2_f32_bf16 v117, v82, v115, v117
    v_dot2_f32_bf16 v118, v83, v114, v118
    v_dot2_f32_bf16 v119, v83, v115, v119
    v_dot2_f32_bf16 v120, v84, v114, v120
    v_dot2_f32_bf16 v121, v84, v115, v121
    v_dot2_f32_bf16 v122, v85, v114, v122
    v_dot2_f32_bf16 v123, v85, v115, v123
    v_dot2_f32_bf16 v124, v86, v114, v124
    v_dot2_f32_bf16 v125, v86, v115, v125
    v_dot2_f32_bf16 v126, v87, v114, v126
    v_dot2_f32_bf16 v127, v87, v115, v127
    v_dot2_f32_bf16 v128, v88, v114, v128
    v_dot2_f32_bf16 v129, v88, v115, v129
    v_dot2_f32_bf16 v130, v89, v114, v130
    v_dot2_f32_bf16 v131, v89, v115, v131
    v_dot2_f32_bf16 v132, v90, v114, v132
    v_dot2_f32_bf16 v133, v90, v115, v133
    v_dot2_f32_bf16 v134, v91, v114, v134
    v_dot2_f32_bf16 v135, v91, v115, v135
    v_cvt_pk_bf16_f32 v62, v116, v117
    v_cvt_pk_bf16_f32 v63, v118, v119
    v_cvt_pk_bf16_f32 v64, v120, v121
    v_cvt_pk_bf16_f32 v65, v122, v123
    v_cvt_pk_bf16_f32 v66, v124, v125
    v_cvt_pk_bf16_f32 v67, v126, v127
    v_cvt_pk_bf16_f32 v68, v128, v129
    v_cvt_pk_bf16_f32 v69, v130, v131
    v_cvt_pk_bf16_f32 v70, v132, v133
    v_cvt_pk_bf16_f32 v71, v134, v135
    ds_write_b64 v20, v[62:63] offset:0
    ds_write_b64 v20, v[64:65] offset:8
    ds_write_b64 v20, v[66:67] offset:16
    ds_write_b64 v20, v[68:69] offset:24
    ds_write_b64 v20, v[70:71] offset:32
    s_waitcnt lgkmcnt(0)
    s_add_u32 s48, s48, 1
    s_cmp_lt_u32 s48, 2
    s_cbranch_scc1 L_pa_att
    s_add_u32 s46, s46, 1
    s_cmp_lt_u32 s46, 2
    s_cbranch_scc1 L_pa_half
    s_mov_b32 s42, 0
    s_waitcnt vmcnt(0) lgkmcnt(0)
    s_barrier
    s_mov_b32 s44, 0
    s_mov_b32 s45, 0
    s_mov_b32 s41, 0
    s_lshl_b32 s90, s32, 10
    s_add_u32 m0, s90, s45
    s_add_u32 s91, s42, 0
    buffer_load_dwordx4 v11, s[20:23], s91 offen lds
    s_add_u32 m0, m0, 4096
    s_add_u32 s91, s91, 40960
    buffer_load_dwordx4 v11, s[20:23], s91 offen lds
    s_add_u32 m0, m0, 4096
    s_add_u32 s91, s91, 40960
    buffer_load_dwordx4 v11, s[20:23], s91 offen lds
    s_add_u32 m0, m0, 4096
    s_add_u32 s91, s91, 40960
    buffer_load_dwordx4 v11, s[20:23], s91 offen lds
    s_add_u32 s45, s45, 16384
    s_cmp_eq_u32 s45, 49152
    s_cselect_b32 s45, 0, s45
    s_lshl_b32 s90, s32, 10
    s_add_u32 m0, s90, s45
    s_add_u32 s91, s42, 163840
    buffer_load_dwordx4 v11, s[20:23], s91 offen lds
    s_add_u32 m0, m0, 4096
    s_add_u32 s91, s91, 40960
    buffer_load_dwordx4 v11, s[20:23], s91 offen lds
    s_add_u32 m0, m0, 4096
    s_add_u32 s91, s91, 40960
    buffer_load_dwordx4 v11, s[20:23], s91 offen lds
    s_add_u32 m0, m0, 4096
    s_add_u32 s91, s91, 40960
    buffer_load_dwordx4 v11, s[20:23], s91 offen lds
    s_add_u32 s45, s45, 16384
    s_cmp_eq_u32 s45, 49152
    s_cselect_b32 s45, 0, s45
    ds_read_b128 a[0:3], v26 offset:0
    ds_read_b128 a[4:7], v26 offset:64
    ds_read_b128 a[8:11], v26 offset:128
    ds_read_b128 a[12:15], v26 offset:192
    ds_read_b128 a[16:19], v26 offset:256
    ds_read_b128 a[20:23], v26 offset:320
    ds_read_b128 a[24:27], v26 offset:384
    ds_read_b128 a[28:31], v26 offset:448
    ds_read_b128 a[32:35], v26 offset:512
    ds_read_b128 a[36:39], v26 offset:576
    ds_read_b128 a[40:43], v26 offset:640
    ds_read_b128 a[44:47], v26 offset:704
    ds_read_b128 a[48:51], v26 offset:768
    ds_read_b128 a[52:55], v26 offset:832
    ds_read_b128 a[56:59], v26 offset:896
    ds_read_b128 a[60:63], v26 offset:960
    ds_read_b128 a[64:67], v26 offset:1024
    ds_read_b128 a[68:71], v26 offset:1088
    ds_read_b128 a[72:75], v26 offset:1152
    ds_read_b128 a[76:79], v26 offset:1216
    ds_read_b128 a[80:83], v26 offset:20736
    ds_read_b128 a[84:87], v26 offset:20800
    ds_read_b128 a[88:91], v26 offset:20864
    ds_read_b128 a[92:95], v26 offset:20928
    ds_read_b128 a[96:99], v26 offset:20992
    ds_read_b128 a[100:103], v26 offset:21056
    ds_read_b128 a[104:107], v26 offset:21120
    ds_read_b128 a[108:111], v26 offset:21184
    ds_read_b128 a[112:115], v26 offset:21248
    ds_read_b128 a[116:119], v26 offset:21312
    ds_read_b128 a[120:123], v26 offset:21376
    ds_read_b128 a[124:127], v26 offset:21440
    ds_read_b128 a[128:131], v26 offset:21504
    ds_read_b128 a[132:135], v26 offset:21568
    ds_read_b128 a[136:139], v26 offset:21632
    ds_read_b128 a[140:143], v26 offset:21696
    ds_read_b128 a[144:147], v26 offset:21760
    ds_read_b128 a[148:151], v26 offset:21824
    ds_read_b128 a[152:155], v26 offset:21888
    ds_read_b128 a[156:159], v26 offset:21952
    s_waitcnt lgkmcnt(0)
L_pa_oblk:
    s_add_u32 s43, s42, 128
    s_cmp_eq_u32 s41, 9
    s_cselect_b32 s43, s42, s43
    v_add_u32 v13, s44, v12
    s_waitcnt vmcnt(4)
    s_barrier
    ds_read_b64_tr_b16 v[28:29], v13 offset:0
    ds_read_b64_tr_b16 v[30:31], v13 offset:512
    ds_read_b64_tr_b16 v[32:33], v13 offset:4096
    ds_read_b64_tr_b16 v[34:35], v13 offset:4608
    ds_read_b64_tr_b16 v[36:37], v13 offset:8192
    ds_read_b64_tr_b16 v[38:39], v13 offset:8704
    ds_read_b64_tr_b16 v[40:41], v13 offset:12288
    ds_read_b64_tr_b16 v[42:43], v13 offset:12800
    s_lshl_b32 s90, s32, 10
    s_add_u32 m0, s90, s45
    s_add_u32 s91, s42, 327680
    buffer_load_dwordx4 v11, s[20:23], s91 offen lds
    s_add_u32 m0, m0, 4096
    s_add_u32 s91, s91, 40960
    buffer_load_dwordx4 v11, s[20:23], s91 offen lds
    s_add_u32 m0, m0, 4096
    s_add_u32 s91, s91, 40960
    buffer_load_dwordx4 v11, s[20:23], s91 offen lds
    s_add_u32 m0, m0, 4096
    s_add_u32 s91, s91, 40960
    buffer_load_dwordx4 v11, s[20:23], s91 offen lds
    s_add_u32 s45, s45, 16384
    s_cmp_eq_u32 s45, 49152
    s_cselect_b32 s45, 0, s45
    s_add_u32 s44, s44, 16384
    s_cmp_eq_u32 s44, 49152
    s_cselect_b32 s44, 0, s44
    s_waitcnt lgkmcnt(6)
    v_mfma_f32_16x16x32_bf16 v[44:47], v[28:31], a[0:3], 0
    v_mfma_f32_16x16x32_bf16 v[48:51], v[28:31], a[80:83], 0
    s_waitcnt lgkmcnt(4)
    v_mfma_f32_16x16x32_bf16 v[44:47], v[32:35], a[4:7], v[44:47]
    v_mfma_f32_16x16x32_bf16 v[48:51], v[32:35], a[84:87], v[48:51]
    s_waitcnt lgkmcnt(2)
    v_mfma_f32_16x16x32_bf16 v[44:47], v[36:39], a[8:11], v[44:47]
    v_mfma_f32_16x16x32_bf16 v[48:51], v[36:39], a[88:91], v[48:51]
    s_waitcnt lgkmcnt(0)
    v_mfma_f32_16x16x32_bf16 v[44:47], v[40:43], a[12:15], v[44:47]
    v_mfma_f32_16x16x32_bf16 v[48:51], v[40:43], a[92:95], v[48:51]
    v_add_u32 v13, s44, v12
    s_waitcnt vmcnt(4)
    s_barrier
    ds_read_b64_tr_b16 v[28:29], v13 offset:0
    ds_read_b64_tr_b16 v[30:31], v13 offset:512
    ds_read_b64_tr_b16 v[32:33], v13 offset:4096
    ds_read_b64_tr_b16 v[34:35], v13 offset:4608
    ds_read_b64_tr_b16 v[36:37], v13 offset:8192
    ds_read_b64_tr_b16 v[38:39], v13 offset:8704
    ds_read_b64_tr_b16 v[40:41], v13 offset:12288
    ds_read_b64_tr_b16 v[42:43], v13 offset:12800
    s_lshl_b32 s90, s32, 10
    s_add_u32 m0, s90, s45
    s_add_u32 s91, s42, 491520
    buffer_load_dwordx4 v11, s[20:23], s91 offen lds
    s_add_u32 m0, m0, 4096
    s_add_u32 s91, s91, 40960
    buffer_load_dwordx4 v11, s[20:23], s91 offen lds
    s_add_u32 m0, m0, 4096
    s_add_u32 s91, s91, 40960
    buffer_load_dwordx4 v11, s[20:23], s91 offen lds
    s_add_u32 m0, m0, 4096
    s_add_u32 s91, s91, 40960
    buffer_load_dwordx4 v11, s[20:23], s91 offen lds
    s_add_u32 s45, s45, 16384
    s_cmp_eq_u32 s45, 49152
    s_cselect_b32 s45, 0, s45
    s_add_u32 s44, s44, 16384
    s_cmp_eq_u32 s44, 49152
    s_cselect_b32 s44, 0, s44
    s_waitcnt lgkmcnt(6)
    v_mfma_f32_16x16x32_bf16 v[44:47], v[28:31], a[16:19], v[44:47]
    v_mfma_f32_16x16x32_bf16 v[48:51], v[28:31], a[96:99], v[48:51]
    s_waitcnt lgkmcnt(4)
    v_mfma_f32_16x16x32_bf16 v[44:47], v[32:35], a[20:23], v[44:47]
    v_mfma_f32_16x16x32_bf16 v[48:51], v[32:35], a[100:103], v[48:51]
    s_waitcnt lgkmcnt(2)
    v_mfma_f32_16x16x32_bf16 v[44:47], v[36:39], a[24:27], v[44:47]
    v_mfma_f32_16x16x32_bf16 v[48:51], v[36:39], a[104:107], v[48:51]
    s_waitcnt lgkmcnt(0)
    v_mfma_f32_16x16x32_bf16 v[44:47], v[40:43], a[28:31], v[44:47]
    v_mfma_f32_16x16x32_bf16 v[48:51], v[40:43], a[108:111], v[48:51]
    v_add_u32 v13, s44, v12
    s_waitcnt vmcnt(4)
    s_barrier
    ds_read_b64_tr_b16 v[28:29], v13 offset:0
    ds_read_b64_tr_b16 v[30:31], v13 offset:512
    ds_read_b64_tr_b16 v[32:33], v13 offset:4096
    ds_read_b64_tr_b16 v[34:35], v13 offset:4608
    ds_read_b64_tr_b16 v[36:37], v13 offset:8192
    ds_read_b64_tr_b16 v[38:39], v13 offset:8704
    ds_read_b64_tr_b16 v[40:41], v13 offset:12288
    ds_read_b64_tr_b16 v[42:43], v13 offset:12800
    s_lshl_b32 s90, s32, 10
    s_add_u32 m0, s90, s45
    s_add_u32 s91, s42, 655360
    buffer_load_dwordx4 v11, s[20:23], s91 offen lds
    s_add_u32 m0, m0, 4096
    s_add_u32 s91, s91, 40960
    buffer_load_dwordx4 v11, s[20:23], s91 offen lds
    s_add_u32 m0, m0, 4096
    s_add_u32 s91, s91, 40960
    buffer_load_dwordx4 v11, s[20:23], s91 offen lds
    s_add_u32 m0, m0, 4096
    s_add_u32 s91, s91, 40960
    buffer_load_dwordx4 v11, s[20:23], s91 offen lds
    s_add_u32 s45, s45, 16384
    s_cmp_eq_u32 s45, 49152
    s_cselect_b32 s45, 0, s45
    s_add_u32 s44, s44, 16384
    s_cmp_eq_u32 s44, 49152
    s_cselect_b32 s44, 0, s44
    s_waitcnt lgkmcnt(6)
    v_mfma_f32_16x16x32_bf16 v[44:47], v[28:31], a[32:35], v[44:47]
    v_mfma_f32_16x16x32_bf16 v[48:51], v[28:31], a[112:115], v[48:51]
    s_waitcnt lgkmcnt(4)
    v_mfma_f32_16x16x32_bf16 v[44:47], v[32:35], a[36:39], v[44:47]
    v_mfma_f32_16x16x32_bf16 v[48:51], v[32:35], a[116:119], v[48:51]
    s_waitcnt lgkmcnt(2)
    v_mfma_f32_16x16x32_bf16 v[44:47], v[36:39], a[40:43], v[44:47]
    v_mfma_f32_16x16x32_bf16 v[48:51], v[36:39], a[120:123], v[48:51]
    s_waitcnt lgkmcnt(0)
    v_mfma_f32_16x16x32_bf16 v[44:47], v[40:43], a[44:47], v[44:47]
    v_mfma_f32_16x16x32_bf16 v[48:51], v[40:43], a[124:127], v[48:51]
    v_add_u32 v13, s44, v12
    s_waitcnt vmcnt(4)
    s_barrier
    ds_read_b64_tr_b16 v[28:29], v13 offset:0
    ds_read_b64_tr_b16 v[30:31], v13 offset:512
    ds_read_b64_tr_b16 v[32:33], v13 offset:4096
    ds_read_b64_tr_b16 v[34:35], v13 offset:4608
    ds_read_b64_tr_b16 v[36:37], v13 offset:8192
    ds_read_b64_tr_b16 v[38:39], v13 offset:8704
    ds_read_b64_tr_b16 v[40:41], v13 offset:12288
    ds_read_b64_tr_b16 v[42:43], v13 offset:12800
    s_lshl_b32 s90, s32, 10
    s_add_u32 m0, s90, s45
    s_add_u32 s91, s43, 0
    buffer_load_dwordx4 v11, s[20:23], s91 offen lds
    s_add_u32 m0, m0, 4096
    s_add_u32 s91, s91, 40960
    buffer_load_dwordx4 v11, s[20:23], s91 offen lds
    s_add_u32 m0, m0, 4096
    s_add_u32 s91, s91, 40960
    buffer_load_dwordx4 v11, s[20:23], s91 offen lds
    s_add_u32 m0, m0, 4096
    s_add_u32 s91, s91, 40960
    buffer_load_dwordx4 v11, s[20:23], s91 offen lds
    s_add_u32 s45, s45, 16384
    s_cmp_eq_u32 s45, 49152
    s_cselect_b32 s45, 0, s45
    s_add_u32 s44, s44, 16384
    s_cmp_eq_u32 s44, 49152
    s_cselect_b32 s44, 0, s44
    s_waitcnt lgkmcnt(6)
    v_mfma_f32_16x16x32_bf16 v[44:47], v[28:31], a[48:51], v[44:47]
    v_mfma_f32_16x16x32_bf16 v[48:51], v[28:31], a[128:131], v[48:51]
    s_waitcnt lgkmcnt(4)
    v_mfma_f32_16x16x32_bf16 v[44:47], v[32:35], a[52:55], v[44:47]
    v_mfma_f32_16x16x32_bf16 v[48:51], v[32:35], a[132:135], v[48:51]
    s_waitcnt lgkmcnt(2)
    v_mfma_f32_16x16x32_bf16 v[44:47], v[36:39], a[56:59], v[44:47]
    v_mfma_f32_16x16x32_bf16 v[48:51], v[36:39], a[136:139], v[48:51]
    s_waitcnt lgkmcnt(0)
    v_mfma_f32_16x16x32_bf16 v[44:47], v[40:43], a[60:63], v[44:47]
    v_mfma_f32_16x16x32_bf16 v[48:51], v[40:43], a[140:143], v[48:51]
    v_add_u32 v13, s44, v12
    s_waitcnt vmcnt(4)
    s_barrier
    ds_read_b64_tr_b16 v[28:29], v13 offset:0
    ds_read_b64_tr_b16 v[30:31], v13 offset:512
    ds_read_b64_tr_b16 v[32:33], v13 offset:4096
    ds_read_b64_tr_b16 v[34:35], v13 offset:4608
    ds_read_b64_tr_b16 v[36:37], v13 offset:8192
    ds_read_b64_tr_b16 v[38:39], v13 offset:8704
    ds_read_b64_tr_b16 v[40:41], v13 offset:12288
    ds_read_b64_tr_b16 v[42:43], v13 offset:12800
    s_lshl_b32 s90, s32, 10
    s_add_u32 m0, s90, s45
    s_add_u32 s91, s43, 163840
    buffer_load_dwordx4 v11, s[20:23], s91 offen lds
    s_add_u32 m0, m0, 4096
    s_add_u32 s91, s91, 40960
    buffer_load_dwordx4 v11, s[20:23], s91 offen lds
    s_add_u32 m0, m0, 4096
    s_add_u32 s91, s91, 40960
    buffer_load_dwordx4 v11, s[20:23], s91 offen lds
    s_add_u32 m0, m0, 4096
    s_add_u32 s91, s91, 40960
    buffer_load_dwordx4 v11, s[20:23], s91 offen lds
    s_add_u32 s45, s45, 16384
    s_cmp_eq_u32 s45, 49152
    s_cselect_b32 s45, 0, s45
    s_add_u32 s44, s44, 16384
    s_cmp_eq_u32 s44, 49152
    s_cselect_b32 s44, 0, s44
    s_waitcnt lgkmcnt(6)
    v_mfma_f32_16x16x32_bf16 v[44:47], v[28:31], a[64:67], v[44:47]
    v_mfma_f32_16x16x32_bf16 v[48:51], v[28:31], a[144:147], v[48:51]
    s_waitcnt lgkmcnt(4)
    v_mfma_f32_16x16x32_bf16 v[44:47], v[32:35], a[68:71], v[44:47]
    v_mfma_f32_16x16x32_bf16 v[48:51], v[32:35], a[148:151], v[48:51]
    s_waitcnt lgkmcnt(2)
    v_mfma_f32_16x16x32_bf16 v[44:47], v[36:39], a[72:75], v[44:47]
    v_mfma_f32_16x16x32_bf16 v[48:51], v[36:39], a[152:155], v[48:51]
    s_waitcnt lgkmcnt(0)
    v_mfma_f32_16x16x32_bf16 v[44:47], v[40:43], a[76:79], v[44:47]
    v_mfma_f32_16x16x32_bf16 v[48:51], v[40:43], a[156:159], v[48:51]
    s_nop 4
    v_cvt_pk_bf16_f32 v56, v44, v45
    v_cvt_pk_bf16_f32 v57, v46, v47
    s_nop 0
    v_cvt_pk_bf16_f32 v58, v48, v49
    v_cvt_pk_bf16_f32 v59, v50, v51
    s_nop 0
    v_permlane16_swap_b32 v56, v58
    v_permlane16_swap_b32 v57, v59
    buffer_store_dwordx4 v[56:59], v17, s[28:31], s42 offen
    s_mov_b32 s42, s43
    s_add_u32 s41, s41, 1
    s_cmp_lt_u32 s41, 10
    s_cbranch_scc1 L_pa_oblk
    s_waitcnt vmcnt(0)
    s_endpgm
L_slow:
    s_waitcnt vmcnt(0) lgkmcnt(0)
    s_barrier
    s_and_b32 s34, s2, 7
    s_lshr_b32 s35, s2, 3
    s_add_u32 s4, s88, 33554432
    s_addc_u32 s5, s89, 0
    s_and_b32 s5, s5, 0xffff
    s_lshl_b32 s38, s34, 21
    s_add_u32 s38, s38, 8388608
    s_cmp_lt_u32 s35, 12
    s_cbranch_scc1 L_qkv_s
    s_cmp_lt_u32 s35, 22
    s_cbranch_scc1 L_wo_s
    s_cmp_lt_u32 s35, 24
    s_cbranch_scc1 L_px_s
    s_branch L_pa_s
L_qkv_s:
    s_mov_b32 s12, s74
    s_and_b32 s13, s75, 0xffff
    s_mov_b32 s14, 7864320
    s_mov_b32 s15, 0x20000
    s_mov_b32 s16, s76
    s_and_b32 s17, s77, 0xffff
    s_mov_b32 s18, 7864320
    s_mov_b32 s19, 0x20000
    s_mov_b32 s20, s78
    s_and_b32 s21, s79, 0xffff
    s_mov_b32 s22, 7864320
    s_mov_b32 s23, 0x20000
    s_mov_b32 s24, s70
    s_and_b32 s25, s71, 0xffff
    s_mov_b32 s26, 2621440
    s_mov_b32 s27, 0x20000
    s_mul_i32 s40, s35, 86
    s_lshr_b32 s40, s40, 8
    s_mul_i32 s90, s40, 3
    s_sub_u32 s41, s35, s90
    v_and_b32 v1, 15, v0
    v_lshrrev_b32 v2, 4, v0
    v_lshrrev_b32 v3, 3, v0
    v_and_b32 v4, 7, v0
    s_lshl_b32 s90, s32, 3
    v_add_u32 v5, s90, v3
    s_and_b32 s91, s32, 1
    s_lshl_b32 s91, s91, 2
    v_and_b32 v6, 2, v3
    v_or_b32 v6, s91, v6
    v_xor_b32 v6, v6, v4
    v_lshlrev_b32 v6, 4, v6
    v_mul_u32_u24 v7, 12288, v5
    s_lshl_b32 s92, s34, 2
    s_add_u32 s92, s92, s40
    s_mul_i32 s92, s92, 384
    s_lshl_b32 s93, s41, 7
    s_add_u32 s92, s92, s93
    v_add3_u32 v164, v6, v7, s92
    v_lshrrev_b32 v6, 1, v3
    v_or_b32 v6, s91, v6
    v_xor_b32 v6, v6, v4
    v_lshlrev_b32 v6, 4, v6
    v_mul_u32_u24 v7, 1280, v5
    v_add_u32 v10, v6, v7
    s_lshl_b32 s90, s32, 10
    s_add_u32 m0, s90, 40960
    s_mov_b32 s91, 0
    buffer_load_dwordx4 v164, s[20:23], s91 offen lds
    s_add_u32 m0, m0, 4096
    s_add_u32 s91, s91, 393216
    buffer_load_dwordx4 v164, s[20:23], s91 offen lds
    s_add_u32 m0, m0, 4096
    s_add_u32 s91, s91, 393216
    buffer_load_dwordx4 v164, s[20:23], s91 offen lds
    s_add_u32 m0, m0, 4096
    s_add_u32 s91, s91, 393216
    buffer_load_dwordx4 v164, s[20:23], s91 offen lds
    s_add_u32 m0, m0, 4096
    s_add_u32 s91, s91, 393216
    buffer_load_dwordx4 v164, s[20:23], s91 offen lds
    s_add_u32 m0, m0, 4096
    s_add_u32 s91, s91, 393216
    buffer_load_dwordx4 v164, s[20:23], s91 offen lds
    s_add_u32 m0, m0, 4096
    s_add_u32 s91, s91, 393216
    buffer_load_dwordx4 v164, s[20:23], s91 offen lds
    s_add_u32 m0, m0, 4096
    s_add_u32 s91, s91, 393216
    buffer_load_dwordx4 v164, s[20:23], s91 offen lds
    s_add_u32 m0, m0, 4096
    s_add_u32 s91, s91, 393216
    buffer_load_dwordx4 v164, s[20:23], s91 offen lds
    s_add_u32 m0, m0, 4096
    s_add_u32 s91, s91, 393216
    buffer_load_dwordx4 v164, s[20:23], s91 offen lds
    s_lshl_b32 s90, s32, 10
    s_add_u32 m0, s90, 81920
    s_mov_b32 s91, 3932160
    buffer_load_dwordx4 v164, s[20:23], s91 offen lds
    s_add_u32 m0, m0, 4096
    s_add_u32 s91, s91, 393216
    buffer_load_dwordx4 v164, s[20:23], s91 offen lds
    s_add_u32 m0, m0, 4096
    s_add_u32 s91, s91, 393216
    buffer_load_dwordx4 v164, s[20:23], s91 offen lds
    s_add_u32 m0, m0, 4096
    s_add_u32 s91, s91, 393216
    buffer_load_dwordx4 v164, s[20:23], s91 offen lds
    s_add_u32 m0, m0, 4096
    s_add_u32 s91, s91, 393216
    buffer_load_dwordx4 v164, s[20:23], s91 offen lds
    s_add_u32 m0, m0, 4096
    s_add_u32 s91, s91, 393216
    buffer_load_dwordx4 v164, s[20:23], s91 offen lds
    s_add_u32 m0, m0, 4096
    s_add_u32 s91, s91, 393216
    buffer_load_dwordx4 v164, s[20:23], s91 offen lds
    s_add_u32 m0, m0, 4096
    s_add_u32 s91, s91, 393216
    buffer_load_dwordx4 v164, s[20:23], s91 offen lds
    s_add_u32 m0, m0, 4096
    s_add_u32 s91, s91, 393216
    buffer_load_dwordx4 v164, s[20:23], s91 offen lds
    s_add_u32 m0, m0, 4096
    s_add_u32 s91, s91, 393216
    buffer_load_dwordx4 v164, s[20:23], s91 offen lds
    s_lshl_b32 s90, s32, 10
    s_add_u32 m0, s90, 122880
    s_mov_b32 s91, 0
    buffer_load_dwordx4 v164, s[16:19], s91 offen lds
    s_add_u32 m0, m0, 4096
    s_add_u32 s91, s91, 393216
    buffer_load_dwordx4 v164, s[16:19], s91 offen lds
    s_add_u32 m0, m0, 4096
    s_add_u32 s91, s91, 393216
    buffer_load_dwordx4 v164, s[16:19], s91 offen lds
    s_add_u32 m0, m0, 4096
    s_add_u32 s91, s91, 393216
    buffer_load_dwordx4 v164, s[16:19], s91 offen lds
    s_add_u32 m0, m0, 4096
    s_add_u32 s91, s91, 393216
    buffer_load_dwordx4 v164, s[16:19], s91 offen lds
    s_add_u32 m0, m0, 4096
    s_add_u32 s91, s91, 393216
    buffer_load_dwordx4 v164, s[16:19], s91 offen lds
    s_add_u32 m0, m0, 4096
    s_add_u32 s91, s91, 393216
    buffer_load_dwordx4 v164, s[16:19], s91 offen lds
    s_add_u32 m0, m0, 4096
    s_add_u32 s91, s91, 393216
    buffer_load_dwordx4 v164, s[16:19], s91 offen lds
    s_add_u32 m0, m0, 4096
    s_add_u32 s91, s91, 393216
    buffer_load_dwordx4 v164, s[16:19], s91 offen lds
    s_add_u32 m0, m0, 4096
    s_add_u32 s91, s91, 393216
    buffer_load_dwordx4 v164, s[16:19], s91 offen lds
    s_mov_b32 s46, 0
    s_lshl_b32 s90, s32, 10
    s_add_u32 m0, s90, 0
    s_nop 0
    buffer_load_dwordx4 v10, s[24:27], s46 offen offset:0 lds
    s_add_u32 m0, m0, 3968
    s_nop 0
    buffer_load_dwordx4 v10, s[24:27], s46 offen offset:128 lds
    s_add_u32 m0, m0, 3968
    s_nop 0
    buffer_load_dwordx4 v10, s[24:27], s46 offen offset:256 lds
    s_add_u32 m0, m0, 3968
    s_nop 0
    buffer_load_dwordx4 v10, s[24:27], s46 offen offset:384 lds
    s_add_u32 m0, m0, 3968
    s_nop 0
    buffer_load_dwordx4 v10, s[24:27], s46 offen offset:512 lds
    s_add_u32 m0, m0, 3968
    s_nop 0
    buffer_load_dwordx4 v10, s[24:27], s46 offen offset:640 lds
    s_add_u32 m0, m0, 3968
    s_nop 0
    buffer_load_dwordx4 v10, s[24:27], s46 offen offset:768 lds
    s_add_u32 m0, m0, 3968
    s_nop 0
    buffer_load_dwordx4 v10, s[24:27], s46 offen offset:896 lds
    s_add_u32 m0, m0, 3968
    s_nop 0
    buffer_load_dwordx4 v10, s[24:27], s46 offen offset:1024 lds
    s_add_u32 m0, m0, 3968
    s_nop 0
    buffer_load_dwordx4 v10, s[24:27], s46 offen offset:1152 lds
    s_mul_i32 s90, s40, 3072
    s_lshl_b32 s91, s41, 10
    s_add_u32 s90, s90, s91
    s_lshl_b32 s91, s32, 8
    s_add_u32 s91, s91, s90
    s_add_u32 s91, s91, 25600
    v_lshl_add_u32 v21, v1, 4, s91
    v_cmp_eq_u32 vcc, 0, v2
    v_mov_b32 v9, 2146435072
    s_nop 0
    v_cndmask_b32 v21, v9, v21, vcc
    v_lshrrev_b32 v3, 2, v1
    v_lshlrev_b32 v3, 1, v3
    v_and_b32 v4, 1, v1
    v_or_b32 v3, v3, v4
    v_lshl_add_u32 v3, v2, 3, v3
    v_lshl_add_u32 v26, v3, 4, s90
    v_and_b32 v4, 2, v1
    v_cmp_ne_u32 vcc, 0, v4
    v_mov_b32 v9, 2146435072
    s_nop 0
    v_cndmask_b32 v26, v9, v26, vcc
    s_mul_i32 s90, s40, 3840
    s_mul_i32 s91, s41, 1280
    s_add_u32 s90, s90, s91
    s_add_u32 s90, s90, 10240
    v_lshrrev_b32 v3, 1, v2
    v_and_b32 v5, 1, v2
    v_lshlrev_b32 v6, 1, v5
    v_or_b32 v7, v6, v3
    v_lshl_add_u32 v7, v7, 4, v1
    v_lshlrev_b32 v7, 2, v7
    v_add_u32 v7, 1024, v7
    v_or_b32 v6, v6, v1
    v_lshl_add_u32 v6, v3, 4, v6
    v_lshlrev_b32 v6, 4, v6
    s_sub_u32 s91, s32, 1
    s_lshl_b32 s91, s91, 9
    v_add_u32 v6, s91, v6
    s_cmp_eq_u32 s32, 0
    s_cselect_b64 vcc, -1, 0
    v_cndmask_b32 v6, v6, v7, vcc
    v_add_u32 v25, s90, v6
    v_cmp_eq_u32 vcc, 0, v4
    v_mov_b32 v9, 2146435072
    s_nop 0
    v_cndmask_b32 v25, v9, v25, vcc
    s_and_b32 s90, s32, 1
    s_lshl_b32 s90, s90, 9
    s_lshr_b32 s91, s32, 1
    s_lshl_b32 s91, s91, 10
    s_add_u32 s90, s90, s91
    v_lshlrev_b32 v6, 4, v1
    v_lshl_add_u32 v6, v3, 8, v6
    v_add_u32 v6, s90, v6
    v_lshl_add_u32 v27, v5, 11, v6
    v_add_u32 v27, 136192, v27
    s_mul_i32 s90, s40, 12288
    s_lshl_b32 s91, s41, 11
    s_add_u32 s90, s90, s91
    v_mul_u32_u24 v7, 6144, v5
    v_add3_u32 v29, v6, v7, s90
    v_and_b32 v6, 9, v1
    v_and_b32 v7, 2, v1
    v_lshl_or_b32 v6, v7, 1, v6
    v_and_b32 v7, 4, v1
    v_lshrrev_b32 v7, 1, v7
    v_or_b32 v6, v6, v7
    v_lshlrev_b32 v6, 4, v6
    v_lshl_add_u32 v6, v2, 8, v6
    s_cmp_eq_u32 s32, 2
    s_cselect_b32 s90, 2048, 0
    s_add_u32 s90, s90, 136192
    v_add_u32 v28, s90, v6
    s_lshl_b32 s90, s40, 7
    s_lshl_b32 s91, s41, 2
    s_add_u32 s92, s91, s32
    s_lshl_b32 s92, s92, 2
    s_add_u32 s92, s92, s90
    s_add_u32 s92, s92, 163840
    v_mov_b32 v30, s92
    s_add_u32 s91, s91, s90
    s_add_u32 s91, s91, 164352
    s_cmp_eq_u32 s32, 3
    s_cselect_b32 s91, s91, 2146435072
    v_mov_b32 v31, s91
    v_cmp_eq_u32 vcc, 0, v0
    v_mov_b32 v9, 2146435072
    s_nop 0
    v_cndmask_b32 v30, v9, v30, vcc
    v_cndmask_b32 v220, 1, 3, vcc
    v_cmp_eq_u32 vcc, 1, v0
    s_nop 1
    v_cndmask_b32 v31, v30, v31, vcc
    v_mov_b32 v36, -1
    v_mov_b32 v37, -1
    v_mov_b32 v38, -1
    v_mov_b32 v39, -1
    s_mul_i32 s90, s35, 49152
    s_lshl_b32 s91, s32, 11
    s_add_u32 s90, s90, s91
    s_lshl_b32 s92, s35, 10
    s_lshl_b32 s91, s32, 8
    s_add_u32 s92, s92, s91
    s_cmp_lt_u32 s35, 10
    s_cselect_b32 s90, s90, 2146435072
    s_cselect_b32 s92, s92, 2146435072
    v_lshl_add_u32 v214, v0, 4, s90
    v_add_u32 v215, 1024, v214
    s_min_u32 s90, s35, 9
    s_lshl_b32 s90, s90, 7
    s_add_u32 s90, s90, 165888
    v_and_b32 v3, 3, v0
    v_lshl_add_u32 v216, v3, 2, s90
    v_lshl_add_u32 v219, v0, 2, s92
    v_lshl_add_u32 v218, v1, 4, s92
    v_cmp_eq_u32 vcc, 0, v2
    v_mov_b32 v9, 2146435072
    s_nop 0
    v_cndmask_b32 v218, v9, v218, vcc
    v_and_b32 v7, 1, v1
    v_cmp_ne_u32 vcc, 0, v7
    v_mov_b32 v5, 0x3f80
    v_mov_b32 v6, 0x3f800000
    v_cndmask_b32 v5, v5, v6, vcc
    v_bfe_u32 v6, v1, 1, 1
    v_cmp_eq_u32 vcc, 0, v6
    s_nop 1
    v_cndmask_b32 v210, 0, v5, vcc
    v_mov_b32 v208, 0
    v_mov_b32 v212, 0
    v_cmp_eq_u32 vcc, 1, v6
    s_nop 1
    v_cndmask_b32 v211, 0, v5, vcc
    v_mov_b32 v209, 0
    v_mov_b32 v213, 0
    v_lshrrev_b32 v3, 2, v1
    v_and_b32 v4, 3, v1
    v_and_b32 v5, 1, v2
    v_lshl_add_u32 v6, v2, 3, v3
    v_lshlrev_b32 v6, 7, v6
    v_and_b32 v7, 2, v3
    v_lshl_or_b32 v7, v5, 2, v7
    v_lshrrev_b32 v8, 1, v4
    s_lshl_b32 s90, s32, 1
    v_or_b32 v8, s90, v8
    v_xor_b32 v7, v7, v8
    v_lshl_add_u32 v6, v7, 4, v6
    v_and_b32 v7, 1, v4
    v_lshl_add_u32 v6, v7, 3, v6
    v_add_u32 v165, 40960, v6
    v_add_u32 v166, 81920, v6
    v_add_u32 v167, 122880, v6
    v_xor_b32 v6, 0, v5
    v_lshl_add_u32 v6, v6, 2, v3
    v_lshl_add_u32 v6, v2, 3, v6
    v_lshlrev_b32 v6, 5, v6
    v_lshl_or_b32 v7, v5, 1, 0
    v_xor_b32 v7, v7, v4
    v_lshl_add_u32 v6, v7, 3, v6
    v_add_u32 v23, 133120, v6
    v_xor_b32 v6, 1, v5
    v_lshl_add_u32 v6, v6, 2, v3
    v_lshl_add_u32 v6, v2, 3, v6
    v_lshlrev_b32 v6, 5, v6
    v_lshl_or_b32 v7, v5, 1, 1
    v_xor_b32 v7, v7, v4
    v_lshl_add_u32 v6, v7, 3, v6
    v_add_u32 v24, 133120, v6
    v_lshrrev_b32 v6, 3, v1
    v_lshlrev_b32 v6, 2, v6
    v_xor_b32 v6, v6, v1
    v_lshlrev_b32 v6, 5, v6
    v_xor_b32 v7, v2, v3
    v_lshl_add_u32 v6, v7, 3, v6
    s_lshl_b32 s90, s32, 9
    s_add_u32 s90, s90, 133120
    v_add_u32 v22, s90, v6
    v_lshlrev_b32 v6, 6, v3
    v_and_b32 v7, 1, v1
    v_lshl_add_u32 v6, v7, 5, v6
    v_lshl_add_u32 v6, v2, 3, v6
    v_and_b32 v7, 2, v1
    v_lshl_add_u32 v6, v7, 1, v6
    s_lshl_b32 s90, s32, 8
    s_add_u32 s90, s90, 135168
    v_add_u32 v19, s90, v6
    v_lshl_add_u32 v20, v1, 3, s90
    v_cmp_ne_u32 vcc, 0, v7
    v_mov_b32 v6, 0x4444
    v_mov_b32 v8, 0xeeee
    v_cndmask_b32 v18, v6, v8, vcc
    v_lshlrev_b32 v6, 4, v0
    v_add_u32 v16, 122880, v6
    s_mul_i32 s90, s32, 2560
    v_lshl_add_u32 v13, v0, 4, s90
    v_lshl_add_u32 v14, v0, 2, s90
    s_add_u32 s48, s90, 122880
    v_mul_u32_u24 v6, 40, v0
    v_add_u32 v15, s48, v6
    v_lshrrev_b32 v6, 3, v1
    v_lshlrev_b32 v6, 10, v6
    v_and_b32 v7, 7, v1
    v_lshl_add_u32 v6, v7, 7, v6
    v_lshrrev_b32 v7, 1, v1
    v_xor_b32 v7, v7, v2
    v_lshl_add_u32 v11, v7, 4, v6
    v_xor_b32 v12, 64, v11
    s_waitcnt vmcnt(30)
    s_barrier
    ds_read_b64_tr_b16 a[160:161], v165 offset:0
    ds_read_b64_tr_b16 a[162:163], v165 offset:512
    ds_read_b64_tr_b16 a[164:165], v165 offset:4096
    ds_read_b64_tr_b16 a[166:167], v165 offset:4608
    ds_read_b64_tr_b16 a[168:169], v165 offset:8192
    ds_read_b64_tr_b16 a[170:171], v165 offset:8704
    ds_read_b64_tr_b16 a[172:173], v165 offset:12288
    ds_read_b64_tr_b16 a[174:175], v165 offset:12800
    ds_read_b64_tr_b16 a[176:177], v165 offset:16384
    ds_read_b64_tr_b16 a[178:179], v165 offset:16896
    ds_read_b64_tr_b16 a[180:181], v165 offset:20480
    ds_read_b64_tr_b16 a[182:183], v165 offset:20992
    ds_read_b64_tr_b16 a[184:185], v165 offset:24576
    ds_read_b64_tr_b16 a[186:187], v165 offset:25088
    ds_read_b64_tr_b16 a[188:189], v165 offset:28672
    ds_read_b64_tr_b16 a[190:191], v165 offset:29184
    ds_read_b64_tr_b16 a[192:193], v165 offset:32768
    ds_read_b64_tr_b16 a[194:195], v165 offset:33280
    ds_read_b64_tr_b16 a[196:197], v165 offset:36864
    ds_read_b64_tr_b16 a[198:199], v165 offset:37376
    s_waitcnt lgkmcnt(0)
    s_barrier
    s_lshl_b32 s90, s32, 10
    s_add_u32 m0, s90, 40960
    s_mov_b32 s91, 3932160
    buffer_load_dwordx4 v164, s[16:19], s91 offen lds
    s_add_u32 m0, m0, 4096
    s_add_u32 s91, s91, 393216
    buffer_load_dwordx4 v164, s[16:19], s91 offen lds
    s_add_u32 m0, m0, 4096
    s_add_u32 s91, s91, 393216
    buffer_load_dwordx4 v164, s[16:19], s91 offen lds
    s_add_u32 m0, m0, 4096
    s_add_u32 s91, s91, 393216
    buffer_load_dwordx4 v164, s[16:19], s91 offen lds
    s_add_u32 m0, m0, 4096
    s_add_u32 s91, s91, 393216
    buffer_load_dwordx4 v164, s[16:19], s91 offen lds
    s_add_u32 m0, m0, 4096
    s_add_u32 s91, s91, 393216
    buffer_load_dwordx4 v164, s[16:19], s91 offen lds
    s_add_u32 m0, m0, 4096
    s_add_u32 s91, s91, 393216
    buffer_load_dwordx4 v164, s[16:19], s91 offen lds
    s_add_u32 m0, m0, 4096
    s_add_u32 s91, s91, 393216
    buffer_load_dwordx4 v164, s[16:19], s91 offen lds
    s_add_u32 m0, m0, 4096
    s_add_u32 s91, s91, 393216
    buffer_load_dwordx4 v164, s[16:19], s91 offen lds
    s_add_u32 m0, m0, 4096
    s_add_u32 s91, s91, 393216
    buffer_load_dwordx4 v164, s[16:19], s91 offen lds
    s_waitcnt vmcnt(30)
    s_barrier
    ds_read_b64_tr_b16 a[200:201], v166 offset:0
    ds_read_b64_tr_b16 a[202:203], v166 offset:512
    ds_read_b64_tr_b16 a[204:205], v166 offset:4096
    ds_read_b64_tr_b16 a[206:207], v166 offset:4608
    ds_read_b64_tr_b16 a[208:209], v166 offset:8192
    ds_read_b64_tr_b16 a[210:211], v166 offset:8704
    ds_read_b64_tr_b16 a[212:213], v166 offset:12288
    ds_read_b64_tr_b16 a[214:215], v166 offset:12800
    ds_read_b64_tr_b16 a[216:217], v166 offset:16384
    ds_read_b64_tr_b16 a[218:219], v166 offset:16896
    ds_read_b64_tr_b16 a[220:221], v166 offset:20480
    ds_read_b64_tr_b16 a[222:223], v166 offset:20992
    ds_read_b64_tr_b16 a[224:225], v166 offset:24576
    ds_read_b64_tr_b16 a[226:227], v166 offset:25088
    ds_read_b64_tr_b16 a[228:229], v166 offset:28672
    ds_read_b64_tr_b16 a[230:231], v166 offset:29184
    ds_read_b64_tr_b16 a[232:233], v166 offset:32768
    ds_read_b64_tr_b16 a[234:235], v166 offset:33280
    ds_read_b64_tr_b16 a[236:237], v166 offset:36864
    ds_read_b64_tr_b16 a[238:239], v166 offset:37376
    s_waitcnt lgkmcnt(0)
    s_barrier
    s_lshl_b32 s90, s32, 10
    s_add_u32 m0, s90, 81920
    s_mov_b32 s91, 0
    buffer_load_dwordx4 v164, s[12:15], s91 offen lds
    s_add_u32 m0, m0, 4096
    s_add_u32 s91, s91, 393216
    buffer_load_dwordx4 v164, s[12:15], s91 offen lds
    s_add_u32 m0, m0, 4096
    s_add_u32 s91, s91, 393216
    buffer_load_dwordx4 v164, s[12:15], s91 offen lds
    s_add_u32 m0, m0, 4096
    s_add_u32 s91, s91, 393216
    buffer_load_dwordx4 v164, s[12:15], s91 offen lds
    s_add_u32 m0, m0, 4096
    s_add_u32 s91, s91, 393216
    buffer_load_dwordx4 v164, s[12:15], s91 offen lds
    s_add_u32 m0, m0, 4096
    s_add_u32 s91, s91, 393216
    buffer_load_dwordx4 v164, s[12:15], s91 offen lds
    s_add_u32 m0, m0, 4096
    s_add_u32 s91, s91, 393216
    buffer_load_dwordx4 v164, s[12:15], s91 offen lds
    s_add_u32 m0, m0, 4096
    s_add_u32 s91, s91, 393216
    buffer_load_dwordx4 v164, s[12:15], s91 offen lds
    s_add_u32 m0, m0, 4096
    s_add_u32 s91, s91, 393216
    buffer_load_dwordx4 v164, s[12:15], s91 offen lds
    s_add_u32 m0, m0, 4096
    s_add_u32 s91, s91, 393216
    buffer_load_dwordx4 v164, s[12:15], s91 offen lds
    s_waitcnt vmcnt(30)
    s_barrier
    ds_read_b64_tr_b16 a[80:81], v167 offset:0
    ds_read_b64_tr_b16 a[82:83], v167 offset:512
    ds_read_b64_tr_b16 a[84:85], v167 offset:4096
    ds_read_b64_tr_b16 a[86:87], v167 offset:4608
    ds_read_b64_tr_b16 a[88:89], v167 offset:8192
    ds_read_b64_tr_b16 a[90:91], v167 offset:8704
    ds_read_b64_tr_b16 a[92:93], v167 offset:12288
    ds_read_b64_tr_b16 a[94:95], v167 offset:12800
    ds_read_b64_tr_b16 a[96:97], v167 offset:16384
    ds_read_b64_tr_b16 a[98:99], v167 offset:16896
    ds_read_b64_tr_b16 a[100:101], v167 offset:20480
    ds_read_b64_tr_b16 a[102:103], v167 offset:20992
    ds_read_b64_tr_b16 a[104:105], v167 offset:24576
    ds_read_b64_tr_b16 a[106:107], v167 offset:25088
    ds_read_b64_tr_b16 a[108:109], v167 offset:28672
    ds_read_b64_tr_b16 a[110:111], v167 offset:29184
    ds_read_b64_tr_b16 a[112:113], v167 offset:32768
    ds_read_b64_tr_b16 a[114:115], v167 offset:33280
    ds_read_b64_tr_b16 a[116:117], v167 offset:36864
    ds_read_b64_tr_b16 a[118:119], v167 offset:37376
    s_waitcnt lgkmcnt(0)
    s_barrier
    s_lshl_b32 s90, s32, 10
    s_add_u32 m0, s90, 122880
    s_mov_b32 s91, 3932160
    buffer_load_dwordx4 v164, s[12:15], s91 offen lds
    s_add_u32 m0, m0, 4096
    s_add_u32 s91, s91, 393216
    buffer_load_dwordx4 v164, s[12:15], s91 offen lds
    s_add_u32 m0, m0, 4096
    s_add_u32 s91, s91, 393216
    buffer_load_dwordx4 v164, s[12:15], s91 offen lds
    s_add_u32 m0, m0, 4096
    s_add_u32 s91, s91, 393216
    buffer_load_dwordx4 v164, s[12:15], s91 offen lds
    s_add_u32 m0, m0, 4096
    s_add_u32 s91, s91, 393216
    buffer_load_dwordx4 v164, s[12:15], s91 offen lds
    s_add_u32 m0, m0, 4096
    s_add_u32 s91, s91, 393216
    buffer_load_dwordx4 v164, s[12:15], s91 offen lds
    s_add_u32 m0, m0, 4096
    s_add_u32 s91, s91, 393216
    buffer_load_dwordx4 v164, s[12:15], s91 offen lds
    s_add_u32 m0, m0, 4096
    s_add_u32 s91, s91, 393216
    buffer_load_dwordx4 v164, s[12:15], s91 offen lds
    s_add_u32 m0, m0, 4096
    s_add_u32 s91, s91, 393216
    buffer_load_dwordx4 v164, s[12:15], s91 offen lds
    s_add_u32 m0, m0, 4096
    s_add_u32 s91, s91, 393216
    buffer_load_dwordx4 v164, s[12:15], s91 offen lds
    s_waitcnt vmcnt(20)
    s_barrier
    ds_read_b64_tr_b16 a[120:121], v165 offset:0
    ds_read_b64_tr_b16 a[122:123], v165 offset:512
    ds_read_b64_tr_b16 a[124:125], v165 offset:4096
    ds_read_b64_tr_b16 a[126:127], v165 offset:4608
    ds_read_b64_tr_b16 a[128:129], v165 offset:8192
    ds_read_b64_tr_b16 a[130:131], v165 offset:8704
    ds_read_b64_tr_b16 a[132:133], v165 offset:12288
    ds_read_b64_tr_b16 a[134:135], v165 offset:12800
    ds_read_b64_tr_b16 a[136:137], v165 offset:16384
    ds_read_b64_tr_b16 a[138:139], v165 offset:16896
    ds_read_b64_tr_b16 a[140:141], v165 offset:20480
    ds_read_b64_tr_b16 a[142:143], v165 offset:20992
    ds_read_b64_tr_b16 a[144:145], v165 offset:24576
    ds_read_b64_tr_b16 a[146:147], v165 offset:25088
    ds_read_b64_tr_b16 a[148:149], v165 offset:28672
    ds_read_b64_tr_b16 a[150:151], v165 offset:29184
    ds_read_b64_tr_b16 a[152:153], v165 offset:32768
    ds_read_b64_tr_b16 a[154:155], v165 offset:33280
    ds_read_b64_tr_b16 a[156:157], v165 offset:36864
    ds_read_b64_tr_b16 a[158:159], v165 offset:37376
    s_waitcnt lgkmcnt(0)
    s_barrier
    s_mov_b32 s46, 40960
    s_lshl_b32 s90, s32, 10
    s_add_u32 m0, s90, 40960
    s_nop 0
    buffer_load_dwordx4 v10, s[24:27], s46 offen offset:0 lds
    s_add_u32 m0, m0, 3968
    s_nop 0
    buffer_load_dwordx4 v10, s[24:27], s46 offen offset:128 lds
    s_add_u32 m0, m0, 3968
    s_nop 0
    buffer_load_dwordx4 v10, s[24:27], s46 offen offset:256 lds
    s_add_u32 m0, m0, 3968
    s_nop 0
    buffer_load_dwordx4 v10, s[24:27], s46 offen offset:384 lds
    s_add_u32 m0, m0, 3968
    s_nop 0
    buffer_load_dwordx4 v10, s[24:27], s46 offen offset:512 lds
    s_add_u32 m0, m0, 3968
    s_nop 0
    buffer_load_dwordx4 v10, s[24:27], s46 offen offset:640 lds
    s_add_u32 m0, m0, 3968
    s_nop 0
    buffer_load_dwordx4 v10, s[24:27], s46 offen offset:768 lds
    s_add_u32 m0, m0, 3968
    s_nop 0
    buffer_load_dwordx4 v10, s[24:27], s46 offen offset:896 lds
    s_add_u32 m0, m0, 3968
    s_nop 0
    buffer_load_dwordx4 v10, s[24:27], s46 offen offset:1024 lds
    s_add_u32 m0, m0, 3968
    s_nop 0
    buffer_load_dwordx4 v10, s[24:27], s46 offen offset:1152 lds
    s_waitcnt vmcnt(20)
    s_barrier
    ds_read_b64_tr_b16 a[0:1], v166 offset:0
    ds_read_b64_tr_b16 a[2:3], v166 offset:512
    ds_read_b64_tr_b16 a[4:5], v166 offset:4096
    ds_read_b64_tr_b16 a[6:7], v166 offset:4608
    ds_read_b64_tr_b16 a[8:9], v166 offset:8192
    ds_read_b64_tr_b16 a[10:11], v166 offset:8704
    ds_read_b64_tr_b16 a[12:13], v166 offset:12288
    ds_read_b64_tr_b16 a[14:15], v166 offset:12800
    ds_read_b64_tr_b16 a[16:17], v166 offset:16384
    ds_read_b64_tr_b16 a[18:19], v166 offset:16896
    ds_read_b64_tr_b16 a[20:21], v166 offset:20480
    ds_read_b64_tr_b16 a[22:23], v166 offset:20992
    ds_read_b64_tr_b16 a[24:25], v166 offset:24576
    ds_read_b64_tr_b16 a[26:27], v166 offset:25088
    ds_read_b64_tr_b16 a[28:29], v166 offset:28672
    ds_read_b64_tr_b16 a[30:31], v166 offset:29184
    ds_read_b64_tr_b16 a[32:33], v166 offset:32768
    ds_read_b64_tr_b16 a[34:35], v166 offset:33280
    ds_read_b64_tr_b16 a[36:37], v166 offset:36864
    ds_read_b64_tr_b16 a[38:39], v166 offset:37376
    s_waitcnt lgkmcnt(0)
    s_barrier
    s_waitcnt vmcnt(10)
    s_barrier
    ds_read_b64_tr_b16 a[40:41], v167 offset:0
    ds_read_b64_tr_b16 a[42:43], v167 offset:512
    ds_read_b64_tr_b16 a[44:45], v167 offset:4096
    ds_read_b64_tr_b16 a[46:47], v167 offset:4608
    ds_read_b64_tr_b16 a[48:49], v167 offset:8192
    ds_read_b64_tr_b16 a[50:51], v167 offset:8704
    ds_read_b64_tr_b16 a[52:53], v167 offset:12288
    ds_read_b64_tr_b16 a[54:55], v167 offset:12800
    ds_read_b64_tr_b16 a[56:57], v167 offset:16384
    ds_read_b64_tr_b16 a[58:59], v167 offset:16896
    ds_read_b64_tr_b16 a[60:61], v167 offset:20480
    ds_read_b64_tr_b16 a[62:63], v167 offset:20992
    ds_read_b64_tr_b16 a[64:65], v167 offset:24576
    ds_read_b64_tr_b16 a[66:67], v167 offset:25088
    ds_read_b64_tr_b16 a[68:69], v167 offset:28672
    ds_read_b64_tr_b16 a[70:71], v167 offset:29184
    ds_read_b64_tr_b16 a[72:73], v167 offset:32768
    ds_read_b64_tr_b16 a[74:75], v167 offset:33280
    ds_read_b64_tr_b16 a[76:77], v167 offset:36864
    ds_read_b64_tr_b16 a[78:79], v167 offset:37376
    s_waitcnt lgkmcnt(0)
    s_barrier
    s_mov_b32 s49, 40960
    s_mov_b32 s47, 40960
    s_add_u32 s45, s38, 221184
    s_add_u32 s50, s45, 49152
    s_add_u32 s51, s45, 98304
    v_add_u32 v34, 0, v27
    s_mov_b32 s46, 40960
    ds_read_b128 v[116:119], v11 offset:0
    ds_read_b128 v[120:123], v11 offset:2048
    ds_read_b128 v[124:127], v12 offset:0
    ds_read_b128 v[128:131], v12 offset:2048
    s_waitcnt lgkmcnt(2)
    v_mfma_f32_16x16x32_bf16 v[140:143], a[160:163], v[116:119], 0
    ds_read_b128 v[132:135], v11 offset:4096
    v_mfma_f32_16x16x32_bf16 v[144:147], a[160:163], v[120:123], 0
    ds_read_b128 v[136:139], v11 offset:6144
    v_mfma_f32_16x16x32_bf16 v[148:151], a[80:83], v[116:119], 0
    v_mfma_f32_16x16x32_bf16 v[152:155], a[80:83], v[120:123], 0
    v_mfma_f32_16x16x32_bf16 v[156:159], a[0:3], v[116:119], 0
    v_mfma_f32_16x16x32_bf16 v[160:163], a[0:3], v[120:123], 0
    s_waitcnt lgkmcnt(2)
    v_mfma_f32_16x16x32_bf16 v[140:143], a[164:167], v[124:127], v[140:143]
    ds_read_b128 v[116:119], v12 offset:4096
    v_mfma_f32_16x16x32_bf16 v[144:147], a[164:167], v[128:131], v[144:147]
    ds_read_b128 v[120:123], v12 offset:6144
    v_mfma_f32_16x16x32_bf16 v[148:151], a[84:87], v[124:127], v[148:151]
    v_mfma_f32_16x16x32_bf16 v[152:155], a[84:87], v[128:131], v[152:155]
    v_mfma_f32_16x16x32_bf16 v[156:159], a[4:7], v[124:127], v[156:159]
    v_mfma_f32_16x16x32_bf16 v[160:163], a[4:7], v[128:131], v[160:163]
    s_waitcnt lgkmcnt(2)
    v_mfma_f32_16x16x32_bf16 v[140:143], a[168:171], v[132:135], v[140:143]
    ds_read_b128 v[124:127], v11 offset:8192
    v_mfma_f32_16x16x32_bf16 v[144:147], a[168:171], v[136:139], v[144:147]
    ds_read_b128 v[128:131], v11 offset:10240
    v_mfma_f32_16x16x32_bf16 v[148:151], a[88:91], v[132:135], v[148:151]
    v_mfma_f32_16x16x32_bf16 v[152:155], a[88:91], v[136:139], v[152:155]
    v_mfma_f32_16x16x32_bf16 v[156:159], a[8:11], v[132:135], v[156:159]
    v_mfma_f32_16x16x32_bf16 v[160:163], a[8:11], v[136:139], v[160:163]
    s_waitcnt lgkmcnt(2)
    v_mfma_f32_16x16x32_bf16 v[140:143], a[172:175], v[116:119], v[140:143]
    ds_read_b128 v[132:135], v12 offset:8192
    v_mfma_f32_16x16x32_bf16 v[144:147], a[172:175], v[120:123], v[144:147]
    ds_read_b128 v[136:139], v12 offset:10240
    v_mfma_f32_16x16x32_bf16 v[148:151], a[92:95], v[116:119], v[148:151]
    v_mfma_f32_16x16x32_bf16 v[152:155], a[92:95], v[120:123], v[152:155]
    v_mfma_f32_16x16x32_bf16 v[156:159], a[12:15], v[116:119], v[156:159]
    v_mfma_f32_16x16x32_bf16 v[160:163], a[12:15], v[120:123], v[160:163]
    s_waitcnt lgkmcnt(2)
    v_mfma_f32_16x16x32_bf16 v[140:143], a[176:179], v[124:127], v[140:143]
    ds_read_b128 v[116:119], v11 offset:12288
    v_mfma_f32_16x16x32_bf16 v[144:147], a[176:179], v[128:131], v[144:147]
    ds_read_b128 v[120:123], v11 offset:14336
    v_mfma_f32_16x16x32_bf16 v[148:151], a[96:99], v[124:127], v[148:151]
    v_mfma_f32_16x16x32_bf16 v[152:155], a[96:99], v[128:131], v[152:155]
    v_mfma_f32_16x16x32_bf16 v[156:159], a[16:19], v[124:127], v[156:159]
    v_mfma_f32_16x16x32_bf16 v[160:163], a[16:19], v[128:131], v[160:163]
    s_waitcnt lgkmcnt(2)
    v_mfma_f32_16x16x32_bf16 v[140:143], a[180:183], v[132:135], v[140:143]
    ds_read_b128 v[124:127], v12 offset:12288
    v_mfma_f32_16x16x32_bf16 v[144:147], a[180:183], v[136:139], v[144:147]
    ds_read_b128 v[128:131], v12 offset:14336
    v_mfma_f32_16x16x32_bf16 v[148:151], a[100:103], v[132:135], v[148:151]
    v_mfma_f32_16x16x32_bf16 v[152:155], a[100:103], v[136:139], v[152:155]
    v_mfma_f32_16x16x32_bf16 v[156:159], a[20:23], v[132:135], v[156:159]
    v_mfma_f32_16x16x32_bf16 v[160:163], a[20:23], v[136:139], v[160:163]
    s_waitcnt lgkmcnt(2)
    v_mfma_f32_16x16x32_bf16 v[140:143], a[184:187], v[116:119], v[140:143]
    ds_read_b128 v[132:135], v11 offset:16384
    v_mfma_f32_16x16x32_bf16 v[144:147], a[184:187], v[120:123], v[144:147]
    ds_read_b128 v[136:139], v11 offset:18432
    v_mfma_f32_16x16x32_bf16 v[148:151], a[104:107], v[116:119], v[148:151]
    v_mfma_f32_16x16x32_bf16 v[152:155], a[104:107], v[120:123], v[152:155]
    v_mfma_f32_16x16x32_bf16 v[156:159], a[24:27], v[116:119], v[156:159]
    v_mfma_f32_16x16x32_bf16 v[160:163], a[24:27], v[120:123], v[160:163]
    s_waitcnt lgkmcnt(2)
    v_mfma_f32_16x16x32_bf16 v[140:143], a[188:191], v[124:127], v[140:143]
    ds_read_b128 v[116:119], v12 offset:16384
    v_mfma_f32_16x16x32_bf16 v[144:147], a[188:191], v[128:131], v[144:147]
    ds_read_b128 v[120:123], v12 offset:18432
    v_mfma_f32_16x16x32_bf16 v[148:151], a[108:111], v[124:127], v[148:151]
    v_mfma_f32_16x16x32_bf16 v[152:155], a[108:111], v[128:131], v[152:155]
    v_mfma_f32_16x16x32_bf16 v[156:159], a[28:31], v[124:127], v[156:159]
    v_mfma_f32_16x16x32_bf16 v[160:163], a[28:31], v[128:131], v[160:163]
    s_waitcnt lgkmcnt(2)
    v_mfma_f32_16x16x32_bf16 v[140:143], a[192:195], v[132:135], v[140:143]
    ds_read_b128 v[124:127], v11 offset:20480
    v_mfma_f32_16x16x32_bf16 v[144:147], a[192:195], v[136:139], v[144:147]
    ds_read_b128 v[128:131], v11 offset:22528
    v_mfma_f32_16x16x32_bf16 v[148:151], a[112:115], v[132:135], v[148:151]
    v_mfma_f32_16x16x32_bf16 v[152:155], a[112:115], v[136:139], v[152:155]
    v_mfma_f32_16x16x32_bf16 v[156:159], a[32:35], v[132:135], v[156:159]
    v_mfma_f32_16x16x32_bf16 v[160:163], a[32:35], v[136:139], v[160:163]
    s_waitcnt lgkmcnt(2)
    v_mfma_f32_16x16x32_bf16 v[140:143], a[196:199], v[116:119], v[140:143]
    ds_read_b128 v[132:135], v12 offset:20480
    v_mfma_f32_16x16x32_bf16 v[144:147], a[196:199], v[120:123], v[144:147]
    ds_read_b128 v[136:139], v12 offset:22528
    v_mfma_f32_16x16x32_bf16 v[148:151], a[116:119], v[116:119], v[148:151]
    v_mfma_f32_16x16x32_bf16 v[152:155], a[116:119], v[120:123], v[152:155]
    v_mfma_f32_16x16x32_bf16 v[156:159], a[36:39], v[116:119], v[156:159]
    v_mfma_f32_16x16x32_bf16 v[160:163], a[36:39], v[120:123], v[160:163]
    s_waitcnt lgkmcnt(2)
    v_mfma_f32_16x16x32_bf16 v[140:143], a[200:203], v[124:127], v[140:143]
    ds_read_b128 v[116:119], v11 offset:24576
    v_mfma_f32_16x16x32_bf16 v[144:147], a[200:203], v[128:131], v[144:147]
    ds_read_b128 v[120:123], v11 offset:26624
    v_mfma_f32_16x16x32_bf16 v[148:151], a[120:123], v[124:127], v[148:151]
    v_mfma_f32_16x16x32_bf16 v[152:155], a[120:123], v[128:131], v[152:155]
    v_mfma_f32_16x16x32_bf16 v[156:159], a[40:43], v[124:127], v[156:159]
    v_mfma_f32_16x16x32_bf16 v[160:163], a[40:43], v[128:131], v[160:163]
    s_waitcnt lgkmcnt(2)
    v_mfma_f32_16x16x32_bf16 v[140:143], a[204:207], v[132:135], v[140:143]
    ds_read_b128 v[124:127], v12 offset:24576
    v_mfma_f32_16x16x32_bf16 v[144:147], a[204:207], v[136:139], v[144:147]
    ds_read_b128 v[128:131], v12 offset:26624
    v_mfma_f32_16x16x32_bf16 v[148:151], a[124:127], v[132:135], v[148:151]
    v_mfma_f32_16x16x32_bf16 v[152:155], a[124:127], v[136:139], v[152:155]
    v_mfma_f32_16x16x32_bf16 v[156:159], a[44:47], v[132:135], v[156:159]
    v_mfma_f32_16x16x32_bf16 v[160:163], a[44:47], v[136:139], v[160:163]
    s_waitcnt lgkmcnt(2)
    v_mfma_f32_16x16x32_bf16 v[140:143], a[208:211], v[116:119], v[140:143]
    ds_read_b128 v[132:135], v11 offset:28672
    v_mfma_f32_16x16x32_bf16 v[144:147], a[208:211], v[120:123], v[144:147]
    ds_read_b128 v[136:139], v11 offset:30720
    v_mfma_f32_16x16x32_bf16 v[148:151], a[128:131], v[116:119], v[148:151]
    v_mfma_f32_16x16x32_bf16 v[152:155], a[128:131], v[120:123], v[152:155]
    v_mfma_f32_16x16x32_bf16 v[156:159], a[48:51], v[116:119], v[156:159]
    v_mfma_f32_16x16x32_bf16 v[160:163], a[48:51], v[120:123], v[160:163]
    s_waitcnt lgkmcnt(2)
    v_mfma_f32_16x16x32_bf16 v[140:143], a[212:215], v[124:127], v[140:143]
    ds_read_b128 v[116:119], v12 offset:28672
    v_mfma_f32_16x16x32_bf16 v[144:147], a[212:215], v[128:131], v[144:147]
    ds_read_b128 v[120:123], v12 offset:30720
    v_mfma_f32_16x16x32_bf16 v[148:151], a[132:135], v[124:127], v[148:151]
    v_mfma_f32_16x16x32_bf16 v[152:155], a[132:135], v[128:131], v[152:155]
    v_mfma_f32_16x16x32_bf16 v[156:159], a[52:55], v[124:127], v[156:159]
    v_mfma_f32_16x16x32_bf16 v[160:163], a[52:55], v[128:131], v[160:163]
    s_waitcnt lgkmcnt(2)
    v_mfma_f32_16x16x32_bf16 v[140:143], a[216:219], v[132:135], v[140:143]
    ds_read_b128 v[124:127], v11 offset:32768
    v_mfma_f32_16x16x32_bf16 v[144:147], a[216:219], v[136:139], v[144:147]
    ds_read_b128 v[128:131], v11 offset:34816
    v_mfma_f32_16x16x32_bf16 v[148:151], a[136:139], v[132:135], v[148:151]
    v_mfma_f32_16x16x32_bf16 v[152:155], a[136:139], v[136:139], v[152:155]
    v_mfma_f32_16x16x32_bf16 v[156:159], a[56:59], v[132:135], v[156:159]
    v_mfma_f32_16x16x32_bf16 v[160:163], a[56:59], v[136:139], v[160:163]
    s_waitcnt lgkmcnt(2)
    v_mfma_f32_16x16x32_bf16 v[140:143], a[220:223], v[116:119], v[140:143]
    ds_read_b128 v[132:135], v12 offset:32768
    v_mfma_f32_16x16x32_bf16 v[144:147], a[220:223], v[120:123], v[144:147]
    ds_read_b128 v[136:139], v12 offset:34816
    v_mfma_f32_16x16x32_bf16 v[148:151], a[140:143], v[116:119], v[148:151]
    v_mfma_f32_16x16x32_bf16 v[152:155], a[140:143], v[120:123], v[152:155]
    v_mfma_f32_16x16x32_bf16 v[156:159], a[60:63], v[116:119], v[156:159]
    v_mfma_f32_16x16x32_bf16 v[160:163], a[60:63], v[120:123], v[160:163]
    s_waitcnt lgkmcnt(2)
    v_mfma_f32_16x16x32_bf16 v[140:143], a[224:227], v[124:127], v[140:143]
    ds_read_b128 v[116:119], v11 offset:36864
    v_mfma_f32_16x16x32_bf16 v[144:147], a[224:227], v[128:131], v[144:147]
    ds_read_b128 v[120:123], v11 offset:38912
    v_mfma_f32_16x16x32_bf16 v[148:151], a[144:147], v[124:127], v[148:151]
    v_mfma_f32_16x16x32_bf16 v[152:155], a[144:147], v[128:131], v[152:155]
    v_mfma_f32_16x16x32_bf16 v[156:159], a[64:67], v[124:127], v[156:159]
    v_mfma_f32_16x16x32_bf16 v[160:163], a[64:67], v[128:131], v[160:163]
    s_waitcnt lgkmcnt(2)
    v_mfma_f32_16x16x32_bf16 v[140:143], a[228:231], v[132:135], v[140:143]
    ds_read_b128 v[124:127], v12 offset:36864
    v_mfma_f32_16x16x32_bf16 v[144:147], a[228:231], v[136:139], v[144:147]
    ds_read_b128 v[128:131], v12 offset:38912
    v_mfma_f32_16x16x32_bf16 v[148:151], a[148:151], v[132:135], v[148:151]
    v_mfma_f32_16x16x32_bf16 v[152:155], a[148:151], v[136:139], v[152:155]
    v_mfma_f32_16x16x32_bf16 v[156:159], a[68:71], v[132:135], v[156:159]
    v_mfma_f32_16x16x32_bf16 v[160:163], a[68:71], v[136:139], v[160:163]
    s_waitcnt lgkmcnt(0)
    v_mfma_f32_16x16x32_bf16 v[140:143], a[232:235], v[116:119], v[140:143]
    v_mfma_f32_16x16x32_bf16 v[144:147], a[232:235], v[120:123], v[144:147]
    v_mfma_f32_16x16x32_bf16 v[140:143], a[236:239], v[124:127], v[140:143]
    v_mfma_f32_16x16x32_bf16 v[144:147], a[236:239], v[128:131], v[144:147]
    v_mfma_f32_16x16x32_bf16 v[148:151], a[152:155], v[116:119], v[148:151]
    v_add_u32 v11, s49, v11
    v_add_u32 v12, s49, v12
    v_mfma_f32_16x16x32_bf16 v[152:155], a[152:155], v[120:123], v[152:155]
    s_sub_u32 s47, s47, s49
    s_sub_u32 s49, 0, s49
    v_mfma_f32_16x16x32_bf16 v[148:151], a[156:159], v[124:127], v[148:151]
    v_mfma_f32_16x16x32_bf16 v[152:155], a[156:159], v[128:131], v[152:155]
    v_mfma_f32_16x16x32_bf16 v[156:159], a[72:75], v[116:119], v[156:159]
    v_cvt_pk_bf16_f32 v164, v140, v141
    v_cvt_pk_bf16_f32 v165, v142, v143
    v_mfma_f32_16x16x32_bf16 v[160:163], a[72:75], v[120:123], v[160:163]
    v_cvt_pk_bf16_f32 v166, v144, v145
    v_cvt_pk_bf16_f32 v167, v146, v147
    v_mfma_f32_16x16x32_bf16 v[156:159], a[76:79], v[124:127], v[156:159]
    v_permlane16_swap_b32 v164, v166
    v_permlane16_swap_b32 v165, v167
    v_mfma_f32_16x16x32_bf16 v[160:163], a[76:79], v[128:131], v[160:163]
    v_cvt_pk_bf16_f32 v168, v148, v149
    v_cvt_pk_bf16_f32 v169, v150, v151
    v_cvt_pk_bf16_f32 v170, v152, v153
    v_cvt_pk_bf16_f32 v171, v154, v155
    s_nop 0
    v_permlane16_swap_b32 v168, v170
    v_permlane16_swap_b32 v169, v171
    ds_write_b128 v34, v[168:171]
    v_cvt_pk_bf16_f32 v172, v156, v157
    v_cvt_pk_bf16_f32 v173, v158, v159
    v_cvt_pk_bf16_f32 v174, v160, v161
    v_cvt_pk_bf16_f32 v175, v162, v163
    s_nop 0
    v_permlane16_swap_b32 v172, v174
    v_permlane16_swap_b32 v173, v175
    buffer_store_dwordx4 v[164:167], v29, s[4:7], s51 offen sc1
    buffer_store_dwordx4 v[168:171], v29, s[4:7], s50 offen sc1
    buffer_store_dwordx4 v[172:175], v29, s[4:7], s45 offen sc1
    v_mov_b32 v1, 196
L_gw_42:
    buffer_load_dword v2, v1, s[8:11], 0 offen sc1
    s_sub_u32 s36, s36, 1
    s_cbranch_scc1 L_exit
    s_waitcnt vmcnt(0)
    v_readfirstlane_b32 s90, v2
    s_nop 0
    s_cmp_eq_u32 s90, 0
    s_cbranch_scc1 L_gw_42
    v_mov_b32 v32, 1
    buffer_store_dword v32, v30, s[4:7], s38 offen sc1
    s_waitcnt lgkmcnt(0)
    s_barrier
    s_add_u32 s45, s38, 393216
    s_add_u32 s50, s45, 49152
    s_add_u32 s51, s45, 98304
    v_add_u32 v34, 4096, v27
    s_mov_b32 s46, 81920
    ds_read_b128 v[116:119], v11 offset:0
    ds_read_b128 v[120:123], v11 offset:2048
    ds_read_b128 v[124:127], v12 offset:0
    ds_read_b128 v[128:131], v12 offset:2048
    s_lshl_b32 s90, s32, 10
    s_add_u32 m0, s90, s47
    s_waitcnt lgkmcnt(2)
    v_mfma_f32_16x16x32_bf16 v[140:143], a[160:163], v[116:119], 0
    ds_read_b128 v[132:135], v11 offset:4096
    v_mfma_f32_16x16x32_bf16 v[144:147], a[160:163], v[120:123], 0
    ds_read_b128 v[136:139], v11 offset:6144
    v_mfma_f32_16x16x32_bf16 v[148:151], a[80:83], v[116:119], 0
    buffer_load_dwordx4 v10, s[24:27], s46 offen offset:0 lds
    s_add_u32 m0, m0, 3968
    v_mfma_f32_16x16x32_bf16 v[152:155], a[80:83], v[120:123], 0
    v_mfma_f32_16x16x32_bf16 v[156:159], a[0:3], v[116:119], 0
    buffer_load_dwordx4 v10, s[24:27], s46 offen offset:128 lds
    s_add_u32 m0, m0, 3968
    v_mfma_f32_16x16x32_bf16 v[160:163], a[0:3], v[120:123], 0
    s_waitcnt lgkmcnt(2)
    v_mfma_f32_16x16x32_bf16 v[140:143], a[164:167], v[124:127], v[140:143]
    ds_read_b128 v[116:119], v12 offset:4096
    v_mfma_f32_16x16x32_bf16 v[144:147], a[164:167], v[128:131], v[144:147]
    ds_read_b128 v[120:123], v12 offset:6144
    v_mfma_f32_16x16x32_bf16 v[148:151], a[84:87], v[124:127], v[148:151]
    buffer_load_dwordx4 v10, s[24:27], s46 offen offset:256 lds
    s_add_u32 m0, m0, 3968
    v_mfma_f32_16x16x32_bf16 v[152:155], a[84:87], v[128:131], v[152:155]
    v_mfma_f32_16x16x32_bf16 v[156:159], a[4:7], v[124:127], v[156:159]
    buffer_load_dwordx4 v10, s[24:27], s46 offen offset:384 lds
    s_add_u32 m0, m0, 3968
    v_mfma_f32_16x16x32_bf16 v[160:163], a[4:7], v[128:131], v[160:163]
    s_waitcnt lgkmcnt(2)
    v_mfma_f32_16x16x32_bf16 v[140:143], a[168:171], v[132:135], v[140:143]
    ds_read_b128 v[124:127], v11 offset:8192
    v_mfma_f32_16x16x32_bf16 v[144:147], a[168:171], v[136:139], v[144:147]
    ds_read_b128 v[128:131], v11 offset:10240
    v_mfma_f32_16x16x32_bf16 v[148:151], a[88:91], v[132:135], v[148:151]
    buffer_load_dwordx4 v10, s[24:27], s46 offen offset:512 lds
    s_add_u32 m0, m0, 3968
    v_mfma_f32_16x16x32_bf16 v[152:155], a[88:91], v[136:139], v[152:155]
    v_mfma_f32_16x16x32_bf16 v[156:159], a[8:11], v[132:135], v[156:159]
    buffer_load_dwordx4 v10, s[24:27], s46 offen offset:640 lds
    s_add_u32 m0, m0, 3968
    v_mfma_f32_16x16x32_bf16 v[160:163], a[8:11], v[136:139], v[160:163]
    s_waitcnt lgkmcnt(2)
    v_mfma_f32_16x16x32_bf16 v[140:143], a[172:175], v[116:119], v[140:143]
    ds_read_b128 v[132:135], v12 offset:8192
    v_mfma_f32_16x16x32_bf16 v[144:147], a[172:175], v[120:123], v[144:147]
    ds_read_b128 v[136:139], v12 offset:10240
    v_mfma_f32_16x16x32_bf16 v[148:151], a[92:95], v[116:119], v[148:151]
    buffer_load_dwordx4 v10, s[24:27], s46 offen offset:768 lds
    s_add_u32 m0, m0, 3968
    v_mfma_f32_16x16x32_bf16 v[152:155], a[92:95], v[120:123], v[152:155]
    v_mfma_f32_16x16x32_bf16 v[156:159], a[12:15], v[116:119], v[156:159]
    buffer_load_dwordx4 v10, s[24:27], s46 offen offset:896 lds
    s_add_u32 m0, m0, 3968
    v_mfma_f32_16x16x32_bf16 v[160:163], a[12:15], v[120:123], v[160:163]
    s_waitcnt lgkmcnt(2)
    v_mfma_f32_16x16x32_bf16 v[140:143], a[176:179], v[124:127], v[140:143]
    ds_read_b128 v[116:119], v11 offset:12288
    v_mfma_f32_16x16x32_bf16 v[144:147], a[176:179], v[128:131], v[144:147]
    ds_read_b128 v[120:123], v11 offset:14336
    v_mfma_f32_16x16x32_bf16 v[148:151], a[96:99], v[124:127], v[148:151]
    buffer_load_dwordx4 v10, s[24:27], s46 offen offset:1024 lds
    s_add_u32 m0, m0, 3968
    v_mfma_f32_16x16x32_bf16 v[152:155], a[96:99], v[128:131], v[152:155]
    v_mfma_f32_16x16x32_bf16 v[156:159], a[16:19], v[124:127], v[156:159]
    buffer_load_dwordx4 v10, s[24:27], s46 offen offset:1152 lds
    v_mfma_f32_16x16x32_bf16 v[160:163], a[16:19], v[128:131], v[160:163]
    s_waitcnt lgkmcnt(2)
    v_mfma_f32_16x16x32_bf16 v[140:143], a[180:183], v[132:135], v[140:143]
    ds_read_b128 v[124:127], v12 offset:12288
    v_mfma_f32_16x16x32_bf16 v[144:147], a[180:183], v[136:139], v[144:147]
    ds_read_b128 v[128:131], v12 offset:14336
    v_mfma_f32_16x16x32_bf16 v[148:151], a[100:103], v[132:135], v[148:151]
    v_mfma_f32_16x16x32_bf16 v[152:155], a[100:103], v[136:139], v[152:155]
    v_mfma_f32_16x16x32_bf16 v[156:159], a[20:23], v[132:135], v[156:159]
    v_mfma_f32_16x16x32_bf16 v[160:163], a[20:23], v[136:139], v[160:163]
    s_waitcnt lgkmcnt(2)
    v_mfma_f32_16x16x32_bf16 v[140:143], a[184:187], v[116:119], v[140:143]
    ds_read_b128 v[132:135], v11 offset:16384
    v_mfma_f32_16x16x32_bf16 v[144:147], a[184:187], v[120:123], v[144:147]
    ds_read_b128 v[136:139], v11 offset:18432
    v_mfma_f32_16x16x32_bf16 v[148:151], a[104:107], v[116:119], v[148:151]
    v_mfma_f32_16x16x32_bf16 v[152:155], a[104:107], v[120:123], v[152:155]
    v_mfma_f32_16x16x32_bf16 v[156:159], a[24:27], v[116:119], v[156:159]
    v_mfma_f32_16x16x32_bf16 v[160:163], a[24:27], v[120:123], v[160:163]
    s_waitcnt lgkmcnt(2)
    v_mfma_f32_16x16x32_bf16 v[140:143], a[188:191], v[124:127], v[140:143]
    ds_read_b128 v[116:119], v12 offset:16384
    v_mfma_f32_16x16x32_bf16 v[144:147], a[188:191], v[128:131], v[144:147]
    ds_read_b128 v[120:123], v12 offset:18432
    v_mfma_f32_16x16x32_bf16 v[148:151], a[108:111], v[124:127], v[148:151]
    v_mfma_f32_16x16x32_bf16 v[152:155], a[108:111], v[128:131], v[152:155]
    v_mfma_f32_16x16x32_bf16 v[156:159], a[28:31], v[124:127], v[156:159]
    v_mfma_f32_16x16x32_bf16 v[160:163], a[28:31], v[128:131], v[160:163]
    s_waitcnt lgkmcnt(2)
    v_mfma_f32_16x16x32_bf16 v[140:143], a[192:195], v[132:135], v[140:143]
    ds_read_b128 v[124:127], v11 offset:20480
    v_mfma_f32_16x16x32_bf16 v[144:147], a[192:195], v[136:139], v[144:147]
    ds_read_b128 v[128:131], v11 offset:22528
    v_mfma_f32_16x16x32_bf16 v[148:151], a[112:115], v[132:135], v[148:151]
    v_mfma_f32_16x16x32_bf16 v[152:155], a[112:115], v[136:139], v[152:155]
    v_mfma_f32_16x16x32_bf16 v[156:159], a[32:35], v[132:135], v[156:159]
    v_mfma_f32_16x16x32_bf16 v[160:163], a[32:35], v[136:139], v[160:163]
    s_waitcnt lgkmcnt(2)
    v_mfma_f32_16x16x32_bf16 v[140:143], a[196:199], v[116:119], v[140:143]
    ds_read_b128 v[132:135], v12 offset:20480
    v_mfma_f32_16x16x32_bf16 v[144:147], a[196:199], v[120:123], v[144:147]
    ds_read_b128 v[136:139], v12 offset:22528
    v_mfma_f32_16x16x32_bf16 v[148:151], a[116:119], v[116:119], v[148:151]
    v_mfma_f32_16x16x32_bf16 v[152:155], a[116:119], v[120:123], v[152:155]
    v_mfma_f32_16x16x32_bf16 v[156:159], a[36:39], v[116:119], v[156:159]
    v_mfma_f32_16x16x32_bf16 v[160:163], a[36:39], v[120:123], v[160:163]
    s_waitcnt lgkmcnt(2)
    v_mfma_f32_16x16x32_bf16 v[140:143], a[200:203], v[124:127], v[140:143]
    ds_read_b128 v[116:119], v11 offset:24576
    v_mfma_f32_16x16x32_bf16 v[144:147], a[200:203], v[128:131], v[144:147]
    ds_read_b128 v[120:123], v11 offset:26624
    v_mfma_f32_16x16x32_bf16 v[148:151], a[120:123], v[124:127], v[148:151]
    v_mfma_f32_16x16x32_bf16 v[152:155], a[120:123], v[128:131], v[152:155]
    v_mfma_f32_16x16x32_bf16 v[156:159], a[40:43], v[124:127], v[156:159]
    v_mfma_f32_16x16x32_bf16 v[160:163], a[40:43], v[128:131], v[160:163]
    s_waitcnt lgkmcnt(2)
    v_mfma_f32_16x16x32_bf16 v[140:143], a[204:207], v[132:135], v[140:143]
    ds_read_b128 v[124:127], v12 offset:24576
    v_mfma_f32_16x16x32_bf16 v[144:147], a[204:207], v[136:139], v[144:147]
    ds_read_b128 v[128:131], v12 offset:26624
    v_mfma_f32_16x16x32_bf16 v[148:151], a[124:127], v[132:135], v[148:151]
    v_mfma_f32_16x16x32_bf16 v[152:155], a[124:127], v[136:139], v[152:155]
    v_mfma_f32_16x16x32_bf16 v[156:159], a[44:47], v[132:135], v[156:159]
    v_mfma_f32_16x16x32_bf16 v[160:163], a[44:47], v[136:139], v[160:163]
    s_waitcnt lgkmcnt(2)
    v_mfma_f32_16x16x32_bf16 v[140:143], a[208:211], v[116:119], v[140:143]
    ds_read_b128 v[132:135], v11 offset:28672
    v_mfma_f32_16x16x32_bf16 v[144:147], a[208:211], v[120:123], v[144:147]
    ds_read_b128 v[136:139], v11 offset:30720
    v_mfma_f32_16x16x32_bf16 v[148:151], a[128:131], v[116:119], v[148:151]
    v_mfma_f32_16x16x32_bf16 v[152:155], a[128:131], v[120:123], v[152:155]
    v_mfma_f32_16x16x32_bf16 v[156:159], a[48:51], v[116:119], v[156:159]
    v_mfma_f32_16x16x32_bf16 v[160:163], a[48:51], v[120:123], v[160:163]
    s_waitcnt lgkmcnt(2)
    v_mfma_f32_16x16x32_bf16 v[140:143], a[212:215], v[124:127], v[140:143]
    ds_read_b128 v[116:119], v12 offset:28672
    v_mfma_f32_16x16x32_bf16 v[144:147], a[212:215], v[128:131], v[144:147]
    ds_read_b128 v[120:123], v12 offset:30720
    v_mfma_f32_16x16x32_bf16 v[148:151], a[132:135], v[124:127], v[148:151]
    v_mfma_f32_16x16x32_bf16 v[152:155], a[132:135], v[128:131], v[152:155]
    v_mfma_f32_16x16x32_bf16 v[156:159], a[52:55], v[124:127], v[156:159]
    v_mfma_f32_16x16x32_bf16 v[160:163], a[52:55], v[128:131], v[160:163]
    s_waitcnt lgkmcnt(2)
    v_mfma_f32_16x16x32_bf16 v[140:143], a[216:219], v[132:135], v[140:143]
    ds_read_b128 v[124:127], v11 offset:32768
    v_mfma_f32_16x16x32_bf16 v[144:147], a[216:219], v[136:139], v[144:147]
    ds_read_b128 v[128:131], v11 offset:34816
    v_mfma_f32_16x16x32_bf16 v[148:151], a[136:139], v[132:135], v[148:151]
    v_mfma_f32_16x16x32_bf16 v[152:155], a[136:139], v[136:139], v[152:155]
    v_mfma_f32_16x16x32_bf16 v[156:159], a[56:59], v[132:135], v[156:159]
    v_mfma_f32_16x16x32_bf16 v[160:163], a[56:59], v[136:139], v[160:163]
    s_waitcnt lgkmcnt(2)
    v_mfma_f32_16x16x32_bf16 v[140:143], a[220:223], v[116:119], v[140:143]
    ds_read_b128 v[132:135], v12 offset:32768
    v_mfma_f32_16x16x32_bf16 v[144:147], a[220:223], v[120:123], v[144:147]
    ds_read_b128 v[136:139], v12 offset:34816
    v_mfma_f32_16x16x32_bf16 v[148:151], a[140:143], v[116:119], v[148:151]
    v_mfma_f32_16x16x32_bf16 v[152:155], a[140:143], v[120:123], v[152:155]
    v_mfma_f32_16x16x32_bf16 v[156:159], a[60:63], v[116:119], v[156:159]
    v_mfma_f32_16x16x32_bf16 v[160:163], a[60:63], v[120:123], v[160:163]
    s_waitcnt lgkmcnt(2)
    v_mfma_f32_16x16x32_bf16 v[140:143], a[224:227], v[124:127], v[140:143]
    ds_read_b128 v[116:119], v11 offset:36864
    v_mfma_f32_16x16x32_bf16 v[144:147], a[224:227], v[128:131], v[144:147]
    ds_read_b128 v[120:123], v11 offset:38912
    v_mfma_f32_16x16x32_bf16 v[148:151], a[144:147], v[124:127], v[148:151]
    v_mfma_f32_16x16x32_bf16 v[152:155], a[144:147], v[128:131], v[152:155]
    v_mfma_f32_16x16x32_bf16 v[156:159], a[64:67], v[124:127], v[156:159]
    v_mfma_f32_16x16x32_bf16 v[160:163], a[64:67], v[128:131], v[160:163]
    s_waitcnt lgkmcnt(2)
    v_mfma_f32_16x16x32_bf16 v[140:143], a[228:231], v[132:135], v[140:143]
    ds_read_b128 v[124:127], v12 offset:36864
    v_mfma_f32_16x16x32_bf16 v[144:147], a[228:231], v[136:139], v[144:147]
    ds_read_b128 v[128:131], v12 offset:38912
    v_mfma_f32_16x16x32_bf16 v[148:151], a[148:151], v[132:135], v[148:151]
    v_mfma_f32_16x16x32_bf16 v[152:155], a[148:151], v[136:139], v[152:155]
    v_mfma_f32_16x16x32_bf16 v[156:159], a[68:71], v[132:135], v[156:159]
    v_mfma_f32_16x16x32_bf16 v[160:163], a[68:71], v[136:139], v[160:163]
    s_waitcnt lgkmcnt(0)
    v_mfma_f32_16x16x32_bf16 v[140:143], a[232:235], v[116:119], v[140:143]
    v_mfma_f32_16x16x32_bf16 v[144:147], a[232:235], v[120:123], v[144:147]
    v_mfma_f32_16x16x32_bf16 v[140:143], a[236:239], v[124:127], v[140:143]
    v_mfma_f32_16x16x32_bf16 v[144:147], a[236:239], v[128:131], v[144:147]
    v_mfma_f32_16x16x32_bf16 v[148:151], a[152:155], v[116:119], v[148:151]
    v_add_u32 v11, s49, v11
    v_add_u32 v12, s49, v12
    v_mfma_f32_16x16x32_bf16 v[152:155], a[152:155], v[120:123], v[152:155]
    s_sub_u32 s47, s47, s49
    s_sub_u32 s49, 0, s49
    v_mfma_f32_16x16x32_bf16 v[148:151], a[156:159], v[124:127], v[148:151]
    v_mfma_f32_16x16x32_bf16 v[152:155], a[156:159], v[128:131], v[152:155]
    v_mfma_f32_16x16x32_bf16 v[156:159], a[72:75], v[116:119], v[156:159]
    v_cvt_pk_bf16_f32 v164, v140, v141
    v_cvt_pk_bf16_f32 v165, v142, v143
    v_mfma_f32_16x16x32_bf16 v[160:163], a[72:75], v[120:123], v[160:163]
    v_cvt_pk_bf16_f32 v166, v144, v145
    v_cvt_pk_bf16_f32 v167, v146, v147
    v_mfma_f32_16x16x32_bf16 v[156:159], a[76:79], v[124:127], v[156:159]
    v_permlane16_swap_b32 v164, v166
    v_permlane16_swap_b32 v165, v167
    v_mfma_f32_16x16x32_bf16 v[160:163], a[76:79], v[128:131], v[160:163]
    v_cvt_pk_bf16_f32 v168, v148, v149
    v_cvt_pk_bf16_f32 v169, v150, v151
    v_cvt_pk_bf16_f32 v170, v152, v153
    v_cvt_pk_bf16_f32 v171, v154, v155
    s_nop 0
    v_permlane16_swap_b32 v168, v170
    v_permlane16_swap_b32 v169, v171
    ds_write_b128 v34, v[168:171]
    v_cvt_pk_bf16_f32 v172, v156, v157
    v_cvt_pk_bf16_f32 v173, v158, v159
    v_cvt_pk_bf16_f32 v174, v160, v161
    v_cvt_pk_bf16_f32 v175, v162, v163
    s_nop 0
    v_permlane16_swap_b32 v172, v174
    v_permlane16_swap_b32 v173, v175
    buffer_store_dwordx4 v[164:167], v29, s[4:7], s51 offen sc1
    buffer_store_dwordx4 v[168:171], v29, s[4:7], s50 offen sc1
    buffer_store_dwordx4 v[172:175], v29, s[4:7], s45 offen sc1
    v_mov_b32 v3, 165376
L_pf_43:
    buffer_load_dword v4, v3, s[4:7], s38 offen sc1
    s_sub_u32 s36, s36, 1
    s_cbranch_scc1 L_exit
    s_waitcnt vmcnt(0) lgkmcnt(0)
    v_readfirstlane_b32 s90, v4
    s_nop 0
    s_cmp_eq_u32 s90, 0
    s_cbranch_scc1 L_pf_43
    v_mov_b32 v32, 2
    buffer_store_dword v32, v30, s[4:7], s38 offen sc1
    s_barrier
    s_and_b32 s90, s90, 2
    s_lshl_b32 s90, s90, 12
    v_mov_b32 v3, s90
    v_add_u32 v6, 16384, v3
    v_mov_b32 v4, 32768
    v_lshrrev_b32 v2, 4, v0
    v_cmp_eq_u32 vcc, s34, v2
    s_nop 1
    v_cndmask_b32 v5, v6, v4, vcc
    v_add_u32 v223, v5, v214
    v_cndmask_b32 v5, v3, v4, vcc
    v_add_u32 v214, v5, v214
    v_add_u32 v2, 4, v2
    v_cmp_eq_u32 vcc, s34, v2
    s_nop 1
    v_cndmask_b32 v5, v6, v4, vcc
    v_add_u32 v224, v5, v215
    v_cndmask_b32 v5, v3, v4, vcc
    v_add_u32 v215, v5, v215
    s_mov_b32 s37, -1
    s_add_u32 s42, s38, 122880
    s_add_u32 s45, s38, 565248
    s_add_u32 s50, s45, 49152
    s_add_u32 s51, s45, 98304
    v_add_u32 v34, 8192, v27
    s_mov_b32 s46, 122880
    ds_read_b128 v[116:119], v11 offset:0
    ds_read_b128 v[120:123], v11 offset:2048
    ds_read_b128 v[124:127], v12 offset:0
    ds_read_b128 v[128:131], v12 offset:2048
    s_lshl_b32 s90, s32, 10
    s_add_u32 m0, s90, s47
    s_waitcnt lgkmcnt(2)
    v_mfma_f32_16x16x32_bf16 v[140:143], a[160:163], v[116:119], 0
    ds_read_b128 v[132:135], v11 offset:4096
    v_mfma_f32_16x16x32_bf16 v[144:147], a[160:163], v[120:123], 0
    ds_read_b128 v[136:139], v11 offset:6144
    v_mfma_f32_16x16x32_bf16 v[148:151], a[80:83], v[116:119], 0
    buffer_load_dwordx4 v10, s[24:27], s46 offen offset:0 lds
    s_add_u32 m0, m0, 3968
    v_mfma_f32_16x16x32_bf16 v[152:155], a[80:83], v[120:123], 0
    v_mfma_f32_16x16x32_bf16 v[156:159], a[0:3], v[116:119], 0
    buffer_load_dwordx4 v10, s[24:27], s46 offen offset:128 lds
    s_add_u32 m0, m0, 3968
    v_mfma_f32_16x16x32_bf16 v[160:163], a[0:3], v[120:123], 0
    s_waitcnt lgkmcnt(2)
    v_mfma_f32_16x16x32_bf16 v[140:143], a[164:167], v[124:127], v[140:143]
    ds_read_b128 v[116:119], v12 offset:4096
    v_mfma_f32_16x16x32_bf16 v[144:147], a[164:167], v[128:131], v[144:147]
    ds_read_b128 v[120:123], v12 offset:6144
    v_mfma_f32_16x16x32_bf16 v[148:151], a[84:87], v[124:127], v[148:151]
    buffer_load_dwordx4 v10, s[24:27], s46 offen offset:256 lds
    s_add_u32 m0, m0, 3968
    v_mfma_f32_16x16x32_bf16 v[152:155], a[84:87], v[128:131], v[152:155]
    v_mfma_f32_16x16x32_bf16 v[156:159], a[4:7], v[124:127], v[156:159]
    buffer_load_dwordx4 v10, s[24:27], s46 offen offset:384 lds
    s_add_u32 m0, m0, 3968
    v_mfma_f32_16x16x32_bf16 v[160:163], a[4:7], v[128:131], v[160:163]
    s_waitcnt lgkmcnt(2)
    v_mfma_f32_16x16x32_bf16 v[140:143], a[168:171], v[132:135], v[140:143]
    ds_read_b128 v[124:127], v11 offset:8192
    v_mfma_f32_16x16x32_bf16 v[144:147], a[168:171], v[136:139], v[144:147]
    ds_read_b128 v[128:131], v11 offset:10240
    v_mfma_f32_16x16x32_bf16 v[148:151], a[88:91], v[132:135], v[148:151]
    buffer_load_dwordx4 v10, s[24:27], s46 offen offset:512 lds
    s_add_u32 m0, m0, 3968
    v_mfma_f32_16x16x32_bf16 v[152:155], a[88:91], v[136:139], v[152:155]
    v_mfma_f32_16x16x32_bf16 v[156:159], a[8:11], v[132:135], v[156:159]
    buffer_load_dwordx4 v10, s[24:27], s46 offen offset:640 lds
    s_add_u32 m0, m0, 3968
    v_mfma_f32_16x16x32_bf16 v[160:163], a[8:11], v[136:139], v[160:163]
    s_waitcnt lgkmcnt(2)
    v_mfma_f32_16x16x32_bf16 v[140:143], a[172:175], v[116:119], v[140:143]
    ds_read_b128 v[132:135], v12 offset:8192
    v_mfma_f32_16x16x32_bf16 v[144:147], a[172:175], v[120:123], v[144:147]
    ds_read_b128 v[136:139], v12 offset:10240
    v_mfma_f32_16x16x32_bf16 v[148:151], a[92:95], v[116:119], v[148:151]
    buffer_load_dwordx4 v10, s[24:27], s46 offen offset:768 lds
    s_add_u32 m0, m0, 3968
    v_mfma_f32_16x16x32_bf16 v[152:155], a[92:95], v[120:123], v[152:155]
    v_mfma_f32_16x16x32_bf16 v[156:159], a[12:15], v[116:119], v[156:159]
    buffer_load_dwordx4 v10, s[24:27], s46 offen offset:896 lds
    s_add_u32 m0, m0, 3968
    v_mfma_f32_16x16x32_bf16 v[160:163], a[12:15], v[120:123], v[160:163]
    s_waitcnt lgkmcnt(2)
    v_mfma_f32_16x16x32_bf16 v[140:143], a[176:179], v[124:127], v[140:143]
    ds_read_b128 v[116:119], v11 offset:12288
    v_mfma_f32_16x16x32_bf16 v[144:147], a[176:179], v[128:131], v[144:147]
    ds_read_b128 v[120:123], v11 offset:14336
    v_mfma_f32_16x16x32_bf16 v[148:151], a[96:99], v[124:127], v[148:151]
    buffer_load_dwordx4 v10, s[24:27], s46 offen offset:1024 lds
    s_add_u32 m0, m0, 3968
    v_mfma_f32_16x16x32_bf16 v[152:155], a[96:99], v[128:131], v[152:155]
    v_mfma_f32_16x16x32_bf16 v[156:159], a[16:19], v[124:127], v[156:159]
    buffer_load_dwordx4 v10, s[24:27], s46 offen offset:1152 lds
    v_mfma_f32_16x16x32_bf16 v[160:163], a[16:19], v[128:131], v[160:163]
    s_waitcnt lgkmcnt(2)
    v_mfma_f32_16x16x32_bf16 v[140:143], a[180:183], v[132:135], v[140:143]
    ds_read_b128 v[124:127], v12 offset:12288
    v_mfma_f32_16x16x32_bf16 v[144:147], a[180:183], v[136:139], v[144:147]
    ds_read_b128 v[128:131], v12 offset:14336
    v_mfma_f32_16x16x32_bf16 v[148:151], a[100:103], v[132:135], v[148:151]
    v_mfma_f32_16x16x32_bf16 v[152:155], a[100:103], v[136:139], v[152:155]
    v_mfma_f32_16x16x32_bf16 v[156:159], a[20:23], v[132:135], v[156:159]
    v_mfma_f32_16x16x32_bf16 v[160:163], a[20:23], v[136:139], v[160:163]
    s_waitcnt lgkmcnt(2)
    v_mfma_f32_16x16x32_bf16 v[140:143], a[184:187], v[116:119], v[140:143]
    ds_read_b128 v[132:135], v11 offset:16384
    s_and_b32 s52, s37, 3
    v_mfma_f32_16x16x32_bf16 v[144:147], a[184:187], v[120:123], v[144:147]
    ds_read_b128 v[136:139], v11 offset:18432
    s_mul_i32 s55, s52, 491520
    v_mfma_f32_16x16x32_bf16 v[148:151], a[104:107], v[116:119], v[148:151]
    s_add_u32 s37, s37, 1
    s_mov_b32 s43, s42
    v_mfma_f32_16x16x32_bf16 v[152:155], a[104:107], v[120:123], v[152:155]
    s_mov_b32 s54, 0
    s_and_b32 s52, s37, 3
    v_mfma_f32_16x16x32_bf16 v[156:159], a[24:27], v[116:119], v[156:159]
    s_mul_i32 s53, s52, 40960
    s_add_u32 s42, s38, s53
    v_mfma_f32_16x16x32_bf16 v[160:163], a[24:27], v[120:123], v[160:163]
    s_waitcnt lgkmcnt(2)
    s_lshl_b32 s52, s52, 12
    v_mfma_f32_16x16x32_bf16 v[140:143], a[188:191], v[124:127], v[140:143]
    ds_read_b128 v[116:119], v12 offset:16384
    v_add_u32 v35, s52, v28
    v_mfma_f32_16x16x32_bf16 v[144:147], a[188:191], v[128:131], v[144:147]
    ds_read_b128 v[120:123], v12 offset:18432
    s_xor_b32 s52, s52, 8192
    v_mfma_f32_16x16x32_bf16 v[148:151], a[108:111], v[124:127], v[148:151]
    v_add_u32 v34, s52, v27
    s_and_b32 s53, s37, 7
    v_mfma_f32_16x16x32_bf16 v[152:155], a[108:111], v[128:131], v[152:155]
    s_mul_i32 s53, s53, 172032
    s_add_u32 s53, s53, 196608
    v_mfma_f32_16x16x32_bf16 v[156:159], a[28:31], v[124:127], v[156:159]
    s_add_u32 s44, s38, s53
    s_add_u32 s53, s37, 2
    v_mfma_f32_16x16x32_bf16 v[160:163], a[28:31], v[128:131], v[160:163]
    s_waitcnt lgkmcnt(2)
    s_and_b32 s53, s53, 7
    v_mfma_f32_16x16x32_bf16 v[140:143], a[192:195], v[132:135], v[140:143]
    ds_read_b128 v[124:127], v11 offset:20480
    s_mul_i32 s53, s53, 172032
    v_mfma_f32_16x16x32_bf16 v[144:147], a[192:195], v[136:139], v[144:147]
    ds_read_b128 v[128:131], v11 offset:22528
    s_add_u32 s53, s53, 221184
    v_mfma_f32_16x16x32_bf16 v[148:151], a[112:115], v[132:135], v[148:151]
    s_add_u32 s45, s38, s53
    s_add_u32 s50, s45, 49152
    v_mfma_f32_16x16x32_bf16 v[152:155], a[112:115], v[136:139], v[152:155]
    s_add_u32 s51, s45, 98304
    v_add_u32 v32, s37, v220
    v_mfma_f32_16x16x32_bf16 v[156:159], a[32:35], v[132:135], v[156:159]
    v_mov_b32 v80, 0
    v_mov_b32 v81, 0
    v_mfma_f32_16x16x32_bf16 v[160:163], a[32:35], v[136:139], v[160:163]
    s_waitcnt lgkmcnt(2)
    v_mov_b32 v82, 0
    v_mfma_f32_16x16x32_bf16 v[140:143], a[196:199], v[116:119], v[140:143]
    ds_read_b128 v[132:135], v12 offset:20480
    v_mov_b32 v83, 0
    v_mfma_f32_16x16x32_bf16 v[144:147], a[196:199], v[120:123], v[144:147]
    ds_read_b128 v[136:139], v12 offset:22528
    v_mov_b32 v84, 0
    v_mfma_f32_16x16x32_bf16 v[148:151], a[116:119], v[116:119], v[148:151]
    v_mov_b32 v85, 0
    v_mov_b32 v86, 0
    v_mfma_f32_16x16x32_bf16 v[152:155], a[116:119], v[120:123], v[152:155]
    v_mov_b32 v87, 0
    v_mov_b32 v88, 0
    v_mfma_f32_16x16x32_bf16 v[156:159], a[36:39], v[116:119], v[156:159]
    v_mov_b32 v89, 0
    v_mov_b32 v90, 0
    v_mfma_f32_16x16x32_bf16 v[160:163], a[36:39], v[120:123], v[160:163]
    s_waitcnt lgkmcnt(2)
    v_mov_b32 v91, 0
    v_mfma_f32_16x16x32_bf16 v[140:143], a[200:203], v[124:127], v[140:143]
    ds_read_b128 v[116:119], v11 offset:24576
    v_mfma_f32_16x16x32_bf16 v[144:147], a[200:203], v[128:131], v[144:147]
    ds_read_b128 v[120:123], v11 offset:26624
    v_mfma_f32_16x16x32_bf16 v[148:151], a[120:123], v[124:127], v[148:151]
    v_mfma_f32_16x16x32_bf16 v[152:155], a[120:123], v[128:131], v[152:155]
    v_mfma_f32_16x16x32_bf16 v[156:159], a[40:43], v[124:127], v[156:159]
    v_mfma_f32_16x16x32_bf16 v[160:163], a[40:43], v[128:131], v[160:163]
    s_waitcnt lgkmcnt(2)
    v_mfma_f32_16x16x32_bf16 v[140:143], a[204:207], v[132:135], v[140:143]
    ds_read_b128 v[124:127], v12 offset:24576
    v_mfma_f32_16x16x32_bf16 v[144:147], a[204:207], v[136:139], v[144:147]
    ds_read_b128 v[128:131], v12 offset:26624
    v_mfma_f32_16x16x32_bf16 v[148:151], a[124:127], v[132:135], v[148:151]
    v_mfma_f32_16x16x32_bf16 v[152:155], a[124:127], v[136:139], v[152:155]
    v_mfma_f32_16x16x32_bf16 v[156:159], a[44:47], v[132:135], v[156:159]
    v_mfma_f32_16x16x32_bf16 v[160:163], a[44:47], v[136:139], v[160:163]
    s_waitcnt lgkmcnt(2)
    v_mfma_f32_16x16x32_bf16 v[140:143], a[208:211], v[116:119], v[140:143]
    ds_read_b128 v[132:135], v11 offset:28672
    v_mfma_f32_16x16x32_bf16 v[144:147], a[208:211], v[120:123], v[144:147]
    ds_read_b128 v[136:139], v11 offset:30720
    v_mfma_f32_16x16x32_bf16 v[148:151], a[128:131], v[116:119], v[148:151]
    v_mfma_f32_16x16x32_bf16 v[152:155], a[128:131], v[120:123], v[152:155]
    v_mfma_f32_16x16x32_bf16 v[156:159], a[48:51], v[116:119], v[156:159]
    v_mfma_f32_16x16x32_bf16 v[160:163], a[48:51], v[120:123], v[160:163]
    s_waitcnt lgkmcnt(2)
    v_mfma_f32_16x16x32_bf16 v[140:143], a[212:215], v[124:127], v[140:143]
    ds_read_b128 v[116:119], v12 offset:28672
    v_mfma_f32_16x16x32_bf16 v[144:147], a[212:215], v[128:131], v[144:147]
    ds_read_b128 v[120:123], v12 offset:30720
    v_mfma_f32_16x16x32_bf16 v[148:151], a[132:135], v[124:127], v[148:151]
    v_mfma_f32_16x16x32_bf16 v[152:155], a[132:135], v[128:131], v[152:155]
    v_mfma_f32_16x16x32_bf16 v[156:159], a[52:55], v[124:127], v[156:159]
    v_mfma_f32_16x16x32_bf16 v[160:163], a[52:55], v[128:131], v[160:163]
    s_waitcnt lgkmcnt(2)
    v_mfma_f32_16x16x32_bf16 v[140:143], a[216:219], v[132:135], v[140:143]
    ds_read_b128 v[124:127], v11 offset:32768
    v_mfma_f32_16x16x32_bf16 v[144:147], a[216:219], v[136:139], v[144:147]
    ds_read_b128 v[128:131], v11 offset:34816
    v_mfma_f32_16x16x32_bf16 v[148:151], a[136:139], v[132:135], v[148:151]
    v_mfma_f32_16x16x32_bf16 v[152:155], a[136:139], v[136:139], v[152:155]
    v_mfma_f32_16x16x32_bf16 v[156:159], a[56:59], v[132:135], v[156:159]
    v_mfma_f32_16x16x32_bf16 v[160:163], a[56:59], v[136:139], v[160:163]
    s_waitcnt lgkmcnt(2)
    v_mfma_f32_16x16x32_bf16 v[140:143], a[220:223], v[116:119], v[140:143]
    ds_read_b128 v[132:135], v12 offset:32768
    v_mfma_f32_16x16x32_bf16 v[144:147], a[220:223], v[120:123], v[144:147]
    ds_read_b128 v[136:139], v12 offset:34816
    v_mfma_f32_16x16x32_bf16 v[148:151], a[140:143], v[116:119], v[148:151]
    v_mfma_f32_16x16x32_bf16 v[152:155], a[140:143], v[120:123], v[152:155]
    v_mfma_f32_16x16x32_bf16 v[156:159], a[60:63], v[116:119], v[156:159]
    v_mfma_f32_16x16x32_bf16 v[160:163], a[60:63], v[120:123], v[160:163]
    s_waitcnt lgkmcnt(2)
    v_mfma_f32_16x16x32_bf16 v[140:143], a[224:227], v[124:127], v[140:143]
    ds_read_b128 v[116:119], v11 offset:36864
    v_mfma_f32_16x16x32_bf16 v[144:147], a[224:227], v[128:131], v[144:147]
    ds_read_b128 v[120:123], v11 offset:38912
    v_mfma_f32_16x16x32_bf16 v[148:151], a[144:147], v[124:127], v[148:151]
    v_mfma_f32_16x16x32_bf16 v[152:155], a[144:147], v[128:131], v[152:155]
    v_mfma_f32_16x16x32_bf16 v[156:159], a[64:67], v[124:127], v[156:159]
    v_mfma_f32_16x16x32_bf16 v[160:163], a[64:67], v[128:131], v[160:163]
    s_waitcnt lgkmcnt(2)
    v_mfma_f32_16x16x32_bf16 v[140:143], a[228:231], v[132:135], v[140:143]
    ds_read_b128 v[124:127], v12 offset:36864
    v_mfma_f32_16x16x32_bf16 v[144:147], a[228:231], v[136:139], v[144:147]
    ds_read_b128 v[128:131], v12 offset:38912
    v_mfma_f32_16x16x32_bf16 v[148:151], a[148:151], v[132:135], v[148:151]
    v_mfma_f32_16x16x32_bf16 v[152:155], a[148:151], v[136:139], v[152:155]
    v_mfma_f32_16x16x32_bf16 v[156:159], a[68:71], v[132:135], v[156:159]
    v_mfma_f32_16x16x32_bf16 v[160:163], a[68:71], v[136:139], v[160:163]
    s_waitcnt lgkmcnt(0)
    v_mfma_f32_16x16x32_bf16 v[140:143], a[232:235], v[116:119], v[140:143]
    v_mfma_f32_16x16x32_bf16 v[144:147], a[232:235], v[120:123], v[144:147]
    v_mfma_f32_16x16x32_bf16 v[140:143], a[236:239], v[124:127], v[140:143]
    v_mfma_f32_16x16x32_bf16 v[144:147], a[236:239], v[128:131], v[144:147]
    v_mfma_f32_16x16x32_bf16 v[148:151], a[152:155], v[116:119], v[148:151]
    v_add_u32 v11, s49, v11
    v_add_u32 v12, s49, v12
    v_mfma_f32_16x16x32_bf16 v[152:155], a[152:155], v[120:123], v[152:155]
    s_sub_u32 s47, s47, s49
    s_sub_u32 s49, 0, s49
    v_mfma_f32_16x16x32_bf16 v[148:151], a[156:159], v[124:127], v[148:151]
    v_mfma_f32_16x16x32_bf16 v[152:155], a[156:159], v[128:131], v[152:155]
    v_mfma_f32_16x16x32_bf16 v[156:159], a[72:75], v[116:119], v[156:159]
    v_cvt_pk_bf16_f32 v164, v140, v141
    v_cvt_pk_bf16_f32 v165, v142, v143
    v_mfma_f32_16x16x32_bf16 v[160:163], a[72:75], v[120:123], v[160:163]
    v_cvt_pk_bf16_f32 v166, v144, v145
    v_cvt_pk_bf16_f32 v167, v146, v147
    v_mfma_f32_16x16x32_bf16 v[156:159], a[76:79], v[124:127], v[156:159]
    v_permlane16_swap_b32 v164, v166
    v_permlane16_swap_b32 v165, v167
    v_mfma_f32_16x16x32_bf16 v[160:163], a[76:79], v[128:131], v[160:163]
    v_cvt_pk_bf16_f32 v168, v148, v149
    v_cvt_pk_bf16_f32 v169, v150, v151
    v_cvt_pk_bf16_f32 v170, v152, v153
    v_cvt_pk_bf16_f32 v171, v154, v155
    s_nop 0
    v_permlane16_swap_b32 v168, v170
    v_permlane16_swap_b32 v169, v171
    ds_write_b128 v34, v[168:171]
    v_cvt_pk_bf16_f32 v172, v156, v157
    v_cvt_pk_bf16_f32 v173, v158, v159
    v_cvt_pk_bf16_f32 v174, v160, v161
    v_cvt_pk_bf16_f32 v175, v162, v163
    s_nop 0
    v_permlane16_swap_b32 v172, v174
    v_permlane16_swap_b32 v173, v175
L_qkv_loop_s:
    s_mov_b32 m0, s48
    s_nop 0
    buffer_load_dwordx4 v13, s[4:7], s42 offen sc1 lds
    buffer_load_dwordx4 v13, s[4:7], s42 offen offset:1024 sc1 lds
    buffer_load_dword v14, s[4:7], s42 offen offset:2048 sc1 lds
    buffer_load_dword v14, s[4:7], s42 offen offset:2304 sc1 lds
    ds_read_b128 v[100:103], v35
    ds_read_b128 v[104:107], v35 offset:1024
    s_add_u32 s90, s37, 4
    s_min_u32 s90, s90, 63
    s_mul_i32 s46, s90, 40960
L_poll_45:
    buffer_load_dwordx4 v13, s[4:7], s42 offen sc1 lds
    buffer_load_dwordx4 v13, s[4:7], s42 offen offset:1024 sc1 lds
    buffer_load_dword v14, s[4:7], s42 offen offset:2048 sc1 lds
    buffer_load_dword v14, s[4:7], s42 offen offset:2304 sc1 lds
    s_sub_u32 s36, s36, 1
    s_cbranch_scc1 L_exit
    s_waitcnt vmcnt(4)
    ds_read_b32 v33, v15
    s_waitcnt lgkmcnt(0)
    v_cmp_eq_u32 vcc, -1, v33
    s_cbranch_vccnz L_poll_45
    s_barrier
    ds_read_b128 v[40:43], v16 offset:0
    ds_read_b128 v[44:47], v16 offset:1024
    ds_read_b128 v[48:51], v16 offset:2048
    ds_read_b128 v[52:55], v16 offset:3072
    ds_read_b128 v[56:59], v16 offset:4096
    ds_read_b128 v[60:63], v16 offset:5120
    ds_read_b128 v[64:67], v16 offset:6144
    ds_read_b128 v[68:71], v16 offset:7168
    ds_read_b128 v[72:75], v16 offset:8192
    ds_read_b128 v[76:79], v16 offset:9216
L_got_44r:
    s_waitcnt lgkmcnt(9)
    v_smfmac_f32_16x16x64_bf16 v[80:83], v[40:43], a[160:167], v18
    s_waitcnt lgkmcnt(8)
    v_smfmac_f32_16x16x64_bf16 v[80:83], v[44:47], a[168:175], v18
    s_waitcnt lgkmcnt(7)
    v_smfmac_f32_16x16x64_bf16 v[80:83], v[48:51], a[176:183], v18
    s_waitcnt lgkmcnt(6)
    v_smfmac_f32_16x16x64_bf16 v[80:83], v[52:55], a[184:191], v18
    s_waitcnt lgkmcnt(5)
    v_smfmac_f32_16x16x64_bf16 v[80:83], v[56:59], a[192:199], v18
    s_waitcnt lgkmcnt(4)
    v_smfmac_f32_16x16x64_bf16 v[80:83], v[60:63], a[200:207], v18
    s_waitcnt lgkmcnt(3)
    v_smfmac_f32_16x16x64_bf16 v[80:83], v[64:67], a[208:215], v18
    s_waitcnt lgkmcnt(2)
    v_smfmac_f32_16x16x64_bf16 v[80:83], v[68:71], a[216:223], v18
    s_waitcnt lgkmcnt(1)
    v_smfmac_f32_16x16x64_bf16 v[80:83], v[72:75], a[224:231], v18
    s_waitcnt lgkmcnt(0)
    v_smfmac_f32_16x16x64_bf16 v[80:83], v[76:79], a[232:239], v18
    v_smfmac_f32_16x16x64_bf16 v[84:87], v[40:43], a[0:7], v18
    v_smfmac_f32_16x16x64_bf16 v[88:91], v[40:43], a[80:87], v18
    v_smfmac_f32_16x16x64_bf16 v[84:87], v[44:47], a[8:15], v18
    v_pk_add_f32 v[80:81], v[80:81], v[82:83]
    v_cvt_pk_bf16_f32 v112, v80, v81
    v_smfmac_f32_16x16x64_bf16 v[88:91], v[44:47], a[88:95], v18
    ds_write_b32 v19, v112
    v_cmp_u_f32 vcc, v80, v81
    v_smfmac_f32_16x16x64_bf16 v[84:87], v[48:51], a[16:23], v18
    ds_read_b64_tr_b16 v[112:113], v20
    ds_read_b64_tr_b16 v[114:115], v20 offset:128
    v_smfmac_f32_16x16x64_bf16 v[88:91], v[48:51], a[96:103], v18
    v_smfmac_f32_16x16x64_bf16 v[84:87], v[52:55], a[24:31], v18
    s_cbranch_vccnz L_nan_46
L_cont_47:
    v_smfmac_f32_16x16x64_bf16 v[88:91], v[52:55], a[104:111], v18
    v_smfmac_f32_16x16x64_bf16 v[84:87], v[56:59], a[32:39], v18
    v_smfmac_f32_16x16x64_bf16 v[88:91], v[56:59], a[112:119], v18
    s_waitcnt lgkmcnt(0)
    buffer_store_dwordx4 v[112:115], v21, s[4:7], s42 offen sc1
    v_smfmac_f32_16x16x64_bf16 v[84:87], v[60:63], a[40:47], v18
    v_smfmac_f32_16x16x64_bf16 v[88:91], v[60:63], a[120:127], v18
    v_smfmac_f32_16x16x64_bf16 v[84:87], v[64:67], a[48:55], v18
    v_smfmac_f32_16x16x64_bf16 v[88:91], v[64:67], a[128:135], v18
    v_smfmac_f32_16x16x64_bf16 v[84:87], v[68:71], a[56:63], v18
    v_smfmac_f32_16x16x64_bf16 v[88:91], v[68:71], a[136:143], v18
    v_smfmac_f32_16x16x64_bf16 v[84:87], v[72:75], a[64:71], v18
    v_smfmac_f32_16x16x64_bf16 v[88:91], v[72:75], a[144:151], v18
    v_smfmac_f32_16x16x64_bf16 v[84:87], v[76:79], a[72:79], v18
    v_smfmac_f32_16x16x64_bf16 v[88:91], v[76:79], a[152:159], v18
    s_cmp_eq_u32 s32, 0
    s_nop 4
    s_cbranch_scc1 L_w0_48
    s_cmp_eq_u32 s32, 3
    s_nop 2
    s_cbranch_scc1 L_w3_49
    s_nop 0
    v_pk_add_f32 v[84:85], v[84:85], v[86:87]
    s_nop 1
    v_pk_add_f32 v[88:89], v[88:89], v[90:91]
    v_cvt_pk_bf16_f32 v176, v84, v85
    v_cvt_pk_bf16_f32 v177, v88, v89
    ds_write_b64 v22, v[176:177]
    s_waitcnt lgkmcnt(0)
    s_barrier
    ds_read_b64_tr_b16 v[92:93], v23 offset:0
    ds_read_b64_tr_b16 v[94:95], v24 offset:0
    ds_read_b64_tr_b16 v[96:97], v23 offset:1024
    ds_read_b64_tr_b16 v[98:99], v24 offset:1024
    ds_read_b128 v[116:119], v11 offset:0
    ds_read_b128 v[120:123], v11 offset:2048
    ds_read_b128 v[124:127], v12 offset:0
    ds_read_b128 v[128:131], v12 offset:2048
    s_waitcnt lgkmcnt(6)
    v_mfma_f32_16x16x32_bf16 v[108:111], v[100:103], v[92:95], 0
    s_waitcnt lgkmcnt(4)
    v_mfma_f32_16x16x32_bf16 v[108:111], v[104:107], v[96:99], v[108:111]
    s_nop 7
    buffer_store_dwordx4 v[108:111], v25, s[4:7], s42 offen sc1
    buffer_store_dwordx4 v[36:39], v25, s[4:7], s43 offen sc1
    s_branch L_join_50
L_w0_48:
    v_pk_add_f32 v[84:85], v[84:85], v[86:87]
    v_pk_add_f32 v[88:89], v[88:89], v[90:91]
    v_cvt_pk_bf16_f32 v176, v84, v85
    v_cvt_pk_bf16_f32 v177, v88, v89
    ds_write_b64 v22, v[176:177]
    s_waitcnt lgkmcnt(0)
    s_barrier
    ds_read_b64_tr_b16 v[92:93], v23 offset:0
    ds_read_b64_tr_b16 v[94:95], v24 offset:0
    ds_read_b64_tr_b16 v[96:97], v23 offset:1024
    ds_read_b64_tr_b16 v[98:99], v24 offset:1024
    ds_read_b128 v[116:119], v11 offset:0
    ds_read_b128 v[120:123], v11 offset:2048
    ds_read_b128 v[124:127], v12 offset:0
    ds_read_b128 v[128:131], v12 offset:2048
    s_waitcnt lgkmcnt(6)
    v_mfma_f32_16x16x32_bf16 v[108:111], v[92:95], v[92:95], 0
    s_waitcnt lgkmcnt(4)
    v_mfma_f32_16x16x32_bf16 v[108:111], v[96:99], v[96:99], v[108:111]
    s_nop 7
    buffer_store_dword v110, v25, s[4:7], s42 offen sc1
    buffer_store_dword v111, v25, s[4:7], s42 offen offset:8 sc1
    buffer_store_dword v38, v25, s[4:7], s43 offen sc1
    buffer_store_dword v39, v25, s[4:7], s43 offen offset:8 sc1
    s_branch L_join_50
L_w3_49:
    v_pk_add_f32 v[84:85], v[84:85], v[86:87]
    v_pk_add_f32 v[88:89], v[88:89], v[90:91]
    v_cvt_pk_bf16_f32 v176, v84, v85
    v_cvt_pk_bf16_f32 v177, v88, v89
    ds_write_b64 v22, v[176:177]
    s_waitcnt lgkmcnt(0)
    s_barrier
    ds_read_b64_tr_b16 v[92:93], v23 offset:0
    ds_read_b64_tr_b16 v[94:95], v24 offset:0
    ds_read_b64_tr_b16 v[96:97], v23 offset:1024
    ds_read_b64_tr_b16 v[98:99], v24 offset:1024
    ds_read_b128 v[116:119], v11 offset:0
    ds_read_b128 v[120:123], v11 offset:2048
    ds_read_b128 v[124:127], v12 offset:0
    ds_read_b128 v[128:131], v12 offset:2048
    s_waitcnt lgkmcnt(6)
    buffer_store_dwordx4 v[92:95], v26, s[4:7], s44 offen sc1
    s_waitcnt lgkmcnt(4)
    buffer_store_dwordx4 v[96:99], v26, s[4:7], s44 offen offset:512 sc1
L_join_50:
    s_cmp_eq_u32 s37, 63
    s_cbranch_scc1 L_skip_51
    s_lshl_b32 s90, s32, 10
    s_add_u32 m0, s90, s47
    s_waitcnt lgkmcnt(2)
    v_mfma_f32_16x16x32_bf16 v[140:143], a[160:163], v[116:119], 0
    ds_read_b128 v[132:135], v11 offset:4096
    v_mfma_f32_16x16x32_bf16 v[144:147], a[160:163], v[120:123], 0
    ds_read_b128 v[136:139], v11 offset:6144
    v_mfma_f32_16x16x32_bf16 v[148:151], a[80:83], v[116:119], 0
    buffer_store_dwordx4 v[164:167], v29, s[4:7], s51 offen sc1
    v_mfma_f32_16x16x32_bf16 v[152:155], a[80:83], v[120:123], 0
    v_mfma_f32_16x16x32_bf16 v[156:159], a[0:3], v[116:119], 0
    buffer_store_dwordx4 v[168:171], v29, s[4:7], s50 offen sc1
    v_mfma_f32_16x16x32_bf16 v[160:163], a[0:3], v[120:123], 0
    s_waitcnt lgkmcnt(2)
    v_mfma_f32_16x16x32_bf16 v[140:143], a[164:167], v[124:127], v[140:143]
    ds_read_b128 v[116:119], v12 offset:4096
    v_mfma_f32_16x16x32_bf16 v[144:147], a[164:167], v[128:131], v[144:147]
    ds_read_b128 v[120:123], v12 offset:6144
    v_mfma_f32_16x16x32_bf16 v[148:151], a[84:87], v[124:127], v[148:151]
    buffer_store_dwordx4 v[172:175], v29, s[4:7], s45 offen sc1
    v_mfma_f32_16x16x32_bf16 v[152:155], a[84:87], v[128:131], v[152:155]
    v_mfma_f32_16x16x32_bf16 v[156:159], a[4:7], v[124:127], v[156:159]
    buffer_store_dwordx4 v[36:39], v21, s[4:7], s43 offen sc1
    v_mfma_f32_16x16x32_bf16 v[160:163], a[4:7], v[128:131], v[160:163]
    s_waitcnt lgkmcnt(2)
    v_mfma_f32_16x16x32_bf16 v[140:143], a[168:171], v[132:135], v[140:143]
    ds_read_b128 v[124:127], v11 offset:8192
    v_mfma_f32_16x16x32_bf16 v[144:147], a[168:171], v[136:139], v[144:147]
    ds_read_b128 v[128:131], v11 offset:10240
    v_mfma_f32_16x16x32_bf16 v[148:151], a[88:91], v[132:135], v[148:151]
    buffer_store_dword v36, v219, s[4:7], s43 offen sc1
    v_mfma_f32_16x16x32_bf16 v[152:155], a[88:91], v[136:139], v[152:155]
    v_mfma_f32_16x16x32_bf16 v[156:159], a[8:11], v[132:135], v[156:159]
    buffer_load_dwordx4 v10, s[24:27], s46 offen offset:0 lds
    s_add_u32 m0, m0, 3968
    v_mfma_f32_16x16x32_bf16 v[160:163], a[8:11], v[136:139], v[160:163]
    s_waitcnt lgkmcnt(2)
    v_mfma_f32_16x16x32_bf16 v[140:143], a[172:175], v[116:119], v[140:143]
    ds_read_b128 v[132:135], v12 offset:8192
    v_mfma_f32_16x16x32_bf16 v[144:147], a[172:175], v[120:123], v[144:147]
    ds_read_b128 v[136:139], v12 offset:10240
    v_mfma_f32_16x16x32_bf16 v[148:151], a[92:95], v[116:119], v[148:151]
    buffer_load_dwordx4 v10, s[24:27], s46 offen offset:128 lds
    s_add_u32 m0, m0, 3968
    v_mfma_f32_16x16x32_bf16 v[152:155], a[92:95], v[120:123], v[152:155]
    v_mfma_f32_16x16x32_bf16 v[156:159], a[12:15], v[116:119], v[156:159]
    buffer_load_dwordx4 v10, s[24:27], s46 offen offset:256 lds
    s_add_u32 m0, m0, 3968
    v_mfma_f32_16x16x32_bf16 v[160:163], a[12:15], v[120:123], v[160:163]
    s_waitcnt lgkmcnt(2)
    v_mfma_f32_16x16x32_bf16 v[140:143], a[176:179], v[124:127], v[140:143]
    ds_read_b128 v[116:119], v11 offset:12288
    v_mfma_f32_16x16x32_bf16 v[144:147], a[176:179], v[128:131], v[144:147]
    ds_read_b128 v[120:123], v11 offset:14336
    v_mfma_f32_16x16x32_bf16 v[148:151], a[96:99], v[124:127], v[148:151]
    buffer_load_dwordx4 v10, s[24:27], s46 offen offset:384 lds
    s_add_u32 m0, m0, 3968
    v_mfma_f32_16x16x32_bf16 v[152:155], a[96:99], v[128:131], v[152:155]
    v_mfma_f32_16x16x32_bf16 v[156:159], a[16:19], v[124:127], v[156:159]
    buffer_load_dwordx4 v10, s[24:27], s46 offen offset:512 lds
    s_add_u32 m0, m0, 3968
    v_mfma_f32_16x16x32_bf16 v[160:163], a[16:19], v[128:131], v[160:163]
    s_waitcnt lgkmcnt(2)
    v_mfma_f32_16x16x32_bf16 v[140:143], a[180:183], v[132:135], v[140:143]
    ds_read_b128 v[124:127], v12 offset:12288
    v_mfma_f32_16x16x32_bf16 v[144:147], a[180:183], v[136:139], v[144:147]
    ds_read_b128 v[128:131], v12 offset:14336
    v_mfma_f32_16x16x32_bf16 v[148:151], a[100:103], v[132:135], v[148:151]
    buffer_load_dwordx4 v10, s[24:27], s46 offen offset:640 lds
    s_add_u32 m0, m0, 3968
    v_mfma_f32_16x16x32_bf16 v[152:155], a[100:103], v[136:139], v[152:155]
    v_mfma_f32_16x16x32_bf16 v[156:159], a[20:23], v[132:135], v[156:159]
    s_waitcnt vmcnt(6)
    buffer_store_dword v32, v31, s[4:7], s38 offen sc1
    v_mfma_f32_16x16x32_bf16 v[160:163], a[20:23], v[136:139], v[160:163]
    s_waitcnt lgkmcnt(2)
    v_mfma_f32_16x16x32_bf16 v[140:143], a[184:187], v[116:119], v[140:143]
    ds_read_b128 v[132:135], v11 offset:16384
    s_and_b32 s52, s37, 3
    v_mfma_f32_16x16x32_bf16 v[144:147], a[184:187], v[120:123], v[144:147]
    ds_read_b128 v[136:139], v11 offset:18432
    s_mul_i32 s55, s52, 491520
    v_mfma_f32_16x16x32_bf16 v[148:151], a[104:107], v[116:119], v[148:151]
    buffer_load_dwordx4 v10, s[24:27], s46 offen offset:768 lds
    s_add_u32 m0, m0, 3968
    v_mfma_f32_16x16x32_bf16 v[152:155], a[104:107], v[120:123], v[152:155]
    s_add_u32 s37, s37, 1
    s_mov_b32 s43, s42
    v_mfma_f32_16x16x32_bf16 v[156:159], a[24:27], v[116:119], v[156:159]
    buffer_load_dwordx4 v10, s[24:27], s46 offen offset:896 lds
    s_add_u32 m0, m0, 3968
    v_mfma_f32_16x16x32_bf16 v[160:163], a[24:27], v[120:123], v[160:163]
    s_waitcnt lgkmcnt(2)
    s_mov_b32 s54, 0
    v_mfma_f32_16x16x32_bf16 v[140:143], a[188:191], v[124:127], v[140:143]
    ds_read_b128 v[116:119], v12 offset:16384
    s_and_b32 s52, s37, 3
    v_mfma_f32_16x16x32_bf16 v[144:147], a[188:191], v[128:131], v[144:147]
    ds_read_b128 v[120:123], v12 offset:18432
    s_mul_i32 s53, s52, 40960
    v_mfma_f32_16x16x32_bf16 v[148:151], a[108:111], v[124:127], v[148:151]
    buffer_load_dwordx4 v10, s[24:27], s46 offen offset:1024 lds
    s_add_u32 m0, m0, 3968
    v_mfma_f32_16x16x32_bf16 v[152:155], a[108:111], v[128:131], v[152:155]
    s_add_u32 s42, s38, s53
    s_lshl_b32 s52, s52, 12
    v_mfma_f32_16x16x32_bf16 v[156:159], a[28:31], v[124:127], v[156:159]
    buffer_load_dwordx4 v10, s[24:27], s46 offen offset:1152 lds
    v_mfma_f32_16x16x32_bf16 v[160:163], a[28:31], v[128:131], v[160:163]
    s_waitcnt lgkmcnt(2)
    v_add_u32 v35, s52, v28
    v_mfma_f32_16x16x32_bf16 v[140:143], a[192:195], v[132:135], v[140:143]
    ds_read_b128 v[124:127], v11 offset:20480
    s_xor_b32 s52, s52, 8192
    v_mfma_f32_16x16x32_bf16 v[144:147], a[192:195], v[136:139], v[144:147]
    ds_read_b128 v[128:131], v11 offset:22528
    v_add_u32 v34, s52, v27
    v_mfma_f32_16x16x32_bf16 v[148:151], a[112:115], v[132:135], v[148:151]
    s_and_b32 s53, s37, 7
    s_mul_i32 s53, s53, 172032
    v_mfma_f32_16x16x32_bf16 v[152:155], a[112:115], v[136:139], v[152:155]
    s_add_u32 s53, s53, 196608
    s_add_u32 s44, s38, s53
    v_mfma_f32_16x16x32_bf16 v[156:159], a[32:35], v[132:135], v[156:159]
    s_add_u32 s53, s37, 2
    s_and_b32 s53, s53, 7
    v_mfma_f32_16x16x32_bf16 v[160:163], a[32:35], v[136:139], v[160:163]
    s_waitcnt lgkmcnt(2)
    s_mul_i32 s53, s53, 172032
    v_mfma_f32_16x16x32_bf16 v[140:143], a[196:199], v[116:119], v[140:143]
    ds_read_b128 v[132:135], v12 offset:20480
    s_add_u32 s53, s53, 221184
    v_mfma_f32_16x16x32_bf16 v[144:147], a[196:199], v[120:123], v[144:147]
    ds_read_b128 v[136:139], v12 offset:22528
    s_add_u32 s45, s38, s53
    v_mfma_f32_16x16x32_bf16 v[148:151], a[116:119], v[116:119], v[148:151]
    s_add_u32 s50, s45, 49152
    s_add_u32 s51, s45, 98304
    v_mfma_f32_16x16x32_bf16 v[152:155], a[116:119], v[120:123], v[152:155]
    v_add_u32 v32, s37, v220
    v_mov_b32 v80, 0
    v_mfma_f32_16x16x32_bf16 v[156:159], a[36:39], v[116:119], v[156:159]
    v_mov_b32 v81, 0
    v_mov_b32 v82, 0
    v_mfma_f32_16x16x32_bf16 v[160:163], a[36:39], v[120:123], v[160:163]
    s_waitcnt lgkmcnt(2)
    v_mov_b32 v83, 0
    v_mfma_f32_16x16x32_bf16 v[140:143], a[200:203], v[124:127], v[140:143]
    ds_read_b128 v[116:119], v11 offset:24576
    v_mov_b32 v84, 0
    v_mfma_f32_16x16x32_bf16 v[144:147], a[200:203], v[128:131], v[144:147]
    ds_read_b128 v[120:123], v11 offset:26624
    v_mov_b32 v85, 0
    v_mfma_f32_16x16x32_bf16 v[148:151], a[120:123], v[124:127], v[148:151]
    v_mov_b32 v86, 0
    v_mov_b32 v87, 0
    v_mfma_f32_16x16x32_bf16 v[152:155], a[120:123], v[128:131], v[152:155]
    v_mov_b32 v88, 0
    v_mov_b32 v89, 0
    v_mfma_f32_16x16x32_bf16 v[156:159], a[40:43], v[124:127], v[156:159]
    v_mov_b32 v90, 0
    v_mov_b32 v91, 0
    v_mfma_f32_16x16x32_bf16 v[160:163], a[40:43], v[128:131], v[160:163]
    s_waitcnt lgkmcnt(2)
    v_mfma_f32_16x16x32_bf16 v[140:143], a[204:207], v[132:135], v[140:143]
    ds_read_b128 v[124:127], v12 offset:24576
    v_mfma_f32_16x16x32_bf16 v[144:147], a[204:207], v[136:139], v[144:147]
    ds_read_b128 v[128:131], v12 offset:26624
    v_mfma_f32_16x16x32_bf16 v[148:151], a[124:127], v[132:135], v[148:151]
    v_mfma_f32_16x16x32_bf16 v[152:155], a[124:127], v[136:139], v[152:155]
    v_mfma_f32_16x16x32_bf16 v[156:159], a[44:47], v[132:135], v[156:159]
    v_mfma_f32_16x16x32_bf16 v[160:163], a[44:47], v[136:139], v[160:163]
    s_waitcnt lgkmcnt(2)
    v_mfma_f32_16x16x32_bf16 v[140:143], a[208:211], v[116:119], v[140:143]
    ds_read_b128 v[132:135], v11 offset:28672
    v_mfma_f32_16x16x32_bf16 v[144:147], a[208:211], v[120:123], v[144:147]
    ds_read_b128 v[136:139], v11 offset:30720
    v_mfma_f32_16x16x32_bf16 v[148:151], a[128:131], v[116:119], v[148:151]
    v_mfma_f32_16x16x32_bf16 v[152:155], a[128:131], v[120:123], v[152:155]
    buffer_load_dword v217, v216, s[4:7], s38 offen sc1
    v_mfma_f32_16x16x32_bf16 v[156:159], a[48:51], v[116:119], v[156:159]
    v_mfma_f32_16x16x32_bf16 v[160:163], a[48:51], v[120:123], v[160:163]
    s_waitcnt lgkmcnt(2)
    v_mfma_f32_16x16x32_bf16 v[140:143], a[212:215], v[124:127], v[140:143]
    ds_read_b128 v[116:119], v12 offset:28672
    v_mfma_f32_16x16x32_bf16 v[144:147], a[212:215], v[128:131], v[144:147]
    ds_read_b128 v[120:123], v12 offset:30720
    v_mfma_f32_16x16x32_bf16 v[148:151], a[132:135], v[124:127], v[148:151]
    v_mfma_f32_16x16x32_bf16 v[152:155], a[132:135], v[128:131], v[152:155]
    v_mfma_f32_16x16x32_bf16 v[156:159], a[52:55], v[124:127], v[156:159]
    v_mfma_f32_16x16x32_bf16 v[160:163], a[52:55], v[128:131], v[160:163]
    s_waitcnt lgkmcnt(2)
    v_mfma_f32_16x16x32_bf16 v[140:143], a[216:219], v[132:135], v[140:143]
    ds_read_b128 v[124:127], v11 offset:32768
    v_mfma_f32_16x16x32_bf16 v[144:147], a[216:219], v[136:139], v[144:147]
    ds_read_b128 v[128:131], v11 offset:34816
    v_mfma_f32_16x16x32_bf16 v[148:151], a[136:139], v[132:135], v[148:151]
    v_mfma_f32_16x16x32_bf16 v[152:155], a[136:139], v[136:139], v[152:155]
    v_mfma_f32_16x16x32_bf16 v[156:159], a[56:59], v[132:135], v[156:159]
    v_mfma_f32_16x16x32_bf16 v[160:163], a[56:59], v[136:139], v[160:163]
    s_waitcnt lgkmcnt(2)
    s_waitcnt vmcnt(0)
    v_cmp_gt_u32 vcc, s37, v217
    s_cbranch_vccnz L_tw_52
L_tok_53:
    s_barrier
    buffer_load_dwordx4 v[180:183], v214, s[4:7], s55 offen sc1
    buffer_load_dwordx4 v[184:187], v215, s[4:7], s55 offen sc1
    v_mfma_f32_16x16x32_bf16 v[140:143], a[220:223], v[116:119], v[140:143]
    ds_read_b128 v[132:135], v12 offset:32768
    v_mfma_f32_16x16x32_bf16 v[144:147], a[220:223], v[120:123], v[144:147]
    ds_read_b128 v[136:139], v12 offset:34816
    v_mfma_f32_16x16x32_bf16 v[148:151], a[140:143], v[116:119], v[148:151]
    v_mfma_f32_16x16x32_bf16 v[152:155], a[140:143], v[120:123], v[152:155]
    v_mfma_f32_16x16x32_bf16 v[156:159], a[60:63], v[116:119], v[156:159]
    v_mfma_f32_16x16x32_bf16 v[160:163], a[60:63], v[120:123], v[160:163]
    s_waitcnt lgkmcnt(2)
    v_mfma_f32_16x16x32_bf16 v[140:143], a[224:227], v[124:127], v[140:143]
    ds_read_b128 v[116:119], v11 offset:36864
    v_mfma_f32_16x16x32_bf16 v[144:147], a[224:227], v[128:131], v[144:147]
    ds_read_b128 v[120:123], v11 offset:38912
    v_mfma_f32_16x16x32_bf16 v[148:151], a[144:147], v[124:127], v[148:151]
    v_mfma_f32_16x16x32_bf16 v[152:155], a[144:147], v[128:131], v[152:155]
    v_mfma_f32_16x16x32_bf16 v[156:159], a[64:67], v[124:127], v[156:159]
    v_mfma_f32_16x16x32_bf16 v[160:163], a[64:67], v[128:131], v[160:163]
    s_waitcnt lgkmcnt(2)
    buffer_load_dwordx4 v[188:191], v223, s[4:7], s55 offen sc1
    buffer_load_dwordx4 v[192:195], v224, s[4:7], s55 offen sc1
    v_mfma_f32_16x16x32_bf16 v[140:143], a[228:231], v[132:135], v[140:143]
    ds_read_b128 v[124:127], v12 offset:36864
    v_mfma_f32_16x16x32_bf16 v[144:147], a[228:231], v[136:139], v[144:147]
    ds_read_b128 v[128:131], v12 offset:38912
    v_mfma_f32_16x16x32_bf16 v[148:151], a[148:151], v[132:135], v[148:151]
    v_mfma_f32_16x16x32_bf16 v[152:155], a[148:151], v[136:139], v[152:155]
    v_mfma_f32_16x16x32_bf16 v[156:159], a[68:71], v[132:135], v[156:159]
    v_mfma_f32_16x16x32_bf16 v[160:163], a[68:71], v[136:139], v[160:163]
    s_waitcnt lgkmcnt(0)
    v_mfma_f32_16x16x32_bf16 v[140:143], a[232:235], v[116:119], v[140:143]
    v_mfma_f32_16x16x32_bf16 v[144:147], a[232:235], v[120:123], v[144:147]
    v_mfma_f32_16x16x32_bf16 v[140:143], a[236:239], v[124:127], v[140:143]
    v_mfma_f32_16x16x32_bf16 v[144:147], a[236:239], v[128:131], v[144:147]
    v_mfma_f32_16x16x32_bf16 v[148:151], a[152:155], v[116:119], v[148:151]
    v_add_u32 v11, s49, v11
    v_add_u32 v12, s49, v12
    v_mfma_f32_16x16x32_bf16 v[152:155], a[152:155], v[120:123], v[152:155]
    s_sub_u32 s47, s47, s49
    s_sub_u32 s49, 0, s49
    v_mfma_f32_16x16x32_bf16 v[148:151], a[156:159], v[124:127], v[148:151]
    v_mfma_f32_16x16x32_bf16 v[152:155], a[156:159], v[128:131], v[152:155]
    v_mfma_f32_16x16x32_bf16 v[156:159], a[72:75], v[116:119], v[156:159]
    v_cvt_pk_bf16_f32 v164, v140, v141
    v_cvt_pk_bf16_f32 v165, v142, v143
    v_mfma_f32_16x16x32_bf16 v[160:163], a[72:75], v[120:123], v[160:163]
    v_cvt_pk_bf16_f32 v166, v144, v145
    v_cvt_pk_bf16_f32 v167, v146, v147
    v_mfma_f32_16x16x32_bf16 v[156:159], a[76:79], v[124:127], v[156:159]
    v_permlane16_swap_b32 v164, v166
    v_permlane16_swap_b32 v165, v167
    v_mfma_f32_16x16x32_bf16 v[160:163], a[76:79], v[128:131], v[160:163]
    v_cvt_pk_bf16_f32 v168, v148, v149
    v_cvt_pk_bf16_f32 v169, v150, v151
    v_cvt_pk_bf16_f32 v170, v152, v153
    v_cvt_pk_bf16_f32 v171, v154, v155
    s_nop 0
    v_permlane16_swap_b32 v168, v170
    v_permlane16_swap_b32 v169, v171
    ds_write_b128 v34, v[168:171]
    v_cvt_pk_bf16_f32 v172, v156, v157
    v_cvt_pk_bf16_f32 v173, v158, v159
    v_cvt_pk_bf16_f32 v174, v160, v161
    v_cvt_pk_bf16_f32 v175, v162, v163
    s_nop 0
    v_permlane16_swap_b32 v172, v174
    v_permlane16_swap_b32 v173, v175
    s_waitcnt vmcnt(3)
    v_mfma_f32_16x16x32_bf16 v[196:199], v[210:213], v[180:183], 0
    v_mfma_f32_16x16x32_bf16 v[200:203], v[208:211], v[180:183], 0
    v_max3_u32 v221, v180, v181, v182
    s_waitcnt vmcnt(2)
    v_mfma_f32_16x16x32_bf16 v[196:199], v[210:213], v[184:187], v[196:199]
    v_max3_u32 v222, v183, v184, v185
    v_max3_u32 v221, v221, v186, v187
    v_mfma_f32_16x16x32_bf16 v[200:203], v[208:211], v[184:187], v[200:203]
    v_max_u32 v221, v221, v222
    v_cmp_eq_u32 vcc, -1, v221
    s_nop 2
    v_cvt_pk_bf16_f32 v204, v196, v197
    v_cvt_pk_bf16_f32 v205, v198, v199
    s_cbranch_vccnz L_pp_54
    v_cvt_pk_bf16_f32 v206, v200, v201
    v_cvt_pk_bf16_f32 v207, v202, v203
    buffer_store_dwordx4 v[204:207], v218, s[4:7], s42 offen sc1
L_pc_55:
    s_branch L_qkv_loop_s
L_skip_51:
    s_waitcnt vmcnt(0) lgkmcnt(0)
    buffer_store_dword v32, v31, s[4:7], s38 offen sc1
    s_endpgm
L_nan_46:
    s_cmp_eq_u32 s54, 1
    s_cbranch_scc1 L_cont_47
    v_lshlrev_b32 v1, 4, v0
L_nan_46r:
    s_mov_b32 s90, s42
    v_mov_b32 v2, 0
    buffer_load_dwordx4 v[40:43], v1, s[4:7], s90 offen sc1
    s_add_u32 s90, s90, 1024
    buffer_load_dwordx4 v[44:47], v1, s[4:7], s90 offen sc1
    s_add_u32 s90, s90, 1024
    buffer_load_dwordx4 v[48:51], v1, s[4:7], s90 offen sc1
    s_add_u32 s90, s90, 1024
    buffer_load_dwordx4 v[52:55], v1, s[4:7], s90 offen sc1
    s_add_u32 s90, s90, 1024
    buffer_load_dwordx4 v[56:59], v1, s[4:7], s90 offen sc1
    s_add_u32 s90, s90, 1024
    buffer_load_dwordx4 v[60:63], v1, s[4:7], s90 offen sc1
    s_add_u32 s90, s90, 1024
    buffer_load_dwordx4 v[64:67], v1, s[4:7], s90 offen sc1
    s_add_u32 s90, s90, 1024
    buffer_load_dwordx4 v[68:71], v1, s[4:7], s90 offen sc1
    s_add_u32 s90, s90, 1024
    buffer_load_dwordx4 v[72:75], v1, s[4:7], s90 offen sc1
    s_add_u32 s90, s90, 1024
    buffer_load_dwordx4 v[76:79], v1, s[4:7], s90 offen sc1
    s_add_u32 s90, s90, 1024
    s_sub_u32 s36, s36, 1
    s_cbranch_scc1 L_exit
    s_waitcnt vmcnt(0) lgkmcnt(0)
    v_max3_u32 v2, v2, v40, v41
    v_max3_u32 v2, v2, v42, v43
    v_max3_u32 v2, v2, v44, v45
    v_max3_u32 v2, v2, v46, v47
    v_max3_u32 v2, v2, v48, v49
    v_max3_u32 v2, v2, v50, v51
    v_max3_u32 v2, v2, v52, v53
    v_max3_u32 v2, v2, v54, v55
    v_max3_u32 v2, v2, v56, v57
    v_max3_u32 v2, v2, v58, v59
    v_max3_u32 v2, v2, v60, v61
    v_max3_u32 v2, v2, v62, v63
    v_max3_u32 v2, v2, v64, v65
    v_max3_u32 v2, v2, v66, v67
    v_max3_u32 v2, v2, v68, v69
    v_max3_u32 v2, v2, v70, v71
    v_max3_u32 v2, v2, v72, v73
    v_max3_u32 v2, v2, v74, v75
    v_max3_u32 v2, v2, v76, v77
    v_max3_u32 v2, v2, v78, v79
    v_cmp_eq_u32 vcc, -1, v2
    s_cbranch_vccnz L_nan_46r
    s_mov_b32 s54, 1
    v_mov_b32 v80, 0
    v_mov_b32 v81, 0
    v_mov_b32 v82, 0
    v_mov_b32 v83, 0
    v_mov_b32 v84, 0
    v_mov_b32 v85, 0
    v_mov_b32 v86, 0
    v_mov_b32 v87, 0
    v_mov_b32 v88, 0
    v_mov_b32 v89, 0
    v_mov_b32 v90, 0
    v_mov_b32 v91, 0
    s_branch L_got_44r
L_wo_s:
    s_mov_b32 s12, s80
    s_and_b32 s13, s81, 0xffff
    s_mov_b32 s14, 7864320
    s_mov_b32 s15, 0x20000
    s_mov_b32 s16, s72
    s_and_b32 s17, s73, 0xffff
    s_mov_b32 s18, 10240
    s_mov_b32 s19, 0x20000
    s_sub_u32 s40, s35, 12
    v_and_b32 v1, 15, v0
    v_lshrrev_b32 v2, 4, v0
    v_lshrrev_b32 v3, 3, v0
    v_and_b32 v4, 7, v0
    v_and_b32 v6, 2, v3
    v_xor_b32 v6, v6, v4
    v_lshlrev_b32 v6, 4, v6
    v_mul_u32_u24 v7, 1280, v3
    s_lshl_b32 s90, s34, 2
    s_add_u32 s90, s90, s32
    s_mul_i32 s90, s90, 245760
    s_lshl_b32 s91, s40, 7
    s_add_u32 s90, s90, s91
    v_add3_u32 v180, v6, v7, s90
    v_xor_b32 v181, 64, v180
    s_mul_i32 s90, s40, 49152
    s_lshl_b32 s91, s32, 11
    s_add_u32 s90, s90, s91
    s_lshl_b32 s91, s34, 8
    s_add_u32 s91, s91, s90
    v_lshlrev_b32 v6, 4, v1
    v_lshl_add_u32 v7, v2, 13, v6
    v_add_u32 v14, s91, v7
    v_lshlrev_b32 v12, 4, v0
    v_lshlrev_b32 v13, 2, v0
    v_add_u32 v46, s91, v13
    v_add_u32 v15, s90, v12
    v_add_u32 v16, 1024, v15
    v_add_u32 v45, 32768, v14
    v_add_u32 v46, 32768, v46
    v_cmp_eq_u32 vcc, 0, v2
    v_mov_b32 v9, 2146435072
    s_nop 0
    v_cndmask_b32 v45, v9, v45, vcc
    s_lshl_b32 s92, s40, 7
    s_lshl_b32 s93, s32, 2
    s_add_u32 s92, s92, s93
    s_add_u32 s92, s92, 165888
    v_mov_b32 v244, s92
    v_cmp_eq_u32 vcc, 0, v0
    v_mov_b32 v9, 2146435072
    s_nop 0
    v_cndmask_b32 v244, v9, v244, vcc
    v_cmp_ne_u32 vcc, s34, v2
    v_mov_b32 v9, 2146435072
    s_nop 0
    v_cndmask_b32 v15, v9, v15, vcc
    v_add_u32 v3, 4, v2
    v_cmp_ne_u32 vcc, s34, v3
    v_mov_b32 v9, 2146435072
    s_nop 0
    v_cndmask_b32 v16, v9, v16, vcc
    s_lshl_b32 s90, s40, 2
    s_add_u32 s90, s90, s32
    s_lshl_b32 s91, s90, 8
    v_add_u32 v17, s91, v6
    v_cmp_eq_u32 vcc, 0, v2
    v_mov_b32 v9, 2146435072
    s_nop 0
    v_cndmask_b32 v17, v9, v17, vcc
    v_lshrrev_b32 v3, 2, v1
    v_and_b32 v7, 1, v1
    v_lshl_or_b32 v4, v3, 1, v7
    v_mul_u32_u24 v4, 1280, v4
    v_and_b32 v5, 2, v1
    v_lshl_add_u32 v4, v5, 1, v4
    s_lshl_b32 s91, s90, 5
    v_add_u32 v4, s91, v4
    v_lshlrev_b32 v6, 6, v3
    v_lshl_add_u32 v6, v7, 5, v6
    v_lshl_add_u32 v6, v2, 3, v6
    v_lshl_add_u32 v6, v5, 1, v6
    s_mul_i32 s92, s32, 1152
    s_add_u32 s92, s92, 122880
    v_add_u32 v18, s92, v6
    buffer_load_dword v164, v4, s[16:19], 0 offen offset:0
    buffer_load_dword v165, v4, s[16:19], 0 offen offset:8
    buffer_load_dword v166, v4, s[16:19], 0 offen offset:16
    buffer_load_dword v167, v4, s[16:19], 0 offen offset:24
    v_mov_b32 v168, -1
    v_mov_b32 v169, -1
    v_mov_b32 v170, -1
    v_mov_b32 v171, -1
    s_mul_i32 s90, s32, 24576
    s_mov_b32 m0, s90
    s_mov_b32 s91, 0
    buffer_load_dwordx4 v180, s[12:15], s91 offen lds
    s_add_u32 m0, m0, 1024
    s_add_u32 s91, s91, 10240
    buffer_load_dwordx4 v181, s[12:15], s91 offen lds
    s_add_u32 m0, m0, 1024
    s_add_u32 s91, s91, 10240
    buffer_load_dwordx4 v180, s[12:15], s91 offen lds
    s_add_u32 m0, m0, 1024
    s_add_u32 s91, s91, 10240
    buffer_load_dwordx4 v181, s[12:15], s91 offen lds
    s_add_u32 m0, m0, 1024
    s_add_u32 s91, s91, 10240
    buffer_load_dwordx4 v180, s[12:15], s91 offen lds
    s_add_u32 m0, m0, 1024
    s_add_u32 s91, s91, 10240
    buffer_load_dwordx4 v181, s[12:15], s91 offen lds
    s_add_u32 m0, m0, 1024
    s_add_u32 s91, s91, 10240
    buffer_load_dwordx4 v180, s[12:15], s91 offen lds
    s_add_u32 m0, m0, 1024
    s_add_u32 s91, s91, 10240
    buffer_load_dwordx4 v181, s[12:15], s91 offen lds
    s_add_u32 m0, m0, 1024
    s_add_u32 s91, s91, 10240
    buffer_load_dwordx4 v180, s[12:15], s91 offen lds
    s_add_u32 m0, m0, 1024
    s_add_u32 s91, s91, 10240
    buffer_load_dwordx4 v181, s[12:15], s91 offen lds
    s_add_u32 m0, m0, 1024
    s_add_u32 s91, s91, 10240
    buffer_load_dwordx4 v180, s[12:15], s91 offen lds
    s_add_u32 m0, m0, 1024
    s_add_u32 s91, s91, 10240
    buffer_load_dwordx4 v181, s[12:15], s91 offen lds
    s_add_u32 m0, m0, 1024
    s_add_u32 s91, s91, 10240
    buffer_load_dwordx4 v180, s[12:15], s91 offen lds
    s_add_u32 m0, m0, 1024
    s_add_u32 s91, s91, 10240
    buffer_load_dwordx4 v181, s[12:15], s91 offen lds
    s_add_u32 m0, m0, 1024
    s_add_u32 s91, s91, 10240
    buffer_load_dwordx4 v180, s[12:15], s91 offen lds
    s_add_u32 m0, m0, 1024
    s_add_u32 s91, s91, 10240
    buffer_load_dwordx4 v181, s[12:15], s91 offen lds
    s_add_u32 m0, m0, 1024
    s_add_u32 s91, s91, 10240
    buffer_load_dwordx4 v180, s[12:15], s91 offen lds
    s_add_u32 m0, m0, 1024
    s_add_u32 s91, s91, 10240
    buffer_load_dwordx4 v181, s[12:15], s91 offen lds
    s_add_u32 m0, m0, 1024
    s_add_u32 s91, s91, 10240
    buffer_load_dwordx4 v180, s[12:15], s91 offen lds
    s_add_u32 m0, m0, 1024
    s_add_u32 s91, s91, 10240
    buffer_load_dwordx4 v181, s[12:15], s91 offen lds
    s_add_u32 m0, m0, 1024
    s_add_u32 s91, s91, 10240
    buffer_load_dwordx4 v180, s[12:15], s91 offen lds
    s_add_u32 m0, m0, 1024
    s_add_u32 s91, s91, 10240
    buffer_load_dwordx4 v181, s[12:15], s91 offen lds
    s_add_u32 m0, m0, 1024
    s_add_u32 s91, s91, 10240
    buffer_load_dwordx4 v180, s[12:15], s91 offen lds
    s_add_u32 m0, m0, 1024
    s_add_u32 s91, s91, 10240
    buffer_load_dwordx4 v181, s[12:15], s91 offen lds
    s_waitcnt vmcnt(24)
    v_min_u32 v164, -2, v164
    v_min_u32 v165, -2, v165
    v_min_u32 v166, -2, v166
    v_min_u32 v167, -2, v167
    v_and_b32 v7, 2, v1
    v_cmp_ne_u32 vcc, 0, v7
    v_mov_b32 v5, 0x4444
    v_mov_b32 v6, 0xeeee
    v_cndmask_b32 v10, v5, v6, vcc
    v_mov_b32 v5, 0xe484
    v_mov_b32 v6, 0xee9e
    v_cndmask_b32 v7, v5, v6, vcc
    v_mov_b32 v5, 0x84e4
    v_mov_b32 v6, 0x9eee
    v_cndmask_b32 v8, v5, v6, vcc
    v_cmp_gt_u32 vcc, 2, v2
    s_nop 1
    v_cndmask_b32 v11, v8, v7, vcc
    v_mov_b32 v84, 1065369472
    v_mov_b32 v85, 1065369472
    v_mov_b32 v86, 1065369472
    v_mov_b32 v87, 0
    v_mov_b32 v88, 1065369472
    v_mov_b32 v89, 1065369472
    v_mov_b32 v90, 1065369472
    v_mov_b32 v91, 0
    v_mov_b32 v51, 0
    v_mov_b32 v55, 0
    v_mov_b32 v59, 0
    v_mov_b32 v63, 0
    v_mov_b32 v67, 0
    v_mov_b32 v71, 0
    v_mov_b32 v75, 0
    v_mov_b32 v79, 0
    v_mov_b32 v210, 0
    v_mov_b32 v211, 0
    v_mov_b32 v218, 0
    v_mov_b32 v219, 0
    v_and_b32 v7, 1, v1
    v_cmp_ne_u32 vcc, 0, v7
    v_mov_b32 v5, 0x3f80
    v_mov_b32 v6, 0x3f800000
    v_cndmask_b32 v5, v5, v6, vcc
    v_bfe_u32 v6, v1, 1, 1
    v_cmp_eq_u32 vcc, 0, v6
    s_nop 1
    v_cndmask_b32 v110, 0, v5, vcc
    v_mov_b32 v108, 0
    v_mov_b32 v112, 0
    v_cmp_eq_u32 vcc, 1, v6
    s_nop 1
    v_cndmask_b32 v111, 0, v5, vcc
    v_mov_b32 v109, 0
    v_mov_b32 v113, 0
    v_mov_b32 v240, 0x3dd53b95
    v_mov_b32 v241, 0x3dd53b95
    s_lshl_b32 s90, s32, 8
    s_add_u32 s90, s90, 122880
    v_mul_u32_u24 v6, 1152, v2
    v_lshl_add_u32 v6, v1, 3, v6
    v_add_u32 v19, s90, v6
    s_mul_i32 s90, s32, 1536
    v_add_u32 v20, s90, v12
    s_add_u32 s90, s90, 1024
    v_lshl_add_u32 v21, v0, 3, s90
    s_mul_i32 s90, s32, 6144
    v_add_u32 v22, s90, v12
    s_add_u32 s90, s90, 1024
    v_lshl_add_u32 v23, v0, 3, s90
    v_add_u32 v28, 98304, v12
    s_mul_i32 s90, s32, 3072
    v_add_u32 v37, s90, v12
    v_add_u32 v44, 25600, v37
    s_add_u32 s54, s90, 98304
    s_mul_i32 s90, s32, 3840
    s_add_u32 s90, s90, 10240
    v_add_u32 v38, s90, v12
    s_add_u32 s90, s90, 1024
    v_add_u32 v39, s90, v13
    s_mul_i32 s90, s32, 12288
    v_add_u32 v40, s90, v12
    s_lshl_b32 s90, s40, 16
    s_lshl_b32 s92, s32, 11
    s_add_u32 s90, s90, s92
    s_lshl_b32 s91, s34, 8
    s_add_u32 s91, s91, s90
    v_lshlrev_b32 v6, 4, v1
    v_lshl_add_u32 v6, v2, 13, v6
    v_add_u32 v30, s91, v6
    s_lshl_b32 s91, s34, 13
    s_add_u32 s91, s91, s90
    v_add_u32 v31, s91, v12
    s_mul_i32 s91, s34, 10240
    s_lshl_b32 s92, s40, 7
    s_add_u32 s91, s91, s92
    s_lshl_b32 s92, s32, 5
    s_add_u32 s91, s91, s92
    s_add_u32 s91, s91, 1280
    v_mul_u32_u24 v6, 2560, v2
    v_lshl_add_u32 v6, v1, 1, v6
    v_add_u32 v32, s91, v6
    s_lshl_b32 s90, s32, 7
    v_add_u32 v5, s90, v13
    v_add_u32 v6, 163840, v5
    v_add_u32 v7, 164816, v5
    v_cmp_gt_u32 vcc, 12, v0
    s_nop 1
    v_cndmask_b32 v33, v7, v6, vcc
    v_mov_b32 v5, -2
    v_cndmask_b32 v34, v5, 3, vcc
    v_cmp_gt_u32 vcc, 14, v0
    v_mov_b32 v9, 2146435072
    s_nop 0
    v_cndmask_b32 v33, v9, v33, vcc
    v_mov_b32 v5, -1000
    v_cndmask_b32 v34, v5, v34, vcc
    v_and_b32 v4, 3, v1
    v_and_b32 v5, 1, v2
    v_lshl_add_u32 v6, v2, 3, v3
    v_lshlrev_b32 v6, 7, v6
    v_and_b32 v7, 2, v3
    v_lshl_or_b32 v7, v5, 2, v7
    v_lshrrev_b32 v8, 1, v4
    v_xor_b32 v7, v7, v8
    v_lshl_add_u32 v6, v7, 4, v6
    v_and_b32 v7, 1, v4
    v_lshl_add_u32 v6, v7, 3, v6
    s_mul_i32 s90, s32, 24576
    v_add_u32 v6, s90, v6
    v_xor_b32 v182, 0, v6
    v_xor_b32 v183, 32, v6
    v_xor_b32 v184, 64, v6
    v_xor_b32 v185, 96, v6
    s_waitcnt vmcnt(0)
    ds_read_b64_tr_b16 a[0:1], v182 offset:0
    ds_read_b64_tr_b16 a[2:3], v182 offset:512
    ds_read_b64_tr_b16 a[4:5], v182 offset:4096
    ds_read_b64_tr_b16 a[6:7], v182 offset:4608
    ds_read_b64_tr_b16 a[8:9], v182 offset:8192
    ds_read_b64_tr_b16 a[10:11], v182 offset:8704
    ds_read_b64_tr_b16 a[12:13], v182 offset:12288
    ds_read_b64_tr_b16 a[14:15], v182 offset:12800
    ds_read_b64_tr_b16 a[16:17], v182 offset:16384
    ds_read_b64_tr_b16 a[18:19], v182 offset:16896
    ds_read_b64_tr_b16 a[20:21], v182 offset:20480
    ds_read_b64_tr_b16 a[22:23], v182 offset:20992
    ds_read_b64_tr_b16 a[24:25], v183 offset:0
    ds_read_b64_tr_b16 a[26:27], v183 offset:512
    ds_read_b64_tr_b16 a[28:29], v183 offset:4096
    ds_read_b64_tr_b16 a[30:31], v183 offset:4608
    ds_read_b64_tr_b16 a[32:33], v183 offset:8192
    ds_read_b64_tr_b16 a[34:35], v183 offset:8704
    ds_read_b64_tr_b16 a[36:37], v183 offset:12288
    ds_read_b64_tr_b16 a[38:39], v183 offset:12800
    ds_read_b64_tr_b16 a[40:41], v183 offset:16384
    ds_read_b64_tr_b16 a[42:43], v183 offset:16896
    ds_read_b64_tr_b16 a[44:45], v183 offset:20480
    ds_read_b64_tr_b16 a[46:47], v183 offset:20992
    ds_read_b64_tr_b16 a[48:49], v184 offset:0
    ds_read_b64_tr_b16 a[50:51], v184 offset:512
    ds_read_b64_tr_b16 a[52:53], v184 offset:4096
    ds_read_b64_tr_b16 a[54:55], v184 offset:4608
    ds_read_b64_tr_b16 a[56:57], v184 offset:8192
    ds_read_b64_tr_b16 a[58:59], v184 offset:8704
    ds_read_b64_tr_b16 a[60:61], v184 offset:12288
    ds_read_b64_tr_b16 a[62:63], v184 offset:12800
    ds_read_b64_tr_b16 a[64:65], v184 offset:16384
    ds_read_b64_tr_b16 a[66:67], v184 offset:16896
    ds_read_b64_tr_b16 a[68:69], v184 offset:20480
    ds_read_b64_tr_b16 a[70:71], v184 offset:20992
    ds_read_b64_tr_b16 a[72:73], v185 offset:0
    ds_read_b64_tr_b16 a[74:75], v185 offset:512
    ds_read_b64_tr_b16 a[76:77], v185 offset:4096
    ds_read_b64_tr_b16 a[78:79], v185 offset:4608
    ds_read_b64_tr_b16 a[80:81], v185 offset:8192
    ds_read_b64_tr_b16 a[82:83], v185 offset:8704
    ds_read_b64_tr_b16 a[84:85], v185 offset:12288
    ds_read_b64_tr_b16 a[86:87], v185 offset:12800
    ds_read_b64_tr_b16 a[88:89], v185 offset:16384
    ds_read_b64_tr_b16 a[90:91], v185 offset:16896
    ds_read_b64_tr_b16 a[92:93], v185 offset:20480
    ds_read_b64_tr_b16 a[94:95], v185 offset:20992
    s_waitcnt lgkmcnt(0)
    s_barrier
    v_mov_b32 v1, 196
L_gw_56:
    buffer_load_dword v2, v1, s[8:11], 0 offen sc1
    s_sub_u32 s36, s36, 1
    s_cbranch_scc1 L_exit
    s_waitcnt vmcnt(0)
    v_readfirstlane_b32 s90, v2
    s_nop 0
    s_cmp_eq_u32 s90, 0
    s_cbranch_scc1 L_gw_56
    buffer_store_dwordx4 v[164:167], v17, s[4:7], s38 offen sc1
    s_mov_b32 s37, -1
    v_add_u32 v35, -2, v34
    s_add_u32 s45, s38, 319488
    s_add_u32 s46, s45, 4096
    s_add_u32 s47, s45, 8192
    v_mov_b32 v24, v20
    v_mov_b32 v25, v21
    buffer_load_dword v36, v33, s[4:7], s38 offen sc1
    s_waitcnt vmcnt(0)
    v_cmp_lt_i32 vcc, v36, v35
    s_cbranch_vccz L_fok_58
L_fw_57:
    buffer_load_dword v36, v33, s[4:7], s38 offen sc1
    s_sub_u32 s36, s36, 1
    s_cbranch_scc1 L_exit
    s_waitcnt vmcnt(0)
    v_cmp_lt_i32 vcc, v36, v35
    s_cbranch_vccnz L_fw_57
L_fok_58:
    buffer_load_dwordx4 a[96:99], v40, s[4:7], s45 offen offset:0 sc1
    buffer_load_dwordx4 a[100:103], v40, s[4:7], s45 offen offset:1024 sc1
    buffer_load_dwordx4 a[104:107], v40, s[4:7], s45 offen offset:2048 sc1
    buffer_load_dwordx4 a[108:111], v40, s[4:7], s45 offen offset:3072 sc1
    buffer_load_dwordx4 a[112:115], v40, s[4:7], s46 offen offset:0 sc1
    buffer_load_dwordx4 a[116:119], v40, s[4:7], s46 offen offset:1024 sc1
    buffer_load_dwordx4 a[120:123], v40, s[4:7], s46 offen offset:2048 sc1
    buffer_load_dwordx4 a[124:127], v40, s[4:7], s46 offen offset:3072 sc1
    buffer_load_dwordx4 a[128:131], v40, s[4:7], s47 offen offset:0 sc1
    buffer_load_dwordx4 a[132:135], v40, s[4:7], s47 offen offset:1024 sc1
    buffer_load_dwordx4 a[136:139], v40, s[4:7], s47 offen offset:2048 sc1
    buffer_load_dwordx4 a[140:143], v40, s[4:7], s47 offen offset:3072 sc1
    s_waitcnt vmcnt(0)
    v_mfma_f32_16x16x32_bf16 v[148:151], a[96:99], a[0:3], 0
    v_mfma_f32_16x16x32_bf16 v[152:155], a[120:123], a[0:3], 0
    v_mfma_f32_16x16x32_bf16 v[148:151], a[100:103], a[4:7], v[148:151]
    v_mfma_f32_16x16x32_bf16 v[152:155], a[124:127], a[4:7], v[152:155]
    v_mfma_f32_16x16x32_bf16 v[148:151], a[104:107], a[8:11], v[148:151]
    v_mfma_f32_16x16x32_bf16 v[152:155], a[128:131], a[8:11], v[152:155]
    v_mfma_f32_16x16x32_bf16 v[148:151], a[108:111], a[12:15], v[148:151]
    v_mfma_f32_16x16x32_bf16 v[152:155], a[132:135], a[12:15], v[152:155]
    v_mfma_f32_16x16x32_bf16 v[148:151], a[112:115], a[16:19], v[148:151]
    v_mfma_f32_16x16x32_bf16 v[152:155], a[136:139], a[16:19], v[152:155]
    v_mfma_f32_16x16x32_bf16 v[148:151], a[116:119], a[20:23], v[148:151]
    v_mfma_f32_16x16x32_bf16 v[152:155], a[140:143], a[20:23], v[152:155]
    v_mfma_f32_16x16x32_bf16 v[156:159], a[96:99], a[24:27], 0
    v_mfma_f32_16x16x32_bf16 v[160:163], a[120:123], a[24:27], 0
    v_mfma_f32_16x16x32_bf16 v[156:159], a[100:103], a[28:31], v[156:159]
    v_mfma_f32_16x16x32_bf16 v[160:163], a[124:127], a[28:31], v[160:163]
    v_cvt_pk_bf16_f32 v48, v148, v149
    v_cvt_pk_bf16_f32 v49, v150, v151
    v_mfma_f32_16x16x32_bf16 v[156:159], a[104:107], a[32:35], v[156:159]
    v_cvt_pk_bf16_f32 v52, v152, v153
    v_cvt_pk_bf16_f32 v53, v154, v155
    v_mfma_f32_16x16x32_bf16 v[160:163], a[128:131], a[32:35], v[160:163]
    ds_write_b64 v24, v[48:49] offset:0
    ds_write_b64 v25, v[52:53] offset:0
    v_mfma_f32_16x16x32_bf16 v[156:159], a[108:111], a[36:39], v[156:159]
    v_mfma_f32_16x16x32_bf16 v[160:163], a[132:135], a[36:39], v[160:163]
    v_mfma_f32_16x16x32_bf16 v[156:159], a[112:115], a[40:43], v[156:159]
    v_mfma_f32_16x16x32_bf16 v[160:163], a[136:139], a[40:43], v[160:163]
    v_mfma_f32_16x16x32_bf16 v[156:159], a[116:119], a[44:47], v[156:159]
    v_mfma_f32_16x16x32_bf16 v[160:163], a[140:143], a[44:47], v[160:163]
    v_mfma_f32_16x16x32_bf16 v[148:151], a[96:99], a[48:51], 0
    v_mfma_f32_16x16x32_bf16 v[152:155], a[120:123], a[48:51], 0
    v_mfma_f32_16x16x32_bf16 v[148:151], a[100:103], a[52:55], v[148:151]
    v_mfma_f32_16x16x32_bf16 v[152:155], a[124:127], a[52:55], v[152:155]
    v_cvt_pk_bf16_f32 v56, v156, v157
    v_cvt_pk_bf16_f32 v57, v158, v159
    v_mfma_f32_16x16x32_bf16 v[148:151], a[104:107], a[56:59], v[148:151]
    v_cvt_pk_bf16_f32 v60, v160, v161
    v_cvt_pk_bf16_f32 v61, v162, v163
    v_mfma_f32_16x16x32_bf16 v[152:155], a[128:131], a[56:59], v[152:155]
    ds_write_b64 v24, v[56:57] offset:6144
    ds_write_b64 v25, v[60:61] offset:6144
    v_mfma_f32_16x16x32_bf16 v[148:151], a[108:111], a[60:63], v[148:151]
    v_mfma_f32_16x16x32_bf16 v[152:155], a[132:135], a[60:63], v[152:155]
    v_mfma_f32_16x16x32_bf16 v[148:151], a[112:115], a[64:67], v[148:151]
    v_mfma_f32_16x16x32_bf16 v[152:155], a[136:139], a[64:67], v[152:155]
    v_mfma_f32_16x16x32_bf16 v[148:151], a[116:119], a[68:71], v[148:151]
    v_mfma_f32_16x16x32_bf16 v[152:155], a[140:143], a[68:71], v[152:155]
    v_mfma_f32_16x16x32_bf16 v[156:159], a[96:99], a[72:75], 0
    v_mfma_f32_16x16x32_bf16 v[160:163], a[120:123], a[72:75], 0
    v_mfma_f32_16x16x32_bf16 v[156:159], a[100:103], a[76:79], v[156:159]
    v_mfma_f32_16x16x32_bf16 v[160:163], a[124:127], a[76:79], v[160:163]
    v_cvt_pk_bf16_f32 v64, v148, v149
    v_cvt_pk_bf16_f32 v65, v150, v151
    v_mfma_f32_16x16x32_bf16 v[156:159], a[104:107], a[80:83], v[156:159]
    v_cvt_pk_bf16_f32 v68, v152, v153
    v_cvt_pk_bf16_f32 v69, v154, v155
    v_mfma_f32_16x16x32_bf16 v[160:163], a[128:131], a[80:83], v[160:163]
    ds_write_b64 v24, v[64:65] offset:12288
    ds_write_b64 v25, v[68:69] offset:12288
    v_mfma_f32_16x16x32_bf16 v[156:159], a[108:111], a[84:87], v[156:159]
    v_mfma_f32_16x16x32_bf16 v[160:163], a[132:135], a[84:87], v[160:163]
    v_mfma_f32_16x16x32_bf16 v[156:159], a[112:115], a[88:91], v[156:159]
    v_mfma_f32_16x16x32_bf16 v[160:163], a[136:139], a[88:91], v[160:163]
    v_mfma_f32_16x16x32_bf16 v[156:159], a[116:119], a[92:95], v[156:159]
    v_mfma_f32_16x16x32_bf16 v[160:163], a[140:143], a[92:95], v[160:163]
    s_nop 4
    v_cvt_pk_bf16_f32 v72, v156, v157
    v_cvt_pk_bf16_f32 v73, v158, v159
    s_nop 0
    v_cvt_pk_bf16_f32 v76, v160, v161
    v_cvt_pk_bf16_f32 v77, v162, v163
    ds_write_b64 v24, v[72:73] offset:18432
    ds_write_b64 v25, v[76:77] offset:18432
    s_add_u32 s56, s37, 2
    s_and_b32 s55, s56, 7
    s_mul_i32 s55, s55, 172032
    s_add_u32 s55, s55, 319488
    s_add_u32 s45, s38, s55
    s_add_u32 s46, s45, 4096
    s_add_u32 s47, s45, 8192
    s_add_u32 s56, s37, -2
    s_and_b32 s55, s56, 3
    s_mul_i32 s55, s55, 24576
    v_add_u32 v26, s55, v22
    v_add_u32 v27, s55, v23
    s_and_b32 s55, s56, 1
    s_mul_i32 s55, s55, 12288
    v_add_u32 v29, s55, v28
    s_add_u32 s56, s37, -1
    s_and_b32 s55, s56, 7
    s_mul_i32 s55, s55, 172032
    s_add_u32 s55, s55, 208896
    s_add_u32 s48, s38, s55
    s_and_b32 s55, s56, 1
    s_add_u32 m0, s55, 12
    s_add_u32 s56, s56, 1
    v_add_u32 v35, s37, v34
    v_writelane_b32 v35, s56, m0
    s_mul_i32 s55, s55, 12288
    s_add_u32 m0, s54, s55
    buffer_load_dword v36, v33, s[4:7], s38 offen sc1
    s_waitcnt vmcnt(0)
    v_cmp_lt_i32 vcc, v36, v35
    s_cbranch_vccz L_fok_60
L_fw_59:
    buffer_load_dword v36, v33, s[4:7], s38 offen sc1
    s_sub_u32 s36, s36, 1
    s_cbranch_scc1 L_exit
    s_waitcnt vmcnt(0)
    v_cmp_lt_i32 vcc, v36, v35
    s_cbranch_vccnz L_fw_59
L_fok_60:
    buffer_load_dwordx4 a[96:99], v40, s[4:7], s45 offen offset:0 sc1
    buffer_load_dwordx4 a[100:103], v40, s[4:7], s45 offen offset:1024 sc1
    buffer_load_dwordx4 a[104:107], v40, s[4:7], s45 offen offset:2048 sc1
    buffer_load_dwordx4 a[108:111], v40, s[4:7], s45 offen offset:3072 sc1
    buffer_load_dwordx4 a[112:115], v40, s[4:7], s46 offen offset:0 sc1
    buffer_load_dwordx4 a[116:119], v40, s[4:7], s46 offen offset:1024 sc1
    buffer_load_dwordx4 a[120:123], v40, s[4:7], s46 offen offset:2048 sc1
    buffer_load_dwordx4 a[124:127], v40, s[4:7], s46 offen offset:3072 sc1
    buffer_load_dwordx4 a[128:131], v40, s[4:7], s47 offen offset:0 sc1
    buffer_load_dwordx4 a[132:135], v40, s[4:7], s47 offen offset:1024 sc1
    buffer_load_dwordx4 a[136:139], v40, s[4:7], s47 offen offset:2048 sc1
    buffer_load_dwordx4 a[140:143], v40, s[4:7], s47 offen offset:3072 sc1
    s_add_u32 s37, s37, 1
    s_and_b32 s55, s37, 3
    s_mul_i32 s56, s55, 40960
    s_add_u32 s43, s38, s56
    s_mul_i32 s41, s55, 491520
    s_xor_b32 s55, s55, 2
    s_mul_i32 s42, s55, 491520
    v_mov_b32 v47, v24
    s_add_u32 s56, s37, 1
    v_mov_b32 v107, s56
    s_and_b32 s55, s56, 3
    s_mul_i32 s55, s55, 24576
    v_add_u32 v24, s55, v20
    v_add_u32 v25, s55, v21
    s_add_u32 s56, s37, -3
    s_and_b32 s55, s56, 7
    s_mul_i32 s55, s55, 655360
    s_add_u32 s49, s55, 2097152
    s_add_u32 s50, s49, 32768
    s_add_u32 s56, s37, -5
    s_and_b32 s55, s56, 7
    s_mul_i32 s55, s55, 655360
    s_add_u32 s51, s55, 2097152
    s_mul_i32 s52, s56, 81920
    v_pk_mul_f32 v[148:149], v[210:211], v[210:211]
    v_pk_mul_f32 v[150:151], v[210:211], v[210:211]
    v_pk_mul_f32 v[152:153], v[210:211], v[210:211]
    v_pk_mul_f32 v[154:155], v[210:211], v[210:211]
    v_pk_mul_f32 v[156:157], v[210:211], v[210:211]
    v_pk_mul_f32 v[158:159], v[210:211], v[210:211]
    v_pk_mul_f32 v[160:161], v[210:211], v[210:211]
    v_pk_mul_f32 v[162:163], v[210:211], v[210:211]
    v_pk_mul_f32 v[116:117], v[210:211], v[210:211]
    v_pk_mul_f32 v[118:119], v[210:211], v[210:211]
    v_pk_mul_f32 v[120:121], v[210:211], v[210:211]
    v_pk_mul_f32 v[122:123], v[210:211], v[210:211]
    v_pk_mul_f32 v[124:125], v[210:211], v[210:211]
    v_pk_mul_f32 v[126:127], v[210:211], v[210:211]
    v_pk_mul_f32 v[128:129], v[210:211], v[210:211]
    v_pk_mul_f32 v[130:131], v[210:211], v[210:211]
    v_pk_mul_f32 v[132:133], v[210:211], v[210:211]
    v_pk_mul_f32 v[134:135], v[210:211], v[210:211]
L_wo_loop_s:
    buffer_load_dwordx4 v[136:139], v44, s[4:7], s43 offen offset:0 sc1
    buffer_load_dwordx4 v[140:143], v44, s[4:7], s43 offen offset:1024 sc1
    buffer_load_dwordx4 v[144:147], v44, s[4:7], s43 offen offset:2048 sc1
L_vm_61:
    buffer_load_dwordx4 v[136:139], v44, s[4:7], s43 offen offset:0 sc1
    buffer_load_dwordx4 v[140:143], v44, s[4:7], s43 offen offset:1024 sc1
    buffer_load_dwordx4 v[144:147], v44, s[4:7], s43 offen offset:2048 sc1
    s_sub_u32 s36, s36, 1
    s_cbranch_scc1 L_exit
    s_waitcnt vmcnt(3)
    v_max3_u32 v41, v136, v137, v138
    v_max3_u32 v42, v139, v140, v141
    v_max3_u32 v41, v41, v142, v143
    v_max3_u32 v42, v42, v144, v145
    v_max3_u32 v41, v41, v146, v147
    v_max_u32 v41, v41, v42
    v_cmp_eq_u32 vcc, -1, v41
    s_cbranch_vccnz L_vm_61
    v_smfmac_f32_16x16x64_bf16 v[148:151], v[136:139], a[0:7], v10
    v_smfmac_f32_16x16x64_bf16 v[148:151], v[140:143], a[8:15], v10
    v_smfmac_f32_16x16x64_bf16 v[148:151], v[144:147], a[16:23], v10
    v_smfmac_f32_16x16x64_bf16 v[152:155], v[136:139], a[24:31], v10
    v_smfmac_f32_16x16x64_bf16 v[152:155], v[140:143], a[32:39], v10
    v_smfmac_f32_16x16x64_bf16 v[152:155], v[144:147], a[40:47], v10
    v_smfmac_f32_16x16x64_bf16 v[156:159], v[136:139], a[48:55], v10
    v_smfmac_f32_16x16x64_bf16 v[156:159], v[140:143], a[56:63], v10
    v_smfmac_f32_16x16x64_bf16 v[156:159], v[144:147], a[64:71], v10
    v_smfmac_f32_16x16x64_bf16 v[160:163], v[136:139], a[72:79], v10
    v_smfmac_f32_16x16x64_bf16 v[160:163], v[140:143], a[80:87], v10
    v_smfmac_f32_16x16x64_bf16 v[160:163], v[144:147], a[88:95], v10
    buffer_load_dwordx4 v[92:95], v38, s[4:7], s43 offen offset:0 sc1
    buffer_load_dword v104, v39, s[4:7], s43 offen offset:0 sc1
    buffer_load_dwordx4 v[96:99], v38, s[4:7], s43 offen offset:1280 sc1
    buffer_load_dword v105, v39, s[4:7], s43 offen offset:1280 sc1
    buffer_load_dwordx4 v[100:103], v38, s[4:7], s43 offen offset:2560 sc1
    buffer_load_dword v106, v39, s[4:7], s43 offen offset:2560 sc1
    v_pk_add_f32 v[148:149], v[148:149], v[150:151]
    v_cvt_pk_bf16_f32 v50, v148, v149
    v_cvt_pk_bf16_f32 v54, v148, v149
    ds_write_b32 v47, v50 offset:8
    v_pk_add_f32 v[152:153], v[152:153], v[154:155]
    v_cvt_pk_bf16_f32 v58, v152, v153
    v_cvt_pk_bf16_f32 v62, v152, v153
    ds_write_b32 v47, v58 offset:6152
    v_pk_add_f32 v[156:157], v[156:157], v[158:159]
    v_cvt_pk_bf16_f32 v66, v156, v157
    v_cvt_pk_bf16_f32 v70, v156, v157
    ds_write_b32 v47, v66 offset:12296
    v_pk_add_f32 v[160:161], v[160:161], v[162:163]
    v_cvt_pk_bf16_f32 v74, v160, v161
    v_cvt_pk_bf16_f32 v78, v160, v161
    ds_write_b32 v47, v74 offset:18440
    s_cmp_eq_u32 s37, 63
    s_cbranch_scc1 L_wo_tail_s
    buffer_load_dwordx4 v[92:95], v38, s[4:7], s43 offen offset:0 sc1
    buffer_load_dword v104, v39, s[4:7], s43 offen offset:0 sc1
    buffer_load_dwordx4 v[96:99], v38, s[4:7], s43 offen offset:1280 sc1
    buffer_load_dword v105, v39, s[4:7], s43 offen offset:1280 sc1
    buffer_load_dwordx4 v[100:103], v38, s[4:7], s43 offen offset:2560 sc1
    buffer_load_dword v106, v39, s[4:7], s43 offen offset:2560 sc1
L_sc_62:
    s_waitcnt vmcnt(6)
    v_pk_add_f32 v[236:237], v[92:93], v[96:97]
    v_pk_add_f32 v[238:239], v[94:95], v[98:99]
    v_add_f32 v43, v104, v105
    v_pk_add_f32 v[236:237], v[236:237], v[100:101]
    v_pk_add_f32 v[238:239], v[238:239], v[102:103]
    v_add_f32 v43, v43, v106
    v_max3_f32 v41, v236, v237, v238
    v_max3_f32 v41, v41, v239, v43
    v_pk_add_f32 v[242:243], v[236:237], v[238:239]
    v_add_f32 v242, v242, v43
    v_max_f32_dpp v42, v41, v41 quad_perm:[2,3,0,1] row_mask:0xf bank_mask:0xf
    v_max_f32_dpp v41, v41, v41 quad_perm:[2,3,0,1] row_mask:0xf bank_mask:0xf
    v_cmp_u_f32 vcc, v242, v243
    s_nop 0
    v_permlane16_swap_b32 v41, v42
    v_max_f32 v41, v41, v42
    v_mov_b32 v42, v41
    s_cbranch_vccnz L_sp_63
L_sg_64:
    s_nop 0
    v_permlane32_swap_b32 v41, v42
    v_max_f32 v41, v41, v42
    v_mul_f32 v242, 0xbdd53b95, v41
    v_pk_fma_f32 v[236:237], v[236:237], v[240:241], v[242:243] op_sel_hi:[1,1,0]
    v_pk_fma_f32 v[238:239], v[238:239], v[240:241], v[242:243] op_sel_hi:[1,1,0]
    v_fma_f32 v43, v43, v240, v242
    v_exp_f32 v236, v236
    v_exp_f32 v237, v237
    v_exp_f32 v238, v238
    v_exp_f32 v239, v239
    v_exp_f32 v43, v43
    v_cvt_pk_bf16_f32 v80, v236, v237
    v_cvt_pk_bf16_f32 v82, v238, v239
    v_cvt_pk_bf16_f32 v81, v43, 0
    v_cvt_pk_bf16_f32 v83, v43, 0
    s_nop 1
    v_smfmac_f32_16x16x64_bf16 v[116:119], v[80:83], v[84:91], v11
    v_smfmac_f32_16x16x64_bf16 v[120:123], v[80:83], v[48:55], v11
    v_smfmac_f32_16x16x64_bf16 v[124:127], v[80:83], v[56:63], v11
    v_smfmac_f32_16x16x64_bf16 v[128:131], v[80:83], v[64:71], v11
    v_smfmac_f32_16x16x64_bf16 v[132:135], v[80:83], v[72:79], v11
    v_pk_add_f32 v[116:117], v[116:117], v[118:119]
    v_rcp_f32 v116, v116
    v_rcp_f32 v117, v117
    v_pk_add_f32 v[120:121], v[120:121], v[122:123]
    v_pk_add_f32 v[124:125], v[124:125], v[126:127]
    v_pk_add_f32 v[128:129], v[128:129], v[130:131]
    s_nop 1
    v_pk_add_f32 v[132:133], v[132:133], v[134:135]
    v_pk_mul_f32 v[120:121], v[120:121], v[116:117]
    v_cvt_pk_bf16_f32 v236, v120, v121
    v_pk_mul_f32 v[124:125], v[124:125], v[116:117]
    v_cvt_pk_bf16_f32 v237, v124, v125
    ds_write2st64_b32 v18, v236, v237 offset0:0 offset1:1
    v_pk_mul_f32 v[128:129], v[128:129], v[116:117]
    v_cvt_pk_bf16_f32 v238, v128, v129
    v_pk_mul_f32 v[132:133], v[132:133], v[116:117]
    v_cvt_pk_bf16_f32 v239, v132, v133
    ds_write2st64_b32 v18, v238, v239 offset0:2 offset1:3
    s_waitcnt lgkmcnt(0)
    s_barrier
    ds_read_b64_tr_b16 v[80:81], v19
    ds_read_b64_tr_b16 v[82:83], v19 offset:128
    s_waitcnt lgkmcnt(0)
    v_mfma_f32_16x16x32_bf16 v[172:175], v[110:113], v[80:83], 0
    v_mfma_f32_16x16x32_bf16 v[176:179], v[108:111], v[80:83], 0
    buffer_store_dword v107, v244, s[4:7], s38 offen sc1
    s_nop 3
    v_cvt_pk_bf16_f32 v236, v172, v173
    v_cvt_pk_bf16_f32 v237, v174, v175
    s_nop 0
    v_cvt_pk_bf16_f32 v238, v176, v177
    v_cvt_pk_bf16_f32 v239, v178, v179
    buffer_store_dwordx4 v[236:239], v45, s[4:7], s41 offen sc1
    buffer_store_dwordx4 v[236:239], v14, s[4:7], s41 offen sc1
    v_mfma_f32_16x16x32_bf16 v[148:151], a[96:99], a[0:3], 0
    buffer_load_dword v36, v33, s[4:7], s38 offen sc1
    v_mfma_f32_16x16x32_bf16 v[152:155], a[120:123], a[0:3], 0
    s_add_u32 s56, s37, 2
    v_mfma_f32_16x16x32_bf16 v[148:151], a[100:103], a[4:7], v[148:151]
    buffer_load_dwordx4 v[228:231], v31, s[4:7], s51 offen sc1
    buffer_load_dwordx4 v[232:235], v31, s[4:7], s51 offen offset:1024 sc1
    v_mfma_f32_16x16x32_bf16 v[152:155], a[124:127], a[4:7], v[152:155]
    s_and_b32 s55, s56, 7
    v_mfma_f32_16x16x32_bf16 v[148:151], a[104:107], a[8:11], v[148:151]
    s_mul_i32 s55, s55, 172032
    v_mfma_f32_16x16x32_bf16 v[152:155], a[128:131], a[8:11], v[152:155]
    buffer_store_dwordx4 v[220:223], v30, s[4:7], s49 offen sc1
    buffer_store_dwordx4 v[224:227], v30, s[4:7], s50 offen sc1
    v_mfma_f32_16x16x32_bf16 v[148:151], a[108:111], a[12:15], v[148:151]
    s_add_u32 s55, s55, 319488
    v_mfma_f32_16x16x32_bf16 v[152:155], a[132:135], a[12:15], v[152:155]
    s_add_u32 s45, s38, s55
    v_mfma_f32_16x16x32_bf16 v[148:151], a[112:115], a[16:19], v[148:151]
    buffer_store_dwordx4 v[168:171], v14, s[4:7], s42 offen sc1
    buffer_store_dword v168, v46, s[4:7], s42 offen sc1
    v_mfma_f32_16x16x32_bf16 v[152:155], a[136:139], a[16:19], v[152:155]
    s_add_u32 s46, s45, 4096
    v_mfma_f32_16x16x32_bf16 v[148:151], a[116:119], a[20:23], v[148:151]
    s_add_u32 s47, s45, 8192
    v_mfma_f32_16x16x32_bf16 v[152:155], a[140:143], a[20:23], v[152:155]
    s_add_u32 s56, s37, -2
    v_mfma_f32_16x16x32_bf16 v[156:159], a[96:99], a[24:27], 0
    s_and_b32 s55, s56, 3
    v_mfma_f32_16x16x32_bf16 v[160:163], a[120:123], a[24:27], 0
    s_mul_i32 s55, s55, 24576
    v_mfma_f32_16x16x32_bf16 v[156:159], a[100:103], a[28:31], v[156:159]
    v_add_u32 v26, s55, v22
    v_mfma_f32_16x16x32_bf16 v[160:163], a[124:127], a[28:31], v[160:163]
    v_cvt_pk_bf16_f32 v48, v148, v149
    v_cvt_pk_bf16_f32 v49, v150, v151
    v_mfma_f32_16x16x32_bf16 v[156:159], a[104:107], a[32:35], v[156:159]
    v_cvt_pk_bf16_f32 v52, v152, v153
    v_cvt_pk_bf16_f32 v53, v154, v155
    v_mfma_f32_16x16x32_bf16 v[160:163], a[128:131], a[32:35], v[160:163]
    ds_write_b64 v24, v[48:49] offset:0
    ds_write_b64 v25, v[52:53] offset:0
    v_mfma_f32_16x16x32_bf16 v[156:159], a[108:111], a[36:39], v[156:159]
    v_add_u32 v27, s55, v23
    v_mfma_f32_16x16x32_bf16 v[160:163], a[132:135], a[36:39], v[160:163]
    s_and_b32 s55, s56, 1
    v_mfma_f32_16x16x32_bf16 v[156:159], a[112:115], a[40:43], v[156:159]
    s_mul_i32 s55, s55, 12288
    v_mfma_f32_16x16x32_bf16 v[160:163], a[136:139], a[40:43], v[160:163]
    v_add_u32 v29, s55, v28
    v_mfma_f32_16x16x32_bf16 v[156:159], a[116:119], a[44:47], v[156:159]
    s_add_u32 s56, s37, -1
    v_mfma_f32_16x16x32_bf16 v[160:163], a[140:143], a[44:47], v[160:163]
    s_and_b32 s55, s56, 7
    v_mfma_f32_16x16x32_bf16 v[148:151], a[96:99], a[48:51], 0
    s_mul_i32 s55, s55, 172032
    v_mfma_f32_16x16x32_bf16 v[152:155], a[120:123], a[48:51], 0
    s_add_u32 s55, s55, 208896
    v_mfma_f32_16x16x32_bf16 v[148:151], a[100:103], a[52:55], v[148:151]
    s_add_u32 s48, s38, s55
    v_mfma_f32_16x16x32_bf16 v[152:155], a[124:127], a[52:55], v[152:155]
    v_cvt_pk_bf16_f32 v56, v156, v157
    v_cvt_pk_bf16_f32 v57, v158, v159
    v_mfma_f32_16x16x32_bf16 v[148:151], a[104:107], a[56:59], v[148:151]
    v_cvt_pk_bf16_f32 v60, v160, v161
    v_cvt_pk_bf16_f32 v61, v162, v163
    v_mfma_f32_16x16x32_bf16 v[152:155], a[128:131], a[56:59], v[152:155]
    ds_write_b64 v24, v[56:57] offset:6144
    ds_write_b64 v25, v[60:61] offset:6144
    v_mfma_f32_16x16x32_bf16 v[148:151], a[108:111], a[60:63], v[148:151]
    s_and_b32 s55, s56, 1
    v_mfma_f32_16x16x32_bf16 v[152:155], a[132:135], a[60:63], v[152:155]
    s_add_u32 m0, s55, 12
    v_mfma_f32_16x16x32_bf16 v[148:151], a[112:115], a[64:67], v[148:151]
    s_add_u32 s56, s56, 1
    v_mfma_f32_16x16x32_bf16 v[152:155], a[136:139], a[64:67], v[152:155]
    v_add_u32 v35, s37, v34
    v_mfma_f32_16x16x32_bf16 v[148:151], a[116:119], a[68:71], v[148:151]
    v_writelane_b32 v35, s56, m0
    v_mfma_f32_16x16x32_bf16 v[152:155], a[140:143], a[68:71], v[152:155]
    s_mul_i32 s55, s55, 12288
    v_mfma_f32_16x16x32_bf16 v[156:159], a[96:99], a[72:75], 0
    s_add_u32 m0, s54, s55
    v_mfma_f32_16x16x32_bf16 v[160:163], a[120:123], a[72:75], 0
    v_mfma_f32_16x16x32_bf16 v[156:159], a[100:103], a[76:79], v[156:159]
    v_mfma_f32_16x16x32_bf16 v[160:163], a[124:127], a[76:79], v[160:163]
    v_cvt_pk_bf16_f32 v64, v148, v149
    v_cvt_pk_bf16_f32 v65, v150, v151
    v_mfma_f32_16x16x32_bf16 v[156:159], a[104:107], a[80:83], v[156:159]
    v_cvt_pk_bf16_f32 v68, v152, v153
    v_cvt_pk_bf16_f32 v69, v154, v155
    v_mfma_f32_16x16x32_bf16 v[160:163], a[128:131], a[80:83], v[160:163]
    ds_write_b64 v24, v[64:65] offset:12288
    ds_write_b64 v25, v[68:69] offset:12288
    v_mfma_f32_16x16x32_bf16 v[156:159], a[108:111], a[84:87], v[156:159]
    v_mfma_f32_16x16x32_bf16 v[160:163], a[132:135], a[84:87], v[160:163]
    v_mfma_f32_16x16x32_bf16 v[156:159], a[112:115], a[88:91], v[156:159]
    v_mfma_f32_16x16x32_bf16 v[160:163], a[136:139], a[88:91], v[160:163]
    v_mfma_f32_16x16x32_bf16 v[156:159], a[116:119], a[92:95], v[156:159]
    v_mfma_f32_16x16x32_bf16 v[160:163], a[140:143], a[92:95], v[160:163]
    s_nop 4
    v_cvt_pk_bf16_f32 v72, v156, v157
    v_cvt_pk_bf16_f32 v73, v158, v159
    s_nop 0
    v_cvt_pk_bf16_f32 v76, v160, v161
    v_cvt_pk_bf16_f32 v77, v162, v163
    ds_write_b64 v24, v[72:73] offset:18432
    ds_write_b64 v25, v[76:77] offset:18432
    s_waitcnt vmcnt(6)
    v_cmp_lt_i32 vcc, v36, v35
    s_cbranch_vccz L_fok_67
L_fw_66:
    buffer_load_dword v36, v33, s[4:7], s38 offen sc1
    s_sub_u32 s36, s36, 1
    s_cbranch_scc1 L_exit
    s_waitcnt vmcnt(0)
    v_cmp_lt_i32 vcc, v36, v35
    s_cbranch_vccnz L_fw_66
L_fok_67:
    buffer_load_dwordx4 v37, s[4:7], s48 offen offset:0 sc1 lds
    buffer_load_dwordx4 v37, s[4:7], s48 offen offset:1024 sc1 lds
    buffer_load_dwordx4 v37, s[4:7], s48 offen offset:2048 sc1 lds
    s_cmp_lt_u32 s37, 5
    s_cbranch_scc1 L_g_65
    s_waitcnt vmcnt(7)
    v_pk_add_f32 v[228:229], v[228:229], v[232:233]
    v_pk_add_f32 v[230:231], v[230:231], v[234:235]
    s_nop 1
    v_permlane32_swap_b32 v228, v230
    v_permlane32_swap_b32 v229, v231
    v_pk_add_f32 v[228:229], v[228:229], v[230:231]
    s_nop 1
    v_permlane16_swap_b32 v228, v229
    v_add_f32 v228, v228, v229
    v_cvt_pk_bf16_f32 v228, v228, v228
    buffer_store_short v228, v32, s[28:31], s52 offen
L_g_65:
    ds_read_b128 v[204:207], v26 offset:0
    ds_read_b128 v[180:183], v29 offset:0
    ds_read_b128 v[184:187], v29 offset:1024
    ds_read_b64 v[208:209], v27 offset:0
    ds_read_b128 v[188:191], v29 offset:2048
    ds_read_b128 v[212:215], v26 offset:1536
    ds_read_b128 v[192:195], v29 offset:3072
    ds_read_b128 v[196:199], v29 offset:4096
    ds_read_b64 v[216:217], v27 offset:1536
    ds_read_b128 v[200:203], v29 offset:5120
    buffer_load_dwordx4 a[96:99], v40, s[4:7], s45 offen offset:0 sc1
    buffer_load_dwordx4 a[100:103], v40, s[4:7], s45 offen offset:1024 sc1
    buffer_load_dwordx4 a[104:107], v40, s[4:7], s45 offen offset:2048 sc1
    s_add_u32 s37, s37, 1
    s_and_b32 s55, s37, 3
    s_mul_i32 s56, s55, 40960
    s_add_u32 s43, s38, s56
    s_mul_i32 s41, s55, 491520
    s_xor_b32 s55, s55, 2
    s_mul_i32 s42, s55, 491520
    v_mov_b32 v47, v24
    s_add_u32 s56, s37, 1
    v_mov_b32 v107, s56
    s_and_b32 s55, s56, 3
    s_waitcnt lgkmcnt(5)
    v_mfma_f32_16x16x32_bf16 v[220:223], v[180:183], v[204:207], 0
    v_mfma_f32_16x16x32_bf16 v[224:227], v[184:187], v[204:207], 0
    v_mfma_f32_16x16x32_bf16 v[224:227], v[188:191], v[208:211], v[224:227]
    ds_read_b128 v[204:207], v26 offset:3072
    ds_read_b128 v[180:183], v29 offset:6144
    ds_read_b128 v[184:187], v29 offset:7168
    ds_read_b64 v[208:209], v27 offset:3072
    ds_read_b128 v[188:191], v29 offset:8192
    buffer_load_dwordx4 a[108:111], v40, s[4:7], s45 offen offset:3072 sc1
    buffer_load_dwordx4 a[112:115], v40, s[4:7], s46 offen offset:0 sc1
    buffer_load_dwordx4 a[116:119], v40, s[4:7], s46 offen offset:1024 sc1
    s_mul_i32 s55, s55, 24576
    v_add_u32 v24, s55, v20
    v_add_u32 v25, s55, v21
    s_add_u32 s56, s37, -3
    s_and_b32 s55, s56, 7
    s_mul_i32 s55, s55, 655360
    s_add_u32 s49, s55, 2097152
    s_add_u32 s50, s49, 32768
    s_add_u32 s56, s37, -5
    s_and_b32 s55, s56, 7
    s_mul_i32 s55, s55, 655360
    s_waitcnt lgkmcnt(5)
    v_mfma_f32_16x16x32_bf16 v[220:223], v[192:195], v[212:215], v[220:223]
    v_mfma_f32_16x16x32_bf16 v[224:227], v[196:199], v[212:215], v[224:227]
    v_mfma_f32_16x16x32_bf16 v[224:227], v[200:203], v[216:219], v[224:227]
    ds_read_b128 v[212:215], v26 offset:4608
    ds_read_b128 v[192:195], v29 offset:9216
    ds_read_b128 v[196:199], v29 offset:10240
    ds_read_b64 v[216:217], v27 offset:4608
    ds_read_b128 v[200:203], v29 offset:11264
    buffer_load_dwordx4 a[120:123], v40, s[4:7], s46 offen offset:2048 sc1
    buffer_load_dwordx4 a[124:127], v40, s[4:7], s46 offen offset:3072 sc1
    buffer_load_dwordx4 a[128:131], v40, s[4:7], s47 offen offset:0 sc1
    s_add_u32 s51, s55, 2097152
    s_mul_i32 s52, s56, 81920
    v_pk_mul_f32 v[148:149], v[210:211], v[210:211]
    v_pk_mul_f32 v[150:151], v[210:211], v[210:211]
    v_pk_mul_f32 v[152:153], v[210:211], v[210:211]
    v_pk_mul_f32 v[154:155], v[210:211], v[210:211]
    v_pk_mul_f32 v[156:157], v[210:211], v[210:211]
    v_pk_mul_f32 v[158:159], v[210:211], v[210:211]
    v_pk_mul_f32 v[160:161], v[210:211], v[210:211]
    v_pk_mul_f32 v[162:163], v[210:211], v[210:211]
    v_pk_mul_f32 v[116:117], v[210:211], v[210:211]
    s_waitcnt lgkmcnt(5)
    v_mfma_f32_16x16x32_bf16 v[220:223], v[180:183], v[204:207], v[220:223]
    v_mfma_f32_16x16x32_bf16 v[224:227], v[184:187], v[204:207], v[224:227]
    v_mfma_f32_16x16x32_bf16 v[224:227], v[188:191], v[208:211], v[224:227]
    buffer_load_dwordx4 a[132:135], v40, s[4:7], s47 offen offset:1024 sc1
    buffer_load_dwordx4 a[136:139], v40, s[4:7], s47 offen offset:2048 sc1
    buffer_load_dwordx4 a[140:143], v40, s[4:7], s47 offen offset:3072 sc1
    v_pk_mul_f32 v[118:119], v[210:211], v[210:211]
    v_pk_mul_f32 v[120:121], v[210:211], v[210:211]
    v_pk_mul_f32 v[122:123], v[210:211], v[210:211]
    v_pk_mul_f32 v[124:125], v[210:211], v[210:211]
    v_pk_mul_f32 v[126:127], v[210:211], v[210:211]
    v_pk_mul_f32 v[128:129], v[210:211], v[210:211]
    v_pk_mul_f32 v[130:131], v[210:211], v[210:211]
    v_pk_mul_f32 v[132:133], v[210:211], v[210:211]
    v_pk_mul_f32 v[134:135], v[210:211], v[210:211]
    s_waitcnt lgkmcnt(0)
    v_mfma_f32_16x16x32_bf16 v[220:223], v[192:195], v[212:215], v[220:223]
    v_mfma_f32_16x16x32_bf16 v[224:227], v[196:199], v[212:215], v[224:227]
    v_mfma_f32_16x16x32_bf16 v[224:227], v[200:203], v[216:219], v[224:227]
    s_branch L_wo_loop_s
L_wo_tail_s:
    buffer_store_dwordx4 v[220:223], v30, s[4:7], s49 offen sc1
    buffer_store_dwordx4 v[224:227], v30, s[4:7], s50 offen sc1
    s_waitcnt vmcnt(0) lgkmcnt(0)
    s_barrier
    s_add_u32 s56, s37, -1
    s_and_b32 s55, s56, 7
    s_mul_i32 s55, s55, 172032
    s_add_u32 s55, s55, 208896
    s_add_u32 s48, s38, s55
    s_and_b32 s55, s56, 1
    s_add_u32 m0, s55, 12
    s_add_u32 s56, s56, 1
    v_mov_b32 v35, -16
    v_writelane_b32 v35, s56, m0
    s_mul_i32 s55, s55, 12288
    s_add_u32 m0, s54, s55
    buffer_load_dword v36, v33, s[4:7], s38 offen sc1
    s_add_u32 s56, s37, -2
    s_and_b32 s55, s56, 3
    s_mul_i32 s55, s55, 24576
    v_add_u32 v26, s55, v22
    v_add_u32 v27, s55, v23
    s_and_b32 s55, s56, 1
    s_mul_i32 s55, s55, 12288
    v_add_u32 v29, s55, v28
    s_add_u32 s56, s37, -2
    s_and_b32 s55, s56, 7
    s_mul_i32 s55, s55, 655360
    s_add_u32 s49, s55, 2097152
    s_add_u32 s50, s49, 32768
    ds_read_b128 v[204:207], v26 offset:0
    ds_read_b128 v[180:183], v29 offset:0
    ds_read_b128 v[184:187], v29 offset:1024
    ds_read_b64 v[208:209], v27 offset:0
    ds_read_b128 v[188:191], v29 offset:2048
    ds_read_b128 v[212:215], v26 offset:1536
    ds_read_b128 v[192:195], v29 offset:3072
    ds_read_b128 v[196:199], v29 offset:4096
    ds_read_b64 v[216:217], v27 offset:1536
    ds_read_b128 v[200:203], v29 offset:5120
    s_waitcnt lgkmcnt(5)
    v_mfma_f32_16x16x32_bf16 v[220:223], v[180:183], v[204:207], 0
    v_mfma_f32_16x16x32_bf16 v[224:227], v[184:187], v[204:207], 0
    v_mfma_f32_16x16x32_bf16 v[224:227], v[188:191], v[208:211], v[224:227]
    ds_read_b128 v[204:207], v26 offset:3072
    ds_read_b128 v[180:183], v29 offset:6144
    ds_read_b128 v[184:187], v29 offset:7168
    ds_read_b64 v[208:209], v27 offset:3072
    ds_read_b128 v[188:191], v29 offset:8192
    s_waitcnt lgkmcnt(5)
    v_mfma_f32_16x16x32_bf16 v[220:223], v[192:195], v[212:215], v[220:223]
    v_mfma_f32_16x16x32_bf16 v[224:227], v[196:199], v[212:215], v[224:227]
    v_mfma_f32_16x16x32_bf16 v[224:227], v[200:203], v[216:219], v[224:227]
    ds_read_b128 v[212:215], v26 offset:4608
    ds_read_b128 v[192:195], v29 offset:9216
    ds_read_b128 v[196:199], v29 offset:10240
    ds_read_b64 v[216:217], v27 offset:4608
    ds_read_b128 v[200:203], v29 offset:11264
    s_waitcnt lgkmcnt(5)
    v_mfma_f32_16x16x32_bf16 v[220:223], v[180:183], v[204:207], v[220:223]
    v_mfma_f32_16x16x32_bf16 v[224:227], v[184:187], v[204:207], v[224:227]
    v_mfma_f32_16x16x32_bf16 v[224:227], v[188:191], v[208:211], v[224:227]
    s_waitcnt lgkmcnt(0)
    v_mfma_f32_16x16x32_bf16 v[220:223], v[192:195], v[212:215], v[220:223]
    v_mfma_f32_16x16x32_bf16 v[224:227], v[196:199], v[212:215], v[224:227]
    v_mfma_f32_16x16x32_bf16 v[224:227], v[200:203], v[216:219], v[224:227]
    s_nop 0
    buffer_store_dwordx4 v[220:223], v30, s[4:7], s49 offen sc1
    s_nop 5
    buffer_store_dwordx4 v[224:227], v30, s[4:7], s50 offen sc1
    s_waitcnt vmcnt(2)
    v_cmp_lt_i32 vcc, v36, v35
    s_cbranch_vccz L_fok_69
L_fw_68:
    buffer_load_dword v36, v33, s[4:7], s38 offen sc1
    s_sub_u32 s36, s36, 1
    s_cbranch_scc1 L_exit
    s_waitcnt vmcnt(0)
    v_cmp_lt_i32 vcc, v36, v35
    s_cbranch_vccnz L_fw_68
L_fok_69:
    buffer_load_dwordx4 v37, s[4:7], s48 offen offset:0 sc1 lds
    buffer_load_dwordx4 v37, s[4:7], s48 offen offset:1024 sc1 lds
    buffer_load_dwordx4 v37, s[4:7], s48 offen offset:2048 sc1 lds
    s_waitcnt vmcnt(0) lgkmcnt(0)
    s_barrier
    s_add_u32 s56, s37, 0
    s_and_b32 s55, s56, 7
    s_mul_i32 s55, s55, 172032
    s_add_u32 s55, s55, 208896
    s_add_u32 s48, s38, s55
    s_and_b32 s55, s56, 1
    s_add_u32 m0, s55, 12
    s_add_u32 s56, s56, 1
    v_mov_b32 v35, -16
    v_writelane_b32 v35, s56, m0
    s_mul_i32 s55, s55, 12288
    s_add_u32 m0, s54, s55
    buffer_load_dword v36, v33, s[4:7], s38 offen sc1
    s_add_u32 s56, s37, -1
    s_and_b32 s55, s56, 3
    s_mul_i32 s55, s55, 24576
    v_add_u32 v26, s55, v22
    v_add_u32 v27, s55, v23
    s_and_b32 s55, s56, 1
    s_mul_i32 s55, s55, 12288
    v_add_u32 v29, s55, v28
    s_add_u32 s56, s37, -1
    s_and_b32 s55, s56, 7
    s_mul_i32 s55, s55, 655360
    s_add_u32 s49, s55, 2097152
    s_add_u32 s50, s49, 32768
    ds_read_b128 v[204:207], v26 offset:0
    ds_read_b128 v[180:183], v29 offset:0
    ds_read_b128 v[184:187], v29 offset:1024
    ds_read_b64 v[208:209], v27 offset:0
    ds_read_b128 v[188:191], v29 offset:2048
    ds_read_b128 v[212:215], v26 offset:1536
    ds_read_b128 v[192:195], v29 offset:3072
    ds_read_b128 v[196:199], v29 offset:4096
    ds_read_b64 v[216:217], v27 offset:1536
    ds_read_b128 v[200:203], v29 offset:5120
    s_waitcnt lgkmcnt(5)
    v_mfma_f32_16x16x32_bf16 v[220:223], v[180:183], v[204:207], 0
    v_mfma_f32_16x16x32_bf16 v[224:227], v[184:187], v[204:207], 0
    v_mfma_f32_16x16x32_bf16 v[224:227], v[188:191], v[208:211], v[224:227]
    ds_read_b128 v[204:207], v26 offset:3072
    ds_read_b128 v[180:183], v29 offset:6144
    ds_read_b128 v[184:187], v29 offset:7168
    ds_read_b64 v[208:209], v27 offset:3072
    ds_read_b128 v[188:191], v29 offset:8192
    s_waitcnt lgkmcnt(5)
    v_mfma_f32_16x16x32_bf16 v[220:223], v[192:195], v[212:215], v[220:223]
    v_mfma_f32_16x16x32_bf16 v[224:227], v[196:199], v[212:215], v[224:227]
    v_mfma_f32_16x16x32_bf16 v[224:227], v[200:203], v[216:219], v[224:227]
    ds_read_b128 v[212:215], v26 offset:4608
    ds_read_b128 v[192:195], v29 offset:9216
    ds_read_b128 v[196:199], v29 offset:10240
    ds_read_b64 v[216:217], v27 offset:4608
    ds_read_b128 v[200:203], v29 offset:11264
    s_waitcnt lgkmcnt(5)
    v_mfma_f32_16x16x32_bf16 v[220:223], v[180:183], v[204:207], v[220:223]
    v_mfma_f32_16x16x32_bf16 v[224:227], v[184:187], v[204:207], v[224:227]
    v_mfma_f32_16x16x32_bf16 v[224:227], v[188:191], v[208:211], v[224:227]
    s_waitcnt lgkmcnt(0)
    v_mfma_f32_16x16x32_bf16 v[220:223], v[192:195], v[212:215], v[220:223]
    v_mfma_f32_16x16x32_bf16 v[224:227], v[196:199], v[212:215], v[224:227]
    v_mfma_f32_16x16x32_bf16 v[224:227], v[200:203], v[216:219], v[224:227]
    s_nop 0
    buffer_store_dwordx4 v[220:223], v30, s[4:7], s49 offen sc1
    s_nop 5
    buffer_store_dwordx4 v[224:227], v30, s[4:7], s50 offen sc1
    s_waitcnt vmcnt(2)
    v_cmp_lt_i32 vcc, v36, v35
    s_cbranch_vccz L_fok_71
L_fw_70:
    buffer_load_dword v36, v33, s[4:7], s38 offen sc1
    s_sub_u32 s36, s36, 1
    s_cbranch_scc1 L_exit
    s_waitcnt vmcnt(0)
    v_cmp_lt_i32 vcc, v36, v35
    s_cbranch_vccnz L_fw_70
L_fok_71:
    buffer_load_dwordx4 v37, s[4:7], s48 offen offset:0 sc1 lds
    buffer_load_dwordx4 v37, s[4:7], s48 offen offset:1024 sc1 lds
    buffer_load_dwordx4 v37, s[4:7], s48 offen offset:2048 sc1 lds
    s_waitcnt vmcnt(0) lgkmcnt(0)
    s_barrier
    s_add_u32 s56, s37, 0
    s_and_b32 s55, s56, 3
    s_mul_i32 s55, s55, 24576
    v_add_u32 v26, s55, v22
    v_add_u32 v27, s55, v23
    s_and_b32 s55, s56, 1
    s_mul_i32 s55, s55, 12288
    v_add_u32 v29, s55, v28
    s_add_u32 s56, s37, 0
    s_and_b32 s55, s56, 7
    s_mul_i32 s55, s55, 655360
    s_add_u32 s49, s55, 2097152
    s_add_u32 s50, s49, 32768
    ds_read_b128 v[204:207], v26 offset:0
    ds_read_b128 v[180:183], v29 offset:0
    ds_read_b128 v[184:187], v29 offset:1024
    ds_read_b64 v[208:209], v27 offset:0
    ds_read_b128 v[188:191], v29 offset:2048
    ds_read_b128 v[212:215], v26 offset:1536
    ds_read_b128 v[192:195], v29 offset:3072
    ds_read_b128 v[196:199], v29 offset:4096
    ds_read_b64 v[216:217], v27 offset:1536
    ds_read_b128 v[200:203], v29 offset:5120
    s_waitcnt lgkmcnt(5)
    v_mfma_f32_16x16x32_bf16 v[220:223], v[180:183], v[204:207], 0
    v_mfma_f32_16x16x32_bf16 v[224:227], v[184:187], v[204:207], 0
    v_mfma_f32_16x16x32_bf16 v[224:227], v[188:191], v[208:211], v[224:227]
    ds_read_b128 v[204:207], v26 offset:3072
    ds_read_b128 v[180:183], v29 offset:6144
    ds_read_b128 v[184:187], v29 offset:7168
    ds_read_b64 v[208:209], v27 offset:3072
    ds_read_b128 v[188:191], v29 offset:8192
    s_waitcnt lgkmcnt(5)
    v_mfma_f32_16x16x32_bf16 v[220:223], v[192:195], v[212:215], v[220:223]
    v_mfma_f32_16x16x32_bf16 v[224:227], v[196:199], v[212:215], v[224:227]
    v_mfma_f32_16x16x32_bf16 v[224:227], v[200:203], v[216:219], v[224:227]
    ds_read_b128 v[212:215], v26 offset:4608
    ds_read_b128 v[192:195], v29 offset:9216
    ds_read_b128 v[196:199], v29 offset:10240
    ds_read_b64 v[216:217], v27 offset:4608
    ds_read_b128 v[200:203], v29 offset:11264
    s_waitcnt lgkmcnt(5)
    v_mfma_f32_16x16x32_bf16 v[220:223], v[180:183], v[204:207], v[220:223]
    v_mfma_f32_16x16x32_bf16 v[224:227], v[184:187], v[204:207], v[224:227]
    v_mfma_f32_16x16x32_bf16 v[224:227], v[188:191], v[208:211], v[224:227]
    s_waitcnt lgkmcnt(0)
    v_mfma_f32_16x16x32_bf16 v[220:223], v[192:195], v[212:215], v[220:223]
    v_mfma_f32_16x16x32_bf16 v[224:227], v[196:199], v[212:215], v[224:227]
    v_mfma_f32_16x16x32_bf16 v[224:227], v[200:203], v[216:219], v[224:227]
    s_nop 0
    buffer_store_dwordx4 v[220:223], v30, s[4:7], s49 offen sc1
    s_nop 5
    buffer_store_dwordx4 v[224:227], v30, s[4:7], s50 offen sc1
    s_waitcnt vmcnt(0)
    s_barrier
    buffer_store_dwordx4 v[84:87], v14, s[4:7], s41 offen sc1
    s_waitcnt vmcnt(0)
L_pc_72:
    buffer_load_dwordx4 v[164:167], v15, s[4:7], s41 offen sc1
    buffer_load_dwordx4 v[168:171], v16, s[4:7], s41 offen sc1
    s_sub_u32 s36, s36, 1
    s_cbranch_scc1 L_exit
    s_waitcnt vmcnt(0)
    v_max_u32 v41, v164, v168
    v_cmp_eq_u32 vcc, -1, v41
    s_cbranch_vccnz L_pc_72
    s_add_u32 s56, s37, -5
    s_and_b32 s55, s56, 7
    s_mul_i32 s55, s55, 655360
    s_add_u32 s51, s55, 2097152
    s_mul_i32 s52, s56, 81920
    buffer_load_dwordx4 v[228:231], v31, s[4:7], s51 offen sc1
    buffer_load_dwordx4 v[232:235], v31, s[4:7], s51 offen offset:1024 sc1
    s_waitcnt vmcnt(0)
    v_pk_add_f32 v[228:229], v[228:229], v[232:233]
    v_pk_add_f32 v[230:231], v[230:231], v[234:235]
    s_nop 1
    v_permlane32_swap_b32 v228, v230
    v_permlane32_swap_b32 v229, v231
    v_pk_add_f32 v[228:229], v[228:229], v[230:231]
    s_nop 1
    v_permlane16_swap_b32 v228, v229
    v_add_f32 v228, v228, v229
    v_cvt_pk_bf16_f32 v228, v228, v228
    buffer_store_short v228, v32, s[28:31], s52 offen
    s_add_u32 s56, s37, -4
    s_and_b32 s55, s56, 7
    s_mul_i32 s55, s55, 655360
    s_add_u32 s51, s55, 2097152
    s_mul_i32 s52, s56, 81920
    buffer_load_dwordx4 v[228:231], v31, s[4:7], s51 offen sc1
    buffer_load_dwordx4 v[232:235], v31, s[4:7], s51 offen offset:1024 sc1
    s_waitcnt vmcnt(0)
    v_pk_add_f32 v[228:229], v[228:229], v[232:233]
    v_pk_add_f32 v[230:231], v[230:231], v[234:235]
    s_nop 1
    v_permlane32_swap_b32 v228, v230
    v_permlane32_swap_b32 v229, v231
    v_pk_add_f32 v[228:229], v[228:229], v[230:231]
    s_nop 1
    v_permlane16_swap_b32 v228, v229
    v_add_f32 v228, v228, v229
    v_cvt_pk_bf16_f32 v228, v228, v228
    buffer_store_short v228, v32, s[28:31], s52 offen
    s_add_u32 s56, s37, -3
    s_and_b32 s55, s56, 7
    s_mul_i32 s55, s55, 655360
    s_add_u32 s51, s55, 2097152
    s_mul_i32 s52, s56, 81920
    buffer_load_dwordx4 v[228:231], v31, s[4:7], s51 offen sc1
    buffer_load_dwordx4 v[232:235], v31, s[4:7], s51 offen offset:1024 sc1
    s_waitcnt vmcnt(0)
    v_pk_add_f32 v[228:229], v[228:229], v[232:233]
    v_pk_add_f32 v[230:231], v[230:231], v[234:235]
    s_nop 1
    v_permlane32_swap_b32 v228, v230
    v_permlane32_swap_b32 v229, v231
    v_pk_add_f32 v[228:229], v[228:229], v[230:231]
    s_nop 1
    v_permlane16_swap_b32 v228, v229
    v_add_f32 v228, v228, v229
    v_cvt_pk_bf16_f32 v228, v228, v228
    buffer_store_short v228, v32, s[28:31], s52 offen
    s_add_u32 s56, s37, -2
    s_and_b32 s55, s56, 7
    s_mul_i32 s55, s55, 655360
    s_add_u32 s51, s55, 2097152
    s_mul_i32 s52, s56, 81920
    buffer_load_dwordx4 v[228:231], v31, s[4:7], s51 offen sc1
    buffer_load_dwordx4 v[232:235], v31, s[4:7], s51 offen offset:1024 sc1
    s_waitcnt vmcnt(0)
    v_pk_add_f32 v[228:229], v[228:229], v[232:233]
    v_pk_add_f32 v[230:231], v[230:231], v[234:235]
    s_nop 1
    v_permlane32_swap_b32 v228, v230
    v_permlane32_swap_b32 v229, v231
    v_pk_add_f32 v[228:229], v[228:229], v[230:231]
    s_nop 1
    v_permlane16_swap_b32 v228, v229
    v_add_f32 v228, v228, v229
    v_cvt_pk_bf16_f32 v228, v228, v228
    buffer_store_short v228, v32, s[28:31], s52 offen
    s_add_u32 s56, s37, -1
    s_and_b32 s55, s56, 7
    s_mul_i32 s55, s55, 655360
    s_add_u32 s51, s55, 2097152
    s_mul_i32 s52, s56, 81920
    buffer_load_dwordx4 v[228:231], v31, s[4:7], s51 offen sc1
    buffer_load_dwordx4 v[232:235], v31, s[4:7], s51 offen offset:1024 sc1
    s_waitcnt vmcnt(0)
    v_pk_add_f32 v[228:229], v[228:229], v[232:233]
    v_pk_add_f32 v[230:231], v[230:231], v[234:235]
    s_nop 1
    v_permlane32_swap_b32 v228, v230
    v_permlane32_swap_b32 v229, v231
    v_pk_add_f32 v[228:229], v[228:229], v[230:231]
    s_nop 1
    v_permlane16_swap_b32 v228, v229
    v_add_f32 v228, v228, v229
    v_cvt_pk_bf16_f32 v228, v228, v228
    buffer_store_short v228, v32, s[28:31], s52 offen
    s_add_u32 s56, s37, 0
    s_and_b32 s55, s56, 7
    s_mul_i32 s55, s55, 655360
    s_add_u32 s51, s55, 2097152
    s_mul_i32 s52, s56, 81920
    buffer_load_dwordx4 v[228:231], v31, s[4:7], s51 offen sc1
    buffer_load_dwordx4 v[232:235], v31, s[4:7], s51 offen offset:1024 sc1
    s_waitcnt vmcnt(0)
    v_pk_add_f32 v[228:229], v[228:229], v[232:233]
    v_pk_add_f32 v[230:231], v[230:231], v[234:235]
    s_nop 1
    v_permlane32_swap_b32 v228, v230
    v_permlane32_swap_b32 v229, v231
    v_pk_add_f32 v[228:229], v[228:229], v[230:231]
    s_nop 1
    v_permlane16_swap_b32 v228, v229
    v_add_f32 v228, v228, v229
    v_cvt_pk_bf16_f32 v228, v228, v228
    buffer_store_short v228, v32, s[28:31], s52 offen
    s_endpgm
L_tw_52:
    buffer_load_dword v217, v216, s[4:7], s38 offen sc1
    buffer_load_dword v217, v216, s[4:7], s38 offen sc1
L_tw_52a:
    buffer_load_dword v217, v216, s[4:7], s38 offen sc1
    s_sub_u32 s36, s36, 1
    s_cbranch_scc1 L_exit
    s_waitcnt vmcnt(2)
    v_cmp_gt_u32 vcc, s37, v217
    s_cbranch_vccz L_tok_53
    s_branch L_tw_52a
L_pp_54:
L_pp_54a:
    s_waitcnt vmcnt(1)
    v_mfma_f32_16x16x32_bf16 v[196:199], v[210:213], v[188:191], 0
    v_mfma_f32_16x16x32_bf16 v[200:203], v[208:211], v[188:191], 0
    v_max3_u32 v221, v188, v189, v190
    s_waitcnt vmcnt(0)
    v_mfma_f32_16x16x32_bf16 v[196:199], v[210:213], v[192:195], v[196:199]
    v_max3_u32 v222, v191, v192, v193
    v_max3_u32 v221, v221, v194, v195
    v_mfma_f32_16x16x32_bf16 v[200:203], v[208:211], v[192:195], v[200:203]
    v_max_u32 v221, v221, v222
    v_cmp_eq_u32 vcc, -1, v221
    s_nop 2
    v_cvt_pk_bf16_f32 v204, v196, v197
    v_cvt_pk_bf16_f32 v205, v198, v199
    s_cbranch_vccnz L_pp_54b
    v_cvt_pk_bf16_f32 v206, v200, v201
    v_cvt_pk_bf16_f32 v207, v202, v203
    buffer_store_dwordx4 v[204:207], v218, s[4:7], s42 offen sc1
    s_branch L_pc_55
L_pp_54b:
    buffer_load_dwordx4 v[188:191], v214, s[4:7], s55 offen sc1
    buffer_load_dwordx4 v[192:195], v215, s[4:7], s55 offen sc1
    s_sub_u32 s36, s36, 1
    s_cbranch_scc1 L_exit
    s_branch L_pp_54a
L_sp_63:
    s_cmp_eq_u32 s55, -1
    s_cbranch_scc1 L_sg_64
    v_max3_u32 v4, v104, v105, v106
    v_max3_u32 v4, v4, v92, v93
    v_max3_u32 v4, v4, v94, v95
    v_max3_u32 v4, v4, v96, v97
    v_max3_u32 v4, v4, v98, v99
    v_max3_u32 v4, v4, v100, v101
    v_max3_u32 v4, v4, v102, v103
    v_cmp_eq_u32 vcc, -1, v4
    s_cbranch_vccnz L_sr_73
    s_mov_b32 s55, -1
    s_branch L_sc_62
L_sr_73:
    buffer_load_dwordx4 v[92:95], v38, s[4:7], s43 offen offset:0 sc1
    buffer_load_dword v104, v39, s[4:7], s43 offen offset:0 sc1
    buffer_load_dwordx4 v[96:99], v38, s[4:7], s43 offen offset:1280 sc1
    buffer_load_dword v105, v39, s[4:7], s43 offen offset:1280 sc1
    buffer_load_dwordx4 v[100:103], v38, s[4:7], s43 offen offset:2560 sc1
    buffer_load_dword v106, v39, s[4:7], s43 offen offset:2560 sc1
    s_sub_u32 s36, s36, 1
    s_cbranch_scc1 L_exit
    s_branch L_sc_62
L_px_s:
    s_sub_u32 s40, s35, 22
    v_and_b32 v1, 15, v0
    v_lshrrev_b32 v2, 4, v0
    s_mul_i32 s90, s32, 12288
    v_lshl_add_u32 v10, v0, 4, s90
    s_mul_i32 s90, s32, 3072
    v_lshl_add_u32 v12, v0, 4, s90
    v_lshrrev_b32 v3, 2, v1
    v_lshlrev_b32 v3, 1, v3
    v_and_b32 v4, 1, v1
    v_or_b32 v3, v3, v4
    v_lshl_add_u32 v3, v2, 3, v3
    v_lshl_add_u32 v11, v3, 4, s90
    s_lshl_b32 s90, s32, 7
    v_min_u32 v3, 11, v0
    v_lshl_add_u32 v3, v3, 2, s90
    v_add_u32 v13, 163840, v3
    v_min_u32 v3, 2, v0
    v_lshl_add_u32 v3, v3, 2, s90
    v_add_u32 v14, 164352, v3
    s_lshl_b32 s91, s40, 2
    s_add_u32 s90, s90, s91
    s_add_u32 s90, s90, 164864
    v_mov_b32 v15, s90
    v_cmp_eq_u32 vcc, 0, v0
    v_mov_b32 v9, 2146435072
    s_nop 0
    v_cndmask_b32 v15, v9, v15, vcc
    v_mov_b32 v24, -1
    v_mov_b32 v28, 0
    v_mov_b32 v25, -1
    v_mov_b32 v29, 0
    v_mov_b32 v26, -1
    v_mov_b32 v30, 0
    v_mov_b32 v27, -1
    v_mov_b32 v31, 0
    v_lshlrev_b32 v3, 4, v0
    s_lshl_b32 s91, s40, 2
    s_add_u32 s91, s91, s32
    s_lshl_b32 s92, s34, 3
    s_add_u32 s92, s92, s91
    s_mul_i32 s92, s92, 30720
    buffer_store_dwordx4 v[24:27], v3, s[4:7], s92 offen sc1
    s_add_u32 s92, s92, 1024
    buffer_store_dwordx4 v[24:27], v3, s[4:7], s92 offen sc1
    s_add_u32 s92, s92, 1024
    buffer_store_dwordx4 v[24:27], v3, s[4:7], s92 offen sc1
    s_add_u32 s92, s92, 1024
    buffer_store_dwordx4 v[24:27], v3, s[4:7], s92 offen sc1
    s_add_u32 s92, s92, 1024
    buffer_store_dwordx4 v[24:27], v3, s[4:7], s92 offen sc1
    s_add_u32 s92, s92, 1024
    buffer_store_dwordx4 v[24:27], v3, s[4:7], s92 offen sc1
    s_add_u32 s92, s92, 1024
    buffer_store_dwordx4 v[24:27], v3, s[4:7], s92 offen sc1
    s_add_u32 s92, s92, 1024
    buffer_store_dwordx4 v[24:27], v3, s[4:7], s92 offen sc1
    s_add_u32 s92, s92, 1024
    buffer_store_dwordx4 v[24:27], v3, s[4:7], s92 offen sc1
    s_add_u32 s92, s92, 1024
    buffer_store_dwordx4 v[24:27], v3, s[4:7], s92 offen sc1
    s_add_u32 s92, s92, 1024
    buffer_store_dwordx4 v[24:27], v3, s[4:7], s92 offen sc1
    s_add_u32 s92, s92, 1024
    buffer_store_dwordx4 v[24:27], v3, s[4:7], s92 offen sc1
    s_add_u32 s92, s92, 1024
    buffer_store_dwordx4 v[24:27], v3, s[4:7], s92 offen sc1
    s_add_u32 s92, s92, 1024
    buffer_store_dwordx4 v[24:27], v3, s[4:7], s92 offen sc1
    s_add_u32 s92, s92, 1024
    buffer_store_dwordx4 v[24:27], v3, s[4:7], s92 offen sc1
    s_add_u32 s92, s92, 1024
    buffer_store_dwordx4 v[24:27], v3, s[4:7], s92 offen sc1
    s_add_u32 s92, s92, 1024
    buffer_store_dwordx4 v[24:27], v3, s[4:7], s92 offen sc1
    s_add_u32 s92, s92, 1024
    buffer_store_dwordx4 v[24:27], v3, s[4:7], s92 offen sc1
    s_add_u32 s92, s92, 1024
    buffer_store_dwordx4 v[24:27], v3, s[4:7], s92 offen sc1
    s_add_u32 s92, s92, 1024
    buffer_store_dwordx4 v[24:27], v3, s[4:7], s92 offen sc1
    s_add_u32 s92, s92, 1024
    buffer_store_dwordx4 v[24:27], v3, s[4:7], s92 offen sc1
    s_add_u32 s92, s92, 1024
    buffer_store_dwordx4 v[24:27], v3, s[4:7], s92 offen sc1
    s_add_u32 s92, s92, 1024
    buffer_store_dwordx4 v[24:27], v3, s[4:7], s92 offen sc1
    s_add_u32 s92, s92, 1024
    buffer_store_dwordx4 v[24:27], v3, s[4:7], s92 offen sc1
    s_add_u32 s92, s92, 1024
    buffer_store_dwordx4 v[24:27], v3, s[4:7], s92 offen sc1
    s_add_u32 s92, s92, 1024
    buffer_store_dwordx4 v[24:27], v3, s[4:7], s92 offen sc1
    s_add_u32 s92, s92, 1024
    buffer_store_dwordx4 v[24:27], v3, s[4:7], s92 offen sc1
    s_add_u32 s92, s92, 1024
    buffer_store_dwordx4 v[24:27], v3, s[4:7], s92 offen sc1
    s_add_u32 s92, s92, 1024
    buffer_store_dwordx4 v[24:27], v3, s[4:7], s92 offen sc1
    s_add_u32 s92, s92, 1024
    buffer_store_dwordx4 v[24:27], v3, s[4:7], s92 offen sc1
    s_add_u32 s92, s92, 1024
    s_waitcnt vmcnt(30)
    s_mul_i32 s92, s91, 20480
    s_add_u32 s92, s92, s38
    buffer_store_dwordx4 v[24:27], v3, s[4:7], s92 offen sc1
    s_add_u32 s92, s92, 1024
    buffer_store_dwordx4 v[24:27], v3, s[4:7], s92 offen sc1
    s_add_u32 s92, s92, 1024
    buffer_store_dwordx4 v[24:27], v3, s[4:7], s92 offen sc1
    s_add_u32 s92, s92, 1024
    buffer_store_dwordx4 v[24:27], v3, s[4:7], s92 offen sc1
    s_add_u32 s92, s92, 1024
    buffer_store_dwordx4 v[24:27], v3, s[4:7], s92 offen sc1
    s_add_u32 s92, s92, 1024
    buffer_store_dwordx4 v[24:27], v3, s[4:7], s92 offen sc1
    s_add_u32 s92, s92, 1024
    buffer_store_dwordx4 v[24:27], v3, s[4:7], s92 offen sc1
    s_add_u32 s92, s92, 1024
    buffer_store_dwordx4 v[24:27], v3, s[4:7], s92 offen sc1
    s_add_u32 s92, s92, 1024
    buffer_store_dwordx4 v[24:27], v3, s[4:7], s92 offen sc1
    s_add_u32 s92, s92, 1024
    buffer_store_dwordx4 v[24:27], v3, s[4:7], s92 offen sc1
    s_add_u32 s92, s92, 1024
    buffer_store_dwordx4 v[24:27], v3, s[4:7], s92 offen sc1
    s_add_u32 s92, s92, 1024
    buffer_store_dwordx4 v[24:27], v3, s[4:7], s92 offen sc1
    s_add_u32 s92, s92, 1024
    buffer_store_dwordx4 v[24:27], v3, s[4:7], s92 offen sc1
    s_add_u32 s92, s92, 1024
    buffer_store_dwordx4 v[24:27], v3, s[4:7], s92 offen sc1
    s_add_u32 s92, s92, 1024
    buffer_store_dwordx4 v[24:27], v3, s[4:7], s92 offen sc1
    s_add_u32 s92, s92, 1024
    buffer_store_dwordx4 v[24:27], v3, s[4:7], s92 offen sc1
    s_add_u32 s92, s92, 1024
    buffer_store_dwordx4 v[24:27], v3, s[4:7], s92 offen sc1
    s_add_u32 s92, s92, 1024
    buffer_store_dwordx4 v[24:27], v3, s[4:7], s92 offen sc1
    s_add_u32 s92, s92, 1024
    buffer_store_dwordx4 v[24:27], v3, s[4:7], s92 offen sc1
    s_add_u32 s92, s92, 1024
    buffer_store_dwordx4 v[24:27], v3, s[4:7], s92 offen sc1
    s_add_u32 s92, s92, 1024
    s_lshl_b32 s92, s91, 8
    s_add_u32 s92, s92, 163840
    s_add_u32 s92, s92, s38
    v_lshlrev_b32 v3, 2, v0
    buffer_store_dword v28, v3, s[4:7], s92 offen sc1
    buffer_store_dword v28, v3, s[4:7], s92 offen offset:2048 sc1
    v_mov_b32 v21, 0xd04e79ff
    s_mov_b32 s44, 0x3dd53b95
    v_lshl_add_u32 v3, v2, 2, 0
    v_cmp_le_u32 s[48:49], v3, v1
    v_lshl_add_u32 v3, v2, 2, 1
    v_cmp_le_u32 s[50:51], v3, v1
    v_lshl_add_u32 v3, v2, 2, 2
    v_cmp_le_u32 s[52:53], v3, v1
    v_lshl_add_u32 v3, v2, 2, 3
    v_cmp_le_u32 s[54:55], v3, v1
    v_mov_b32 v167, 0
    v_mov_b32 v171, 0
    v_mov_b32 v174, 0
    v_mov_b32 v175, 0
    s_waitcnt vmcnt(0)
    s_barrier
    s_mov_b32 s24, s70
    s_and_b32 s25, s71, 0xffff
    s_mov_b32 s26, 2621440
    s_mov_b32 s27, 0x20000
    s_mul_i32 s90, s32, 10240
    v_lshl_add_u32 v22, v0, 4, s90
    s_mov_b32 s37, s40
    s_cmp_lg_u32 s32, 0
    s_cbranch_scc1 L_arr_74
    v_mov_b32 v1, 68
    v_mov_b32 v2, 1
    s_mov_b64 exec, 1
    buffer_atomic_add v2, v1, s[8:11], 0 offen sc0 sc1
    s_waitcnt vmcnt(0)
    v_readfirstlane_b32 s90, v2
    s_mov_b64 exec, -1
    s_cmp_lg_u32 s90, 15
    s_cbranch_scc1 L_arr_74
    v_mov_b32 v1, 196
    v_mov_b32 v2, 1
    s_mov_b64 exec, 1
    buffer_store_dword v2, v1, s[8:11], 0 offen sc1
    s_mov_b64 exec, -1
L_arr_74:
    s_cmp_eq_u32 s40, 1
    s_cbranch_scc1 L_xp_76
    s_cmp_lg_u32 s32, 0
    s_cbranch_scc1 L_xg_77
    s_lshl_b32 s92, s34, 14
    s_add_u32 s92, s92, 1966080
    s_add_u32 s93, s92, 8192
    v_lshlrev_b32 v3, 4, v0
    buffer_store_dwordx4 v[24:27], v3, s[4:7], s92 offen sc1
    buffer_store_dwordx4 v[24:27], v3, s[4:7], s93 offen sc1
    v_mov_b32 v3, 0
    s_mov_b32 s56, -1
    s_mov_b32 s57, -1
    s_mov_b32 s62, 0
    s_waitcnt vmcnt(0)
L_pr_78:
    s_memtime s[58:59]
    s_waitcnt lgkmcnt(0)
    buffer_load_dword v4, v3, s[4:7], s92 offen sc1
    s_waitcnt vmcnt(0)
    s_memtime s[60:61]
    s_waitcnt lgkmcnt(0)
    s_sub_u32 s60, s60, s58
    s_min_u32 s56, s56, s60
    s_memtime s[58:59]
    s_waitcnt lgkmcnt(0)
    buffer_load_dword v4, v3, s[4:7], s93 offen sc1
    s_waitcnt vmcnt(0)
    s_memtime s[60:61]
    s_waitcnt lgkmcnt(0)
    s_sub_u32 s60, s60, s58
    s_min_u32 s57, s57, s60
    v_add_u32 v3, 128, v3
    s_add_u32 s62, s62, 1
    s_cmp_lt_u32 s62, 6
    s_cbranch_scc1 L_pr_78
    s_cmp_lt_u32 s57, s56
    s_cselect_b32 s62, 2, 1
L_xg_77:
    s_barrier
    s_branch L_xg_77x
L_xp_76:
    s_add_u32 s90, s37, 1
    s_min_u32 s90, s90, 63
    s_mul_i32 s90, s90, 40960
    buffer_load_dwordx4 v[248:251], v22, s[24:27], s90 offen offset:0
    buffer_load_dwordx4 v[248:251], v22, s[24:27], s90 offen offset:1024
    buffer_load_dwordx4 v[248:251], v22, s[24:27], s90 offen offset:2048
    buffer_load_dwordx4 v[248:251], v22, s[24:27], s90 offen offset:3072
    s_add_u32 s90, s90, 4096
    buffer_load_dwordx4 v[248:251], v22, s[24:27], s90 offen offset:0
    buffer_load_dwordx4 v[248:251], v22, s[24:27], s90 offen offset:1024
    buffer_load_dwordx4 v[248:251], v22, s[24:27], s90 offen offset:2048
    buffer_load_dwordx4 v[248:251], v22, s[24:27], s90 offen offset:3072
    s_add_u32 s90, s90, 4096
    buffer_load_dwordx4 v[248:251], v22, s[24:27], s90 offen offset:0
    buffer_load_dwordx4 v[248:251], v22, s[24:27], s90 offen offset:1024
    s_add_u32 s90, s37, 2
    s_min_u32 s90, s90, 63
    s_mul_i32 s90, s90, 40960
    buffer_load_dwordx4 v[248:251], v22, s[24:27], s90 offen offset:0
    buffer_load_dwordx4 v[248:251], v22, s[24:27], s90 offen offset:1024
    buffer_load_dwordx4 v[248:251], v22, s[24:27], s90 offen offset:2048
    buffer_load_dwordx4 v[248:251], v22, s[24:27], s90 offen offset:3072
    s_add_u32 s90, s90, 4096
    buffer_load_dwordx4 v[248:251], v22, s[24:27], s90 offen offset:0
    buffer_load_dwordx4 v[248:251], v22, s[24:27], s90 offen offset:1024
    buffer_load_dwordx4 v[248:251], v22, s[24:27], s90 offen offset:2048
    buffer_load_dwordx4 v[248:251], v22, s[24:27], s90 offen offset:3072
    s_add_u32 s90, s90, 4096
    buffer_load_dwordx4 v[248:251], v22, s[24:27], s90 offen offset:0
    buffer_load_dwordx4 v[248:251], v22, s[24:27], s90 offen offset:1024
    s_add_u32 s90, s37, 3
    s_min_u32 s90, s90, 63
    s_mul_i32 s90, s90, 40960
    buffer_load_dwordx4 v[248:251], v22, s[24:27], s90 offen offset:0
    buffer_load_dwordx4 v[248:251], v22, s[24:27], s90 offen offset:1024
    buffer_load_dwordx4 v[248:251], v22, s[24:27], s90 offen offset:2048
    buffer_load_dwordx4 v[248:251], v22, s[24:27], s90 offen offset:3072
    s_add_u32 s90, s90, 4096
    buffer_load_dwordx4 v[248:251], v22, s[24:27], s90 offen offset:0
    buffer_load_dwordx4 v[248:251], v22, s[24:27], s90 offen offset:1024
    buffer_load_dwordx4 v[248:251], v22, s[24:27], s90 offen offset:2048
    buffer_load_dwordx4 v[248:251], v22, s[24:27], s90 offen offset:3072
    s_add_u32 s90, s90, 4096
    buffer_load_dwordx4 v[248:251], v22, s[24:27], s90 offen offset:0
    buffer_load_dwordx4 v[248:251], v22, s[24:27], s90 offen offset:1024
    s_add_u32 s90, s37, 4
    s_min_u32 s90, s90, 63
    s_mul_i32 s90, s90, 40960
    buffer_load_dwordx4 v[248:251], v22, s[24:27], s90 offen offset:0
    buffer_load_dwordx4 v[248:251], v22, s[24:27], s90 offen offset:1024
    buffer_load_dwordx4 v[248:251], v22, s[24:27], s90 offen offset:2048
    buffer_load_dwordx4 v[248:251], v22, s[24:27], s90 offen offset:3072
    s_add_u32 s90, s90, 4096
    buffer_load_dwordx4 v[248:251], v22, s[24:27], s90 offen offset:0
    buffer_load_dwordx4 v[248:251], v22, s[24:27], s90 offen offset:1024
    buffer_load_dwordx4 v[248:251], v22, s[24:27], s90 offen offset:2048
    buffer_load_dwordx4 v[248:251], v22, s[24:27], s90 offen offset:3072
    s_add_u32 s90, s90, 4096
    buffer_load_dwordx4 v[248:251], v22, s[24:27], s90 offen offset:0
    buffer_load_dwordx4 v[248:251], v22, s[24:27], s90 offen offset:1024
    s_add_u32 s90, s37, 5
    s_min_u32 s90, s90, 63
    s_mul_i32 s90, s90, 40960
    buffer_load_dwordx4 v[248:251], v22, s[24:27], s90 offen offset:0
    buffer_load_dwordx4 v[248:251], v22, s[24:27], s90 offen offset:1024
    buffer_load_dwordx4 v[248:251], v22, s[24:27], s90 offen offset:2048
    buffer_load_dwordx4 v[248:251], v22, s[24:27], s90 offen offset:3072
    s_add_u32 s90, s90, 4096
    buffer_load_dwordx4 v[248:251], v22, s[24:27], s90 offen offset:0
    buffer_load_dwordx4 v[248:251], v22, s[24:27], s90 offen offset:1024
    buffer_load_dwordx4 v[248:251], v22, s[24:27], s90 offen offset:2048
    buffer_load_dwordx4 v[248:251], v22, s[24:27], s90 offen offset:3072
    s_add_u32 s90, s90, 4096
    buffer_load_dwordx4 v[248:251], v22, s[24:27], s90 offen offset:0
    buffer_load_dwordx4 v[248:251], v22, s[24:27], s90 offen offset:1024
    s_add_u32 s90, s37, 6
    s_min_u32 s90, s90, 63
    s_mul_i32 s90, s90, 40960
    buffer_load_dwordx4 v[248:251], v22, s[24:27], s90 offen offset:0
    buffer_load_dwordx4 v[248:251], v22, s[24:27], s90 offen offset:1024
    buffer_load_dwordx4 v[248:251], v22, s[24:27], s90 offen offset:2048
    buffer_load_dwordx4 v[248:251], v22, s[24:27], s90 offen offset:3072
    s_add_u32 s90, s90, 4096
    buffer_load_dwordx4 v[248:251], v22, s[24:27], s90 offen offset:0
    buffer_load_dwordx4 v[248:251], v22, s[24:27], s90 offen offset:1024
    buffer_load_dwordx4 v[248:251], v22, s[24:27], s90 offen offset:2048
    buffer_load_dwordx4 v[248:251], v22, s[24:27], s90 offen offset:3072
    s_add_u32 s90, s90, 4096
    buffer_load_dwordx4 v[248:251], v22, s[24:27], s90 offen offset:0
    buffer_load_dwordx4 v[248:251], v22, s[24:27], s90 offen offset:1024
L_xg_77x:
    v_mov_b32 v1, 196
L_gw_79:
    buffer_load_dword v2, v1, s[8:11], 0 offen sc1
    s_sub_u32 s36, s36, 1
    s_cbranch_scc1 L_exit
    s_waitcnt vmcnt(0)
    v_readfirstlane_b32 s90, v2
    s_nop 0
    s_cmp_eq_u32 s90, 0
    s_cbranch_scc1 L_gw_79
    s_or_b32 s90, s40, s32
    s_cbranch_scc1 L_xg_77y
    v_mov_b32 v3, 165376
    v_mov_b32 v4, s62
    buffer_store_dword v4, v3, s[4:7], s38 offen sc1
L_xg_77y:
L_px_loop_s:
    s_and_b32 s90, s37, 7
    s_mul_i32 s91, s90, 172032
    s_add_u32 s91, s91, 196608
    s_add_u32 s41, s38, s91
    s_add_u32 s42, s41, 0
    s_add_u32 s43, s41, 12288
    s_add_u32 s90, s37, 1
    v_mov_b32 v17, s90
    s_add_u32 s90, s37, 8
    s_min_u32 s90, s90, 63
    s_mul_i32 s90, s90, 40960
    buffer_load_dwordx4 v[248:251], v22, s[24:27], s90 offen offset:0
    buffer_load_dwordx4 v[248:251], v22, s[24:27], s90 offen offset:1024
    buffer_load_dwordx4 v[248:251], v22, s[24:27], s90 offen offset:2048
    buffer_load_dwordx4 v[248:251], v22, s[24:27], s90 offen offset:3072
    s_add_u32 s90, s90, 4096
    buffer_load_dwordx4 v[248:251], v22, s[24:27], s90 offen offset:0
    buffer_load_dwordx4 v[248:251], v22, s[24:27], s90 offen offset:1024
    buffer_load_dwordx4 v[248:251], v22, s[24:27], s90 offen offset:2048
    buffer_load_dwordx4 v[248:251], v22, s[24:27], s90 offen offset:3072
    s_add_u32 s90, s90, 4096
    buffer_load_dwordx4 v[248:251], v22, s[24:27], s90 offen offset:0
    buffer_load_dwordx4 v[248:251], v22, s[24:27], s90 offen offset:1024
L_pf_80:
    buffer_load_dword v16, v13, s[4:7], s38 offen sc1
    s_sub_u32 s36, s36, 1
    s_cbranch_scc1 L_exit
    s_waitcnt vmcnt(0)
    v_cmp_ge_u32 vcc, s37, v16
    s_cbranch_vccnz L_pf_80
    s_add_u32 s90, s41, 24576
    buffer_load_dwordx4 v[24:27], v10, s[4:7], s90 offen offset:0 sc1
    buffer_load_dwordx4 v[28:31], v10, s[4:7], s90 offen offset:1024 sc1
    buffer_load_dwordx4 v[32:35], v10, s[4:7], s90 offen offset:2048 sc1
    buffer_load_dwordx4 v[36:39], v10, s[4:7], s90 offen offset:3072 sc1
    s_add_u32 s90, s41, 28672
    buffer_load_dwordx4 v[40:43], v10, s[4:7], s90 offen offset:0 sc1
    buffer_load_dwordx4 v[44:47], v10, s[4:7], s90 offen offset:1024 sc1
    buffer_load_dwordx4 v[48:51], v10, s[4:7], s90 offen offset:2048 sc1
    buffer_load_dwordx4 v[52:55], v10, s[4:7], s90 offen offset:3072 sc1
    s_add_u32 s90, s41, 32768
    buffer_load_dwordx4 v[56:59], v10, s[4:7], s90 offen offset:0 sc1
    buffer_load_dwordx4 v[60:63], v10, s[4:7], s90 offen offset:1024 sc1
    buffer_load_dwordx4 v[64:67], v10, s[4:7], s90 offen offset:2048 sc1
    buffer_load_dwordx4 v[68:71], v10, s[4:7], s90 offen offset:3072 sc1
    s_add_u32 s90, s41, 73728
    buffer_load_dwordx4 v[72:75], v10, s[4:7], s90 offen offset:0 sc1
    buffer_load_dwordx4 v[76:79], v10, s[4:7], s90 offen offset:1024 sc1
    buffer_load_dwordx4 v[80:83], v10, s[4:7], s90 offen offset:2048 sc1
    buffer_load_dwordx4 v[84:87], v10, s[4:7], s90 offen offset:3072 sc1
    s_add_u32 s90, s41, 77824
    buffer_load_dwordx4 v[88:91], v10, s[4:7], s90 offen offset:0 sc1
    buffer_load_dwordx4 v[92:95], v10, s[4:7], s90 offen offset:1024 sc1
    buffer_load_dwordx4 v[96:99], v10, s[4:7], s90 offen offset:2048 sc1
    buffer_load_dwordx4 v[100:103], v10, s[4:7], s90 offen offset:3072 sc1
    s_add_u32 s90, s41, 81920
    buffer_load_dwordx4 v[104:107], v10, s[4:7], s90 offen offset:0 sc1
    buffer_load_dwordx4 v[108:111], v10, s[4:7], s90 offen offset:1024 sc1
    buffer_load_dwordx4 v[112:115], v10, s[4:7], s90 offen offset:2048 sc1
    buffer_load_dwordx4 v[116:119], v10, s[4:7], s90 offen offset:3072 sc1
    s_waitcnt vmcnt(0)
    v_mfma_f32_16x16x32_bf16 v[144:147], v[72:75], v[24:27], 0
    v_mfma_f32_16x16x32_bf16 v[152:155], v[72:75], v[48:51], 0
    v_mfma_f32_16x16x32_bf16 v[156:159], v[96:99], v[48:51], 0
    v_mfma_f32_16x16x32_bf16 v[144:147], v[76:79], v[28:31], v[144:147]
    v_mfma_f32_16x16x32_bf16 v[152:155], v[76:79], v[52:55], v[152:155]
    v_mfma_f32_16x16x32_bf16 v[156:159], v[100:103], v[52:55], v[156:159]
    v_mfma_f32_16x16x32_bf16 v[144:147], v[80:83], v[32:35], v[144:147]
    v_mfma_f32_16x16x32_bf16 v[152:155], v[80:83], v[56:59], v[152:155]
    v_mfma_f32_16x16x32_bf16 v[156:159], v[104:107], v[56:59], v[156:159]
    v_mfma_f32_16x16x32_bf16 v[144:147], v[84:87], v[36:39], v[144:147]
    v_mfma_f32_16x16x32_bf16 v[152:155], v[84:87], v[60:63], v[152:155]
    v_mfma_f32_16x16x32_bf16 v[156:159], v[108:111], v[60:63], v[156:159]
    v_mfma_f32_16x16x32_bf16 v[144:147], v[88:91], v[40:43], v[144:147]
    v_mfma_f32_16x16x32_bf16 v[152:155], v[88:91], v[64:67], v[152:155]
    v_mfma_f32_16x16x32_bf16 v[156:159], v[112:115], v[64:67], v[156:159]
    v_mfma_f32_16x16x32_bf16 v[144:147], v[92:95], v[44:47], v[144:147]
    v_mfma_f32_16x16x32_bf16 v[152:155], v[92:95], v[68:71], v[152:155]
    v_mfma_f32_16x16x32_bf16 v[156:159], v[116:119], v[68:71], v[156:159]
    s_nop 0
    v_cndmask_b32 v144, v21, v144, s[48:49]
    v_cndmask_b32 v145, v21, v145, s[50:51]
    v_cndmask_b32 v146, v21, v146, s[52:53]
    v_cndmask_b32 v147, v21, v147, s[54:55]
    s_nop 2
    v_cndmask_b32 v156, v21, v156, s[48:49]
    v_cndmask_b32 v157, v21, v157, s[50:51]
    v_cndmask_b32 v158, v21, v158, s[52:53]
    v_cndmask_b32 v159, v21, v159, s[54:55]
L_pf_81:
    buffer_load_dword v16, v14, s[4:7], s38 offen sc1
    s_sub_u32 s36, s36, 1
    s_cbranch_scc1 L_exit
    s_waitcnt vmcnt(0)
    v_cmp_ge_u32 vcc, s37, v16
    s_cbranch_vccnz L_pf_81
    buffer_load_dwordx4 v[120:123], v11, s[4:7], s42 offen offset:0 sc1
    buffer_load_dwordx4 v[124:127], v11, s[4:7], s42 offen offset:512 sc1
    buffer_load_dwordx4 v[128:131], v11, s[4:7], s42 offen offset:1024 sc1
    buffer_load_dwordx4 v[132:135], v11, s[4:7], s42 offen offset:1536 sc1
    buffer_load_dwordx4 v[136:139], v11, s[4:7], s42 offen offset:2048 sc1
    buffer_load_dwordx4 v[140:143], v11, s[4:7], s42 offen offset:2560 sc1
    s_waitcnt vmcnt(5)
    v_mfma_f32_16x16x32_bf16 v[148:151], v[120:123], v[24:27], 0
    v_mfma_f32_16x16x32_bf16 v[160:163], v[120:123], v[48:51], 0
    s_waitcnt vmcnt(4)
    v_mfma_f32_16x16x32_bf16 v[148:151], v[124:127], v[28:31], v[148:151]
    v_mfma_f32_16x16x32_bf16 v[160:163], v[124:127], v[52:55], v[160:163]
    s_waitcnt vmcnt(3)
    v_mfma_f32_16x16x32_bf16 v[148:151], v[128:131], v[32:35], v[148:151]
    v_mfma_f32_16x16x32_bf16 v[160:163], v[128:131], v[56:59], v[160:163]
    s_waitcnt vmcnt(2)
    v_mfma_f32_16x16x32_bf16 v[148:151], v[132:135], v[36:39], v[148:151]
    v_mfma_f32_16x16x32_bf16 v[160:163], v[132:135], v[60:63], v[160:163]
    s_waitcnt vmcnt(1)
    v_mfma_f32_16x16x32_bf16 v[148:151], v[136:139], v[40:43], v[148:151]
    v_mfma_f32_16x16x32_bf16 v[160:163], v[136:139], v[64:67], v[160:163]
    s_waitcnt vmcnt(0)
    v_mfma_f32_16x16x32_bf16 v[148:151], v[140:143], v[44:47], v[148:151]
    v_mfma_f32_16x16x32_bf16 v[160:163], v[140:143], v[68:71], v[160:163]
    v_max_f32 v18, v144, v145
    v_max3_f32 v18, v18, v146, v147
    s_nop 2
    v_max3_f32 v18, v18, v148, v149
    v_mov_b32 v19, v18
    s_nop 1
    v_permlane16_swap_b32 v18, v19
    v_max_f32 v18, v18, v19
    v_mov_b32 v19, v18
    s_nop 1
    v_permlane32_swap_b32 v18, v19
    v_max_f32 v18, v18, v19
    v_mul_f32 v18, 0xbdd53b95, v18
    v_fma_f32 v144, v144, s44, v18
    v_fma_f32 v145, v145, s44, v18
    v_fma_f32 v146, v146, s44, v18
    v_fma_f32 v147, v147, s44, v18
    v_fma_f32 v148, v148, s44, v18
    v_fma_f32 v149, v149, s44, v18
    v_exp_f32 v144, v144
    v_exp_f32 v145, v145
    v_exp_f32 v146, v146
    v_exp_f32 v147, v147
    v_exp_f32 v148, v148
    v_exp_f32 v149, v149
    v_add_f32 v20, v144, v145
    v_add_f32 v20, v20, v146
    v_add_f32 v20, v20, v147
    v_add_f32 v20, v20, v148
    v_add_f32 v20, v20, v149
    v_mov_b32 v19, v20
    s_nop 1
    v_permlane16_swap_b32 v20, v19
    v_add_f32 v20, v20, v19
    v_mov_b32 v19, v20
    s_nop 1
    v_permlane32_swap_b32 v20, v19
    v_add_f32 v20, v20, v19
    v_rcp_f32 v20, v20
    s_nop 0
    v_mul_f32 v144, v144, v20
    v_mul_f32 v145, v145, v20
    v_mul_f32 v146, v146, v20
    v_mul_f32 v147, v147, v20
    v_mul_f32 v148, v148, v20
    v_mul_f32 v149, v149, v20
    v_cvt_pk_bf16_f32 v164, v144, v145
    v_cvt_pk_bf16_f32 v165, v146, v147
    v_cvt_pk_bf16_f32 v166, v148, v149
    v_max_f32 v18, v152, v153
    v_max3_f32 v18, v18, v154, v155
    v_max3_f32 v18, v18, v160, v161
    v_max3_f32 v18, v18, v156, v157
    v_max3_f32 v18, v18, v158, v159
    v_mov_b32 v19, v18
    s_nop 1
    v_permlane16_swap_b32 v18, v19
    v_max_f32 v18, v18, v19
    v_mov_b32 v19, v18
    s_nop 1
    v_permlane32_swap_b32 v18, v19
    v_max_f32 v18, v18, v19
    v_mul_f32 v18, 0xbdd53b95, v18
    v_fma_f32 v152, v152, s44, v18
    v_fma_f32 v153, v153, s44, v18
    v_fma_f32 v154, v154, s44, v18
    v_fma_f32 v155, v155, s44, v18
    v_fma_f32 v160, v160, s44, v18
    v_fma_f32 v161, v161, s44, v18
    v_fma_f32 v156, v156, s44, v18
    v_fma_f32 v157, v157, s44, v18
    v_fma_f32 v158, v158, s44, v18
    v_fma_f32 v159, v159, s44, v18
    v_exp_f32 v152, v152
    v_exp_f32 v153, v153
    v_exp_f32 v154, v154
    v_exp_f32 v155, v155
    v_exp_f32 v160, v160
    v_exp_f32 v161, v161
    v_exp_f32 v156, v156
    v_exp_f32 v157, v157
    v_exp_f32 v158, v158
    v_exp_f32 v159, v159
    v_add_f32 v20, v152, v153
    v_add_f32 v20, v20, v154
    v_add_f32 v20, v20, v155
    v_add_f32 v20, v20, v160
    v_add_f32 v20, v20, v161
    v_add_f32 v20, v20, v156
    v_add_f32 v20, v20, v157
    v_add_f32 v20, v20, v158
    v_add_f32 v20, v20, v159
    v_mov_b32 v19, v20
    s_nop 1
    v_permlane16_swap_b32 v20, v19
    v_add_f32 v20, v20, v19
    v_mov_b32 v19, v20
    s_nop 1
    v_permlane32_swap_b32 v20, v19
    v_add_f32 v20, v20, v19
    v_rcp_f32 v20, v20
    s_nop 0
    v_mul_f32 v152, v152, v20
    v_mul_f32 v153, v153, v20
    v_mul_f32 v154, v154, v20
    v_mul_f32 v155, v155, v20
    v_mul_f32 v160, v160, v20
    v_mul_f32 v161, v161, v20
    v_mul_f32 v156, v156, v20
    v_mul_f32 v157, v157, v20
    v_mul_f32 v158, v158, v20
    v_mul_f32 v159, v159, v20
    v_cvt_pk_bf16_f32 v168, v152, v153
    v_cvt_pk_bf16_f32 v169, v154, v155
    v_cvt_pk_bf16_f32 v170, v160, v161
    v_cvt_pk_bf16_f32 v172, v156, v157
    v_cvt_pk_bf16_f32 v173, v158, v159
    buffer_store_dwordx4 v[164:167], v12, s[4:7], s43 offen offset:0 sc1
    buffer_store_dwordx4 v[168:171], v12, s[4:7], s43 offen offset:1024 sc1
    buffer_store_dwordx4 v[172:175], v12, s[4:7], s43 offen offset:2048 sc1
    s_waitcnt vmcnt(0)
    buffer_store_dword v17, v15, s[4:7], s38 offen sc1
    s_add_u32 s37, s37, 2
    s_cmp_lt_u32 s37, 64
    s_cbranch_scc1 L_px_loop_s
    s_endpgm
L_pa_s:
    v_mov_b32 v1, 196
L_gw_82:
    buffer_load_dword v2, v1, s[8:11], 0 offen sc1
    s_sub_u32 s36, s36, 1
    s_cbranch_scc1 L_exit
    s_waitcnt vmcnt(0)
    v_readfirstlane_b32 s90, v2
    s_nop 0
    s_cmp_eq_u32 s90, 0
    s_cbranch_scc1 L_gw_82
    s_branch L_pa_body
.section .rodata,"a"
.p2align 6
.amdhsa_kernel concat_heads__sliding_local_dilated__memory_aug_recurrent_mem_tr__prompt_kernel
  .amdhsa_next_free_vgpr 512
  .amdhsa_next_free_sgpr 102
  .amdhsa_accum_offset 256
  .amdhsa_group_segment_fixed_size 0
  .amdhsa_kernarg_size 104
  .amdhsa_user_sgpr_count 2
  .amdhsa_user_sgpr_kernarg_segment_ptr 1
  .amdhsa_system_sgpr_workgroup_id_x 1
  .amdhsa_float_denorm_mode_32 3
.end_amdhsa_kernel
```

```asm
; @launch grid=(256,1,1) block=(256,1,1) lds=163840
.amdgcn_target "amdgcn-amd-amdhsa--gfx950"
.text
.globl concat_heads__sliding_local_dilated__memory_aug_recurrent_mem_tr__prompt_kernel
.p2align 8
.type concat_heads__sliding_local_dilated__memory_aug_recurrent_mem_tr__prompt_kernel,@function
concat_heads__sliding_local_dilated__memory_aug_recurrent_mem_tr__prompt_kernel:
    s_cmp_ge_u32 s2, 256
    s_cbranch_scc1 L_exit
    s_load_dwordx16 s[64:79], s[0:1], 0
    s_load_dwordx8 s[80:87], s[0:1], 64
    s_load_dwordx2 s[88:89], s[0:1], 96
    s_getreg_b32 s33, hwreg(HW_REG_XCC_ID, 0, 4)
    v_lshrrev_b32 v1, 6, v0
    v_and_b32 v0, 63, v0
    v_readfirstlane_b32 s32, v1
    s_mov_b32 s36, 0x100000
    s_mov_b32 s96, 0
    s_mov_b32 s97, 0
    s_and_b32 s90, s33, 4
    s_lshl_b32 s90, s90, 5
    s_and_b32 s91, s33, 3
    s_lshl_b32 s91, s91, 2
    s_add_u32 s90, s90, s91
    s_lshr_b32 s91, s33, 3
    s_lshl_b32 s91, s91, 4
    s_add_u32 s90, s90, s91
    v_mov_b32 v1, s90
    v_mov_b32 v2, 1
    v_mov_b32 v3, 0
    s_waitcnt lgkmcnt(0)
    s_mov_b32 s8, s86
    s_and_b32 s9, s87, 0xffff
    s_mov_b32 s10, 256
    s_mov_b32 s11, 0x20000
    s_mov_b32 s4, s88
    s_and_b32 s5, s89, 0xffff
    s_mov_b32 s6, 33554432
    s_mov_b32 s7, 0x20000
    s_mov_b32 s28, s84
    s_and_b32 s29, s85, 0xffff
    s_mov_b32 s30, 5242880
    s_mov_b32 s31, 0x20000
    s_cmp_lg_u32 s32, 0
    s_cbranch_scc1 L_norank
    s_mov_b64 exec, 1
    buffer_atomic_add v2, v1, s[8:11], 0 offen sc0 sc1
    s_mov_b64 exec, -1
    v_mov_b32 v240, -1
    v_mov_b32 v241, -1
    v_mov_b32 v242, -1
    v_mov_b32 v243, -1
    v_mov_b32 v244, 0
    v_lshlrev_b32 v4, 4, v0
    v_lshlrev_b32 v5, 2, v0
    s_mul_i32 s91, s2, 2560
    s_and_b32 s92, s2, 7
    s_lshl_b32 s92, s92, 21
    s_add_u32 s92, s92, 8388608
    s_lshr_b32 s93, s2, 3
    s_lshl_b32 s40, s93, 7
    s_add_u32 s40, s40, s92
    s_add_u32 s40, s40, 458752
    s_lshr_b32 s41, s93, 4
    s_mul_i32 s41, s41, 114688
    s_add_u32 s92, s92, s41
    s_and_b32 s93, s93, 15
    s_mul_i32 s93, s93, 2560
    s_add_u32 s92, s92, s93
    buffer_store_dwordx4 v[240:243], v4, s[4:7], s91 offen sc1
    buffer_store_dwordx4 v[240:243], v4, s[4:7], s91 offen offset:1024 sc1
    buffer_store_dword v240, v5, s[4:7], s91 offen offset:2048 sc1
    buffer_store_dword v240, v5, s[4:7], s91 offen offset:2304 sc1
    buffer_store_dwordx4 v[240:243], v4, s[4:7], s92 offen sc1
    buffer_store_dwordx4 v[240:243], v4, s[4:7], s92 offen offset:1024 sc1
    buffer_store_dword v240, v5, s[4:7], s92 offen offset:2048 sc1
    buffer_store_dword v240, v5, s[4:7], s92 offen offset:2304 sc1
    s_mov_b64 exec, 0xffffffff
    buffer_store_dword v244, v5, s[4:7], s40 offen sc1
    s_mov_b64 exec, -1
    s_waitcnt vmcnt(9)
    s_mov_b64 exec, 1
    ds_write_b32 v3, v2
    s_mov_b64 exec, -1
    s_waitcnt vmcnt(0) lgkmcnt(0)
    s_and_b32 s91, s33, 4
    s_lshl_b32 s91, s91, 5
    s_add_u32 s91, s91, 48
    v_mov_b32 v1, s91
    v_mov_b32 v4, 1
    s_mov_b64 exec, 1
    buffer_atomic_add v4, v1, s[8:11], 0 offen sc1
    s_mov_b64 exec, -1
    s_branch L_rank
L_norank:
    s_and_b32 s34, s33, 7
    s_lshr_b32 s93, s2, 3
    s_mul_i32 s93, s93, 3
    s_add_u32 s93, s93, s32
    s_sub_u32 s93, s93, 1
    v_add_u32 v4, 0, v0
    v_cmp_le_u32 vcc, 96, v4
    v_subrev_u32 v5, 96, v4
    s_nop 0
    v_cndmask_b32 v4, v4, v5, vcc
    v_lshlrev_b32 v4, 4, v4
    v_mov_b32 v5, 12288
    v_cndmask_b32 v5, 0, v5, vcc
    s_mul_i32 s90, s34, 1536
    v_add3_u32 v6, v4, v5, s90
    v_add_u32 v4, 64, v0
    v_cmp_le_u32 vcc, 96, v4
    v_subrev_u32 v5, 96, v4
    s_nop 0
    v_cndmask_b32 v4, v4, v5, vcc
    v_lshlrev_b32 v4, 4, v4
    v_mov_b32 v5, 12288
    v_cndmask_b32 v5, 0, v5, vcc
    s_mul_i32 s90, s34, 1536
    v_add3_u32 v7, v4, v5, s90
    v_add_u32 v4, 128, v0
    v_cmp_le_u32 vcc, 96, v4
    v_subrev_u32 v5, 96, v4
    s_nop 0
    v_cndmask_b32 v4, v4, v5, vcc
    v_lshlrev_b32 v4, 4, v4
    v_mov_b32 v5, 12288
    v_cndmask_b32 v5, 0, v5, vcc
    s_mul_i32 s90, s34, 1536
    v_add3_u32 v8, v4, v5, s90
    s_cmp_lt_u32 s93, 64
    s_cselect_b32 s12, s78, s76
    s_cselect_b32 s13, s79, s77
    s_cselect_b32 s91, 2, 0
    s_cmp_lt_u32 s93, 32
    s_cselect_b32 s12, s78, s12
    s_cselect_b32 s13, s79, s13
    s_cselect_b32 s91, 2, s91
    s_and_b32 s13, s13, 0xffff
    s_mov_b32 s14, 7864320
    s_mov_b32 s15, 0x20000
    s_mul_i32 s91, s91, 320
    s_mul_i32 s90, s93, 10
    s_add_u32 s90, s90, s91
    s_sub_u32 s90, s90, 640
    s_mul_i32 s90, s90, 12288
    buffer_load_dwordx4 v[248:251], v6, s[12:15], s90 offen
    buffer_load_dwordx4 v[248:251], v7, s[12:15], s90 offen
    buffer_load_dwordx4 v[248:251], v8, s[12:15], s90 offen
    s_add_u32 s90, s90, 24576
    buffer_load_dwordx4 v[248:251], v6, s[12:15], s90 offen
    buffer_load_dwordx4 v[248:251], v7, s[12:15], s90 offen
    buffer_load_dwordx4 v[248:251], v8, s[12:15], s90 offen
    s_add_u32 s90, s90, 24576
    buffer_load_dwordx4 v[248:251], v6, s[12:15], s90 offen
    buffer_load_dwordx4 v[248:251], v7, s[12:15], s90 offen
    buffer_load_dwordx4 v[248:251], v8, s[12:15], s90 offen
    s_add_u32 s90, s90, 24576
    buffer_load_dwordx4 v[248:251], v6, s[12:15], s90 offen
    buffer_load_dwordx4 v[248:251], v7, s[12:15], s90 offen
    buffer_load_dwordx4 v[248:251], v8, s[12:15], s90 offen
    s_add_u32 s90, s90, 24576
    buffer_load_dwordx4 v[248:251], v6, s[12:15], s90 offen
    buffer_load_dwordx4 v[248:251], v7, s[12:15], s90 offen
    buffer_load_dwordx4 v[248:251], v8, s[12:15], s90 offen
    s_add_u32 s90, s90, 24576
L_rank:
    s_barrier
    ds_read_b32 v2, v3
    s_waitcnt lgkmcnt(0)
    v_readfirstlane_b32 s35, v2
    s_mov_b32 s34, s33
    s_barrier
    s_cmp_ge_u32 s33, 8
    s_cbranch_scc1 L_norole
    s_cmp_ge_u32 s35, 32
    s_cbranch_scc1 L_norole
    s_lshl_b32 s38, s34, 21
    s_add_u32 s38, s38, 8388608
    s_cmp_lt_u32 s35, 12
    s_cbranch_scc1 L_qkv_f
    s_cmp_lt_u32 s35, 22
    s_cbranch_scc1 L_wo_f
    s_cmp_lt_u32 s35, 24
    s_cbranch_scc1 L_px_f
    s_branch L_pa_f
L_norole:
    v_mov_b32 v1, 192
    v_mov_b32 v2, 2
    s_mov_b64 exec, 1
    buffer_store_dword v2, v1, s[8:11], 0 offen sc1
    s_mov_b64 exec, -1
    s_branch L_slow
L_exit:
    s_endpgm
L_qkv_f:
    s_mov_b32 s12, s74
    s_and_b32 s13, s75, 0xffff
    s_mov_b32 s14, 7864320
    s_mov_b32 s15, 0x20000
    s_mov_b32 s16, s76
    s_and_b32 s17, s77, 0xffff
    s_mov_b32 s18, 7864320
    s_mov_b32 s19, 0x20000
    s_mov_b32 s20, s78
    s_and_b32 s21, s79, 0xffff
    s_mov_b32 s22, 7864320
    s_mov_b32 s23, 0x20000
    s_mov_b32 s24, s70
    s_and_b32 s25, s71, 0xffff
    s_mov_b32 s26, 2621440
    s_mov_b32 s27, 0x20000
    s_mul_i32 s40, s35, 86
    s_lshr_b32 s40, s40, 8
    s_mul_i32 s90, s40, 3
    s_sub_u32 s41, s35, s90
    v_and_b32 v1, 15, v0
    v_lshrrev_b32 v2, 4, v0
    v_lshrrev_b32 v3, 3, v0
    v_and_b32 v4, 7, v0
    s_lshl_b32 s90, s32, 3
    v_add_u32 v5, s90, v3
    s_and_b32 s91, s32, 1
    s_lshl_b32 s91, s91, 2
    v_and_b32 v6, 2, v3
    v_or_b32 v6, s91, v6
    v_xor_b32 v6, v6, v4
    v_lshlrev_b32 v6, 4, v6
    v_mul_u32_u24 v7, 12288, v5
    s_lshl_b32 s92, s34, 2
    s_add_u32 s92, s92, s40
    s_mul_i32 s92, s92, 384
    s_lshl_b32 s93, s41, 7
    s_add_u32 s92, s92, s93
    v_add3_u32 v164, v6, v7, s92
    v_lshrrev_b32 v6, 1, v3
    v_or_b32 v6, s91, v6
    v_xor_b32 v6, v6, v4
    v_lshlrev_b32 v6, 4, v6
    v_mul_u32_u24 v7, 1280, v5
    v_add_u32 v10, v6, v7
    s_lshl_b32 s90, s32, 10
    s_add_u32 m0, s90, 40960
    s_mov_b32 s91, 0
    buffer_load_dwordx4 v164, s[20:23], s91 offen nt lds
    s_add_u32 m0, m0, 4096
    s_add_u32 s91, s91, 393216
    buffer_load_dwordx4 v164, s[20:23], s91 offen nt lds
    s_add_u32 m0, m0, 4096
    s_add_u32 s91, s91, 393216
    buffer_load_dwordx4 v164, s[20:23], s91 offen nt lds
    s_add_u32 m0, m0, 4096
    s_add_u32 s91, s91, 393216
    buffer_load_dwordx4 v164, s[20:23], s91 offen nt lds
    s_add_u32 m0, m0, 4096
    s_add_u32 s91, s91, 393216
    buffer_load_dwordx4 v164, s[20:23], s91 offen nt lds
    s_add_u32 m0, m0, 4096
    s_add_u32 s91, s91, 393216
    buffer_load_dwordx4 v164, s[20:23], s91 offen nt lds
    s_add_u32 m0, m0, 4096
    s_add_u32 s91, s91, 393216
    buffer_load_dwordx4 v164, s[20:23], s91 offen nt lds
    s_add_u32 m0, m0, 4096
    s_add_u32 s91, s91, 393216
    buffer_load_dwordx4 v164, s[20:23], s91 offen nt lds
    s_add_u32 m0, m0, 4096
    s_add_u32 s91, s91, 393216
    buffer_load_dwordx4 v164, s[20:23], s91 offen nt lds
    s_add_u32 m0, m0, 4096
    s_add_u32 s91, s91, 393216
    buffer_load_dwordx4 v164, s[20:23], s91 offen nt lds
    s_lshl_b32 s90, s32, 10
    s_add_u32 m0, s90, 81920
    s_mov_b32 s91, 3932160
    buffer_load_dwordx4 v164, s[20:23], s91 offen nt lds
    s_add_u32 m0, m0, 4096
    s_add_u32 s91, s91, 393216
    buffer_load_dwordx4 v164, s[20:23], s91 offen nt lds
    s_add_u32 m0, m0, 4096
    s_add_u32 s91, s91, 393216
    buffer_load_dwordx4 v164, s[20:23], s91 offen nt lds
    s_add_u32 m0, m0, 4096
    s_add_u32 s91, s91, 393216
    buffer_load_dwordx4 v164, s[20:23], s91 offen nt lds
    s_add_u32 m0, m0, 4096
    s_add_u32 s91, s91, 393216
    buffer_load_dwordx4 v164, s[20:23], s91 offen nt lds
    s_add_u32 m0, m0, 4096
    s_add_u32 s91, s91, 393216
    buffer_load_dwordx4 v164, s[20:23], s91 offen nt lds
    s_add_u32 m0, m0, 4096
    s_add_u32 s91, s91, 393216
    buffer_load_dwordx4 v164, s[20:23], s91 offen nt lds
    s_add_u32 m0, m0, 4096
    s_add_u32 s91, s91, 393216
    buffer_load_dwordx4 v164, s[20:23], s91 offen nt lds
    s_add_u32 m0, m0, 4096
    s_add_u32 s91, s91, 393216
    buffer_load_dwordx4 v164, s[20:23], s91 offen nt lds
    s_add_u32 m0, m0, 4096
    s_add_u32 s91, s91, 393216
    buffer_load_dwordx4 v164, s[20:23], s91 offen nt lds
    s_lshl_b32 s90, s32, 10
    s_add_u32 m0, s90, 122880
    s_mov_b32 s91, 0
    buffer_load_dwordx4 v164, s[16:19], s91 offen nt lds
    s_add_u32 m0, m0, 4096
    s_add_u32 s91, s91, 393216
    buffer_load_dwordx4 v164, s[16:19], s91 offen nt lds
    s_add_u32 m0, m0, 4096
    s_add_u32 s91, s91, 393216
    buffer_load_dwordx4 v164, s[16:19], s91 offen nt lds
    s_add_u32 m0, m0, 4096
    s_add_u32 s91, s91, 393216
    buffer_load_dwordx4 v164, s[16:19], s91 offen nt lds
    s_add_u32 m0, m0, 4096
    s_add_u32 s91, s91, 393216
    buffer_load_dwordx4 v164, s[16:19], s91 offen nt lds
    s_add_u32 m0, m0, 4096
    s_add_u32 s91, s91, 393216
    buffer_load_dwordx4 v164, s[16:19], s91 offen nt lds
    s_add_u32 m0, m0, 4096
    s_add_u32 s91, s91, 393216
    buffer_load_dwordx4 v164, s[16:19], s91 offen nt lds
    s_add_u32 m0, m0, 4096
    s_add_u32 s91, s91, 393216
    buffer_load_dwordx4 v164, s[16:19], s91 offen nt lds
    s_add_u32 m0, m0, 4096
    s_add_u32 s91, s91, 393216
    buffer_load_dwordx4 v164, s[16:19], s91 offen nt lds
    s_add_u32 m0, m0, 4096
    s_add_u32 s91, s91, 393216
    buffer_load_dwordx4 v164, s[16:19], s91 offen nt lds
    s_mov_b32 s46, 0
    s_lshl_b32 s90, s32, 10
    s_add_u32 m0, s90, 0
    s_nop 0
    buffer_load_dwordx4 v10, s[24:27], s46 offen offset:0 lds
    s_add_u32 m0, m0, 3968
    s_nop 0
    buffer_load_dwordx4 v10, s[24:27], s46 offen offset:128 lds
    s_add_u32 m0, m0, 3968
    s_nop 0
    buffer_load_dwordx4 v10, s[24:27], s46 offen offset:256 lds
    s_add_u32 m0, m0, 3968
    s_nop 0
    buffer_load_dwordx4 v10, s[24:27], s46 offen offset:384 lds
    s_add_u32 m0, m0, 3968
    s_nop 0
    buffer_load_dwordx4 v10, s[24:27], s46 offen offset:512 lds
    s_add_u32 m0, m0, 3968
    s_nop 0
    buffer_load_dwordx4 v10, s[24:27], s46 offen offset:640 lds
    s_add_u32 m0, m0, 3968
    s_nop 0
    buffer_load_dwordx4 v10, s[24:27], s46 offen offset:768 lds
    s_add_u32 m0, m0, 3968
    s_nop 0
    buffer_load_dwordx4 v10, s[24:27], s46 offen offset:896 lds
    s_add_u32 m0, m0, 3968
    s_nop 0
    buffer_load_dwordx4 v10, s[24:27], s46 offen offset:1024 lds
    s_add_u32 m0, m0, 3968
    s_nop 0
    buffer_load_dwordx4 v10, s[24:27], s46 offen offset:1152 lds
    s_mul_i32 s90, s40, 3072
    s_lshl_b32 s91, s41, 10
    s_add_u32 s90, s90, s91
    s_lshl_b32 s91, s32, 8
    s_add_u32 s91, s91, s90
    s_add_u32 s91, s91, 25600
    v_lshl_add_u32 v226, v0, 2, s91
    v_lshl_add_u32 v21, v1, 4, s91
    v_cmp_eq_u32 vcc, 0, v2
    v_mov_b32 v9, 2146435072
    s_nop 0
    v_cndmask_b32 v21, v9, v21, vcc
    v_lshrrev_b32 v3, 2, v1
    v_lshlrev_b32 v3, 1, v3
    v_and_b32 v4, 1, v1
    v_or_b32 v3, v3, v4
    v_lshl_add_u32 v3, v2, 3, v3
    v_lshl_add_u32 v26, v3, 4, s90
    v_and_b32 v4, 2, v1
    v_cmp_ne_u32 vcc, 0, v4
    v_mov_b32 v9, 2146435072
    s_nop 0
    v_cndmask_b32 v26, v9, v26, vcc
    s_mul_i32 s90, s40, 3840
    s_mul_i32 s91, s41, 1280
    s_add_u32 s90, s90, s91
    s_add_u32 s90, s90, 10240
    v_lshrrev_b32 v3, 1, v2
    v_and_b32 v5, 1, v2
    v_lshlrev_b32 v6, 1, v5
    v_or_b32 v7, v6, v3
    v_lshl_add_u32 v7, v7, 4, v1
    v_lshlrev_b32 v7, 2, v7
    v_add_u32 v7, 1024, v7
    v_or_b32 v6, v6, v1
    v_lshl_add_u32 v6, v3, 4, v6
    v_lshlrev_b32 v6, 4, v6
    s_sub_u32 s91, s32, 1
    s_lshl_b32 s91, s91, 9
    v_add_u32 v6, s91, v6
    s_cmp_eq_u32 s32, 0
    s_cselect_b64 vcc, -1, 0
    v_cndmask_b32 v6, v6, v7, vcc
    v_add_u32 v25, s90, v6
    s_lshl_b32 s91, s32, 8
    s_add_u32 s91, s91, s90
    v_lshl_add_u32 v227, v0, 2, s91
    v_cmp_eq_u32 vcc, 0, v4
    v_mov_b32 v9, 2146435072
    s_nop 0
    v_cndmask_b32 v25, v9, v25, vcc
    s_and_b32 s90, s32, 1
    s_lshl_b32 s90, s90, 9
    s_lshr_b32 s91, s32, 1
    s_lshl_b32 s91, s91, 10
    s_add_u32 s90, s90, s91
    v_lshlrev_b32 v6, 4, v1
    v_lshl_add_u32 v6, v3, 8, v6
    v_add_u32 v6, s90, v6
    v_lshl_add_u32 v27, v5, 11, v6
    v_add_u32 v27, 136192, v27
    s_mul_i32 s90, s40, 12288
    s_lshl_b32 s91, s41, 11
    s_add_u32 s90, s90, s91
    v_mul_u32_u24 v7, 6144, v5
    v_add3_u32 v29, v6, v7, s90
    v_and_b32 v6, 9, v1
    v_and_b32 v7, 2, v1
    v_lshl_or_b32 v6, v7, 1, v6
    v_and_b32 v7, 4, v1
    v_lshrrev_b32 v7, 1, v7
    v_or_b32 v6, v6, v7
    v_lshlrev_b32 v6, 4, v6
    v_lshl_add_u32 v6, v2, 8, v6
    s_cmp_eq_u32 s32, 2
    s_cselect_b32 s90, 2048, 0
    s_add_u32 s90, s90, 136192
    v_add_u32 v28, s90, v6
    s_lshl_b32 s90, s40, 7
    s_lshl_b32 s91, s41, 2
    s_add_u32 s92, s91, s32
    s_lshl_b32 s92, s92, 2
    s_add_u32 s92, s92, s90
    s_add_u32 s92, s92, 458752
    v_mov_b32 v30, s92
    s_add_u32 s91, s91, s90
    s_add_u32 s91, s91, 459264
    s_cmp_eq_u32 s32, 3
    s_cselect_b32 s91, s91, 2146435072
    v_mov_b32 v31, s91
    v_cmp_eq_u32 vcc, 0, v0
    v_mov_b32 v9, 2146435072
    s_nop 0
    v_cndmask_b32 v30, v9, v30, vcc
    v_cndmask_b32 v220, 1, 3, vcc
    v_cmp_eq_u32 vcc, 1, v0
    v_add_u32 v225, 3072, v31
    s_nop 0
    v_cndmask_b32 v225, v9, v225, vcc
    v_cndmask_b32 v31, v30, v31, vcc
    v_mov_b32 v36, -1
    v_mov_b32 v37, -1
    v_mov_b32 v38, -1
    v_mov_b32 v39, -1
    s_mul_i32 s90, s35, 32768
    s_lshl_b32 s91, s32, 11
    s_add_u32 s90, s90, s91
    s_lshl_b32 s92, s35, 10
    s_lshl_b32 s91, s32, 8
    s_add_u32 s92, s92, s91
    s_cmp_lt_u32 s35, 10
    s_cselect_b32 s90, s90, 2146435072
    s_cselect_b32 s92, s92, 2146435072
    v_lshl_add_u32 v214, v0, 4, s90
    v_add_u32 v215, 1024, v214
    s_min_u32 s90, s35, 9
    s_lshl_b32 s90, s90, 7
    s_add_u32 s90, s90, 460800
    v_and_b32 v3, 3, v0
    v_lshl_add_u32 v216, v3, 2, s90
    v_lshl_add_u32 v219, v0, 2, s92
    v_lshl_add_u32 v218, v1, 4, s92
    v_cmp_eq_u32 vcc, 0, v2
    v_mov_b32 v9, 2146435072
    s_nop 0
    v_cndmask_b32 v218, v9, v218, vcc
    v_and_b32 v7, 1, v1
    v_cmp_ne_u32 vcc, 0, v7
    v_mov_b32 v5, 0x3f80
    v_mov_b32 v6, 0x3f800000
    v_cndmask_b32 v5, v5, v6, vcc
    v_bfe_u32 v6, v1, 1, 1
    v_cmp_eq_u32 vcc, 0, v6
    s_nop 1
    v_cndmask_b32 v210, 0, v5, vcc
    v_mov_b32 v208, 0
    v_mov_b32 v212, 0
    v_cmp_eq_u32 vcc, 1, v6
    s_nop 1
    v_cndmask_b32 v211, 0, v5, vcc
    v_mov_b32 v209, 0
    v_mov_b32 v213, 0
    v_lshrrev_b32 v3, 2, v1
    v_and_b32 v4, 3, v1
    v_and_b32 v5, 1, v2
    v_lshl_add_u32 v6, v2, 3, v3
    v_lshlrev_b32 v6, 7, v6
    v_and_b32 v7, 2, v3
    v_lshl_or_b32 v7, v5, 2, v7
    v_lshrrev_b32 v8, 1, v4
    s_lshl_b32 s90, s32, 1
    v_or_b32 v8, s90, v8
    v_xor_b32 v7, v7, v8
    v_lshl_add_u32 v6, v7, 4, v6
    v_and_b32 v7, 1, v4
    v_lshl_add_u32 v6, v7, 3, v6
    v_add_u32 v165, 40960, v6
    v_add_u32 v166, 81920, v6
    v_add_u32 v167, 122880, v6
    v_xor_b32 v6, 0, v5
    v_lshl_add_u32 v6, v6, 2, v3
    v_lshl_add_u32 v6, v2, 3, v6
    v_lshlrev_b32 v6, 5, v6
    v_lshl_or_b32 v7, v5, 1, 0
    v_xor_b32 v7, v7, v4
    v_lshl_add_u32 v6, v7, 3, v6
    v_add_u32 v23, 133120, v6
    v_xor_b32 v6, 1, v5
    v_lshl_add_u32 v6, v6, 2, v3
    v_lshl_add_u32 v6, v2, 3, v6
    v_lshlrev_b32 v6, 5, v6
    v_lshl_or_b32 v7, v5, 1, 1
    v_xor_b32 v7, v7, v4
    v_lshl_add_u32 v6, v7, 3, v6
    v_add_u32 v24, 133120, v6
    v_lshrrev_b32 v6, 3, v1
    v_lshlrev_b32 v6, 2, v6
    v_xor_b32 v6, v6, v1
    v_lshlrev_b32 v6, 5, v6
    v_xor_b32 v7, v2, v3
    v_lshl_add_u32 v6, v7, 3, v6
    s_lshl_b32 s90, s32, 9
    s_add_u32 s90, s90, 133120
    v_add_u32 v22, s90, v6
    v_lshlrev_b32 v6, 6, v3
    v_and_b32 v7, 1, v1
    v_lshl_add_u32 v6, v7, 5, v6
    v_lshl_add_u32 v6, v2, 3, v6
    v_and_b32 v7, 2, v1
    v_lshl_add_u32 v6, v7, 1, v6
    s_lshl_b32 s90, s32, 8
    s_add_u32 s90, s90, 135168
    v_add_u32 v19, s90, v6
    v_lshl_add_u32 v20, v1, 3, s90
    v_cmp_ne_u32 vcc, 0, v7
    v_mov_b32 v6, 0x4444
    v_mov_b32 v8, 0xeeee
    v_cndmask_b32 v18, v6, v8, vcc
    v_lshlrev_b32 v6, 4, v0
    v_add_u32 v16, 122880, v6
    s_mul_i32 s90, s32, 2560
    v_lshl_add_u32 v13, v0, 4, s90
    v_lshl_add_u32 v14, v0, 2, s90
    s_add_u32 s48, s90, 122880
    v_mul_u32_u24 v6, 40, v0
    v_add_u32 v15, s48, v6
    v_lshrrev_b32 v6, 3, v1
    v_lshlrev_b32 v6, 10, v6
    v_and_b32 v7, 7, v1
    v_lshl_add_u32 v6, v7, 7, v6
    v_lshrrev_b32 v7, 1, v1
    v_xor_b32 v7, v7, v2
    v_lshl_add_u32 v11, v7, 4, v6
    v_xor_b32 v12, 64, v11
    s_waitcnt vmcnt(30)
    s_barrier
    ds_read_b64_tr_b16 a[160:161], v165 offset:0
    ds_read_b64_tr_b16 a[162:163], v165 offset:512
    ds_read_b64_tr_b16 a[164:165], v165 offset:4096
    ds_read_b64_tr_b16 a[166:167], v165 offset:4608
    ds_read_b64_tr_b16 a[168:169], v165 offset:8192
    ds_read_b64_tr_b16 a[170:171], v165 offset:8704
    ds_read_b64_tr_b16 a[172:173], v165 offset:12288
    ds_read_b64_tr_b16 a[174:175], v165 offset:12800
    ds_read_b64_tr_b16 a[176:177], v165 offset:16384
    ds_read_b64_tr_b16 a[178:179], v165 offset:16896
    ds_read_b64_tr_b16 a[180:181], v165 offset:20480
    ds_read_b64_tr_b16 a[182:183], v165 offset:20992
    ds_read_b64_tr_b16 a[184:185], v165 offset:24576
    ds_read_b64_tr_b16 a[186:187], v165 offset:25088
    ds_read_b64_tr_b16 a[188:189], v165 offset:28672
    ds_read_b64_tr_b16 a[190:191], v165 offset:29184
    ds_read_b64_tr_b16 a[192:193], v165 offset:32768
    ds_read_b64_tr_b16 a[194:195], v165 offset:33280
    ds_read_b64_tr_b16 a[196:197], v165 offset:36864
    ds_read_b64_tr_b16 a[198:199], v165 offset:37376
    s_waitcnt lgkmcnt(0)
    s_barrier
    s_lshl_b32 s90, s32, 10
    s_add_u32 m0, s90, 40960
    s_mov_b32 s91, 3932160
    buffer_load_dwordx4 v164, s[16:19], s91 offen nt lds
    s_add_u32 m0, m0, 4096
    s_add_u32 s91, s91, 393216
    buffer_load_dwordx4 v164, s[16:19], s91 offen nt lds
    s_add_u32 m0, m0, 4096
    s_add_u32 s91, s91, 393216
    buffer_load_dwordx4 v164, s[16:19], s91 offen nt lds
    s_add_u32 m0, m0, 4096
    s_add_u32 s91, s91, 393216
    buffer_load_dwordx4 v164, s[16:19], s91 offen nt lds
    s_add_u32 m0, m0, 4096
    s_add_u32 s91, s91, 393216
    buffer_load_dwordx4 v164, s[16:19], s91 offen nt lds
    s_add_u32 m0, m0, 4096
    s_add_u32 s91, s91, 393216
    buffer_load_dwordx4 v164, s[16:19], s91 offen nt lds
    s_add_u32 m0, m0, 4096
    s_add_u32 s91, s91, 393216
    buffer_load_dwordx4 v164, s[16:19], s91 offen nt lds
    s_add_u32 m0, m0, 4096
    s_add_u32 s91, s91, 393216
    buffer_load_dwordx4 v164, s[16:19], s91 offen nt lds
    s_add_u32 m0, m0, 4096
    s_add_u32 s91, s91, 393216
    buffer_load_dwordx4 v164, s[16:19], s91 offen nt lds
    s_add_u32 m0, m0, 4096
    s_add_u32 s91, s91, 393216
    buffer_load_dwordx4 v164, s[16:19], s91 offen nt lds
    s_waitcnt vmcnt(30)
    s_barrier
    ds_read_b64_tr_b16 a[200:201], v166 offset:0
    ds_read_b64_tr_b16 a[202:203], v166 offset:512
    ds_read_b64_tr_b16 a[204:205], v166 offset:4096
    ds_read_b64_tr_b16 a[206:207], v166 offset:4608
    ds_read_b64_tr_b16 a[208:209], v166 offset:8192
    ds_read_b64_tr_b16 a[210:211], v166 offset:8704
    ds_read_b64_tr_b16 a[212:213], v166 offset:12288
    ds_read_b64_tr_b16 a[214:215], v166 offset:12800
    ds_read_b64_tr_b16 a[216:217], v166 offset:16384
    ds_read_b64_tr_b16 a[218:219], v166 offset:16896
    ds_read_b64_tr_b16 a[220:221], v166 offset:20480
    ds_read_b64_tr_b16 a[222:223], v166 offset:20992
    ds_read_b64_tr_b16 a[224:225], v166 offset:24576
    ds_read_b64_tr_b16 a[226:227], v166 offset:25088
    ds_read_b64_tr_b16 a[228:229], v166 offset:28672
    ds_read_b64_tr_b16 a[230:231], v166 offset:29184
    ds_read_b64_tr_b16 a[232:233], v166 offset:32768
    ds_read_b64_tr_b16 a[234:235], v166 offset:33280
    ds_read_b64_tr_b16 a[236:237], v166 offset:36864
    ds_read_b64_tr_b16 a[238:239], v166 offset:37376
    s_waitcnt lgkmcnt(0)
    s_barrier
    s_lshl_b32 s90, s32, 10
    s_add_u32 m0, s90, 81920
    s_mov_b32 s91, 0
    buffer_load_dwordx4 v164, s[12:15], s91 offen nt lds
    s_add_u32 m0, m0, 4096
    s_add_u32 s91, s91, 393216
    buffer_load_dwordx4 v164, s[12:15], s91 offen nt lds
    s_add_u32 m0, m0, 4096
    s_add_u32 s91, s91, 393216
    buffer_load_dwordx4 v164, s[12:15], s91 offen nt lds
    s_add_u32 m0, m0, 4096
    s_add_u32 s91, s91, 393216
    buffer_load_dwordx4 v164, s[12:15], s91 offen nt lds
    s_add_u32 m0, m0, 4096
    s_add_u32 s91, s91, 393216
    buffer_load_dwordx4 v164, s[12:15], s91 offen nt lds
    s_add_u32 m0, m0, 4096
    s_add_u32 s91, s91, 393216
    buffer_load_dwordx4 v164, s[12:15], s91 offen nt lds
    s_add_u32 m0, m0, 4096
    s_add_u32 s91, s91, 393216
    buffer_load_dwordx4 v164, s[12:15], s91 offen nt lds
    s_add_u32 m0, m0, 4096
    s_add_u32 s91, s91, 393216
    buffer_load_dwordx4 v164, s[12:15], s91 offen nt lds
    s_add_u32 m0, m0, 4096
    s_add_u32 s91, s91, 393216
    buffer_load_dwordx4 v164, s[12:15], s91 offen nt lds
    s_add_u32 m0, m0, 4096
    s_add_u32 s91, s91, 393216
    buffer_load_dwordx4 v164, s[12:15], s91 offen nt lds
    s_waitcnt vmcnt(30)
    s_barrier
    ds_read_b64_tr_b16 a[80:81], v167 offset:0
    ds_read_b64_tr_b16 a[82:83], v167 offset:512
    ds_read_b64_tr_b16 a[84:85], v167 offset:4096
    ds_read_b64_tr_b16 a[86:87], v167 offset:4608
    ds_read_b64_tr_b16 a[88:89], v167 offset:8192
    ds_read_b64_tr_b16 a[90:91], v167 offset:8704
    ds_read_b64_tr_b16 a[92:93], v167 offset:12288
    ds_read_b64_tr_b16 a[94:95], v167 offset:12800
    ds_read_b64_tr_b16 a[96:97], v167 offset:16384
    ds_read_b64_tr_b16 a[98:99], v167 offset:16896
    ds_read_b64_tr_b16 a[100:101], v167 offset:20480
    ds_read_b64_tr_b16 a[102:103], v167 offset:20992
    ds_read_b64_tr_b16 a[104:105], v167 offset:24576
    ds_read_b64_tr_b16 a[106:107], v167 offset:25088
    ds_read_b64_tr_b16 a[108:109], v167 offset:28672
    ds_read_b64_tr_b16 a[110:111], v167 offset:29184
    ds_read_b64_tr_b16 a[112:113], v167 offset:32768
    ds_read_b64_tr_b16 a[114:115], v167 offset:33280
    ds_read_b64_tr_b16 a[116:117], v167 offset:36864
    ds_read_b64_tr_b16 a[118:119], v167 offset:37376
    s_waitcnt lgkmcnt(0)
    s_barrier
    s_lshl_b32 s90, s32, 10
    s_add_u32 m0, s90, 122880
    s_mov_b32 s91, 3932160
    buffer_load_dwordx4 v164, s[12:15], s91 offen nt lds
    s_add_u32 m0, m0, 4096
    s_add_u32 s91, s91, 393216
    buffer_load_dwordx4 v164, s[12:15], s91 offen nt lds
    s_add_u32 m0, m0, 4096
    s_add_u32 s91, s91, 393216
    buffer_load_dwordx4 v164, s[12:15], s91 offen nt lds
    s_add_u32 m0, m0, 4096
    s_add_u32 s91, s91, 393216
    buffer_load_dwordx4 v164, s[12:15], s91 offen nt lds
    s_add_u32 m0, m0, 4096
    s_add_u32 s91, s91, 393216
    buffer_load_dwordx4 v164, s[12:15], s91 offen nt lds
    s_add_u32 m0, m0, 4096
    s_add_u32 s91, s91, 393216
    buffer_load_dwordx4 v164, s[12:15], s91 offen nt lds
    s_add_u32 m0, m0, 4096
    s_add_u32 s91, s91, 393216
    buffer_load_dwordx4 v164, s[12:15], s91 offen nt lds
    s_add_u32 m0, m0, 4096
    s_add_u32 s91, s91, 393216
    buffer_load_dwordx4 v164, s[12:15], s91 offen nt lds
    s_add_u32 m0, m0, 4096
    s_add_u32 s91, s91, 393216
    buffer_load_dwordx4 v164, s[12:15], s91 offen nt lds
    s_add_u32 m0, m0, 4096
    s_add_u32 s91, s91, 393216
    buffer_load_dwordx4 v164, s[12:15], s91 offen nt lds
    s_waitcnt vmcnt(20)
    s_barrier
    ds_read_b64_tr_b16 a[120:121], v165 offset:0
    ds_read_b64_tr_b16 a[122:123], v165 offset:512
    ds_read_b64_tr_b16 a[124:125], v165 offset:4096
    ds_read_b64_tr_b16 a[126:127], v165 offset:4608
    ds_read_b64_tr_b16 a[128:129], v165 offset:8192
    ds_read_b64_tr_b16 a[130:131], v165 offset:8704
    ds_read_b64_tr_b16 a[132:133], v165 offset:12288
    ds_read_b64_tr_b16 a[134:135], v165 offset:12800
    ds_read_b64_tr_b16 a[136:137], v165 offset:16384
    ds_read_b64_tr_b16 a[138:139], v165 offset:16896
    ds_read_b64_tr_b16 a[140:141], v165 offset:20480
    ds_read_b64_tr_b16 a[142:143], v165 offset:20992
    ds_read_b64_tr_b16 a[144:145], v165 offset:24576
    ds_read_b64_tr_b16 a[146:147], v165 offset:25088
    ds_read_b64_tr_b16 a[148:149], v165 offset:28672
    ds_read_b64_tr_b16 a[150:151], v165 offset:29184
    ds_read_b64_tr_b16 a[152:153], v165 offset:32768
    ds_read_b64_tr_b16 a[154:155], v165 offset:33280
    ds_read_b64_tr_b16 a[156:157], v165 offset:36864
    ds_read_b64_tr_b16 a[158:159], v165 offset:37376
    s_waitcnt lgkmcnt(0)
    s_barrier
    s_mov_b32 s46, 40960
    s_lshl_b32 s90, s32, 10
    s_add_u32 m0, s90, 40960
    s_nop 0
    buffer_load_dwordx4 v10, s[24:27], s46 offen offset:0 lds
    s_add_u32 m0, m0, 3968
    s_nop 0
    buffer_load_dwordx4 v10, s[24:27], s46 offen offset:128 lds
    s_add_u32 m0, m0, 3968
    s_nop 0
    buffer_load_dwordx4 v10, s[24:27], s46 offen offset:256 lds
    s_add_u32 m0, m0, 3968
    s_nop 0
    buffer_load_dwordx4 v10, s[24:27], s46 offen offset:384 lds
    s_add_u32 m0, m0, 3968
    s_nop 0
    buffer_load_dwordx4 v10, s[24:27], s46 offen offset:512 lds
    s_add_u32 m0, m0, 3968
    s_nop 0
    buffer_load_dwordx4 v10, s[24:27], s46 offen offset:640 lds
    s_add_u32 m0, m0, 3968
    s_nop 0
    buffer_load_dwordx4 v10, s[24:27], s46 offen offset:768 lds
    s_add_u32 m0, m0, 3968
    s_nop 0
    buffer_load_dwordx4 v10, s[24:27], s46 offen offset:896 lds
    s_add_u32 m0, m0, 3968
    s_nop 0
    buffer_load_dwordx4 v10, s[24:27], s46 offen offset:1024 lds
    s_add_u32 m0, m0, 3968
    s_nop 0
    buffer_load_dwordx4 v10, s[24:27], s46 offen offset:1152 lds
    s_waitcnt vmcnt(20)
    s_barrier
    ds_read_b64_tr_b16 a[0:1], v166 offset:0
    ds_read_b64_tr_b16 a[2:3], v166 offset:512
    ds_read_b64_tr_b16 a[4:5], v166 offset:4096
    ds_read_b64_tr_b16 a[6:7], v166 offset:4608
    ds_read_b64_tr_b16 a[8:9], v166 offset:8192
    ds_read_b64_tr_b16 a[10:11], v166 offset:8704
    ds_read_b64_tr_b16 a[12:13], v166 offset:12288
    ds_read_b64_tr_b16 a[14:15], v166 offset:12800
    ds_read_b64_tr_b16 a[16:17], v166 offset:16384
    ds_read_b64_tr_b16 a[18:19], v166 offset:16896
    ds_read_b64_tr_b16 a[20:21], v166 offset:20480
    ds_read_b64_tr_b16 a[22:23], v166 offset:20992
    ds_read_b64_tr_b16 a[24:25], v166 offset:24576
    ds_read_b64_tr_b16 a[26:27], v166 offset:25088
    ds_read_b64_tr_b16 a[28:29], v166 offset:28672
    ds_read_b64_tr_b16 a[30:31], v166 offset:29184
    ds_read_b64_tr_b16 a[32:33], v166 offset:32768
    ds_read_b64_tr_b16 a[34:35], v166 offset:33280
    ds_read_b64_tr_b16 a[36:37], v166 offset:36864
    ds_read_b64_tr_b16 a[38:39], v166 offset:37376
    s_waitcnt lgkmcnt(0)
    s_barrier
    s_waitcnt vmcnt(10)
    s_barrier
    ds_read_b64_tr_b16 a[40:41], v167 offset:0
    ds_read_b64_tr_b16 a[42:43], v167 offset:512
    ds_read_b64_tr_b16 a[44:45], v167 offset:4096
    ds_read_b64_tr_b16 a[46:47], v167 offset:4608
    ds_read_b64_tr_b16 a[48:49], v167 offset:8192
    ds_read_b64_tr_b16 a[50:51], v167 offset:8704
    ds_read_b64_tr_b16 a[52:53], v167 offset:12288
    ds_read_b64_tr_b16 a[54:55], v167 offset:12800
    ds_read_b64_tr_b16 a[56:57], v167 offset:16384
    ds_read_b64_tr_b16 a[58:59], v167 offset:16896
    ds_read_b64_tr_b16 a[60:61], v167 offset:20480
    ds_read_b64_tr_b16 a[62:63], v167 offset:20992
    ds_read_b64_tr_b16 a[64:65], v167 offset:24576
    ds_read_b64_tr_b16 a[66:67], v167 offset:25088
    ds_read_b64_tr_b16 a[68:69], v167 offset:28672
    ds_read_b64_tr_b16 a[70:71], v167 offset:29184
    ds_read_b64_tr_b16 a[72:73], v167 offset:32768
    ds_read_b64_tr_b16 a[74:75], v167 offset:33280
    ds_read_b64_tr_b16 a[76:77], v167 offset:36864
    ds_read_b64_tr_b16 a[78:79], v167 offset:37376
    s_waitcnt lgkmcnt(0)
    s_barrier
    s_mov_b32 s49, 40960
    s_mov_b32 s47, 40960
    s_add_u32 s45, s38, 475136
    s_add_u32 s50, s45, 49152
    s_add_u32 s51, s38, 65536
    v_add_u32 v34, 0, v27
    s_mov_b32 s46, 40960
    ds_read_b128 v[116:119], v11 offset:0
    ds_read_b128 v[120:123], v11 offset:2048
    ds_read_b128 v[124:127], v12 offset:0
    ds_read_b128 v[128:131], v12 offset:2048
    s_waitcnt lgkmcnt(2)
    v_mfma_f32_16x16x32_bf16 v[140:143], a[160:163], v[116:119], 0
    ds_read_b128 v[132:135], v11 offset:4096
    v_mfma_f32_16x16x32_bf16 v[144:147], a[160:163], v[120:123], 0
    ds_read_b128 v[136:139], v11 offset:6144
    v_mfma_f32_16x16x32_bf16 v[148:151], a[80:83], v[116:119], 0
    v_mfma_f32_16x16x32_bf16 v[152:155], a[80:83], v[120:123], 0
    v_mfma_f32_16x16x32_bf16 v[156:159], a[0:3], v[116:119], 0
    v_mfma_f32_16x16x32_bf16 v[160:163], a[0:3], v[120:123], 0
    s_waitcnt lgkmcnt(2)
    v_mfma_f32_16x16x32_bf16 v[140:143], a[164:167], v[124:127], v[140:143]
    ds_read_b128 v[116:119], v12 offset:4096
    v_mfma_f32_16x16x32_bf16 v[144:147], a[164:167], v[128:131], v[144:147]
    ds_read_b128 v[120:123], v12 offset:6144
    v_mfma_f32_16x16x32_bf16 v[148:151], a[84:87], v[124:127], v[148:151]
    v_mfma_f32_16x16x32_bf16 v[152:155], a[84:87], v[128:131], v[152:155]
    v_mfma_f32_16x16x32_bf16 v[156:159], a[4:7], v[124:127], v[156:159]
    v_mfma_f32_16x16x32_bf16 v[160:163], a[4:7], v[128:131], v[160:163]
    s_waitcnt lgkmcnt(2)
    v_mfma_f32_16x16x32_bf16 v[140:143], a[168:171], v[132:135], v[140:143]
    ds_read_b128 v[124:127], v11 offset:8192
    v_mfma_f32_16x16x32_bf16 v[144:147], a[168:171], v[136:139], v[144:147]
    ds_read_b128 v[128:131], v11 offset:10240
    v_mfma_f32_16x16x32_bf16 v[148:151], a[88:91], v[132:135], v[148:151]
    v_mfma_f32_16x16x32_bf16 v[152:155], a[88:91], v[136:139], v[152:155]
    v_mfma_f32_16x16x32_bf16 v[156:159], a[8:11], v[132:135], v[156:159]
    v_mfma_f32_16x16x32_bf16 v[160:163], a[8:11], v[136:139], v[160:163]
    s_waitcnt lgkmcnt(2)
    v_mfma_f32_16x16x32_bf16 v[140:143], a[172:175], v[116:119], v[140:143]
    ds_read_b128 v[132:135], v12 offset:8192
    v_mfma_f32_16x16x32_bf16 v[144:147], a[172:175], v[120:123], v[144:147]
    ds_read_b128 v[136:139], v12 offset:10240
    v_mfma_f32_16x16x32_bf16 v[148:151], a[92:95], v[116:119], v[148:151]
    v_mfma_f32_16x16x32_bf16 v[152:155], a[92:95], v[120:123], v[152:155]
    v_mfma_f32_16x16x32_bf16 v[156:159], a[12:15], v[116:119], v[156:159]
    v_mfma_f32_16x16x32_bf16 v[160:163], a[12:15], v[120:123], v[160:163]
    s_waitcnt lgkmcnt(2)
    v_mfma_f32_16x16x32_bf16 v[140:143], a[176:179], v[124:127], v[140:143]
    ds_read_b128 v[116:119], v11 offset:12288
    v_mfma_f32_16x16x32_bf16 v[144:147], a[176:179], v[128:131], v[144:147]
    ds_read_b128 v[120:123], v11 offset:14336
    v_mfma_f32_16x16x32_bf16 v[148:151], a[96:99], v[124:127], v[148:151]
    v_mfma_f32_16x16x32_bf16 v[152:155], a[96:99], v[128:131], v[152:155]
    v_mfma_f32_16x16x32_bf16 v[156:159], a[16:19], v[124:127], v[156:159]
    v_mfma_f32_16x16x32_bf16 v[160:163], a[16:19], v[128:131], v[160:163]
    s_waitcnt lgkmcnt(2)
    v_mfma_f32_16x16x32_bf16 v[140:143], a[180:183], v[132:135], v[140:143]
    ds_read_b128 v[124:127], v12 offset:12288
    v_mfma_f32_16x16x32_bf16 v[144:147], a[180:183], v[136:139], v[144:147]
    ds_read_b128 v[128:131], v12 offset:14336
    v_mfma_f32_16x16x32_bf16 v[148:151], a[100:103], v[132:135], v[148:151]
    v_mfma_f32_16x16x32_bf16 v[152:155], a[100:103], v[136:139], v[152:155]
    v_mfma_f32_16x16x32_bf16 v[156:159], a[20:23], v[132:135], v[156:159]
    v_mfma_f32_16x16x32_bf16 v[160:163], a[20:23], v[136:139], v[160:163]
    s_waitcnt lgkmcnt(2)
    v_mfma_f32_16x16x32_bf16 v[140:143], a[184:187], v[116:119], v[140:143]
    ds_read_b128 v[132:135], v11 offset:16384
    v_mfma_f32_16x16x32_bf16 v[144:147], a[184:187], v[120:123], v[144:147]
    ds_read_b128 v[136:139], v11 offset:18432
    v_mfma_f32_16x16x32_bf16 v[148:151], a[104:107], v[116:119], v[148:151]
    v_mfma_f32_16x16x32_bf16 v[152:155], a[104:107], v[120:123], v[152:155]
    v_mfma_f32_16x16x32_bf16 v[156:159], a[24:27], v[116:119], v[156:159]
    v_mfma_f32_16x16x32_bf16 v[160:163], a[24:27], v[120:123], v[160:163]
    s_waitcnt lgkmcnt(2)
    v_mfma_f32_16x16x32_bf16 v[140:143], a[188:191], v[124:127], v[140:143]
    ds_read_b128 v[116:119], v12 offset:16384
    v_mfma_f32_16x16x32_bf16 v[144:147], a[188:191], v[128:131], v[144:147]
    ds_read_b128 v[120:123], v12 offset:18432
    v_mfma_f32_16x16x32_bf16 v[148:151], a[108:111], v[124:127], v[148:151]
    v_mfma_f32_16x16x32_bf16 v[152:155], a[108:111], v[128:131], v[152:155]
    v_mfma_f32_16x16x32_bf16 v[156:159], a[28:31], v[124:127], v[156:159]
    v_mfma_f32_16x16x32_bf16 v[160:163], a[28:31], v[128:131], v[160:163]
    s_waitcnt lgkmcnt(2)
    v_mfma_f32_16x16x32_bf16 v[140:143], a[192:195], v[132:135], v[140:143]
    ds_read_b128 v[124:127], v11 offset:20480
    v_mfma_f32_16x16x32_bf16 v[144:147], a[192:195], v[136:139], v[144:147]
    ds_read_b128 v[128:131], v11 offset:22528
    v_mfma_f32_16x16x32_bf16 v[148:151], a[112:115], v[132:135], v[148:151]
    v_mfma_f32_16x16x32_bf16 v[152:155], a[112:115], v[136:139], v[152:155]
    v_mfma_f32_16x16x32_bf16 v[156:159], a[32:35], v[132:135], v[156:159]
    v_mfma_f32_16x16x32_bf16 v[160:163], a[32:35], v[136:139], v[160:163]
    s_waitcnt lgkmcnt(2)
    v_mfma_f32_16x16x32_bf16 v[140:143], a[196:199], v[116:119], v[140:143]
    ds_read_b128 v[132:135], v12 offset:20480
    v_mfma_f32_16x16x32_bf16 v[144:147], a[196:199], v[120:123], v[144:147]
    ds_read_b128 v[136:139], v12 offset:22528
    v_mfma_f32_16x16x32_bf16 v[148:151], a[116:119], v[116:119], v[148:151]
    v_mfma_f32_16x16x32_bf16 v[152:155], a[116:119], v[120:123], v[152:155]
    v_mfma_f32_16x16x32_bf16 v[156:159], a[36:39], v[116:119], v[156:159]
    v_mfma_f32_16x16x32_bf16 v[160:163], a[36:39], v[120:123], v[160:163]
    s_waitcnt lgkmcnt(2)
    v_mfma_f32_16x16x32_bf16 v[140:143], a[200:203], v[124:127], v[140:143]
    ds_read_b128 v[116:119], v11 offset:24576
    v_mfma_f32_16x16x32_bf16 v[144:147], a[200:203], v[128:131], v[144:147]
    ds_read_b128 v[120:123], v11 offset:26624
    v_mfma_f32_16x16x32_bf16 v[148:151], a[120:123], v[124:127], v[148:151]
    v_mfma_f32_16x16x32_bf16 v[152:155], a[120:123], v[128:131], v[152:155]
    v_mfma_f32_16x16x32_bf16 v[156:159], a[40:43], v[124:127], v[156:159]
    v_mfma_f32_16x16x32_bf16 v[160:163], a[40:43], v[128:131], v[160:163]
    s_waitcnt lgkmcnt(2)
    v_mfma_f32_16x16x32_bf16 v[140:143], a[204:207], v[132:135], v[140:143]
    ds_read_b128 v[124:127], v12 offset:24576
    v_mfma_f32_16x16x32_bf16 v[144:147], a[204:207], v[136:139], v[144:147]
    ds_read_b128 v[128:131], v12 offset:26624
    v_mfma_f32_16x16x32_bf16 v[148:151], a[124:127], v[132:135], v[148:151]
    v_mfma_f32_16x16x32_bf16 v[152:155], a[124:127], v[136:139], v[152:155]
    v_mfma_f32_16x16x32_bf16 v[156:159], a[44:47], v[132:135], v[156:159]
    v_mfma_f32_16x16x32_bf16 v[160:163], a[44:47], v[136:139], v[160:163]
    s_waitcnt lgkmcnt(2)
    v_mfma_f32_16x16x32_bf16 v[140:143], a[208:211], v[116:119], v[140:143]
    ds_read_b128 v[132:135], v11 offset:28672
    v_mfma_f32_16x16x32_bf16 v[144:147], a[208:211], v[120:123], v[144:147]
    ds_read_b128 v[136:139], v11 offset:30720
    v_mfma_f32_16x16x32_bf16 v[148:151], a[128:131], v[116:119], v[148:151]
    v_mfma_f32_16x16x32_bf16 v[152:155], a[128:131], v[120:123], v[152:155]
    v_mfma_f32_16x16x32_bf16 v[156:159], a[48:51], v[116:119], v[156:159]
    v_mfma_f32_16x16x32_bf16 v[160:163], a[48:51], v[120:123], v[160:163]
    s_waitcnt lgkmcnt(2)
    v_mfma_f32_16x16x32_bf16 v[140:143], a[212:215], v[124:127], v[140:143]
    ds_read_b128 v[116:119], v12 offset:28672
    v_mfma_f32_16x16x32_bf16 v[144:147], a[212:215], v[128:131], v[144:147]
    ds_read_b128 v[120:123], v12 offset:30720
    v_mfma_f32_16x16x32_bf16 v[148:151], a[132:135], v[124:127], v[148:151]
    v_mfma_f32_16x16x32_bf16 v[152:155], a[132:135], v[128:131], v[152:155]
    v_mfma_f32_16x16x32_bf16 v[156:159], a[52:55], v[124:127], v[156:159]
    v_mfma_f32_16x16x32_bf16 v[160:163], a[52:55], v[128:131], v[160:163]
    s_waitcnt lgkmcnt(2)
    v_mfma_f32_16x16x32_bf16 v[140:143], a[216:219], v[132:135], v[140:143]
    ds_read_b128 v[124:127], v11 offset:32768
    v_mfma_f32_16x16x32_bf16 v[144:147], a[216:219], v[136:139], v[144:147]
    ds_read_b128 v[128:131], v11 offset:34816
    v_mfma_f32_16x16x32_bf16 v[148:151], a[136:139], v[132:135], v[148:151]
    v_mfma_f32_16x16x32_bf16 v[152:155], a[136:139], v[136:139], v[152:155]
    v_mfma_f32_16x16x32_bf16 v[156:159], a[56:59], v[132:135], v[156:159]
    v_mfma_f32_16x16x32_bf16 v[160:163], a[56:59], v[136:139], v[160:163]
    s_waitcnt lgkmcnt(2)
    v_mfma_f32_16x16x32_bf16 v[140:143], a[220:223], v[116:119], v[140:143]
    ds_read_b128 v[132:135], v12 offset:32768
    v_mfma_f32_16x16x32_bf16 v[144:147], a[220:223], v[120:123], v[144:147]
    ds_read_b128 v[136:139], v12 offset:34816
    v_mfma_f32_16x16x32_bf16 v[148:151], a[140:143], v[116:119], v[148:151]
    v_mfma_f32_16x16x32_bf16 v[152:155], a[140:143], v[120:123], v[152:155]
    v_mfma_f32_16x16x32_bf16 v[156:159], a[60:63], v[116:119], v[156:159]
    v_mfma_f32_16x16x32_bf16 v[160:163], a[60:63], v[120:123], v[160:163]
    s_waitcnt lgkmcnt(2)
    v_mfma_f32_16x16x32_bf16 v[140:143], a[224:227], v[124:127], v[140:143]
    ds_read_b128 v[116:119], v11 offset:36864
    v_mfma_f32_16x16x32_bf16 v[144:147], a[224:227], v[128:131], v[144:147]
    ds_read_b128 v[120:123], v11 offset:38912
    v_mfma_f32_16x16x32_bf16 v[148:151], a[144:147], v[124:127], v[148:151]
    v_mfma_f32_16x16x32_bf16 v[152:155], a[144:147], v[128:131], v[152:155]
    v_mfma_f32_16x16x32_bf16 v[156:159], a[64:67], v[124:127], v[156:159]
    v_mfma_f32_16x16x32_bf16 v[160:163], a[64:67], v[128:131], v[160:163]
    s_waitcnt lgkmcnt(2)
    v_mfma_f32_16x16x32_bf16 v[140:143], a[228:231], v[132:135], v[140:143]
    ds_read_b128 v[124:127], v12 offset:36864
    v_mfma_f32_16x16x32_bf16 v[144:147], a[228:231], v[136:139], v[144:147]
    ds_read_b128 v[128:131], v12 offset:38912
    v_mfma_f32_16x16x32_bf16 v[148:151], a[148:151], v[132:135], v[148:151]
    v_mfma_f32_16x16x32_bf16 v[152:155], a[148:151], v[136:139], v[152:155]
    v_mfma_f32_16x16x32_bf16 v[156:159], a[68:71], v[132:135], v[156:159]
    v_mfma_f32_16x16x32_bf16 v[160:163], a[68:71], v[136:139], v[160:163]
    s_waitcnt lgkmcnt(0)
    v_mfma_f32_16x16x32_bf16 v[140:143], a[232:235], v[116:119], v[140:143]
    v_mfma_f32_16x16x32_bf16 v[144:147], a[232:235], v[120:123], v[144:147]
    v_mfma_f32_16x16x32_bf16 v[140:143], a[236:239], v[124:127], v[140:143]
    v_mfma_f32_16x16x32_bf16 v[144:147], a[236:239], v[128:131], v[144:147]
    v_mfma_f32_16x16x32_bf16 v[148:151], a[152:155], v[116:119], v[148:151]
    v_add_u32 v11, s49, v11
    v_add_u32 v12, s49, v12
    v_mfma_f32_16x16x32_bf16 v[152:155], a[152:155], v[120:123], v[152:155]
    s_sub_u32 s47, s47, s49
    s_sub_u32 s49, 0, s49
    v_mfma_f32_16x16x32_bf16 v[148:151], a[156:159], v[124:127], v[148:151]
    v_mfma_f32_16x16x32_bf16 v[152:155], a[156:159], v[128:131], v[152:155]
    v_mfma_f32_16x16x32_bf16 v[156:159], a[72:75], v[116:119], v[156:159]
    v_cvt_pk_bf16_f32 v164, v140, v141
    v_cvt_pk_bf16_f32 v165, v142, v143
    v_mfma_f32_16x16x32_bf16 v[160:163], a[72:75], v[120:123], v[160:163]
    v_cvt_pk_bf16_f32 v166, v144, v145
    v_cvt_pk_bf16_f32 v167, v146, v147
    v_mfma_f32_16x16x32_bf16 v[156:159], a[76:79], v[124:127], v[156:159]
    v_permlane16_swap_b32 v164, v166
    v_permlane16_swap_b32 v165, v167
    v_mfma_f32_16x16x32_bf16 v[160:163], a[76:79], v[128:131], v[160:163]
    v_cvt_pk_bf16_f32 v168, v148, v149
    v_cvt_pk_bf16_f32 v169, v150, v151
    v_cvt_pk_bf16_f32 v170, v152, v153
    v_cvt_pk_bf16_f32 v171, v154, v155
    s_nop 0
    v_permlane16_swap_b32 v168, v170
    v_permlane16_swap_b32 v169, v171
    ds_write_b128 v34, v[168:171]
    v_cvt_pk_bf16_f32 v172, v156, v157
    v_cvt_pk_bf16_f32 v173, v158, v159
    v_cvt_pk_bf16_f32 v174, v160, v161
    v_cvt_pk_bf16_f32 v175, v162, v163
    s_nop 0
    v_permlane16_swap_b32 v172, v174
    v_permlane16_swap_b32 v173, v175
    buffer_store_dwordx4 v[164:167], v29, s[4:7], s51 offen
    buffer_store_dwordx4 v[168:171], v29, s[4:7], s50 offen
    buffer_store_dwordx4 v[172:175], v29, s[4:7], s45 offen
    v_mov_b32 v1, 192
L_gw_1:
    buffer_load_dword v2, v1, s[8:11], 0 offen sc1
    s_sub_u32 s36, s36, 1
    s_cbranch_scc1 L_exit
    s_waitcnt vmcnt(0)
    v_readfirstlane_b32 s90, v2
    s_nop 0
    s_cmp_eq_u32 s90, 0
    s_cbranch_scc1 L_gw_1
    s_cmp_lg_u32 s90, 1
    s_cbranch_scc1 L_slow
    v_mov_b32 v32, 1
    buffer_store_dword v32, v30, s[4:7], s38 offen
    s_waitcnt lgkmcnt(0)
    s_barrier
    s_add_u32 s45, s38, 573440
    s_add_u32 s50, s45, 49152
    s_add_u32 s51, s38, 180224
    v_add_u32 v34, 4096, v27
    s_mov_b32 s46, 81920
    ds_read_b128 v[116:119], v11 offset:0
    ds_read_b128 v[120:123], v11 offset:2048
    ds_read_b128 v[124:127], v12 offset:0
    ds_read_b128 v[128:131], v12 offset:2048
    s_lshl_b32 s90, s32, 10
    s_add_u32 m0, s90, s47
    s_waitcnt lgkmcnt(2)
    v_mfma_f32_16x16x32_bf16 v[140:143], a[160:163], v[116:119], 0
    ds_read_b128 v[132:135], v11 offset:4096
    v_mfma_f32_16x16x32_bf16 v[144:147], a[160:163], v[120:123], 0
    ds_read_b128 v[136:139], v11 offset:6144
    v_mfma_f32_16x16x32_bf16 v[148:151], a[80:83], v[116:119], 0
    buffer_load_dwordx4 v10, s[24:27], s46 offen offset:0 lds
    s_add_u32 m0, m0, 3968
    v_mfma_f32_16x16x32_bf16 v[152:155], a[80:83], v[120:123], 0
    v_mfma_f32_16x16x32_bf16 v[156:159], a[0:3], v[116:119], 0
    buffer_load_dwordx4 v10, s[24:27], s46 offen offset:128 lds
    s_add_u32 m0, m0, 3968
    v_mfma_f32_16x16x32_bf16 v[160:163], a[0:3], v[120:123], 0
    s_waitcnt lgkmcnt(2)
    v_mfma_f32_16x16x32_bf16 v[140:143], a[164:167], v[124:127], v[140:143]
    ds_read_b128 v[116:119], v12 offset:4096
    v_mfma_f32_16x16x32_bf16 v[144:147], a[164:167], v[128:131], v[144:147]
    ds_read_b128 v[120:123], v12 offset:6144
    v_mfma_f32_16x16x32_bf16 v[148:151], a[84:87], v[124:127], v[148:151]
    buffer_load_dwordx4 v10, s[24:27], s46 offen offset:256 lds
    s_add_u32 m0, m0, 3968
    v_mfma_f32_16x16x32_bf16 v[152:155], a[84:87], v[128:131], v[152:155]
    v_mfma_f32_16x16x32_bf16 v[156:159], a[4:7], v[124:127], v[156:159]
    v_mfma_f32_16x16x32_bf16 v[160:163], a[4:7], v[128:131], v[160:163]
    s_waitcnt lgkmcnt(2)
    v_mfma_f32_16x16x32_bf16 v[140:143], a[168:171], v[132:135], v[140:143]
    ds_read_b128 v[124:127], v11 offset:8192
    v_mfma_f32_16x16x32_bf16 v[144:147], a[168:171], v[136:139], v[144:147]
    ds_read_b128 v[128:131], v11 offset:10240
    v_mfma_f32_16x16x32_bf16 v[148:151], a[88:91], v[132:135], v[148:151]
    buffer_load_dwordx4 v10, s[24:27], s46 offen offset:384 lds
    s_add_u32 m0, m0, 3968
    v_mfma_f32_16x16x32_bf16 v[152:155], a[88:91], v[136:139], v[152:155]
    v_mfma_f32_16x16x32_bf16 v[156:159], a[8:11], v[132:135], v[156:159]
    buffer_load_dwordx4 v10, s[24:27], s46 offen offset:512 lds
    s_add_u32 m0, m0, 3968
    v_mfma_f32_16x16x32_bf16 v[160:163], a[8:11], v[136:139], v[160:163]
    s_waitcnt lgkmcnt(2)
    v_mfma_f32_16x16x32_bf16 v[140:143], a[172:175], v[116:119], v[140:143]
    ds_read_b128 v[132:135], v12 offset:8192
    v_mfma_f32_16x16x32_bf16 v[144:147], a[172:175], v[120:123], v[144:147]
    ds_read_b128 v[136:139], v12 offset:10240
    v_mfma_f32_16x16x32_bf16 v[148:151], a[92:95], v[116:119], v[148:151]
    buffer_load_dwordx4 v10, s[24:27], s46 offen offset:640 lds
    s_add_u32 m0, m0, 3968
    v_mfma_f32_16x16x32_bf16 v[152:155], a[92:95], v[120:123], v[152:155]
    v_mfma_f32_16x16x32_bf16 v[156:159], a[12:15], v[116:119], v[156:159]
    v_mfma_f32_16x16x32_bf16 v[160:163], a[12:15], v[120:123], v[160:163]
    s_waitcnt lgkmcnt(2)
    v_mfma_f32_16x16x32_bf16 v[140:143], a[176:179], v[124:127], v[140:143]
    ds_read_b128 v[116:119], v11 offset:12288
    v_mfma_f32_16x16x32_bf16 v[144:147], a[176:179], v[128:131], v[144:147]
    ds_read_b128 v[120:123], v11 offset:14336
    v_mfma_f32_16x16x32_bf16 v[148:151], a[96:99], v[124:127], v[148:151]
    buffer_load_dwordx4 v10, s[24:27], s46 offen offset:768 lds
    s_add_u32 m0, m0, 3968
    v_mfma_f32_16x16x32_bf16 v[152:155], a[96:99], v[128:131], v[152:155]
    v_mfma_f32_16x16x32_bf16 v[156:159], a[16:19], v[124:127], v[156:159]
    buffer_load_dwordx4 v10, s[24:27], s46 offen offset:896 lds
    s_add_u32 m0, m0, 3968
    v_mfma_f32_16x16x32_bf16 v[160:163], a[16:19], v[128:131], v[160:163]
    s_waitcnt lgkmcnt(2)
    v_mfma_f32_16x16x32_bf16 v[140:143], a[180:183], v[132:135], v[140:143]
    ds_read_b128 v[124:127], v12 offset:12288
    v_mfma_f32_16x16x32_bf16 v[144:147], a[180:183], v[136:139], v[144:147]
    ds_read_b128 v[128:131], v12 offset:14336
    v_mfma_f32_16x16x32_bf16 v[148:151], a[100:103], v[132:135], v[148:151]
    buffer_load_dwordx4 v10, s[24:27], s46 offen offset:1024 lds
    s_add_u32 m0, m0, 3968
    v_mfma_f32_16x16x32_bf16 v[152:155], a[100:103], v[136:139], v[152:155]
    v_mfma_f32_16x16x32_bf16 v[156:159], a[20:23], v[132:135], v[156:159]
    v_mfma_f32_16x16x32_bf16 v[160:163], a[20:23], v[136:139], v[160:163]
    s_waitcnt lgkmcnt(2)
    v_mfma_f32_16x16x32_bf16 v[140:143], a[184:187], v[116:119], v[140:143]
    ds_read_b128 v[132:135], v11 offset:16384
    v_mfma_f32_16x16x32_bf16 v[144:147], a[184:187], v[120:123], v[144:147]
    ds_read_b128 v[136:139], v11 offset:18432
    v_mfma_f32_16x16x32_bf16 v[148:151], a[104:107], v[116:119], v[148:151]
    buffer_load_dwordx4 v10, s[24:27], s46 offen offset:1152 lds
    v_mfma_f32_16x16x32_bf16 v[152:155], a[104:107], v[120:123], v[152:155]
    v_mfma_f32_16x16x32_bf16 v[156:159], a[24:27], v[116:119], v[156:159]
    v_mfma_f32_16x16x32_bf16 v[160:163], a[24:27], v[120:123], v[160:163]
    s_waitcnt lgkmcnt(2)
    v_mfma_f32_16x16x32_bf16 v[140:143], a[188:191], v[124:127], v[140:143]
    ds_read_b128 v[116:119], v12 offset:16384
    v_mfma_f32_16x16x32_bf16 v[144:147], a[188:191], v[128:131], v[144:147]
    ds_read_b128 v[120:123], v12 offset:18432
    v_mfma_f32_16x16x32_bf16 v[148:151], a[108:111], v[124:127], v[148:151]
    v_mfma_f32_16x16x32_bf16 v[152:155], a[108:111], v[128:131], v[152:155]
    v_mfma_f32_16x16x32_bf16 v[156:159], a[28:31], v[124:127], v[156:159]
    v_mfma_f32_16x16x32_bf16 v[160:163], a[28:31], v[128:131], v[160:163]
    s_waitcnt lgkmcnt(2)
    v_mfma_f32_16x16x32_bf16 v[140:143], a[192:195], v[132:135], v[140:143]
    ds_read_b128 v[124:127], v11 offset:20480
    v_mfma_f32_16x16x32_bf16 v[144:147], a[192:195], v[136:139], v[144:147]
    ds_read_b128 v[128:131], v11 offset:22528
    v_mfma_f32_16x16x32_bf16 v[148:151], a[112:115], v[132:135], v[148:151]
    v_mfma_f32_16x16x32_bf16 v[152:155], a[112:115], v[136:139], v[152:155]
    v_mfma_f32_16x16x32_bf16 v[156:159], a[32:35], v[132:135], v[156:159]
    v_mfma_f32_16x16x32_bf16 v[160:163], a[32:35], v[136:139], v[160:163]
    s_waitcnt lgkmcnt(2)
    v_mfma_f32_16x16x32_bf16 v[140:143], a[196:199], v[116:119], v[140:143]
    ds_read_b128 v[132:135], v12 offset:20480
    v_mfma_f32_16x16x32_bf16 v[144:147], a[196:199], v[120:123], v[144:147]
    ds_read_b128 v[136:139], v12 offset:22528
    v_mfma_f32_16x16x32_bf16 v[148:151], a[116:119], v[116:119], v[148:151]
    v_mfma_f32_16x16x32_bf16 v[152:155], a[116:119], v[120:123], v[152:155]
    v_mfma_f32_16x16x32_bf16 v[156:159], a[36:39], v[116:119], v[156:159]
    v_mfma_f32_16x16x32_bf16 v[160:163], a[36:39], v[120:123], v[160:163]
    s_waitcnt lgkmcnt(2)
    v_mfma_f32_16x16x32_bf16 v[140:143], a[200:203], v[124:127], v[140:143]
    ds_read_b128 v[116:119], v11 offset:24576
    v_mfma_f32_16x16x32_bf16 v[144:147], a[200:203], v[128:131], v[144:147]
    ds_read_b128 v[120:123], v11 offset:26624
    v_mfma_f32_16x16x32_bf16 v[148:151], a[120:123], v[124:127], v[148:151]
    v_mfma_f32_16x16x32_bf16 v[152:155], a[120:123], v[128:131], v[152:155]
    v_mfma_f32_16x16x32_bf16 v[156:159], a[40:43], v[124:127], v[156:159]
    v_mfma_f32_16x16x32_bf16 v[160:163], a[40:43], v[128:131], v[160:163]
    s_waitcnt lgkmcnt(2)
    v_mfma_f32_16x16x32_bf16 v[140:143], a[204:207], v[132:135], v[140:143]
    ds_read_b128 v[124:127], v12 offset:24576
    v_mfma_f32_16x16x32_bf16 v[144:147], a[204:207], v[136:139], v[144:147]
    ds_read_b128 v[128:131], v12 offset:26624
    v_mfma_f32_16x16x32_bf16 v[148:151], a[124:127], v[132:135], v[148:151]
    v_mfma_f32_16x16x32_bf16 v[152:155], a[124:127], v[136:139], v[152:155]
    v_mfma_f32_16x16x32_bf16 v[156:159], a[44:47], v[132:135], v[156:159]
    v_mfma_f32_16x16x32_bf16 v[160:163], a[44:47], v[136:139], v[160:163]
    s_waitcnt lgkmcnt(2)
    v_mfma_f32_16x16x32_bf16 v[140:143], a[208:211], v[116:119], v[140:143]
    ds_read_b128 v[132:135], v11 offset:28672
    v_mfma_f32_16x16x32_bf16 v[144:147], a[208:211], v[120:123], v[144:147]
    ds_read_b128 v[136:139], v11 offset:30720
    v_mfma_f32_16x16x32_bf16 v[148:151], a[128:131], v[116:119], v[148:151]
    v_mfma_f32_16x16x32_bf16 v[152:155], a[128:131], v[120:123], v[152:155]
    v_mfma_f32_16x16x32_bf16 v[156:159], a[48:51], v[116:119], v[156:159]
    v_mfma_f32_16x16x32_bf16 v[160:163], a[48:51], v[120:123], v[160:163]
    s_waitcnt lgkmcnt(2)
    v_mfma_f32_16x16x32_bf16 v[140:143], a[212:215], v[124:127], v[140:143]
    ds_read_b128 v[116:119], v12 offset:28672
    v_mfma_f32_16x16x32_bf16 v[144:147], a[212:215], v[128:131], v[144:147]
    ds_read_b128 v[120:123], v12 offset:30720
    v_mfma_f32_16x16x32_bf16 v[148:151], a[132:135], v[124:127], v[148:151]
    v_mfma_f32_16x16x32_bf16 v[152:155], a[132:135], v[128:131], v[152:155]
    v_mfma_f32_16x16x32_bf16 v[156:159], a[52:55], v[124:127], v[156:159]
    v_mfma_f32_16x16x32_bf16 v[160:163], a[52:55], v[128:131], v[160:163]
    s_waitcnt lgkmcnt(2)
    v_mfma_f32_16x16x32_bf16 v[140:143], a[216:219], v[132:135], v[140:143]
    ds_read_b128 v[124:127], v11 offset:32768
    v_mfma_f32_16x16x32_bf16 v[144:147], a[216:219], v[136:139], v[144:147]
    ds_read_b128 v[128:131], v11 offset:34816
    v_mfma_f32_16x16x32_bf16 v[148:151], a[136:139], v[132:135], v[148:151]
    v_mfma_f32_16x16x32_bf16 v[152:155], a[136:139], v[136:139], v[152:155]
    v_mfma_f32_16x16x32_bf16 v[156:159], a[56:59], v[132:135], v[156:159]
    v_mfma_f32_16x16x32_bf16 v[160:163], a[56:59], v[136:139], v[160:163]
    s_waitcnt lgkmcnt(2)
    v_mfma_f32_16x16x32_bf16 v[140:143], a[220:223], v[116:119], v[140:143]
    ds_read_b128 v[132:135], v12 offset:32768
    v_mfma_f32_16x16x32_bf16 v[144:147], a[220:223], v[120:123], v[144:147]
    ds_read_b128 v[136:139], v12 offset:34816
    v_mfma_f32_16x16x32_bf16 v[148:151], a[140:143], v[116:119], v[148:151]
    v_mfma_f32_16x16x32_bf16 v[152:155], a[140:143], v[120:123], v[152:155]
    v_mfma_f32_16x16x32_bf16 v[156:159], a[60:63], v[116:119], v[156:159]
    v_mfma_f32_16x16x32_bf16 v[160:163], a[60:63], v[120:123], v[160:163]
    s_waitcnt lgkmcnt(2)
    v_mfma_f32_16x16x32_bf16 v[140:143], a[224:227], v[124:127], v[140:143]
    ds_read_b128 v[116:119], v11 offset:36864
    v_mfma_f32_16x16x32_bf16 v[144:147], a[224:227], v[128:131], v[144:147]
    ds_read_b128 v[120:123], v11 offset:38912
    v_mfma_f32_16x16x32_bf16 v[148:151], a[144:147], v[124:127], v[148:151]
    v_mfma_f32_16x16x32_bf16 v[152:155], a[144:147], v[128:131], v[152:155]
    v_mfma_f32_16x16x32_bf16 v[156:159], a[64:67], v[124:127], v[156:159]
    v_mfma_f32_16x16x32_bf16 v[160:163], a[64:67], v[128:131], v[160:163]
    s_waitcnt lgkmcnt(2)
    v_mfma_f32_16x16x32_bf16 v[140:143], a[228:231], v[132:135], v[140:143]
    ds_read_b128 v[124:127], v12 offset:36864
    v_mfma_f32_16x16x32_bf16 v[144:147], a[228:231], v[136:139], v[144:147]
    ds_read_b128 v[128:131], v12 offset:38912
    v_mfma_f32_16x16x32_bf16 v[148:151], a[148:151], v[132:135], v[148:151]
    v_mfma_f32_16x16x32_bf16 v[152:155], a[148:151], v[136:139], v[152:155]
    v_mfma_f32_16x16x32_bf16 v[156:159], a[68:71], v[132:135], v[156:159]
    v_mfma_f32_16x16x32_bf16 v[160:163], a[68:71], v[136:139], v[160:163]
    s_waitcnt lgkmcnt(0)
    v_mfma_f32_16x16x32_bf16 v[140:143], a[232:235], v[116:119], v[140:143]
    v_mfma_f32_16x16x32_bf16 v[144:147], a[232:235], v[120:123], v[144:147]
    v_mfma_f32_16x16x32_bf16 v[140:143], a[236:239], v[124:127], v[140:143]
    v_mfma_f32_16x16x32_bf16 v[144:147], a[236:239], v[128:131], v[144:147]
    v_mfma_f32_16x16x32_bf16 v[148:151], a[152:155], v[116:119], v[148:151]
    v_add_u32 v11, s49, v11
    v_add_u32 v12, s49, v12
    v_mfma_f32_16x16x32_bf16 v[152:155], a[152:155], v[120:123], v[152:155]
    s_sub_u32 s47, s47, s49
    s_sub_u32 s49, 0, s49
    v_mfma_f32_16x16x32_bf16 v[148:151], a[156:159], v[124:127], v[148:151]
    v_mfma_f32_16x16x32_bf16 v[152:155], a[156:159], v[128:131], v[152:155]
    v_mfma_f32_16x16x32_bf16 v[156:159], a[72:75], v[116:119], v[156:159]
    v_cvt_pk_bf16_f32 v164, v140, v141
    v_cvt_pk_bf16_f32 v165, v142, v143
    v_mfma_f32_16x16x32_bf16 v[160:163], a[72:75], v[120:123], v[160:163]
    v_cvt_pk_bf16_f32 v166, v144, v145
    v_cvt_pk_bf16_f32 v167, v146, v147
    v_mfma_f32_16x16x32_bf16 v[156:159], a[76:79], v[124:127], v[156:159]
    v_permlane16_swap_b32 v164, v166
    v_permlane16_swap_b32 v165, v167
    v_mfma_f32_16x16x32_bf16 v[160:163], a[76:79], v[128:131], v[160:163]
    v_cvt_pk_bf16_f32 v168, v148, v149
    v_cvt_pk_bf16_f32 v169, v150, v151
    v_cvt_pk_bf16_f32 v170, v152, v153
    v_cvt_pk_bf16_f32 v171, v154, v155
    s_nop 0
    v_permlane16_swap_b32 v168, v170
    v_permlane16_swap_b32 v169, v171
    ds_write_b128 v34, v[168:171]
    v_cvt_pk_bf16_f32 v172, v156, v157
    v_cvt_pk_bf16_f32 v173, v158, v159
    v_cvt_pk_bf16_f32 v174, v160, v161
    v_cvt_pk_bf16_f32 v175, v162, v163
    s_nop 0
    v_permlane16_swap_b32 v172, v174
    v_permlane16_swap_b32 v173, v175
    buffer_store_dwordx4 v[164:167], v29, s[4:7], s51 offen
    buffer_store_dwordx4 v[168:171], v29, s[4:7], s50 offen
    buffer_store_dwordx4 v[172:175], v29, s[4:7], s45 offen
    s_waitcnt vmcnt(0) lgkmcnt(0)
    v_mov_b32 v32, 2
    buffer_store_dword v32, v30, s[4:7], s38 offen
    s_barrier
    s_mov_b32 s37, -1
    s_add_u32 s45, s38, 671744
    s_add_u32 s50, s45, 49152
    s_add_u32 s51, s38, 294912
    v_add_u32 v34, 8192, v27
    s_mov_b32 s46, 122880
    ds_read_b128 v[116:119], v11 offset:0
    ds_read_b128 v[120:123], v11 offset:2048
    ds_read_b128 v[124:127], v12 offset:0
    ds_read_b128 v[128:131], v12 offset:2048
    s_lshl_b32 s90, s32, 10
    s_add_u32 m0, s90, s47
    s_waitcnt lgkmcnt(2)
    v_mfma_f32_16x16x32_bf16 v[140:143], a[160:163], v[116:119], 0
    ds_read_b128 v[132:135], v11 offset:4096
    s_and_b32 s52, s37, 3
    v_mfma_f32_16x16x32_bf16 v[144:147], a[160:163], v[120:123], 0
    ds_read_b128 v[136:139], v11 offset:6144
    s_mul_i32 s55, s52, 327680
    v_mfma_f32_16x16x32_bf16 v[148:151], a[80:83], v[116:119], 0
    buffer_load_dwordx4 v10, s[24:27], s46 offen offset:0 lds
    s_add_u32 m0, m0, 3968
    v_mfma_f32_16x16x32_bf16 v[152:155], a[80:83], v[120:123], 0
    s_add_u32 s37, s37, 1
    s_mov_b32 s54, 0
    v_mfma_f32_16x16x32_bf16 v[156:159], a[0:3], v[116:119], 0
    buffer_load_dwordx4 v10, s[24:27], s46 offen offset:128 lds
    s_add_u32 m0, m0, 3968
    v_mfma_f32_16x16x32_bf16 v[160:163], a[0:3], v[120:123], 0
    s_waitcnt lgkmcnt(2)
    s_and_b32 s52, s37, 3
    v_mfma_f32_16x16x32_bf16 v[140:143], a[164:167], v[124:127], v[140:143]
    ds_read_b128 v[116:119], v12 offset:4096
    s_mul_i32 s53, s52, 114688
    v_mfma_f32_16x16x32_bf16 v[144:147], a[164:167], v[128:131], v[144:147]
    ds_read_b128 v[120:123], v12 offset:6144
    s_add_u32 s42, s38, s53
    v_mfma_f32_16x16x32_bf16 v[148:151], a[84:87], v[124:127], v[148:151]
    buffer_load_dwordx4 v10, s[24:27], s46 offen offset:256 lds
    s_add_u32 m0, m0, 3968
    v_mfma_f32_16x16x32_bf16 v[152:155], a[84:87], v[128:131], v[152:155]
    s_lshl_b32 s52, s52, 12
    v_add_u32 v35, s52, v28
    v_mfma_f32_16x16x32_bf16 v[156:159], a[4:7], v[124:127], v[156:159]
    s_xor_b32 s52, s52, 8192
    v_add_u32 v34, s52, v27
    v_mfma_f32_16x16x32_bf16 v[160:163], a[4:7], v[128:131], v[160:163]
    s_waitcnt lgkmcnt(2)
    s_add_u32 s44, s42, 40960
    v_mfma_f32_16x16x32_bf16 v[140:143], a[168:171], v[132:135], v[140:143]
    ds_read_b128 v[124:127], v11 offset:8192
    s_mul_i32 s52, s52, 28
    v_mfma_f32_16x16x32_bf16 v[144:147], a[168:171], v[136:139], v[144:147]
    ds_read_b128 v[128:131], v11 offset:10240
    s_add_u32 s43, s38, s52
    v_mfma_f32_16x16x32_bf16 v[148:151], a[88:91], v[132:135], v[148:151]
    buffer_load_dwordx4 v10, s[24:27], s46 offen offset:384 lds
    s_add_u32 m0, m0, 3968
    v_mfma_f32_16x16x32_bf16 v[152:155], a[88:91], v[136:139], v[152:155]
    s_add_u32 s53, s37, 2
    s_and_b32 s53, s53, 7
    v_mfma_f32_16x16x32_bf16 v[156:159], a[8:11], v[132:135], v[156:159]
    buffer_load_dwordx4 v10, s[24:27], s46 offen offset:512 lds
    s_add_u32 m0, m0, 3968
    v_mfma_f32_16x16x32_bf16 v[160:163], a[8:11], v[136:139], v[160:163]
    s_waitcnt lgkmcnt(2)
    s_mul_i32 s53, s53, 98304
    v_mfma_f32_16x16x32_bf16 v[140:143], a[172:175], v[116:119], v[140:143]
    ds_read_b128 v[132:135], v12 offset:8192
    s_add_u32 s53, s53, 475136
    v_mfma_f32_16x16x32_bf16 v[144:147], a[172:175], v[120:123], v[144:147]
    ds_read_b128 v[136:139], v12 offset:10240
    s_add_u32 s45, s38, s53
    v_mfma_f32_16x16x32_bf16 v[148:151], a[92:95], v[116:119], v[148:151]
    buffer_load_dwordx4 v10, s[24:27], s46 offen offset:640 lds
    s_add_u32 m0, m0, 3968
    v_mfma_f32_16x16x32_bf16 v[152:155], a[92:95], v[120:123], v[152:155]
    s_add_u32 s50, s45, 49152
    s_add_u32 s51, s43, 65536
    v_mfma_f32_16x16x32_bf16 v[156:159], a[12:15], v[116:119], v[156:159]
    v_add_u32 v32, s37, v220
    v_mov_b32 v80, 0
    v_mfma_f32_16x16x32_bf16 v[160:163], a[12:15], v[120:123], v[160:163]
    s_waitcnt lgkmcnt(2)
    v_mov_b32 v81, 0
    v_mfma_f32_16x16x32_bf16 v[140:143], a[176:179], v[124:127], v[140:143]
    ds_read_b128 v[116:119], v11 offset:12288
    v_mov_b32 v82, 0
    v_mfma_f32_16x16x32_bf16 v[144:147], a[176:179], v[128:131], v[144:147]
    ds_read_b128 v[120:123], v11 offset:14336
    v_mov_b32 v83, 0
    v_mfma_f32_16x16x32_bf16 v[148:151], a[96:99], v[124:127], v[148:151]
    buffer_load_dwordx4 v10, s[24:27], s46 offen offset:768 lds
    s_add_u32 m0, m0, 3968
    v_mfma_f32_16x16x32_bf16 v[152:155], a[96:99], v[128:131], v[152:155]
    v_mov_b32 v84, 0
    v_mov_b32 v85, 0
    v_mfma_f32_16x16x32_bf16 v[156:159], a[16:19], v[124:127], v[156:159]
    buffer_load_dwordx4 v10, s[24:27], s46 offen offset:896 lds
    s_add_u32 m0, m0, 3968
    v_mfma_f32_16x16x32_bf16 v[160:163], a[16:19], v[128:131], v[160:163]
    s_waitcnt lgkmcnt(2)
    v_mov_b32 v86, 0
    v_mfma_f32_16x16x32_bf16 v[140:143], a[180:183], v[132:135], v[140:143]
    ds_read_b128 v[124:127], v12 offset:12288
    v_mov_b32 v87, 0
    v_mfma_f32_16x16x32_bf16 v[144:147], a[180:183], v[136:139], v[144:147]
    ds_read_b128 v[128:131], v12 offset:14336
    v_mov_b32 v88, 0
    v_mfma_f32_16x16x32_bf16 v[148:151], a[100:103], v[132:135], v[148:151]
    buffer_load_dwordx4 v10, s[24:27], s46 offen offset:1024 lds
    s_add_u32 m0, m0, 3968
    v_mfma_f32_16x16x32_bf16 v[152:155], a[100:103], v[136:139], v[152:155]
    v_mov_b32 v89, 0
    v_mov_b32 v90, 0
    v_mfma_f32_16x16x32_bf16 v[156:159], a[20:23], v[132:135], v[156:159]
    v_mov_b32 v91, 0
    v_mfma_f32_16x16x32_bf16 v[160:163], a[20:23], v[136:139], v[160:163]
    s_waitcnt lgkmcnt(2)
    v_mfma_f32_16x16x32_bf16 v[140:143], a[184:187], v[116:119], v[140:143]
    ds_read_b128 v[132:135], v11 offset:16384
    v_mfma_f32_16x16x32_bf16 v[144:147], a[184:187], v[120:123], v[144:147]
    ds_read_b128 v[136:139], v11 offset:18432
    v_mfma_f32_16x16x32_bf16 v[148:151], a[104:107], v[116:119], v[148:151]
    buffer_load_dwordx4 v10, s[24:27], s46 offen offset:1152 lds
    v_mfma_f32_16x16x32_bf16 v[152:155], a[104:107], v[120:123], v[152:155]
    v_mfma_f32_16x16x32_bf16 v[156:159], a[24:27], v[116:119], v[156:159]
    v_mfma_f32_16x16x32_bf16 v[160:163], a[24:27], v[120:123], v[160:163]
    s_waitcnt lgkmcnt(2)
    v_mfma_f32_16x16x32_bf16 v[140:143], a[188:191], v[124:127], v[140:143]
    ds_read_b128 v[116:119], v12 offset:16384
    v_mfma_f32_16x16x32_bf16 v[144:147], a[188:191], v[128:131], v[144:147]
    ds_read_b128 v[120:123], v12 offset:18432
    v_mfma_f32_16x16x32_bf16 v[148:151], a[108:111], v[124:127], v[148:151]
    v_mfma_f32_16x16x32_bf16 v[152:155], a[108:111], v[128:131], v[152:155]
    v_mfma_f32_16x16x32_bf16 v[156:159], a[28:31], v[124:127], v[156:159]
    v_mfma_f32_16x16x32_bf16 v[160:163], a[28:31], v[128:131], v[160:163]
    s_waitcnt lgkmcnt(2)
    v_mfma_f32_16x16x32_bf16 v[140:143], a[192:195], v[132:135], v[140:143]
    ds_read_b128 v[124:127], v11 offset:20480
    v_mfma_f32_16x16x32_bf16 v[144:147], a[192:195], v[136:139], v[144:147]
    ds_read_b128 v[128:131], v11 offset:22528
    v_mfma_f32_16x16x32_bf16 v[148:151], a[112:115], v[132:135], v[148:151]
    v_mfma_f32_16x16x32_bf16 v[152:155], a[112:115], v[136:139], v[152:155]
    v_mfma_f32_16x16x32_bf16 v[156:159], a[32:35], v[132:135], v[156:159]
    v_mfma_f32_16x16x32_bf16 v[160:163], a[32:35], v[136:139], v[160:163]
    s_waitcnt lgkmcnt(2)
    v_mfma_f32_16x16x32_bf16 v[140:143], a[196:199], v[116:119], v[140:143]
    ds_read_b128 v[132:135], v12 offset:20480
    v_mfma_f32_16x16x32_bf16 v[144:147], a[196:199], v[120:123], v[144:147]
    ds_read_b128 v[136:139], v12 offset:22528
    v_mfma_f32_16x16x32_bf16 v[148:151], a[116:119], v[116:119], v[148:151]
    v_mfma_f32_16x16x32_bf16 v[152:155], a[116:119], v[120:123], v[152:155]
    v_mfma_f32_16x16x32_bf16 v[156:159], a[36:39], v[116:119], v[156:159]
    v_mfma_f32_16x16x32_bf16 v[160:163], a[36:39], v[120:123], v[160:163]
    s_waitcnt lgkmcnt(2)
    v_mfma_f32_16x16x32_bf16 v[140:143], a[200:203], v[124:127], v[140:143]
    ds_read_b128 v[116:119], v11 offset:24576
    v_mfma_f32_16x16x32_bf16 v[144:147], a[200:203], v[128:131], v[144:147]
    ds_read_b128 v[120:123], v11 offset:26624
    v_mfma_f32_16x16x32_bf16 v[148:151], a[120:123], v[124:127], v[148:151]
    v_mfma_f32_16x16x32_bf16 v[152:155], a[120:123], v[128:131], v[152:155]
    v_mfma_f32_16x16x32_bf16 v[156:159], a[40:43], v[124:127], v[156:159]
    v_mfma_f32_16x16x32_bf16 v[160:163], a[40:43], v[128:131], v[160:163]
    s_waitcnt lgkmcnt(2)
    v_mfma_f32_16x16x32_bf16 v[140:143], a[204:207], v[132:135], v[140:143]
    ds_read_b128 v[124:127], v12 offset:24576
    v_mfma_f32_16x16x32_bf16 v[144:147], a[204:207], v[136:139], v[144:147]
    ds_read_b128 v[128:131], v12 offset:26624
    v_mfma_f32_16x16x32_bf16 v[148:151], a[124:127], v[132:135], v[148:151]
    v_mfma_f32_16x16x32_bf16 v[152:155], a[124:127], v[136:139], v[152:155]
    v_mfma_f32_16x16x32_bf16 v[156:159], a[44:47], v[132:135], v[156:159]
    v_mfma_f32_16x16x32_bf16 v[160:163], a[44:47], v[136:139], v[160:163]
    s_waitcnt lgkmcnt(2)
    v_mfma_f32_16x16x32_bf16 v[140:143], a[208:211], v[116:119], v[140:143]
    ds_read_b128 v[132:135], v11 offset:28672
    v_mfma_f32_16x16x32_bf16 v[144:147], a[208:211], v[120:123], v[144:147]
    ds_read_b128 v[136:139], v11 offset:30720
    v_mfma_f32_16x16x32_bf16 v[148:151], a[128:131], v[116:119], v[148:151]
    v_mfma_f32_16x16x32_bf16 v[152:155], a[128:131], v[120:123], v[152:155]
    v_mfma_f32_16x16x32_bf16 v[156:159], a[48:51], v[116:119], v[156:159]
    v_mfma_f32_16x16x32_bf16 v[160:163], a[48:51], v[120:123], v[160:163]
    s_waitcnt lgkmcnt(2)
    v_mfma_f32_16x16x32_bf16 v[140:143], a[212:215], v[124:127], v[140:143]
    ds_read_b128 v[116:119], v12 offset:28672
    v_mfma_f32_16x16x32_bf16 v[144:147], a[212:215], v[128:131], v[144:147]
    ds_read_b128 v[120:123], v12 offset:30720
    v_mfma_f32_16x16x32_bf16 v[148:151], a[132:135], v[124:127], v[148:151]
    v_mfma_f32_16x16x32_bf16 v[152:155], a[132:135], v[128:131], v[152:155]
    v_mfma_f32_16x16x32_bf16 v[156:159], a[52:55], v[124:127], v[156:159]
    v_mfma_f32_16x16x32_bf16 v[160:163], a[52:55], v[128:131], v[160:163]
    s_waitcnt lgkmcnt(2)
    v_mfma_f32_16x16x32_bf16 v[140:143], a[216:219], v[132:135], v[140:143]
    ds_read_b128 v[124:127], v11 offset:32768
    v_mfma_f32_16x16x32_bf16 v[144:147], a[216:219], v[136:139], v[144:147]
    ds_read_b128 v[128:131], v11 offset:34816
    v_mfma_f32_16x16x32_bf16 v[148:151], a[136:139], v[132:135], v[148:151]
    v_mfma_f32_16x16x32_bf16 v[152:155], a[136:139], v[136:139], v[152:155]
    v_mfma_f32_16x16x32_bf16 v[156:159], a[56:59], v[132:135], v[156:159]
    v_mfma_f32_16x16x32_bf16 v[160:163], a[56:59], v[136:139], v[160:163]
    s_waitcnt lgkmcnt(2)
    v_mfma_f32_16x16x32_bf16 v[140:143], a[220:223], v[116:119], v[140:143]
    ds_read_b128 v[132:135], v12 offset:32768
    v_mfma_f32_16x16x32_bf16 v[144:147], a[220:223], v[120:123], v[144:147]
    ds_read_b128 v[136:139], v12 offset:34816
    v_mfma_f32_16x16x32_bf16 v[148:151], a[140:143], v[116:119], v[148:151]
    v_mfma_f32_16x16x32_bf16 v[152:155], a[140:143], v[120:123], v[152:155]
    v_mfma_f32_16x16x32_bf16 v[156:159], a[60:63], v[116:119], v[156:159]
    v_mfma_f32_16x16x32_bf16 v[160:163], a[60:63], v[120:123], v[160:163]
    s_waitcnt lgkmcnt(2)
    v_mfma_f32_16x16x32_bf16 v[140:143], a[224:227], v[124:127], v[140:143]
    ds_read_b128 v[116:119], v11 offset:36864
    v_mfma_f32_16x16x32_bf16 v[144:147], a[224:227], v[128:131], v[144:147]
    ds_read_b128 v[120:123], v11 offset:38912
    v_mfma_f32_16x16x32_bf16 v[148:151], a[144:147], v[124:127], v[148:151]
    v_mfma_f32_16x16x32_bf16 v[152:155], a[144:147], v[128:131], v[152:155]
    v_mfma_f32_16x16x32_bf16 v[156:159], a[64:67], v[124:127], v[156:159]
    v_mfma_f32_16x16x32_bf16 v[160:163], a[64:67], v[128:131], v[160:163]
    s_waitcnt lgkmcnt(2)
    v_mfma_f32_16x16x32_bf16 v[140:143], a[228:231], v[132:135], v[140:143]
    ds_read_b128 v[124:127], v12 offset:36864
    v_mfma_f32_16x16x32_bf16 v[144:147], a[228:231], v[136:139], v[144:147]
    ds_read_b128 v[128:131], v12 offset:38912
    v_mfma_f32_16x16x32_bf16 v[148:151], a[148:151], v[132:135], v[148:151]
    v_mfma_f32_16x16x32_bf16 v[152:155], a[148:151], v[136:139], v[152:155]
    v_mfma_f32_16x16x32_bf16 v[156:159], a[68:71], v[132:135], v[156:159]
    v_mfma_f32_16x16x32_bf16 v[160:163], a[68:71], v[136:139], v[160:163]
    s_waitcnt lgkmcnt(0)
    v_mfma_f32_16x16x32_bf16 v[140:143], a[232:235], v[116:119], v[140:143]
    v_mfma_f32_16x16x32_bf16 v[144:147], a[232:235], v[120:123], v[144:147]
    v_mfma_f32_16x16x32_bf16 v[140:143], a[236:239], v[124:127], v[140:143]
    v_mfma_f32_16x16x32_bf16 v[144:147], a[236:239], v[128:131], v[144:147]
    v_mfma_f32_16x16x32_bf16 v[148:151], a[152:155], v[116:119], v[148:151]
    v_add_u32 v11, s49, v11
    v_add_u32 v12, s49, v12
    v_mfma_f32_16x16x32_bf16 v[152:155], a[152:155], v[120:123], v[152:155]
    s_sub_u32 s47, s47, s49
    s_sub_u32 s49, 0, s49
    v_mfma_f32_16x16x32_bf16 v[148:151], a[156:159], v[124:127], v[148:151]
    v_mfma_f32_16x16x32_bf16 v[152:155], a[156:159], v[128:131], v[152:155]
    v_mfma_f32_16x16x32_bf16 v[156:159], a[72:75], v[116:119], v[156:159]
    v_cvt_pk_bf16_f32 v164, v140, v141
    v_cvt_pk_bf16_f32 v165, v142, v143
    v_mfma_f32_16x16x32_bf16 v[160:163], a[72:75], v[120:123], v[160:163]
    v_cvt_pk_bf16_f32 v166, v144, v145
    v_cvt_pk_bf16_f32 v167, v146, v147
    v_mfma_f32_16x16x32_bf16 v[156:159], a[76:79], v[124:127], v[156:159]
    v_permlane16_swap_b32 v164, v166
    v_permlane16_swap_b32 v165, v167
    v_mfma_f32_16x16x32_bf16 v[160:163], a[76:79], v[128:131], v[160:163]
    v_mov_b32 v3, 460288
L_pf_2:
    buffer_load_dword v4, v3, s[4:7], s38 offen sc1
    s_sub_u32 s36, s36, 1
    s_cbranch_scc1 L_exit
    s_waitcnt vmcnt(0) lgkmcnt(0)
    v_readfirstlane_b32 s90, v4
    s_nop 0
    s_cmp_eq_u32 s90, 0
    s_cbranch_scc1 L_pf_2
    s_and_b32 s90, s90, 2
    s_lshl_b32 s90, s90, 12
    v_add_u32 v214, s90, v214
    v_add_u32 v215, s90, v215
    v_add_u32 v223, 16384, v214
    v_add_u32 v224, 16384, v215
L_qkv_loop_f:
    s_mov_b32 m0, s48
    s_nop 0
    buffer_load_dwordx4 v13, s[4:7], s42 offen sc1 lds
    buffer_load_dwordx4 v13, s[4:7], s42 offen offset:1024 sc1 lds
    buffer_load_dword v14, s[4:7], s42 offen offset:2048 sc1 lds
    buffer_load_dword v14, s[4:7], s42 offen offset:2304 sc1 lds
    v_cvt_pk_bf16_f32 v168, v148, v149
    v_cvt_pk_bf16_f32 v169, v150, v151
    v_cvt_pk_bf16_f32 v170, v152, v153
    v_cvt_pk_bf16_f32 v171, v154, v155
    s_nop 0
    v_permlane16_swap_b32 v168, v170
    v_permlane16_swap_b32 v169, v171
    ds_write_b128 v34, v[168:171]
    v_cvt_pk_bf16_f32 v172, v156, v157
    v_cvt_pk_bf16_f32 v173, v158, v159
    v_cvt_pk_bf16_f32 v174, v160, v161
    v_cvt_pk_bf16_f32 v175, v162, v163
    s_nop 0
    v_permlane16_swap_b32 v172, v174
    v_permlane16_swap_b32 v173, v175
    ds_read_b128 v[100:103], v35
    ds_read_b128 v[104:107], v35 offset:1024
    s_add_u32 s90, s37, 4
    s_min_u32 s90, s90, 63
    s_mul_i32 s46, s90, 40960
L_poll_4:
    buffer_load_dwordx4 v13, s[4:7], s42 offen sc1 lds
    buffer_load_dwordx4 v13, s[4:7], s42 offen offset:1024 sc1 lds
    buffer_load_dword v14, s[4:7], s42 offen offset:2048 sc1 lds
    buffer_load_dword v14, s[4:7], s42 offen offset:2304 sc1 lds
    s_sub_u32 s36, s36, 1
    s_cbranch_scc1 L_exit
    s_waitcnt vmcnt(4)
    ds_read_b32 v33, v15
    s_waitcnt lgkmcnt(0)
    v_cmp_eq_u32 vcc, -1, v33
    s_cbranch_vccnz L_poll_4
    s_barrier
    ds_read_b128 v[40:43], v16 offset:0
    ds_read_b128 v[44:47], v16 offset:1024
    ds_read_b128 v[48:51], v16 offset:2048
    ds_read_b128 v[52:55], v16 offset:3072
    s_waitcnt lgkmcnt(3)
    v_smfmac_f32_16x16x64_bf16 v[80:83], v[40:43], a[160:167], v18
    ds_read_b128 v[56:59], v16 offset:4096
    s_waitcnt lgkmcnt(3)
    v_smfmac_f32_16x16x64_bf16 v[80:83], v[44:47], a[168:175], v18
    ds_read_b128 v[60:63], v16 offset:5120
    s_waitcnt lgkmcnt(3)
    v_smfmac_f32_16x16x64_bf16 v[80:83], v[48:51], a[176:183], v18
    ds_read_b128 v[64:67], v16 offset:6144
    s_waitcnt lgkmcnt(3)
    v_smfmac_f32_16x16x64_bf16 v[80:83], v[52:55], a[184:191], v18
    ds_read_b128 v[68:71], v16 offset:7168
    s_waitcnt lgkmcnt(3)
    v_smfmac_f32_16x16x64_bf16 v[80:83], v[56:59], a[192:199], v18
    ds_read_b128 v[72:75], v16 offset:8192
    s_waitcnt lgkmcnt(3)
    v_smfmac_f32_16x16x64_bf16 v[80:83], v[60:63], a[200:207], v18
    ds_read_b128 v[76:79], v16 offset:9216
    s_waitcnt lgkmcnt(3)
    v_smfmac_f32_16x16x64_bf16 v[80:83], v[64:67], a[208:215], v18
    s_waitcnt lgkmcnt(2)
    v_smfmac_f32_16x16x64_bf16 v[80:83], v[68:71], a[216:223], v18
    s_waitcnt lgkmcnt(1)
    v_smfmac_f32_16x16x64_bf16 v[80:83], v[72:75], a[224:231], v18
    s_waitcnt lgkmcnt(0)
    v_smfmac_f32_16x16x64_bf16 v[80:83], v[76:79], a[232:239], v18
L_got_3r:
    v_smfmac_f32_16x16x64_bf16 v[84:87], v[40:43], a[0:7], v18
    v_smfmac_f32_16x16x64_bf16 v[84:87], v[44:47], a[8:15], v18
    v_smfmac_f32_16x16x64_bf16 v[84:87], v[48:51], a[16:23], v18
    v_add_f32 v80, v80, v82
    v_add_f32 v81, v81, v83
    v_smfmac_f32_16x16x64_bf16 v[84:87], v[52:55], a[24:31], v18
    v_cvt_pk_bf16_f32 v112, v80, v81
    ds_write_b32 v19, v112
    v_smfmac_f32_16x16x64_bf16 v[84:87], v[56:59], a[32:39], v18
    ds_read_b64_tr_b16 v[112:113], v20
    ds_read_b64_tr_b16 v[114:115], v20 offset:128
    v_smfmac_f32_16x16x64_bf16 v[84:87], v[60:63], a[40:47], v18
    v_cmp_u_f32 vcc, v80, v81
    v_smfmac_f32_16x16x64_bf16 v[84:87], v[64:67], a[48:55], v18
    buffer_store_dword v32, v225, s[4:7], s38 offen
    v_smfmac_f32_16x16x64_bf16 v[84:87], v[68:71], a[56:63], v18
    s_cbranch_vccnz L_nan_5
L_cont_6:
    v_smfmac_f32_16x16x64_bf16 v[84:87], v[72:75], a[64:71], v18
    s_waitcnt lgkmcnt(0)
    buffer_store_dwordx4 v[112:115], v21, s[4:7], s42 offen
    v_smfmac_f32_16x16x64_bf16 v[84:87], v[76:79], a[72:79], v18
    v_smfmac_f32_16x16x64_bf16 v[88:91], v[40:43], a[80:87], v18
    v_smfmac_f32_16x16x64_bf16 v[88:91], v[44:47], a[88:95], v18
    v_smfmac_f32_16x16x64_bf16 v[88:91], v[48:51], a[96:103], v18
    v_smfmac_f32_16x16x64_bf16 v[88:91], v[52:55], a[104:111], v18
    v_smfmac_f32_16x16x64_bf16 v[88:91], v[56:59], a[112:119], v18
    v_add_f32 v84, v84, v86
    v_add_f32 v85, v85, v87
    v_smfmac_f32_16x16x64_bf16 v[88:91], v[60:63], a[120:127], v18
    v_cvt_pk_bf16_f32 v176, v84, v85
    v_smfmac_f32_16x16x64_bf16 v[88:91], v[64:67], a[128:135], v18
    v_smfmac_f32_16x16x64_bf16 v[88:91], v[68:71], a[136:143], v18
    v_smfmac_f32_16x16x64_bf16 v[88:91], v[72:75], a[144:151], v18
    v_smfmac_f32_16x16x64_bf16 v[88:91], v[76:79], a[152:159], v18
    s_nop 7
    v_pk_add_f32 v[88:89], v[88:89], v[90:91]
    v_cvt_pk_bf16_f32 v177, v88, v89
    ds_write_b64 v22, v[176:177]
    s_cmp_eq_u32 s32, 0
    s_cbranch_scc1 L_w0_7
    s_cmp_eq_u32 s32, 3
    s_cbranch_scc1 L_w3_8
    s_waitcnt lgkmcnt(0)
    s_barrier
    ds_read_b64_tr_b16 v[92:93], v23 offset:0
    ds_read_b64_tr_b16 v[94:95], v24 offset:0
    ds_read_b64_tr_b16 v[96:97], v23 offset:1024
    ds_read_b64_tr_b16 v[98:99], v24 offset:1024
    s_waitcnt lgkmcnt(2)
    v_mfma_f32_16x16x32_bf16 v[108:111], v[100:103], v[92:95], 0
    s_waitcnt lgkmcnt(0)
    v_mfma_f32_16x16x32_bf16 v[108:111], v[104:107], v[96:99], v[108:111]
    ds_read_b128 v[116:119], v11 offset:0
    ds_read_b128 v[120:123], v11 offset:2048
    ds_read_b128 v[124:127], v12 offset:0
    ds_read_b128 v[128:131], v12 offset:2048
    s_nop 3
    buffer_store_dwordx4 v[108:111], v25, s[4:7], s42 offen
    s_branch L_join_9
L_w0_7:
    s_waitcnt lgkmcnt(0)
    s_barrier
    ds_read_b64_tr_b16 v[92:93], v23 offset:0
    ds_read_b64_tr_b16 v[94:95], v24 offset:0
    ds_read_b64_tr_b16 v[96:97], v23 offset:1024
    ds_read_b64_tr_b16 v[98:99], v24 offset:1024
    s_waitcnt lgkmcnt(2)
    v_mfma_f32_16x16x32_bf16 v[108:111], v[92:95], v[92:95], 0
    s_waitcnt lgkmcnt(0)
    v_mfma_f32_16x16x32_bf16 v[108:111], v[96:99], v[96:99], v[108:111]
    ds_read_b128 v[116:119], v11 offset:0
    ds_read_b128 v[120:123], v11 offset:2048
    ds_read_b128 v[124:127], v12 offset:0
    ds_read_b128 v[128:131], v12 offset:2048
    s_nop 3
    buffer_store_dword v110, v25, s[4:7], s42 offen
    buffer_store_dword v111, v25, s[4:7], s42 offen offset:8
    s_branch L_join_9
L_w3_8:
    s_waitcnt lgkmcnt(0)
    s_barrier
    ds_read_b64_tr_b16 v[92:93], v23 offset:0
    ds_read_b64_tr_b16 v[94:95], v24 offset:0
    ds_read_b64_tr_b16 v[96:97], v23 offset:1024
    ds_read_b64_tr_b16 v[98:99], v24 offset:1024
    s_waitcnt lgkmcnt(0)
    ds_read_b128 v[116:119], v11 offset:0
    ds_read_b128 v[120:123], v11 offset:2048
    ds_read_b128 v[124:127], v12 offset:0
    ds_read_b128 v[128:131], v12 offset:2048
    s_waitcnt lgkmcnt(0)
    buffer_store_dwordx4 v[92:95], v26, s[4:7], s44 offen
    buffer_store_dwordx4 v[96:99], v26, s[4:7], s44 offen offset:512
L_join_9:
    s_cmp_eq_u32 s37, 63
    s_cbranch_scc1 L_skip_10
    s_lshl_b32 s90, s32, 10
    s_add_u32 m0, s90, s47
    s_waitcnt lgkmcnt(2)
    v_mfma_f32_16x16x32_bf16 v[140:143], a[160:163], v[116:119], 0
    ds_read_b128 v[132:135], v11 offset:4096
    v_mfma_f32_16x16x32_bf16 v[144:147], a[160:163], v[120:123], 0
    ds_read_b128 v[136:139], v11 offset:6144
    v_mfma_f32_16x16x32_bf16 v[148:151], a[80:83], v[116:119], 0
    v_mfma_f32_16x16x32_bf16 v[152:155], a[80:83], v[120:123], 0
    v_mfma_f32_16x16x32_bf16 v[156:159], a[0:3], v[116:119], 0
    buffer_store_dwordx4 v[164:167], v29, s[4:7], s51 offen
    v_mfma_f32_16x16x32_bf16 v[160:163], a[0:3], v[120:123], 0
    s_waitcnt lgkmcnt(2)
    v_mfma_f32_16x16x32_bf16 v[140:143], a[164:167], v[124:127], v[140:143]
    ds_read_b128 v[116:119], v12 offset:4096
    v_mfma_f32_16x16x32_bf16 v[144:147], a[164:167], v[128:131], v[144:147]
    ds_read_b128 v[120:123], v12 offset:6144
    v_mfma_f32_16x16x32_bf16 v[148:151], a[84:87], v[124:127], v[148:151]
    buffer_store_dwordx4 v[168:171], v29, s[4:7], s50 offen
    v_mfma_f32_16x16x32_bf16 v[152:155], a[84:87], v[128:131], v[152:155]
    v_mfma_f32_16x16x32_bf16 v[156:159], a[4:7], v[124:127], v[156:159]
    v_mfma_f32_16x16x32_bf16 v[160:163], a[4:7], v[128:131], v[160:163]
    s_waitcnt lgkmcnt(2)
    v_mfma_f32_16x16x32_bf16 v[140:143], a[168:171], v[132:135], v[140:143]
    ds_read_b128 v[124:127], v11 offset:8192
    v_mfma_f32_16x16x32_bf16 v[144:147], a[168:171], v[136:139], v[144:147]
    ds_read_b128 v[128:131], v11 offset:10240
    v_mfma_f32_16x16x32_bf16 v[148:151], a[88:91], v[132:135], v[148:151]
    buffer_store_dwordx4 v[172:175], v29, s[4:7], s45 offen
    v_mfma_f32_16x16x32_bf16 v[152:155], a[88:91], v[136:139], v[152:155]
    v_mfma_f32_16x16x32_bf16 v[156:159], a[8:11], v[132:135], v[156:159]
    buffer_store_dword v36, v226, s[4:7], s43 offen offset:0
    v_mfma_f32_16x16x32_bf16 v[160:163], a[8:11], v[136:139], v[160:163]
    s_waitcnt lgkmcnt(2)
    v_mfma_f32_16x16x32_bf16 v[140:143], a[172:175], v[116:119], v[140:143]
    ds_read_b128 v[132:135], v12 offset:8192
    v_mfma_f32_16x16x32_bf16 v[144:147], a[172:175], v[120:123], v[144:147]
    ds_read_b128 v[136:139], v12 offset:10240
    v_mfma_f32_16x16x32_bf16 v[148:151], a[92:95], v[116:119], v[148:151]
    buffer_store_dword v36, v227, s[4:7], s43 offen offset:0
    v_mfma_f32_16x16x32_bf16 v[152:155], a[92:95], v[120:123], v[152:155]
    buffer_store_dword v36, v219, s[4:7], s43 offen offset:0
    v_mfma_f32_16x16x32_bf16 v[156:159], a[12:15], v[116:119], v[156:159]
    buffer_store_dword v36, v227, s[4:7], s43 offen offset:256
    v_mfma_f32_16x16x32_bf16 v[160:163], a[12:15], v[120:123], v[160:163]
    s_waitcnt lgkmcnt(2)
    v_mfma_f32_16x16x32_bf16 v[140:143], a[176:179], v[124:127], v[140:143]
    ds_read_b128 v[116:119], v11 offset:12288
    v_mfma_f32_16x16x32_bf16 v[144:147], a[176:179], v[128:131], v[144:147]
    ds_read_b128 v[120:123], v11 offset:14336
    v_mfma_f32_16x16x32_bf16 v[148:151], a[96:99], v[124:127], v[148:151]
    buffer_load_dwordx4 v10, s[24:27], s46 offen offset:0 lds
    s_add_u32 m0, m0, 3968
    v_mfma_f32_16x16x32_bf16 v[152:155], a[96:99], v[128:131], v[152:155]
    buffer_load_dwordx4 v10, s[24:27], s46 offen offset:128 lds
    s_add_u32 m0, m0, 3968
    v_mfma_f32_16x16x32_bf16 v[156:159], a[16:19], v[124:127], v[156:159]
    v_mfma_f32_16x16x32_bf16 v[160:163], a[16:19], v[128:131], v[160:163]
    s_waitcnt lgkmcnt(2)
    v_mfma_f32_16x16x32_bf16 v[140:143], a[180:183], v[132:135], v[140:143]
    ds_read_b128 v[124:127], v12 offset:12288
    v_mfma_f32_16x16x32_bf16 v[144:147], a[180:183], v[136:139], v[144:147]
    ds_read_b128 v[128:131], v12 offset:14336
    v_mfma_f32_16x16x32_bf16 v[148:151], a[100:103], v[132:135], v[148:151]
    buffer_load_dwordx4 v10, s[24:27], s46 offen offset:256 lds
    s_add_u32 m0, m0, 3968
    v_mfma_f32_16x16x32_bf16 v[152:155], a[100:103], v[136:139], v[152:155]
    v_mfma_f32_16x16x32_bf16 v[156:159], a[20:23], v[132:135], v[156:159]
    s_waitcnt vmcnt(7)
    buffer_store_dword v32, v31, s[4:7], s38 offen
    v_mfma_f32_16x16x32_bf16 v[160:163], a[20:23], v[136:139], v[160:163]
    s_waitcnt lgkmcnt(2)
    s_and_b32 s52, s37, 3
    v_mfma_f32_16x16x32_bf16 v[140:143], a[184:187], v[116:119], v[140:143]
    ds_read_b128 v[132:135], v11 offset:16384
    s_mul_i32 s55, s52, 327680
    v_mfma_f32_16x16x32_bf16 v[144:147], a[184:187], v[120:123], v[144:147]
    ds_read_b128 v[136:139], v11 offset:18432
    s_add_u32 s37, s37, 1
    v_mfma_f32_16x16x32_bf16 v[148:151], a[104:107], v[116:119], v[148:151]
    buffer_load_dwordx4 v10, s[24:27], s46 offen offset:384 lds
    s_add_u32 m0, m0, 3968
    v_mfma_f32_16x16x32_bf16 v[152:155], a[104:107], v[120:123], v[152:155]
    s_mov_b32 s54, 0
    s_and_b32 s52, s37, 3
    v_mfma_f32_16x16x32_bf16 v[156:159], a[24:27], v[116:119], v[156:159]
    buffer_load_dwordx4 v10, s[24:27], s46 offen offset:512 lds
    s_add_u32 m0, m0, 3968
    v_mfma_f32_16x16x32_bf16 v[160:163], a[24:27], v[120:123], v[160:163]
    s_waitcnt lgkmcnt(2)
    s_mul_i32 s53, s52, 114688
    v_mfma_f32_16x16x32_bf16 v[140:143], a[188:191], v[124:127], v[140:143]
    ds_read_b128 v[116:119], v12 offset:16384
    s_add_u32 s42, s38, s53
    v_mfma_f32_16x16x32_bf16 v[144:147], a[188:191], v[128:131], v[144:147]
    ds_read_b128 v[120:123], v12 offset:18432
    s_lshl_b32 s52, s52, 12
    v_mfma_f32_16x16x32_bf16 v[148:151], a[108:111], v[124:127], v[148:151]
    buffer_load_dwordx4 v10, s[24:27], s46 offen offset:640 lds
    s_add_u32 m0, m0, 3968
    v_mfma_f32_16x16x32_bf16 v[152:155], a[108:111], v[128:131], v[152:155]
    v_add_u32 v35, s52, v28
    s_xor_b32 s52, s52, 8192
    v_mfma_f32_16x16x32_bf16 v[156:159], a[28:31], v[124:127], v[156:159]
    v_add_u32 v34, s52, v27
    s_add_u32 s44, s42, 40960
    v_mfma_f32_16x16x32_bf16 v[160:163], a[28:31], v[128:131], v[160:163]
    s_waitcnt lgkmcnt(2)
    s_mul_i32 s52, s52, 28
    v_mfma_f32_16x16x32_bf16 v[140:143], a[192:195], v[132:135], v[140:143]
    ds_read_b128 v[124:127], v11 offset:20480
    s_add_u32 s43, s38, s52
    v_mfma_f32_16x16x32_bf16 v[144:147], a[192:195], v[136:139], v[144:147]
    ds_read_b128 v[128:131], v11 offset:22528
    s_add_u32 s53, s37, 2
    v_mfma_f32_16x16x32_bf16 v[148:151], a[112:115], v[132:135], v[148:151]
    buffer_load_dwordx4 v10, s[24:27], s46 offen offset:768 lds
    s_add_u32 m0, m0, 3968
    v_mfma_f32_16x16x32_bf16 v[152:155], a[112:115], v[136:139], v[152:155]
    s_and_b32 s53, s53, 7
    s_mul_i32 s53, s53, 98304
    v_mfma_f32_16x16x32_bf16 v[156:159], a[32:35], v[132:135], v[156:159]
    buffer_load_dwordx4 v10, s[24:27], s46 offen offset:896 lds
    s_add_u32 m0, m0, 3968
    v_mfma_f32_16x16x32_bf16 v[160:163], a[32:35], v[136:139], v[160:163]
    s_waitcnt lgkmcnt(2)
    s_add_u32 s53, s53, 475136
    v_mfma_f32_16x16x32_bf16 v[140:143], a[196:199], v[116:119], v[140:143]
    ds_read_b128 v[132:135], v12 offset:20480
    s_add_u32 s45, s38, s53
    v_mfma_f32_16x16x32_bf16 v[144:147], a[196:199], v[120:123], v[144:147]
    ds_read_b128 v[136:139], v12 offset:22528
    s_add_u32 s50, s45, 49152
    v_mfma_f32_16x16x32_bf16 v[148:151], a[116:119], v[116:119], v[148:151]
    buffer_load_dwordx4 v10, s[24:27], s46 offen offset:1024 lds
    s_add_u32 m0, m0, 3968
    v_mfma_f32_16x16x32_bf16 v[152:155], a[116:119], v[120:123], v[152:155]
    s_add_u32 s51, s43, 65536
    v_add_u32 v32, s37, v220
    v_mfma_f32_16x16x32_bf16 v[156:159], a[36:39], v[116:119], v[156:159]
    v_mov_b32 v80, 0
    v_mov_b32 v81, 0
    v_mfma_f32_16x16x32_bf16 v[160:163], a[36:39], v[120:123], v[160:163]
    s_waitcnt lgkmcnt(2)
    v_mov_b32 v82, 0
    v_mfma_f32_16x16x32_bf16 v[140:143], a[200:203], v[124:127], v[140:143]
    ds_read_b128 v[116:119], v11 offset:24576
    v_mov_b32 v83, 0
    v_mfma_f32_16x16x32_bf16 v[144:147], a[200:203], v[128:131], v[144:147]
    ds_read_b128 v[120:123], v11 offset:26624
    v_mov_b32 v84, 0
    v_mfma_f32_16x16x32_bf16 v[148:151], a[120:123], v[124:127], v[148:151]
    buffer_load_dwordx4 v10, s[24:27], s46 offen offset:1152 lds
    v_mfma_f32_16x16x32_bf16 v[152:155], a[120:123], v[128:131], v[152:155]
    v_mov_b32 v85, 0
    v_mov_b32 v86, 0
    v_mfma_f32_16x16x32_bf16 v[156:159], a[40:43], v[124:127], v[156:159]
    v_mov_b32 v87, 0
    v_mov_b32 v88, 0
    v_mfma_f32_16x16x32_bf16 v[160:163], a[40:43], v[128:131], v[160:163]
    s_waitcnt lgkmcnt(2)
    v_mov_b32 v89, 0
    v_mfma_f32_16x16x32_bf16 v[140:143], a[204:207], v[132:135], v[140:143]
    ds_read_b128 v[124:127], v12 offset:24576
    v_mov_b32 v90, 0
    v_mfma_f32_16x16x32_bf16 v[144:147], a[204:207], v[136:139], v[144:147]
    ds_read_b128 v[128:131], v12 offset:26624
    v_mov_b32 v91, 0
    v_mfma_f32_16x16x32_bf16 v[148:151], a[124:127], v[132:135], v[148:151]
    v_mfma_f32_16x16x32_bf16 v[152:155], a[124:127], v[136:139], v[152:155]
    buffer_load_dword v217, v216, s[4:7], s38 offen sc1
    v_mfma_f32_16x16x32_bf16 v[156:159], a[44:47], v[132:135], v[156:159]
    v_mfma_f32_16x16x32_bf16 v[160:163], a[44:47], v[136:139], v[160:163]
    s_waitcnt lgkmcnt(2)
    v_mfma_f32_16x16x32_bf16 v[140:143], a[208:211], v[116:119], v[140:143]
    ds_read_b128 v[132:135], v11 offset:28672
    v_mfma_f32_16x16x32_bf16 v[144:147], a[208:211], v[120:123], v[144:147]
    ds_read_b128 v[136:139], v11 offset:30720
    v_mfma_f32_16x16x32_bf16 v[148:151], a[128:131], v[116:119], v[148:151]
    v_mfma_f32_16x16x32_bf16 v[152:155], a[128:131], v[120:123], v[152:155]
    v_mfma_f32_16x16x32_bf16 v[156:159], a[48:51], v[116:119], v[156:159]
    v_mfma_f32_16x16x32_bf16 v[160:163], a[48:51], v[120:123], v[160:163]
    s_waitcnt lgkmcnt(2)
    v_mfma_f32_16x16x32_bf16 v[140:143], a[212:215], v[124:127], v[140:143]
    ds_read_b128 v[116:119], v12 offset:28672
    v_mfma_f32_16x16x32_bf16 v[144:147], a[212:215], v[128:131], v[144:147]
    ds_read_b128 v[120:123], v12 offset:30720
    v_mfma_f32_16x16x32_bf16 v[148:151], a[132:135], v[124:127], v[148:151]
    v_mfma_f32_16x16x32_bf16 v[152:155], a[132:135], v[128:131], v[152:155]
    v_mfma_f32_16x16x32_bf16 v[156:159], a[52:55], v[124:127], v[156:159]
    v_mfma_f32_16x16x32_bf16 v[160:163], a[52:55], v[128:131], v[160:163]
    s_waitcnt lgkmcnt(2)
    s_waitcnt vmcnt(0)
    v_cmp_gt_u32 vcc, s37, v217
    s_cbranch_vccnz L_tw_11
L_tok_12:
    s_barrier
    buffer_load_dwordx4 v[180:183], v214, s[4:7], s55 offen sc1
    buffer_load_dwordx4 v[184:187], v215, s[4:7], s55 offen sc1
    v_mfma_f32_16x16x32_bf16 v[140:143], a[216:219], v[132:135], v[140:143]
    ds_read_b128 v[124:127], v11 offset:32768
    v_mfma_f32_16x16x32_bf16 v[144:147], a[216:219], v[136:139], v[144:147]
    ds_read_b128 v[128:131], v11 offset:34816
    v_mfma_f32_16x16x32_bf16 v[148:151], a[136:139], v[132:135], v[148:151]
    v_mfma_f32_16x16x32_bf16 v[152:155], a[136:139], v[136:139], v[152:155]
    v_mfma_f32_16x16x32_bf16 v[156:159], a[56:59], v[132:135], v[156:159]
    v_mfma_f32_16x16x32_bf16 v[160:163], a[56:59], v[136:139], v[160:163]
    s_waitcnt lgkmcnt(2)
    v_mfma_f32_16x16x32_bf16 v[140:143], a[220:223], v[116:119], v[140:143]
    ds_read_b128 v[132:135], v12 offset:32768
    v_mfma_f32_16x16x32_bf16 v[144:147], a[220:223], v[120:123], v[144:147]
    ds_read_b128 v[136:139], v12 offset:34816
    v_mfma_f32_16x16x32_bf16 v[148:151], a[140:143], v[116:119], v[148:151]
    v_mfma_f32_16x16x32_bf16 v[152:155], a[140:143], v[120:123], v[152:155]
    v_mfma_f32_16x16x32_bf16 v[156:159], a[60:63], v[116:119], v[156:159]
    v_mfma_f32_16x16x32_bf16 v[160:163], a[60:63], v[120:123], v[160:163]
    s_waitcnt lgkmcnt(2)
    buffer_load_dwordx4 v[188:191], v223, s[4:7], s55 offen sc1
    buffer_load_dwordx4 v[192:195], v224, s[4:7], s55 offen sc1
    v_mfma_f32_16x16x32_bf16 v[140:143], a[224:227], v[124:127], v[140:143]
    ds_read_b128 v[116:119], v11 offset:36864
    v_mfma_f32_16x16x32_bf16 v[144:147], a[224:227], v[128:131], v[144:147]
    ds_read_b128 v[120:123], v11 offset:38912
    v_mfma_f32_16x16x32_bf16 v[148:151], a[144:147], v[124:127], v[148:151]
    v_mfma_f32_16x16x32_bf16 v[152:155], a[144:147], v[128:131], v[152:155]
    v_mfma_f32_16x16x32_bf16 v[156:159], a[64:67], v[124:127], v[156:159]
    v_mfma_f32_16x16x32_bf16 v[160:163], a[64:67], v[128:131], v[160:163]
    s_waitcnt lgkmcnt(2)
    v_mfma_f32_16x16x32_bf16 v[140:143], a[228:231], v[132:135], v[140:143]
    ds_read_b128 v[124:127], v12 offset:36864
    v_mfma_f32_16x16x32_bf16 v[144:147], a[228:231], v[136:139], v[144:147]
    ds_read_b128 v[128:131], v12 offset:38912
    v_mfma_f32_16x16x32_bf16 v[148:151], a[148:151], v[132:135], v[148:151]
    v_mfma_f32_16x16x32_bf16 v[152:155], a[148:151], v[136:139], v[152:155]
    v_mfma_f32_16x16x32_bf16 v[156:159], a[68:71], v[132:135], v[156:159]
    v_mfma_f32_16x16x32_bf16 v[160:163], a[68:71], v[136:139], v[160:163]
    s_waitcnt lgkmcnt(0)
    s_waitcnt vmcnt(3)
    v_mfma_f32_16x16x32_bf16 v[196:199], v[210:213], v[180:183], 0
    v_mfma_f32_16x16x32_bf16 v[200:203], v[208:211], v[180:183], 0
    v_max3_u32 v221, v180, v181, v182
    s_waitcnt vmcnt(2)
    v_mfma_f32_16x16x32_bf16 v[196:199], v[210:213], v[184:187], v[196:199]
    v_max3_u32 v222, v183, v184, v185
    v_max3_u32 v221, v221, v186, v187
    v_mfma_f32_16x16x32_bf16 v[200:203], v[208:211], v[184:187], v[200:203]
    v_max_u32 v221, v221, v222
    v_cmp_eq_u32 vcc, -1, v221
    s_nop 2
    v_cvt_pk_bf16_f32 v204, v196, v197
    v_cvt_pk_bf16_f32 v205, v198, v199
    s_cbranch_vccnz L_pp_13
    v_cvt_pk_bf16_f32 v206, v200, v201
    v_cvt_pk_bf16_f32 v207, v202, v203
    buffer_store_dwordx4 v[204:207], v218, s[4:7], s42 offen
L_pc_14:
    v_mfma_f32_16x16x32_bf16 v[140:143], a[232:235], v[116:119], v[140:143]
    v_mfma_f32_16x16x32_bf16 v[144:147], a[232:235], v[120:123], v[144:147]
    v_mfma_f32_16x16x32_bf16 v[140:143], a[236:239], v[124:127], v[140:143]
    v_mfma_f32_16x16x32_bf16 v[144:147], a[236:239], v[128:131], v[144:147]
    v_mfma_f32_16x16x32_bf16 v[148:151], a[152:155], v[116:119], v[148:151]
    v_add_u32 v11, s49, v11
    v_add_u32 v12, s49, v12
    v_mfma_f32_16x16x32_bf16 v[152:155], a[152:155], v[120:123], v[152:155]
    s_sub_u32 s47, s47, s49
    s_sub_u32 s49, 0, s49
    v_mfma_f32_16x16x32_bf16 v[148:151], a[156:159], v[124:127], v[148:151]
    v_mfma_f32_16x16x32_bf16 v[152:155], a[156:159], v[128:131], v[152:155]
    v_mfma_f32_16x16x32_bf16 v[156:159], a[72:75], v[116:119], v[156:159]
    v_cvt_pk_bf16_f32 v164, v140, v141
    v_cvt_pk_bf16_f32 v165, v142, v143
    v_mfma_f32_16x16x32_bf16 v[160:163], a[72:75], v[120:123], v[160:163]
    v_cvt_pk_bf16_f32 v166, v144, v145
    v_cvt_pk_bf16_f32 v167, v146, v147
    v_mfma_f32_16x16x32_bf16 v[156:159], a[76:79], v[124:127], v[156:159]
    v_permlane16_swap_b32 v164, v166
    v_permlane16_swap_b32 v165, v167
    v_mfma_f32_16x16x32_bf16 v[160:163], a[76:79], v[128:131], v[160:163]
    s_branch L_qkv_loop_f
L_skip_10:
    s_waitcnt vmcnt(0) lgkmcnt(0)
    buffer_store_dword v32, v31, s[4:7], s38 offen
    s_endpgm
L_nan_5:
    s_cmp_eq_u32 s54, 1
    s_cbranch_scc1 L_cont_6
    v_lshlrev_b32 v1, 4, v0
L_nan_5r:
    s_mov_b32 s90, s42
    v_mov_b32 v2, 0
    buffer_load_dwordx4 v[40:43], v1, s[4:7], s90 offen sc1
    s_add_u32 s90, s90, 1024
    buffer_load_dwordx4 v[44:47], v1, s[4:7], s90 offen sc1
    s_add_u32 s90, s90, 1024
    buffer_load_dwordx4 v[48:51], v1, s[4:7], s90 offen sc1
    s_add_u32 s90, s90, 1024
    buffer_load_dwordx4 v[52:55], v1, s[4:7], s90 offen sc1
    s_add_u32 s90, s90, 1024
    buffer_load_dwordx4 v[56:59], v1, s[4:7], s90 offen sc1
    s_add_u32 s90, s90, 1024
    buffer_load_dwordx4 v[60:63], v1, s[4:7], s90 offen sc1
    s_add_u32 s90, s90, 1024
    buffer_load_dwordx4 v[64:67], v1, s[4:7], s90 offen sc1
    s_add_u32 s90, s90, 1024
    buffer_load_dwordx4 v[68:71], v1, s[4:7], s90 offen sc1
    s_add_u32 s90, s90, 1024
    buffer_load_dwordx4 v[72:75], v1, s[4:7], s90 offen sc1
    s_add_u32 s90, s90, 1024
    buffer_load_dwordx4 v[76:79], v1, s[4:7], s90 offen sc1
    s_add_u32 s90, s90, 1024
    s_sub_u32 s36, s36, 1
    s_cbranch_scc1 L_exit
    s_waitcnt vmcnt(0) lgkmcnt(0)
    v_max3_u32 v2, v2, v40, v41
    v_max3_u32 v2, v2, v42, v43
    v_max3_u32 v2, v2, v44, v45
    v_max3_u32 v2, v2, v46, v47
    v_max3_u32 v2, v2, v48, v49
    v_max3_u32 v2, v2, v50, v51
    v_max3_u32 v2, v2, v52, v53
    v_max3_u32 v2, v2, v54, v55
    v_max3_u32 v2, v2, v56, v57
    v_max3_u32 v2, v2, v58, v59
    v_max3_u32 v2, v2, v60, v61
    v_max3_u32 v2, v2, v62, v63
    v_max3_u32 v2, v2, v64, v65
    v_max3_u32 v2, v2, v66, v67
    v_max3_u32 v2, v2, v68, v69
    v_max3_u32 v2, v2, v70, v71
    v_max3_u32 v2, v2, v72, v73
    v_max3_u32 v2, v2, v74, v75
    v_max3_u32 v2, v2, v76, v77
    v_max3_u32 v2, v2, v78, v79
    v_cmp_eq_u32 vcc, -1, v2
    s_cbranch_vccnz L_nan_5r
    s_mov_b32 s54, 1
    v_mov_b32 v80, 0
    v_mov_b32 v81, 0
    v_mov_b32 v82, 0
    v_mov_b32 v83, 0
    v_mov_b32 v84, 0
    v_mov_b32 v85, 0
    v_mov_b32 v86, 0
    v_mov_b32 v87, 0
    v_mov_b32 v88, 0
    v_mov_b32 v89, 0
    v_mov_b32 v90, 0
    v_mov_b32 v91, 0
    v_smfmac_f32_16x16x64_bf16 v[80:83], v[40:43], a[160:167], v18
    v_smfmac_f32_16x16x64_bf16 v[80:83], v[44:47], a[168:175], v18
    v_smfmac_f32_16x16x64_bf16 v[80:83], v[48:51], a[176:183], v18
    v_smfmac_f32_16x16x64_bf16 v[80:83], v[52:55], a[184:191], v18
    v_smfmac_f32_16x16x64_bf16 v[80:83], v[56:59], a[192:199], v18
    v_smfmac_f32_16x16x64_bf16 v[80:83], v[60:63], a[200:207], v18
    v_smfmac_f32_16x16x64_bf16 v[80:83], v[64:67], a[208:215], v18
    v_smfmac_f32_16x16x64_bf16 v[80:83], v[68:71], a[216:223], v18
    v_smfmac_f32_16x16x64_bf16 v[80:83], v[72:75], a[224:231], v18
    v_smfmac_f32_16x16x64_bf16 v[80:83], v[76:79], a[232:239], v18
    s_nop 3
    s_branch L_got_3r
L_tw_11:
    buffer_load_dword v217, v216, s[4:7], s38 offen sc1
    buffer_load_dword v217, v216, s[4:7], s38 offen sc1
L_tw_11a:
    buffer_load_dword v217, v216, s[4:7], s38 offen sc1
    s_sub_u32 s36, s36, 1
    s_cbranch_scc1 L_exit
    s_waitcnt vmcnt(2)
    v_cmp_gt_u32 vcc, s37, v217
    s_cbranch_vccz L_tok_12
    s_branch L_tw_11a
L_pp_13:
L_pp_13a:
    s_waitcnt vmcnt(1)
    v_mfma_f32_16x16x32_bf16 v[196:199], v[210:213], v[188:191], 0
    v_mfma_f32_16x16x32_bf16 v[200:203], v[208:211], v[188:191], 0
    v_max3_u32 v221, v188, v189, v190
    s_waitcnt vmcnt(0)
    v_mfma_f32_16x16x32_bf16 v[196:199], v[210:213], v[192:195], v[196:199]
    v_max3_u32 v222, v191, v192, v193
    v_max3_u32 v221, v221, v194, v195
    v_mfma_f32_16x16x32_bf16 v[200:203], v[208:211], v[192:195], v[200:203]
    v_max_u32 v221, v221, v222
    v_cmp_eq_u32 vcc, -1, v221
    s_nop 2
    v_cvt_pk_bf16_f32 v204, v196, v197
    v_cvt_pk_bf16_f32 v205, v198, v199
    s_cbranch_vccnz L_pp_13b
    v_cvt_pk_bf16_f32 v206, v200, v201
    v_cvt_pk_bf16_f32 v207, v202, v203
    buffer_store_dwordx4 v[204:207], v218, s[4:7], s42 offen
    s_branch L_pc_14
L_pp_13b:
    buffer_load_dwordx4 v[188:191], v214, s[4:7], s55 offen sc1
    buffer_load_dwordx4 v[192:195], v215, s[4:7], s55 offen sc1
    s_sub_u32 s36, s36, 1
    s_cbranch_scc1 L_exit
    s_branch L_pp_13a
L_wo_f:
    s_mov_b32 s12, s80
    s_and_b32 s13, s81, 0xffff
    s_mov_b32 s14, 7864320
    s_mov_b32 s15, 0x20000
    s_mov_b32 s16, s72
    s_and_b32 s17, s73, 0xffff
    s_mov_b32 s18, 10240
    s_mov_b32 s19, 0x20000
    s_sub_u32 s40, s35, 12
    v_and_b32 v1, 15, v0
    v_lshrrev_b32 v2, 4, v0
    v_lshrrev_b32 v3, 3, v0
    v_and_b32 v4, 7, v0
    v_and_b32 v6, 2, v3
    v_xor_b32 v6, v6, v4
    v_lshlrev_b32 v6, 4, v6
    v_mul_u32_u24 v7, 1280, v3
    s_lshl_b32 s90, s34, 2
    s_add_u32 s90, s90, s32
    s_mul_i32 s90, s90, 245760
    s_lshl_b32 s91, s40, 7
    s_add_u32 s90, s90, s91
    v_add3_u32 v180, v6, v7, s90
    v_xor_b32 v181, 64, v180
    s_mul_i32 s90, s40, 32768
    s_lshl_b32 s91, s32, 11
    s_add_u32 s90, s90, s91
    s_lshr_b32 s91, s32, 1
    s_mul_i32 s91, s91, 0
    s_xor_b32 s91, s91, s34
    v_mul_u32_u24 v7, 0, v2
    v_xor_b32 v7, s91, v7
    v_lshlrev_b32 v6, 4, v1
    v_lshl_add_u32 v7, v7, 8, v6
    v_lshl_add_u32 v7, v2, 13, v7
    v_add_u32 v14, s90, v7
    v_lshlrev_b32 v12, 4, v0
    v_lshlrev_b32 v13, 2, v0
    v_add_u32 v46, s90, v13
    s_xor_b32 s92, s91, 0
    s_lshl_b32 s92, s92, 8
    s_add_u32 s60, s92, 0
    s_xor_b32 s92, s91, 0
    s_lshl_b32 s92, s92, 8
    s_add_u32 s61, s92, 8192
    s_xor_b32 s92, s91, 0
    s_lshl_b32 s92, s92, 8
    s_add_u32 s62, s92, 16384
    s_xor_b32 s92, s91, 0
    s_lshl_b32 s92, s92, 8
    s_add_u32 s63, s92, 24576
    s_lshl_b32 s92, s40, 7
    s_lshl_b32 s93, s32, 2
    s_add_u32 s92, s92, s93
    s_add_u32 s92, s92, 460800
    v_mov_b32 v244, s92
    v_cmp_eq_u32 vcc, 0, v0
    v_mov_b32 v9, 2146435072
    s_nop 0
    v_cndmask_b32 v244, v9, v244, vcc
    s_lshl_b32 s92, s32, 7
    s_add_u32 s92, s92, 462336
    v_min_u32 v3, 2, v0
    v_lshl_add_u32 v245, v3, 2, s92
    s_lshl_b32 s90, s40, 2
    s_add_u32 s90, s90, s32
    s_lshl_b32 s91, s90, 8
    v_add_u32 v17, s91, v6
    v_cmp_eq_u32 vcc, 0, v2
    v_mov_b32 v9, 2146435072
    s_nop 0
    v_cndmask_b32 v17, v9, v17, vcc
    v_lshrrev_b32 v3, 2, v1
    v_and_b32 v7, 1, v1
    v_lshl_or_b32 v4, v3, 1, v7
    v_mul_u32_u24 v4, 1280, v4
    v_and_b32 v5, 2, v1
    v_lshl_add_u32 v4, v5, 1, v4
    s_lshl_b32 s91, s90, 5
    v_add_u32 v4, s91, v4
    v_lshlrev_b32 v6, 6, v3
    v_lshl_add_u32 v6, v7, 5, v6
    v_lshl_add_u32 v6, v2, 3, v6
    v_lshl_add_u32 v6, v5, 1, v6
    s_mul_i32 s92, s32, 1152
    s_add_u32 s92, s92, 122880
    v_add_u32 v18, s92, v6
    buffer_load_dword v164, v4, s[16:19], 0 offen offset:0
    buffer_load_dword v165, v4, s[16:19], 0 offen offset:8
    buffer_load_dword v166, v4, s[16:19], 0 offen offset:16
    buffer_load_dword v167, v4, s[16:19], 0 offen offset:24
    v_mov_b32 v168, -1
    v_mov_b32 v169, -1
    v_mov_b32 v170, -1
    v_mov_b32 v171, -1
    s_mul_i32 s90, s32, 24576
    s_mov_b32 m0, s90
    s_mov_b32 s91, 0
    buffer_load_dwordx4 v180, s[12:15], s91 offen nt lds
    s_add_u32 m0, m0, 1024
    s_add_u32 s91, s91, 10240
    buffer_load_dwordx4 v181, s[12:15], s91 offen nt lds
    s_add_u32 m0, m0, 1024
    s_add_u32 s91, s91, 10240
    buffer_load_dwordx4 v180, s[12:15], s91 offen nt lds
    s_add_u32 m0, m0, 1024
    s_add_u32 s91, s91, 10240
    buffer_load_dwordx4 v181, s[12:15], s91 offen nt lds
    s_add_u32 m0, m0, 1024
    s_add_u32 s91, s91, 10240
    buffer_load_dwordx4 v180, s[12:15], s91 offen nt lds
    s_add_u32 m0, m0, 1024
    s_add_u32 s91, s91, 10240
    buffer_load_dwordx4 v181, s[12:15], s91 offen nt lds
    s_add_u32 m0, m0, 1024
    s_add_u32 s91, s91, 10240
    buffer_load_dwordx4 v180, s[12:15], s91 offen nt lds
    s_add_u32 m0, m0, 1024
    s_add_u32 s91, s91, 10240
    buffer_load_dwordx4 v181, s[12:15], s91 offen nt lds
    s_add_u32 m0, m0, 1024
    s_add_u32 s91, s91, 10240
    buffer_load_dwordx4 v180, s[12:15], s91 offen nt lds
    s_add_u32 m0, m0, 1024
    s_add_u32 s91, s91, 10240
    buffer_load_dwordx4 v181, s[12:15], s91 offen nt lds
    s_add_u32 m0, m0, 1024
    s_add_u32 s91, s91, 10240
    buffer_load_dwordx4 v180, s[12:15], s91 offen nt lds
    s_add_u32 m0, m0, 1024
    s_add_u32 s91, s91, 10240
    buffer_load_dwordx4 v181, s[12:15], s91 offen nt lds
    s_add_u32 m0, m0, 1024
    s_add_u32 s91, s91, 10240
    buffer_load_dwordx4 v180, s[12:15], s91 offen nt lds
    s_add_u32 m0, m0, 1024
    s_add_u32 s91, s91, 10240
    buffer_load_dwordx4 v181, s[12:15], s91 offen nt lds
    s_add_u32 m0, m0, 1024
    s_add_u32 s91, s91, 10240
    buffer_load_dwordx4 v180, s[12:15], s91 offen nt lds
    s_add_u32 m0, m0, 1024
    s_add_u32 s91, s91, 10240
    buffer_load_dwordx4 v181, s[12:15], s91 offen nt lds
    s_add_u32 m0, m0, 1024
    s_add_u32 s91, s91, 10240
    buffer_load_dwordx4 v180, s[12:15], s91 offen nt lds
    s_add_u32 m0, m0, 1024
    s_add_u32 s91, s91, 10240
    buffer_load_dwordx4 v181, s[12:15], s91 offen nt lds
    s_add_u32 m0, m0, 1024
    s_add_u32 s91, s91, 10240
    buffer_load_dwordx4 v180, s[12:15], s91 offen nt lds
    s_add_u32 m0, m0, 1024
    s_add_u32 s91, s91, 10240
    buffer_load_dwordx4 v181, s[12:15], s91 offen nt lds
    s_add_u32 m0, m0, 1024
    s_add_u32 s91, s91, 10240
    buffer_load_dwordx4 v180, s[12:15], s91 offen nt lds
    s_add_u32 m0, m0, 1024
    s_add_u32 s91, s91, 10240
    buffer_load_dwordx4 v181, s[12:15], s91 offen nt lds
    s_add_u32 m0, m0, 1024
    s_add_u32 s91, s91, 10240
    buffer_load_dwordx4 v180, s[12:15], s91 offen nt lds
    s_add_u32 m0, m0, 1024
    s_add_u32 s91, s91, 10240
    buffer_load_dwordx4 v181, s[12:15], s91 offen nt lds
    s_waitcnt vmcnt(24)
    v_min_u32 v164, -2, v164
    v_min_u32 v165, -2, v165
    v_min_u32 v166, -2, v166
    v_min_u32 v167, -2, v167
    v_and_b32 v7, 2, v1
    v_cmp_ne_u32 vcc, 0, v7
    v_mov_b32 v5, 0x4444
    v_mov_b32 v6, 0xeeee
    v_cndmask_b32 v10, v5, v6, vcc
    v_mov_b32 v5, 0xe484
    v_mov_b32 v6, 0xee9e
    v_cndmask_b32 v7, v5, v6, vcc
    v_mov_b32 v5, 0x84e4
    v_mov_b32 v6, 0x9eee
    v_cndmask_b32 v8, v5, v6, vcc
    v_cmp_gt_u32 vcc, 2, v2
    s_nop 1
    v_cndmask_b32 v11, v8, v7, vcc
    v_mov_b32 v84, 1065369472
    v_mov_b32 v85, 1065369472
    v_mov_b32 v86, 1065369472
    v_mov_b32 v87, 0
    v_mov_b32 v88, 1065369472
    v_mov_b32 v89, 1065369472
    v_mov_b32 v90, 1065369472
    v_mov_b32 v91, 0
    v_mov_b32 v51, 0
    v_mov_b32 v55, 0
    v_mov_b32 v59, 0
    v_mov_b32 v63, 0
    v_mov_b32 v67, 0
    v_mov_b32 v71, 0
    v_mov_b32 v75, 0
    v_mov_b32 v79, 0
    v_mov_b32 v210, 0
    v_mov_b32 v211, 0
    v_mov_b32 v218, 0
    v_mov_b32 v219, 0
    v_and_b32 v7, 1, v1
    v_cmp_ne_u32 vcc, 0, v7
    v_mov_b32 v5, 0x3f80
    v_mov_b32 v6, 0x3f800000
    v_cndmask_b32 v5, v5, v6, vcc
    v_bfe_u32 v6, v1, 1, 1
    v_cmp_eq_u32 vcc, 0, v6
    s_nop 1
    v_cndmask_b32 v110, 0, v5, vcc
    v_mov_b32 v108, 0
    v_mov_b32 v112, 0
    v_cmp_eq_u32 vcc, 1, v6
    s_nop 1
    v_cndmask_b32 v111, 0, v5, vcc
    v_mov_b32 v109, 0
    v_mov_b32 v113, 0
    v_mov_b32 v240, 0x3dd53b95
    v_mov_b32 v241, 0x3dd53b95
    s_lshl_b32 s90, s32, 8
    s_add_u32 s90, s90, 122880
    v_mul_u32_u24 v6, 1152, v2
    v_lshl_add_u32 v6, v1, 3, v6
    v_add_u32 v19, s90, v6
    s_mul_i32 s90, s32, 1536
    v_add_u32 v20, s90, v12
    s_add_u32 s90, s90, 1024
    v_lshl_add_u32 v21, v0, 3, s90
    s_mul_i32 s90, s32, 6144
    v_add_u32 v22, s90, v12
    s_add_u32 s90, s90, 1024
    v_lshl_add_u32 v23, v0, 3, s90
    v_add_u32 v28, 98304, v12
    s_mul_i32 s90, s32, 3072
    v_add_u32 v37, s90, v12
    v_add_u32 v44, 25600, v37
    s_add_u32 s54, s90, 98304
    s_mul_i32 s90, s32, 3840
    s_add_u32 s90, s90, 10240
    v_add_u32 v38, s90, v12
    s_add_u32 s90, s90, 1024
    v_add_u32 v39, s90, v13
    s_mul_i32 s90, s32, 12288
    v_add_u32 v40, s90, v12
    s_lshl_b32 s90, s40, 15
    s_lshl_b32 s92, s32, 10
    s_add_u32 s90, s90, s92
    v_lshrrev_b32 v5, 3, v0
    v_mul_u32_u24 v5, 0, v5
    v_xor_b32 v5, s34, v5
    v_and_b32 v6, 7, v1
    v_lshlrev_b32 v6, 4, v6
    v_lshl_add_u32 v6, v5, 7, v6
    v_lshrrev_b32 v7, 3, v1
    v_lshl_add_u32 v6, v7, 12, v6
    v_lshrrev_b32 v5, 1, v2
    v_lshl_add_u32 v6, v5, 13, v6
    v_and_b32 v5, 1, v2
    v_lshl_add_u32 v6, v5, 14, v6
    v_add_u32 v30, s90, v6
    s_and_b32 s91, s34, 1
    s_lshl_b32 s91, s91, 12
    s_add_u32 s90, s90, s91
    s_lshr_b32 s91, s34, 2
    s_lshl_b32 s91, s91, 13
    s_add_u32 s90, s90, s91
    s_and_b32 s91, s34, 2
    s_lshl_b32 s91, s91, 13
    s_add_u32 s90, s90, s91
    v_add_u32 v31, s90, v12
    s_lshr_b32 s91, s34, 1
    s_mul_i32 s91, s91, 10240
    s_lshl_b32 s92, s40, 7
    s_add_u32 s91, s91, s92
    s_lshl_b32 s92, s32, 5
    s_add_u32 s91, s91, s92
    s_and_b32 s92, s34, 1
    s_lshl_b32 s92, s92, 4
    s_add_u32 s91, s91, s92
    s_add_u32 s91, s91, 1280
    v_lshl_add_u32 v6, v7, 4, v2
    v_mul_u32_u24 v6, 2560, v6
    v_and_b32 v5, 7, v1
    v_lshl_add_u32 v6, v5, 1, v6
    v_add_u32 v32, s91, v6
    v_cmp_gt_u32 s[58:59], 8, v1
    v_and_b32 v5, 1, v1
    v_lshrrev_b32 v6, 3, v1
    v_lshl_add_u32 v5, v5, 1, v6
    v_bfe_u32 v6, v1, 2, 1
    v_cmp_ne_u32 vcc, 0, v6
    v_mov_b32 v6, 0x3f80
    v_mov_b32 v7, 0x3f800000
    v_cndmask_b32 v6, v6, v7, vcc
    v_cmp_eq_u32 vcc, 0, v5
    s_nop 1
    v_cndmask_b32 v7, 0, v6, vcc
    v_accvgpr_write_b32 a144, v7
    v_cmp_eq_u32 vcc, 1, v5
    s_nop 1
    v_cndmask_b32 v7, 0, v6, vcc
    v_accvgpr_write_b32 a145, v7
    v_cmp_eq_u32 vcc, 2, v5
    s_nop 1
    v_cndmask_b32 v7, 0, v6, vcc
    v_accvgpr_write_b32 a146, v7
    v_cmp_eq_u32 vcc, 3, v5
    s_nop 1
    v_cndmask_b32 v7, 0, v6, vcc
    v_accvgpr_write_b32 a147, v7
    s_lshl_b32 s90, s32, 7
    v_add_u32 v5, s90, v13
    v_add_u32 v6, 458752, v5
    v_add_u32 v7, 459728, v5
    v_cmp_gt_u32 vcc, 12, v0
    s_nop 1
    v_cndmask_b32 v33, v7, v6, vcc
    v_mov_b32 v5, -2
    v_cndmask_b32 v34, v5, 3, vcc
    v_cmp_gt_u32 vcc, 14, v0
    v_mov_b32 v9, 2146435072
    s_nop 0
    v_cndmask_b32 v33, v9, v33, vcc
    v_mov_b32 v5, -1000
    v_cndmask_b32 v34, v5, v34, vcc
    v_and_b32 v4, 3, v1
    v_and_b32 v5, 1, v2
    v_lshl_add_u32 v6, v2, 3, v3
    v_lshlrev_b32 v6, 7, v6
    v_and_b32 v7, 2, v3
    v_lshl_or_b32 v7, v5, 2, v7
    v_lshrrev_b32 v8, 1, v4
    v_xor_b32 v7, v7, v8
    v_lshl_add_u32 v6, v7, 4, v6
    v_and_b32 v7, 1, v4
    v_lshl_add_u32 v6, v7, 3, v6
    s_mul_i32 s90, s32, 24576
    v_add_u32 v6, s90, v6
    v_xor_b32 v182, 0, v6
    v_xor_b32 v183, 32, v6
    v_xor_b32 v184, 64, v6
    v_xor_b32 v185, 96, v6
    s_waitcnt vmcnt(0)
    ds_read_b64_tr_b16 a[0:1], v182 offset:0
    ds_read_b64_tr_b16 a[2:3], v182 offset:512
    ds_read_b64_tr_b16 a[4:5], v182 offset:4096
    ds_read_b64_tr_b16 a[6:7], v182 offset:4608
    ds_read_b64_tr_b16 a[8:9], v182 offset:8192
    ds_read_b64_tr_b16 a[10:11], v182 offset:8704
    ds_read_b64_tr_b16 a[12:13], v182 offset:12288
    ds_read_b64_tr_b16 a[14:15], v182 offset:12800
    ds_read_b64_tr_b16 a[16:17], v182 offset:16384
    ds_read_b64_tr_b16 a[18:19], v182 offset:16896
    ds_read_b64_tr_b16 a[20:21], v182 offset:20480
    ds_read_b64_tr_b16 a[22:23], v182 offset:20992
    ds_read_b64_tr_b16 a[24:25], v183 offset:0
    ds_read_b64_tr_b16 a[26:27], v183 offset:512
    ds_read_b64_tr_b16 a[28:29], v183 offset:4096
    ds_read_b64_tr_b16 a[30:31], v183 offset:4608
    ds_read_b64_tr_b16 a[32:33], v183 offset:8192
    ds_read_b64_tr_b16 a[34:35], v183 offset:8704
    ds_read_b64_tr_b16 a[36:37], v183 offset:12288
    ds_read_b64_tr_b16 a[38:39], v183 offset:12800
    ds_read_b64_tr_b16 a[40:41], v183 offset:16384
    ds_read_b64_tr_b16 a[42:43], v183 offset:16896
    ds_read_b64_tr_b16 a[44:45], v183 offset:20480
    ds_read_b64_tr_b16 a[46:47], v183 offset:20992
    ds_read_b64_tr_b16 a[48:49], v184 offset:0
    ds_read_b64_tr_b16 a[50:51], v184 offset:512
    ds_read_b64_tr_b16 a[52:53], v184 offset:4096
    ds_read_b64_tr_b16 a[54:55], v184 offset:4608
    ds_read_b64_tr_b16 a[56:57], v184 offset:8192
    ds_read_b64_tr_b16 a[58:59], v184 offset:8704
    ds_read_b64_tr_b16 a[60:61], v184 offset:12288
    ds_read_b64_tr_b16 a[62:63], v184 offset:12800
    ds_read_b64_tr_b16 a[64:65], v184 offset:16384
    ds_read_b64_tr_b16 a[66:67], v184 offset:16896
    ds_read_b64_tr_b16 a[68:69], v184 offset:20480
    ds_read_b64_tr_b16 a[70:71], v184 offset:20992
    ds_read_b64_tr_b16 a[72:73], v185 offset:0
    ds_read_b64_tr_b16 a[74:75], v185 offset:512
    ds_read_b64_tr_b16 a[76:77], v185 offset:4096
    ds_read_b64_tr_b16 a[78:79], v185 offset:4608
    ds_read_b64_tr_b16 a[80:81], v185 offset:8192
    ds_read_b64_tr_b16 a[82:83], v185 offset:8704
    ds_read_b64_tr_b16 a[84:85], v185 offset:12288
    ds_read_b64_tr_b16 a[86:87], v185 offset:12800
    ds_read_b64_tr_b16 a[88:89], v185 offset:16384
    ds_read_b64_tr_b16 a[90:91], v185 offset:16896
    ds_read_b64_tr_b16 a[92:93], v185 offset:20480
    ds_read_b64_tr_b16 a[94:95], v185 offset:20992
    s_waitcnt lgkmcnt(0)
    s_barrier
    v_mov_b32 v1, 192
L_gw_15:
    buffer_load_dword v2, v1, s[8:11], 0 offen sc1
    s_sub_u32 s36, s36, 1
    s_cbranch_scc1 L_exit
    s_waitcnt vmcnt(0)
    v_readfirstlane_b32 s90, v2
    s_nop 0
    s_cmp_eq_u32 s90, 0
    s_cbranch_scc1 L_gw_15
    s_cmp_lg_u32 s90, 1
    s_cbranch_scc1 L_slow
    buffer_store_dwordx4 v[164:167], v17, s[4:7], s38 offen
    s_mov_b32 s37, -1
    v_add_u32 v35, -2, v34
    s_add_u32 s45, s38, 65536
    s_add_u32 s46, s45, 4096
    s_add_u32 s47, s45, 8192
    v_mov_b32 v24, v20
    v_mov_b32 v25, v21
    buffer_load_dword v36, v33, s[4:7], s38 offen sc1
    s_waitcnt vmcnt(0)
    v_cmp_lt_i32 vcc, v36, v35
    s_cbranch_vccz L_fok_17
L_fw_16:
    buffer_load_dword v36, v33, s[4:7], s38 offen sc1
    s_sub_u32 s36, s36, 1
    s_cbranch_scc1 L_exit
    s_waitcnt vmcnt(0)
    v_cmp_lt_i32 vcc, v36, v35
    s_cbranch_vccnz L_fw_16
L_fok_17:
    buffer_load_dwordx4 a[96:99], v40, s[4:7], s45 offen offset:0 sc1
    buffer_load_dwordx4 a[100:103], v40, s[4:7], s45 offen offset:1024 sc1
    buffer_load_dwordx4 a[104:107], v40, s[4:7], s45 offen offset:2048 sc1
    buffer_load_dwordx4 a[108:111], v40, s[4:7], s45 offen offset:3072 sc1
    buffer_load_dwordx4 a[112:115], v40, s[4:7], s46 offen offset:0 sc1
    buffer_load_dwordx4 a[116:119], v40, s[4:7], s46 offen offset:1024 sc1
    buffer_load_dwordx4 a[120:123], v40, s[4:7], s46 offen offset:2048 sc1
    buffer_load_dwordx4 a[124:127], v40, s[4:7], s46 offen offset:3072 sc1
    buffer_load_dwordx4 a[128:131], v40, s[4:7], s47 offen offset:0 sc1
    buffer_load_dwordx4 a[132:135], v40, s[4:7], s47 offen offset:1024 sc1
    buffer_load_dwordx4 a[136:139], v40, s[4:7], s47 offen offset:2048 sc1
    buffer_load_dwordx4 a[140:143], v40, s[4:7], s47 offen offset:3072 sc1
    s_waitcnt vmcnt(0)
    v_mfma_f32_16x16x32_bf16 v[148:151], a[96:99], a[0:3], 0
    v_mfma_f32_16x16x32_bf16 v[152:155], a[120:123], a[0:3], 0
    v_mfma_f32_16x16x32_bf16 v[156:159], a[96:99], a[24:27], 0
    v_mfma_f32_16x16x32_bf16 v[160:163], a[120:123], a[24:27], 0
    v_mfma_f32_16x16x32_bf16 v[180:183], a[96:99], a[48:51], 0
    v_mfma_f32_16x16x32_bf16 v[184:187], a[120:123], a[48:51], 0
    v_mfma_f32_16x16x32_bf16 v[188:191], a[96:99], a[72:75], 0
    v_mfma_f32_16x16x32_bf16 v[192:195], a[120:123], a[72:75], 0
    v_mfma_f32_16x16x32_bf16 v[148:151], a[100:103], a[4:7], v[148:151]
    v_mfma_f32_16x16x32_bf16 v[152:155], a[124:127], a[4:7], v[152:155]
    v_mfma_f32_16x16x32_bf16 v[156:159], a[100:103], a[28:31], v[156:159]
    v_mfma_f32_16x16x32_bf16 v[160:163], a[124:127], a[28:31], v[160:163]
    v_mfma_f32_16x16x32_bf16 v[180:183], a[100:103], a[52:55], v[180:183]
    v_mfma_f32_16x16x32_bf16 v[184:187], a[124:127], a[52:55], v[184:187]
    v_mfma_f32_16x16x32_bf16 v[188:191], a[100:103], a[76:79], v[188:191]
    v_mfma_f32_16x16x32_bf16 v[192:195], a[124:127], a[76:79], v[192:195]
    v_mfma_f32_16x16x32_bf16 v[148:151], a[104:107], a[8:11], v[148:151]
    v_mfma_f32_16x16x32_bf16 v[152:155], a[128:131], a[8:11], v[152:155]
    v_mfma_f32_16x16x32_bf16 v[156:159], a[104:107], a[32:35], v[156:159]
    v_mfma_f32_16x16x32_bf16 v[160:163], a[128:131], a[32:35], v[160:163]
    v_mfma_f32_16x16x32_bf16 v[180:183], a[104:107], a[56:59], v[180:183]
    v_mfma_f32_16x16x32_bf16 v[184:187], a[128:131], a[56:59], v[184:187]
    v_mfma_f32_16x16x32_bf16 v[188:191], a[104:107], a[80:83], v[188:191]
    v_mfma_f32_16x16x32_bf16 v[192:195], a[128:131], a[80:83], v[192:195]
    v_mfma_f32_16x16x32_bf16 v[148:151], a[108:111], a[12:15], v[148:151]
    v_mfma_f32_16x16x32_bf16 v[152:155], a[132:135], a[12:15], v[152:155]
    v_mfma_f32_16x16x32_bf16 v[156:159], a[108:111], a[36:39], v[156:159]
    v_mfma_f32_16x16x32_bf16 v[160:163], a[132:135], a[36:39], v[160:163]
    v_mfma_f32_16x16x32_bf16 v[180:183], a[108:111], a[60:63], v[180:183]
    v_mfma_f32_16x16x32_bf16 v[184:187], a[132:135], a[60:63], v[184:187]
    v_mfma_f32_16x16x32_bf16 v[188:191], a[108:111], a[84:87], v[188:191]
    v_mfma_f32_16x16x32_bf16 v[192:195], a[132:135], a[84:87], v[192:195]
    v_mfma_f32_16x16x32_bf16 v[148:151], a[112:115], a[16:19], v[148:151]
    v_mfma_f32_16x16x32_bf16 v[152:155], a[136:139], a[16:19], v[152:155]
    v_mfma_f32_16x16x32_bf16 v[156:159], a[112:115], a[40:43], v[156:159]
    v_mfma_f32_16x16x32_bf16 v[160:163], a[136:139], a[40:43], v[160:163]
    v_mfma_f32_16x16x32_bf16 v[180:183], a[112:115], a[64:67], v[180:183]
    v_mfma_f32_16x16x32_bf16 v[184:187], a[136:139], a[64:67], v[184:187]
    v_mfma_f32_16x16x32_bf16 v[188:191], a[112:115], a[88:91], v[188:191]
    v_mfma_f32_16x16x32_bf16 v[192:195], a[136:139], a[88:91], v[192:195]
    v_mfma_f32_16x16x32_bf16 v[148:151], a[116:119], a[20:23], v[148:151]
    v_mfma_f32_16x16x32_bf16 v[152:155], a[140:143], a[20:23], v[152:155]
    v_mfma_f32_16x16x32_bf16 v[156:159], a[116:119], a[44:47], v[156:159]
    v_mfma_f32_16x16x32_bf16 v[160:163], a[140:143], a[44:47], v[160:163]
    v_mfma_f32_16x16x32_bf16 v[180:183], a[116:119], a[68:71], v[180:183]
    v_mfma_f32_16x16x32_bf16 v[184:187], a[140:143], a[68:71], v[184:187]
    v_mfma_f32_16x16x32_bf16 v[188:191], a[116:119], a[92:95], v[188:191]
    v_mfma_f32_16x16x32_bf16 v[192:195], a[140:143], a[92:95], v[192:195]
    v_cvt_pk_bf16_f32 v64, v180, v181
    v_cvt_pk_bf16_f32 v65, v182, v183
    ds_write_b64 v24, v[64:65] offset:12288
    v_cvt_pk_bf16_f32 v68, v184, v185
    v_cvt_pk_bf16_f32 v69, v186, v187
    ds_write_b64 v25, v[68:69] offset:12288
    v_cvt_pk_bf16_f32 v72, v188, v189
    v_cvt_pk_bf16_f32 v73, v190, v191
    ds_write_b64 v24, v[72:73] offset:18432
    v_cvt_pk_bf16_f32 v76, v192, v193
    v_cvt_pk_bf16_f32 v77, v194, v195
    ds_write_b64 v25, v[76:77] offset:18432
    v_cvt_pk_bf16_f32 v48, v148, v149
    v_cvt_pk_bf16_f32 v49, v150, v151
    ds_write_b64 v24, v[48:49] offset:0
    v_cvt_pk_bf16_f32 v52, v152, v153
    v_cvt_pk_bf16_f32 v53, v154, v155
    ds_write_b64 v25, v[52:53] offset:0
    v_cvt_pk_bf16_f32 v56, v156, v157
    v_cvt_pk_bf16_f32 v57, v158, v159
    ds_write_b64 v24, v[56:57] offset:6144
    v_cvt_pk_bf16_f32 v60, v160, v161
    v_cvt_pk_bf16_f32 v61, v162, v163
    ds_write_b64 v25, v[60:61] offset:6144
    s_add_u32 s56, s37, 2
    s_and_b32 s55, s56, 3
    s_mul_i32 s55, s55, 114688
    s_add_u32 s55, s55, 65536
    s_add_u32 s45, s38, s55
    s_add_u32 s46, s45, 4096
    s_add_u32 s47, s45, 8192
    s_add_u32 s56, s37, -1
    s_and_b32 s55, s56, 3
    s_mul_i32 s55, s55, 114688
    s_add_u32 s55, s55, 53248
    s_add_u32 s48, s38, s55
    s_and_b32 s55, s56, 1
    s_add_u32 m0, s55, 12
    s_add_u32 s56, s56, 1
    v_add_u32 v35, s37, v34
    v_writelane_b32 v35, s56, m0
    s_mul_i32 s55, s55, 12288
    s_add_u32 m0, s54, s55
    buffer_load_dword v36, v33, s[4:7], s38 offen sc1
    s_waitcnt vmcnt(0)
    v_cmp_lt_i32 vcc, v36, v35
    s_cbranch_vccz L_fok_19
L_fw_18:
    buffer_load_dword v36, v33, s[4:7], s38 offen sc1
    s_sub_u32 s36, s36, 1
    s_cbranch_scc1 L_exit
    s_waitcnt vmcnt(0)
    v_cmp_lt_i32 vcc, v36, v35
    s_cbranch_vccnz L_fw_18
L_fok_19:
    buffer_load_dwordx4 a[96:99], v40, s[4:7], s45 offen offset:0 sc1
    buffer_load_dwordx4 a[100:103], v40, s[4:7], s45 offen offset:1024 sc1
    buffer_load_dwordx4 a[104:107], v40, s[4:7], s45 offen offset:2048 sc1
    buffer_load_dwordx4 a[108:111], v40, s[4:7], s45 offen offset:3072 sc1
    buffer_load_dwordx4 a[112:115], v40, s[4:7], s46 offen offset:0 sc1
    buffer_load_dwordx4 a[116:119], v40, s[4:7], s46 offen offset:1024 sc1
    buffer_load_dwordx4 a[120:123], v40, s[4:7], s46 offen offset:2048 sc1
    buffer_load_dwordx4 a[124:127], v40, s[4:7], s46 offen offset:3072 sc1
    buffer_load_dwordx4 a[128:131], v40, s[4:7], s47 offen offset:0 sc1
    buffer_load_dwordx4 a[132:135], v40, s[4:7], s47 offen offset:1024 sc1
    buffer_load_dwordx4 a[136:139], v40, s[4:7], s47 offen offset:2048 sc1
    buffer_load_dwordx4 a[140:143], v40, s[4:7], s47 offen offset:3072 sc1
    s_add_u32 s56, s37, 1
    v_mov_b32 v47, v24
    s_and_b32 s55, s56, 3
    s_mul_i32 s41, s55, 327680
    s_mul_i32 s56, s55, 114688
    s_add_u32 s43, s38, s56
    s_xor_b32 s55, s55, 2
    s_mul_i32 s42, s55, 327680
    s_add_u32 s56, s37, 2
    v_mov_b32 v107, s56
    s_and_b32 s55, s56, 3
    s_mul_i32 s44, s55, 24576
    s_mov_b32 s50, s52
    s_add_u32 s56, s37, -2
    s_and_b32 s55, s56, 3
    s_mul_i32 s55, s55, 327680
    s_add_u32 s49, s55, 4194304
    s_add_u32 s56, s37, -4
    s_and_b32 s55, s56, 3
    s_mul_i32 s55, s55, 327680
    s_add_u32 s51, s55, 4194304
    s_mul_i32 s52, s56, 81920
    s_add_u32 s56, s37, -1
    s_and_b32 s55, s56, 3
    s_mul_i32 s55, s55, 24576
    v_add_u32 v26, s55, v22
    v_add_u32 v27, s55, v23
    s_and_b32 s55, s56, 1
    s_mul_i32 s55, s55, 12288
    v_add_u32 v29, s55, v28
    s_add_u32 s37, s37, 1
    v_add_u32 v24, s44, v20
    v_add_u32 v25, s44, v21
    v_pk_mul_f32 v[148:149], v[210:211], v[210:211]
    v_pk_mul_f32 v[150:151], v[210:211], v[210:211]
    v_pk_mul_f32 v[152:153], v[210:211], v[210:211]
    v_pk_mul_f32 v[154:155], v[210:211], v[210:211]
    v_pk_mul_f32 v[156:157], v[210:211], v[210:211]
    v_pk_mul_f32 v[158:159], v[210:211], v[210:211]
    v_pk_mul_f32 v[160:161], v[210:211], v[210:211]
    v_pk_mul_f32 v[162:163], v[210:211], v[210:211]
    v_mov_b32 v120, 0
    v_mov_b32 v121, 0
    v_mov_b32 v122, 0
    v_mov_b32 v123, 0
    v_mov_b32 v124, 0
    v_mov_b32 v125, 0
    v_mov_b32 v126, 0
    v_mov_b32 v127, 0
    v_mov_b32 v128, 0
    v_mov_b32 v129, 0
    v_mov_b32 v130, 0
    v_mov_b32 v131, 0
    v_mov_b32 v132, 0
    v_mov_b32 v133, 0
    v_mov_b32 v134, 0
    v_mov_b32 v135, 0
    v_mov_b32 v116, 0
    v_mov_b32 v117, 0
    v_mov_b32 v118, 0
    v_mov_b32 v119, 0
    v_mov_b32 v3, 200
L_p0_20:
    buffer_load_dword v4, v3, s[8:11], 0 offen sc1
    s_sub_u32 s36, s36, 1
    s_cbranch_scc1 L_exit
    s_waitcnt vmcnt(0)
    v_readfirstlane_b32 s90, v4
    s_nop 0
    s_cmp_eq_u32 s90, 0
    s_cbranch_scc1 L_p0_20
    s_and_b32 s90, s90, 2
    s_lshl_b32 s90, s90, 12
    s_xor_b32 s90, s90, 0
    v_xor_b32 v30, s90, v30
    v_xor_b32 v31, s90, v31
    s_mov_b32 s90, 5832704
    buffer_store_dwordx4 v[168:171], v30, s[4:7], s90 offen sc1
    s_mov_b32 s90, 6160384
    buffer_store_dwordx4 v[168:171], v30, s[4:7], s90 offen sc1
L_wo_loop_f:
    buffer_load_dword v41, v245, s[4:7], s38 offen sc1
    buffer_load_dword v41, v245, s[4:7], s38 offen sc1
    buffer_load_dword v41, v245, s[4:7], s38 offen sc1
L_bf_21:
    buffer_load_dword v41, v245, s[4:7], s38 offen sc1
    s_sub_u32 s36, s36, 1
    s_cbranch_scc1 L_exit
    s_waitcnt vmcnt(3)
    v_cmp_ge_u32 vcc, s37, v41
    s_cbranch_vccnz L_bf_21
    buffer_load_dwordx4 v[136:139], v44, s[4:7], s43 offen offset:0 sc1
    buffer_load_dwordx4 v[140:143], v44, s[4:7], s43 offen offset:1024 sc1
    buffer_load_dwordx4 v[144:147], v44, s[4:7], s43 offen offset:2048 sc1
    s_waitcnt vmcnt(2)
    v_smfmac_f32_16x16x64_bf16 v[148:151], v[136:139], a[0:7], v10
    v_smfmac_f32_16x16x64_bf16 v[152:155], v[136:139], a[24:31], v10
    v_smfmac_f32_16x16x64_bf16 v[156:159], v[136:139], a[48:55], v10
    v_smfmac_f32_16x16x64_bf16 v[160:163], v[136:139], a[72:79], v10
    s_waitcnt vmcnt(1)
    v_smfmac_f32_16x16x64_bf16 v[148:151], v[140:143], a[8:15], v10
    v_smfmac_f32_16x16x64_bf16 v[152:155], v[140:143], a[32:39], v10
    v_smfmac_f32_16x16x64_bf16 v[156:159], v[140:143], a[56:63], v10
    v_smfmac_f32_16x16x64_bf16 v[160:163], v[140:143], a[80:87], v10
    s_waitcnt vmcnt(0)
    v_smfmac_f32_16x16x64_bf16 v[148:151], v[144:147], a[16:23], v10
    v_smfmac_f32_16x16x64_bf16 v[152:155], v[144:147], a[40:47], v10
    v_smfmac_f32_16x16x64_bf16 v[156:159], v[144:147], a[64:71], v10
    v_smfmac_f32_16x16x64_bf16 v[160:163], v[144:147], a[88:95], v10
    v_pk_add_f32 v[148:149], v[148:149], v[150:151]
    v_cmp_u_f32 vcc, v148, v149
    buffer_load_dwordx4 v[92:95], v38, s[4:7], s43 offen offset:0 sc1
    buffer_load_dword v104, v39, s[4:7], s43 offen offset:0 sc1
    v_cvt_pk_bf16_f32 v50, v148, v149
    buffer_load_dwordx4 v[96:99], v38, s[4:7], s43 offen offset:1280 sc1
    buffer_load_dword v105, v39, s[4:7], s43 offen offset:1280 sc1
    v_cvt_pk_bf16_f32 v54, v148, v149
    buffer_load_dwordx4 v[100:103], v38, s[4:7], s43 offen offset:2560 sc1
    buffer_load_dword v106, v39, s[4:7], s43 offen offset:2560 sc1
    v_pk_add_f32 v[152:153], v[152:153], v[154:155]
    v_cvt_pk_bf16_f32 v58, v152, v153
    v_cvt_pk_bf16_f32 v62, v152, v153
    v_pk_add_f32 v[156:157], v[156:157], v[158:159]
    v_cvt_pk_bf16_f32 v66, v156, v157
    v_cvt_pk_bf16_f32 v70, v156, v157
    v_pk_add_f32 v[160:161], v[160:161], v[162:163]
    v_cvt_pk_bf16_f32 v74, v160, v161
    v_cvt_pk_bf16_f32 v78, v160, v161
    s_cbranch_vccnz L_vm_22
L_u_23:
    ds_write_b32 v47, v50 offset:8
    ds_write_b32 v47, v58 offset:6152
    ds_write_b32 v47, v66 offset:12296
    ds_write_b32 v47, v74 offset:18440
    s_cmp_eq_u32 s37, 63
    s_cbranch_scc1 L_wo_tail_f
L_sc_24:
    s_waitcnt vmcnt(2)
    v_pk_add_f32 v[236:237], v[92:93], v[96:97]
    v_pk_add_f32 v[238:239], v[94:95], v[98:99]
    v_add_f32 v43, v104, v105
    s_waitcnt vmcnt(0)
    v_pk_add_f32 v[236:237], v[236:237], v[100:101]
    v_pk_add_f32 v[238:239], v[238:239], v[102:103]
    v_add_f32 v43, v43, v106
    v_max3_f32 v41, v236, v237, v238
    v_max3_f32 v41, v41, v239, v43
    v_pk_add_f32 v[242:243], v[236:237], v[238:239]
    v_add_f32 v242, v242, v43
    v_max_f32_dpp v42, v41, v41 quad_perm:[2,3,0,1] row_mask:0xf bank_mask:0xf
    v_max_f32_dpp v41, v41, v41 quad_perm:[2,3,0,1] row_mask:0xf bank_mask:0xf
    v_cmp_u_f32 vcc, v242, v243
    s_nop 0
    v_permlane16_swap_b32 v41, v42
    v_max_f32 v41, v41, v42
    v_mov_b32 v42, v41
    s_cbranch_vccnz L_sp_25
L_sg_26:
    s_nop 0
    v_permlane32_swap_b32 v41, v42
    v_max_f32 v41, v41, v42
    v_mul_f32 v242, 0xbdd53b95, v41
    v_pk_fma_f32 v[236:237], v[236:237], v[240:241], v[242:243] op_sel_hi:[1,1,0]
    v_pk_fma_f32 v[238:239], v[238:239], v[240:241], v[242:243] op_sel_hi:[1,1,0]
    v_fma_f32 v43, v43, v240, v242
    v_exp_f32 v236, v236
    v_exp_f32 v237, v237
    v_exp_f32 v238, v238
    v_exp_f32 v239, v239
    v_exp_f32 v43, v43
    v_cvt_pk_bf16_f32 v80, v236, v237
    v_cvt_pk_bf16_f32 v82, v238, v239
    v_cvt_pk_bf16_f32 v81, v43, 0
    v_cvt_pk_bf16_f32 v83, v43, 0
    s_nop 1
    v_smfmac_f32_16x16x64_bf16 v[116:119], v[80:83], v[84:91], v11
    v_smfmac_f32_16x16x64_bf16 v[120:123], v[80:83], v[48:55], v11
    v_smfmac_f32_16x16x64_bf16 v[124:127], v[80:83], v[56:63], v11
    v_smfmac_f32_16x16x64_bf16 v[128:131], v[80:83], v[64:71], v11
    v_add_f32 v116, v116, v118
    v_add_f32 v117, v117, v119
    v_smfmac_f32_16x16x64_bf16 v[132:135], v[80:83], v[72:79], v11
    v_rcp_f32 v116, v116
    v_rcp_f32 v117, v117
    v_pk_add_f32 v[120:121], v[120:121], v[122:123]
    v_pk_mul_f32 v[120:121], v[120:121], v[116:117]
    v_cvt_pk_bf16_f32 v236, v120, v121
    v_pk_add_f32 v[124:125], v[124:125], v[126:127]
    v_pk_mul_f32 v[124:125], v[124:125], v[116:117]
    v_cvt_pk_bf16_f32 v237, v124, v125
    ds_write2st64_b32 v18, v236, v237 offset0:0 offset1:1
    v_pk_add_f32 v[128:129], v[128:129], v[130:131]
    v_pk_mul_f32 v[128:129], v[128:129], v[116:117]
    v_cvt_pk_bf16_f32 v238, v128, v129
    v_pk_add_f32 v[132:133], v[132:133], v[134:135]
    v_pk_mul_f32 v[132:133], v[132:133], v[116:117]
    v_cvt_pk_bf16_f32 v239, v132, v133
    ds_write2st64_b32 v18, v238, v239 offset0:2 offset1:3
    v_mov_b32 v120, 0
    v_mov_b32 v121, 0
    v_mov_b32 v122, 0
    v_mov_b32 v123, 0
    v_mov_b32 v124, 0
    v_mov_b32 v125, 0
    v_mov_b32 v126, 0
    v_mov_b32 v127, 0
    v_mov_b32 v128, 0
    v_mov_b32 v129, 0
    s_waitcnt lgkmcnt(0)
    s_barrier
    ds_read_b64_tr_b16 v[80:81], v19
    ds_read_b64_tr_b16 v[82:83], v19 offset:128
    v_mov_b32 v130, 0
    v_mov_b32 v131, 0
    v_mov_b32 v132, 0
    v_mov_b32 v133, 0
    v_mov_b32 v134, 0
    v_mov_b32 v135, 0
    v_mov_b32 v116, 0
    v_mov_b32 v117, 0
    v_mov_b32 v118, 0
    v_mov_b32 v119, 0
    s_waitcnt lgkmcnt(0)
    v_mfma_f32_16x16x32_bf16 v[172:175], v[110:113], v[80:83], 0
    v_mfma_f32_16x16x32_bf16 v[176:179], v[108:111], v[80:83], 0
    buffer_store_dword v107, v244, s[4:7], s38 offen
    buffer_load_dword v36, v33, s[4:7], s38 offen sc1
    s_nop 2
    v_cvt_pk_bf16_f32 v236, v172, v173
    v_cvt_pk_bf16_f32 v237, v174, v175
    s_nop 0
    v_cvt_pk_bf16_f32 v238, v176, v177
    v_cvt_pk_bf16_f32 v239, v178, v179
    buffer_store_dwordx4 v[236:239], v14, s[4:7], s41 offen sc1
    ds_read_b128 v[204:207], v26 offset:0
    ds_read_b128 v[180:183], v29 offset:0
    ds_read_b128 v[184:187], v29 offset:1024
    ds_read_b64 v[208:209], v27 offset:0
    ds_read_b128 v[188:191], v29 offset:2048
    ds_read_b128 v[212:215], v26 offset:1536
    ds_read_b128 v[192:195], v29 offset:3072
    ds_read_b128 v[196:199], v29 offset:4096
    ds_read_b64 v[216:217], v27 offset:1536
    ds_read_b128 v[200:203], v29 offset:5120
    buffer_store_dwordx4 v[220:223], v30, s[4:7], s49 offen sc1
    buffer_load_dwordx4 v[228:231], v31, s[4:7], s51 offen sc1
    s_add_u32 s55, s42, s60
    buffer_store_dword v168, v46, s[4:7], s55 offen sc1
    s_add_u32 s55, s42, s61
    buffer_store_dword v168, v46, s[4:7], s55 offen sc1
    s_add_u32 s55, s42, s62
    buffer_store_dword v168, v46, s[4:7], s55 offen sc1
    s_add_u32 s55, s42, s63
    buffer_store_dword v168, v46, s[4:7], s55 offen sc1
    s_waitcnt lgkmcnt(5)
    v_mfma_f32_16x16x32_bf16 v[220:223], v[180:183], v[204:207], 0
    v_mfma_f32_16x16x32_bf16 v[224:227], v[184:187], v[204:207], 0
    v_mfma_f32_16x16x32_bf16 v[224:227], v[188:191], v[208:211], v[224:227]
    ds_read_b128 v[204:207], v26 offset:3072
    ds_read_b128 v[180:183], v29 offset:6144
    ds_read_b128 v[184:187], v29 offset:7168
    ds_read_b64 v[208:209], v27 offset:3072
    ds_read_b128 v[188:191], v29 offset:8192
    s_add_u32 s56, s37, 2
    s_and_b32 s55, s56, 3
    s_mul_i32 s55, s55, 114688
    s_add_u32 s55, s55, 65536
    s_add_u32 s45, s38, s55
    s_add_u32 s46, s45, 4096
    s_add_u32 s47, s45, 8192
    s_add_u32 s56, s37, -1
    s_and_b32 s55, s56, 3
    s_mul_i32 s55, s55, 114688
    s_add_u32 s55, s55, 53248
    s_add_u32 s48, s38, s55
    s_and_b32 s55, s56, 1
    s_add_u32 m0, s55, 12
    s_add_u32 s56, s56, 1
    v_add_u32 v35, s37, v34
    v_writelane_b32 v35, s56, m0
    s_mul_i32 s55, s55, 12288
    s_add_u32 m0, s54, s55
    s_waitcnt lgkmcnt(5)
    v_mfma_f32_16x16x32_bf16 v[220:223], v[192:195], v[212:215], v[220:223]
    v_mfma_f32_16x16x32_bf16 v[224:227], v[196:199], v[212:215], v[224:227]
    v_mfma_f32_16x16x32_bf16 v[224:227], v[200:203], v[216:219], v[224:227]
    ds_read_b128 v[212:215], v26 offset:4608
    ds_read_b128 v[192:195], v29 offset:9216
    ds_read_b128 v[196:199], v29 offset:10240
    ds_read_b64 v[216:217], v27 offset:4608
    ds_read_b128 v[200:203], v29 offset:11264
    s_waitcnt lgkmcnt(5)
    v_mfma_f32_16x16x32_bf16 v[220:223], v[180:183], v[204:207], v[220:223]
    v_mfma_f32_16x16x32_bf16 v[224:227], v[184:187], v[204:207], v[224:227]
    v_mfma_f32_16x16x32_bf16 v[224:227], v[188:191], v[208:211], v[224:227]
    s_waitcnt lgkmcnt(0)
    v_mfma_f32_16x16x32_bf16 v[220:223], v[192:195], v[212:215], v[220:223]
    v_mfma_f32_16x16x32_bf16 v[224:227], v[196:199], v[212:215], v[224:227]
    v_mfma_f32_16x16x32_bf16 v[224:227], v[200:203], v[216:219], v[224:227]
    s_waitcnt vmcnt(7)
    v_cmp_lt_i32 vcc, v36, v35
    s_cbranch_vccz L_fok_28
L_fw_27:
    buffer_load_dword v36, v33, s[4:7], s38 offen sc1
    s_sub_u32 s36, s36, 1
    s_cbranch_scc1 L_exit
    s_waitcnt vmcnt(0)
    v_cmp_lt_i32 vcc, v36, v35
    s_cbranch_vccnz L_fw_27
L_fok_28:
    buffer_load_dwordx4 v37, s[4:7], s48 offen offset:0 sc1 lds
    buffer_load_dwordx4 v37, s[4:7], s48 offen offset:1024 sc1 lds
    buffer_load_dwordx4 v37, s[4:7], s48 offen offset:2048 sc1 lds
    v_cvt_pk_bf16_f32 v220, v220, v221
    v_cvt_pk_bf16_f32 v221, v222, v223
    v_cvt_pk_bf16_f32 v222, v224, v225
    v_cvt_pk_bf16_f32 v223, v226, v227
    v_mfma_f32_16x16x32_bf16 v[148:151], a[96:99], a[0:3], 0
    s_add_u32 s56, s37, 1
    v_mov_b32 v47, v24
    v_mfma_f32_16x16x32_bf16 v[152:155], a[120:123], a[0:3], 0
    s_and_b32 s55, s56, 3
    s_mul_i32 s41, s55, 327680
    v_mfma_f32_16x16x32_bf16 v[156:159], a[96:99], a[24:27], 0
    s_mul_i32 s56, s55, 114688
    s_add_u32 s43, s38, s56
    v_mfma_f32_16x16x32_bf16 v[160:163], a[120:123], a[24:27], 0
    s_xor_b32 s55, s55, 2
    s_mul_i32 s42, s55, 327680
    v_mfma_f32_16x16x32_bf16 v[180:183], a[96:99], a[48:51], 0
    s_add_u32 s56, s37, 2
    v_mov_b32 v107, s56
    v_mfma_f32_16x16x32_bf16 v[184:187], a[120:123], a[48:51], 0
    s_and_b32 s55, s56, 3
    s_mul_i32 s44, s55, 24576
    v_mfma_f32_16x16x32_bf16 v[188:191], a[96:99], a[72:75], 0
    s_mov_b32 s50, s52
    s_add_u32 s56, s37, -2
    v_mfma_f32_16x16x32_bf16 v[192:195], a[120:123], a[72:75], 0
    buffer_load_dwordx4 a[96:99], v40, s[4:7], s45 offen offset:0 sc1
    v_mfma_f32_16x16x32_bf16 v[148:151], a[100:103], a[4:7], v[148:151]
    s_and_b32 s55, s56, 3
    s_mul_i32 s55, s55, 327680
    v_mfma_f32_16x16x32_bf16 v[152:155], a[124:127], a[4:7], v[152:155]
    buffer_load_dwordx4 a[120:123], v40, s[4:7], s46 offen offset:2048 sc1
    v_mfma_f32_16x16x32_bf16 v[156:159], a[100:103], a[28:31], v[156:159]
    s_add_u32 s49, s55, 4194304
    s_add_u32 s56, s37, -4
    v_mfma_f32_16x16x32_bf16 v[160:163], a[124:127], a[28:31], v[160:163]
    s_and_b32 s55, s56, 3
    s_mul_i32 s55, s55, 327680
    v_mfma_f32_16x16x32_bf16 v[180:183], a[100:103], a[52:55], v[180:183]
    s_add_u32 s51, s55, 4194304
    s_mul_i32 s52, s56, 81920
    v_mfma_f32_16x16x32_bf16 v[184:187], a[124:127], a[52:55], v[184:187]
    s_add_u32 s56, s37, -1
    s_and_b32 s55, s56, 3
    v_mfma_f32_16x16x32_bf16 v[188:191], a[100:103], a[76:79], v[188:191]
    s_mul_i32 s55, s55, 24576
    v_add_u32 v26, s55, v22
    v_mfma_f32_16x16x32_bf16 v[192:195], a[124:127], a[76:79], v[192:195]
    buffer_load_dwordx4 a[100:103], v40, s[4:7], s45 offen offset:1024 sc1
    v_mfma_f32_16x16x32_bf16 v[148:151], a[104:107], a[8:11], v[148:151]
    v_add_u32 v27, s55, v23
    s_and_b32 s55, s56, 1
    v_mfma_f32_16x16x32_bf16 v[152:155], a[128:131], a[8:11], v[152:155]
    buffer_load_dwordx4 a[124:127], v40, s[4:7], s46 offen offset:3072 sc1
    v_mfma_f32_16x16x32_bf16 v[156:159], a[104:107], a[32:35], v[156:159]
    s_mul_i32 s55, s55, 12288
    v_add_u32 v29, s55, v28
    v_mfma_f32_16x16x32_bf16 v[160:163], a[128:131], a[32:35], v[160:163]
    v_mfma_f32_16x16x32_bf16 v[180:183], a[104:107], a[56:59], v[180:183]
    v_mfma_f32_16x16x32_bf16 v[184:187], a[128:131], a[56:59], v[184:187]
    v_mfma_f32_16x16x32_bf16 v[188:191], a[104:107], a[80:83], v[188:191]
    v_mfma_f32_16x16x32_bf16 v[192:195], a[128:131], a[80:83], v[192:195]
    buffer_load_dwordx4 a[104:107], v40, s[4:7], s45 offen offset:2048 sc1
    v_mfma_f32_16x16x32_bf16 v[148:151], a[108:111], a[12:15], v[148:151]
    v_mfma_f32_16x16x32_bf16 v[152:155], a[132:135], a[12:15], v[152:155]
    buffer_load_dwordx4 a[128:131], v40, s[4:7], s47 offen offset:0 sc1
    v_mfma_f32_16x16x32_bf16 v[156:159], a[108:111], a[36:39], v[156:159]
    v_mfma_f32_16x16x32_bf16 v[160:163], a[132:135], a[36:39], v[160:163]
    v_mfma_f32_16x16x32_bf16 v[180:183], a[108:111], a[60:63], v[180:183]
    v_mfma_f32_16x16x32_bf16 v[184:187], a[132:135], a[60:63], v[184:187]
    v_mfma_f32_16x16x32_bf16 v[188:191], a[108:111], a[84:87], v[188:191]
    v_mfma_f32_16x16x32_bf16 v[192:195], a[132:135], a[84:87], v[192:195]
    buffer_load_dwordx4 a[108:111], v40, s[4:7], s45 offen offset:3072 sc1
    v_mfma_f32_16x16x32_bf16 v[148:151], a[112:115], a[16:19], v[148:151]
    v_mfma_f32_16x16x32_bf16 v[152:155], a[136:139], a[16:19], v[152:155]
    buffer_load_dwordx4 a[132:135], v40, s[4:7], s47 offen offset:1024 sc1
    v_mfma_f32_16x16x32_bf16 v[156:159], a[112:115], a[40:43], v[156:159]
    v_mfma_f32_16x16x32_bf16 v[160:163], a[136:139], a[40:43], v[160:163]
    v_mfma_f32_16x16x32_bf16 v[180:183], a[112:115], a[64:67], v[180:183]
    v_mfma_f32_16x16x32_bf16 v[184:187], a[136:139], a[64:67], v[184:187]
    v_mfma_f32_16x16x32_bf16 v[188:191], a[112:115], a[88:91], v[188:191]
    v_mfma_f32_16x16x32_bf16 v[192:195], a[136:139], a[88:91], v[192:195]
    buffer_load_dwordx4 a[112:115], v40, s[4:7], s46 offen offset:0 sc1
    v_mfma_f32_16x16x32_bf16 v[148:151], a[116:119], a[20:23], v[148:151]
    v_mfma_f32_16x16x32_bf16 v[152:155], a[140:143], a[20:23], v[152:155]
    buffer_load_dwordx4 a[136:139], v40, s[4:7], s47 offen offset:2048 sc1
    v_mfma_f32_16x16x32_bf16 v[156:159], a[116:119], a[44:47], v[156:159]
    v_mfma_f32_16x16x32_bf16 v[160:163], a[140:143], a[44:47], v[160:163]
    v_mfma_f32_16x16x32_bf16 v[180:183], a[116:119], a[68:71], v[180:183]
    v_mfma_f32_16x16x32_bf16 v[184:187], a[140:143], a[68:71], v[184:187]
    v_mfma_f32_16x16x32_bf16 v[188:191], a[116:119], a[92:95], v[188:191]
    v_mfma_f32_16x16x32_bf16 v[192:195], a[140:143], a[92:95], v[192:195]
    buffer_load_dwordx4 a[116:119], v40, s[4:7], s46 offen offset:1024 sc1
    buffer_load_dwordx4 a[140:143], v40, s[4:7], s47 offen offset:3072 sc1
    s_cmp_lt_u32 s37, 5
    s_nop 0
    s_cbranch_scc1 L_g_29
    s_waitcnt vmcnt(19)
    v_mfma_f32_16x16x32_bf16 v[232:235], a[144:147], v[228:231], 0
    s_nop 7
    v_cndmask_b32 v234, v232, v233, s[58:59]
    v_cndmask_b32 v235, v233, v232, s[58:59]
    s_nop 1
    v_add_f32_dpp v235, v234, v235 row_ror:8 row_mask:0xf bank_mask:0xf
    v_cvt_pk_bf16_f32 v235, v235, v235
    buffer_store_short v235, v32, s[28:31], s50 offen
L_g_29:
    v_cvt_pk_bf16_f32 v64, v180, v181
    v_cvt_pk_bf16_f32 v65, v182, v183
    ds_write_b64 v24, v[64:65] offset:12288
    v_cvt_pk_bf16_f32 v68, v184, v185
    v_cvt_pk_bf16_f32 v69, v186, v187
    ds_write_b64 v25, v[68:69] offset:12288
    v_cvt_pk_bf16_f32 v72, v188, v189
    v_cvt_pk_bf16_f32 v73, v190, v191
    ds_write_b64 v24, v[72:73] offset:18432
    v_cvt_pk_bf16_f32 v76, v192, v193
    v_cvt_pk_bf16_f32 v77, v194, v195
    ds_write_b64 v25, v[76:77] offset:18432
    v_cvt_pk_bf16_f32 v48, v148, v149
    v_cvt_pk_bf16_f32 v49, v150, v151
    ds_write_b64 v24, v[48:49] offset:0
    v_cvt_pk_bf16_f32 v52, v152, v153
    v_cvt_pk_bf16_f32 v53, v154, v155
    ds_write_b64 v25, v[52:53] offset:0
    v_cvt_pk_bf16_f32 v56, v156, v157
    v_cvt_pk_bf16_f32 v57, v158, v159
    ds_write_b64 v24, v[56:57] offset:6144
    v_cvt_pk_bf16_f32 v60, v160, v161
    v_cvt_pk_bf16_f32 v61, v162, v163
    ds_write_b64 v25, v[60:61] offset:6144
    s_add_u32 s37, s37, 1
    v_add_u32 v24, s44, v20
    v_add_u32 v25, s44, v21
    v_pk_mul_f32 v[148:149], v[210:211], v[210:211]
    v_pk_mul_f32 v[150:151], v[210:211], v[210:211]
    v_pk_mul_f32 v[152:153], v[210:211], v[210:211]
    v_pk_mul_f32 v[154:155], v[210:211], v[210:211]
    v_pk_mul_f32 v[156:157], v[210:211], v[210:211]
    v_pk_mul_f32 v[158:159], v[210:211], v[210:211]
    v_pk_mul_f32 v[160:161], v[210:211], v[210:211]
    v_pk_mul_f32 v[162:163], v[210:211], v[210:211]
    s_branch L_wo_loop_f
L_wo_tail_f:
    buffer_store_dwordx4 v[220:223], v30, s[4:7], s49 offen sc1
    s_waitcnt vmcnt(0) lgkmcnt(0)
    s_barrier
    s_add_u32 s56, s37, -1
    s_and_b32 s55, s56, 3
    s_mul_i32 s55, s55, 114688
    s_add_u32 s55, s55, 53248
    s_add_u32 s48, s38, s55
    s_and_b32 s55, s56, 1
    s_add_u32 m0, s55, 12
    s_add_u32 s56, s56, 1
    v_mov_b32 v35, -16
    v_writelane_b32 v35, s56, m0
    s_mul_i32 s55, s55, 12288
    s_add_u32 m0, s54, s55
    buffer_load_dword v36, v33, s[4:7], s38 offen sc1
    s_add_u32 s56, s37, -2
    s_and_b32 s55, s56, 3
    s_mul_i32 s55, s55, 24576
    v_add_u32 v26, s55, v22
    v_add_u32 v27, s55, v23
    s_and_b32 s55, s56, 1
    s_mul_i32 s55, s55, 12288
    v_add_u32 v29, s55, v28
    s_mov_b32 s49, 5505024
    ds_read_b128 v[204:207], v26 offset:0
    ds_read_b128 v[180:183], v29 offset:0
    ds_read_b128 v[184:187], v29 offset:1024
    ds_read_b64 v[208:209], v27 offset:0
    ds_read_b128 v[188:191], v29 offset:2048
    ds_read_b128 v[212:215], v26 offset:1536
    ds_read_b128 v[192:195], v29 offset:3072
    ds_read_b128 v[196:199], v29 offset:4096
    ds_read_b64 v[216:217], v27 offset:1536
    ds_read_b128 v[200:203], v29 offset:5120
    s_waitcnt lgkmcnt(5)
    v_mfma_f32_16x16x32_bf16 v[220:223], v[180:183], v[204:207], 0
    v_mfma_f32_16x16x32_bf16 v[224:227], v[184:187], v[204:207], 0
    v_mfma_f32_16x16x32_bf16 v[224:227], v[188:191], v[208:211], v[224:227]
    ds_read_b128 v[204:207], v26 offset:3072
    ds_read_b128 v[180:183], v29 offset:6144
    ds_read_b128 v[184:187], v29 offset:7168
    ds_read_b64 v[208:209], v27 offset:3072
    ds_read_b128 v[188:191], v29 offset:8192
    s_waitcnt lgkmcnt(5)
    v_mfma_f32_16x16x32_bf16 v[220:223], v[192:195], v[212:215], v[220:223]
    v_mfma_f32_16x16x32_bf16 v[224:227], v[196:199], v[212:215], v[224:227]
    v_mfma_f32_16x16x32_bf16 v[224:227], v[200:203], v[216:219], v[224:227]
    ds_read_b128 v[212:215], v26 offset:4608
    ds_read_b128 v[192:195], v29 offset:9216
    ds_read_b128 v[196:199], v29 offset:10240
    ds_read_b64 v[216:217], v27 offset:4608
    ds_read_b128 v[200:203], v29 offset:11264
    s_waitcnt lgkmcnt(5)
    v_mfma_f32_16x16x32_bf16 v[220:223], v[180:183], v[204:207], v[220:223]
    v_mfma_f32_16x16x32_bf16 v[224:227], v[184:187], v[204:207], v[224:227]
    v_mfma_f32_16x16x32_bf16 v[224:227], v[188:191], v[208:211], v[224:227]
    s_waitcnt lgkmcnt(0)
    v_mfma_f32_16x16x32_bf16 v[220:223], v[192:195], v[212:215], v[220:223]
    v_mfma_f32_16x16x32_bf16 v[224:227], v[196:199], v[212:215], v[224:227]
    v_mfma_f32_16x16x32_bf16 v[224:227], v[200:203], v[216:219], v[224:227]
    s_nop 0
    v_cvt_pk_bf16_f32 v220, v220, v221
    v_cvt_pk_bf16_f32 v221, v222, v223
    s_nop 4
    v_cvt_pk_bf16_f32 v222, v224, v225
    v_cvt_pk_bf16_f32 v223, v226, v227
    buffer_store_dwordx4 v[220:223], v30, s[4:7], s49 offen sc1
    s_waitcnt vmcnt(1)
    v_cmp_lt_i32 vcc, v36, v35
    s_cbranch_vccz L_fok_31
L_fw_30:
    buffer_load_dword v36, v33, s[4:7], s38 offen sc1
    s_sub_u32 s36, s36, 1
    s_cbranch_scc1 L_exit
    s_waitcnt vmcnt(0)
    v_cmp_lt_i32 vcc, v36, v35
    s_cbranch_vccnz L_fw_30
L_fok_31:
    buffer_load_dwordx4 v37, s[4:7], s48 offen offset:0 sc1 lds
    buffer_load_dwordx4 v37, s[4:7], s48 offen offset:1024 sc1 lds
    buffer_load_dwordx4 v37, s[4:7], s48 offen offset:2048 sc1 lds
    s_waitcnt vmcnt(0) lgkmcnt(0)
    s_barrier
    s_add_u32 s56, s37, -1
    s_and_b32 s55, s56, 3
    s_mul_i32 s55, s55, 24576
    v_add_u32 v26, s55, v22
    v_add_u32 v27, s55, v23
    s_and_b32 s55, s56, 1
    s_mul_i32 s55, s55, 12288
    v_add_u32 v29, s55, v28
    s_mov_b32 s49, 5832704
    ds_read_b128 v[204:207], v26 offset:0
    ds_read_b128 v[180:183], v29 offset:0
    ds_read_b128 v[184:187], v29 offset:1024
    ds_read_b64 v[208:209], v27 offset:0
    ds_read_b128 v[188:191], v29 offset:2048
    ds_read_b128 v[212:215], v26 offset:1536
    ds_read_b128 v[192:195], v29 offset:3072
    ds_read_b128 v[196:199], v29 offset:4096
    ds_read_b64 v[216:217], v27 offset:1536
    ds_read_b128 v[200:203], v29 offset:5120
    s_waitcnt lgkmcnt(5)
    v_mfma_f32_16x16x32_bf16 v[220:223], v[180:183], v[204:207], 0
    v_mfma_f32_16x16x32_bf16 v[224:227], v[184:187], v[204:207], 0
    v_mfma_f32_16x16x32_bf16 v[224:227], v[188:191], v[208:211], v[224:227]
    ds_read_b128 v[204:207], v26 offset:3072
    ds_read_b128 v[180:183], v29 offset:6144
    ds_read_b128 v[184:187], v29 offset:7168
    ds_read_b64 v[208:209], v27 offset:3072
    ds_read_b128 v[188:191], v29 offset:8192
    s_waitcnt lgkmcnt(5)
    v_mfma_f32_16x16x32_bf16 v[220:223], v[192:195], v[212:215], v[220:223]
    v_mfma_f32_16x16x32_bf16 v[224:227], v[196:199], v[212:215], v[224:227]
    v_mfma_f32_16x16x32_bf16 v[224:227], v[200:203], v[216:219], v[224:227]
    ds_read_b128 v[212:215], v26 offset:4608
    ds_read_b128 v[192:195], v29 offset:9216
    ds_read_b128 v[196:199], v29 offset:10240
    ds_read_b64 v[216:217], v27 offset:4608
    ds_read_b128 v[200:203], v29 offset:11264
    s_waitcnt lgkmcnt(5)
    v_mfma_f32_16x16x32_bf16 v[220:223], v[180:183], v[204:207], v[220:223]
    v_mfma_f32_16x16x32_bf16 v[224:227], v[184:187], v[204:207], v[224:227]
    v_mfma_f32_16x16x32_bf16 v[224:227], v[188:191], v[208:211], v[224:227]
    s_waitcnt lgkmcnt(0)
    v_mfma_f32_16x16x32_bf16 v[220:223], v[192:195], v[212:215], v[220:223]
    v_mfma_f32_16x16x32_bf16 v[224:227], v[196:199], v[212:215], v[224:227]
    v_mfma_f32_16x16x32_bf16 v[224:227], v[200:203], v[216:219], v[224:227]
    s_nop 0
    v_cvt_pk_bf16_f32 v220, v220, v221
    v_cvt_pk_bf16_f32 v221, v222, v223
    s_nop 4
    v_cvt_pk_bf16_f32 v222, v224, v225
    v_cvt_pk_bf16_f32 v223, v226, v227
    buffer_store_dwordx4 v[220:223], v30, s[4:7], s49 offen sc1
    s_mov_b32 s51, 5832704
L_fp_32:
    buffer_load_dwordx4 v[120:123], v31, s[4:7], s51 offen sc1
    s_sub_u32 s36, s36, 1
    s_cbranch_scc1 L_exit
    s_waitcnt vmcnt(0)
    v_max3_u32 v41, v120, v121, v122
    v_max_u32 v41, v41, v123
    v_cmp_eq_u32 vcc, -1, v41
    s_cbranch_vccnz L_fp_32
    s_mov_b32 s51, 4849664
    buffer_load_dwordx4 v[148:151], v31, s[4:7], s51 offen sc1
    s_mov_b32 s51, 5177344
    buffer_load_dwordx4 v[152:155], v31, s[4:7], s51 offen sc1
    s_mov_b32 s51, 4194304
    buffer_load_dwordx4 v[156:159], v31, s[4:7], s51 offen sc1
    s_mov_b32 s51, 5505024
    buffer_load_dwordx4 v[160:163], v31, s[4:7], s51 offen sc1
    s_mov_b32 s52, 5079040
    v_mfma_f32_16x16x32_bf16 v[232:235], a[144:147], v[120:123], 0
    s_nop 7
    v_cndmask_b32 v234, v232, v233, s[58:59]
    v_cndmask_b32 v235, v233, v232, s[58:59]
    s_nop 1
    v_add_f32_dpp v235, v234, v235 row_ror:8 row_mask:0xf bank_mask:0xf
    v_cvt_pk_bf16_f32 v235, v235, v235
    buffer_store_short v235, v32, s[28:31], s52 offen
    s_waitcnt vmcnt(1)
    s_mov_b32 s52, 4751360
    v_mfma_f32_16x16x32_bf16 v[232:235], a[144:147], v[148:151], 0
    s_nop 7
    v_cndmask_b32 v234, v232, v233, s[58:59]
    v_cndmask_b32 v235, v233, v232, s[58:59]
    s_nop 1
    v_add_f32_dpp v235, v234, v235 row_ror:8 row_mask:0xf bank_mask:0xf
    v_cvt_pk_bf16_f32 v235, v235, v235
    buffer_store_short v235, v32, s[28:31], s52 offen
    s_mov_b32 s52, 4833280
    v_mfma_f32_16x16x32_bf16 v[232:235], a[144:147], v[152:155], 0
    s_nop 7
    v_cndmask_b32 v234, v232, v233, s[58:59]
    v_cndmask_b32 v235, v233, v232, s[58:59]
    s_nop 1
    v_add_f32_dpp v235, v234, v235 row_ror:8 row_mask:0xf bank_mask:0xf
    v_cvt_pk_bf16_f32 v235, v235, v235
    buffer_store_short v235, v32, s[28:31], s52 offen
    s_mov_b32 s52, 4915200
    v_mfma_f32_16x16x32_bf16 v[232:235], a[144:147], v[156:159], 0
    s_nop 7
    v_cndmask_b32 v234, v232, v233, s[58:59]
    v_cndmask_b32 v235, v233, v232, s[58:59]
    s_nop 1
    v_add_f32_dpp v235, v234, v235 row_ror:8 row_mask:0xf bank_mask:0xf
    v_cvt_pk_bf16_f32 v235, v235, v235
    buffer_store_short v235, v32, s[28:31], s52 offen
    s_mov_b32 s52, 4997120
    v_mfma_f32_16x16x32_bf16 v[232:235], a[144:147], v[160:163], 0
    s_nop 7
    v_cndmask_b32 v234, v232, v233, s[58:59]
    v_cndmask_b32 v235, v233, v232, s[58:59]
    s_nop 1
    v_add_f32_dpp v235, v234, v235 row_ror:8 row_mask:0xf bank_mask:0xf
    v_cvt_pk_bf16_f32 v235, v235, v235
    buffer_store_short v235, v32, s[28:31], s52 offen
    s_add_u32 s56, s37, 0
    s_and_b32 s55, s56, 3
    s_mul_i32 s55, s55, 114688
    s_add_u32 s55, s55, 53248
    s_add_u32 s48, s38, s55
    s_and_b32 s55, s56, 1
    s_add_u32 m0, s55, 12
    s_add_u32 s56, s56, 1
    v_mov_b32 v35, -16
    v_writelane_b32 v35, s56, m0
    s_mul_i32 s55, s55, 12288
    s_add_u32 m0, s54, s55
    buffer_load_dword v36, v33, s[4:7], s38 offen sc1
    s_waitcnt vmcnt(0)
    v_cmp_lt_i32 vcc, v36, v35
    s_cbranch_vccz L_fok_34
L_fw_33:
    buffer_load_dword v36, v33, s[4:7], s38 offen sc1
    s_sub_u32 s36, s36, 1
    s_cbranch_scc1 L_exit
    s_waitcnt vmcnt(0)
    v_cmp_lt_i32 vcc, v36, v35
    s_cbranch_vccnz L_fw_33
L_fok_34:
    buffer_load_dwordx4 v37, s[4:7], s48 offen offset:0 sc1 lds
    buffer_load_dwordx4 v37, s[4:7], s48 offen offset:1024 sc1 lds
    buffer_load_dwordx4 v37, s[4:7], s48 offen offset:2048 sc1 lds
    s_waitcnt vmcnt(0) lgkmcnt(0)
    s_barrier
    s_add_u32 s56, s37, 0
    s_and_b32 s55, s56, 3
    s_mul_i32 s55, s55, 24576
    v_add_u32 v26, s55, v22
    v_add_u32 v27, s55, v23
    s_and_b32 s55, s56, 1
    s_mul_i32 s55, s55, 12288
    v_add_u32 v29, s55, v28
    s_mov_b32 s49, 6160384
    ds_read_b128 v[204:207], v26 offset:0
    ds_read_b128 v[180:183], v29 offset:0
    ds_read_b128 v[184:187], v29 offset:1024
    ds_read_b64 v[208:209], v27 offset:0
    ds_read_b128 v[188:191], v29 offset:2048
    ds_read_b128 v[212:215], v26 offset:1536
    ds_read_b128 v[192:195], v29 offset:3072
    ds_read_b128 v[196:199], v29 offset:4096
    ds_read_b64 v[216:217], v27 offset:1536
    ds_read_b128 v[200:203], v29 offset:5120
    s_waitcnt lgkmcnt(5)
    v_mfma_f32_16x16x32_bf16 v[220:223], v[180:183], v[204:207], 0
    v_mfma_f32_16x16x32_bf16 v[224:227], v[184:187], v[204:207], 0
    v_mfma_f32_16x16x32_bf16 v[224:227], v[188:191], v[208:211], v[224:227]
    ds_read_b128 v[204:207], v26 offset:3072
    ds_read_b128 v[180:183], v29 offset:6144
    ds_read_b128 v[184:187], v29 offset:7168
    ds_read_b64 v[208:209], v27 offset:3072
    ds_read_b128 v[188:191], v29 offset:8192
    s_waitcnt lgkmcnt(5)
    v_mfma_f32_16x16x32_bf16 v[220:223], v[192:195], v[212:215], v[220:223]
    v_mfma_f32_16x16x32_bf16 v[224:227], v[196:199], v[212:215], v[224:227]
    v_mfma_f32_16x16x32_bf16 v[224:227], v[200:203], v[216:219], v[224:227]
    ds_read_b128 v[212:215], v26 offset:4608
    ds_read_b128 v[192:195], v29 offset:9216
    ds_read_b128 v[196:199], v29 offset:10240
    ds_read_b64 v[216:217], v27 offset:4608
    ds_read_b128 v[200:203], v29 offset:11264
    s_waitcnt lgkmcnt(5)
    v_mfma_f32_16x16x32_bf16 v[220:223], v[180:183], v[204:207], v[220:223]
    v_mfma_f32_16x16x32_bf16 v[224:227], v[184:187], v[204:207], v[224:227]
    v_mfma_f32_16x16x32_bf16 v[224:227], v[188:191], v[208:211], v[224:227]
    s_waitcnt lgkmcnt(0)
    v_mfma_f32_16x16x32_bf16 v[220:223], v[192:195], v[212:215], v[220:223]
    v_mfma_f32_16x16x32_bf16 v[224:227], v[196:199], v[212:215], v[224:227]
    v_mfma_f32_16x16x32_bf16 v[224:227], v[200:203], v[216:219], v[224:227]
    s_nop 0
    v_cvt_pk_bf16_f32 v220, v220, v221
    v_cvt_pk_bf16_f32 v221, v222, v223
    s_nop 4
    v_cvt_pk_bf16_f32 v222, v224, v225
    v_cvt_pk_bf16_f32 v223, v226, v227
    buffer_store_dwordx4 v[220:223], v30, s[4:7], s49 offen sc1
    s_mov_b32 s51, 6160384
L_fp_35:
    buffer_load_dwordx4 v[120:123], v31, s[4:7], s51 offen sc1
    s_sub_u32 s36, s36, 1
    s_cbranch_scc1 L_exit
    s_waitcnt vmcnt(0)
    v_max3_u32 v41, v120, v121, v122
    v_max_u32 v41, v41, v123
    v_cmp_eq_u32 vcc, -1, v41
    s_cbranch_vccnz L_fp_35
    s_mov_b32 s52, 5160960
    v_mfma_f32_16x16x32_bf16 v[232:235], a[144:147], v[120:123], 0
    s_nop 7
    v_cndmask_b32 v234, v232, v233, s[58:59]
    v_cndmask_b32 v235, v233, v232, s[58:59]
    s_nop 1
    v_add_f32_dpp v235, v234, v235 row_ror:8 row_mask:0xf bank_mask:0xf
    v_cvt_pk_bf16_f32 v235, v235, v235
    buffer_store_short v235, v32, s[28:31], s52 offen
    s_endpgm
L_vm_22:
    buffer_load_dwordx4 v[136:139], v44, s[4:7], s43 offen offset:0 sc1
    buffer_load_dwordx4 v[140:143], v44, s[4:7], s43 offen offset:1024 sc1
    buffer_load_dwordx4 v[144:147], v44, s[4:7], s43 offen offset:2048 sc1
    s_sub_u32 s36, s36, 1
    s_cbranch_scc1 L_exit
    s_waitcnt vmcnt(0)
    v_max_u32 v4, v136, v137
    v_max3_u32 v4, v4, v138, v139
    v_max3_u32 v4, v4, v140, v141
    v_max3_u32 v4, v4, v142, v143
    v_max3_u32 v4, v4, v144, v145
    v_max3_u32 v4, v4, v146, v147
    v_cmp_eq_u32 vcc, -1, v4
    s_cbranch_vccnz L_vm_22
    buffer_load_dwordx4 v[92:95], v38, s[4:7], s43 offen offset:0 sc1
    buffer_load_dword v104, v39, s[4:7], s43 offen offset:0 sc1
    buffer_load_dwordx4 v[96:99], v38, s[4:7], s43 offen offset:1280 sc1
    buffer_load_dword v105, v39, s[4:7], s43 offen offset:1280 sc1
    buffer_load_dwordx4 v[100:103], v38, s[4:7], s43 offen offset:2560 sc1
    buffer_load_dword v106, v39, s[4:7], s43 offen offset:2560 sc1
    v_mov_b32 v148, 0
    v_mov_b32 v149, 0
    v_mov_b32 v150, 0
    v_mov_b32 v151, 0
    v_mov_b32 v152, 0
    v_mov_b32 v153, 0
    v_mov_b32 v154, 0
    v_mov_b32 v155, 0
    v_mov_b32 v156, 0
    v_mov_b32 v157, 0
    v_mov_b32 v158, 0
    v_mov_b32 v159, 0
    v_mov_b32 v160, 0
    v_mov_b32 v161, 0
    v_mov_b32 v162, 0
    v_mov_b32 v163, 0
    v_smfmac_f32_16x16x64_bf16 v[148:151], v[136:139], a[0:7], v10
    v_smfmac_f32_16x16x64_bf16 v[152:155], v[136:139], a[24:31], v10
    v_smfmac_f32_16x16x64_bf16 v[156:159], v[136:139], a[48:55], v10
    v_smfmac_f32_16x16x64_bf16 v[160:163], v[136:139], a[72:79], v10
    v_smfmac_f32_16x16x64_bf16 v[148:151], v[140:143], a[8:15], v10
    v_smfmac_f32_16x16x64_bf16 v[152:155], v[140:143], a[32:39], v10
    v_smfmac_f32_16x16x64_bf16 v[156:159], v[140:143], a[56:63], v10
    v_smfmac_f32_16x16x64_bf16 v[160:163], v[140:143], a[80:87], v10
    v_smfmac_f32_16x16x64_bf16 v[148:151], v[144:147], a[16:23], v10
    v_smfmac_f32_16x16x64_bf16 v[152:155], v[144:147], a[40:47], v10
    v_smfmac_f32_16x16x64_bf16 v[156:159], v[144:147], a[64:71], v10
    v_smfmac_f32_16x16x64_bf16 v[160:163], v[144:147], a[88:95], v10
    v_pk_add_f32 v[148:149], v[148:149], v[150:151]
    v_cmp_u_f32 vcc, v148, v149
    v_cvt_pk_bf16_f32 v50, v148, v149
    v_cvt_pk_bf16_f32 v54, v148, v149
    v_pk_add_f32 v[152:153], v[152:153], v[154:155]
    v_cvt_pk_bf16_f32 v58, v152, v153
    v_cvt_pk_bf16_f32 v62, v152, v153
    v_pk_add_f32 v[156:157], v[156:157], v[158:159]
    v_cvt_pk_bf16_f32 v66, v156, v157
    v_cvt_pk_bf16_f32 v70, v156, v157
    v_pk_add_f32 v[160:161], v[160:161], v[162:163]
    v_cvt_pk_bf16_f32 v74, v160, v161
    v_cvt_pk_bf16_f32 v78, v160, v161
    s_branch L_u_23
L_sp_25:
    v_max3_u32 v4, v104, v105, v106
    v_max3_u32 v4, v4, v92, v93
    v_max3_u32 v4, v4, v94, v95
    v_max3_u32 v4, v4, v96, v97
    v_max3_u32 v4, v4, v98, v99
    v_max3_u32 v4, v4, v100, v101
    v_max3_u32 v4, v4, v102, v103
    v_cmp_eq_u32 vcc, -1, v4
    s_cbranch_vccz L_sg_26
    buffer_load_dwordx4 v[92:95], v38, s[4:7], s43 offen offset:0 sc1
    buffer_load_dword v104, v39, s[4:7], s43 offen offset:0 sc1
    buffer_load_dwordx4 v[96:99], v38, s[4:7], s43 offen offset:1280 sc1
    buffer_load_dword v105, v39, s[4:7], s43 offen offset:1280 sc1
    buffer_load_dwordx4 v[100:103], v38, s[4:7], s43 offen offset:2560 sc1
    buffer_load_dword v106, v39, s[4:7], s43 offen offset:2560 sc1
    s_sub_u32 s36, s36, 1
    s_cbranch_scc1 L_exit
    s_branch L_sc_24
L_px_f:
    s_sub_u32 s40, s35, 22
    v_and_b32 v1, 15, v0
    v_lshrrev_b32 v2, 4, v0
    s_mul_i32 s90, s32, 12288
    v_lshl_add_u32 v10, v0, 4, s90
    s_mul_i32 s90, s32, 3072
    v_lshl_add_u32 v12, v0, 4, s90
    v_lshrrev_b32 v3, 2, v1
    v_lshlrev_b32 v3, 1, v3
    v_and_b32 v4, 1, v1
    v_or_b32 v3, v3, v4
    v_lshl_add_u32 v3, v2, 3, v3
    v_lshl_add_u32 v11, v3, 4, s90
    s_lshl_b32 s90, s32, 7
    v_min_u32 v3, 11, v0
    v_lshl_add_u32 v3, v3, 2, s90
    v_add_u32 v13, 458752, v3
    v_min_u32 v3, 2, v0
    v_lshl_add_u32 v3, v3, 2, s90
    v_add_u32 v14, 459264, v3
    s_lshl_b32 s91, s40, 2
    s_add_u32 s90, s90, s91
    s_add_u32 s90, s90, 459776
    v_mov_b32 v15, s90
    v_cmp_eq_u32 vcc, 0, v0
    v_mov_b32 v9, 2146435072
    s_nop 0
    v_cndmask_b32 v15, v9, v15, vcc
    s_nop 0
    v_mov_b32 v21, 0xd04e79ff
    s_mov_b32 s44, 0x3dd53b95
    v_lshl_add_u32 v3, v2, 2, 0
    v_cmp_le_u32 s[48:49], v3, v1
    v_lshl_add_u32 v3, v2, 2, 1
    v_cmp_le_u32 s[50:51], v3, v1
    v_lshl_add_u32 v3, v2, 2, 2
    v_cmp_le_u32 s[52:53], v3, v1
    v_lshl_add_u32 v3, v2, 2, 3
    v_cmp_le_u32 s[54:55], v3, v1
    v_mov_b32 v167, 0
    v_mov_b32 v171, 0
    v_mov_b32 v174, 0
    v_mov_b32 v175, 0
    s_waitcnt vmcnt(0)
    s_barrier
    s_mov_b32 s24, s70
    s_and_b32 s25, s71, 0xffff
    s_mov_b32 s26, 2621440
    s_mov_b32 s27, 0x20000
    s_mul_i32 s90, s32, 10240
    v_lshl_add_u32 v22, v0, 4, s90
    s_mov_b32 s37, s40
    s_cmp_eq_u32 s40, 1
    s_cbranch_scc1 L_xp_36
    v_mov_b32 v1, 192
L_gw_38:
    buffer_load_dword v2, v1, s[8:11], 0 offen sc1
    s_sub_u32 s36, s36, 1
    s_cbranch_scc1 L_exit
    s_waitcnt vmcnt(0)
    v_readfirstlane_b32 s90, v2
    s_nop 0
    s_cmp_eq_u32 s90, 0
    s_cbranch_scc1 L_gw_38
    s_cmp_lg_u32 s90, 1
    s_cbranch_scc1 L_slow
    s_cmp_lg_u32 s32, 0
    s_cbranch_scc1 L_xg_37
    s_lshl_b32 s92, s34, 14
    s_add_u32 s92, s92, 1966080
    s_add_u32 s93, s92, 8192
    v_lshlrev_b32 v3, 4, v0
    buffer_store_dwordx4 v[24:27], v3, s[4:7], s92 offen offset:0 sc1
    buffer_store_dwordx4 v[24:27], v3, s[4:7], s93 offen offset:0 sc1
    buffer_store_dwordx4 v[24:27], v3, s[4:7], s92 offen offset:1024 sc1
    buffer_store_dwordx4 v[24:27], v3, s[4:7], s93 offen offset:1024 sc1
    buffer_store_dwordx4 v[24:27], v3, s[4:7], s92 offen offset:2048 sc1
    buffer_store_dwordx4 v[24:27], v3, s[4:7], s93 offen offset:2048 sc1
    buffer_store_dwordx4 v[24:27], v3, s[4:7], s92 offen offset:3072 sc1
    buffer_store_dwordx4 v[24:27], v3, s[4:7], s93 offen offset:3072 sc1
    v_mov_b32 v3, 0
    s_mov_b32 s56, -1
    s_mov_b32 s57, -1
    s_mov_b32 s62, 0
    s_mov_b32 s63, 0
    s_waitcnt vmcnt(0)
L_pr_39:
    s_memtime s[58:59]
    s_waitcnt lgkmcnt(0)
    buffer_load_dword v4, v3, s[4:7], s92 offen sc1
    s_waitcnt vmcnt(0)
    s_memtime s[60:61]
    s_waitcnt lgkmcnt(0)
    s_sub_u32 s60, s60, s58
    s_min_u32 s56, s56, s60
    s_memtime s[58:59]
    s_waitcnt lgkmcnt(0)
    buffer_load_dword v4, v3, s[4:7], s93 offen sc1
    s_waitcnt vmcnt(0)
    s_memtime s[60:61]
    s_waitcnt lgkmcnt(0)
    s_sub_u32 s60, s60, s58
    s_min_u32 s57, s57, s60
    buffer_load_dword v4, v13, s[4:7], s38 offen sc1
    v_add_u32 v3, 128, v3
    s_add_u32 s62, s62, 1
    s_waitcnt vmcnt(0)
    v_cmp_eq_u32 vcc, 0, v4
    s_nop 0
    s_cmp_eq_u64 vcc, 0
    s_addc_u32 s63, s63, 0
    s_cmp_ge_u32 s63, 2
    s_cselect_b32 s62, 32, s62
    s_cmp_lt_u32 s62, 32
    s_cbranch_scc1 L_pr_39
    s_cmp_lt_u32 s57, s56
    s_cselect_b32 s62, 2, 1
L_xg_37:
    s_barrier
    s_branch L_xg_37x
L_xp_36:
    s_or_b32 s90, s34, s32
    s_cbranch_scc1 L_xp_36c
    v_lshlrev_b32 v1, 2, v0
L_arp_41:
    buffer_load_dword v2, v1, s[8:11], 0 offen sc1
    s_sub_u32 s36, s36, 1
    s_cbranch_scc1 L_exit
    s_waitcnt vmcnt(0)
    v_readlane_b32 s92, v2, 12
    v_readlane_b32 s93, v2, 44
    v_cmp_eq_u32 s[90:91], 32, v2
    s_add_u32 s92, s92, s93
    s_cmp_lg_u32 s92, 256
    s_cbranch_scc1 L_arp_41
    s_and_b32 s90, s90, s91
    s_and_b32 s90, s90, 15
    s_cmp_lg_u32 s90, 15
    s_cbranch_scc1 L_arr_40
    v_mov_b32 v1, 192
    v_mov_b32 v2, 1
    s_mov_b64 exec, 1
    buffer_store_dword v2, v1, s[8:11], 0 offen sc1
    s_mov_b64 exec, -1
L_arr_40:
L_xp_36c:
    s_barrier
    s_add_u32 s90, s37, 1
    s_min_u32 s90, s90, 63
    s_mul_i32 s90, s90, 40960
    buffer_load_dwordx4 v[248:251], v22, s[24:27], s90 offen offset:0
    buffer_load_dwordx4 v[248:251], v22, s[24:27], s90 offen offset:1024
    buffer_load_dwordx4 v[248:251], v22, s[24:27], s90 offen offset:2048
    buffer_load_dwordx4 v[248:251], v22, s[24:27], s90 offen offset:3072
    s_add_u32 s90, s90, 4096
    buffer_load_dwordx4 v[248:251], v22, s[24:27], s90 offen offset:0
    buffer_load_dwordx4 v[248:251], v22, s[24:27], s90 offen offset:1024
    buffer_load_dwordx4 v[248:251], v22, s[24:27], s90 offen offset:2048
    buffer_load_dwordx4 v[248:251], v22, s[24:27], s90 offen offset:3072
    s_add_u32 s90, s90, 4096
    buffer_load_dwordx4 v[248:251], v22, s[24:27], s90 offen offset:0
    buffer_load_dwordx4 v[248:251], v22, s[24:27], s90 offen offset:1024
    s_add_u32 s90, s37, 2
    s_min_u32 s90, s90, 63
    s_mul_i32 s90, s90, 40960
    buffer_load_dwordx4 v[248:251], v22, s[24:27], s90 offen offset:0
    buffer_load_dwordx4 v[248:251], v22, s[24:27], s90 offen offset:1024
    buffer_load_dwordx4 v[248:251], v22, s[24:27], s90 offen offset:2048
    buffer_load_dwordx4 v[248:251], v22, s[24:27], s90 offen offset:3072
    s_add_u32 s90, s90, 4096
    buffer_load_dwordx4 v[248:251], v22, s[24:27], s90 offen offset:0
    buffer_load_dwordx4 v[248:251], v22, s[24:27], s90 offen offset:1024
    buffer_load_dwordx4 v[248:251], v22, s[24:27], s90 offen offset:2048
    buffer_load_dwordx4 v[248:251], v22, s[24:27], s90 offen offset:3072
    s_add_u32 s90, s90, 4096
    buffer_load_dwordx4 v[248:251], v22, s[24:27], s90 offen offset:0
    buffer_load_dwordx4 v[248:251], v22, s[24:27], s90 offen offset:1024
    s_add_u32 s90, s37, 3
    s_min_u32 s90, s90, 63
    s_mul_i32 s90, s90, 40960
    buffer_load_dwordx4 v[248:251], v22, s[24:27], s90 offen offset:0
    buffer_load_dwordx4 v[248:251], v22, s[24:27], s90 offen offset:1024
    buffer_load_dwordx4 v[248:251], v22, s[24:27], s90 offen offset:2048
    buffer_load_dwordx4 v[248:251], v22, s[24:27], s90 offen offset:3072
    s_add_u32 s90, s90, 4096
    buffer_load_dwordx4 v[248:251], v22, s[24:27], s90 offen offset:0
    buffer_load_dwordx4 v[248:251], v22, s[24:27], s90 offen offset:1024
    buffer_load_dwordx4 v[248:251], v22, s[24:27], s90 offen offset:2048
    buffer_load_dwordx4 v[248:251], v22, s[24:27], s90 offen offset:3072
    s_add_u32 s90, s90, 4096
    buffer_load_dwordx4 v[248:251], v22, s[24:27], s90 offen offset:0
    buffer_load_dwordx4 v[248:251], v22, s[24:27], s90 offen offset:1024
    s_add_u32 s90, s37, 4
    s_min_u32 s90, s90, 63
    s_mul_i32 s90, s90, 40960
    buffer_load_dwordx4 v[248:251], v22, s[24:27], s90 offen offset:0
    buffer_load_dwordx4 v[248:251], v22, s[24:27], s90 offen offset:1024
    buffer_load_dwordx4 v[248:251], v22, s[24:27], s90 offen offset:2048
    buffer_load_dwordx4 v[248:251], v22, s[24:27], s90 offen offset:3072
    s_add_u32 s90, s90, 4096
    buffer_load_dwordx4 v[248:251], v22, s[24:27], s90 offen offset:0
    buffer_load_dwordx4 v[248:251], v22, s[24:27], s90 offen offset:1024
    buffer_load_dwordx4 v[248:251], v22, s[24:27], s90 offen offset:2048
    buffer_load_dwordx4 v[248:251], v22, s[24:27], s90 offen offset:3072
    s_add_u32 s90, s90, 4096
    buffer_load_dwordx4 v[248:251], v22, s[24:27], s90 offen offset:0
    buffer_load_dwordx4 v[248:251], v22, s[24:27], s90 offen offset:1024
    s_add_u32 s90, s37, 5
    s_min_u32 s90, s90, 63
    s_mul_i32 s90, s90, 40960
    buffer_load_dwordx4 v[248:251], v22, s[24:27], s90 offen offset:0
    buffer_load_dwordx4 v[248:251], v22, s[24:27], s90 offen offset:1024
    buffer_load_dwordx4 v[248:251], v22, s[24:27], s90 offen offset:2048
    buffer_load_dwordx4 v[248:251], v22, s[24:27], s90 offen offset:3072
    s_add_u32 s90, s90, 4096
    buffer_load_dwordx4 v[248:251], v22, s[24:27], s90 offen offset:0
    buffer_load_dwordx4 v[248:251], v22, s[24:27], s90 offen offset:1024
    buffer_load_dwordx4 v[248:251], v22, s[24:27], s90 offen offset:2048
    buffer_load_dwordx4 v[248:251], v22, s[24:27], s90 offen offset:3072
    s_add_u32 s90, s90, 4096
    buffer_load_dwordx4 v[248:251], v22, s[24:27], s90 offen offset:0
    buffer_load_dwordx4 v[248:251], v22, s[24:27], s90 offen offset:1024
    s_add_u32 s90, s37, 6
    s_min_u32 s90, s90, 63
    s_mul_i32 s90, s90, 40960
    buffer_load_dwordx4 v[248:251], v22, s[24:27], s90 offen offset:0
    buffer_load_dwordx4 v[248:251], v22, s[24:27], s90 offen offset:1024
    buffer_load_dwordx4 v[248:251], v22, s[24:27], s90 offen offset:2048
    buffer_load_dwordx4 v[248:251], v22, s[24:27], s90 offen offset:3072
    s_add_u32 s90, s90, 4096
    buffer_load_dwordx4 v[248:251], v22, s[24:27], s90 offen offset:0
    buffer_load_dwordx4 v[248:251], v22, s[24:27], s90 offen offset:1024
    buffer_load_dwordx4 v[248:251], v22, s[24:27], s90 offen offset:2048
    buffer_load_dwordx4 v[248:251], v22, s[24:27], s90 offen offset:3072
    s_add_u32 s90, s90, 4096
    buffer_load_dwordx4 v[248:251], v22, s[24:27], s90 offen offset:0
    buffer_load_dwordx4 v[248:251], v22, s[24:27], s90 offen offset:1024
L_xg_37x:
    v_mov_b32 v1, 192
L_gw_42:
    buffer_load_dword v2, v1, s[8:11], 0 offen sc1
    s_sub_u32 s36, s36, 1
    s_cbranch_scc1 L_exit
    s_waitcnt vmcnt(0)
    v_readfirstlane_b32 s90, v2
    s_nop 0
    s_cmp_eq_u32 s90, 0
    s_cbranch_scc1 L_gw_42
    s_cmp_lg_u32 s90, 1
    s_cbranch_scc1 L_slow
    s_or_b32 s90, s40, s32
    s_cbranch_scc1 L_xg_37y
    v_mov_b32 v3, 460288
    v_mov_b32 v4, s62
    buffer_store_dword v4, v3, s[4:7], s38 offen
    s_cmp_lg_u32 s34, 0
    s_cbranch_scc1 L_xg_37y
    v_mov_b32 v3, 200
    buffer_store_dword v4, v3, s[8:11], 0 offen sc1
L_xg_37y:
L_px_loop_f:
    s_and_b32 s90, s37, 7
    s_mul_i32 s91, s90, 98304
    s_add_u32 s91, s91, 475136
    s_add_u32 s41, s38, s91
    s_and_b32 s90, s37, 3
    s_mul_i32 s91, s90, 114688
    s_add_u32 s91, s91, s38
    s_add_u32 s42, s91, 40960
    s_add_u32 s43, s91, 53248
    s_add_u32 s90, s37, 1
    v_mov_b32 v17, s90
    s_add_u32 s90, s37, 8
    s_min_u32 s90, s90, 63
    s_mul_i32 s90, s90, 40960
    buffer_load_dwordx4 v[248:251], v22, s[24:27], s90 offen offset:0
    buffer_load_dwordx4 v[248:251], v22, s[24:27], s90 offen offset:1024
    buffer_load_dwordx4 v[248:251], v22, s[24:27], s90 offen offset:2048
    buffer_load_dwordx4 v[248:251], v22, s[24:27], s90 offen offset:3072
    s_add_u32 s90, s90, 4096
    buffer_load_dwordx4 v[248:251], v22, s[24:27], s90 offen offset:0
    buffer_load_dwordx4 v[248:251], v22, s[24:27], s90 offen offset:1024
    buffer_load_dwordx4 v[248:251], v22, s[24:27], s90 offen offset:2048
    buffer_load_dwordx4 v[248:251], v22, s[24:27], s90 offen offset:3072
    s_add_u32 s90, s90, 4096
    buffer_load_dwordx4 v[248:251], v22, s[24:27], s90 offen offset:0
    buffer_load_dwordx4 v[248:251], v22, s[24:27], s90 offen offset:1024
L_pf_43:
    buffer_load_dword v16, v13, s[4:7], s38 offen sc1
    s_sub_u32 s36, s36, 1
    s_cbranch_scc1 L_exit
    s_waitcnt vmcnt(0)
    v_cmp_ge_u32 vcc, s37, v16
    s_cbranch_vccnz L_pf_43
    s_add_u32 s90, s41, 0
    buffer_load_dwordx4 v[24:27], v10, s[4:7], s90 offen offset:0 sc1
    buffer_load_dwordx4 v[28:31], v10, s[4:7], s90 offen offset:1024 sc1
    buffer_load_dwordx4 v[32:35], v10, s[4:7], s90 offen offset:2048 sc1
    buffer_load_dwordx4 v[36:39], v10, s[4:7], s90 offen offset:3072 sc1
    s_add_u32 s90, s41, 4096
    buffer_load_dwordx4 v[40:43], v10, s[4:7], s90 offen offset:0 sc1
    buffer_load_dwordx4 v[44:47], v10, s[4:7], s90 offen offset:1024 sc1
    buffer_load_dwordx4 v[48:51], v10, s[4:7], s90 offen offset:2048 sc1
    buffer_load_dwordx4 v[52:55], v10, s[4:7], s90 offen offset:3072 sc1
    s_add_u32 s90, s41, 8192
    buffer_load_dwordx4 v[56:59], v10, s[4:7], s90 offen offset:0 sc1
    buffer_load_dwordx4 v[60:63], v10, s[4:7], s90 offen offset:1024 sc1
    buffer_load_dwordx4 v[64:67], v10, s[4:7], s90 offen offset:2048 sc1
    buffer_load_dwordx4 v[68:71], v10, s[4:7], s90 offen offset:3072 sc1
    s_add_u32 s90, s41, 49152
    buffer_load_dwordx4 v[72:75], v10, s[4:7], s90 offen offset:0 sc1
    buffer_load_dwordx4 v[76:79], v10, s[4:7], s90 offen offset:1024 sc1
    buffer_load_dwordx4 v[80:83], v10, s[4:7], s90 offen offset:2048 sc1
    buffer_load_dwordx4 v[84:87], v10, s[4:7], s90 offen offset:3072 sc1
    s_add_u32 s90, s41, 53248
    buffer_load_dwordx4 v[88:91], v10, s[4:7], s90 offen offset:0 sc1
    buffer_load_dwordx4 v[92:95], v10, s[4:7], s90 offen offset:1024 sc1
    buffer_load_dwordx4 v[96:99], v10, s[4:7], s90 offen offset:2048 sc1
    buffer_load_dwordx4 v[100:103], v10, s[4:7], s90 offen offset:3072 sc1
    s_add_u32 s90, s41, 57344
    buffer_load_dwordx4 v[104:107], v10, s[4:7], s90 offen offset:0 sc1
    buffer_load_dwordx4 v[108:111], v10, s[4:7], s90 offen offset:1024 sc1
    buffer_load_dwordx4 v[112:115], v10, s[4:7], s90 offen offset:2048 sc1
    buffer_load_dwordx4 v[116:119], v10, s[4:7], s90 offen offset:3072 sc1
    s_waitcnt vmcnt(0)
    v_mfma_f32_16x16x32_bf16 v[144:147], v[72:75], v[24:27], 0
    v_mfma_f32_16x16x32_bf16 v[152:155], v[72:75], v[48:51], 0
    v_mfma_f32_16x16x32_bf16 v[156:159], v[96:99], v[48:51], 0
    v_mfma_f32_16x16x32_bf16 v[144:147], v[76:79], v[28:31], v[144:147]
    v_mfma_f32_16x16x32_bf16 v[152:155], v[76:79], v[52:55], v[152:155]
    v_mfma_f32_16x16x32_bf16 v[156:159], v[100:103], v[52:55], v[156:159]
    v_mfma_f32_16x16x32_bf16 v[144:147], v[80:83], v[32:35], v[144:147]
    v_mfma_f32_16x16x32_bf16 v[152:155], v[80:83], v[56:59], v[152:155]
    v_mfma_f32_16x16x32_bf16 v[156:159], v[104:107], v[56:59], v[156:159]
    v_mfma_f32_16x16x32_bf16 v[144:147], v[84:87], v[36:39], v[144:147]
    v_mfma_f32_16x16x32_bf16 v[152:155], v[84:87], v[60:63], v[152:155]
    v_mfma_f32_16x16x32_bf16 v[156:159], v[108:111], v[60:63], v[156:159]
    v_mfma_f32_16x16x32_bf16 v[144:147], v[88:91], v[40:43], v[144:147]
    v_mfma_f32_16x16x32_bf16 v[152:155], v[88:91], v[64:67], v[152:155]
    v_mfma_f32_16x16x32_bf16 v[156:159], v[112:115], v[64:67], v[156:159]
    v_mfma_f32_16x16x32_bf16 v[144:147], v[92:95], v[44:47], v[144:147]
    v_mfma_f32_16x16x32_bf16 v[152:155], v[92:95], v[68:71], v[152:155]
    v_mfma_f32_16x16x32_bf16 v[156:159], v[116:119], v[68:71], v[156:159]
    s_nop 0
    v_cndmask_b32 v144, v21, v144, s[48:49]
    v_cndmask_b32 v145, v21, v145, s[50:51]
    v_cndmask_b32 v146, v21, v146, s[52:53]
    v_cndmask_b32 v147, v21, v147, s[54:55]
    s_nop 2
    v_cndmask_b32 v156, v21, v156, s[48:49]
    v_cndmask_b32 v157, v21, v157, s[50:51]
    v_cndmask_b32 v158, v21, v158, s[52:53]
    v_cndmask_b32 v159, v21, v159, s[54:55]
L_pf_44:
    buffer_load_dword v16, v14, s[4:7], s38 offen sc1
    s_sub_u32 s36, s36, 1
    s_cbranch_scc1 L_exit
    s_waitcnt vmcnt(0)
    v_cmp_ge_u32 vcc, s37, v16
    s_cbranch_vccnz L_pf_44
    buffer_load_dwordx4 v[120:123], v11, s[4:7], s42 offen offset:0 sc1
    buffer_load_dwordx4 v[124:127], v11, s[4:7], s42 offen offset:512 sc1
    buffer_load_dwordx4 v[128:131], v11, s[4:7], s42 offen offset:1024 sc1
    buffer_load_dwordx4 v[132:135], v11, s[4:7], s42 offen offset:1536 sc1
    buffer_load_dwordx4 v[136:139], v11, s[4:7], s42 offen offset:2048 sc1
    buffer_load_dwordx4 v[140:143], v11, s[4:7], s42 offen offset:2560 sc1
    s_waitcnt vmcnt(5)
    v_mfma_f32_16x16x32_bf16 v[148:151], v[120:123], v[24:27], 0
    v_mfma_f32_16x16x32_bf16 v[160:163], v[120:123], v[48:51], 0
    s_waitcnt vmcnt(4)
    v_mfma_f32_16x16x32_bf16 v[148:151], v[124:127], v[28:31], v[148:151]
    v_mfma_f32_16x16x32_bf16 v[160:163], v[124:127], v[52:55], v[160:163]
    s_waitcnt vmcnt(3)
    v_mfma_f32_16x16x32_bf16 v[148:151], v[128:131], v[32:35], v[148:151]
    v_mfma_f32_16x16x32_bf16 v[160:163], v[128:131], v[56:59], v[160:163]
    s_waitcnt vmcnt(2)
    v_mfma_f32_16x16x32_bf16 v[148:151], v[132:135], v[36:39], v[148:151]
    v_mfma_f32_16x16x32_bf16 v[160:163], v[132:135], v[60:63], v[160:163]
    s_waitcnt vmcnt(1)
    v_mfma_f32_16x16x32_bf16 v[148:151], v[136:139], v[40:43], v[148:151]
    v_mfma_f32_16x16x32_bf16 v[160:163], v[136:139], v[64:67], v[160:163]
    s_waitcnt vmcnt(0)
    v_mfma_f32_16x16x32_bf16 v[148:151], v[140:143], v[44:47], v[148:151]
    v_mfma_f32_16x16x32_bf16 v[160:163], v[140:143], v[68:71], v[160:163]
    v_max_f32 v18, v144, v145
    v_max3_f32 v18, v18, v146, v147
    s_nop 2
    v_max3_f32 v18, v18, v148, v149
    v_mov_b32 v19, v18
    s_nop 1
    v_permlane16_swap_b32 v18, v19
    v_max_f32 v18, v18, v19
    v_mov_b32 v19, v18
    s_nop 1
    v_permlane32_swap_b32 v18, v19
    v_max_f32 v18, v18, v19
    v_mul_f32 v18, 0xbdd53b95, v18
    v_fma_f32 v144, v144, s44, v18
    v_fma_f32 v145, v145, s44, v18
    v_fma_f32 v146, v146, s44, v18
    v_fma_f32 v147, v147, s44, v18
    v_fma_f32 v148, v148, s44, v18
    v_fma_f32 v149, v149, s44, v18
    v_exp_f32 v144, v144
    v_exp_f32 v145, v145
    v_exp_f32 v146, v146
    v_exp_f32 v147, v147
    v_exp_f32 v148, v148
    v_exp_f32 v149, v149
    v_add_f32 v20, v144, v145
    v_add_f32 v20, v20, v146
    v_add_f32 v20, v20, v147
    v_add_f32 v20, v20, v148
    v_add_f32 v20, v20, v149
    v_mov_b32 v19, v20
    s_nop 1
    v_permlane16_swap_b32 v20, v19
    v_add_f32 v20, v20, v19
    v_mov_b32 v19, v20
    s_nop 1
    v_permlane32_swap_b32 v20, v19
    v_add_f32 v20, v20, v19
    v_rcp_f32 v20, v20
    s_nop 0
    v_mul_f32 v144, v144, v20
    v_mul_f32 v145, v145, v20
    v_mul_f32 v146, v146, v20
    v_mul_f32 v147, v147, v20
    v_mul_f32 v148, v148, v20
    v_mul_f32 v149, v149, v20
    v_cvt_pk_bf16_f32 v164, v144, v145
    v_cvt_pk_bf16_f32 v165, v146, v147
    v_cvt_pk_bf16_f32 v166, v148, v149
    v_max_f32 v18, v152, v153
    v_max3_f32 v18, v18, v154, v155
    v_max3_f32 v18, v18, v160, v161
    v_max3_f32 v18, v18, v156, v157
    v_max3_f32 v18, v18, v158, v159
    v_mov_b32 v19, v18
    s_nop 1
    v_permlane16_swap_b32 v18, v19
    v_max_f32 v18, v18, v19
    v_mov_b32 v19, v18
    s_nop 1
    v_permlane32_swap_b32 v18, v19
    v_max_f32 v18, v18, v19
    v_mul_f32 v18, 0xbdd53b95, v18
    v_fma_f32 v152, v152, s44, v18
    v_fma_f32 v153, v153, s44, v18
    v_fma_f32 v154, v154, s44, v18
    v_fma_f32 v155, v155, s44, v18
    v_fma_f32 v160, v160, s44, v18
    v_fma_f32 v161, v161, s44, v18
    v_fma_f32 v156, v156, s44, v18
    v_fma_f32 v157, v157, s44, v18
    v_fma_f32 v158, v158, s44, v18
    v_fma_f32 v159, v159, s44, v18
    v_exp_f32 v152, v152
    v_exp_f32 v153, v153
    v_exp_f32 v154, v154
    v_exp_f32 v155, v155
    v_exp_f32 v160, v160
    v_exp_f32 v161, v161
    v_exp_f32 v156, v156
    v_exp_f32 v157, v157
    v_exp_f32 v158, v158
    v_exp_f32 v159, v159
    v_add_f32 v20, v152, v153
    v_add_f32 v20, v20, v154
    v_add_f32 v20, v20, v155
    v_add_f32 v20, v20, v160
    v_add_f32 v20, v20, v161
    v_add_f32 v20, v20, v156
    v_add_f32 v20, v20, v157
    v_add_f32 v20, v20, v158
    v_add_f32 v20, v20, v159
    v_mov_b32 v19, v20
    s_nop 1
    v_permlane16_swap_b32 v20, v19
    v_add_f32 v20, v20, v19
    v_mov_b32 v19, v20
    s_nop 1
    v_permlane32_swap_b32 v20, v19
    v_add_f32 v20, v20, v19
    v_rcp_f32 v20, v20
    s_nop 0
    v_mul_f32 v152, v152, v20
    v_mul_f32 v153, v153, v20
    v_mul_f32 v154, v154, v20
    v_mul_f32 v155, v155, v20
    v_mul_f32 v160, v160, v20
    v_mul_f32 v161, v161, v20
    v_mul_f32 v156, v156, v20
    v_mul_f32 v157, v157, v20
    v_mul_f32 v158, v158, v20
    v_mul_f32 v159, v159, v20
    v_cvt_pk_bf16_f32 v168, v152, v153
    v_cvt_pk_bf16_f32 v169, v154, v155
    v_cvt_pk_bf16_f32 v170, v160, v161
    v_cvt_pk_bf16_f32 v172, v156, v157
    v_cvt_pk_bf16_f32 v173, v158, v159
    buffer_store_dwordx4 v[164:167], v12, s[4:7], s43 offen offset:0
    buffer_store_dwordx4 v[168:171], v12, s[4:7], s43 offen offset:1024
    buffer_store_dwordx4 v[172:175], v12, s[4:7], s43 offen offset:2048
    s_waitcnt vmcnt(0)
    buffer_store_dword v17, v15, s[4:7], s38 offen
    s_add_u32 s37, s37, 2
    s_cmp_lt_u32 s37, 64
    s_cbranch_scc1 L_px_loop_f
    s_endpgm
L_pa_f:
    s_sub_u32 s93, s35, 24
    s_lshl_b32 s93, s93, 2
    s_add_u32 s93, s93, s32
    s_add_u32 s93, s93, 0
    v_add_u32 v4, 0, v0
    v_cmp_le_u32 vcc, 96, v4
    v_subrev_u32 v5, 96, v4
    s_nop 0
    v_cndmask_b32 v4, v4, v5, vcc
    v_lshlrev_b32 v4, 4, v4
    v_mov_b32 v5, 12288
    v_cndmask_b32 v5, 0, v5, vcc
    s_mul_i32 s90, s34, 1536
    v_add3_u32 v6, v4, v5, s90
    v_add_u32 v4, 64, v0
    v_cmp_le_u32 vcc, 96, v4
    v_subrev_u32 v5, 96, v4
    s_nop 0
    v_cndmask_b32 v4, v4, v5, vcc
    v_lshlrev_b32 v4, 4, v4
    v_mov_b32 v5, 12288
    v_cndmask_b32 v5, 0, v5, vcc
    s_mul_i32 s90, s34, 1536
    v_add3_u32 v7, v4, v5, s90
    v_add_u32 v4, 128, v0
    v_cmp_le_u32 vcc, 96, v4
    v_subrev_u32 v5, 96, v4
    s_nop 0
    v_cndmask_b32 v4, v4, v5, vcc
    v_lshlrev_b32 v4, 4, v4
    v_mov_b32 v5, 12288
    v_cndmask_b32 v5, 0, v5, vcc
    s_mul_i32 s90, s34, 1536
    v_add3_u32 v8, v4, v5, s90
    s_cmp_lt_u32 s93, 64
    s_cselect_b32 s12, s74, s74
    s_cselect_b32 s13, s75, s75
    s_cselect_b32 s91, 1, 1
    s_cmp_lt_u32 s93, 32
    s_cselect_b32 s12, s76, s12
    s_cselect_b32 s13, s77, s13
    s_cselect_b32 s91, 3, s91
    s_and_b32 s13, s13, 0xffff
    s_mov_b32 s14, 7864320
    s_mov_b32 s15, 0x20000
    s_mul_i32 s91, s91, 320
    s_mul_i32 s90, s93, 10
    s_add_u32 s90, s90, s91
    s_sub_u32 s90, s90, 640
    s_mul_i32 s90, s90, 12288
    buffer_load_dwordx4 v[248:251], v6, s[12:15], s90 offen
    buffer_load_dwordx4 v[248:251], v7, s[12:15], s90 offen
    buffer_load_dwordx4 v[248:251], v8, s[12:15], s90 offen
    s_add_u32 s90, s90, 24576
    buffer_load_dwordx4 v[248:251], v6, s[12:15], s90 offen
    buffer_load_dwordx4 v[248:251], v7, s[12:15], s90 offen
    buffer_load_dwordx4 v[248:251], v8, s[12:15], s90 offen
    s_add_u32 s90, s90, 24576
    buffer_load_dwordx4 v[248:251], v6, s[12:15], s90 offen
    buffer_load_dwordx4 v[248:251], v7, s[12:15], s90 offen
    buffer_load_dwordx4 v[248:251], v8, s[12:15], s90 offen
    s_add_u32 s90, s90, 24576
    buffer_load_dwordx4 v[248:251], v6, s[12:15], s90 offen
    buffer_load_dwordx4 v[248:251], v7, s[12:15], s90 offen
    buffer_load_dwordx4 v[248:251], v8, s[12:15], s90 offen
    s_add_u32 s90, s90, 24576
    buffer_load_dwordx4 v[248:251], v6, s[12:15], s90 offen
    buffer_load_dwordx4 v[248:251], v7, s[12:15], s90 offen
    buffer_load_dwordx4 v[248:251], v8, s[12:15], s90 offen
    s_add_u32 s90, s90, 24576
    s_sub_u32 s93, s35, 24
    s_lshl_b32 s93, s93, 2
    s_add_u32 s93, s93, s32
    s_add_u32 s93, s93, 32
    v_add_u32 v4, 0, v0
    v_cmp_le_u32 vcc, 96, v4
    v_subrev_u32 v5, 96, v4
    s_nop 0
    v_cndmask_b32 v4, v4, v5, vcc
    v_lshlrev_b32 v4, 4, v4
    v_mov_b32 v5, 12288
    v_cndmask_b32 v5, 0, v5, vcc
    s_mul_i32 s90, s34, 1536
    v_add3_u32 v6, v4, v5, s90
    v_add_u32 v4, 64, v0
    v_cmp_le_u32 vcc, 96, v4
    v_subrev_u32 v5, 96, v4
    s_nop 0
    v_cndmask_b32 v4, v4, v5, vcc
    v_lshlrev_b32 v4, 4, v4
    v_mov_b32 v5, 12288
    v_cndmask_b32 v5, 0, v5, vcc
    s_mul_i32 s90, s34, 1536
    v_add3_u32 v7, v4, v5, s90
    v_add_u32 v4, 128, v0
    v_cmp_le_u32 vcc, 96, v4
    v_subrev_u32 v5, 96, v4
    s_nop 0
    v_cndmask_b32 v4, v4, v5, vcc
    v_lshlrev_b32 v4, 4, v4
    v_mov_b32 v5, 12288
    v_cndmask_b32 v5, 0, v5, vcc
    s_mul_i32 s90, s34, 1536
    v_add3_u32 v8, v4, v5, s90
    s_cmp_lt_u32 s93, 64
    s_cselect_b32 s12, s74, s74
    s_cselect_b32 s13, s75, s75
    s_cselect_b32 s91, 1, 1
    s_cmp_lt_u32 s93, 32
    s_cselect_b32 s12, s76, s12
    s_cselect_b32 s13, s77, s13
    s_cselect_b32 s91, 3, s91
    s_and_b32 s13, s13, 0xffff
    s_mov_b32 s14, 7864320
    s_mov_b32 s15, 0x20000
    s_mul_i32 s91, s91, 320
    s_mul_i32 s90, s93, 10
    s_add_u32 s90, s90, s91
    s_sub_u32 s90, s90, 640
    s_mul_i32 s90, s90, 12288
    buffer_load_dwordx4 v[248:251], v6, s[12:15], s90 offen
    buffer_load_dwordx4 v[248:251], v7, s[12:15], s90 offen
    buffer_load_dwordx4 v[248:251], v8, s[12:15], s90 offen
    s_add_u32 s90, s90, 24576
    buffer_load_dwordx4 v[248:251], v6, s[12:15], s90 offen
    buffer_load_dwordx4 v[248:251], v7, s[12:15], s90 offen
    buffer_load_dwordx4 v[248:251], v8, s[12:15], s90 offen
    s_add_u32 s90, s90, 24576
    buffer_load_dwordx4 v[248:251], v6, s[12:15], s90 offen
    buffer_load_dwordx4 v[248:251], v7, s[12:15], s90 offen
    buffer_load_dwordx4 v[248:251], v8, s[12:15], s90 offen
    s_add_u32 s90, s90, 24576
    buffer_load_dwordx4 v[248:251], v6, s[12:15], s90 offen
    buffer_load_dwordx4 v[248:251], v7, s[12:15], s90 offen
    buffer_load_dwordx4 v[248:251], v8, s[12:15], s90 offen
    s_add_u32 s90, s90, 24576
    buffer_load_dwordx4 v[248:251], v6, s[12:15], s90 offen
    buffer_load_dwordx4 v[248:251], v7, s[12:15], s90 offen
    buffer_load_dwordx4 v[248:251], v8, s[12:15], s90 offen
    s_add_u32 s90, s90, 24576
    s_sub_u32 s93, s35, 24
    s_lshl_b32 s93, s93, 2
    s_add_u32 s93, s93, s32
    s_add_u32 s93, s93, 64
    v_add_u32 v4, 0, v0
    v_cmp_le_u32 vcc, 96, v4
    v_subrev_u32 v5, 96, v4
    s_nop 0
    v_cndmask_b32 v4, v4, v5, vcc
    v_lshlrev_b32 v4, 4, v4
    v_mov_b32 v5, 12288
    v_cndmask_b32 v5, 0, v5, vcc
    s_mul_i32 s90, s34, 1536
    v_add3_u32 v6, v4, v5, s90
    v_add_u32 v4, 64, v0
    v_cmp_le_u32 vcc, 96, v4
    v_subrev_u32 v5, 96, v4
    s_nop 0
    v_cndmask_b32 v4, v4, v5, vcc
    v_lshlrev_b32 v4, 4, v4
    v_mov_b32 v5, 12288
    v_cndmask_b32 v5, 0, v5, vcc
    s_mul_i32 s90, s34, 1536
    v_add3_u32 v7, v4, v5, s90
    v_add_u32 v4, 128, v0
    v_cmp_le_u32 vcc, 96, v4
    v_subrev_u32 v5, 96, v4
    s_nop 0
    v_cndmask_b32 v4, v4, v5, vcc
    v_lshlrev_b32 v4, 4, v4
    v_mov_b32 v5, 12288
    v_cndmask_b32 v5, 0, v5, vcc
    s_mul_i32 s90, s34, 1536
    v_add3_u32 v8, v4, v5, s90
    s_cmp_lt_u32 s93, 64
    s_cselect_b32 s12, s74, s74
    s_cselect_b32 s13, s75, s75
    s_cselect_b32 s91, 1, 1
    s_cmp_lt_u32 s93, 32
    s_cselect_b32 s12, s76, s12
    s_cselect_b32 s13, s77, s13
    s_cselect_b32 s91, 3, s91
    s_and_b32 s13, s13, 0xffff
    s_mov_b32 s14, 7864320
    s_mov_b32 s15, 0x20000
    s_mul_i32 s91, s91, 320
    s_mul_i32 s90, s93, 10
    s_add_u32 s90, s90, s91
    s_sub_u32 s90, s90, 640
    s_mul_i32 s90, s90, 12288
    buffer_load_dwordx4 v[248:251], v6, s[12:15], s90 offen
    buffer_load_dwordx4 v[248:251], v7, s[12:15], s90 offen
    buffer_load_dwordx4 v[248:251], v8, s[12:15], s90 offen
    s_add_u32 s90, s90, 24576
    buffer_load_dwordx4 v[248:251], v6, s[12:15], s90 offen
    buffer_load_dwordx4 v[248:251], v7, s[12:15], s90 offen
    buffer_load_dwordx4 v[248:251], v8, s[12:15], s90 offen
    s_add_u32 s90, s90, 24576
    buffer_load_dwordx4 v[248:251], v6, s[12:15], s90 offen
    buffer_load_dwordx4 v[248:251], v7, s[12:15], s90 offen
    buffer_load_dwordx4 v[248:251], v8, s[12:15], s90 offen
    s_add_u32 s90, s90, 24576
    buffer_load_dwordx4 v[248:251], v6, s[12:15], s90 offen
    buffer_load_dwordx4 v[248:251], v7, s[12:15], s90 offen
    buffer_load_dwordx4 v[248:251], v8, s[12:15], s90 offen
    s_add_u32 s90, s90, 24576
    buffer_load_dwordx4 v[248:251], v6, s[12:15], s90 offen
    buffer_load_dwordx4 v[248:251], v7, s[12:15], s90 offen
    buffer_load_dwordx4 v[248:251], v8, s[12:15], s90 offen
    s_add_u32 s90, s90, 24576
    v_mov_b32 v1, 192
L_gw_45:
    buffer_load_dword v2, v1, s[8:11], 0 offen sc1
    s_sub_u32 s36, s36, 1
    s_cbranch_scc1 L_exit
    s_waitcnt vmcnt(0)
    v_readfirstlane_b32 s90, v2
    s_nop 0
    s_cmp_eq_u32 s90, 0
    s_cbranch_scc1 L_gw_45
    s_cmp_lg_u32 s90, 1
    s_cbranch_scc1 L_slow
    s_sub_u32 s93, s35, 24
    s_lshl_b32 s93, s93, 2
    s_add_u32 s93, s93, s32
    s_lshl_b32 s93, s93, 10
    s_add_u32 s93, s93, s38
    v_lshlrev_b32 v4, 4, v0
    buffer_load_dwordx4 v[248:251], v4, s[4:7], s93 offen sc1
    s_add_u32 s93, s93, 32768
    buffer_load_dwordx4 v[248:251], v4, s[4:7], s93 offen sc1
    s_add_u32 s93, s93, 32768
    buffer_load_dwordx4 v[248:251], v4, s[4:7], s93 offen sc1
    s_add_u32 s93, s93, 32768
    buffer_load_dwordx4 v[248:251], v4, s[4:7], s93 offen sc1
    s_add_u32 s93, s93, 32768
    buffer_load_dwordx4 v[248:251], v4, s[4:7], s93 offen sc1
    s_add_u32 s93, s93, 32768
    buffer_load_dwordx4 v[248:251], v4, s[4:7], s93 offen sc1
    s_add_u32 s93, s93, 32768
    buffer_load_dwordx4 v[248:251], v4, s[4:7], s93 offen sc1
    s_add_u32 s93, s93, 32768
    buffer_load_dwordx4 v[248:251], v4, s[4:7], s93 offen sc1
    s_add_u32 s93, s93, 32768
    buffer_load_dwordx4 v[248:251], v4, s[4:7], s93 offen sc1
    s_add_u32 s93, s93, 32768
    buffer_load_dwordx4 v[248:251], v4, s[4:7], s93 offen sc1
    s_add_u32 s93, s93, 32768
    buffer_load_dwordx4 v[248:251], v4, s[4:7], s93 offen sc1
    s_add_u32 s93, s93, 32768
    buffer_load_dwordx4 v[248:251], v4, s[4:7], s93 offen sc1
    s_add_u32 s93, s93, 32768
    buffer_load_dwordx4 v[248:251], v4, s[4:7], s93 offen sc1
    s_add_u32 s93, s93, 32768
    buffer_load_dwordx4 v[248:251], v4, s[4:7], s93 offen sc1
    s_add_u32 s93, s93, 32768
    buffer_load_dwordx4 v[248:251], v4, s[4:7], s93 offen sc1
    s_add_u32 s93, s93, 32768
    s_waitcnt vmcnt(0)
    s_branch L_pa_body
L_pa_body:
    s_mov_b32 s12, s64
    s_and_b32 s13, s65, 0xffff
    s_mov_b32 s14, 2621440
    s_mov_b32 s15, 0x20000
    s_mov_b32 s16, s66
    s_and_b32 s17, s67, 0xffff
    s_mov_b32 s18, 2457600
    s_mov_b32 s19, 0x20000
    s_mov_b32 s20, s68
    s_and_b32 s21, s69, 0xffff
    s_mov_b32 s22, 819200
    s_mov_b32 s23, 0x20000
    v_and_b32 v1, 15, v0
    v_lshrrev_b32 v2, 4, v0
    s_lshl_b32 s40, s34, 3
    s_add_u32 s40, s40, s35
    s_sub_u32 s40, s40, 24
    s_lshl_b32 s40, s40, 5
    s_add_u32 s90, s40, -16
    v_add_u32 v3, s90, v1
    v_cmp_le_i32 vcc, 0, v3
    v_mul_u32_u24 v3, 1280, v3
    v_lshl_add_u32 v3, v2, 4, v3
    v_mov_b32 v4, 2146435072
    v_cndmask_b32 v3, v4, v3, vcc
    buffer_load_dwordx4 a[0:3], v3, s[12:15], 0 offen offset:0
    buffer_load_dwordx4 a[4:7], v3, s[12:15], 0 offen offset:64
    buffer_load_dwordx4 a[8:11], v3, s[12:15], 0 offen offset:128
    buffer_load_dwordx4 a[12:15], v3, s[12:15], 0 offen offset:192
    buffer_load_dwordx4 a[16:19], v3, s[12:15], 0 offen offset:256
    buffer_load_dwordx4 a[20:23], v3, s[12:15], 0 offen offset:320
    buffer_load_dwordx4 a[24:27], v3, s[12:15], 0 offen offset:384
    buffer_load_dwordx4 a[28:31], v3, s[12:15], 0 offen offset:448
    buffer_load_dwordx4 a[32:35], v3, s[12:15], 0 offen offset:512
    buffer_load_dwordx4 a[36:39], v3, s[12:15], 0 offen offset:576
    buffer_load_dwordx4 a[40:43], v3, s[12:15], 0 offen offset:640
    buffer_load_dwordx4 a[44:47], v3, s[12:15], 0 offen offset:704
    buffer_load_dwordx4 a[48:51], v3, s[12:15], 0 offen offset:768
    buffer_load_dwordx4 a[52:55], v3, s[12:15], 0 offen offset:832
    buffer_load_dwordx4 a[56:59], v3, s[12:15], 0 offen offset:896
    buffer_load_dwordx4 a[60:63], v3, s[12:15], 0 offen offset:960
    buffer_load_dwordx4 a[64:67], v3, s[12:15], 0 offen offset:1024
    buffer_load_dwordx4 a[68:71], v3, s[12:15], 0 offen offset:1088
    buffer_load_dwordx4 a[72:75], v3, s[12:15], 0 offen offset:1152
    buffer_load_dwordx4 a[76:79], v3, s[12:15], 0 offen offset:1216
    s_add_u32 s90, s40, 0
    v_add_u32 v3, s90, v1
    v_cmp_le_i32 vcc, 0, v3
    v_mul_u32_u24 v3, 1280, v3
    v_lshl_add_u32 v3, v2, 4, v3
    v_mov_b32 v4, 2146435072
    v_cndmask_b32 v3, v4, v3, vcc
    buffer_load_dwordx4 a[80:83], v3, s[12:15], 0 offen offset:0
    buffer_load_dwordx4 a[84:87], v3, s[12:15], 0 offen offset:64
    buffer_load_dwordx4 a[88:91], v3, s[12:15], 0 offen offset:128
    buffer_load_dwordx4 a[92:95], v3, s[12:15], 0 offen offset:192
    buffer_load_dwordx4 a[96:99], v3, s[12:15], 0 offen offset:256
    buffer_load_dwordx4 a[100:103], v3, s[12:15], 0 offen offset:320
    buffer_load_dwordx4 a[104:107], v3, s[12:15], 0 offen offset:384
    buffer_load_dwordx4 a[108:111], v3, s[12:15], 0 offen offset:448
    buffer_load_dwordx4 a[112:115], v3, s[12:15], 0 offen offset:512
    buffer_load_dwordx4 a[116:119], v3, s[12:15], 0 offen offset:576
    buffer_load_dwordx4 a[120:123], v3, s[12:15], 0 offen offset:640
    buffer_load_dwordx4 a[124:127], v3, s[12:15], 0 offen offset:704
    buffer_load_dwordx4 a[128:131], v3, s[12:15], 0 offen offset:768
    buffer_load_dwordx4 a[132:135], v3, s[12:15], 0 offen offset:832
    buffer_load_dwordx4 a[136:139], v3, s[12:15], 0 offen offset:896
    buffer_load_dwordx4 a[140:143], v3, s[12:15], 0 offen offset:960
    buffer_load_dwordx4 a[144:147], v3, s[12:15], 0 offen offset:1024
    buffer_load_dwordx4 a[148:151], v3, s[12:15], 0 offen offset:1088
    buffer_load_dwordx4 a[152:155], v3, s[12:15], 0 offen offset:1152
    buffer_load_dwordx4 a[156:159], v3, s[12:15], 0 offen offset:1216
    s_add_u32 s90, s40, 16
    v_add_u32 v3, s90, v1
    v_cmp_le_i32 vcc, 0, v3
    v_mul_u32_u24 v3, 1280, v3
    v_lshl_add_u32 v3, v2, 4, v3
    v_mov_b32 v4, 2146435072
    v_cndmask_b32 v3, v4, v3, vcc
    buffer_load_dwordx4 a[160:163], v3, s[12:15], 0 offen offset:0
    buffer_load_dwordx4 a[164:167], v3, s[12:15], 0 offen offset:64
    buffer_load_dwordx4 a[168:171], v3, s[12:15], 0 offen offset:128
    buffer_load_dwordx4 a[172:175], v3, s[12:15], 0 offen offset:192
    buffer_load_dwordx4 a[176:179], v3, s[12:15], 0 offen offset:256
    buffer_load_dwordx4 a[180:183], v3, s[12:15], 0 offen offset:320
    buffer_load_dwordx4 a[184:187], v3, s[12:15], 0 offen offset:384
    buffer_load_dwordx4 a[188:191], v3, s[12:15], 0 offen offset:448
    buffer_load_dwordx4 a[192:195], v3, s[12:15], 0 offen offset:512
    buffer_load_dwordx4 a[196:199], v3, s[12:15], 0 offen offset:576
    buffer_load_dwordx4 a[200:203], v3, s[12:15], 0 offen offset:640
    buffer_load_dwordx4 a[204:207], v3, s[12:15], 0 offen offset:704
    buffer_load_dwordx4 a[208:211], v3, s[12:15], 0 offen offset:768
    buffer_load_dwordx4 a[212:215], v3, s[12:15], 0 offen offset:832
    buffer_load_dwordx4 a[216:219], v3, s[12:15], 0 offen offset:896
    buffer_load_dwordx4 a[220:223], v3, s[12:15], 0 offen offset:960
    buffer_load_dwordx4 a[224:227], v3, s[12:15], 0 offen offset:1024
    buffer_load_dwordx4 a[228:231], v3, s[12:15], 0 offen offset:1088
    buffer_load_dwordx4 a[232:235], v3, s[12:15], 0 offen offset:1152
    buffer_load_dwordx4 a[236:239], v3, s[12:15], 0 offen offset:1216
    v_lshrrev_b32 v3, 3, v0
    v_and_b32 v4, 7, v0
    s_lshl_b32 s90, s32, 3
    v_add_u32 v5, s90, v3
    s_and_b32 s91, s32, 1
    s_lshl_b32 s91, s91, 2
    v_and_b32 v6, 2, v3
    v_or_b32 v6, s91, v6
    v_xor_b32 v6, v6, v4
    v_lshlrev_b32 v6, 4, v6
    v_mul_u32_u24 v7, 3840, v5
    v_add_u32 v10, v6, v7
    v_mul_u32_u24 v7, 1280, v5
    v_add_u32 v11, v6, v7
    v_lshrrev_b32 v3, 2, v1
    v_and_b32 v4, 3, v1
    v_and_b32 v5, 1, v2
    v_lshl_add_u32 v6, v2, 3, v3
    v_lshlrev_b32 v6, 7, v6
    v_and_b32 v7, 2, v3
    v_lshl_or_b32 v7, v5, 2, v7
    v_lshrrev_b32 v8, 1, v4
    s_lshl_b32 s90, s32, 1
    v_or_b32 v8, s90, v8
    v_xor_b32 v7, v7, v8
    v_lshl_add_u32 v6, v7, 4, v6
    v_and_b32 v7, 1, v4
    v_lshl_add_u32 v12, v7, 3, v6
    s_lshl_b32 s90, s32, 5
    v_lshl_add_u32 v6, v2, 3, s90
    v_mul_u32_u24 v7, 1296, v1
    v_add_u32 v14, v6, v7
    v_add_u32 v14, 49152, v14
    v_lshl_add_u32 v26, v2, 4, v7
    v_add_u32 v26, 49152, v26
    v_mul_u32_u24 v7, 648, v1
    v_add_u32 v15, v6, v7
    v_add_u32 v15, 90624, v15
    v_lshl_add_u32 v6, v5, 4, v1
    v_add_u32 v6, s40, v6
    v_mul_u32_u24 v6, 2560, v6
    v_lshrrev_b32 v7, 1, v2
    v_lshl_add_u32 v6, v7, 4, v6
    v_add_u32 v17, s90, v6
    v_and_b32 v3, 31, v0
    v_add_u32 v22, s40, v3
    v_lshrrev_b32 v4, 5, v0
    s_lshl_b32 s90, s32, 2
    v_add_u32 v4, s90, v4
    v_mul_u32_u24 v4, 40, v4
    v_mul_u32_u24 v5, 1296, v3
    v_add_u32 v5, v5, v4
    v_add_u32 v18, 49152, v5
    v_mul_u32_u24 v5, 648, v3
    v_add_u32 v5, v5, v4
    v_add_u32 v19, 91920, v5
    v_mov_b32 v25, 0xcf8547b1
    s_mov_b32 s47, 0x3ea52b5c
    s_mov_b32 s46, 0
L_pa_half:
    s_mul_i32 s42, s46, 640
    s_waitcnt vmcnt(0) lgkmcnt(0)
    s_barrier
    s_mov_b32 s44, 0
    s_mov_b32 s45, 0
    s_mov_b32 s41, 0
    s_lshl_b32 s90, s32, 10
    s_add_u32 m0, s90, s45
    s_add_u32 s91, s42, 0
    buffer_load_dwordx4 v10, s[16:19], s91 offen lds
    s_add_u32 m0, m0, 4096
    s_add_u32 s91, s91, 122880
    buffer_load_dwordx4 v10, s[16:19], s91 offen lds
    s_add_u32 m0, m0, 4096
    s_add_u32 s91, s91, 122880
    buffer_load_dwordx4 v10, s[16:19], s91 offen lds
    s_add_u32 m0, m0, 4096
    s_add_u32 s91, s91, 122880
    buffer_load_dwordx4 v10, s[16:19], s91 offen lds
    s_add_u32 s45, s45, 16384
    s_cmp_eq_u32 s45, 49152
    s_cselect_b32 s45, 0, s45
    s_lshl_b32 s90, s32, 10
    s_add_u32 m0, s90, s45
    s_add_u32 s91, s42, 491520
    buffer_load_dwordx4 v10, s[16:19], s91 offen lds
    s_add_u32 m0, m0, 4096
    s_add_u32 s91, s91, 122880
    buffer_load_dwordx4 v10, s[16:19], s91 offen lds
    s_add_u32 m0, m0, 4096
    s_add_u32 s91, s91, 122880
    buffer_load_dwordx4 v10, s[16:19], s91 offen lds
    s_add_u32 m0, m0, 4096
    s_add_u32 s91, s91, 122880
    buffer_load_dwordx4 v10, s[16:19], s91 offen lds
    s_add_u32 s45, s45, 16384
    s_cmp_eq_u32 s45, 49152
    s_cselect_b32 s45, 0, s45
L_pa_blk:
    s_add_u32 s43, s42, 128
    s_add_u32 s90, s42, 768
    s_cmp_eq_u32 s41, 4
    s_cselect_b32 s43, s90, s43
    s_cmp_eq_u32 s41, 9
    s_cselect_b32 s43, s90, s43
    s_cmp_eq_u32 s41, 14
    s_cselect_b32 s43, s42, s43
    v_add_u32 v13, s44, v12
    s_waitcnt vmcnt(4)
    s_barrier
    ds_read_b64_tr_b16 v[28:29], v13 offset:0
    ds_read_b64_tr_b16 v[30:31], v13 offset:512
    ds_read_b64_tr_b16 v[32:33], v13 offset:4096
    ds_read_b64_tr_b16 v[34:35], v13 offset:4608
    ds_read_b64_tr_b16 v[36:37], v13 offset:8192
    ds_read_b64_tr_b16 v[38:39], v13 offset:8704
    ds_read_b64_tr_b16 v[40:41], v13 offset:12288
    ds_read_b64_tr_b16 v[42:43], v13 offset:12800
    s_lshl_b32 s90, s32, 10
    s_add_u32 m0, s90, s45
    s_add_u32 s91, s42, 983040
    buffer_load_dwordx4 v10, s[16:19], s91 offen lds
    s_add_u32 m0, m0, 4096
    s_add_u32 s91, s91, 122880
    buffer_load_dwordx4 v10, s[16:19], s91 offen lds
    s_add_u32 m0, m0, 4096
    s_add_u32 s91, s91, 122880
    buffer_load_dwordx4 v10, s[16:19], s91 offen lds
    s_add_u32 m0, m0, 4096
    s_add_u32 s91, s91, 122880
    buffer_load_dwordx4 v10, s[16:19], s91 offen lds
    s_add_u32 s45, s45, 16384
    s_cmp_eq_u32 s45, 49152
    s_cselect_b32 s45, 0, s45
    s_add_u32 s44, s44, 16384
    s_cmp_eq_u32 s44, 49152
    s_cselect_b32 s44, 0, s44
    s_waitcnt lgkmcnt(6)
    v_mfma_f32_16x16x32_bf16 v[44:47], v[28:31], a[0:3], 0
    v_mfma_f32_16x16x32_bf16 v[48:51], v[28:31], a[80:83], 0
    v_mfma_f32_16x16x32_bf16 v[52:55], v[28:31], a[160:163], 0
    s_waitcnt lgkmcnt(4)
    v_mfma_f32_16x16x32_bf16 v[44:47], v[32:35], a[4:7], v[44:47]
    v_mfma_f32_16x16x32_bf16 v[48:51], v[32:35], a[84:87], v[48:51]
    v_mfma_f32_16x16x32_bf16 v[52:55], v[32:35], a[164:167], v[52:55]
    s_waitcnt lgkmcnt(2)
    v_mfma_f32_16x16x32_bf16 v[44:47], v[36:39], a[8:11], v[44:47]
    v_mfma_f32_16x16x32_bf16 v[48:51], v[36:39], a[88:91], v[48:51]
    v_mfma_f32_16x16x32_bf16 v[52:55], v[36:39], a[168:171], v[52:55]
    s_waitcnt lgkmcnt(0)
    v_mfma_f32_16x16x32_bf16 v[44:47], v[40:43], a[12:15], v[44:47]
    v_mfma_f32_16x16x32_bf16 v[48:51], v[40:43], a[92:95], v[48:51]
    v_mfma_f32_16x16x32_bf16 v[52:55], v[40:43], a[172:175], v[52:55]
    v_add_u32 v13, s44, v12
    s_waitcnt vmcnt(4)
    s_barrier
    ds_read_b64_tr_b16 v[28:29], v13 offset:0
    ds_read_b64_tr_b16 v[30:31], v13 offset:512
    ds_read_b64_tr_b16 v[32:33], v13 offset:4096
    ds_read_b64_tr_b16 v[34:35], v13 offset:4608
    ds_read_b64_tr_b16 v[36:37], v13 offset:8192
    ds_read_b64_tr_b16 v[38:39], v13 offset:8704
    ds_read_b64_tr_b16 v[40:41], v13 offset:12288
    ds_read_b64_tr_b16 v[42:43], v13 offset:12800
    s_lshl_b32 s90, s32, 10
    s_add_u32 m0, s90, s45
    s_add_u32 s91, s42, 1474560
    buffer_load_dwordx4 v10, s[16:19], s91 offen lds
    s_add_u32 m0, m0, 4096
    s_add_u32 s91, s91, 122880
    buffer_load_dwordx4 v10, s[16:19], s91 offen lds
    s_add_u32 m0, m0, 4096
    s_add_u32 s91, s91, 122880
    buffer_load_dwordx4 v10, s[16:19], s91 offen lds
    s_add_u32 m0, m0, 4096
    s_add_u32 s91, s91, 122880
    buffer_load_dwordx4 v10, s[16:19], s91 offen lds
    s_add_u32 s45, s45, 16384
    s_cmp_eq_u32 s45, 49152
    s_cselect_b32 s45, 0, s45
    s_add_u32 s44, s44, 16384
    s_cmp_eq_u32 s44, 49152
    s_cselect_b32 s44, 0, s44
    s_waitcnt lgkmcnt(6)
    v_mfma_f32_16x16x32_bf16 v[44:47], v[28:31], a[16:19], v[44:47]
    v_mfma_f32_16x16x32_bf16 v[48:51], v[28:31], a[96:99], v[48:51]
    v_mfma_f32_16x16x32_bf16 v[52:55], v[28:31], a[176:179], v[52:55]
    s_waitcnt lgkmcnt(4)
    v_mfma_f32_16x16x32_bf16 v[44:47], v[32:35], a[20:23], v[44:47]
    v_mfma_f32_16x16x32_bf16 v[48:51], v[32:35], a[100:103], v[48:51]
    v_mfma_f32_16x16x32_bf16 v[52:55], v[32:35], a[180:183], v[52:55]
    s_waitcnt lgkmcnt(2)
    v_mfma_f32_16x16x32_bf16 v[44:47], v[36:39], a[24:27], v[44:47]
    v_mfma_f32_16x16x32_bf16 v[48:51], v[36:39], a[104:107], v[48:51]
    v_mfma_f32_16x16x32_bf16 v[52:55], v[36:39], a[184:187], v[52:55]
    s_waitcnt lgkmcnt(0)
    v_mfma_f32_16x16x32_bf16 v[44:47], v[40:43], a[28:31], v[44:47]
    v_mfma_f32_16x16x32_bf16 v[48:51], v[40:43], a[108:111], v[48:51]
    v_mfma_f32_16x16x32_bf16 v[52:55], v[40:43], a[188:191], v[52:55]
    v_add_u32 v13, s44, v12
    s_waitcnt vmcnt(4)
    s_barrier
    ds_read_b64_tr_b16 v[28:29], v13 offset:0
    ds_read_b64_tr_b16 v[30:31], v13 offset:512
    ds_read_b64_tr_b16 v[32:33], v13 offset:4096
    ds_read_b64_tr_b16 v[34:35], v13 offset:4608
    ds_read_b64_tr_b16 v[36:37], v13 offset:8192
    ds_read_b64_tr_b16 v[38:39], v13 offset:8704
    ds_read_b64_tr_b16 v[40:41], v13 offset:12288
    ds_read_b64_tr_b16 v[42:43], v13 offset:12800
    s_lshl_b32 s90, s32, 10
    s_add_u32 m0, s90, s45
    s_add_u32 s91, s42, 1966080
    buffer_load_dwordx4 v10, s[16:19], s91 offen lds
    s_add_u32 m0, m0, 4096
    s_add_u32 s91, s91, 122880
    buffer_load_dwordx4 v10, s[16:19], s91 offen lds
    s_add_u32 m0, m0, 4096
    s_add_u32 s91, s91, 122880
    buffer_load_dwordx4 v10, s[16:19], s91 offen lds
    s_add_u32 m0, m0, 4096
    s_add_u32 s91, s91, 122880
    buffer_load_dwordx4 v10, s[16:19], s91 offen lds
    s_add_u32 s45, s45, 16384
    s_cmp_eq_u32 s45, 49152
    s_cselect_b32 s45, 0, s45
    s_add_u32 s44, s44, 16384
    s_cmp_eq_u32 s44, 49152
    s_cselect_b32 s44, 0, s44
    s_waitcnt lgkmcnt(6)
    v_mfma_f32_16x16x32_bf16 v[44:47], v[28:31], a[32:35], v[44:47]
    v_mfma_f32_16x16x32_bf16 v[48:51], v[28:31], a[112:115], v[48:51]
    v_mfma_f32_16x16x32_bf16 v[52:55], v[28:31], a[192:195], v[52:55]
    s_waitcnt lgkmcnt(4)
    v_mfma_f32_16x16x32_bf16 v[44:47], v[32:35], a[36:39], v[44:47]
    v_mfma_f32_16x16x32_bf16 v[48:51], v[32:35], a[116:119], v[48:51]
    v_mfma_f32_16x16x32_bf16 v[52:55], v[32:35], a[196:199], v[52:55]
    s_waitcnt lgkmcnt(2)
    v_mfma_f32_16x16x32_bf16 v[44:47], v[36:39], a[40:43], v[44:47]
    v_mfma_f32_16x16x32_bf16 v[48:51], v[36:39], a[120:123], v[48:51]
    v_mfma_f32_16x16x32_bf16 v[52:55], v[36:39], a[200:203], v[52:55]
    s_waitcnt lgkmcnt(0)
    v_mfma_f32_16x16x32_bf16 v[44:47], v[40:43], a[44:47], v[44:47]
    v_mfma_f32_16x16x32_bf16 v[48:51], v[40:43], a[124:127], v[48:51]
    v_mfma_f32_16x16x32_bf16 v[52:55], v[40:43], a[204:207], v[52:55]
    v_add_u32 v13, s44, v12
    s_waitcnt vmcnt(4)
    s_barrier
    ds_read_b64_tr_b16 v[28:29], v13 offset:0
    ds_read_b64_tr_b16 v[30:31], v13 offset:512
    ds_read_b64_tr_b16 v[32:33], v13 offset:4096
    ds_read_b64_tr_b16 v[34:35], v13 offset:4608
    ds_read_b64_tr_b16 v[36:37], v13 offset:8192
    ds_read_b64_tr_b16 v[38:39], v13 offset:8704
    ds_read_b64_tr_b16 v[40:41], v13 offset:12288
    ds_read_b64_tr_b16 v[42:43], v13 offset:12800
    s_lshl_b32 s90, s32, 10
    s_add_u32 m0, s90, s45
    s_add_u32 s91, s43, 0
    buffer_load_dwordx4 v10, s[16:19], s91 offen lds
    s_add_u32 m0, m0, 4096
    s_add_u32 s91, s91, 122880
    buffer_load_dwordx4 v10, s[16:19], s91 offen lds
    s_add_u32 m0, m0, 4096
    s_add_u32 s91, s91, 122880
    buffer_load_dwordx4 v10, s[16:19], s91 offen lds
    s_add_u32 m0, m0, 4096
    s_add_u32 s91, s91, 122880
    buffer_load_dwordx4 v10, s[16:19], s91 offen lds
    s_add_u32 s45, s45, 16384
    s_cmp_eq_u32 s45, 49152
    s_cselect_b32 s45, 0, s45
    s_add_u32 s44, s44, 16384
    s_cmp_eq_u32 s44, 49152
    s_cselect_b32 s44, 0, s44
    s_waitcnt lgkmcnt(6)
    v_mfma_f32_16x16x32_bf16 v[44:47], v[28:31], a[48:51], v[44:47]
    v_mfma_f32_16x16x32_bf16 v[48:51], v[28:31], a[128:131], v[48:51]
    v_mfma_f32_16x16x32_bf16 v[52:55], v[28:31], a[208:211], v[52:55]
    s_waitcnt lgkmcnt(4)
    v_mfma_f32_16x16x32_bf16 v[44:47], v[32:35], a[52:55], v[44:47]
    v_mfma_f32_16x16x32_bf16 v[48:51], v[32:35], a[132:135], v[48:51]
    v_mfma_f32_16x16x32_bf16 v[52:55], v[32:35], a[212:215], v[52:55]
    s_waitcnt lgkmcnt(2)
    v_mfma_f32_16x16x32_bf16 v[44:47], v[36:39], a[56:59], v[44:47]
    v_mfma_f32_16x16x32_bf16 v[48:51], v[36:39], a[136:139], v[48:51]
    v_mfma_f32_16x16x32_bf16 v[52:55], v[36:39], a[216:219], v[52:55]
    s_waitcnt lgkmcnt(0)
    v_mfma_f32_16x16x32_bf16 v[44:47], v[40:43], a[60:63], v[44:47]
    v_mfma_f32_16x16x32_bf16 v[48:51], v[40:43], a[140:143], v[48:51]
    v_mfma_f32_16x16x32_bf16 v[52:55], v[40:43], a[220:223], v[52:55]
    v_add_u32 v13, s44, v12
    s_waitcnt vmcnt(4)
    s_barrier
    ds_read_b64_tr_b16 v[28:29], v13 offset:0
    ds_read_b64_tr_b16 v[30:31], v13 offset:512
    ds_read_b64_tr_b16 v[32:33], v13 offset:4096
    ds_read_b64_tr_b16 v[34:35], v13 offset:4608
    ds_read_b64_tr_b16 v[36:37], v13 offset:8192
    ds_read_b64_tr_b16 v[38:39], v13 offset:8704
    ds_read_b64_tr_b16 v[40:41], v13 offset:12288
    ds_read_b64_tr_b16 v[42:43], v13 offset:12800
    s_lshl_b32 s90, s32, 10
    s_add_u32 m0, s90, s45
    s_add_u32 s91, s43, 491520
    buffer_load_dwordx4 v10, s[16:19], s91 offen lds
    s_add_u32 m0, m0, 4096
    s_add_u32 s91, s91, 122880
    buffer_load_dwordx4 v10, s[16:19], s91 offen lds
    s_add_u32 m0, m0, 4096
    s_add_u32 s91, s91, 122880
    buffer_load_dwordx4 v10, s[16:19], s91 offen lds
    s_add_u32 m0, m0, 4096
    s_add_u32 s91, s91, 122880
    buffer_load_dwordx4 v10, s[16:19], s91 offen lds
    s_add_u32 s45, s45, 16384
    s_cmp_eq_u32 s45, 49152
    s_cselect_b32 s45, 0, s45
    s_add_u32 s44, s44, 16384
    s_cmp_eq_u32 s44, 49152
    s_cselect_b32 s44, 0, s44
    s_waitcnt lgkmcnt(6)
    v_mfma_f32_16x16x32_bf16 v[44:47], v[28:31], a[64:67], v[44:47]
    v_mfma_f32_16x16x32_bf16 v[48:51], v[28:31], a[144:147], v[48:51]
    v_mfma_f32_16x16x32_bf16 v[52:55], v[28:31], a[224:227], v[52:55]
    s_waitcnt lgkmcnt(4)
    v_mfma_f32_16x16x32_bf16 v[44:47], v[32:35], a[68:71], v[44:47]
    v_mfma_f32_16x16x32_bf16 v[48:51], v[32:35], a[148:151], v[48:51]
    v_mfma_f32_16x16x32_bf16 v[52:55], v[32:35], a[228:231], v[52:55]
    s_waitcnt lgkmcnt(2)
    v_mfma_f32_16x16x32_bf16 v[44:47], v[36:39], a[72:75], v[44:47]
    v_mfma_f32_16x16x32_bf16 v[48:51], v[36:39], a[152:155], v[48:51]
    v_mfma_f32_16x16x32_bf16 v[52:55], v[36:39], a[232:235], v[52:55]
    s_waitcnt lgkmcnt(0)
    v_mfma_f32_16x16x32_bf16 v[44:47], v[40:43], a[76:79], v[44:47]
    v_mfma_f32_16x16x32_bf16 v[48:51], v[40:43], a[156:159], v[48:51]
    v_mfma_f32_16x16x32_bf16 v[52:55], v[40:43], a[236:239], v[52:55]
    s_nop 0
    v_cvt_pk_bf16_f32 v56, v44, v45
    v_cvt_pk_bf16_f32 v57, v46, v47
    s_nop 1
    v_cvt_pk_bf16_f32 v58, v48, v49
    v_cvt_pk_bf16_f32 v59, v50, v51
    s_nop 0
    v_cvt_pk_bf16_f32 v60, v52, v53
    v_cvt_pk_bf16_f32 v61, v54, v55
    s_cmp_ge_u32 s41, 5
    s_cbranch_scc1 L_pa_kv
    v_add_u32 v16, s42, v14
    ds_write_b64 v16, v[58:59]
    ds_write_b64 v16, v[60:61] offset:20736
    s_branch L_pa_wr
L_pa_kv:
    s_sub_u32 s90, s41, 5
    s_lshl_b32 s90, s90, 7
    s_add_u32 s91, s90, 30464
    s_cmp_ge_u32 s41, 10
    s_cselect_b32 s90, s91, s90
    v_add_u32 v16, s90, v15
    ds_write_b64 v16, v[56:57]
    ds_write_b64 v16, v[58:59] offset:10368
    ds_write_b64 v16, v[60:61] offset:20736
L_pa_wr:
    s_waitcnt lgkmcnt(0)
    s_mov_b32 s42, s43
    s_add_u32 s41, s41, 1
    s_cmp_lt_u32 s41, 15
    s_cbranch_scc1 L_pa_blk
    s_barrier
    s_mov_b32 s48, 0
L_pa_att:
    s_mul_i32 s90, s48, 80
    v_add_u32 v21, s90, v19
    s_mul_i32 s91, s46, 640
    s_add_u32 s90, s90, s91
    v_add_u32 v20, s90, v18
    ds_read_b64 v[62:63], v20 offset:0
    ds_read_b64 v[64:65], v20 offset:8
    ds_read_b64 v[66:67], v20 offset:16
    ds_read_b64 v[68:69], v20 offset:24
    ds_read_b64 v[70:71], v20 offset:32
    ds_read_b64 v[72:73], v21 offset:9072
    ds_read_b64 v[74:75], v21 offset:9080
    ds_read_b64 v[76:77], v21 offset:9088
    ds_read_b64 v[78:79], v21 offset:9096
    ds_read_b64 v[80:81], v21 offset:9104
    ds_read_b64 v[82:83], v21 offset:7776
    ds_read_b64 v[84:85], v21 offset:7784
    ds_read_b64 v[86:87], v21 offset:7792
    ds_read_b64 v[88:89], v21 offset:7800
    ds_read_b64 v[90:91], v21 offset:7808
    s_waitcnt lgkmcnt(5)
    v_dot2_f32_bf16 v92, v62, v72, 0
    v_dot2_f32_bf16 v92, v63, v73, v92
    v_dot2_f32_bf16 v92, v64, v74, v92
    v_dot2_f32_bf16 v92, v65, v75, v92
    v_dot2_f32_bf16 v92, v66, v76, v92
    v_dot2_f32_bf16 v92, v67, v77, v92
    v_dot2_f32_bf16 v92, v68, v78, v92
    v_dot2_f32_bf16 v92, v69, v79, v92
    v_dot2_f32_bf16 v92, v70, v80, v92
    v_dot2_f32_bf16 v92, v71, v81, v92
    ds_read_b64 v[72:73], v21 offset:6480
    ds_read_b64 v[74:75], v21 offset:6488
    ds_read_b64 v[76:77], v21 offset:6496
    ds_read_b64 v[78:79], v21 offset:6504
    ds_read_b64 v[80:81], v21 offset:6512
    s_waitcnt lgkmcnt(5)
    v_dot2_f32_bf16 v93, v62, v82, 0
    v_dot2_f32_bf16 v93, v63, v83, v93
    v_dot2_f32_bf16 v93, v64, v84, v93
    v_dot2_f32_bf16 v93, v65, v85, v93
    v_dot2_f32_bf16 v93, v66, v86, v93
    v_dot2_f32_bf16 v93, v67, v87, v93
    v_dot2_f32_bf16 v93, v68, v88, v93
    v_dot2_f32_bf16 v93, v69, v89, v93
    v_dot2_f32_bf16 v93, v70, v90, v93
    v_dot2_f32_bf16 v93, v71, v91, v93
    ds_read_b64 v[82:83], v21 offset:5184
    ds_read_b64 v[84:85], v21 offset:5192
    ds_read_b64 v[86:87], v21 offset:5200
    ds_read_b64 v[88:89], v21 offset:5208
    ds_read_b64 v[90:91], v21 offset:5216
    s_waitcnt lgkmcnt(5)
    v_dot2_f32_bf16 v94, v62, v72, 0
    v_dot2_f32_bf16 v94, v63, v73, v94
    v_dot2_f32_bf16 v94, v64, v74, v94
    v_dot2_f32_bf16 v94, v65, v75, v94
    v_dot2_f32_bf16 v94, v66, v76, v94
    v_dot2_f32_bf16 v94, v67, v77, v94
    v_dot2_f32_bf16 v94, v68, v78, v94
    v_dot2_f32_bf16 v94, v69, v79, v94
    v_dot2_f32_bf16 v94, v70, v80, v94
    v_dot2_f32_bf16 v94, v71, v81, v94
    ds_read_b64 v[72:73], v21 offset:3888
    ds_read_b64 v[74:75], v21 offset:3896
    ds_read_b64 v[76:77], v21 offset:3904
    ds_read_b64 v[78:79], v21 offset:3912
    ds_read_b64 v[80:81], v21 offset:3920
    s_waitcnt lgkmcnt(5)
    v_dot2_f32_bf16 v95, v62, v82, 0
    v_dot2_f32_bf16 v95, v63, v83, v95
    v_dot2_f32_bf16 v95, v64, v84, v95
    v_dot2_f32_bf16 v95, v65, v85, v95
    v_dot2_f32_bf16 v95, v66, v86, v95
    v_dot2_f32_bf16 v95, v67, v87, v95
    v_dot2_f32_bf16 v95, v68, v88, v95
    v_dot2_f32_bf16 v95, v69, v89, v95
    v_dot2_f32_bf16 v95, v70, v90, v95
    v_dot2_f32_bf16 v95, v71, v91, v95
    ds_read_b64 v[82:83], v21 offset:2592
    ds_read_b64 v[84:85], v21 offset:2600
    ds_read_b64 v[86:87], v21 offset:2608
    ds_read_b64 v[88:89], v21 offset:2616
    ds_read_b64 v[90:91], v21 offset:2624
    s_waitcnt lgkmcnt(5)
    v_dot2_f32_bf16 v96, v62, v72, 0
    v_dot2_f32_bf16 v96, v63, v73, v96
    v_dot2_f32_bf16 v96, v64, v74, v96
    v_dot2_f32_bf16 v96, v65, v75, v96
    v_dot2_f32_bf16 v96, v66, v76, v96
    v_dot2_f32_bf16 v96, v67, v77, v96
    v_dot2_f32_bf16 v96, v68, v78, v96
    v_dot2_f32_bf16 v96, v69, v79, v96
    v_dot2_f32_bf16 v96, v70, v80, v96
    v_dot2_f32_bf16 v96, v71, v81, v96
    ds_read_b64 v[72:73], v21 offset:1296
    ds_read_b64 v[74:75], v21 offset:1304
    ds_read_b64 v[76:77], v21 offset:1312
    ds_read_b64 v[78:79], v21 offset:1320
    ds_read_b64 v[80:81], v21 offset:1328
    s_waitcnt lgkmcnt(5)
    v_dot2_f32_bf16 v97, v62, v82, 0
    v_dot2_f32_bf16 v97, v63, v83, v97
    v_dot2_f32_bf16 v97, v64, v84, v97
    v_dot2_f32_bf16 v97, v65, v85, v97
    v_dot2_f32_bf16 v97, v66, v86, v97
    v_dot2_f32_bf16 v97, v67, v87, v97
    v_dot2_f32_bf16 v97, v68, v88, v97
    v_dot2_f32_bf16 v97, v69, v89, v97
    v_dot2_f32_bf16 v97, v70, v90, v97
    v_dot2_f32_bf16 v97, v71, v91, v97
    ds_read_b64 v[82:83], v21 offset:0
    ds_read_b64 v[84:85], v21 offset:8
    ds_read_b64 v[86:87], v21 offset:16
    ds_read_b64 v[88:89], v21 offset:24
    ds_read_b64 v[90:91], v21 offset:32
    s_waitcnt lgkmcnt(5)
    v_dot2_f32_bf16 v98, v62, v72, 0
    v_dot2_f32_bf16 v98, v63, v73, v98
    v_dot2_f32_bf16 v98, v64, v74, v98
    v_dot2_f32_bf16 v98, v65, v75, v98
    v_dot2_f32_bf16 v98, v66, v76, v98
    v_dot2_f32_bf16 v98, v67, v77, v98
    v_dot2_f32_bf16 v98, v68, v78, v98
    v_dot2_f32_bf16 v98, v69, v79, v98
    v_dot2_f32_bf16 v98, v70, v80, v98
    v_dot2_f32_bf16 v98, v71, v81, v98
    ds_read_b64 v[72:73], v21 offset:40176
    ds_read_b64 v[74:75], v21 offset:40184
    ds_read_b64 v[76:77], v21 offset:40192
    ds_read_b64 v[78:79], v21 offset:40200
    ds_read_b64 v[80:81], v21 offset:40208
    s_waitcnt lgkmcnt(5)
    v_dot2_f32_bf16 v99, v62, v82, 0
    v_dot2_f32_bf16 v99, v63, v83, v99
    v_dot2_f32_bf16 v99, v64, v84, v99
    v_dot2_f32_bf16 v99, v65, v85, v99
    v_dot2_f32_bf16 v99, v66, v86, v99
    v_dot2_f32_bf16 v99, v67, v87, v99
    v_dot2_f32_bf16 v99, v68, v88, v99
    v_dot2_f32_bf16 v99, v69, v89, v99
    v_dot2_f32_bf16 v99, v70, v90, v99
    v_dot2_f32_bf16 v99, v71, v91, v99
    v_cmp_le_u32 vcc, 2, v22
    s_nop 1
    v_cndmask_b32 v93, v25, v93, vcc
    v_cmp_le_u32 vcc, 4, v22
    s_nop 1
    v_cndmask_b32 v94, v25, v94, vcc
    v_cmp_le_u32 vcc, 6, v22
    s_nop 1
    v_cndmask_b32 v95, v25, v95, vcc
    v_cmp_le_u32 vcc, 8, v22
    s_nop 1
    v_cndmask_b32 v96, v25, v96, vcc
    v_cmp_le_u32 vcc, 10, v22
    s_nop 1
    v_cndmask_b32 v97, v25, v97, vcc
    v_cmp_le_u32 vcc, 12, v22
    s_nop 1
    v_cndmask_b32 v98, v25, v98, vcc
    v_cmp_le_u32 vcc, 14, v22
    s_nop 1
    v_cndmask_b32 v99, v25, v99, vcc
    v_max_f32 v23, v92, v93
    v_max3_f32 v23, v23, v94, v95
    v_max3_f32 v23, v23, v96, v97
    v_max3_f32 v23, v23, v98, v99
    v_mul_f32 v23, 0xbea52b5c, v23
    v_fma_f32 v92, v92, s47, v23
    v_fma_f32 v93, v93, s47, v23
    v_fma_f32 v94, v94, s47, v23
    v_fma_f32 v95, v95, s47, v23
    v_fma_f32 v96, v96, s47, v23
    v_fma_f32 v97, v97, s47, v23
    v_fma_f32 v98, v98, s47, v23
    v_fma_f32 v99, v99, s47, v23
    v_exp_f32 v92, v92
    v_exp_f32 v93, v93
    v_exp_f32 v94, v94
    v_exp_f32 v95, v95
    v_exp_f32 v96, v96
    v_exp_f32 v97, v97
    v_exp_f32 v98, v98
    v_exp_f32 v99, v99
    v_add_f32 v24, v92, v93
    v_add_f32 v24, v24, v94
    v_add_f32 v24, v24, v95
    v_add_f32 v24, v24, v96
    v_add_f32 v24, v24, v97
    v_add_f32 v24, v24, v98
    v_add_f32 v24, v24, v99
    v_rcp_f32 v24, v24
    s_nop 0
    v_mul_f32 v92, v92, v24
    v_cvt_pk_bf16_f32 v100, v92, 0
    v_cvt_pk_bf16_f32 v101, 0, v92
    v_mul_f32 v93, v93, v24
    v_cvt_pk_bf16_f32 v102, v93, 0
    v_cvt_pk_bf16_f32 v103, 0, v93
    v_mul_f32 v94, v94, v24
    v_cvt_pk_bf16_f32 v104, v94, 0
    v_cvt_pk_bf16_f32 v105, 0, v94
    v_mul_f32 v95, v95, v24
    v_cvt_pk_bf16_f32 v106, v95, 0
    v_cvt_pk_bf16_f32 v107, 0, v95
    v_mul_f32 v96, v96, v24
    v_cvt_pk_bf16_f32 v108, v96, 0
    v_cvt_pk_bf16_f32 v109, 0, v96
    v_mul_f32 v97, v97, v24
    v_cvt_pk_bf16_f32 v110, v97, 0
    v_cvt_pk_bf16_f32 v111, 0, v97
    v_mul_f32 v98, v98, v24
    v_cvt_pk_bf16_f32 v112, v98, 0
    v_cvt_pk_bf16_f32 v113, 0, v98
    v_mul_f32 v99, v99, v24
    v_cvt_pk_bf16_f32 v114, v99, 0
    v_cvt_pk_bf16_f32 v115, 0, v99
    ds_read_b64 v[82:83], v21 offset:38880
    ds_read_b64 v[84:85], v21 offset:38888
    ds_read_b64 v[86:87], v21 offset:38896
    ds_read_b64 v[88:89], v21 offset:38904
    ds_read_b64 v[90:91], v21 offset:38912
    s_waitcnt lgkmcnt(5)
    v_dot2_f32_bf16 v116, v72, v100, 0
    v_dot2_f32_bf16 v117, v72, v101, 0
    v_dot2_f32_bf16 v118, v73, v100, 0
    v_dot2_f32_bf16 v119, v73, v101, 0
    v_dot2_f32_bf16 v120, v74, v100, 0
    v_dot2_f32_bf16 v121, v74, v101, 0
    v_dot2_f32_bf16 v122, v75, v100, 0
    v_dot2_f32_bf16 v123, v75, v101, 0
    v_dot2_f32_bf16 v124, v76, v100, 0
    v_dot2_f32_bf16 v125, v76, v101, 0
    v_dot2_f32_bf16 v126, v77, v100, 0
    v_dot2_f32_bf16 v127, v77, v101, 0
    v_dot2_f32_bf16 v128, v78, v100, 0
    v_dot2_f32_bf16 v129, v78, v101, 0
    v_dot2_f32_bf16 v130, v79, v100, 0
    v_dot2_f32_bf16 v131, v79, v101, 0
    v_dot2_f32_bf16 v132, v80, v100, 0
    v_dot2_f32_bf16 v133, v80, v101, 0
    v_dot2_f32_bf16 v134, v81, v100, 0
    v_dot2_f32_bf16 v135, v81, v101, 0
    ds_read_b64 v[72:73], v21 offset:37584
    ds_read_b64 v[74:75], v21 offset:37592
    ds_read_b64 v[76:77], v21 offset:37600
    ds_read_b64 v[78:79], v21 offset:37608
    ds_read_b64 v[80:81], v21 offset:37616
    s_waitcnt lgkmcnt(5)
    v_dot2_f32_bf16 v116, v82, v102, v116
    v_dot2_f32_bf16 v117, v82, v103, v117
    v_dot2_f32_bf16 v118, v83, v102, v118
    v_dot2_f32_bf16 v119, v83, v103, v119
    v_dot2_f32_bf16 v120, v84, v102, v120
    v_dot2_f32_bf16 v121, v84, v103, v121
    v_dot2_f32_bf16 v122, v85, v102, v122
    v_dot2_f32_bf16 v123, v85, v103, v123
    v_dot2_f32_bf16 v124, v86, v102, v124
    v_dot2_f32_bf16 v125, v86, v103, v125
    v_dot2_f32_bf16 v126, v87, v102, v126
    v_dot2_f32_bf16 v127, v87, v103, v127
    v_dot2_f32_bf16 v128, v88, v102, v128
    v_dot2_f32_bf16 v129, v88, v103, v129
    v_dot2_f32_bf16 v130, v89, v102, v130
    v_dot2_f32_bf16 v131, v89, v103, v131
    v_dot2_f32_bf16 v132, v90, v102, v132
    v_dot2_f32_bf16 v133, v90, v103, v133
    v_dot2_f32_bf16 v134, v91, v102, v134
    v_dot2_f32_bf16 v135, v91, v103, v135
    ds_read_b64 v[82:83], v21 offset:36288
    ds_read_b64 v[84:85], v21 offset:36296
    ds_read_b64 v[86:87], v21 offset:36304
    ds_read_b64 v[88:89], v21 offset:36312
    ds_read_b64 v[90:91], v21 offset:36320
    s_waitcnt lgkmcnt(5)
    v_dot2_f32_bf16 v116, v72, v104, v116
    v_dot2_f32_bf16 v117, v72, v105, v117
    v_dot2_f32_bf16 v118, v73, v104, v118
    v_dot2_f32_bf16 v119, v73, v105, v119
    v_dot2_f32_bf16 v120, v74, v104, v120
    v_dot2_f32_bf16 v121, v74, v105, v121
    v_dot2_f32_bf16 v122, v75, v104, v122
    v_dot2_f32_bf16 v123, v75, v105, v123
    v_dot2_f32_bf16 v124, v76, v104, v124
    v_dot2_f32_bf16 v125, v76, v105, v125
    v_dot2_f32_bf16 v126, v77, v104, v126
    v_dot2_f32_bf16 v127, v77, v105, v127
    v_dot2_f32_bf16 v128, v78, v104, v128
    v_dot2_f32_bf16 v129, v78, v105, v129
    v_dot2_f32_bf16 v130, v79, v104, v130
    v_dot2_f32_bf16 v131, v79, v105, v131
    v_dot2_f32_bf16 v132, v80, v104, v132
    v_dot2_f32_bf16 v133, v80, v105, v133
    v_dot2_f32_bf16 v134, v81, v104, v134
    v_dot2_f32_bf16 v135, v81, v105, v135
    ds_read_b64 v[72:73], v21 offset:34992
    ds_read_b64 v[74:75], v21 offset:35000
    ds_read_b64 v[76:77], v21 offset:35008
    ds_read_b64 v[78:79], v21 offset:35016
    ds_read_b64 v[80:81], v21 offset:35024
    s_waitcnt lgkmcnt(5)
    v_dot2_f32_bf16 v116, v82, v106, v116
    v_dot2_f32_bf16 v117, v82, v107, v117
    v_dot2_f32_bf16 v118, v83, v106, v118
    v_dot2_f32_bf16 v119, v83, v107, v119
    v_dot2_f32_bf16 v120, v84, v106, v120
    v_dot2_f32_bf16 v121, v84, v107, v121
    v_dot2_f32_bf16 v122, v85, v106, v122
    v_dot2_f32_bf16 v123, v85, v107, v123
    v_dot2_f32_bf16 v124, v86, v106, v124
    v_dot2_f32_bf16 v125, v86, v107, v125
    v_dot2_f32_bf16 v126, v87, v106, v126
    v_dot2_f32_bf16 v127, v87, v107, v127
    v_dot2_f32_bf16 v128, v88, v106, v128
    v_dot2_f32_bf16 v129, v88, v107, v129
    v_dot2_f32_bf16 v130, v89, v106, v130
    v_dot2_f32_bf16 v131, v89, v107, v131
    v_dot2_f32_bf16 v132, v90, v106, v132
    v_dot2_f32_bf16 v133, v90, v107, v133
    v_dot2_f32_bf16 v134, v91, v106, v134
    v_dot2_f32_bf16 v135, v91, v107, v135
    ds_read_b64 v[82:83], v21 offset:33696
    ds_read_b64 v[84:85], v21 offset:33704
    ds_read_b64 v[86:87], v21 offset:33712
    ds_read_b64 v[88:89], v21 offset:33720
    ds_read_b64 v[90:91], v21 offset:33728
    s_waitcnt lgkmcnt(5)
    v_dot2_f32_bf16 v116, v72, v108, v116
    v_dot2_f32_bf16 v117, v72, v109, v117
    v_dot2_f32_bf16 v118, v73, v108, v118
    v_dot2_f32_bf16 v119, v73, v109, v119
    v_dot2_f32_bf16 v120, v74, v108, v120
    v_dot2_f32_bf16 v121, v74, v109, v121
    v_dot2_f32_bf16 v122, v75, v108, v122
    v_dot2_f32_bf16 v123, v75, v109, v123
    v_dot2_f32_bf16 v124, v76, v108, v124
    v_dot2_f32_bf16 v125, v76, v109, v125
    v_dot2_f32_bf16 v126, v77, v108, v126
    v_dot2_f32_bf16 v127, v77, v109, v127
    v_dot2_f32_bf16 v128, v78, v108, v128
    v_dot2_f32_bf16 v129, v78, v109, v129
    v_dot2_f32_bf16 v130, v79, v108, v130
    v_dot2_f32_bf16 v131, v79, v109, v131
    v_dot2_f32_bf16 v132, v80, v108, v132
    v_dot2_f32_bf16 v133, v80, v109, v133
    v_dot2_f32_bf16 v134, v81, v108, v134
    v_dot2_f32_bf16 v135, v81, v109, v135
    ds_read_b64 v[72:73], v21 offset:32400
    ds_read_b64 v[74:75], v21 offset:32408
    ds_read_b64 v[76:77], v21 offset:32416
    ds_read_b64 v[78:79], v21 offset:32424
    ds_read_b64 v[80:81], v21 offset:32432
    s_waitcnt lgkmcnt(5)
    v_dot2_f32_bf16 v116, v82, v110, v116
    v_dot2_f32_bf16 v117, v82, v111, v117
    v_dot2_f32_bf16 v118, v83, v110, v118
    v_dot2_f32_bf16 v119, v83, v111, v119
    v_dot2_f32_bf16 v120, v84, v110, v120
    v_dot2_f32_bf16 v121, v84, v111, v121
    v_dot2_f32_bf16 v122, v85, v110, v122
    v_dot2_f32_bf16 v123, v85, v111, v123
    v_dot2_f32_bf16 v124, v86, v110, v124
    v_dot2_f32_bf16 v125, v86, v111, v125
    v_dot2_f32_bf16 v126, v87, v110, v126
    v_dot2_f32_bf16 v127, v87, v111, v127
    v_dot2_f32_bf16 v128, v88, v110, v128
    v_dot2_f32_bf16 v129, v88, v111, v129
    v_dot2_f32_bf16 v130, v89, v110, v130
    v_dot2_f32_bf16 v131, v89, v111, v131
    v_dot2_f32_bf16 v132, v90, v110, v132
    v_dot2_f32_bf16 v133, v90, v111, v133
    v_dot2_f32_bf16 v134, v91, v110, v134
    v_dot2_f32_bf16 v135, v91, v111, v135
    ds_read_b64 v[82:83], v21 offset:31104
    ds_read_b64 v[84:85], v21 offset:31112
    ds_read_b64 v[86:87], v21 offset:31120
    ds_read_b64 v[88:89], v21 offset:31128
    ds_read_b64 v[90:91], v21 offset:31136
    s_waitcnt lgkmcnt(5)
    v_dot2_f32_bf16 v116, v72, v112, v116
    v_dot2_f32_bf16 v117, v72, v113, v117
    v_dot2_f32_bf16 v118, v73, v112, v118
    v_dot2_f32_bf16 v119, v73, v113, v119
    v_dot2_f32_bf16 v120, v74, v112, v120
    v_dot2_f32_bf16 v121, v74, v113, v121
    v_dot2_f32_bf16 v122, v75, v112, v122
    v_dot2_f32_bf16 v123, v75, v113, v123
    v_dot2_f32_bf16 v124, v76, v112, v124
    v_dot2_f32_bf16 v125, v76, v113, v125
    v_dot2_f32_bf16 v126, v77, v112, v126
    v_dot2_f32_bf16 v127, v77, v113, v127
    v_dot2_f32_bf16 v128, v78, v112, v128
    v_dot2_f32_bf16 v129, v78, v113, v129
    v_dot2_f32_bf16 v130, v79, v112, v130
    v_dot2_f32_bf16 v131, v79, v113, v131
    v_dot2_f32_bf16 v132, v80, v112, v132
    v_dot2_f32_bf16 v133, v80, v113, v133
    v_dot2_f32_bf16 v134, v81, v112, v134
    v_dot2_f32_bf16 v135, v81, v113, v135
    s_waitcnt lgkmcnt(0)
    v_dot2_f32_bf16 v116, v82, v114, v116
    v_dot2_f32_bf16 v117, v82, v115, v117
    v_dot2_f32_bf16 v118, v83, v114, v118
    v_dot2_f32_bf16 v119, v83, v115, v119
    v_dot2_f32_bf16 v120, v84, v114, v120
    v_dot2_f32_bf16 v121, v84, v115, v121
    v_dot2_f32_bf16 v122, v85, v114, v122
    v_dot2_f32_bf16 v123, v85, v115, v123
    v_dot2_f32_bf16 v124, v86, v114, v124
    v_dot2_f32_bf16 v125, v86, v115, v125
    v_dot2_f32_bf16 v126, v87, v114, v126
    v_dot2_f32_bf16 v127, v87, v115, v127
    v_dot2_f32_bf16 v128, v88, v114, v128
    v_dot2_f32_bf16 v129, v88, v115, v129
    v_dot2_f32_bf16 v130, v89, v114, v130
    v_dot2_f32_bf16 v131, v89, v115, v131
    v_dot2_f32_bf16 v132, v90, v114, v132
    v_dot2_f32_bf16 v133, v90, v115, v133
    v_dot2_f32_bf16 v134, v91, v114, v134
    v_dot2_f32_bf16 v135, v91, v115, v135
    v_cvt_pk_bf16_f32 v62, v116, v117
    v_cvt_pk_bf16_f32 v63, v118, v119
    v_cvt_pk_bf16_f32 v64, v120, v121
    v_cvt_pk_bf16_f32 v65, v122, v123
    v_cvt_pk_bf16_f32 v66, v124, v125
    v_cvt_pk_bf16_f32 v67, v126, v127
    v_cvt_pk_bf16_f32 v68, v128, v129
    v_cvt_pk_bf16_f32 v69, v130, v131
    v_cvt_pk_bf16_f32 v70, v132, v133
    v_cvt_pk_bf16_f32 v71, v134, v135
    ds_write_b64 v20, v[62:63] offset:0
    ds_write_b64 v20, v[64:65] offset:8
    ds_write_b64 v20, v[66:67] offset:16
    ds_write_b64 v20, v[68:69] offset:24
    ds_write_b64 v20, v[70:71] offset:32
    s_waitcnt lgkmcnt(0)
    s_add_u32 s48, s48, 1
    s_cmp_lt_u32 s48, 2
    s_cbranch_scc1 L_pa_att
    s_add_u32 s46, s46, 1
    s_cmp_lt_u32 s46, 2
    s_cbranch_scc1 L_pa_half
    s_mov_b32 s42, 0
    s_waitcnt vmcnt(0) lgkmcnt(0)
    s_barrier
    s_mov_b32 s44, 0
    s_mov_b32 s45, 0
    s_mov_b32 s41, 0
    s_lshl_b32 s90, s32, 10
    s_add_u32 m0, s90, s45
    s_add_u32 s91, s42, 0
    buffer_load_dwordx4 v11, s[20:23], s91 offen lds
    s_add_u32 m0, m0, 4096
    s_add_u32 s91, s91, 40960
    buffer_load_dwordx4 v11, s[20:23], s91 offen lds
    s_add_u32 m0, m0, 4096
    s_add_u32 s91, s91, 40960
    buffer_load_dwordx4 v11, s[20:23], s91 offen lds
    s_add_u32 m0, m0, 4096
    s_add_u32 s91, s91, 40960
    buffer_load_dwordx4 v11, s[20:23], s91 offen lds
    s_add_u32 s45, s45, 16384
    s_cmp_eq_u32 s45, 49152
    s_cselect_b32 s45, 0, s45
    s_lshl_b32 s90, s32, 10
    s_add_u32 m0, s90, s45
    s_add_u32 s91, s42, 163840
    buffer_load_dwordx4 v11, s[20:23], s91 offen lds
    s_add_u32 m0, m0, 4096
    s_add_u32 s91, s91, 40960
    buffer_load_dwordx4 v11, s[20:23], s91 offen lds
    s_add_u32 m0, m0, 4096
    s_add_u32 s91, s91, 40960
    buffer_load_dwordx4 v11, s[20:23], s91 offen lds
    s_add_u32 m0, m0, 4096
    s_add_u32 s91, s91, 40960
    buffer_load_dwordx4 v11, s[20:23], s91 offen lds
    s_add_u32 s45, s45, 16384
    s_cmp_eq_u32 s45, 49152
    s_cselect_b32 s45, 0, s45
    ds_read_b128 a[0:3], v26 offset:0
    ds_read_b128 a[4:7], v26 offset:64
    ds_read_b128 a[8:11], v26 offset:128
    ds_read_b128 a[12:15], v26 offset:192
    ds_read_b128 a[16:19], v26 offset:256
    ds_read_b128 a[20:23], v26 offset:320
    ds_read_b128 a[24:27], v26 offset:384
    ds_read_b128 a[28:31], v26 offset:448
    ds_read_b128 a[32:35], v26 offset:512
    ds_read_b128 a[36:39], v26 offset:576
    ds_read_b128 a[40:43], v26 offset:640
    ds_read_b128 a[44:47], v26 offset:704
    ds_read_b128 a[48:51], v26 offset:768
    ds_read_b128 a[52:55], v26 offset:832
    ds_read_b128 a[56:59], v26 offset:896
    ds_read_b128 a[60:63], v26 offset:960
    ds_read_b128 a[64:67], v26 offset:1024
    ds_read_b128 a[68:71], v26 offset:1088
    ds_read_b128 a[72:75], v26 offset:1152
    ds_read_b128 a[76:79], v26 offset:1216
    ds_read_b128 a[80:83], v26 offset:20736
    ds_read_b128 a[84:87], v26 offset:20800
    ds_read_b128 a[88:91], v26 offset:20864
    ds_read_b128 a[92:95], v26 offset:20928
    ds_read_b128 a[96:99], v26 offset:20992
    ds_read_b128 a[100:103], v26 offset:21056
    ds_read_b128 a[104:107], v26 offset:21120
    ds_read_b128 a[108:111], v26 offset:21184
    ds_read_b128 a[112:115], v26 offset:21248
    ds_read_b128 a[116:119], v26 offset:21312
    ds_read_b128 a[120:123], v26 offset:21376
    ds_read_b128 a[124:127], v26 offset:21440
    ds_read_b128 a[128:131], v26 offset:21504
    ds_read_b128 a[132:135], v26 offset:21568
    ds_read_b128 a[136:139], v26 offset:21632
    ds_read_b128 a[140:143], v26 offset:21696
    ds_read_b128 a[144:147], v26 offset:21760
    ds_read_b128 a[148:151], v26 offset:21824
    ds_read_b128 a[152:155], v26 offset:21888
    ds_read_b128 a[156:159], v26 offset:21952
    s_waitcnt lgkmcnt(0)
L_pa_oblk:
    s_add_u32 s43, s42, 128
    s_cmp_eq_u32 s41, 9
    s_cselect_b32 s43, s42, s43
    v_add_u32 v13, s44, v12
    s_waitcnt vmcnt(4)
    s_barrier
    ds_read_b64_tr_b16 v[28:29], v13 offset:0
    ds_read_b64_tr_b16 v[30:31], v13 offset:512
    ds_read_b64_tr_b16 v[32:33], v13 offset:4096
    ds_read_b64_tr_b16 v[34:35], v13 offset:4608
    ds_read_b64_tr_b16 v[36:37], v13 offset:8192
    ds_read_b64_tr_b16 v[38:39], v13 offset:8704
    ds_read_b64_tr_b16 v[40:41], v13 offset:12288
    ds_read_b64_tr_b16 v[42:43], v13 offset:12800
    s_lshl_b32 s90, s32, 10
    s_add_u32 m0, s90, s45
    s_add_u32 s91, s42, 327680
    buffer_load_dwordx4 v11, s[20:23], s91 offen lds
    s_add_u32 m0, m0, 4096
    s_add_u32 s91, s91, 40960
    buffer_load_dwordx4 v11, s[20:23], s91 offen lds
    s_add_u32 m0, m0, 4096
    s_add_u32 s91, s91, 40960
    buffer_load_dwordx4 v11, s[20:23], s91 offen lds
    s_add_u32 m0, m0, 4096
    s_add_u32 s91, s91, 40960
    buffer_load_dwordx4 v11, s[20:23], s91 offen lds
    s_add_u32 s45, s45, 16384
    s_cmp_eq_u32 s45, 49152
    s_cselect_b32 s45, 0, s45
    s_add_u32 s44, s44, 16384
    s_cmp_eq_u32 s44, 49152
    s_cselect_b32 s44, 0, s44
    s_waitcnt lgkmcnt(6)
    v_mfma_f32_16x16x32_bf16 v[44:47], v[28:31], a[0:3], 0
    v_mfma_f32_16x16x32_bf16 v[48:51], v[28:31], a[80:83], 0
    s_waitcnt lgkmcnt(4)
    v_mfma_f32_16x16x32_bf16 v[44:47], v[32:35], a[4:7], v[44:47]
    v_mfma_f32_16x16x32_bf16 v[48:51], v[32:35], a[84:87], v[48:51]
    s_waitcnt lgkmcnt(2)
    v_mfma_f32_16x16x32_bf16 v[44:47], v[36:39], a[8:11], v[44:47]
    v_mfma_f32_16x16x32_bf16 v[48:51], v[36:39], a[88:91], v[48:51]
    s_waitcnt lgkmcnt(0)
    v_mfma_f32_16x16x32_bf16 v[44:47], v[40:43], a[12:15], v[44:47]
    v_mfma_f32_16x16x32_bf16 v[48:51], v[40:43], a[92:95], v[48:51]
    v_add_u32 v13, s44, v12
    s_waitcnt vmcnt(4)
    s_barrier
    ds_read_b64_tr_b16 v[28:29], v13 offset:0
    ds_read_b64_tr_b16 v[30:31], v13 offset:512
    ds_read_b64_tr_b16 v[32:33], v13 offset:4096
    ds_read_b64_tr_b16 v[34:35], v13 offset:4608
    ds_read_b64_tr_b16 v[36:37], v13 offset:8192
    ds_read_b64_tr_b16 v[38:39], v13 offset:8704
    ds_read_b64_tr_b16 v[40:41], v13 offset:12288
    ds_read_b64_tr_b16 v[42:43], v13 offset:12800
    s_lshl_b32 s90, s32, 10
    s_add_u32 m0, s90, s45
    s_add_u32 s91, s42, 491520
    buffer_load_dwordx4 v11, s[20:23], s91 offen lds
    s_add_u32 m0, m0, 4096
    s_add_u32 s91, s91, 40960
    buffer_load_dwordx4 v11, s[20:23], s91 offen lds
    s_add_u32 m0, m0, 4096
    s_add_u32 s91, s91, 40960
    buffer_load_dwordx4 v11, s[20:23], s91 offen lds
    s_add_u32 m0, m0, 4096
    s_add_u32 s91, s91, 40960
    buffer_load_dwordx4 v11, s[20:23], s91 offen lds
    s_add_u32 s45, s45, 16384
    s_cmp_eq_u32 s45, 49152
    s_cselect_b32 s45, 0, s45
    s_add_u32 s44, s44, 16384
    s_cmp_eq_u32 s44, 49152
    s_cselect_b32 s44, 0, s44
    s_waitcnt lgkmcnt(6)
    v_mfma_f32_16x16x32_bf16 v[44:47], v[28:31], a[16:19], v[44:47]
    v_mfma_f32_16x16x32_bf16 v[48:51], v[28:31], a[96:99], v[48:51]
    s_waitcnt lgkmcnt(4)
    v_mfma_f32_16x16x32_bf16 v[44:47], v[32:35], a[20:23], v[44:47]
    v_mfma_f32_16x16x32_bf16 v[48:51], v[32:35], a[100:103], v[48:51]
    s_waitcnt lgkmcnt(2)
    v_mfma_f32_16x16x32_bf16 v[44:47], v[36:39], a[24:27], v[44:47]
    v_mfma_f32_16x16x32_bf16 v[48:51], v[36:39], a[104:107], v[48:51]
    s_waitcnt lgkmcnt(0)
    v_mfma_f32_16x16x32_bf16 v[44:47], v[40:43], a[28:31], v[44:47]
    v_mfma_f32_16x16x32_bf16 v[48:51], v[40:43], a[108:111], v[48:51]
    v_add_u32 v13, s44, v12
    s_waitcnt vmcnt(4)
    s_barrier
    ds_read_b64_tr_b16 v[28:29], v13 offset:0
    ds_read_b64_tr_b16 v[30:31], v13 offset:512
    ds_read_b64_tr_b16 v[32:33], v13 offset:4096
    ds_read_b64_tr_b16 v[34:35], v13 offset:4608
    ds_read_b64_tr_b16 v[36:37], v13 offset:8192
    ds_read_b64_tr_b16 v[38:39], v13 offset:8704
    ds_read_b64_tr_b16 v[40:41], v13 offset:12288
    ds_read_b64_tr_b16 v[42:43], v13 offset:12800
    s_lshl_b32 s90, s32, 10
    s_add_u32 m0, s90, s45
    s_add_u32 s91, s42, 655360
    buffer_load_dwordx4 v11, s[20:23], s91 offen lds
    s_add_u32 m0, m0, 4096
    s_add_u32 s91, s91, 40960
    buffer_load_dwordx4 v11, s[20:23], s91 offen lds
    s_add_u32 m0, m0, 4096
    s_add_u32 s91, s91, 40960
    buffer_load_dwordx4 v11, s[20:23], s91 offen lds
    s_add_u32 m0, m0, 4096
    s_add_u32 s91, s91, 40960
    buffer_load_dwordx4 v11, s[20:23], s91 offen lds
    s_add_u32 s45, s45, 16384
    s_cmp_eq_u32 s45, 49152
    s_cselect_b32 s45, 0, s45
    s_add_u32 s44, s44, 16384
    s_cmp_eq_u32 s44, 49152
    s_cselect_b32 s44, 0, s44
    s_waitcnt lgkmcnt(6)
    v_mfma_f32_16x16x32_bf16 v[44:47], v[28:31], a[32:35], v[44:47]
    v_mfma_f32_16x16x32_bf16 v[48:51], v[28:31], a[112:115], v[48:51]
    s_waitcnt lgkmcnt(4)
    v_mfma_f32_16x16x32_bf16 v[44:47], v[32:35], a[36:39], v[44:47]
    v_mfma_f32_16x16x32_bf16 v[48:51], v[32:35], a[116:119], v[48:51]
    s_waitcnt lgkmcnt(2)
    v_mfma_f32_16x16x32_bf16 v[44:47], v[36:39], a[40:43], v[44:47]
    v_mfma_f32_16x16x32_bf16 v[48:51], v[36:39], a[120:123], v[48:51]
    s_waitcnt lgkmcnt(0)
    v_mfma_f32_16x16x32_bf16 v[44:47], v[40:43], a[44:47], v[44:47]
    v_mfma_f32_16x16x32_bf16 v[48:51], v[40:43], a[124:127], v[48:51]
    v_add_u32 v13, s44, v12
    s_waitcnt vmcnt(4)
    s_barrier
    ds_read_b64_tr_b16 v[28:29], v13 offset:0
    ds_read_b64_tr_b16 v[30:31], v13 offset:512
    ds_read_b64_tr_b16 v[32:33], v13 offset:4096
    ds_read_b64_tr_b16 v[34:35], v13 offset:4608
    ds_read_b64_tr_b16 v[36:37], v13 offset:8192
    ds_read_b64_tr_b16 v[38:39], v13 offset:8704
    ds_read_b64_tr_b16 v[40:41], v13 offset:12288
    ds_read_b64_tr_b16 v[42:43], v13 offset:12800
    s_lshl_b32 s90, s32, 10
    s_add_u32 m0, s90, s45
    s_add_u32 s91, s43, 0
    buffer_load_dwordx4 v11, s[20:23], s91 offen lds
    s_add_u32 m0, m0, 4096
    s_add_u32 s91, s91, 40960
    buffer_load_dwordx4 v11, s[20:23], s91 offen lds
    s_add_u32 m0, m0, 4096
    s_add_u32 s91, s91, 40960
    buffer_load_dwordx4 v11, s[20:23], s91 offen lds
    s_add_u32 m0, m0, 4096
    s_add_u32 s91, s91, 40960
    buffer_load_dwordx4 v11, s[20:23], s91 offen lds
    s_add_u32 s45, s45, 16384
    s_cmp_eq_u32 s45, 49152
    s_cselect_b32 s45, 0, s45
    s_add_u32 s44, s44, 16384
    s_cmp_eq_u32 s44, 49152
    s_cselect_b32 s44, 0, s44
    s_waitcnt lgkmcnt(6)
    v_mfma_f32_16x16x32_bf16 v[44:47], v[28:31], a[48:51], v[44:47]
    v_mfma_f32_16x16x32_bf16 v[48:51], v[28:31], a[128:131], v[48:51]
    s_waitcnt lgkmcnt(4)
    v_mfma_f32_16x16x32_bf16 v[44:47], v[32:35], a[52:55], v[44:47]
    v_mfma_f32_16x16x32_bf16 v[48:51], v[32:35], a[132:135], v[48:51]
    s_waitcnt lgkmcnt(2)
    v_mfma_f32_16x16x32_bf16 v[44:47], v[36:39], a[56:59], v[44:47]
    v_mfma_f32_16x16x32_bf16 v[48:51], v[36:39], a[136:139], v[48:51]
    s_waitcnt lgkmcnt(0)
    v_mfma_f32_16x16x32_bf16 v[44:47], v[40:43], a[60:63], v[44:47]
    v_mfma_f32_16x16x32_bf16 v[48:51], v[40:43], a[140:143], v[48:51]
    v_add_u32 v13, s44, v12
    s_waitcnt vmcnt(4)
    s_barrier
    ds_read_b64_tr_b16 v[28:29], v13 offset:0
    ds_read_b64_tr_b16 v[30:31], v13 offset:512
    ds_read_b64_tr_b16 v[32:33], v13 offset:4096
    ds_read_b64_tr_b16 v[34:35], v13 offset:4608
    ds_read_b64_tr_b16 v[36:37], v13 offset:8192
    ds_read_b64_tr_b16 v[38:39], v13 offset:8704
    ds_read_b64_tr_b16 v[40:41], v13 offset:12288
    ds_read_b64_tr_b16 v[42:43], v13 offset:12800
    s_lshl_b32 s90, s32, 10
    s_add_u32 m0, s90, s45
    s_add_u32 s91, s43, 163840
    buffer_load_dwordx4 v11, s[20:23], s91 offen lds
    s_add_u32 m0, m0, 4096
    s_add_u32 s91, s91, 40960
    buffer_load_dwordx4 v11, s[20:23], s91 offen lds
    s_add_u32 m0, m0, 4096
    s_add_u32 s91, s91, 40960
    buffer_load_dwordx4 v11, s[20:23], s91 offen lds
    s_add_u32 m0, m0, 4096
    s_add_u32 s91, s91, 40960
    buffer_load_dwordx4 v11, s[20:23], s91 offen lds
    s_add_u32 s45, s45, 16384
    s_cmp_eq_u32 s45, 49152
    s_cselect_b32 s45, 0, s45
    s_add_u32 s44, s44, 16384
    s_cmp_eq_u32 s44, 49152
    s_cselect_b32 s44, 0, s44
    s_waitcnt lgkmcnt(6)
    v_mfma_f32_16x16x32_bf16 v[44:47], v[28:31], a[64:67], v[44:47]
    v_mfma_f32_16x16x32_bf16 v[48:51], v[28:31], a[144:147], v[48:51]
    s_waitcnt lgkmcnt(4)
    v_mfma_f32_16x16x32_bf16 v[44:47], v[32:35], a[68:71], v[44:47]
    v_mfma_f32_16x16x32_bf16 v[48:51], v[32:35], a[148:151], v[48:51]
    s_waitcnt lgkmcnt(2)
    v_mfma_f32_16x16x32_bf16 v[44:47], v[36:39], a[72:75], v[44:47]
    v_mfma_f32_16x16x32_bf16 v[48:51], v[36:39], a[152:155], v[48:51]
    s_waitcnt lgkmcnt(0)
    v_mfma_f32_16x16x32_bf16 v[44:47], v[40:43], a[76:79], v[44:47]
    v_mfma_f32_16x16x32_bf16 v[48:51], v[40:43], a[156:159], v[48:51]
    s_nop 4
    v_cvt_pk_bf16_f32 v56, v44, v45
    v_cvt_pk_bf16_f32 v57, v46, v47
    s_nop 0
    v_cvt_pk_bf16_f32 v58, v48, v49
    v_cvt_pk_bf16_f32 v59, v50, v51
    s_nop 0
    v_permlane16_swap_b32 v56, v58
    v_permlane16_swap_b32 v57, v59
    buffer_store_dwordx4 v[56:59], v17, s[28:31], s42 offen
    s_mov_b32 s42, s43
    s_add_u32 s41, s41, 1
    s_cmp_lt_u32 s41, 10
    s_cbranch_scc1 L_pa_oblk
    s_waitcnt vmcnt(0)
    s_endpgm
L_slow:
    s_waitcnt vmcnt(0) lgkmcnt(0)
    s_barrier
    s_and_b32 s34, s2, 7
    s_lshr_b32 s35, s2, 3
    s_add_u32 s4, s88, 33554432
    s_addc_u32 s5, s89, 0
    s_and_b32 s5, s5, 0xffff
    s_cmp_lg_u32 s32, 0
    s_cbranch_scc1 L_slow_go
    v_mov_b32 v240, -1
    v_mov_b32 v241, -1
    v_mov_b32 v242, -1
    v_mov_b32 v243, -1
    v_mov_b32 v244, 0
    v_lshlrev_b32 v4, 4, v0
    v_lshlrev_b32 v5, 2, v0
    s_mul_i32 s91, s2, 2560
    s_and_b32 s92, s2, 7
    s_lshl_b32 s92, s92, 21
    s_add_u32 s92, s92, 8388608
    s_lshr_b32 s93, s2, 3
    s_lshl_b32 s40, s93, 7
    s_add_u32 s40, s40, s92
    s_add_u32 s40, s40, 458752
    s_lshr_b32 s41, s93, 4
    s_mul_i32 s41, s41, 114688
    s_add_u32 s92, s92, s41
    s_and_b32 s93, s93, 15
    s_mul_i32 s93, s93, 2560
    s_add_u32 s92, s92, s93
    buffer_store_dwordx4 v[240:243], v4, s[4:7], s91 offen sc1
    buffer_store_dwordx4 v[240:243], v4, s[4:7], s91 offen offset:1024 sc1
    buffer_store_dword v240, v5, s[4:7], s91 offen offset:2048 sc1
    buffer_store_dword v240, v5, s[4:7], s91 offen offset:2304 sc1
    buffer_store_dwordx4 v[240:243], v4, s[4:7], s92 offen sc1
    buffer_store_dwordx4 v[240:243], v4, s[4:7], s92 offen offset:1024 sc1
    buffer_store_dword v240, v5, s[4:7], s92 offen offset:2048 sc1
    buffer_store_dword v240, v5, s[4:7], s92 offen offset:2304 sc1
    s_mov_b64 exec, 0xffffffff
    buffer_store_dword v244, v5, s[4:7], s40 offen sc1
    s_mov_b64 exec, -1
    s_waitcnt vmcnt(0)
    v_mov_b32 v1, 68
    v_mov_b32 v4, 1
    s_mov_b64 exec, 1
    buffer_atomic_add v4, v1, s[8:11], 0 offen sc1
    s_mov_b64 exec, -1
L_slow_go:
    s_lshl_b32 s38, s34, 21
    s_add_u32 s38, s38, 8388608
    s_cmp_lt_u32 s35, 12
    s_cbranch_scc1 L_qkv_s
    s_cmp_lt_u32 s35, 22
    s_cbranch_scc1 L_wo_s
    s_cmp_lt_u32 s35, 24
    s_cbranch_scc1 L_px_s
    s_branch L_pa_s
L_qkv_s:
    s_mov_b32 s12, s74
    s_and_b32 s13, s75, 0xffff
    s_mov_b32 s14, 7864320
    s_mov_b32 s15, 0x20000
    s_mov_b32 s16, s76
    s_and_b32 s17, s77, 0xffff
    s_mov_b32 s18, 7864320
    s_mov_b32 s19, 0x20000
    s_mov_b32 s20, s78
    s_and_b32 s21, s79, 0xffff
    s_mov_b32 s22, 7864320
    s_mov_b32 s23, 0x20000
    s_mov_b32 s24, s70
    s_and_b32 s25, s71, 0xffff
    s_mov_b32 s26, 2621440
    s_mov_b32 s27, 0x20000
    s_mul_i32 s40, s35, 86
    s_lshr_b32 s40, s40, 8
    s_mul_i32 s90, s40, 3
    s_sub_u32 s41, s35, s90
    v_and_b32 v1, 15, v0
    v_lshrrev_b32 v2, 4, v0
    v_lshrrev_b32 v3, 3, v0
    v_and_b32 v4, 7, v0
    s_lshl_b32 s90, s32, 3
    v_add_u32 v5, s90, v3
    s_and_b32 s91, s32, 1
    s_lshl_b32 s91, s91, 2
    v_and_b32 v6, 2, v3
    v_or_b32 v6, s91, v6
    v_xor_b32 v6, v6, v4
    v_lshlrev_b32 v6, 4, v6
    v_mul_u32_u24 v7, 12288, v5
    s_lshl_b32 s92, s34, 2
    s_add_u32 s92, s92, s40
    s_mul_i32 s92, s92, 384
    s_lshl_b32 s93, s41, 7
    s_add_u32 s92, s92, s93
    v_add3_u32 v164, v6, v7, s92
    v_lshrrev_b32 v6, 1, v3
    v_or_b32 v6, s91, v6
    v_xor_b32 v6, v6, v4
    v_lshlrev_b32 v6, 4, v6
    v_mul_u32_u24 v7, 1280, v5
    v_add_u32 v10, v6, v7
    s_lshl_b32 s90, s32, 10
    s_add_u32 m0, s90, 40960
    s_mov_b32 s91, 0
    buffer_load_dwordx4 v164, s[20:23], s91 offen nt lds
    s_add_u32 m0, m0, 4096
    s_add_u32 s91, s91, 393216
    buffer_load_dwordx4 v164, s[20:23], s91 offen nt lds
    s_add_u32 m0, m0, 4096
    s_add_u32 s91, s91, 393216
    buffer_load_dwordx4 v164, s[20:23], s91 offen nt lds
    s_add_u32 m0, m0, 4096
    s_add_u32 s91, s91, 393216
    buffer_load_dwordx4 v164, s[20:23], s91 offen nt lds
    s_add_u32 m0, m0, 4096
    s_add_u32 s91, s91, 393216
    buffer_load_dwordx4 v164, s[20:23], s91 offen nt lds
    s_add_u32 m0, m0, 4096
    s_add_u32 s91, s91, 393216
    buffer_load_dwordx4 v164, s[20:23], s91 offen nt lds
    s_add_u32 m0, m0, 4096
    s_add_u32 s91, s91, 393216
    buffer_load_dwordx4 v164, s[20:23], s91 offen nt lds
    s_add_u32 m0, m0, 4096
    s_add_u32 s91, s91, 393216
    buffer_load_dwordx4 v164, s[20:23], s91 offen nt lds
    s_add_u32 m0, m0, 4096
    s_add_u32 s91, s91, 393216
    buffer_load_dwordx4 v164, s[20:23], s91 offen nt lds
    s_add_u32 m0, m0, 4096
    s_add_u32 s91, s91, 393216
    buffer_load_dwordx4 v164, s[20:23], s91 offen nt lds
    s_lshl_b32 s90, s32, 10
    s_add_u32 m0, s90, 81920
    s_mov_b32 s91, 3932160
    buffer_load_dwordx4 v164, s[20:23], s91 offen nt lds
    s_add_u32 m0, m0, 4096
    s_add_u32 s91, s91, 393216
    buffer_load_dwordx4 v164, s[20:23], s91 offen nt lds
    s_add_u32 m0, m0, 4096
    s_add_u32 s91, s91, 393216
    buffer_load_dwordx4 v164, s[20:23], s91 offen nt lds
    s_add_u32 m0, m0, 4096
    s_add_u32 s91, s91, 393216
    buffer_load_dwordx4 v164, s[20:23], s91 offen nt lds
    s_add_u32 m0, m0, 4096
    s_add_u32 s91, s91, 393216
    buffer_load_dwordx4 v164, s[20:23], s91 offen nt lds
    s_add_u32 m0, m0, 4096
    s_add_u32 s91, s91, 393216
    buffer_load_dwordx4 v164, s[20:23], s91 offen nt lds
    s_add_u32 m0, m0, 4096
    s_add_u32 s91, s91, 393216
    buffer_load_dwordx4 v164, s[20:23], s91 offen nt lds
    s_add_u32 m0, m0, 4096
    s_add_u32 s91, s91, 393216
    buffer_load_dwordx4 v164, s[20:23], s91 offen nt lds
    s_add_u32 m0, m0, 4096
    s_add_u32 s91, s91, 393216
    buffer_load_dwordx4 v164, s[20:23], s91 offen nt lds
    s_add_u32 m0, m0, 4096
    s_add_u32 s91, s91, 393216
    buffer_load_dwordx4 v164, s[20:23], s91 offen nt lds
    s_lshl_b32 s90, s32, 10
    s_add_u32 m0, s90, 122880
    s_mov_b32 s91, 0
    buffer_load_dwordx4 v164, s[16:19], s91 offen nt lds
    s_add_u32 m0, m0, 4096
    s_add_u32 s91, s91, 393216
    buffer_load_dwordx4 v164, s[16:19], s91 offen nt lds
    s_add_u32 m0, m0, 4096
    s_add_u32 s91, s91, 393216
    buffer_load_dwordx4 v164, s[16:19], s91 offen nt lds
    s_add_u32 m0, m0, 4096
    s_add_u32 s91, s91, 393216
    buffer_load_dwordx4 v164, s[16:19], s91 offen nt lds
    s_add_u32 m0, m0, 4096
    s_add_u32 s91, s91, 393216
    buffer_load_dwordx4 v164, s[16:19], s91 offen nt lds
    s_add_u32 m0, m0, 4096
    s_add_u32 s91, s91, 393216
    buffer_load_dwordx4 v164, s[16:19], s91 offen nt lds
    s_add_u32 m0, m0, 4096
    s_add_u32 s91, s91, 393216
    buffer_load_dwordx4 v164, s[16:19], s91 offen nt lds
    s_add_u32 m0, m0, 4096
    s_add_u32 s91, s91, 393216
    buffer_load_dwordx4 v164, s[16:19], s91 offen nt lds
    s_add_u32 m0, m0, 4096
    s_add_u32 s91, s91, 393216
    buffer_load_dwordx4 v164, s[16:19], s91 offen nt lds
    s_add_u32 m0, m0, 4096
    s_add_u32 s91, s91, 393216
    buffer_load_dwordx4 v164, s[16:19], s91 offen nt lds
    s_mov_b32 s46, 0
    s_lshl_b32 s90, s32, 10
    s_add_u32 m0, s90, 0
    s_nop 0
    buffer_load_dwordx4 v10, s[24:27], s46 offen offset:0 lds
    s_add_u32 m0, m0, 3968
    s_nop 0
    buffer_load_dwordx4 v10, s[24:27], s46 offen offset:128 lds
    s_add_u32 m0, m0, 3968
    s_nop 0
    buffer_load_dwordx4 v10, s[24:27], s46 offen offset:256 lds
    s_add_u32 m0, m0, 3968
    s_nop 0
    buffer_load_dwordx4 v10, s[24:27], s46 offen offset:384 lds
    s_add_u32 m0, m0, 3968
    s_nop 0
    buffer_load_dwordx4 v10, s[24:27], s46 offen offset:512 lds
    s_add_u32 m0, m0, 3968
    s_nop 0
    buffer_load_dwordx4 v10, s[24:27], s46 offen offset:640 lds
    s_add_u32 m0, m0, 3968
    s_nop 0
    buffer_load_dwordx4 v10, s[24:27], s46 offen offset:768 lds
    s_add_u32 m0, m0, 3968
    s_nop 0
    buffer_load_dwordx4 v10, s[24:27], s46 offen offset:896 lds
    s_add_u32 m0, m0, 3968
    s_nop 0
    buffer_load_dwordx4 v10, s[24:27], s46 offen offset:1024 lds
    s_add_u32 m0, m0, 3968
    s_nop 0
    buffer_load_dwordx4 v10, s[24:27], s46 offen offset:1152 lds
    s_mul_i32 s90, s40, 3072
    s_lshl_b32 s91, s41, 10
    s_add_u32 s90, s90, s91
    s_lshl_b32 s91, s32, 8
    s_add_u32 s91, s91, s90
    s_add_u32 s91, s91, 25600
    v_lshl_add_u32 v226, v0, 2, s91
    v_lshl_add_u32 v21, v1, 4, s91
    v_cmp_eq_u32 vcc, 0, v2
    v_mov_b32 v9, 2146435072
    s_nop 0
    v_cndmask_b32 v21, v9, v21, vcc
    v_lshrrev_b32 v3, 2, v1
    v_lshlrev_b32 v3, 1, v3
    v_and_b32 v4, 1, v1
    v_or_b32 v3, v3, v4
    v_lshl_add_u32 v3, v2, 3, v3
    v_lshl_add_u32 v26, v3, 4, s90
    v_and_b32 v4, 2, v1
    v_cmp_ne_u32 vcc, 0, v4
    v_mov_b32 v9, 2146435072
    s_nop 0
    v_cndmask_b32 v26, v9, v26, vcc
    s_mul_i32 s90, s40, 3840
    s_mul_i32 s91, s41, 1280
    s_add_u32 s90, s90, s91
    s_add_u32 s90, s90, 10240
    v_lshrrev_b32 v3, 1, v2
    v_and_b32 v5, 1, v2
    v_lshlrev_b32 v6, 1, v5
    v_or_b32 v7, v6, v3
    v_lshl_add_u32 v7, v7, 4, v1
    v_lshlrev_b32 v7, 2, v7
    v_add_u32 v7, 1024, v7
    v_or_b32 v6, v6, v1
    v_lshl_add_u32 v6, v3, 4, v6
    v_lshlrev_b32 v6, 4, v6
    s_sub_u32 s91, s32, 1
    s_lshl_b32 s91, s91, 9
    v_add_u32 v6, s91, v6
    s_cmp_eq_u32 s32, 0
    s_cselect_b64 vcc, -1, 0
    v_cndmask_b32 v6, v6, v7, vcc
    v_add_u32 v25, s90, v6
    s_lshl_b32 s91, s32, 8
    s_add_u32 s91, s91, s90
    v_lshl_add_u32 v227, v0, 2, s91
    v_cmp_eq_u32 vcc, 0, v4
    v_mov_b32 v9, 2146435072
    s_nop 0
    v_cndmask_b32 v25, v9, v25, vcc
    s_and_b32 s90, s32, 1
    s_lshl_b32 s90, s90, 9
    s_lshr_b32 s91, s32, 1
    s_lshl_b32 s91, s91, 10
    s_add_u32 s90, s90, s91
    v_lshlrev_b32 v6, 4, v1
    v_lshl_add_u32 v6, v3, 8, v6
    v_add_u32 v6, s90, v6
    v_lshl_add_u32 v27, v5, 11, v6
    v_add_u32 v27, 136192, v27
    s_mul_i32 s90, s40, 12288
    s_lshl_b32 s91, s41, 11
    s_add_u32 s90, s90, s91
    v_mul_u32_u24 v7, 6144, v5
    v_add3_u32 v29, v6, v7, s90
    v_and_b32 v6, 9, v1
    v_and_b32 v7, 2, v1
    v_lshl_or_b32 v6, v7, 1, v6
    v_and_b32 v7, 4, v1
    v_lshrrev_b32 v7, 1, v7
    v_or_b32 v6, v6, v7
    v_lshlrev_b32 v6, 4, v6
    v_lshl_add_u32 v6, v2, 8, v6
    s_cmp_eq_u32 s32, 2
    s_cselect_b32 s90, 2048, 0
    s_add_u32 s90, s90, 136192
    v_add_u32 v28, s90, v6
    s_lshl_b32 s90, s40, 7
    s_lshl_b32 s91, s41, 2
    s_add_u32 s92, s91, s32
    s_lshl_b32 s92, s92, 2
    s_add_u32 s92, s92, s90
    s_add_u32 s92, s92, 458752
    v_mov_b32 v30, s92
    s_add_u32 s91, s91, s90
    s_add_u32 s91, s91, 459264
    s_cmp_eq_u32 s32, 3
    s_cselect_b32 s91, s91, 2146435072
    v_mov_b32 v31, s91
    v_cmp_eq_u32 vcc, 0, v0
    v_mov_b32 v9, 2146435072
    s_nop 0
    v_cndmask_b32 v30, v9, v30, vcc
    v_cndmask_b32 v220, 1, 3, vcc
    v_cmp_eq_u32 vcc, 1, v0
    v_add_u32 v225, 3072, v31
    s_nop 0
    v_cndmask_b32 v225, v9, v225, vcc
    v_cndmask_b32 v31, v30, v31, vcc
    v_mov_b32 v36, -1
    v_mov_b32 v37, -1
    v_mov_b32 v38, -1
    v_mov_b32 v39, -1
    s_mul_i32 s90, s35, 32768
    s_lshl_b32 s91, s32, 11
    s_add_u32 s90, s90, s91
    s_lshl_b32 s92, s35, 10
    s_lshl_b32 s91, s32, 8
    s_add_u32 s92, s92, s91
    s_cmp_lt_u32 s35, 10
    s_cselect_b32 s90, s90, 2146435072
    s_cselect_b32 s92, s92, 2146435072
    v_lshl_add_u32 v214, v0, 4, s90
    v_add_u32 v215, 1024, v214
    s_min_u32 s90, s35, 9
    s_lshl_b32 s90, s90, 7
    s_add_u32 s90, s90, 460800
    v_and_b32 v3, 3, v0
    v_lshl_add_u32 v216, v3, 2, s90
    v_lshl_add_u32 v219, v0, 2, s92
    v_lshl_add_u32 v218, v1, 4, s92
    v_cmp_eq_u32 vcc, 0, v2
    v_mov_b32 v9, 2146435072
    s_nop 0
    v_cndmask_b32 v218, v9, v218, vcc
    v_and_b32 v7, 1, v1
    v_cmp_ne_u32 vcc, 0, v7
    v_mov_b32 v5, 0x3f80
    v_mov_b32 v6, 0x3f800000
    v_cndmask_b32 v5, v5, v6, vcc
    v_bfe_u32 v6, v1, 1, 1
    v_cmp_eq_u32 vcc, 0, v6
    s_nop 1
    v_cndmask_b32 v210, 0, v5, vcc
    v_mov_b32 v208, 0
    v_mov_b32 v212, 0
    v_cmp_eq_u32 vcc, 1, v6
    s_nop 1
    v_cndmask_b32 v211, 0, v5, vcc
    v_mov_b32 v209, 0
    v_mov_b32 v213, 0
    v_lshrrev_b32 v3, 2, v1
    v_and_b32 v4, 3, v1
    v_and_b32 v5, 1, v2
    v_lshl_add_u32 v6, v2, 3, v3
    v_lshlrev_b32 v6, 7, v6
    v_and_b32 v7, 2, v3
    v_lshl_or_b32 v7, v5, 2, v7
    v_lshrrev_b32 v8, 1, v4
    s_lshl_b32 s90, s32, 1
    v_or_b32 v8, s90, v8
    v_xor_b32 v7, v7, v8
    v_lshl_add_u32 v6, v7, 4, v6
    v_and_b32 v7, 1, v4
    v_lshl_add_u32 v6, v7, 3, v6
    v_add_u32 v165, 40960, v6
    v_add_u32 v166, 81920, v6
    v_add_u32 v167, 122880, v6
    v_xor_b32 v6, 0, v5
    v_lshl_add_u32 v6, v6, 2, v3
    v_lshl_add_u32 v6, v2, 3, v6
    v_lshlrev_b32 v6, 5, v6
    v_lshl_or_b32 v7, v5, 1, 0
    v_xor_b32 v7, v7, v4
    v_lshl_add_u32 v6, v7, 3, v6
    v_add_u32 v23, 133120, v6
    v_xor_b32 v6, 1, v5
    v_lshl_add_u32 v6, v6, 2, v3
    v_lshl_add_u32 v6, v2, 3, v6
    v_lshlrev_b32 v6, 5, v6
    v_lshl_or_b32 v7, v5, 1, 1
    v_xor_b32 v7, v7, v4
    v_lshl_add_u32 v6, v7, 3, v6
    v_add_u32 v24, 133120, v6
    v_lshrrev_b32 v6, 3, v1
    v_lshlrev_b32 v6, 2, v6
    v_xor_b32 v6, v6, v1
    v_lshlrev_b32 v6, 5, v6
    v_xor_b32 v7, v2, v3
    v_lshl_add_u32 v6, v7, 3, v6
    s_lshl_b32 s90, s32, 9
    s_add_u32 s90, s90, 133120
    v_add_u32 v22, s90, v6
    v_lshlrev_b32 v6, 6, v3
    v_and_b32 v7, 1, v1
    v_lshl_add_u32 v6, v7, 5, v6
    v_lshl_add_u32 v6, v2, 3, v6
    v_and_b32 v7, 2, v1
    v_lshl_add_u32 v6, v7, 1, v6
    s_lshl_b32 s90, s32, 8
    s_add_u32 s90, s90, 135168
    v_add_u32 v19, s90, v6
    v_lshl_add_u32 v20, v1, 3, s90
    v_cmp_ne_u32 vcc, 0, v7
    v_mov_b32 v6, 0x4444
    v_mov_b32 v8, 0xeeee
    v_cndmask_b32 v18, v6, v8, vcc
    v_lshlrev_b32 v6, 4, v0
    v_add_u32 v16, 122880, v6
    s_mul_i32 s90, s32, 2560
    v_lshl_add_u32 v13, v0, 4, s90
    v_lshl_add_u32 v14, v0, 2, s90
    s_add_u32 s48, s90, 122880
    v_mul_u32_u24 v6, 40, v0
    v_add_u32 v15, s48, v6
    v_lshrrev_b32 v6, 3, v1
    v_lshlrev_b32 v6, 10, v6
    v_and_b32 v7, 7, v1
    v_lshl_add_u32 v6, v7, 7, v6
    v_lshrrev_b32 v7, 1, v1
    v_xor_b32 v7, v7, v2
    v_lshl_add_u32 v11, v7, 4, v6
    v_xor_b32 v12, 64, v11
    s_waitcnt vmcnt(30)
    s_barrier
    ds_read_b64_tr_b16 a[160:161], v165 offset:0
    ds_read_b64_tr_b16 a[162:163], v165 offset:512
    ds_read_b64_tr_b16 a[164:165], v165 offset:4096
    ds_read_b64_tr_b16 a[166:167], v165 offset:4608
    ds_read_b64_tr_b16 a[168:169], v165 offset:8192
    ds_read_b64_tr_b16 a[170:171], v165 offset:8704
    ds_read_b64_tr_b16 a[172:173], v165 offset:12288
    ds_read_b64_tr_b16 a[174:175], v165 offset:12800
    ds_read_b64_tr_b16 a[176:177], v165 offset:16384
    ds_read_b64_tr_b16 a[178:179], v165 offset:16896
    ds_read_b64_tr_b16 a[180:181], v165 offset:20480
    ds_read_b64_tr_b16 a[182:183], v165 offset:20992
    ds_read_b64_tr_b16 a[184:185], v165 offset:24576
    ds_read_b64_tr_b16 a[186:187], v165 offset:25088
    ds_read_b64_tr_b16 a[188:189], v165 offset:28672
    ds_read_b64_tr_b16 a[190:191], v165 offset:29184
    ds_read_b64_tr_b16 a[192:193], v165 offset:32768
    ds_read_b64_tr_b16 a[194:195], v165 offset:33280
    ds_read_b64_tr_b16 a[196:197], v165 offset:36864
    ds_read_b64_tr_b16 a[198:199], v165 offset:37376
    s_waitcnt lgkmcnt(0)
    s_barrier
    s_lshl_b32 s90, s32, 10
    s_add_u32 m0, s90, 40960
    s_mov_b32 s91, 3932160
    buffer_load_dwordx4 v164, s[16:19], s91 offen nt lds
    s_add_u32 m0, m0, 4096
    s_add_u32 s91, s91, 393216
    buffer_load_dwordx4 v164, s[16:19], s91 offen nt lds
    s_add_u32 m0, m0, 4096
    s_add_u32 s91, s91, 393216
    buffer_load_dwordx4 v164, s[16:19], s91 offen nt lds
    s_add_u32 m0, m0, 4096
    s_add_u32 s91, s91, 393216
    buffer_load_dwordx4 v164, s[16:19], s91 offen nt lds
    s_add_u32 m0, m0, 4096
    s_add_u32 s91, s91, 393216
    buffer_load_dwordx4 v164, s[16:19], s91 offen nt lds
    s_add_u32 m0, m0, 4096
    s_add_u32 s91, s91, 393216
    buffer_load_dwordx4 v164, s[16:19], s91 offen nt lds
    s_add_u32 m0, m0, 4096
    s_add_u32 s91, s91, 393216
    buffer_load_dwordx4 v164, s[16:19], s91 offen nt lds
    s_add_u32 m0, m0, 4096
    s_add_u32 s91, s91, 393216
    buffer_load_dwordx4 v164, s[16:19], s91 offen nt lds
    s_add_u32 m0, m0, 4096
    s_add_u32 s91, s91, 393216
    buffer_load_dwordx4 v164, s[16:19], s91 offen nt lds
    s_add_u32 m0, m0, 4096
    s_add_u32 s91, s91, 393216
    buffer_load_dwordx4 v164, s[16:19], s91 offen nt lds
    s_waitcnt vmcnt(30)
    s_barrier
    ds_read_b64_tr_b16 a[200:201], v166 offset:0
    ds_read_b64_tr_b16 a[202:203], v166 offset:512
    ds_read_b64_tr_b16 a[204:205], v166 offset:4096
    ds_read_b64_tr_b16 a[206:207], v166 offset:4608
    ds_read_b64_tr_b16 a[208:209], v166 offset:8192
    ds_read_b64_tr_b16 a[210:211], v166 offset:8704
    ds_read_b64_tr_b16 a[212:213], v166 offset:12288
    ds_read_b64_tr_b16 a[214:215], v166 offset:12800
    ds_read_b64_tr_b16 a[216:217], v166 offset:16384
    ds_read_b64_tr_b16 a[218:219], v166 offset:16896
    ds_read_b64_tr_b16 a[220:221], v166 offset:20480
    ds_read_b64_tr_b16 a[222:223], v166 offset:20992
    ds_read_b64_tr_b16 a[224:225], v166 offset:24576
    ds_read_b64_tr_b16 a[226:227], v166 offset:25088
    ds_read_b64_tr_b16 a[228:229], v166 offset:28672
    ds_read_b64_tr_b16 a[230:231], v166 offset:29184
    ds_read_b64_tr_b16 a[232:233], v166 offset:32768
    ds_read_b64_tr_b16 a[234:235], v166 offset:33280
    ds_read_b64_tr_b16 a[236:237], v166 offset:36864
    ds_read_b64_tr_b16 a[238:239], v166 offset:37376
    s_waitcnt lgkmcnt(0)
    s_barrier
    s_lshl_b32 s90, s32, 10
    s_add_u32 m0, s90, 81920
    s_mov_b32 s91, 0
    buffer_load_dwordx4 v164, s[12:15], s91 offen nt lds
    s_add_u32 m0, m0, 4096
    s_add_u32 s91, s91, 393216
    buffer_load_dwordx4 v164, s[12:15], s91 offen nt lds
    s_add_u32 m0, m0, 4096
    s_add_u32 s91, s91, 393216
    buffer_load_dwordx4 v164, s[12:15], s91 offen nt lds
    s_add_u32 m0, m0, 4096
    s_add_u32 s91, s91, 393216
    buffer_load_dwordx4 v164, s[12:15], s91 offen nt lds
    s_add_u32 m0, m0, 4096
    s_add_u32 s91, s91, 393216
    buffer_load_dwordx4 v164, s[12:15], s91 offen nt lds
    s_add_u32 m0, m0, 4096
    s_add_u32 s91, s91, 393216
    buffer_load_dwordx4 v164, s[12:15], s91 offen nt lds
    s_add_u32 m0, m0, 4096
    s_add_u32 s91, s91, 393216
    buffer_load_dwordx4 v164, s[12:15], s91 offen nt lds
    s_add_u32 m0, m0, 4096
    s_add_u32 s91, s91, 393216
    buffer_load_dwordx4 v164, s[12:15], s91 offen nt lds
    s_add_u32 m0, m0, 4096
    s_add_u32 s91, s91, 393216
    buffer_load_dwordx4 v164, s[12:15], s91 offen nt lds
    s_add_u32 m0, m0, 4096
    s_add_u32 s91, s91, 393216
    buffer_load_dwordx4 v164, s[12:15], s91 offen nt lds
    s_waitcnt vmcnt(30)
    s_barrier
    ds_read_b64_tr_b16 a[80:81], v167 offset:0
    ds_read_b64_tr_b16 a[82:83], v167 offset:512
    ds_read_b64_tr_b16 a[84:85], v167 offset:4096
    ds_read_b64_tr_b16 a[86:87], v167 offset:4608
    ds_read_b64_tr_b16 a[88:89], v167 offset:8192
    ds_read_b64_tr_b16 a[90:91], v167 offset:8704
    ds_read_b64_tr_b16 a[92:93], v167 offset:12288
    ds_read_b64_tr_b16 a[94:95], v167 offset:12800
    ds_read_b64_tr_b16 a[96:97], v167 offset:16384
    ds_read_b64_tr_b16 a[98:99], v167 offset:16896
    ds_read_b64_tr_b16 a[100:101], v167 offset:20480
    ds_read_b64_tr_b16 a[102:103], v167 offset:20992
    ds_read_b64_tr_b16 a[104:105], v167 offset:24576
    ds_read_b64_tr_b16 a[106:107], v167 offset:25088
    ds_read_b64_tr_b16 a[108:109], v167 offset:28672
    ds_read_b64_tr_b16 a[110:111], v167 offset:29184
    ds_read_b64_tr_b16 a[112:113], v167 offset:32768
    ds_read_b64_tr_b16 a[114:115], v167 offset:33280
    ds_read_b64_tr_b16 a[116:117], v167 offset:36864
    ds_read_b64_tr_b16 a[118:119], v167 offset:37376
    s_waitcnt lgkmcnt(0)
    s_barrier
    s_lshl_b32 s90, s32, 10
    s_add_u32 m0, s90, 122880
    s_mov_b32 s91, 3932160
    buffer_load_dwordx4 v164, s[12:15], s91 offen nt lds
    s_add_u32 m0, m0, 4096
    s_add_u32 s91, s91, 393216
    buffer_load_dwordx4 v164, s[12:15], s91 offen nt lds
    s_add_u32 m0, m0, 4096
    s_add_u32 s91, s91, 393216
    buffer_load_dwordx4 v164, s[12:15], s91 offen nt lds
    s_add_u32 m0, m0, 4096
    s_add_u32 s91, s91, 393216
    buffer_load_dwordx4 v164, s[12:15], s91 offen nt lds
    s_add_u32 m0, m0, 4096
    s_add_u32 s91, s91, 393216
    buffer_load_dwordx4 v164, s[12:15], s91 offen nt lds
    s_add_u32 m0, m0, 4096
    s_add_u32 s91, s91, 393216
    buffer_load_dwordx4 v164, s[12:15], s91 offen nt lds
    s_add_u32 m0, m0, 4096
    s_add_u32 s91, s91, 393216
    buffer_load_dwordx4 v164, s[12:15], s91 offen nt lds
    s_add_u32 m0, m0, 4096
    s_add_u32 s91, s91, 393216
    buffer_load_dwordx4 v164, s[12:15], s91 offen nt lds
    s_add_u32 m0, m0, 4096
    s_add_u32 s91, s91, 393216
    buffer_load_dwordx4 v164, s[12:15], s91 offen nt lds
    s_add_u32 m0, m0, 4096
    s_add_u32 s91, s91, 393216
    buffer_load_dwordx4 v164, s[12:15], s91 offen nt lds
    s_waitcnt vmcnt(20)
    s_barrier
    ds_read_b64_tr_b16 a[120:121], v165 offset:0
    ds_read_b64_tr_b16 a[122:123], v165 offset:512
    ds_read_b64_tr_b16 a[124:125], v165 offset:4096
    ds_read_b64_tr_b16 a[126:127], v165 offset:4608
    ds_read_b64_tr_b16 a[128:129], v165 offset:8192
    ds_read_b64_tr_b16 a[130:131], v165 offset:8704
    ds_read_b64_tr_b16 a[132:133], v165 offset:12288
    ds_read_b64_tr_b16 a[134:135], v165 offset:12800
    ds_read_b64_tr_b16 a[136:137], v165 offset:16384
    ds_read_b64_tr_b16 a[138:139], v165 offset:16896
    ds_read_b64_tr_b16 a[140:141], v165 offset:20480
    ds_read_b64_tr_b16 a[142:143], v165 offset:20992
    ds_read_b64_tr_b16 a[144:145], v165 offset:24576
    ds_read_b64_tr_b16 a[146:147], v165 offset:25088
    ds_read_b64_tr_b16 a[148:149], v165 offset:28672
    ds_read_b64_tr_b16 a[150:151], v165 offset:29184
    ds_read_b64_tr_b16 a[152:153], v165 offset:32768
    ds_read_b64_tr_b16 a[154:155], v165 offset:33280
    ds_read_b64_tr_b16 a[156:157], v165 offset:36864
    ds_read_b64_tr_b16 a[158:159], v165 offset:37376
    s_waitcnt lgkmcnt(0)
    s_barrier
    s_mov_b32 s46, 40960
    s_lshl_b32 s90, s32, 10
    s_add_u32 m0, s90, 40960
    s_nop 0
    buffer_load_dwordx4 v10, s[24:27], s46 offen offset:0 lds
    s_add_u32 m0, m0, 3968
    s_nop 0
    buffer_load_dwordx4 v10, s[24:27], s46 offen offset:128 lds
    s_add_u32 m0, m0, 3968
    s_nop 0
    buffer_load_dwordx4 v10, s[24:27], s46 offen offset:256 lds
    s_add_u32 m0, m0, 3968
    s_nop 0
    buffer_load_dwordx4 v10, s[24:27], s46 offen offset:384 lds
    s_add_u32 m0, m0, 3968
    s_nop 0
    buffer_load_dwordx4 v10, s[24:27], s46 offen offset:512 lds
    s_add_u32 m0, m0, 3968
    s_nop 0
    buffer_load_dwordx4 v10, s[24:27], s46 offen offset:640 lds
    s_add_u32 m0, m0, 3968
    s_nop 0
    buffer_load_dwordx4 v10, s[24:27], s46 offen offset:768 lds
    s_add_u32 m0, m0, 3968
    s_nop 0
    buffer_load_dwordx4 v10, s[24:27], s46 offen offset:896 lds
    s_add_u32 m0, m0, 3968
    s_nop 0
    buffer_load_dwordx4 v10, s[24:27], s46 offen offset:1024 lds
    s_add_u32 m0, m0, 3968
    s_nop 0
    buffer_load_dwordx4 v10, s[24:27], s46 offen offset:1152 lds
    s_waitcnt vmcnt(20)
    s_barrier
    ds_read_b64_tr_b16 a[0:1], v166 offset:0
    ds_read_b64_tr_b16 a[2:3], v166 offset:512
    ds_read_b64_tr_b16 a[4:5], v166 offset:4096
    ds_read_b64_tr_b16 a[6:7], v166 offset:4608
    ds_read_b64_tr_b16 a[8:9], v166 offset:8192
    ds_read_b64_tr_b16 a[10:11], v166 offset:8704
    ds_read_b64_tr_b16 a[12:13], v166 offset:12288
    ds_read_b64_tr_b16 a[14:15], v166 offset:12800
    ds_read_b64_tr_b16 a[16:17], v166 offset:16384
    ds_read_b64_tr_b16 a[18:19], v166 offset:16896
    ds_read_b64_tr_b16 a[20:21], v166 offset:20480
    ds_read_b64_tr_b16 a[22:23], v166 offset:20992
    ds_read_b64_tr_b16 a[24:25], v166 offset:24576
    ds_read_b64_tr_b16 a[26:27], v166 offset:25088
    ds_read_b64_tr_b16 a[28:29], v166 offset:28672
    ds_read_b64_tr_b16 a[30:31], v166 offset:29184
    ds_read_b64_tr_b16 a[32:33], v166 offset:32768
    ds_read_b64_tr_b16 a[34:35], v166 offset:33280
    ds_read_b64_tr_b16 a[36:37], v166 offset:36864
    ds_read_b64_tr_b16 a[38:39], v166 offset:37376
    s_waitcnt lgkmcnt(0)
    s_barrier
    s_waitcnt vmcnt(10)
    s_barrier
    ds_read_b64_tr_b16 a[40:41], v167 offset:0
    ds_read_b64_tr_b16 a[42:43], v167 offset:512
    ds_read_b64_tr_b16 a[44:45], v167 offset:4096
    ds_read_b64_tr_b16 a[46:47], v167 offset:4608
    ds_read_b64_tr_b16 a[48:49], v167 offset:8192
    ds_read_b64_tr_b16 a[50:51], v167 offset:8704
    ds_read_b64_tr_b16 a[52:53], v167 offset:12288
    ds_read_b64_tr_b16 a[54:55], v167 offset:12800
    ds_read_b64_tr_b16 a[56:57], v167 offset:16384
    ds_read_b64_tr_b16 a[58:59], v167 offset:16896
    ds_read_b64_tr_b16 a[60:61], v167 offset:20480
    ds_read_b64_tr_b16 a[62:63], v167 offset:20992
    ds_read_b64_tr_b16 a[64:65], v167 offset:24576
    ds_read_b64_tr_b16 a[66:67], v167 offset:25088
    ds_read_b64_tr_b16 a[68:69], v167 offset:28672
    ds_read_b64_tr_b16 a[70:71], v167 offset:29184
    ds_read_b64_tr_b16 a[72:73], v167 offset:32768
    ds_read_b64_tr_b16 a[74:75], v167 offset:33280
    ds_read_b64_tr_b16 a[76:77], v167 offset:36864
    ds_read_b64_tr_b16 a[78:79], v167 offset:37376
    s_waitcnt lgkmcnt(0)
    s_barrier
    s_mov_b32 s49, 40960
    s_mov_b32 s47, 40960
    s_add_u32 s45, s38, 475136
    s_add_u32 s50, s45, 49152
    s_add_u32 s51, s38, 65536
    v_add_u32 v34, 0, v27
    s_mov_b32 s46, 40960
    ds_read_b128 v[116:119], v11 offset:0
    ds_read_b128 v[120:123], v11 offset:2048
    ds_read_b128 v[124:127], v12 offset:0
    ds_read_b128 v[128:131], v12 offset:2048
    s_waitcnt lgkmcnt(2)
    v_mfma_f32_16x16x32_bf16 v[140:143], a[160:163], v[116:119], 0
    ds_read_b128 v[132:135], v11 offset:4096
    v_mfma_f32_16x16x32_bf16 v[144:147], a[160:163], v[120:123], 0
    ds_read_b128 v[136:139], v11 offset:6144
    v_mfma_f32_16x16x32_bf16 v[148:151], a[80:83], v[116:119], 0
    v_mfma_f32_16x16x32_bf16 v[152:155], a[80:83], v[120:123], 0
    v_mfma_f32_16x16x32_bf16 v[156:159], a[0:3], v[116:119], 0
    v_mfma_f32_16x16x32_bf16 v[160:163], a[0:3], v[120:123], 0
    s_waitcnt lgkmcnt(2)
    v_mfma_f32_16x16x32_bf16 v[140:143], a[164:167], v[124:127], v[140:143]
    ds_read_b128 v[116:119], v12 offset:4096
    v_mfma_f32_16x16x32_bf16 v[144:147], a[164:167], v[128:131], v[144:147]
    ds_read_b128 v[120:123], v12 offset:6144
    v_mfma_f32_16x16x32_bf16 v[148:151], a[84:87], v[124:127], v[148:151]
    v_mfma_f32_16x16x32_bf16 v[152:155], a[84:87], v[128:131], v[152:155]
    v_mfma_f32_16x16x32_bf16 v[156:159], a[4:7], v[124:127], v[156:159]
    v_mfma_f32_16x16x32_bf16 v[160:163], a[4:7], v[128:131], v[160:163]
    s_waitcnt lgkmcnt(2)
    v_mfma_f32_16x16x32_bf16 v[140:143], a[168:171], v[132:135], v[140:143]
    ds_read_b128 v[124:127], v11 offset:8192
    v_mfma_f32_16x16x32_bf16 v[144:147], a[168:171], v[136:139], v[144:147]
    ds_read_b128 v[128:131], v11 offset:10240
    v_mfma_f32_16x16x32_bf16 v[148:151], a[88:91], v[132:135], v[148:151]
    v_mfma_f32_16x16x32_bf16 v[152:155], a[88:91], v[136:139], v[152:155]
    v_mfma_f32_16x16x32_bf16 v[156:159], a[8:11], v[132:135], v[156:159]
    v_mfma_f32_16x16x32_bf16 v[160:163], a[8:11], v[136:139], v[160:163]
    s_waitcnt lgkmcnt(2)
    v_mfma_f32_16x16x32_bf16 v[140:143], a[172:175], v[116:119], v[140:143]
    ds_read_b128 v[132:135], v12 offset:8192
    v_mfma_f32_16x16x32_bf16 v[144:147], a[172:175], v[120:123], v[144:147]
    ds_read_b128 v[136:139], v12 offset:10240
    v_mfma_f32_16x16x32_bf16 v[148:151], a[92:95], v[116:119], v[148:151]
    v_mfma_f32_16x16x32_bf16 v[152:155], a[92:95], v[120:123], v[152:155]
    v_mfma_f32_16x16x32_bf16 v[156:159], a[12:15], v[116:119], v[156:159]
    v_mfma_f32_16x16x32_bf16 v[160:163], a[12:15], v[120:123], v[160:163]
    s_waitcnt lgkmcnt(2)
    v_mfma_f32_16x16x32_bf16 v[140:143], a[176:179], v[124:127], v[140:143]
    ds_read_b128 v[116:119], v11 offset:12288
    v_mfma_f32_16x16x32_bf16 v[144:147], a[176:179], v[128:131], v[144:147]
    ds_read_b128 v[120:123], v11 offset:14336
    v_mfma_f32_16x16x32_bf16 v[148:151], a[96:99], v[124:127], v[148:151]
    v_mfma_f32_16x16x32_bf16 v[152:155], a[96:99], v[128:131], v[152:155]
    v_mfma_f32_16x16x32_bf16 v[156:159], a[16:19], v[124:127], v[156:159]
    v_mfma_f32_16x16x32_bf16 v[160:163], a[16:19], v[128:131], v[160:163]
    s_waitcnt lgkmcnt(2)
    v_mfma_f32_16x16x32_bf16 v[140:143], a[180:183], v[132:135], v[140:143]
    ds_read_b128 v[124:127], v12 offset:12288
    v_mfma_f32_16x16x32_bf16 v[144:147], a[180:183], v[136:139], v[144:147]
    ds_read_b128 v[128:131], v12 offset:14336
    v_mfma_f32_16x16x32_bf16 v[148:151], a[100:103], v[132:135], v[148:151]
    v_mfma_f32_16x16x32_bf16 v[152:155], a[100:103], v[136:139], v[152:155]
    v_mfma_f32_16x16x32_bf16 v[156:159], a[20:23], v[132:135], v[156:159]
    v_mfma_f32_16x16x32_bf16 v[160:163], a[20:23], v[136:139], v[160:163]
    s_waitcnt lgkmcnt(2)
    v_mfma_f32_16x16x32_bf16 v[140:143], a[184:187], v[116:119], v[140:143]
    ds_read_b128 v[132:135], v11 offset:16384
    v_mfma_f32_16x16x32_bf16 v[144:147], a[184:187], v[120:123], v[144:147]
    ds_read_b128 v[136:139], v11 offset:18432
    v_mfma_f32_16x16x32_bf16 v[148:151], a[104:107], v[116:119], v[148:151]
    v_mfma_f32_16x16x32_bf16 v[152:155], a[104:107], v[120:123], v[152:155]
    v_mfma_f32_16x16x32_bf16 v[156:159], a[24:27], v[116:119], v[156:159]
    v_mfma_f32_16x16x32_bf16 v[160:163], a[24:27], v[120:123], v[160:163]
    s_waitcnt lgkmcnt(2)
    v_mfma_f32_16x16x32_bf16 v[140:143], a[188:191], v[124:127], v[140:143]
    ds_read_b128 v[116:119], v12 offset:16384
    v_mfma_f32_16x16x32_bf16 v[144:147], a[188:191], v[128:131], v[144:147]
    ds_read_b128 v[120:123], v12 offset:18432
    v_mfma_f32_16x16x32_bf16 v[148:151], a[108:111], v[124:127], v[148:151]
    v_mfma_f32_16x16x32_bf16 v[152:155], a[108:111], v[128:131], v[152:155]
    v_mfma_f32_16x16x32_bf16 v[156:159], a[28:31], v[124:127], v[156:159]
    v_mfma_f32_16x16x32_bf16 v[160:163], a[28:31], v[128:131], v[160:163]
    s_waitcnt lgkmcnt(2)
    v_mfma_f32_16x16x32_bf16 v[140:143], a[192:195], v[132:135], v[140:143]
    ds_read_b128 v[124:127], v11 offset:20480
    v_mfma_f32_16x16x32_bf16 v[144:147], a[192:195], v[136:139], v[144:147]
    ds_read_b128 v[128:131], v11 offset:22528
    v_mfma_f32_16x16x32_bf16 v[148:151], a[112:115], v[132:135], v[148:151]
    v_mfma_f32_16x16x32_bf16 v[152:155], a[112:115], v[136:139], v[152:155]
    v_mfma_f32_16x16x32_bf16 v[156:159], a[32:35], v[132:135], v[156:159]
    v_mfma_f32_16x16x32_bf16 v[160:163], a[32:35], v[136:139], v[160:163]
    s_waitcnt lgkmcnt(2)
    v_mfma_f32_16x16x32_bf16 v[140:143], a[196:199], v[116:119], v[140:143]
    ds_read_b128 v[132:135], v12 offset:20480
    v_mfma_f32_16x16x32_bf16 v[144:147], a[196:199], v[120:123], v[144:147]
    ds_read_b128 v[136:139], v12 offset:22528
    v_mfma_f32_16x16x32_bf16 v[148:151], a[116:119], v[116:119], v[148:151]
    v_mfma_f32_16x16x32_bf16 v[152:155], a[116:119], v[120:123], v[152:155]
    v_mfma_f32_16x16x32_bf16 v[156:159], a[36:39], v[116:119], v[156:159]
    v_mfma_f32_16x16x32_bf16 v[160:163], a[36:39], v[120:123], v[160:163]
    s_waitcnt lgkmcnt(2)
    v_mfma_f32_16x16x32_bf16 v[140:143], a[200:203], v[124:127], v[140:143]
    ds_read_b128 v[116:119], v11 offset:24576
    v_mfma_f32_16x16x32_bf16 v[144:147], a[200:203], v[128:131], v[144:147]
    ds_read_b128 v[120:123], v11 offset:26624
    v_mfma_f32_16x16x32_bf16 v[148:151], a[120:123], v[124:127], v[148:151]
    v_mfma_f32_16x16x32_bf16 v[152:155], a[120:123], v[128:131], v[152:155]
    v_mfma_f32_16x16x32_bf16 v[156:159], a[40:43], v[124:127], v[156:159]
    v_mfma_f32_16x16x32_bf16 v[160:163], a[40:43], v[128:131], v[160:163]
    s_waitcnt lgkmcnt(2)
    v_mfma_f32_16x16x32_bf16 v[140:143], a[204:207], v[132:135], v[140:143]
    ds_read_b128 v[124:127], v12 offset:24576
    v_mfma_f32_16x16x32_bf16 v[144:147], a[204:207], v[136:139], v[144:147]
    ds_read_b128 v[128:131], v12 offset:26624
    v_mfma_f32_16x16x32_bf16 v[148:151], a[124:127], v[132:135], v[148:151]
    v_mfma_f32_16x16x32_bf16 v[152:155], a[124:127], v[136:139], v[152:155]
    v_mfma_f32_16x16x32_bf16 v[156:159], a[44:47], v[132:135], v[156:159]
    v_mfma_f32_16x16x32_bf16 v[160:163], a[44:47], v[136:139], v[160:163]
    s_waitcnt lgkmcnt(2)
    v_mfma_f32_16x16x32_bf16 v[140:143], a[208:211], v[116:119], v[140:143]
    ds_read_b128 v[132:135], v11 offset:28672
    v_mfma_f32_16x16x32_bf16 v[144:147], a[208:211], v[120:123], v[144:147]
    ds_read_b128 v[136:139], v11 offset:30720
    v_mfma_f32_16x16x32_bf16 v[148:151], a[128:131], v[116:119], v[148:151]
    v_mfma_f32_16x16x32_bf16 v[152:155], a[128:131], v[120:123], v[152:155]
    v_mfma_f32_16x16x32_bf16 v[156:159], a[48:51], v[116:119], v[156:159]
    v_mfma_f32_16x16x32_bf16 v[160:163], a[48:51], v[120:123], v[160:163]
    s_waitcnt lgkmcnt(2)
    v_mfma_f32_16x16x32_bf16 v[140:143], a[212:215], v[124:127], v[140:143]
    ds_read_b128 v[116:119], v12 offset:28672
    v_mfma_f32_16x16x32_bf16 v[144:147], a[212:215], v[128:131], v[144:147]
    ds_read_b128 v[120:123], v12 offset:30720
    v_mfma_f32_16x16x32_bf16 v[148:151], a[132:135], v[124:127], v[148:151]
    v_mfma_f32_16x16x32_bf16 v[152:155], a[132:135], v[128:131], v[152:155]
    v_mfma_f32_16x16x32_bf16 v[156:159], a[52:55], v[124:127], v[156:159]
    v_mfma_f32_16x16x32_bf16 v[160:163], a[52:55], v[128:131], v[160:163]
    s_waitcnt lgkmcnt(2)
    v_mfma_f32_16x16x32_bf16 v[140:143], a[216:219], v[132:135], v[140:143]
    ds_read_b128 v[124:127], v11 offset:32768
    v_mfma_f32_16x16x32_bf16 v[144:147], a[216:219], v[136:139], v[144:147]
    ds_read_b128 v[128:131], v11 offset:34816
    v_mfma_f32_16x16x32_bf16 v[148:151], a[136:139], v[132:135], v[148:151]
    v_mfma_f32_16x16x32_bf16 v[152:155], a[136:139], v[136:139], v[152:155]
    v_mfma_f32_16x16x32_bf16 v[156:159], a[56:59], v[132:135], v[156:159]
    v_mfma_f32_16x16x32_bf16 v[160:163], a[56:59], v[136:139], v[160:163]
    s_waitcnt lgkmcnt(2)
    v_mfma_f32_16x16x32_bf16 v[140:143], a[220:223], v[116:119], v[140:143]
    ds_read_b128 v[132:135], v12 offset:32768
    v_mfma_f32_16x16x32_bf16 v[144:147], a[220:223], v[120:123], v[144:147]
    ds_read_b128 v[136:139], v12 offset:34816
    v_mfma_f32_16x16x32_bf16 v[148:151], a[140:143], v[116:119], v[148:151]
    v_mfma_f32_16x16x32_bf16 v[152:155], a[140:143], v[120:123], v[152:155]
    v_mfma_f32_16x16x32_bf16 v[156:159], a[60:63], v[116:119], v[156:159]
    v_mfma_f32_16x16x32_bf16 v[160:163], a[60:63], v[120:123], v[160:163]
    s_waitcnt lgkmcnt(2)
    v_mfma_f32_16x16x32_bf16 v[140:143], a[224:227], v[124:127], v[140:143]
    ds_read_b128 v[116:119], v11 offset:36864
    v_mfma_f32_16x16x32_bf16 v[144:147], a[224:227], v[128:131], v[144:147]
    ds_read_b128 v[120:123], v11 offset:38912
    v_mfma_f32_16x16x32_bf16 v[148:151], a[144:147], v[124:127], v[148:151]
    v_mfma_f32_16x16x32_bf16 v[152:155], a[144:147], v[128:131], v[152:155]
    v_mfma_f32_16x16x32_bf16 v[156:159], a[64:67], v[124:127], v[156:159]
    v_mfma_f32_16x16x32_bf16 v[160:163], a[64:67], v[128:131], v[160:163]
    s_waitcnt lgkmcnt(2)
    v_mfma_f32_16x16x32_bf16 v[140:143], a[228:231], v[132:135], v[140:143]
    ds_read_b128 v[124:127], v12 offset:36864
    v_mfma_f32_16x16x32_bf16 v[144:147], a[228:231], v[136:139], v[144:147]
    ds_read_b128 v[128:131], v12 offset:38912
    v_mfma_f32_16x16x32_bf16 v[148:151], a[148:151], v[132:135], v[148:151]
    v_mfma_f32_16x16x32_bf16 v[152:155], a[148:151], v[136:139], v[152:155]
    v_mfma_f32_16x16x32_bf16 v[156:159], a[68:71], v[132:135], v[156:159]
    v_mfma_f32_16x16x32_bf16 v[160:163], a[68:71], v[136:139], v[160:163]
    s_waitcnt lgkmcnt(0)
    v_mfma_f32_16x16x32_bf16 v[140:143], a[232:235], v[116:119], v[140:143]
    v_mfma_f32_16x16x32_bf16 v[144:147], a[232:235], v[120:123], v[144:147]
    v_mfma_f32_16x16x32_bf16 v[140:143], a[236:239], v[124:127], v[140:143]
    v_mfma_f32_16x16x32_bf16 v[144:147], a[236:239], v[128:131], v[144:147]
    v_mfma_f32_16x16x32_bf16 v[148:151], a[152:155], v[116:119], v[148:151]
    v_add_u32 v11, s49, v11
    v_add_u32 v12, s49, v12
    v_mfma_f32_16x16x32_bf16 v[152:155], a[152:155], v[120:123], v[152:155]
    s_sub_u32 s47, s47, s49
    s_sub_u32 s49, 0, s49
    v_mfma_f32_16x16x32_bf16 v[148:151], a[156:159], v[124:127], v[148:151]
    v_mfma_f32_16x16x32_bf16 v[152:155], a[156:159], v[128:131], v[152:155]
    v_mfma_f32_16x16x32_bf16 v[156:159], a[72:75], v[116:119], v[156:159]
    v_cvt_pk_bf16_f32 v164, v140, v141
    v_cvt_pk_bf16_f32 v165, v142, v143
    v_mfma_f32_16x16x32_bf16 v[160:163], a[72:75], v[120:123], v[160:163]
    v_cvt_pk_bf16_f32 v166, v144, v145
    v_cvt_pk_bf16_f32 v167, v146, v147
    v_mfma_f32_16x16x32_bf16 v[156:159], a[76:79], v[124:127], v[156:159]
    v_permlane16_swap_b32 v164, v166
    v_permlane16_swap_b32 v165, v167
    v_mfma_f32_16x16x32_bf16 v[160:163], a[76:79], v[128:131], v[160:163]
    v_cvt_pk_bf16_f32 v168, v148, v149
    v_cvt_pk_bf16_f32 v169, v150, v151
    v_cvt_pk_bf16_f32 v170, v152, v153
    v_cvt_pk_bf16_f32 v171, v154, v155
    s_nop 0
    v_permlane16_swap_b32 v168, v170
    v_permlane16_swap_b32 v169, v171
    ds_write_b128 v34, v[168:171]
    v_cvt_pk_bf16_f32 v172, v156, v157
    v_cvt_pk_bf16_f32 v173, v158, v159
    v_cvt_pk_bf16_f32 v174, v160, v161
    v_cvt_pk_bf16_f32 v175, v162, v163
    s_nop 0
    v_permlane16_swap_b32 v172, v174
    v_permlane16_swap_b32 v173, v175
    buffer_store_dwordx4 v[164:167], v29, s[4:7], s51 offen sc1
    buffer_store_dwordx4 v[168:171], v29, s[4:7], s50 offen sc1
    buffer_store_dwordx4 v[172:175], v29, s[4:7], s45 offen sc1
    v_mov_b32 v1, 196
L_gw_46:
    buffer_load_dword v2, v1, s[8:11], 0 offen sc1
    s_sub_u32 s36, s36, 1
    s_cbranch_scc1 L_exit
    s_waitcnt vmcnt(0)
    v_readfirstlane_b32 s90, v2
    s_nop 0
    s_cmp_eq_u32 s90, 0
    s_cbranch_scc1 L_gw_46
    v_mov_b32 v32, 1
    buffer_store_dword v32, v30, s[4:7], s38 offen sc1
    s_waitcnt lgkmcnt(0)
    s_barrier
    s_add_u32 s45, s38, 573440
    s_add_u32 s50, s45, 49152
    s_add_u32 s51, s38, 180224
    v_add_u32 v34, 4096, v27
    s_mov_b32 s46, 81920
    ds_read_b128 v[116:119], v11 offset:0
    ds_read_b128 v[120:123], v11 offset:2048
    ds_read_b128 v[124:127], v12 offset:0
    ds_read_b128 v[128:131], v12 offset:2048
    s_lshl_b32 s90, s32, 10
    s_add_u32 m0, s90, s47
    s_waitcnt lgkmcnt(2)
    v_mfma_f32_16x16x32_bf16 v[140:143], a[160:163], v[116:119], 0
    ds_read_b128 v[132:135], v11 offset:4096
    v_mfma_f32_16x16x32_bf16 v[144:147], a[160:163], v[120:123], 0
    ds_read_b128 v[136:139], v11 offset:6144
    v_mfma_f32_16x16x32_bf16 v[148:151], a[80:83], v[116:119], 0
    buffer_load_dwordx4 v10, s[24:27], s46 offen offset:0 lds
    s_add_u32 m0, m0, 3968
    v_mfma_f32_16x16x32_bf16 v[152:155], a[80:83], v[120:123], 0
    v_mfma_f32_16x16x32_bf16 v[156:159], a[0:3], v[116:119], 0
    buffer_load_dwordx4 v10, s[24:27], s46 offen offset:128 lds
    s_add_u32 m0, m0, 3968
    v_mfma_f32_16x16x32_bf16 v[160:163], a[0:3], v[120:123], 0
    s_waitcnt lgkmcnt(2)
    v_mfma_f32_16x16x32_bf16 v[140:143], a[164:167], v[124:127], v[140:143]
    ds_read_b128 v[116:119], v12 offset:4096
    v_mfma_f32_16x16x32_bf16 v[144:147], a[164:167], v[128:131], v[144:147]
    ds_read_b128 v[120:123], v12 offset:6144
    v_mfma_f32_16x16x32_bf16 v[148:151], a[84:87], v[124:127], v[148:151]
    buffer_load_dwordx4 v10, s[24:27], s46 offen offset:256 lds
    s_add_u32 m0, m0, 3968
    v_mfma_f32_16x16x32_bf16 v[152:155], a[84:87], v[128:131], v[152:155]
    v_mfma_f32_16x16x32_bf16 v[156:159], a[4:7], v[124:127], v[156:159]
    v_mfma_f32_16x16x32_bf16 v[160:163], a[4:7], v[128:131], v[160:163]
    s_waitcnt lgkmcnt(2)
    v_mfma_f32_16x16x32_bf16 v[140:143], a[168:171], v[132:135], v[140:143]
    ds_read_b128 v[124:127], v11 offset:8192
    v_mfma_f32_16x16x32_bf16 v[144:147], a[168:171], v[136:139], v[144:147]
    ds_read_b128 v[128:131], v11 offset:10240
    v_mfma_f32_16x16x32_bf16 v[148:151], a[88:91], v[132:135], v[148:151]
    buffer_load_dwordx4 v10, s[24:27], s46 offen offset:384 lds
    s_add_u32 m0, m0, 3968
    v_mfma_f32_16x16x32_bf16 v[152:155], a[88:91], v[136:139], v[152:155]
    v_mfma_f32_16x16x32_bf16 v[156:159], a[8:11], v[132:135], v[156:159]
    buffer_load_dwordx4 v10, s[24:27], s46 offen offset:512 lds
    s_add_u32 m0, m0, 3968
    v_mfma_f32_16x16x32_bf16 v[160:163], a[8:11], v[136:139], v[160:163]
    s_waitcnt lgkmcnt(2)
    v_mfma_f32_16x16x32_bf16 v[140:143], a[172:175], v[116:119], v[140:143]
    ds_read_b128 v[132:135], v12 offset:8192
    v_mfma_f32_16x16x32_bf16 v[144:147], a[172:175], v[120:123], v[144:147]
    ds_read_b128 v[136:139], v12 offset:10240
    v_mfma_f32_16x16x32_bf16 v[148:151], a[92:95], v[116:119], v[148:151]
    buffer_load_dwordx4 v10, s[24:27], s46 offen offset:640 lds
    s_add_u32 m0, m0, 3968
    v_mfma_f32_16x16x32_bf16 v[152:155], a[92:95], v[120:123], v[152:155]
    v_mfma_f32_16x16x32_bf16 v[156:159], a[12:15], v[116:119], v[156:159]
    v_mfma_f32_16x16x32_bf16 v[160:163], a[12:15], v[120:123], v[160:163]
    s_waitcnt lgkmcnt(2)
    v_mfma_f32_16x16x32_bf16 v[140:143], a[176:179], v[124:127], v[140:143]
    ds_read_b128 v[116:119], v11 offset:12288
    v_mfma_f32_16x16x32_bf16 v[144:147], a[176:179], v[128:131], v[144:147]
    ds_read_b128 v[120:123], v11 offset:14336
    v_mfma_f32_16x16x32_bf16 v[148:151], a[96:99], v[124:127], v[148:151]
    buffer_load_dwordx4 v10, s[24:27], s46 offen offset:768 lds
    s_add_u32 m0, m0, 3968
    v_mfma_f32_16x16x32_bf16 v[152:155], a[96:99], v[128:131], v[152:155]
    v_mfma_f32_16x16x32_bf16 v[156:159], a[16:19], v[124:127], v[156:159]
    buffer_load_dwordx4 v10, s[24:27], s46 offen offset:896 lds
    s_add_u32 m0, m0, 3968
    v_mfma_f32_16x16x32_bf16 v[160:163], a[16:19], v[128:131], v[160:163]
    s_waitcnt lgkmcnt(2)
    v_mfma_f32_16x16x32_bf16 v[140:143], a[180:183], v[132:135], v[140:143]
    ds_read_b128 v[124:127], v12 offset:12288
    v_mfma_f32_16x16x32_bf16 v[144:147], a[180:183], v[136:139], v[144:147]
    ds_read_b128 v[128:131], v12 offset:14336
    v_mfma_f32_16x16x32_bf16 v[148:151], a[100:103], v[132:135], v[148:151]
    buffer_load_dwordx4 v10, s[24:27], s46 offen offset:1024 lds
    s_add_u32 m0, m0, 3968
    v_mfma_f32_16x16x32_bf16 v[152:155], a[100:103], v[136:139], v[152:155]
    v_mfma_f32_16x16x32_bf16 v[156:159], a[20:23], v[132:135], v[156:159]
    v_mfma_f32_16x16x32_bf16 v[160:163], a[20:23], v[136:139], v[160:163]
    s_waitcnt lgkmcnt(2)
    v_mfma_f32_16x16x32_bf16 v[140:143], a[184:187], v[116:119], v[140:143]
    ds_read_b128 v[132:135], v11 offset:16384
    v_mfma_f32_16x16x32_bf16 v[144:147], a[184:187], v[120:123], v[144:147]
    ds_read_b128 v[136:139], v11 offset:18432
    v_mfma_f32_16x16x32_bf16 v[148:151], a[104:107], v[116:119], v[148:151]
    buffer_load_dwordx4 v10, s[24:27], s46 offen offset:1152 lds
    v_mfma_f32_16x16x32_bf16 v[152:155], a[104:107], v[120:123], v[152:155]
    v_mfma_f32_16x16x32_bf16 v[156:159], a[24:27], v[116:119], v[156:159]
    v_mfma_f32_16x16x32_bf16 v[160:163], a[24:27], v[120:123], v[160:163]
    s_waitcnt lgkmcnt(2)
    v_mfma_f32_16x16x32_bf16 v[140:143], a[188:191], v[124:127], v[140:143]
    ds_read_b128 v[116:119], v12 offset:16384
    v_mfma_f32_16x16x32_bf16 v[144:147], a[188:191], v[128:131], v[144:147]
    ds_read_b128 v[120:123], v12 offset:18432
    v_mfma_f32_16x16x32_bf16 v[148:151], a[108:111], v[124:127], v[148:151]
    v_mfma_f32_16x16x32_bf16 v[152:155], a[108:111], v[128:131], v[152:155]
    v_mfma_f32_16x16x32_bf16 v[156:159], a[28:31], v[124:127], v[156:159]
    v_mfma_f32_16x16x32_bf16 v[160:163], a[28:31], v[128:131], v[160:163]
    s_waitcnt lgkmcnt(2)
    v_mfma_f32_16x16x32_bf16 v[140:143], a[192:195], v[132:135], v[140:143]
    ds_read_b128 v[124:127], v11 offset:20480
    v_mfma_f32_16x16x32_bf16 v[144:147], a[192:195], v[136:139], v[144:147]
    ds_read_b128 v[128:131], v11 offset:22528
    v_mfma_f32_16x16x32_bf16 v[148:151], a[112:115], v[132:135], v[148:151]
    v_mfma_f32_16x16x32_bf16 v[152:155], a[112:115], v[136:139], v[152:155]
    v_mfma_f32_16x16x32_bf16 v[156:159], a[32:35], v[132:135], v[156:159]
    v_mfma_f32_16x16x32_bf16 v[160:163], a[32:35], v[136:139], v[160:163]
    s_waitcnt lgkmcnt(2)
    v_mfma_f32_16x16x32_bf16 v[140:143], a[196:199], v[116:119], v[140:143]
    ds_read_b128 v[132:135], v12 offset:20480
    v_mfma_f32_16x16x32_bf16 v[144:147], a[196:199], v[120:123], v[144:147]
    ds_read_b128 v[136:139], v12 offset:22528
    v_mfma_f32_16x16x32_bf16 v[148:151], a[116:119], v[116:119], v[148:151]
    v_mfma_f32_16x16x32_bf16 v[152:155], a[116:119], v[120:123], v[152:155]
    v_mfma_f32_16x16x32_bf16 v[156:159], a[36:39], v[116:119], v[156:159]
    v_mfma_f32_16x16x32_bf16 v[160:163], a[36:39], v[120:123], v[160:163]
    s_waitcnt lgkmcnt(2)
    v_mfma_f32_16x16x32_bf16 v[140:143], a[200:203], v[124:127], v[140:143]
    ds_read_b128 v[116:119], v11 offset:24576
    v_mfma_f32_16x16x32_bf16 v[144:147], a[200:203], v[128:131], v[144:147]
    ds_read_b128 v[120:123], v11 offset:26624
    v_mfma_f32_16x16x32_bf16 v[148:151], a[120:123], v[124:127], v[148:151]
    v_mfma_f32_16x16x32_bf16 v[152:155], a[120:123], v[128:131], v[152:155]
    v_mfma_f32_16x16x32_bf16 v[156:159], a[40:43], v[124:127], v[156:159]
    v_mfma_f32_16x16x32_bf16 v[160:163], a[40:43], v[128:131], v[160:163]
    s_waitcnt lgkmcnt(2)
    v_mfma_f32_16x16x32_bf16 v[140:143], a[204:207], v[132:135], v[140:143]
    ds_read_b128 v[124:127], v12 offset:24576
    v_mfma_f32_16x16x32_bf16 v[144:147], a[204:207], v[136:139], v[144:147]
    ds_read_b128 v[128:131], v12 offset:26624
    v_mfma_f32_16x16x32_bf16 v[148:151], a[124:127], v[132:135], v[148:151]
    v_mfma_f32_16x16x32_bf16 v[152:155], a[124:127], v[136:139], v[152:155]
    v_mfma_f32_16x16x32_bf16 v[156:159], a[44:47], v[132:135], v[156:159]
    v_mfma_f32_16x16x32_bf16 v[160:163], a[44:47], v[136:139], v[160:163]
    s_waitcnt lgkmcnt(2)
    v_mfma_f32_16x16x32_bf16 v[140:143], a[208:211], v[116:119], v[140:143]
    ds_read_b128 v[132:135], v11 offset:28672
    v_mfma_f32_16x16x32_bf16 v[144:147], a[208:211], v[120:123], v[144:147]
    ds_read_b128 v[136:139], v11 offset:30720
    v_mfma_f32_16x16x32_bf16 v[148:151], a[128:131], v[116:119], v[148:151]
    v_mfma_f32_16x16x32_bf16 v[152:155], a[128:131], v[120:123], v[152:155]
    v_mfma_f32_16x16x32_bf16 v[156:159], a[48:51], v[116:119], v[156:159]
    v_mfma_f32_16x16x32_bf16 v[160:163], a[48:51], v[120:123], v[160:163]
    s_waitcnt lgkmcnt(2)
    v_mfma_f32_16x16x32_bf16 v[140:143], a[212:215], v[124:127], v[140:143]
    ds_read_b128 v[116:119], v12 offset:28672
    v_mfma_f32_16x16x32_bf16 v[144:147], a[212:215], v[128:131], v[144:147]
    ds_read_b128 v[120:123], v12 offset:30720
    v_mfma_f32_16x16x32_bf16 v[148:151], a[132:135], v[124:127], v[148:151]
    v_mfma_f32_16x16x32_bf16 v[152:155], a[132:135], v[128:131], v[152:155]
    v_mfma_f32_16x16x32_bf16 v[156:159], a[52:55], v[124:127], v[156:159]
    v_mfma_f32_16x16x32_bf16 v[160:163], a[52:55], v[128:131], v[160:163]
    s_waitcnt lgkmcnt(2)
    v_mfma_f32_16x16x32_bf16 v[140:143], a[216:219], v[132:135], v[140:143]
    ds_read_b128 v[124:127], v11 offset:32768
    v_mfma_f32_16x16x32_bf16 v[144:147], a[216:219], v[136:139], v[144:147]
    ds_read_b128 v[128:131], v11 offset:34816
    v_mfma_f32_16x16x32_bf16 v[148:151], a[136:139], v[132:135], v[148:151]
    v_mfma_f32_16x16x32_bf16 v[152:155], a[136:139], v[136:139], v[152:155]
    v_mfma_f32_16x16x32_bf16 v[156:159], a[56:59], v[132:135], v[156:159]
    v_mfma_f32_16x16x32_bf16 v[160:163], a[56:59], v[136:139], v[160:163]
    s_waitcnt lgkmcnt(2)
    v_mfma_f32_16x16x32_bf16 v[140:143], a[220:223], v[116:119], v[140:143]
    ds_read_b128 v[132:135], v12 offset:32768
    v_mfma_f32_16x16x32_bf16 v[144:147], a[220:223], v[120:123], v[144:147]
    ds_read_b128 v[136:139], v12 offset:34816
    v_mfma_f32_16x16x32_bf16 v[148:151], a[140:143], v[116:119], v[148:151]
    v_mfma_f32_16x16x32_bf16 v[152:155], a[140:143], v[120:123], v[152:155]
    v_mfma_f32_16x16x32_bf16 v[156:159], a[60:63], v[116:119], v[156:159]
    v_mfma_f32_16x16x32_bf16 v[160:163], a[60:63], v[120:123], v[160:163]
    s_waitcnt lgkmcnt(2)
    v_mfma_f32_16x16x32_bf16 v[140:143], a[224:227], v[124:127], v[140:143]
    ds_read_b128 v[116:119], v11 offset:36864
    v_mfma_f32_16x16x32_bf16 v[144:147], a[224:227], v[128:131], v[144:147]
    ds_read_b128 v[120:123], v11 offset:38912
    v_mfma_f32_16x16x32_bf16 v[148:151], a[144:147], v[124:127], v[148:151]
    v_mfma_f32_16x16x32_bf16 v[152:155], a[144:147], v[128:131], v[152:155]
    v_mfma_f32_16x16x32_bf16 v[156:159], a[64:67], v[124:127], v[156:159]
    v_mfma_f32_16x16x32_bf16 v[160:163], a[64:67], v[128:131], v[160:163]
    s_waitcnt lgkmcnt(2)
    v_mfma_f32_16x16x32_bf16 v[140:143], a[228:231], v[132:135], v[140:143]
    ds_read_b128 v[124:127], v12 offset:36864
    v_mfma_f32_16x16x32_bf16 v[144:147], a[228:231], v[136:139], v[144:147]
    ds_read_b128 v[128:131], v12 offset:38912
    v_mfma_f32_16x16x32_bf16 v[148:151], a[148:151], v[132:135], v[148:151]
    v_mfma_f32_16x16x32_bf16 v[152:155], a[148:151], v[136:139], v[152:155]
    v_mfma_f32_16x16x32_bf16 v[156:159], a[68:71], v[132:135], v[156:159]
    v_mfma_f32_16x16x32_bf16 v[160:163], a[68:71], v[136:139], v[160:163]
    s_waitcnt lgkmcnt(0)
    v_mfma_f32_16x16x32_bf16 v[140:143], a[232:235], v[116:119], v[140:143]
    v_mfma_f32_16x16x32_bf16 v[144:147], a[232:235], v[120:123], v[144:147]
    v_mfma_f32_16x16x32_bf16 v[140:143], a[236:239], v[124:127], v[140:143]
    v_mfma_f32_16x16x32_bf16 v[144:147], a[236:239], v[128:131], v[144:147]
    v_mfma_f32_16x16x32_bf16 v[148:151], a[152:155], v[116:119], v[148:151]
    v_add_u32 v11, s49, v11
    v_add_u32 v12, s49, v12
    v_mfma_f32_16x16x32_bf16 v[152:155], a[152:155], v[120:123], v[152:155]
    s_sub_u32 s47, s47, s49
    s_sub_u32 s49, 0, s49
    v_mfma_f32_16x16x32_bf16 v[148:151], a[156:159], v[124:127], v[148:151]
    v_mfma_f32_16x16x32_bf16 v[152:155], a[156:159], v[128:131], v[152:155]
    v_mfma_f32_16x16x32_bf16 v[156:159], a[72:75], v[116:119], v[156:159]
    v_cvt_pk_bf16_f32 v164, v140, v141
    v_cvt_pk_bf16_f32 v165, v142, v143
    v_mfma_f32_16x16x32_bf16 v[160:163], a[72:75], v[120:123], v[160:163]
    v_cvt_pk_bf16_f32 v166, v144, v145
    v_cvt_pk_bf16_f32 v167, v146, v147
    v_mfma_f32_16x16x32_bf16 v[156:159], a[76:79], v[124:127], v[156:159]
    v_permlane16_swap_b32 v164, v166
    v_permlane16_swap_b32 v165, v167
    v_mfma_f32_16x16x32_bf16 v[160:163], a[76:79], v[128:131], v[160:163]
    v_cvt_pk_bf16_f32 v168, v148, v149
    v_cvt_pk_bf16_f32 v169, v150, v151
    v_cvt_pk_bf16_f32 v170, v152, v153
    v_cvt_pk_bf16_f32 v171, v154, v155
    s_nop 0
    v_permlane16_swap_b32 v168, v170
    v_permlane16_swap_b32 v169, v171
    ds_write_b128 v34, v[168:171]
    v_cvt_pk_bf16_f32 v172, v156, v157
    v_cvt_pk_bf16_f32 v173, v158, v159
    v_cvt_pk_bf16_f32 v174, v160, v161
    v_cvt_pk_bf16_f32 v175, v162, v163
    s_nop 0
    v_permlane16_swap_b32 v172, v174
    v_permlane16_swap_b32 v173, v175
    buffer_store_dwordx4 v[164:167], v29, s[4:7], s51 offen sc1
    buffer_store_dwordx4 v[168:171], v29, s[4:7], s50 offen sc1
    buffer_store_dwordx4 v[172:175], v29, s[4:7], s45 offen sc1
    s_waitcnt vmcnt(0) lgkmcnt(0)
    v_mov_b32 v32, 2
    buffer_store_dword v32, v30, s[4:7], s38 offen sc1
    s_barrier
    s_mov_b32 s37, -1
    s_add_u32 s45, s38, 671744
    s_add_u32 s50, s45, 49152
    s_add_u32 s51, s38, 294912
    v_add_u32 v34, 8192, v27
    s_mov_b32 s46, 122880
    ds_read_b128 v[116:119], v11 offset:0
    ds_read_b128 v[120:123], v11 offset:2048
    ds_read_b128 v[124:127], v12 offset:0
    ds_read_b128 v[128:131], v12 offset:2048
    s_lshl_b32 s90, s32, 10
    s_add_u32 m0, s90, s47
    s_waitcnt lgkmcnt(2)
    v_mfma_f32_16x16x32_bf16 v[140:143], a[160:163], v[116:119], 0
    ds_read_b128 v[132:135], v11 offset:4096
    s_and_b32 s52, s37, 3
    v_mfma_f32_16x16x32_bf16 v[144:147], a[160:163], v[120:123], 0
    ds_read_b128 v[136:139], v11 offset:6144
    s_mul_i32 s55, s52, 327680
    v_mfma_f32_16x16x32_bf16 v[148:151], a[80:83], v[116:119], 0
    buffer_load_dwordx4 v10, s[24:27], s46 offen offset:0 lds
    s_add_u32 m0, m0, 3968
    v_mfma_f32_16x16x32_bf16 v[152:155], a[80:83], v[120:123], 0
    s_add_u32 s37, s37, 1
    s_mov_b32 s54, 0
    v_mfma_f32_16x16x32_bf16 v[156:159], a[0:3], v[116:119], 0
    buffer_load_dwordx4 v10, s[24:27], s46 offen offset:128 lds
    s_add_u32 m0, m0, 3968
    v_mfma_f32_16x16x32_bf16 v[160:163], a[0:3], v[120:123], 0
    s_waitcnt lgkmcnt(2)
    s_and_b32 s52, s37, 3
    v_mfma_f32_16x16x32_bf16 v[140:143], a[164:167], v[124:127], v[140:143]
    ds_read_b128 v[116:119], v12 offset:4096
    s_mul_i32 s53, s52, 114688
    v_mfma_f32_16x16x32_bf16 v[144:147], a[164:167], v[128:131], v[144:147]
    ds_read_b128 v[120:123], v12 offset:6144
    s_add_u32 s42, s38, s53
    v_mfma_f32_16x16x32_bf16 v[148:151], a[84:87], v[124:127], v[148:151]
    buffer_load_dwordx4 v10, s[24:27], s46 offen offset:256 lds
    s_add_u32 m0, m0, 3968
    v_mfma_f32_16x16x32_bf16 v[152:155], a[84:87], v[128:131], v[152:155]
    s_lshl_b32 s52, s52, 12
    v_add_u32 v35, s52, v28
    v_mfma_f32_16x16x32_bf16 v[156:159], a[4:7], v[124:127], v[156:159]
    s_xor_b32 s52, s52, 8192
    v_add_u32 v34, s52, v27
    v_mfma_f32_16x16x32_bf16 v[160:163], a[4:7], v[128:131], v[160:163]
    s_waitcnt lgkmcnt(2)
    s_add_u32 s44, s42, 40960
    v_mfma_f32_16x16x32_bf16 v[140:143], a[168:171], v[132:135], v[140:143]
    ds_read_b128 v[124:127], v11 offset:8192
    s_mul_i32 s52, s52, 28
    v_mfma_f32_16x16x32_bf16 v[144:147], a[168:171], v[136:139], v[144:147]
    ds_read_b128 v[128:131], v11 offset:10240
    s_add_u32 s43, s38, s52
    v_mfma_f32_16x16x32_bf16 v[148:151], a[88:91], v[132:135], v[148:151]
    buffer_load_dwordx4 v10, s[24:27], s46 offen offset:384 lds
    s_add_u32 m0, m0, 3968
    v_mfma_f32_16x16x32_bf16 v[152:155], a[88:91], v[136:139], v[152:155]
    s_add_u32 s53, s37, 2
    s_and_b32 s53, s53, 7
    v_mfma_f32_16x16x32_bf16 v[156:159], a[8:11], v[132:135], v[156:159]
    buffer_load_dwordx4 v10, s[24:27], s46 offen offset:512 lds
    s_add_u32 m0, m0, 3968
    v_mfma_f32_16x16x32_bf16 v[160:163], a[8:11], v[136:139], v[160:163]
    s_waitcnt lgkmcnt(2)
    s_mul_i32 s53, s53, 98304
    v_mfma_f32_16x16x32_bf16 v[140:143], a[172:175], v[116:119], v[140:143]
    ds_read_b128 v[132:135], v12 offset:8192
    s_add_u32 s53, s53, 475136
    v_mfma_f32_16x16x32_bf16 v[144:147], a[172:175], v[120:123], v[144:147]
    ds_read_b128 v[136:139], v12 offset:10240
    s_add_u32 s45, s38, s53
    v_mfma_f32_16x16x32_bf16 v[148:151], a[92:95], v[116:119], v[148:151]
    buffer_load_dwordx4 v10, s[24:27], s46 offen offset:640 lds
    s_add_u32 m0, m0, 3968
    v_mfma_f32_16x16x32_bf16 v[152:155], a[92:95], v[120:123], v[152:155]
    s_add_u32 s50, s45, 49152
    s_add_u32 s51, s43, 65536
    v_mfma_f32_16x16x32_bf16 v[156:159], a[12:15], v[116:119], v[156:159]
    v_add_u32 v32, s37, v220
    v_mov_b32 v80, 0
    v_mfma_f32_16x16x32_bf16 v[160:163], a[12:15], v[120:123], v[160:163]
    s_waitcnt lgkmcnt(2)
    v_mov_b32 v81, 0
    v_mfma_f32_16x16x32_bf16 v[140:143], a[176:179], v[124:127], v[140:143]
    ds_read_b128 v[116:119], v11 offset:12288
    v_mov_b32 v82, 0
    v_mfma_f32_16x16x32_bf16 v[144:147], a[176:179], v[128:131], v[144:147]
    ds_read_b128 v[120:123], v11 offset:14336
    v_mov_b32 v83, 0
    v_mfma_f32_16x16x32_bf16 v[148:151], a[96:99], v[124:127], v[148:151]
    buffer_load_dwordx4 v10, s[24:27], s46 offen offset:768 lds
    s_add_u32 m0, m0, 3968
    v_mfma_f32_16x16x32_bf16 v[152:155], a[96:99], v[128:131], v[152:155]
    v_mov_b32 v84, 0
    v_mov_b32 v85, 0
    v_mfma_f32_16x16x32_bf16 v[156:159], a[16:19], v[124:127], v[156:159]
    buffer_load_dwordx4 v10, s[24:27], s46 offen offset:896 lds
    s_add_u32 m0, m0, 3968
    v_mfma_f32_16x16x32_bf16 v[160:163], a[16:19], v[128:131], v[160:163]
    s_waitcnt lgkmcnt(2)
    v_mov_b32 v86, 0
    v_mfma_f32_16x16x32_bf16 v[140:143], a[180:183], v[132:135], v[140:143]
    ds_read_b128 v[124:127], v12 offset:12288
    v_mov_b32 v87, 0
    v_mfma_f32_16x16x32_bf16 v[144:147], a[180:183], v[136:139], v[144:147]
    ds_read_b128 v[128:131], v12 offset:14336
    v_mov_b32 v88, 0
    v_mfma_f32_16x16x32_bf16 v[148:151], a[100:103], v[132:135], v[148:151]
    buffer_load_dwordx4 v10, s[24:27], s46 offen offset:1024 lds
    s_add_u32 m0, m0, 3968
    v_mfma_f32_16x16x32_bf16 v[152:155], a[100:103], v[136:139], v[152:155]
    v_mov_b32 v89, 0
    v_mov_b32 v90, 0
    v_mfma_f32_16x16x32_bf16 v[156:159], a[20:23], v[132:135], v[156:159]
    v_mov_b32 v91, 0
    v_mfma_f32_16x16x32_bf16 v[160:163], a[20:23], v[136:139], v[160:163]
    s_waitcnt lgkmcnt(2)
    v_mfma_f32_16x16x32_bf16 v[140:143], a[184:187], v[116:119], v[140:143]
    ds_read_b128 v[132:135], v11 offset:16384
    v_mfma_f32_16x16x32_bf16 v[144:147], a[184:187], v[120:123], v[144:147]
    ds_read_b128 v[136:139], v11 offset:18432
    v_mfma_f32_16x16x32_bf16 v[148:151], a[104:107], v[116:119], v[148:151]
    buffer_load_dwordx4 v10, s[24:27], s46 offen offset:1152 lds
    v_mfma_f32_16x16x32_bf16 v[152:155], a[104:107], v[120:123], v[152:155]
    v_mfma_f32_16x16x32_bf16 v[156:159], a[24:27], v[116:119], v[156:159]
    v_mfma_f32_16x16x32_bf16 v[160:163], a[24:27], v[120:123], v[160:163]
    s_waitcnt lgkmcnt(2)
    v_mfma_f32_16x16x32_bf16 v[140:143], a[188:191], v[124:127], v[140:143]
    ds_read_b128 v[116:119], v12 offset:16384
    v_mfma_f32_16x16x32_bf16 v[144:147], a[188:191], v[128:131], v[144:147]
    ds_read_b128 v[120:123], v12 offset:18432
    v_mfma_f32_16x16x32_bf16 v[148:151], a[108:111], v[124:127], v[148:151]
    v_mfma_f32_16x16x32_bf16 v[152:155], a[108:111], v[128:131], v[152:155]
    v_mfma_f32_16x16x32_bf16 v[156:159], a[28:31], v[124:127], v[156:159]
    v_mfma_f32_16x16x32_bf16 v[160:163], a[28:31], v[128:131], v[160:163]
    s_waitcnt lgkmcnt(2)
    v_mfma_f32_16x16x32_bf16 v[140:143], a[192:195], v[132:135], v[140:143]
    ds_read_b128 v[124:127], v11 offset:20480
    v_mfma_f32_16x16x32_bf16 v[144:147], a[192:195], v[136:139], v[144:147]
    ds_read_b128 v[128:131], v11 offset:22528
    v_mfma_f32_16x16x32_bf16 v[148:151], a[112:115], v[132:135], v[148:151]
    v_mfma_f32_16x16x32_bf16 v[152:155], a[112:115], v[136:139], v[152:155]
    v_mfma_f32_16x16x32_bf16 v[156:159], a[32:35], v[132:135], v[156:159]
    v_mfma_f32_16x16x32_bf16 v[160:163], a[32:35], v[136:139], v[160:163]
    s_waitcnt lgkmcnt(2)
    v_mfma_f32_16x16x32_bf16 v[140:143], a[196:199], v[116:119], v[140:143]
    ds_read_b128 v[132:135], v12 offset:20480
    v_mfma_f32_16x16x32_bf16 v[144:147], a[196:199], v[120:123], v[144:147]
    ds_read_b128 v[136:139], v12 offset:22528
    v_mfma_f32_16x16x32_bf16 v[148:151], a[116:119], v[116:119], v[148:151]
    v_mfma_f32_16x16x32_bf16 v[152:155], a[116:119], v[120:123], v[152:155]
    v_mfma_f32_16x16x32_bf16 v[156:159], a[36:39], v[116:119], v[156:159]
    v_mfma_f32_16x16x32_bf16 v[160:163], a[36:39], v[120:123], v[160:163]
    s_waitcnt lgkmcnt(2)
    v_mfma_f32_16x16x32_bf16 v[140:143], a[200:203], v[124:127], v[140:143]
    ds_read_b128 v[116:119], v11 offset:24576
    v_mfma_f32_16x16x32_bf16 v[144:147], a[200:203], v[128:131], v[144:147]
    ds_read_b128 v[120:123], v11 offset:26624
    v_mfma_f32_16x16x32_bf16 v[148:151], a[120:123], v[124:127], v[148:151]
    v_mfma_f32_16x16x32_bf16 v[152:155], a[120:123], v[128:131], v[152:155]
    v_mfma_f32_16x16x32_bf16 v[156:159], a[40:43], v[124:127], v[156:159]
    v_mfma_f32_16x16x32_bf16 v[160:163], a[40:43], v[128:131], v[160:163]
    s_waitcnt lgkmcnt(2)
    v_mfma_f32_16x16x32_bf16 v[140:143], a[204:207], v[132:135], v[140:143]
    ds_read_b128 v[124:127], v12 offset:24576
    v_mfma_f32_16x16x32_bf16 v[144:147], a[204:207], v[136:139], v[144:147]
    ds_read_b128 v[128:131], v12 offset:26624
    v_mfma_f32_16x16x32_bf16 v[148:151], a[124:127], v[132:135], v[148:151]
    v_mfma_f32_16x16x32_bf16 v[152:155], a[124:127], v[136:139], v[152:155]
    v_mfma_f32_16x16x32_bf16 v[156:159], a[44:47], v[132:135], v[156:159]
    v_mfma_f32_16x16x32_bf16 v[160:163], a[44:47], v[136:139], v[160:163]
    s_waitcnt lgkmcnt(2)
    v_mfma_f32_16x16x32_bf16 v[140:143], a[208:211], v[116:119], v[140:143]
    ds_read_b128 v[132:135], v11 offset:28672
    v_mfma_f32_16x16x32_bf16 v[144:147], a[208:211], v[120:123], v[144:147]
    ds_read_b128 v[136:139], v11 offset:30720
    v_mfma_f32_16x16x32_bf16 v[148:151], a[128:131], v[116:119], v[148:151]
    v_mfma_f32_16x16x32_bf16 v[152:155], a[128:131], v[120:123], v[152:155]
    v_mfma_f32_16x16x32_bf16 v[156:159], a[48:51], v[116:119], v[156:159]
    v_mfma_f32_16x16x32_bf16 v[160:163], a[48:51], v[120:123], v[160:163]
    s_waitcnt lgkmcnt(2)
    v_mfma_f32_16x16x32_bf16 v[140:143], a[212:215], v[124:127], v[140:143]
    ds_read_b128 v[116:119], v12 offset:28672
    v_mfma_f32_16x16x32_bf16 v[144:147], a[212:215], v[128:131], v[144:147]
    ds_read_b128 v[120:123], v12 offset:30720
    v_mfma_f32_16x16x32_bf16 v[148:151], a[132:135], v[124:127], v[148:151]
    v_mfma_f32_16x16x32_bf16 v[152:155], a[132:135], v[128:131], v[152:155]
    v_mfma_f32_16x16x32_bf16 v[156:159], a[52:55], v[124:127], v[156:159]
    v_mfma_f32_16x16x32_bf16 v[160:163], a[52:55], v[128:131], v[160:163]
    s_waitcnt lgkmcnt(2)
    v_mfma_f32_16x16x32_bf16 v[140:143], a[216:219], v[132:135], v[140:143]
    ds_read_b128 v[124:127], v11 offset:32768
    v_mfma_f32_16x16x32_bf16 v[144:147], a[216:219], v[136:139], v[144:147]
    ds_read_b128 v[128:131], v11 offset:34816
    v_mfma_f32_16x16x32_bf16 v[148:151], a[136:139], v[132:135], v[148:151]
    v_mfma_f32_16x16x32_bf16 v[152:155], a[136:139], v[136:139], v[152:155]
    v_mfma_f32_16x16x32_bf16 v[156:159], a[56:59], v[132:135], v[156:159]
    v_mfma_f32_16x16x32_bf16 v[160:163], a[56:59], v[136:139], v[160:163]
    s_waitcnt lgkmcnt(2)
    v_mfma_f32_16x16x32_bf16 v[140:143], a[220:223], v[116:119], v[140:143]
    ds_read_b128 v[132:135], v12 offset:32768
    v_mfma_f32_16x16x32_bf16 v[144:147], a[220:223], v[120:123], v[144:147]
    ds_read_b128 v[136:139], v12 offset:34816
    v_mfma_f32_16x16x32_bf16 v[148:151], a[140:143], v[116:119], v[148:151]
    v_mfma_f32_16x16x32_bf16 v[152:155], a[140:143], v[120:123], v[152:155]
    v_mfma_f32_16x16x32_bf16 v[156:159], a[60:63], v[116:119], v[156:159]
    v_mfma_f32_16x16x32_bf16 v[160:163], a[60:63], v[120:123], v[160:163]
    s_waitcnt lgkmcnt(2)
    v_mfma_f32_16x16x32_bf16 v[140:143], a[224:227], v[124:127], v[140:143]
    ds_read_b128 v[116:119], v11 offset:36864
    v_mfma_f32_16x16x32_bf16 v[144:147], a[224:227], v[128:131], v[144:147]
    ds_read_b128 v[120:123], v11 offset:38912
    v_mfma_f32_16x16x32_bf16 v[148:151], a[144:147], v[124:127], v[148:151]
    v_mfma_f32_16x16x32_bf16 v[152:155], a[144:147], v[128:131], v[152:155]
    v_mfma_f32_16x16x32_bf16 v[156:159], a[64:67], v[124:127], v[156:159]
    v_mfma_f32_16x16x32_bf16 v[160:163], a[64:67], v[128:131], v[160:163]
    s_waitcnt lgkmcnt(2)
    v_mfma_f32_16x16x32_bf16 v[140:143], a[228:231], v[132:135], v[140:143]
    ds_read_b128 v[124:127], v12 offset:36864
    v_mfma_f32_16x16x32_bf16 v[144:147], a[228:231], v[136:139], v[144:147]
    ds_read_b128 v[128:131], v12 offset:38912
    v_mfma_f32_16x16x32_bf16 v[148:151], a[148:151], v[132:135], v[148:151]
    v_mfma_f32_16x16x32_bf16 v[152:155], a[148:151], v[136:139], v[152:155]
    v_mfma_f32_16x16x32_bf16 v[156:159], a[68:71], v[132:135], v[156:159]
    v_mfma_f32_16x16x32_bf16 v[160:163], a[68:71], v[136:139], v[160:163]
    s_waitcnt lgkmcnt(0)
    v_mfma_f32_16x16x32_bf16 v[140:143], a[232:235], v[116:119], v[140:143]
    v_mfma_f32_16x16x32_bf16 v[144:147], a[232:235], v[120:123], v[144:147]
    v_mfma_f32_16x16x32_bf16 v[140:143], a[236:239], v[124:127], v[140:143]
    v_mfma_f32_16x16x32_bf16 v[144:147], a[236:239], v[128:131], v[144:147]
    v_mfma_f32_16x16x32_bf16 v[148:151], a[152:155], v[116:119], v[148:151]
    v_add_u32 v11, s49, v11
    v_add_u32 v12, s49, v12
    v_mfma_f32_16x16x32_bf16 v[152:155], a[152:155], v[120:123], v[152:155]
    s_sub_u32 s47, s47, s49
    s_sub_u32 s49, 0, s49
    v_mfma_f32_16x16x32_bf16 v[148:151], a[156:159], v[124:127], v[148:151]
    v_mfma_f32_16x16x32_bf16 v[152:155], a[156:159], v[128:131], v[152:155]
    v_mfma_f32_16x16x32_bf16 v[156:159], a[72:75], v[116:119], v[156:159]
    v_cvt_pk_bf16_f32 v164, v140, v141
    v_cvt_pk_bf16_f32 v165, v142, v143
    v_mfma_f32_16x16x32_bf16 v[160:163], a[72:75], v[120:123], v[160:163]
    v_cvt_pk_bf16_f32 v166, v144, v145
    v_cvt_pk_bf16_f32 v167, v146, v147
    v_mfma_f32_16x16x32_bf16 v[156:159], a[76:79], v[124:127], v[156:159]
    v_permlane16_swap_b32 v164, v166
    v_permlane16_swap_b32 v165, v167
    v_mfma_f32_16x16x32_bf16 v[160:163], a[76:79], v[128:131], v[160:163]
    v_mov_b32 v3, 460288
L_pf_47:
    buffer_load_dword v4, v3, s[4:7], s38 offen sc1
    s_sub_u32 s36, s36, 1
    s_cbranch_scc1 L_exit
    s_waitcnt vmcnt(0) lgkmcnt(0)
    v_readfirstlane_b32 s90, v4
    s_nop 0
    s_cmp_eq_u32 s90, 0
    s_cbranch_scc1 L_pf_47
    s_and_b32 s90, s90, 2
    s_lshl_b32 s90, s90, 12
    v_add_u32 v214, s90, v214
    v_add_u32 v215, s90, v215
    v_add_u32 v223, 16384, v214
    v_add_u32 v224, 16384, v215
L_qkv_loop_s:
    s_mov_b32 m0, s48
    s_nop 0
    buffer_load_dwordx4 v13, s[4:7], s42 offen sc1 lds
    buffer_load_dwordx4 v13, s[4:7], s42 offen offset:1024 sc1 lds
    buffer_load_dword v14, s[4:7], s42 offen offset:2048 sc1 lds
    buffer_load_dword v14, s[4:7], s42 offen offset:2304 sc1 lds
    v_cvt_pk_bf16_f32 v168, v148, v149
    v_cvt_pk_bf16_f32 v169, v150, v151
    v_cvt_pk_bf16_f32 v170, v152, v153
    v_cvt_pk_bf16_f32 v171, v154, v155
    s_nop 0
    v_permlane16_swap_b32 v168, v170
    v_permlane16_swap_b32 v169, v171
    ds_write_b128 v34, v[168:171]
    v_cvt_pk_bf16_f32 v172, v156, v157
    v_cvt_pk_bf16_f32 v173, v158, v159
    v_cvt_pk_bf16_f32 v174, v160, v161
    v_cvt_pk_bf16_f32 v175, v162, v163
    s_nop 0
    v_permlane16_swap_b32 v172, v174
    v_permlane16_swap_b32 v173, v175
    ds_read_b128 v[100:103], v35
    ds_read_b128 v[104:107], v35 offset:1024
    s_add_u32 s90, s37, 4
    s_min_u32 s90, s90, 63
    s_mul_i32 s46, s90, 40960
L_poll_49:
    buffer_load_dwordx4 v13, s[4:7], s42 offen sc1 lds
    buffer_load_dwordx4 v13, s[4:7], s42 offen offset:1024 sc1 lds
    buffer_load_dword v14, s[4:7], s42 offen offset:2048 sc1 lds
    buffer_load_dword v14, s[4:7], s42 offen offset:2304 sc1 lds
    s_sub_u32 s36, s36, 1
    s_cbranch_scc1 L_exit
    s_waitcnt vmcnt(4)
    ds_read_b32 v33, v15
    s_waitcnt lgkmcnt(0)
    v_cmp_eq_u32 vcc, -1, v33
    s_cbranch_vccnz L_poll_49
    s_barrier
    ds_read_b128 v[40:43], v16 offset:0
    ds_read_b128 v[44:47], v16 offset:1024
    ds_read_b128 v[48:51], v16 offset:2048
    ds_read_b128 v[52:55], v16 offset:3072
    s_waitcnt lgkmcnt(3)
    v_smfmac_f32_16x16x64_bf16 v[80:83], v[40:43], a[160:167], v18
    ds_read_b128 v[56:59], v16 offset:4096
    s_waitcnt lgkmcnt(3)
    v_smfmac_f32_16x16x64_bf16 v[80:83], v[44:47], a[168:175], v18
    ds_read_b128 v[60:63], v16 offset:5120
    s_waitcnt lgkmcnt(3)
    v_smfmac_f32_16x16x64_bf16 v[80:83], v[48:51], a[176:183], v18
    ds_read_b128 v[64:67], v16 offset:6144
    s_waitcnt lgkmcnt(3)
    v_smfmac_f32_16x16x64_bf16 v[80:83], v[52:55], a[184:191], v18
    ds_read_b128 v[68:71], v16 offset:7168
    s_waitcnt lgkmcnt(3)
    v_smfmac_f32_16x16x64_bf16 v[80:83], v[56:59], a[192:199], v18
    ds_read_b128 v[72:75], v16 offset:8192
    s_waitcnt lgkmcnt(3)
    v_smfmac_f32_16x16x64_bf16 v[80:83], v[60:63], a[200:207], v18
    ds_read_b128 v[76:79], v16 offset:9216
    s_waitcnt lgkmcnt(3)
    v_smfmac_f32_16x16x64_bf16 v[80:83], v[64:67], a[208:215], v18
    s_waitcnt lgkmcnt(2)
    v_smfmac_f32_16x16x64_bf16 v[80:83], v[68:71], a[216:223], v18
    s_waitcnt lgkmcnt(1)
    v_smfmac_f32_16x16x64_bf16 v[80:83], v[72:75], a[224:231], v18
    s_waitcnt lgkmcnt(0)
    v_smfmac_f32_16x16x64_bf16 v[80:83], v[76:79], a[232:239], v18
L_got_48r:
    v_smfmac_f32_16x16x64_bf16 v[84:87], v[40:43], a[0:7], v18
    v_smfmac_f32_16x16x64_bf16 v[84:87], v[44:47], a[8:15], v18
    v_smfmac_f32_16x16x64_bf16 v[84:87], v[48:51], a[16:23], v18
    v_add_f32 v80, v80, v82
    v_add_f32 v81, v81, v83
    v_smfmac_f32_16x16x64_bf16 v[84:87], v[52:55], a[24:31], v18
    v_cvt_pk_bf16_f32 v112, v80, v81
    ds_write_b32 v19, v112
    v_smfmac_f32_16x16x64_bf16 v[84:87], v[56:59], a[32:39], v18
    ds_read_b64_tr_b16 v[112:113], v20
    ds_read_b64_tr_b16 v[114:115], v20 offset:128
    v_smfmac_f32_16x16x64_bf16 v[84:87], v[60:63], a[40:47], v18
    v_cmp_u_f32 vcc, v80, v81
    v_smfmac_f32_16x16x64_bf16 v[84:87], v[64:67], a[48:55], v18
    buffer_store_dword v32, v225, s[4:7], s38 offen sc1
    v_smfmac_f32_16x16x64_bf16 v[84:87], v[68:71], a[56:63], v18
    s_cbranch_vccnz L_nan_50
L_cont_51:
    v_smfmac_f32_16x16x64_bf16 v[84:87], v[72:75], a[64:71], v18
    s_waitcnt lgkmcnt(0)
    buffer_store_dwordx4 v[112:115], v21, s[4:7], s42 offen sc1
    v_smfmac_f32_16x16x64_bf16 v[84:87], v[76:79], a[72:79], v18
    v_smfmac_f32_16x16x64_bf16 v[88:91], v[40:43], a[80:87], v18
    v_smfmac_f32_16x16x64_bf16 v[88:91], v[44:47], a[88:95], v18
    v_smfmac_f32_16x16x64_bf16 v[88:91], v[48:51], a[96:103], v18
    v_smfmac_f32_16x16x64_bf16 v[88:91], v[52:55], a[104:111], v18
    v_smfmac_f32_16x16x64_bf16 v[88:91], v[56:59], a[112:119], v18
    v_add_f32 v84, v84, v86
    v_add_f32 v85, v85, v87
    v_smfmac_f32_16x16x64_bf16 v[88:91], v[60:63], a[120:127], v18
    v_cvt_pk_bf16_f32 v176, v84, v85
    v_smfmac_f32_16x16x64_bf16 v[88:91], v[64:67], a[128:135], v18
    v_smfmac_f32_16x16x64_bf16 v[88:91], v[68:71], a[136:143], v18
    v_smfmac_f32_16x16x64_bf16 v[88:91], v[72:75], a[144:151], v18
    v_smfmac_f32_16x16x64_bf16 v[88:91], v[76:79], a[152:159], v18
    s_nop 7
    v_pk_add_f32 v[88:89], v[88:89], v[90:91]
    v_cvt_pk_bf16_f32 v177, v88, v89
    ds_write_b64 v22, v[176:177]
    s_cmp_eq_u32 s32, 0
    s_cbranch_scc1 L_w0_52
    s_cmp_eq_u32 s32, 3
    s_cbranch_scc1 L_w3_53
    s_waitcnt lgkmcnt(0)
    s_barrier
    ds_read_b64_tr_b16 v[92:93], v23 offset:0
    ds_read_b64_tr_b16 v[94:95], v24 offset:0
    ds_read_b64_tr_b16 v[96:97], v23 offset:1024
    ds_read_b64_tr_b16 v[98:99], v24 offset:1024
    s_waitcnt lgkmcnt(2)
    v_mfma_f32_16x16x32_bf16 v[108:111], v[100:103], v[92:95], 0
    s_waitcnt lgkmcnt(0)
    v_mfma_f32_16x16x32_bf16 v[108:111], v[104:107], v[96:99], v[108:111]
    ds_read_b128 v[116:119], v11 offset:0
    ds_read_b128 v[120:123], v11 offset:2048
    ds_read_b128 v[124:127], v12 offset:0
    ds_read_b128 v[128:131], v12 offset:2048
    s_nop 3
    buffer_store_dwordx4 v[108:111], v25, s[4:7], s42 offen sc1
    s_branch L_join_54
L_w0_52:
    s_waitcnt lgkmcnt(0)
    s_barrier
    ds_read_b64_tr_b16 v[92:93], v23 offset:0
    ds_read_b64_tr_b16 v[94:95], v24 offset:0
    ds_read_b64_tr_b16 v[96:97], v23 offset:1024
    ds_read_b64_tr_b16 v[98:99], v24 offset:1024
    s_waitcnt lgkmcnt(2)
    v_mfma_f32_16x16x32_bf16 v[108:111], v[92:95], v[92:95], 0
    s_waitcnt lgkmcnt(0)
    v_mfma_f32_16x16x32_bf16 v[108:111], v[96:99], v[96:99], v[108:111]
    ds_read_b128 v[116:119], v11 offset:0
    ds_read_b128 v[120:123], v11 offset:2048
    ds_read_b128 v[124:127], v12 offset:0
    ds_read_b128 v[128:131], v12 offset:2048
    s_nop 3
    buffer_store_dword v110, v25, s[4:7], s42 offen sc1
    buffer_store_dword v111, v25, s[4:7], s42 offen offset:8 sc1
    s_branch L_join_54
L_w3_53:
    s_waitcnt lgkmcnt(0)
    s_barrier
    ds_read_b64_tr_b16 v[92:93], v23 offset:0
    ds_read_b64_tr_b16 v[94:95], v24 offset:0
    ds_read_b64_tr_b16 v[96:97], v23 offset:1024
    ds_read_b64_tr_b16 v[98:99], v24 offset:1024
    s_waitcnt lgkmcnt(0)
    ds_read_b128 v[116:119], v11 offset:0
    ds_read_b128 v[120:123], v11 offset:2048
    ds_read_b128 v[124:127], v12 offset:0
    ds_read_b128 v[128:131], v12 offset:2048
    s_waitcnt lgkmcnt(0)
    buffer_store_dwordx4 v[92:95], v26, s[4:7], s44 offen sc1
    buffer_store_dwordx4 v[96:99], v26, s[4:7], s44 offen offset:512 sc1
L_join_54:
    s_cmp_eq_u32 s37, 63
    s_cbranch_scc1 L_skip_55
    s_lshl_b32 s90, s32, 10
    s_add_u32 m0, s90, s47
    s_waitcnt lgkmcnt(2)
    v_mfma_f32_16x16x32_bf16 v[140:143], a[160:163], v[116:119], 0
    ds_read_b128 v[132:135], v11 offset:4096
    v_mfma_f32_16x16x32_bf16 v[144:147], a[160:163], v[120:123], 0
    ds_read_b128 v[136:139], v11 offset:6144
    v_mfma_f32_16x16x32_bf16 v[148:151], a[80:83], v[116:119], 0
    v_mfma_f32_16x16x32_bf16 v[152:155], a[80:83], v[120:123], 0
    v_mfma_f32_16x16x32_bf16 v[156:159], a[0:3], v[116:119], 0
    buffer_store_dwordx4 v[164:167], v29, s[4:7], s51 offen sc1
    v_mfma_f32_16x16x32_bf16 v[160:163], a[0:3], v[120:123], 0
    s_waitcnt lgkmcnt(2)
    v_mfma_f32_16x16x32_bf16 v[140:143], a[164:167], v[124:127], v[140:143]
    ds_read_b128 v[116:119], v12 offset:4096
    v_mfma_f32_16x16x32_bf16 v[144:147], a[164:167], v[128:131], v[144:147]
    ds_read_b128 v[120:123], v12 offset:6144
    v_mfma_f32_16x16x32_bf16 v[148:151], a[84:87], v[124:127], v[148:151]
    buffer_store_dwordx4 v[168:171], v29, s[4:7], s50 offen sc1
    v_mfma_f32_16x16x32_bf16 v[152:155], a[84:87], v[128:131], v[152:155]
    v_mfma_f32_16x16x32_bf16 v[156:159], a[4:7], v[124:127], v[156:159]
    v_mfma_f32_16x16x32_bf16 v[160:163], a[4:7], v[128:131], v[160:163]
    s_waitcnt lgkmcnt(2)
    v_mfma_f32_16x16x32_bf16 v[140:143], a[168:171], v[132:135], v[140:143]
    ds_read_b128 v[124:127], v11 offset:8192
    v_mfma_f32_16x16x32_bf16 v[144:147], a[168:171], v[136:139], v[144:147]
    ds_read_b128 v[128:131], v11 offset:10240
    v_mfma_f32_16x16x32_bf16 v[148:151], a[88:91], v[132:135], v[148:151]
    buffer_store_dwordx4 v[172:175], v29, s[4:7], s45 offen sc1
    v_mfma_f32_16x16x32_bf16 v[152:155], a[88:91], v[136:139], v[152:155]
    v_mfma_f32_16x16x32_bf16 v[156:159], a[8:11], v[132:135], v[156:159]
    buffer_store_dword v36, v226, s[4:7], s43 offen offset:0 sc1
    v_mfma_f32_16x16x32_bf16 v[160:163], a[8:11], v[136:139], v[160:163]
    s_waitcnt lgkmcnt(2)
    v_mfma_f32_16x16x32_bf16 v[140:143], a[172:175], v[116:119], v[140:143]
    ds_read_b128 v[132:135], v12 offset:8192
    v_mfma_f32_16x16x32_bf16 v[144:147], a[172:175], v[120:123], v[144:147]
    ds_read_b128 v[136:139], v12 offset:10240
    v_mfma_f32_16x16x32_bf16 v[148:151], a[92:95], v[116:119], v[148:151]
    buffer_store_dword v36, v227, s[4:7], s43 offen offset:0 sc1
    v_mfma_f32_16x16x32_bf16 v[152:155], a[92:95], v[120:123], v[152:155]
    buffer_store_dword v36, v219, s[4:7], s43 offen offset:0 sc1
    v_mfma_f32_16x16x32_bf16 v[156:159], a[12:15], v[116:119], v[156:159]
    buffer_store_dword v36, v227, s[4:7], s43 offen offset:256 sc1
    v_mfma_f32_16x16x32_bf16 v[160:163], a[12:15], v[120:123], v[160:163]
    s_waitcnt lgkmcnt(2)
    v_mfma_f32_16x16x32_bf16 v[140:143], a[176:179], v[124:127], v[140:143]
    ds_read_b128 v[116:119], v11 offset:12288
    v_mfma_f32_16x16x32_bf16 v[144:147], a[176:179], v[128:131], v[144:147]
    ds_read_b128 v[120:123], v11 offset:14336
    v_mfma_f32_16x16x32_bf16 v[148:151], a[96:99], v[124:127], v[148:151]
    buffer_load_dwordx4 v10, s[24:27], s46 offen offset:0 lds
    s_add_u32 m0, m0, 3968
    v_mfma_f32_16x16x32_bf16 v[152:155], a[96:99], v[128:131], v[152:155]
    buffer_load_dwordx4 v10, s[24:27], s46 offen offset:128 lds
    s_add_u32 m0, m0, 3968
    v_mfma_f32_16x16x32_bf16 v[156:159], a[16:19], v[124:127], v[156:159]
    v_mfma_f32_16x16x32_bf16 v[160:163], a[16:19], v[128:131], v[160:163]
    s_waitcnt lgkmcnt(2)
    v_mfma_f32_16x16x32_bf16 v[140:143], a[180:183], v[132:135], v[140:143]
    ds_read_b128 v[124:127], v12 offset:12288
    v_mfma_f32_16x16x32_bf16 v[144:147], a[180:183], v[136:139], v[144:147]
    ds_read_b128 v[128:131], v12 offset:14336
    v_mfma_f32_16x16x32_bf16 v[148:151], a[100:103], v[132:135], v[148:151]
    buffer_load_dwordx4 v10, s[24:27], s46 offen offset:256 lds
    s_add_u32 m0, m0, 3968
    v_mfma_f32_16x16x32_bf16 v[152:155], a[100:103], v[136:139], v[152:155]
    v_mfma_f32_16x16x32_bf16 v[156:159], a[20:23], v[132:135], v[156:159]
    s_waitcnt vmcnt(7)
    buffer_store_dword v32, v31, s[4:7], s38 offen sc1
    v_mfma_f32_16x16x32_bf16 v[160:163], a[20:23], v[136:139], v[160:163]
    s_waitcnt lgkmcnt(2)
    s_and_b32 s52, s37, 3
    v_mfma_f32_16x16x32_bf16 v[140:143], a[184:187], v[116:119], v[140:143]
    ds_read_b128 v[132:135], v11 offset:16384
    s_mul_i32 s55, s52, 327680
    v_mfma_f32_16x16x32_bf16 v[144:147], a[184:187], v[120:123], v[144:147]
    ds_read_b128 v[136:139], v11 offset:18432
    s_add_u32 s37, s37, 1
    v_mfma_f32_16x16x32_bf16 v[148:151], a[104:107], v[116:119], v[148:151]
    buffer_load_dwordx4 v10, s[24:27], s46 offen offset:384 lds
    s_add_u32 m0, m0, 3968
    v_mfma_f32_16x16x32_bf16 v[152:155], a[104:107], v[120:123], v[152:155]
    s_mov_b32 s54, 0
    s_and_b32 s52, s37, 3
    v_mfma_f32_16x16x32_bf16 v[156:159], a[24:27], v[116:119], v[156:159]
    buffer_load_dwordx4 v10, s[24:27], s46 offen offset:512 lds
    s_add_u32 m0, m0, 3968
    v_mfma_f32_16x16x32_bf16 v[160:163], a[24:27], v[120:123], v[160:163]
    s_waitcnt lgkmcnt(2)
    s_mul_i32 s53, s52, 114688
    v_mfma_f32_16x16x32_bf16 v[140:143], a[188:191], v[124:127], v[140:143]
    ds_read_b128 v[116:119], v12 offset:16384
    s_add_u32 s42, s38, s53
    v_mfma_f32_16x16x32_bf16 v[144:147], a[188:191], v[128:131], v[144:147]
    ds_read_b128 v[120:123], v12 offset:18432
    s_lshl_b32 s52, s52, 12
    v_mfma_f32_16x16x32_bf16 v[148:151], a[108:111], v[124:127], v[148:151]
    buffer_load_dwordx4 v10, s[24:27], s46 offen offset:640 lds
    s_add_u32 m0, m0, 3968
    v_mfma_f32_16x16x32_bf16 v[152:155], a[108:111], v[128:131], v[152:155]
    v_add_u32 v35, s52, v28
    s_xor_b32 s52, s52, 8192
    v_mfma_f32_16x16x32_bf16 v[156:159], a[28:31], v[124:127], v[156:159]
    v_add_u32 v34, s52, v27
    s_add_u32 s44, s42, 40960
    v_mfma_f32_16x16x32_bf16 v[160:163], a[28:31], v[128:131], v[160:163]
    s_waitcnt lgkmcnt(2)
    s_mul_i32 s52, s52, 28
    v_mfma_f32_16x16x32_bf16 v[140:143], a[192:195], v[132:135], v[140:143]
    ds_read_b128 v[124:127], v11 offset:20480
    s_add_u32 s43, s38, s52
    v_mfma_f32_16x16x32_bf16 v[144:147], a[192:195], v[136:139], v[144:147]
    ds_read_b128 v[128:131], v11 offset:22528
    s_add_u32 s53, s37, 2
    v_mfma_f32_16x16x32_bf16 v[148:151], a[112:115], v[132:135], v[148:151]
    buffer_load_dwordx4 v10, s[24:27], s46 offen offset:768 lds
    s_add_u32 m0, m0, 3968
    v_mfma_f32_16x16x32_bf16 v[152:155], a[112:115], v[136:139], v[152:155]
    s_and_b32 s53, s53, 7
    s_mul_i32 s53, s53, 98304
    v_mfma_f32_16x16x32_bf16 v[156:159], a[32:35], v[132:135], v[156:159]
    buffer_load_dwordx4 v10, s[24:27], s46 offen offset:896 lds
    s_add_u32 m0, m0, 3968
    v_mfma_f32_16x16x32_bf16 v[160:163], a[32:35], v[136:139], v[160:163]
    s_waitcnt lgkmcnt(2)
    s_add_u32 s53, s53, 475136
    v_mfma_f32_16x16x32_bf16 v[140:143], a[196:199], v[116:119], v[140:143]
    ds_read_b128 v[132:135], v12 offset:20480
    s_add_u32 s45, s38, s53
    v_mfma_f32_16x16x32_bf16 v[144:147], a[196:199], v[120:123], v[144:147]
    ds_read_b128 v[136:139], v12 offset:22528
    s_add_u32 s50, s45, 49152
    v_mfma_f32_16x16x32_bf16 v[148:151], a[116:119], v[116:119], v[148:151]
    buffer_load_dwordx4 v10, s[24:27], s46 offen offset:1024 lds
    s_add_u32 m0, m0, 3968
    v_mfma_f32_16x16x32_bf16 v[152:155], a[116:119], v[120:123], v[152:155]
    s_add_u32 s51, s43, 65536
    v_add_u32 v32, s37, v220
    v_mfma_f32_16x16x32_bf16 v[156:159], a[36:39], v[116:119], v[156:159]
    v_mov_b32 v80, 0
    v_mov_b32 v81, 0
    v_mfma_f32_16x16x32_bf16 v[160:163], a[36:39], v[120:123], v[160:163]
    s_waitcnt lgkmcnt(2)
    v_mov_b32 v82, 0
    v_mfma_f32_16x16x32_bf16 v[140:143], a[200:203], v[124:127], v[140:143]
    ds_read_b128 v[116:119], v11 offset:24576
    v_mov_b32 v83, 0
    v_mfma_f32_16x16x32_bf16 v[144:147], a[200:203], v[128:131], v[144:147]
    ds_read_b128 v[120:123], v11 offset:26624
    v_mov_b32 v84, 0
    v_mfma_f32_16x16x32_bf16 v[148:151], a[120:123], v[124:127], v[148:151]
    buffer_load_dwordx4 v10, s[24:27], s46 offen offset:1152 lds
    v_mfma_f32_16x16x32_bf16 v[152:155], a[120:123], v[128:131], v[152:155]
    v_mov_b32 v85, 0
    v_mov_b32 v86, 0
    v_mfma_f32_16x16x32_bf16 v[156:159], a[40:43], v[124:127], v[156:159]
    v_mov_b32 v87, 0
    v_mov_b32 v88, 0
    v_mfma_f32_16x16x32_bf16 v[160:163], a[40:43], v[128:131], v[160:163]
    s_waitcnt lgkmcnt(2)
    v_mov_b32 v89, 0
    v_mfma_f32_16x16x32_bf16 v[140:143], a[204:207], v[132:135], v[140:143]
    ds_read_b128 v[124:127], v12 offset:24576
    v_mov_b32 v90, 0
    v_mfma_f32_16x16x32_bf16 v[144:147], a[204:207], v[136:139], v[144:147]
    ds_read_b128 v[128:131], v12 offset:26624
    v_mov_b32 v91, 0
    v_mfma_f32_16x16x32_bf16 v[148:151], a[124:127], v[132:135], v[148:151]
    v_mfma_f32_16x16x32_bf16 v[152:155], a[124:127], v[136:139], v[152:155]
    buffer_load_dword v217, v216, s[4:7], s38 offen sc1
    v_mfma_f32_16x16x32_bf16 v[156:159], a[44:47], v[132:135], v[156:159]
    v_mfma_f32_16x16x32_bf16 v[160:163], a[44:47], v[136:139], v[160:163]
    s_waitcnt lgkmcnt(2)
    v_mfma_f32_16x16x32_bf16 v[140:143], a[208:211], v[116:119], v[140:143]
    ds_read_b128 v[132:135], v11 offset:28672
    v_mfma_f32_16x16x32_bf16 v[144:147], a[208:211], v[120:123], v[144:147]
    ds_read_b128 v[136:139], v11 offset:30720
    v_mfma_f32_16x16x32_bf16 v[148:151], a[128:131], v[116:119], v[148:151]
    v_mfma_f32_16x16x32_bf16 v[152:155], a[128:131], v[120:123], v[152:155]
    v_mfma_f32_16x16x32_bf16 v[156:159], a[48:51], v[116:119], v[156:159]
    v_mfma_f32_16x16x32_bf16 v[160:163], a[48:51], v[120:123], v[160:163]
    s_waitcnt lgkmcnt(2)
    v_mfma_f32_16x16x32_bf16 v[140:143], a[212:215], v[124:127], v[140:143]
    ds_read_b128 v[116:119], v12 offset:28672
    v_mfma_f32_16x16x32_bf16 v[144:147], a[212:215], v[128:131], v[144:147]
    ds_read_b128 v[120:123], v12 offset:30720
    v_mfma_f32_16x16x32_bf16 v[148:151], a[132:135], v[124:127], v[148:151]
    v_mfma_f32_16x16x32_bf16 v[152:155], a[132:135], v[128:131], v[152:155]
    v_mfma_f32_16x16x32_bf16 v[156:159], a[52:55], v[124:127], v[156:159]
    v_mfma_f32_16x16x32_bf16 v[160:163], a[52:55], v[128:131], v[160:163]
    s_waitcnt lgkmcnt(2)
    s_waitcnt vmcnt(0)
    v_cmp_gt_u32 vcc, s37, v217
    s_cbranch_vccnz L_tw_56
L_tok_57:
    s_barrier
    buffer_load_dwordx4 v[180:183], v214, s[4:7], s55 offen sc1
    buffer_load_dwordx4 v[184:187], v215, s[4:7], s55 offen sc1
    v_mfma_f32_16x16x32_bf16 v[140:143], a[216:219], v[132:135], v[140:143]
    ds_read_b128 v[124:127], v11 offset:32768
    v_mfma_f32_16x16x32_bf16 v[144:147], a[216:219], v[136:139], v[144:147]
    ds_read_b128 v[128:131], v11 offset:34816
    v_mfma_f32_16x16x32_bf16 v[148:151], a[136:139], v[132:135], v[148:151]
    v_mfma_f32_16x16x32_bf16 v[152:155], a[136:139], v[136:139], v[152:155]
    v_mfma_f32_16x16x32_bf16 v[156:159], a[56:59], v[132:135], v[156:159]
    v_mfma_f32_16x16x32_bf16 v[160:163], a[56:59], v[136:139], v[160:163]
    s_waitcnt lgkmcnt(2)
    v_mfma_f32_16x16x32_bf16 v[140:143], a[220:223], v[116:119], v[140:143]
    ds_read_b128 v[132:135], v12 offset:32768
    v_mfma_f32_16x16x32_bf16 v[144:147], a[220:223], v[120:123], v[144:147]
    ds_read_b128 v[136:139], v12 offset:34816
    v_mfma_f32_16x16x32_bf16 v[148:151], a[140:143], v[116:119], v[148:151]
    v_mfma_f32_16x16x32_bf16 v[152:155], a[140:143], v[120:123], v[152:155]
    v_mfma_f32_16x16x32_bf16 v[156:159], a[60:63], v[116:119], v[156:159]
    v_mfma_f32_16x16x32_bf16 v[160:163], a[60:63], v[120:123], v[160:163]
    s_waitcnt lgkmcnt(2)
    buffer_load_dwordx4 v[188:191], v223, s[4:7], s55 offen sc1
    buffer_load_dwordx4 v[192:195], v224, s[4:7], s55 offen sc1
    v_mfma_f32_16x16x32_bf16 v[140:143], a[224:227], v[124:127], v[140:143]
    ds_read_b128 v[116:119], v11 offset:36864
    v_mfma_f32_16x16x32_bf16 v[144:147], a[224:227], v[128:131], v[144:147]
    ds_read_b128 v[120:123], v11 offset:38912
    v_mfma_f32_16x16x32_bf16 v[148:151], a[144:147], v[124:127], v[148:151]
    v_mfma_f32_16x16x32_bf16 v[152:155], a[144:147], v[128:131], v[152:155]
    v_mfma_f32_16x16x32_bf16 v[156:159], a[64:67], v[124:127], v[156:159]
    v_mfma_f32_16x16x32_bf16 v[160:163], a[64:67], v[128:131], v[160:163]
    s_waitcnt lgkmcnt(2)
    v_mfma_f32_16x16x32_bf16 v[140:143], a[228:231], v[132:135], v[140:143]
    ds_read_b128 v[124:127], v12 offset:36864
    v_mfma_f32_16x16x32_bf16 v[144:147], a[228:231], v[136:139], v[144:147]
    ds_read_b128 v[128:131], v12 offset:38912
    v_mfma_f32_16x16x32_bf16 v[148:151], a[148:151], v[132:135], v[148:151]
    v_mfma_f32_16x16x32_bf16 v[152:155], a[148:151], v[136:139], v[152:155]
    v_mfma_f32_16x16x32_bf16 v[156:159], a[68:71], v[132:135], v[156:159]
    v_mfma_f32_16x16x32_bf16 v[160:163], a[68:71], v[136:139], v[160:163]
    s_waitcnt lgkmcnt(0)
    s_waitcnt vmcnt(3)
    v_mfma_f32_16x16x32_bf16 v[196:199], v[210:213], v[180:183], 0
    v_mfma_f32_16x16x32_bf16 v[200:203], v[208:211], v[180:183], 0
    v_max3_u32 v221, v180, v181, v182
    s_waitcnt vmcnt(2)
    v_mfma_f32_16x16x32_bf16 v[196:199], v[210:213], v[184:187], v[196:199]
    v_max3_u32 v222, v183, v184, v185
    v_max3_u32 v221, v221, v186, v187
    v_mfma_f32_16x16x32_bf16 v[200:203], v[208:211], v[184:187], v[200:203]
    v_max_u32 v221, v221, v222
    v_cmp_eq_u32 vcc, -1, v221
    s_nop 2
    v_cvt_pk_bf16_f32 v204, v196, v197
    v_cvt_pk_bf16_f32 v205, v198, v199
    s_cbranch_vccnz L_pp_58
    v_cvt_pk_bf16_f32 v206, v200, v201
    v_cvt_pk_bf16_f32 v207, v202, v203
    buffer_store_dwordx4 v[204:207], v218, s[4:7], s42 offen sc1
L_pc_59:
    v_mfma_f32_16x16x32_bf16 v[140:143], a[232:235], v[116:119], v[140:143]
    v_mfma_f32_16x16x32_bf16 v[144:147], a[232:235], v[120:123], v[144:147]
    v_mfma_f32_16x16x32_bf16 v[140:143], a[236:239], v[124:127], v[140:143]
    v_mfma_f32_16x16x32_bf16 v[144:147], a[236:239], v[128:131], v[144:147]
    v_mfma_f32_16x16x32_bf16 v[148:151], a[152:155], v[116:119], v[148:151]
    v_add_u32 v11, s49, v11
    v_add_u32 v12, s49, v12
    v_mfma_f32_16x16x32_bf16 v[152:155], a[152:155], v[120:123], v[152:155]
    s_sub_u32 s47, s47, s49
    s_sub_u32 s49, 0, s49
    v_mfma_f32_16x16x32_bf16 v[148:151], a[156:159], v[124:127], v[148:151]
    v_mfma_f32_16x16x32_bf16 v[152:155], a[156:159], v[128:131], v[152:155]
    v_mfma_f32_16x16x32_bf16 v[156:159], a[72:75], v[116:119], v[156:159]
    v_cvt_pk_bf16_f32 v164, v140, v141
    v_cvt_pk_bf16_f32 v165, v142, v143
    v_mfma_f32_16x16x32_bf16 v[160:163], a[72:75], v[120:123], v[160:163]
    v_cvt_pk_bf16_f32 v166, v144, v145
    v_cvt_pk_bf16_f32 v167, v146, v147
    v_mfma_f32_16x16x32_bf16 v[156:159], a[76:79], v[124:127], v[156:159]
    v_permlane16_swap_b32 v164, v166
    v_permlane16_swap_b32 v165, v167
    v_mfma_f32_16x16x32_bf16 v[160:163], a[76:79], v[128:131], v[160:163]
    s_branch L_qkv_loop_s
L_skip_55:
    s_waitcnt vmcnt(0) lgkmcnt(0)
    buffer_store_dword v32, v31, s[4:7], s38 offen sc1
    s_endpgm
L_nan_50:
    s_cmp_eq_u32 s54, 1
    s_cbranch_scc1 L_cont_51
    v_lshlrev_b32 v1, 4, v0
L_nan_50r:
    s_mov_b32 s90, s42
    v_mov_b32 v2, 0
    buffer_load_dwordx4 v[40:43], v1, s[4:7], s90 offen sc1
    s_add_u32 s90, s90, 1024
    buffer_load_dwordx4 v[44:47], v1, s[4:7], s90 offen sc1
    s_add_u32 s90, s90, 1024
    buffer_load_dwordx4 v[48:51], v1, s[4:7], s90 offen sc1
    s_add_u32 s90, s90, 1024
    buffer_load_dwordx4 v[52:55], v1, s[4:7], s90 offen sc1
    s_add_u32 s90, s90, 1024
    buffer_load_dwordx4 v[56:59], v1, s[4:7], s90 offen sc1
    s_add_u32 s90, s90, 1024
    buffer_load_dwordx4 v[60:63], v1, s[4:7], s90 offen sc1
    s_add_u32 s90, s90, 1024
    buffer_load_dwordx4 v[64:67], v1, s[4:7], s90 offen sc1
    s_add_u32 s90, s90, 1024
    buffer_load_dwordx4 v[68:71], v1, s[4:7], s90 offen sc1
    s_add_u32 s90, s90, 1024
    buffer_load_dwordx4 v[72:75], v1, s[4:7], s90 offen sc1
    s_add_u32 s90, s90, 1024
    buffer_load_dwordx4 v[76:79], v1, s[4:7], s90 offen sc1
    s_add_u32 s90, s90, 1024
    s_sub_u32 s36, s36, 1
    s_cbranch_scc1 L_exit
    s_waitcnt vmcnt(0) lgkmcnt(0)
    v_max3_u32 v2, v2, v40, v41
    v_max3_u32 v2, v2, v42, v43
    v_max3_u32 v2, v2, v44, v45
    v_max3_u32 v2, v2, v46, v47
    v_max3_u32 v2, v2, v48, v49
    v_max3_u32 v2, v2, v50, v51
    v_max3_u32 v2, v2, v52, v53
    v_max3_u32 v2, v2, v54, v55
    v_max3_u32 v2, v2, v56, v57
    v_max3_u32 v2, v2, v58, v59
    v_max3_u32 v2, v2, v60, v61
    v_max3_u32 v2, v2, v62, v63
    v_max3_u32 v2, v2, v64, v65
    v_max3_u32 v2, v2, v66, v67
    v_max3_u32 v2, v2, v68, v69
    v_max3_u32 v2, v2, v70, v71
    v_max3_u32 v2, v2, v72, v73
    v_max3_u32 v2, v2, v74, v75
    v_max3_u32 v2, v2, v76, v77
    v_max3_u32 v2, v2, v78, v79
    v_cmp_eq_u32 vcc, -1, v2
    s_cbranch_vccnz L_nan_50r
    s_mov_b32 s54, 1
    v_mov_b32 v80, 0
    v_mov_b32 v81, 0
    v_mov_b32 v82, 0
    v_mov_b32 v83, 0
    v_mov_b32 v84, 0
    v_mov_b32 v85, 0
    v_mov_b32 v86, 0
    v_mov_b32 v87, 0
    v_mov_b32 v88, 0
    v_mov_b32 v89, 0
    v_mov_b32 v90, 0
    v_mov_b32 v91, 0
    v_smfmac_f32_16x16x64_bf16 v[80:83], v[40:43], a[160:167], v18
    v_smfmac_f32_16x16x64_bf16 v[80:83], v[44:47], a[168:175], v18
    v_smfmac_f32_16x16x64_bf16 v[80:83], v[48:51], a[176:183], v18
    v_smfmac_f32_16x16x64_bf16 v[80:83], v[52:55], a[184:191], v18
    v_smfmac_f32_16x16x64_bf16 v[80:83], v[56:59], a[192:199], v18
    v_smfmac_f32_16x16x64_bf16 v[80:83], v[60:63], a[200:207], v18
    v_smfmac_f32_16x16x64_bf16 v[80:83], v[64:67], a[208:215], v18
    v_smfmac_f32_16x16x64_bf16 v[80:83], v[68:71], a[216:223], v18
    v_smfmac_f32_16x16x64_bf16 v[80:83], v[72:75], a[224:231], v18
    v_smfmac_f32_16x16x64_bf16 v[80:83], v[76:79], a[232:239], v18
    s_nop 3
    s_branch L_got_48r
L_wo_s:
    s_mov_b32 s12, s80
    s_and_b32 s13, s81, 0xffff
    s_mov_b32 s14, 7864320
    s_mov_b32 s15, 0x20000
    s_mov_b32 s16, s72
    s_and_b32 s17, s73, 0xffff
    s_mov_b32 s18, 10240
    s_mov_b32 s19, 0x20000
    s_sub_u32 s40, s35, 12
    v_and_b32 v1, 15, v0
    v_lshrrev_b32 v2, 4, v0
    v_lshrrev_b32 v3, 3, v0
    v_and_b32 v4, 7, v0
    v_and_b32 v6, 2, v3
    v_xor_b32 v6, v6, v4
    v_lshlrev_b32 v6, 4, v6
    v_mul_u32_u24 v7, 1280, v3
    s_lshl_b32 s90, s34, 2
    s_add_u32 s90, s90, s32
    s_mul_i32 s90, s90, 245760
    s_lshl_b32 s91, s40, 7
    s_add_u32 s90, s90, s91
    v_add3_u32 v180, v6, v7, s90
    v_xor_b32 v181, 64, v180
    s_mul_i32 s90, s40, 32768
    s_lshl_b32 s91, s32, 11
    s_add_u32 s90, s90, s91
    s_lshr_b32 s91, s32, 1
    s_mul_i32 s91, s91, 0
    s_xor_b32 s91, s91, s34
    v_mul_u32_u24 v7, 0, v2
    v_xor_b32 v7, s91, v7
    v_lshlrev_b32 v6, 4, v1
    v_lshl_add_u32 v7, v7, 8, v6
    v_lshl_add_u32 v7, v2, 13, v7
    v_add_u32 v14, s90, v7
    v_lshlrev_b32 v12, 4, v0
    v_lshlrev_b32 v13, 2, v0
    v_add_u32 v46, s90, v13
    s_xor_b32 s92, s91, 0
    s_lshl_b32 s92, s92, 8
    s_add_u32 s60, s92, 0
    s_xor_b32 s92, s91, 0
    s_lshl_b32 s92, s92, 8
    s_add_u32 s61, s92, 8192
    s_xor_b32 s92, s91, 0
    s_lshl_b32 s92, s92, 8
    s_add_u32 s62, s92, 16384
    s_xor_b32 s92, s91, 0
    s_lshl_b32 s92, s92, 8
    s_add_u32 s63, s92, 24576
    s_lshl_b32 s92, s40, 7
    s_lshl_b32 s93, s32, 2
    s_add_u32 s92, s92, s93
    s_add_u32 s92, s92, 460800
    v_mov_b32 v244, s92
    v_cmp_eq_u32 vcc, 0, v0
    v_mov_b32 v9, 2146435072
    s_nop 0
    v_cndmask_b32 v244, v9, v244, vcc
    s_lshl_b32 s92, s32, 7
    s_add_u32 s92, s92, 462336
    v_min_u32 v3, 2, v0
    v_lshl_add_u32 v245, v3, 2, s92
    s_lshl_b32 s90, s40, 2
    s_add_u32 s90, s90, s32
    s_lshl_b32 s91, s90, 8
    v_add_u32 v17, s91, v6
    v_cmp_eq_u32 vcc, 0, v2
    v_mov_b32 v9, 2146435072
    s_nop 0
    v_cndmask_b32 v17, v9, v17, vcc
    v_lshrrev_b32 v3, 2, v1
    v_and_b32 v7, 1, v1
    v_lshl_or_b32 v4, v3, 1, v7
    v_mul_u32_u24 v4, 1280, v4
    v_and_b32 v5, 2, v1
    v_lshl_add_u32 v4, v5, 1, v4
    s_lshl_b32 s91, s90, 5
    v_add_u32 v4, s91, v4
    v_lshlrev_b32 v6, 6, v3
    v_lshl_add_u32 v6, v7, 5, v6
    v_lshl_add_u32 v6, v2, 3, v6
    v_lshl_add_u32 v6, v5, 1, v6
    s_mul_i32 s92, s32, 1152
    s_add_u32 s92, s92, 122880
    v_add_u32 v18, s92, v6
    buffer_load_dword v164, v4, s[16:19], 0 offen offset:0
    buffer_load_dword v165, v4, s[16:19], 0 offen offset:8
    buffer_load_dword v166, v4, s[16:19], 0 offen offset:16
    buffer_load_dword v167, v4, s[16:19], 0 offen offset:24
    v_mov_b32 v168, -1
    v_mov_b32 v169, -1
    v_mov_b32 v170, -1
    v_mov_b32 v171, -1
    s_mul_i32 s90, s32, 24576
    s_mov_b32 m0, s90
    s_mov_b32 s91, 0
    buffer_load_dwordx4 v180, s[12:15], s91 offen nt lds
    s_add_u32 m0, m0, 1024
    s_add_u32 s91, s91, 10240
    buffer_load_dwordx4 v181, s[12:15], s91 offen nt lds
    s_add_u32 m0, m0, 1024
    s_add_u32 s91, s91, 10240
    buffer_load_dwordx4 v180, s[12:15], s91 offen nt lds
    s_add_u32 m0, m0, 1024
    s_add_u32 s91, s91, 10240
    buffer_load_dwordx4 v181, s[12:15], s91 offen nt lds
    s_add_u32 m0, m0, 1024
    s_add_u32 s91, s91, 10240
    buffer_load_dwordx4 v180, s[12:15], s91 offen nt lds
    s_add_u32 m0, m0, 1024
    s_add_u32 s91, s91, 10240
    buffer_load_dwordx4 v181, s[12:15], s91 offen nt lds
    s_add_u32 m0, m0, 1024
    s_add_u32 s91, s91, 10240
    buffer_load_dwordx4 v180, s[12:15], s91 offen nt lds
    s_add_u32 m0, m0, 1024
    s_add_u32 s91, s91, 10240
    buffer_load_dwordx4 v181, s[12:15], s91 offen nt lds
    s_add_u32 m0, m0, 1024
    s_add_u32 s91, s91, 10240
    buffer_load_dwordx4 v180, s[12:15], s91 offen nt lds
    s_add_u32 m0, m0, 1024
    s_add_u32 s91, s91, 10240
    buffer_load_dwordx4 v181, s[12:15], s91 offen nt lds
    s_add_u32 m0, m0, 1024
    s_add_u32 s91, s91, 10240
    buffer_load_dwordx4 v180, s[12:15], s91 offen nt lds
    s_add_u32 m0, m0, 1024
    s_add_u32 s91, s91, 10240
    buffer_load_dwordx4 v181, s[12:15], s91 offen nt lds
    s_add_u32 m0, m0, 1024
    s_add_u32 s91, s91, 10240
    buffer_load_dwordx4 v180, s[12:15], s91 offen nt lds
    s_add_u32 m0, m0, 1024
    s_add_u32 s91, s91, 10240
    buffer_load_dwordx4 v181, s[12:15], s91 offen nt lds
    s_add_u32 m0, m0, 1024
    s_add_u32 s91, s91, 10240
    buffer_load_dwordx4 v180, s[12:15], s91 offen nt lds
    s_add_u32 m0, m0, 1024
    s_add_u32 s91, s91, 10240
    buffer_load_dwordx4 v181, s[12:15], s91 offen nt lds
    s_add_u32 m0, m0, 1024
    s_add_u32 s91, s91, 10240
    buffer_load_dwordx4 v180, s[12:15], s91 offen nt lds
    s_add_u32 m0, m0, 1024
    s_add_u32 s91, s91, 10240
    buffer_load_dwordx4 v181, s[12:15], s91 offen nt lds
    s_add_u32 m0, m0, 1024
    s_add_u32 s91, s91, 10240
    buffer_load_dwordx4 v180, s[12:15], s91 offen nt lds
    s_add_u32 m0, m0, 1024
    s_add_u32 s91, s91, 10240
    buffer_load_dwordx4 v181, s[12:15], s91 offen nt lds
    s_add_u32 m0, m0, 1024
    s_add_u32 s91, s91, 10240
    buffer_load_dwordx4 v180, s[12:15], s91 offen nt lds
    s_add_u32 m0, m0, 1024
    s_add_u32 s91, s91, 10240
    buffer_load_dwordx4 v181, s[12:15], s91 offen nt lds
    s_add_u32 m0, m0, 1024
    s_add_u32 s91, s91, 10240
    buffer_load_dwordx4 v180, s[12:15], s91 offen nt lds
    s_add_u32 m0, m0, 1024
    s_add_u32 s91, s91, 10240
    buffer_load_dwordx4 v181, s[12:15], s91 offen nt lds
    s_waitcnt vmcnt(24)
    v_min_u32 v164, -2, v164
    v_min_u32 v165, -2, v165
    v_min_u32 v166, -2, v166
    v_min_u32 v167, -2, v167
    v_and_b32 v7, 2, v1
    v_cmp_ne_u32 vcc, 0, v7
    v_mov_b32 v5, 0x4444
    v_mov_b32 v6, 0xeeee
    v_cndmask_b32 v10, v5, v6, vcc
    v_mov_b32 v5, 0xe484
    v_mov_b32 v6, 0xee9e
    v_cndmask_b32 v7, v5, v6, vcc
    v_mov_b32 v5, 0x84e4
    v_mov_b32 v6, 0x9eee
    v_cndmask_b32 v8, v5, v6, vcc
    v_cmp_gt_u32 vcc, 2, v2
    s_nop 1
    v_cndmask_b32 v11, v8, v7, vcc
    v_mov_b32 v84, 1065369472
    v_mov_b32 v85, 1065369472
    v_mov_b32 v86, 1065369472
    v_mov_b32 v87, 0
    v_mov_b32 v88, 1065369472
    v_mov_b32 v89, 1065369472
    v_mov_b32 v90, 1065369472
    v_mov_b32 v91, 0
    v_mov_b32 v51, 0
    v_mov_b32 v55, 0
    v_mov_b32 v59, 0
    v_mov_b32 v63, 0
    v_mov_b32 v67, 0
    v_mov_b32 v71, 0
    v_mov_b32 v75, 0
    v_mov_b32 v79, 0
    v_mov_b32 v210, 0
    v_mov_b32 v211, 0
    v_mov_b32 v218, 0
    v_mov_b32 v219, 0
    v_and_b32 v7, 1, v1
    v_cmp_ne_u32 vcc, 0, v7
    v_mov_b32 v5, 0x3f80
    v_mov_b32 v6, 0x3f800000
    v_cndmask_b32 v5, v5, v6, vcc
    v_bfe_u32 v6, v1, 1, 1
    v_cmp_eq_u32 vcc, 0, v6
    s_nop 1
    v_cndmask_b32 v110, 0, v5, vcc
    v_mov_b32 v108, 0
    v_mov_b32 v112, 0
    v_cmp_eq_u32 vcc, 1, v6
    s_nop 1
    v_cndmask_b32 v111, 0, v5, vcc
    v_mov_b32 v109, 0
    v_mov_b32 v113, 0
    v_mov_b32 v240, 0x3dd53b95
    v_mov_b32 v241, 0x3dd53b95
    s_lshl_b32 s90, s32, 8
    s_add_u32 s90, s90, 122880
    v_mul_u32_u24 v6, 1152, v2
    v_lshl_add_u32 v6, v1, 3, v6
    v_add_u32 v19, s90, v6
    s_mul_i32 s90, s32, 1536
    v_add_u32 v20, s90, v12
    s_add_u32 s90, s90, 1024
    v_lshl_add_u32 v21, v0, 3, s90
    s_mul_i32 s90, s32, 6144
    v_add_u32 v22, s90, v12
    s_add_u32 s90, s90, 1024
    v_lshl_add_u32 v23, v0, 3, s90
    v_add_u32 v28, 98304, v12
    s_mul_i32 s90, s32, 3072
    v_add_u32 v37, s90, v12
    v_add_u32 v44, 25600, v37
    s_add_u32 s54, s90, 98304
    s_mul_i32 s90, s32, 3840
    s_add_u32 s90, s90, 10240
    v_add_u32 v38, s90, v12
    s_add_u32 s90, s90, 1024
    v_add_u32 v39, s90, v13
    s_mul_i32 s90, s32, 12288
    v_add_u32 v40, s90, v12
    s_lshl_b32 s90, s40, 15
    s_lshl_b32 s92, s32, 10
    s_add_u32 s90, s90, s92
    v_lshrrev_b32 v5, 3, v0
    v_mul_u32_u24 v5, 0, v5
    v_xor_b32 v5, s34, v5
    v_and_b32 v6, 7, v1
    v_lshlrev_b32 v6, 4, v6
    v_lshl_add_u32 v6, v5, 7, v6
    v_lshrrev_b32 v7, 3, v1
    v_lshl_add_u32 v6, v7, 12, v6
    v_lshrrev_b32 v5, 1, v2
    v_lshl_add_u32 v6, v5, 13, v6
    v_and_b32 v5, 1, v2
    v_lshl_add_u32 v6, v5, 14, v6
    v_add_u32 v30, s90, v6
    s_and_b32 s91, s34, 1
    s_lshl_b32 s91, s91, 12
    s_add_u32 s90, s90, s91
    s_lshr_b32 s91, s34, 2
    s_lshl_b32 s91, s91, 13
    s_add_u32 s90, s90, s91
    s_and_b32 s91, s34, 2
    s_lshl_b32 s91, s91, 13
    s_add_u32 s90, s90, s91
    v_add_u32 v31, s90, v12
    s_lshr_b32 s91, s34, 1
    s_mul_i32 s91, s91, 10240
    s_lshl_b32 s92, s40, 7
    s_add_u32 s91, s91, s92
    s_lshl_b32 s92, s32, 5
    s_add_u32 s91, s91, s92
    s_and_b32 s92, s34, 1
    s_lshl_b32 s92, s92, 4
    s_add_u32 s91, s91, s92
    s_add_u32 s91, s91, 1280
    v_lshl_add_u32 v6, v7, 4, v2
    v_mul_u32_u24 v6, 2560, v6
    v_and_b32 v5, 7, v1
    v_lshl_add_u32 v6, v5, 1, v6
    v_add_u32 v32, s91, v6
    v_cmp_gt_u32 s[58:59], 8, v1
    v_and_b32 v5, 1, v1
    v_lshrrev_b32 v6, 3, v1
    v_lshl_add_u32 v5, v5, 1, v6
    v_bfe_u32 v6, v1, 2, 1
    v_cmp_ne_u32 vcc, 0, v6
    v_mov_b32 v6, 0x3f80
    v_mov_b32 v7, 0x3f800000
    v_cndmask_b32 v6, v6, v7, vcc
    v_cmp_eq_u32 vcc, 0, v5
    s_nop 1
    v_cndmask_b32 v7, 0, v6, vcc
    v_accvgpr_write_b32 a144, v7
    v_cmp_eq_u32 vcc, 1, v5
    s_nop 1
    v_cndmask_b32 v7, 0, v6, vcc
    v_accvgpr_write_b32 a145, v7
    v_cmp_eq_u32 vcc, 2, v5
    s_nop 1
    v_cndmask_b32 v7, 0, v6, vcc
    v_accvgpr_write_b32 a146, v7
    v_cmp_eq_u32 vcc, 3, v5
    s_nop 1
    v_cndmask_b32 v7, 0, v6, vcc
    v_accvgpr_write_b32 a147, v7
    s_lshl_b32 s90, s32, 7
    v_add_u32 v5, s90, v13
    v_add_u32 v6, 458752, v5
    v_add_u32 v7, 459728, v5
    v_cmp_gt_u32 vcc, 12, v0
    s_nop 1
    v_cndmask_b32 v33, v7, v6, vcc
    v_mov_b32 v5, -2
    v_cndmask_b32 v34, v5, 3, vcc
    v_cmp_gt_u32 vcc, 14, v0
    v_mov_b32 v9, 2146435072
    s_nop 0
    v_cndmask_b32 v33, v9, v33, vcc
    v_mov_b32 v5, -1000
    v_cndmask_b32 v34, v5, v34, vcc
    v_and_b32 v4, 3, v1
    v_and_b32 v5, 1, v2
    v_lshl_add_u32 v6, v2, 3, v3
    v_lshlrev_b32 v6, 7, v6
    v_and_b32 v7, 2, v3
    v_lshl_or_b32 v7, v5, 2, v7
    v_lshrrev_b32 v8, 1, v4
    v_xor_b32 v7, v7, v8
    v_lshl_add_u32 v6, v7, 4, v6
    v_and_b32 v7, 1, v4
    v_lshl_add_u32 v6, v7, 3, v6
    s_mul_i32 s90, s32, 24576
    v_add_u32 v6, s90, v6
    v_xor_b32 v182, 0, v6
    v_xor_b32 v183, 32, v6
    v_xor_b32 v184, 64, v6
    v_xor_b32 v185, 96, v6
    s_waitcnt vmcnt(0)
    ds_read_b64_tr_b16 a[0:1], v182 offset:0
    ds_read_b64_tr_b16 a[2:3], v182 offset:512
    ds_read_b64_tr_b16 a[4:5], v182 offset:4096
    ds_read_b64_tr_b16 a[6:7], v182 offset:4608
    ds_read_b64_tr_b16 a[8:9], v182 offset:8192
    ds_read_b64_tr_b16 a[10:11], v182 offset:8704
    ds_read_b64_tr_b16 a[12:13], v182 offset:12288
    ds_read_b64_tr_b16 a[14:15], v182 offset:12800
    ds_read_b64_tr_b16 a[16:17], v182 offset:16384
    ds_read_b64_tr_b16 a[18:19], v182 offset:16896
    ds_read_b64_tr_b16 a[20:21], v182 offset:20480
    ds_read_b64_tr_b16 a[22:23], v182 offset:20992
    ds_read_b64_tr_b16 a[24:25], v183 offset:0
    ds_read_b64_tr_b16 a[26:27], v183 offset:512
    ds_read_b64_tr_b16 a[28:29], v183 offset:4096
    ds_read_b64_tr_b16 a[30:31], v183 offset:4608
    ds_read_b64_tr_b16 a[32:33], v183 offset:8192
    ds_read_b64_tr_b16 a[34:35], v183 offset:8704
    ds_read_b64_tr_b16 a[36:37], v183 offset:12288
    ds_read_b64_tr_b16 a[38:39], v183 offset:12800
    ds_read_b64_tr_b16 a[40:41], v183 offset:16384
    ds_read_b64_tr_b16 a[42:43], v183 offset:16896
    ds_read_b64_tr_b16 a[44:45], v183 offset:20480
    ds_read_b64_tr_b16 a[46:47], v183 offset:20992
    ds_read_b64_tr_b16 a[48:49], v184 offset:0
    ds_read_b64_tr_b16 a[50:51], v184 offset:512
    ds_read_b64_tr_b16 a[52:53], v184 offset:4096
    ds_read_b64_tr_b16 a[54:55], v184 offset:4608
    ds_read_b64_tr_b16 a[56:57], v184 offset:8192
    ds_read_b64_tr_b16 a[58:59], v184 offset:8704
    ds_read_b64_tr_b16 a[60:61], v184 offset:12288
    ds_read_b64_tr_b16 a[62:63], v184 offset:12800
    ds_read_b64_tr_b16 a[64:65], v184 offset:16384
    ds_read_b64_tr_b16 a[66:67], v184 offset:16896
    ds_read_b64_tr_b16 a[68:69], v184 offset:20480
    ds_read_b64_tr_b16 a[70:71], v184 offset:20992
    ds_read_b64_tr_b16 a[72:73], v185 offset:0
    ds_read_b64_tr_b16 a[74:75], v185 offset:512
    ds_read_b64_tr_b16 a[76:77], v185 offset:4096
    ds_read_b64_tr_b16 a[78:79], v185 offset:4608
    ds_read_b64_tr_b16 a[80:81], v185 offset:8192
    ds_read_b64_tr_b16 a[82:83], v185 offset:8704
    ds_read_b64_tr_b16 a[84:85], v185 offset:12288
    ds_read_b64_tr_b16 a[86:87], v185 offset:12800
    ds_read_b64_tr_b16 a[88:89], v185 offset:16384
    ds_read_b64_tr_b16 a[90:91], v185 offset:16896
    ds_read_b64_tr_b16 a[92:93], v185 offset:20480
    ds_read_b64_tr_b16 a[94:95], v185 offset:20992
    s_waitcnt lgkmcnt(0)
    s_barrier
    v_mov_b32 v1, 196
L_gw_60:
    buffer_load_dword v2, v1, s[8:11], 0 offen sc1
    s_sub_u32 s36, s36, 1
    s_cbranch_scc1 L_exit
    s_waitcnt vmcnt(0)
    v_readfirstlane_b32 s90, v2
    s_nop 0
    s_cmp_eq_u32 s90, 0
    s_cbranch_scc1 L_gw_60
    buffer_store_dwordx4 v[164:167], v17, s[4:7], s38 offen sc1
    s_mov_b32 s37, -1
    v_add_u32 v35, -2, v34
    s_add_u32 s45, s38, 65536
    s_add_u32 s46, s45, 4096
    s_add_u32 s47, s45, 8192
    v_mov_b32 v24, v20
    v_mov_b32 v25, v21
    buffer_load_dword v36, v33, s[4:7], s38 offen sc1
    s_waitcnt vmcnt(0)
    v_cmp_lt_i32 vcc, v36, v35
    s_cbranch_vccz L_fok_62
L_fw_61:
    buffer_load_dword v36, v33, s[4:7], s38 offen sc1
    s_sub_u32 s36, s36, 1
    s_cbranch_scc1 L_exit
    s_waitcnt vmcnt(0)
    v_cmp_lt_i32 vcc, v36, v35
    s_cbranch_vccnz L_fw_61
L_fok_62:
    buffer_load_dwordx4 a[96:99], v40, s[4:7], s45 offen offset:0 sc1
    buffer_load_dwordx4 a[100:103], v40, s[4:7], s45 offen offset:1024 sc1
    buffer_load_dwordx4 a[104:107], v40, s[4:7], s45 offen offset:2048 sc1
    buffer_load_dwordx4 a[108:111], v40, s[4:7], s45 offen offset:3072 sc1
    buffer_load_dwordx4 a[112:115], v40, s[4:7], s46 offen offset:0 sc1
    buffer_load_dwordx4 a[116:119], v40, s[4:7], s46 offen offset:1024 sc1
    buffer_load_dwordx4 a[120:123], v40, s[4:7], s46 offen offset:2048 sc1
    buffer_load_dwordx4 a[124:127], v40, s[4:7], s46 offen offset:3072 sc1
    buffer_load_dwordx4 a[128:131], v40, s[4:7], s47 offen offset:0 sc1
    buffer_load_dwordx4 a[132:135], v40, s[4:7], s47 offen offset:1024 sc1
    buffer_load_dwordx4 a[136:139], v40, s[4:7], s47 offen offset:2048 sc1
    buffer_load_dwordx4 a[140:143], v40, s[4:7], s47 offen offset:3072 sc1
    s_waitcnt vmcnt(0)
    v_mfma_f32_16x16x32_bf16 v[148:151], a[96:99], a[0:3], 0
    v_mfma_f32_16x16x32_bf16 v[152:155], a[120:123], a[0:3], 0
    v_mfma_f32_16x16x32_bf16 v[156:159], a[96:99], a[24:27], 0
    v_mfma_f32_16x16x32_bf16 v[160:163], a[120:123], a[24:27], 0
    v_mfma_f32_16x16x32_bf16 v[180:183], a[96:99], a[48:51], 0
    v_mfma_f32_16x16x32_bf16 v[184:187], a[120:123], a[48:51], 0
    v_mfma_f32_16x16x32_bf16 v[188:191], a[96:99], a[72:75], 0
    v_mfma_f32_16x16x32_bf16 v[192:195], a[120:123], a[72:75], 0
    v_mfma_f32_16x16x32_bf16 v[148:151], a[100:103], a[4:7], v[148:151]
    v_mfma_f32_16x16x32_bf16 v[152:155], a[124:127], a[4:7], v[152:155]
    v_mfma_f32_16x16x32_bf16 v[156:159], a[100:103], a[28:31], v[156:159]
    v_mfma_f32_16x16x32_bf16 v[160:163], a[124:127], a[28:31], v[160:163]
    v_mfma_f32_16x16x32_bf16 v[180:183], a[100:103], a[52:55], v[180:183]
    v_mfma_f32_16x16x32_bf16 v[184:187], a[124:127], a[52:55], v[184:187]
    v_mfma_f32_16x16x32_bf16 v[188:191], a[100:103], a[76:79], v[188:191]
    v_mfma_f32_16x16x32_bf16 v[192:195], a[124:127], a[76:79], v[192:195]
    v_mfma_f32_16x16x32_bf16 v[148:151], a[104:107], a[8:11], v[148:151]
    v_mfma_f32_16x16x32_bf16 v[152:155], a[128:131], a[8:11], v[152:155]
    v_mfma_f32_16x16x32_bf16 v[156:159], a[104:107], a[32:35], v[156:159]
    v_mfma_f32_16x16x32_bf16 v[160:163], a[128:131], a[32:35], v[160:163]
    v_mfma_f32_16x16x32_bf16 v[180:183], a[104:107], a[56:59], v[180:183]
    v_mfma_f32_16x16x32_bf16 v[184:187], a[128:131], a[56:59], v[184:187]
    v_mfma_f32_16x16x32_bf16 v[188:191], a[104:107], a[80:83], v[188:191]
    v_mfma_f32_16x16x32_bf16 v[192:195], a[128:131], a[80:83], v[192:195]
    v_mfma_f32_16x16x32_bf16 v[148:151], a[108:111], a[12:15], v[148:151]
    v_mfma_f32_16x16x32_bf16 v[152:155], a[132:135], a[12:15], v[152:155]
    v_mfma_f32_16x16x32_bf16 v[156:159], a[108:111], a[36:39], v[156:159]
    v_mfma_f32_16x16x32_bf16 v[160:163], a[132:135], a[36:39], v[160:163]
    v_mfma_f32_16x16x32_bf16 v[180:183], a[108:111], a[60:63], v[180:183]
    v_mfma_f32_16x16x32_bf16 v[184:187], a[132:135], a[60:63], v[184:187]
    v_mfma_f32_16x16x32_bf16 v[188:191], a[108:111], a[84:87], v[188:191]
    v_mfma_f32_16x16x32_bf16 v[192:195], a[132:135], a[84:87], v[192:195]
    v_mfma_f32_16x16x32_bf16 v[148:151], a[112:115], a[16:19], v[148:151]
    v_mfma_f32_16x16x32_bf16 v[152:155], a[136:139], a[16:19], v[152:155]
    v_mfma_f32_16x16x32_bf16 v[156:159], a[112:115], a[40:43], v[156:159]
    v_mfma_f32_16x16x32_bf16 v[160:163], a[136:139], a[40:43], v[160:163]
    v_mfma_f32_16x16x32_bf16 v[180:183], a[112:115], a[64:67], v[180:183]
    v_mfma_f32_16x16x32_bf16 v[184:187], a[136:139], a[64:67], v[184:187]
    v_mfma_f32_16x16x32_bf16 v[188:191], a[112:115], a[88:91], v[188:191]
    v_mfma_f32_16x16x32_bf16 v[192:195], a[136:139], a[88:91], v[192:195]
    v_mfma_f32_16x16x32_bf16 v[148:151], a[116:119], a[20:23], v[148:151]
    v_mfma_f32_16x16x32_bf16 v[152:155], a[140:143], a[20:23], v[152:155]
    v_mfma_f32_16x16x32_bf16 v[156:159], a[116:119], a[44:47], v[156:159]
    v_mfma_f32_16x16x32_bf16 v[160:163], a[140:143], a[44:47], v[160:163]
    v_mfma_f32_16x16x32_bf16 v[180:183], a[116:119], a[68:71], v[180:183]
    v_mfma_f32_16x16x32_bf16 v[184:187], a[140:143], a[68:71], v[184:187]
    v_mfma_f32_16x16x32_bf16 v[188:191], a[116:119], a[92:95], v[188:191]
    v_mfma_f32_16x16x32_bf16 v[192:195], a[140:143], a[92:95], v[192:195]
    v_cvt_pk_bf16_f32 v64, v180, v181
    v_cvt_pk_bf16_f32 v65, v182, v183
    ds_write_b64 v24, v[64:65] offset:12288
    v_cvt_pk_bf16_f32 v68, v184, v185
    v_cvt_pk_bf16_f32 v69, v186, v187
    ds_write_b64 v25, v[68:69] offset:12288
    v_cvt_pk_bf16_f32 v72, v188, v189
    v_cvt_pk_bf16_f32 v73, v190, v191
    ds_write_b64 v24, v[72:73] offset:18432
    v_cvt_pk_bf16_f32 v76, v192, v193
    v_cvt_pk_bf16_f32 v77, v194, v195
    ds_write_b64 v25, v[76:77] offset:18432
    v_cvt_pk_bf16_f32 v48, v148, v149
    v_cvt_pk_bf16_f32 v49, v150, v151
    ds_write_b64 v24, v[48:49] offset:0
    v_cvt_pk_bf16_f32 v52, v152, v153
    v_cvt_pk_bf16_f32 v53, v154, v155
    ds_write_b64 v25, v[52:53] offset:0
    v_cvt_pk_bf16_f32 v56, v156, v157
    v_cvt_pk_bf16_f32 v57, v158, v159
    ds_write_b64 v24, v[56:57] offset:6144
    v_cvt_pk_bf16_f32 v60, v160, v161
    v_cvt_pk_bf16_f32 v61, v162, v163
    ds_write_b64 v25, v[60:61] offset:6144
    s_add_u32 s56, s37, 2
    s_and_b32 s55, s56, 3
    s_mul_i32 s55, s55, 114688
    s_add_u32 s55, s55, 65536
    s_add_u32 s45, s38, s55
    s_add_u32 s46, s45, 4096
    s_add_u32 s47, s45, 8192
    s_add_u32 s56, s37, -1
    s_and_b32 s55, s56, 3
    s_mul_i32 s55, s55, 114688
    s_add_u32 s55, s55, 53248
    s_add_u32 s48, s38, s55
    s_and_b32 s55, s56, 1
    s_add_u32 m0, s55, 12
    s_add_u32 s56, s56, 1
    v_add_u32 v35, s37, v34
    v_writelane_b32 v35, s56, m0
    s_mul_i32 s55, s55, 12288
    s_add_u32 m0, s54, s55
    buffer_load_dword v36, v33, s[4:7], s38 offen sc1
    s_waitcnt vmcnt(0)
    v_cmp_lt_i32 vcc, v36, v35
    s_cbranch_vccz L_fok_64
L_fw_63:
    buffer_load_dword v36, v33, s[4:7], s38 offen sc1
    s_sub_u32 s36, s36, 1
    s_cbranch_scc1 L_exit
    s_waitcnt vmcnt(0)
    v_cmp_lt_i32 vcc, v36, v35
    s_cbranch_vccnz L_fw_63
L_fok_64:
    buffer_load_dwordx4 a[96:99], v40, s[4:7], s45 offen offset:0 sc1
    buffer_load_dwordx4 a[100:103], v40, s[4:7], s45 offen offset:1024 sc1
    buffer_load_dwordx4 a[104:107], v40, s[4:7], s45 offen offset:2048 sc1
    buffer_load_dwordx4 a[108:111], v40, s[4:7], s45 offen offset:3072 sc1
    buffer_load_dwordx4 a[112:115], v40, s[4:7], s46 offen offset:0 sc1
    buffer_load_dwordx4 a[116:119], v40, s[4:7], s46 offen offset:1024 sc1
    buffer_load_dwordx4 a[120:123], v40, s[4:7], s46 offen offset:2048 sc1
    buffer_load_dwordx4 a[124:127], v40, s[4:7], s46 offen offset:3072 sc1
    buffer_load_dwordx4 a[128:131], v40, s[4:7], s47 offen offset:0 sc1
    buffer_load_dwordx4 a[132:135], v40, s[4:7], s47 offen offset:1024 sc1
    buffer_load_dwordx4 a[136:139], v40, s[4:7], s47 offen offset:2048 sc1
    buffer_load_dwordx4 a[140:143], v40, s[4:7], s47 offen offset:3072 sc1
    s_add_u32 s56, s37, 1
    v_mov_b32 v47, v24
    s_and_b32 s55, s56, 3
    s_mul_i32 s41, s55, 327680
    s_mul_i32 s56, s55, 114688
    s_add_u32 s43, s38, s56
    s_xor_b32 s55, s55, 2
    s_mul_i32 s42, s55, 327680
    s_add_u32 s56, s37, 2
    v_mov_b32 v107, s56
    s_and_b32 s55, s56, 3
    s_mul_i32 s44, s55, 24576
    s_mov_b32 s50, s52
    s_add_u32 s56, s37, -2
    s_and_b32 s55, s56, 3
    s_mul_i32 s55, s55, 327680
    s_add_u32 s49, s55, 4194304
    s_add_u32 s56, s37, -4
    s_and_b32 s55, s56, 3
    s_mul_i32 s55, s55, 327680
    s_add_u32 s51, s55, 4194304
    s_mul_i32 s52, s56, 81920
    s_add_u32 s56, s37, -1
    s_and_b32 s55, s56, 3
    s_mul_i32 s55, s55, 24576
    v_add_u32 v26, s55, v22
    v_add_u32 v27, s55, v23
    s_and_b32 s55, s56, 1
    s_mul_i32 s55, s55, 12288
    v_add_u32 v29, s55, v28
    s_add_u32 s37, s37, 1
    v_add_u32 v24, s44, v20
    v_add_u32 v25, s44, v21
    v_pk_mul_f32 v[148:149], v[210:211], v[210:211]
    v_pk_mul_f32 v[150:151], v[210:211], v[210:211]
    v_pk_mul_f32 v[152:153], v[210:211], v[210:211]
    v_pk_mul_f32 v[154:155], v[210:211], v[210:211]
    v_pk_mul_f32 v[156:157], v[210:211], v[210:211]
    v_pk_mul_f32 v[158:159], v[210:211], v[210:211]
    v_pk_mul_f32 v[160:161], v[210:211], v[210:211]
    v_pk_mul_f32 v[162:163], v[210:211], v[210:211]
    v_mov_b32 v120, 0
    v_mov_b32 v121, 0
    v_mov_b32 v122, 0
    v_mov_b32 v123, 0
    v_mov_b32 v124, 0
    v_mov_b32 v125, 0
    v_mov_b32 v126, 0
    v_mov_b32 v127, 0
    v_mov_b32 v128, 0
    v_mov_b32 v129, 0
    v_mov_b32 v130, 0
    v_mov_b32 v131, 0
    v_mov_b32 v132, 0
    v_mov_b32 v133, 0
    v_mov_b32 v134, 0
    v_mov_b32 v135, 0
    v_mov_b32 v116, 0
    v_mov_b32 v117, 0
    v_mov_b32 v118, 0
    v_mov_b32 v119, 0
    v_mov_b32 v3, 204
L_p0_65:
    buffer_load_dword v4, v3, s[8:11], 0 offen sc1
    s_sub_u32 s36, s36, 1
    s_cbranch_scc1 L_exit
    s_waitcnt vmcnt(0)
    v_readfirstlane_b32 s90, v4
    s_nop 0
    s_cmp_eq_u32 s90, 0
    s_cbranch_scc1 L_p0_65
    s_and_b32 s90, s90, 2
    s_lshl_b32 s90, s90, 12
    s_xor_b32 s90, s90, 0
    v_xor_b32 v30, s90, v30
    v_xor_b32 v31, s90, v31
    s_mov_b32 s90, 5832704
    buffer_store_dwordx4 v[168:171], v30, s[4:7], s90 offen sc1
    s_mov_b32 s90, 6160384
    buffer_store_dwordx4 v[168:171], v30, s[4:7], s90 offen sc1
L_wo_loop_s:
    buffer_load_dword v41, v245, s[4:7], s38 offen sc1
    buffer_load_dword v41, v245, s[4:7], s38 offen sc1
    buffer_load_dword v41, v245, s[4:7], s38 offen sc1
L_bf_66:
    buffer_load_dword v41, v245, s[4:7], s38 offen sc1
    s_sub_u32 s36, s36, 1
    s_cbranch_scc1 L_exit
    s_waitcnt vmcnt(3)
    v_cmp_ge_u32 vcc, s37, v41
    s_cbranch_vccnz L_bf_66
    buffer_load_dwordx4 v[136:139], v44, s[4:7], s43 offen offset:0 sc1
    buffer_load_dwordx4 v[140:143], v44, s[4:7], s43 offen offset:1024 sc1
    buffer_load_dwordx4 v[144:147], v44, s[4:7], s43 offen offset:2048 sc1
    s_waitcnt vmcnt(2)
    v_smfmac_f32_16x16x64_bf16 v[148:151], v[136:139], a[0:7], v10
    v_smfmac_f32_16x16x64_bf16 v[152:155], v[136:139], a[24:31], v10
    v_smfmac_f32_16x16x64_bf16 v[156:159], v[136:139], a[48:55], v10
    v_smfmac_f32_16x16x64_bf16 v[160:163], v[136:139], a[72:79], v10
    s_waitcnt vmcnt(1)
    v_smfmac_f32_16x16x64_bf16 v[148:151], v[140:143], a[8:15], v10
    v_smfmac_f32_16x16x64_bf16 v[152:155], v[140:143], a[32:39], v10
    v_smfmac_f32_16x16x64_bf16 v[156:159], v[140:143], a[56:63], v10
    v_smfmac_f32_16x16x64_bf16 v[160:163], v[140:143], a[80:87], v10
    s_waitcnt vmcnt(0)
    v_smfmac_f32_16x16x64_bf16 v[148:151], v[144:147], a[16:23], v10
    v_smfmac_f32_16x16x64_bf16 v[152:155], v[144:147], a[40:47], v10
    v_smfmac_f32_16x16x64_bf16 v[156:159], v[144:147], a[64:71], v10
    v_smfmac_f32_16x16x64_bf16 v[160:163], v[144:147], a[88:95], v10
    v_pk_add_f32 v[148:149], v[148:149], v[150:151]
    v_cmp_u_f32 vcc, v148, v149
    buffer_load_dwordx4 v[92:95], v38, s[4:7], s43 offen offset:0 sc1
    buffer_load_dword v104, v39, s[4:7], s43 offen offset:0 sc1
    v_cvt_pk_bf16_f32 v50, v148, v149
    buffer_load_dwordx4 v[96:99], v38, s[4:7], s43 offen offset:1280 sc1
    buffer_load_dword v105, v39, s[4:7], s43 offen offset:1280 sc1
    v_cvt_pk_bf16_f32 v54, v148, v149
    buffer_load_dwordx4 v[100:103], v38, s[4:7], s43 offen offset:2560 sc1
    buffer_load_dword v106, v39, s[4:7], s43 offen offset:2560 sc1
    v_pk_add_f32 v[152:153], v[152:153], v[154:155]
    v_cvt_pk_bf16_f32 v58, v152, v153
    v_cvt_pk_bf16_f32 v62, v152, v153
    v_pk_add_f32 v[156:157], v[156:157], v[158:159]
    v_cvt_pk_bf16_f32 v66, v156, v157
    v_cvt_pk_bf16_f32 v70, v156, v157
    v_pk_add_f32 v[160:161], v[160:161], v[162:163]
    v_cvt_pk_bf16_f32 v74, v160, v161
    v_cvt_pk_bf16_f32 v78, v160, v161
    s_cbranch_vccnz L_vm_67
L_u_68:
    ds_write_b32 v47, v50 offset:8
    ds_write_b32 v47, v58 offset:6152
    ds_write_b32 v47, v66 offset:12296
    ds_write_b32 v47, v74 offset:18440
    s_cmp_eq_u32 s37, 63
    s_cbranch_scc1 L_wo_tail_s
L_sc_69:
    s_waitcnt vmcnt(2)
    v_pk_add_f32 v[236:237], v[92:93], v[96:97]
    v_pk_add_f32 v[238:239], v[94:95], v[98:99]
    v_add_f32 v43, v104, v105
    s_waitcnt vmcnt(0)
    v_pk_add_f32 v[236:237], v[236:237], v[100:101]
    v_pk_add_f32 v[238:239], v[238:239], v[102:103]
    v_add_f32 v43, v43, v106
    v_max3_f32 v41, v236, v237, v238
    v_max3_f32 v41, v41, v239, v43
    v_pk_add_f32 v[242:243], v[236:237], v[238:239]
    v_add_f32 v242, v242, v43
    v_max_f32_dpp v42, v41, v41 quad_perm:[2,3,0,1] row_mask:0xf bank_mask:0xf
    v_max_f32_dpp v41, v41, v41 quad_perm:[2,3,0,1] row_mask:0xf bank_mask:0xf
    v_cmp_u_f32 vcc, v242, v243
    s_nop 0
    v_permlane16_swap_b32 v41, v42
    v_max_f32 v41, v41, v42
    v_mov_b32 v42, v41
    s_cbranch_vccnz L_sp_70
L_sg_71:
    s_nop 0
    v_permlane32_swap_b32 v41, v42
    v_max_f32 v41, v41, v42
    v_mul_f32 v242, 0xbdd53b95, v41
    v_pk_fma_f32 v[236:237], v[236:237], v[240:241], v[242:243] op_sel_hi:[1,1,0]
    v_pk_fma_f32 v[238:239], v[238:239], v[240:241], v[242:243] op_sel_hi:[1,1,0]
    v_fma_f32 v43, v43, v240, v242
    v_exp_f32 v236, v236
    v_exp_f32 v237, v237
    v_exp_f32 v238, v238
    v_exp_f32 v239, v239
    v_exp_f32 v43, v43
    v_cvt_pk_bf16_f32 v80, v236, v237
    v_cvt_pk_bf16_f32 v82, v238, v239
    v_cvt_pk_bf16_f32 v81, v43, 0
    v_cvt_pk_bf16_f32 v83, v43, 0
    s_nop 1
    v_smfmac_f32_16x16x64_bf16 v[116:119], v[80:83], v[84:91], v11
    v_smfmac_f32_16x16x64_bf16 v[120:123], v[80:83], v[48:55], v11
    v_smfmac_f32_16x16x64_bf16 v[124:127], v[80:83], v[56:63], v11
    v_smfmac_f32_16x16x64_bf16 v[128:131], v[80:83], v[64:71], v11
    v_add_f32 v116, v116, v118
    v_add_f32 v117, v117, v119
    v_smfmac_f32_16x16x64_bf16 v[132:135], v[80:83], v[72:79], v11
    v_rcp_f32 v116, v116
    v_rcp_f32 v117, v117
    v_pk_add_f32 v[120:121], v[120:121], v[122:123]
    v_pk_mul_f32 v[120:121], v[120:121], v[116:117]
    v_cvt_pk_bf16_f32 v236, v120, v121
    v_pk_add_f32 v[124:125], v[124:125], v[126:127]
    v_pk_mul_f32 v[124:125], v[124:125], v[116:117]
    v_cvt_pk_bf16_f32 v237, v124, v125
    ds_write2st64_b32 v18, v236, v237 offset0:0 offset1:1
    v_pk_add_f32 v[128:129], v[128:129], v[130:131]
    v_pk_mul_f32 v[128:129], v[128:129], v[116:117]
    v_cvt_pk_bf16_f32 v238, v128, v129
    v_pk_add_f32 v[132:133], v[132:133], v[134:135]
    v_pk_mul_f32 v[132:133], v[132:133], v[116:117]
    v_cvt_pk_bf16_f32 v239, v132, v133
    ds_write2st64_b32 v18, v238, v239 offset0:2 offset1:3
    v_mov_b32 v120, 0
    v_mov_b32 v121, 0
    v_mov_b32 v122, 0
    v_mov_b32 v123, 0
    v_mov_b32 v124, 0
    v_mov_b32 v125, 0
    v_mov_b32 v126, 0
    v_mov_b32 v127, 0
    v_mov_b32 v128, 0
    v_mov_b32 v129, 0
    s_waitcnt lgkmcnt(0)
    s_barrier
    ds_read_b64_tr_b16 v[80:81], v19
    ds_read_b64_tr_b16 v[82:83], v19 offset:128
    v_mov_b32 v130, 0
    v_mov_b32 v131, 0
    v_mov_b32 v132, 0
    v_mov_b32 v133, 0
    v_mov_b32 v134, 0
    v_mov_b32 v135, 0
    v_mov_b32 v116, 0
    v_mov_b32 v117, 0
    v_mov_b32 v118, 0
    v_mov_b32 v119, 0
    s_waitcnt lgkmcnt(0)
    v_mfma_f32_16x16x32_bf16 v[172:175], v[110:113], v[80:83], 0
    v_mfma_f32_16x16x32_bf16 v[176:179], v[108:111], v[80:83], 0
    buffer_store_dword v107, v244, s[4:7], s38 offen sc1
    buffer_load_dword v36, v33, s[4:7], s38 offen sc1
    s_nop 2
    v_cvt_pk_bf16_f32 v236, v172, v173
    v_cvt_pk_bf16_f32 v237, v174, v175
    s_nop 0
    v_cvt_pk_bf16_f32 v238, v176, v177
    v_cvt_pk_bf16_f32 v239, v178, v179
    buffer_store_dwordx4 v[236:239], v14, s[4:7], s41 offen sc1
    ds_read_b128 v[204:207], v26 offset:0
    ds_read_b128 v[180:183], v29 offset:0
    ds_read_b128 v[184:187], v29 offset:1024
    ds_read_b64 v[208:209], v27 offset:0
    ds_read_b128 v[188:191], v29 offset:2048
    ds_read_b128 v[212:215], v26 offset:1536
    ds_read_b128 v[192:195], v29 offset:3072
    ds_read_b128 v[196:199], v29 offset:4096
    ds_read_b64 v[216:217], v27 offset:1536
    ds_read_b128 v[200:203], v29 offset:5120
    buffer_store_dwordx4 v[220:223], v30, s[4:7], s49 offen sc1
    buffer_load_dwordx4 v[228:231], v31, s[4:7], s51 offen sc1
    s_add_u32 s55, s42, s60
    buffer_store_dword v168, v46, s[4:7], s55 offen sc1
    s_add_u32 s55, s42, s61
    buffer_store_dword v168, v46, s[4:7], s55 offen sc1
    s_add_u32 s55, s42, s62
    buffer_store_dword v168, v46, s[4:7], s55 offen sc1
    s_add_u32 s55, s42, s63
    buffer_store_dword v168, v46, s[4:7], s55 offen sc1
    s_waitcnt lgkmcnt(5)
    v_mfma_f32_16x16x32_bf16 v[220:223], v[180:183], v[204:207], 0
    v_mfma_f32_16x16x32_bf16 v[224:227], v[184:187], v[204:207], 0
    v_mfma_f32_16x16x32_bf16 v[224:227], v[188:191], v[208:211], v[224:227]
    ds_read_b128 v[204:207], v26 offset:3072
    ds_read_b128 v[180:183], v29 offset:6144
    ds_read_b128 v[184:187], v29 offset:7168
    ds_read_b64 v[208:209], v27 offset:3072
    ds_read_b128 v[188:191], v29 offset:8192
    s_add_u32 s56, s37, 2
    s_and_b32 s55, s56, 3
    s_mul_i32 s55, s55, 114688
    s_add_u32 s55, s55, 65536
    s_add_u32 s45, s38, s55
    s_add_u32 s46, s45, 4096
    s_add_u32 s47, s45, 8192
    s_add_u32 s56, s37, -1
    s_and_b32 s55, s56, 3
    s_mul_i32 s55, s55, 114688
    s_add_u32 s55, s55, 53248
    s_add_u32 s48, s38, s55
    s_and_b32 s55, s56, 1
    s_add_u32 m0, s55, 12
    s_add_u32 s56, s56, 1
    v_add_u32 v35, s37, v34
    v_writelane_b32 v35, s56, m0
    s_mul_i32 s55, s55, 12288
    s_add_u32 m0, s54, s55
    s_waitcnt lgkmcnt(5)
    v_mfma_f32_16x16x32_bf16 v[220:223], v[192:195], v[212:215], v[220:223]
    v_mfma_f32_16x16x32_bf16 v[224:227], v[196:199], v[212:215], v[224:227]
    v_mfma_f32_16x16x32_bf16 v[224:227], v[200:203], v[216:219], v[224:227]
    ds_read_b128 v[212:215], v26 offset:4608
    ds_read_b128 v[192:195], v29 offset:9216
    ds_read_b128 v[196:199], v29 offset:10240
    ds_read_b64 v[216:217], v27 offset:4608
    ds_read_b128 v[200:203], v29 offset:11264
    s_waitcnt lgkmcnt(5)
    v_mfma_f32_16x16x32_bf16 v[220:223], v[180:183], v[204:207], v[220:223]
    v_mfma_f32_16x16x32_bf16 v[224:227], v[184:187], v[204:207], v[224:227]
    v_mfma_f32_16x16x32_bf16 v[224:227], v[188:191], v[208:211], v[224:227]
    s_waitcnt lgkmcnt(0)
    v_mfma_f32_16x16x32_bf16 v[220:223], v[192:195], v[212:215], v[220:223]
    v_mfma_f32_16x16x32_bf16 v[224:227], v[196:199], v[212:215], v[224:227]
    v_mfma_f32_16x16x32_bf16 v[224:227], v[200:203], v[216:219], v[224:227]
    s_waitcnt vmcnt(7)
    v_cmp_lt_i32 vcc, v36, v35
    s_cbranch_vccz L_fok_73
L_fw_72:
    buffer_load_dword v36, v33, s[4:7], s38 offen sc1
    s_sub_u32 s36, s36, 1
    s_cbranch_scc1 L_exit
    s_waitcnt vmcnt(0)
    v_cmp_lt_i32 vcc, v36, v35
    s_cbranch_vccnz L_fw_72
L_fok_73:
    buffer_load_dwordx4 v37, s[4:7], s48 offen offset:0 sc1 lds
    buffer_load_dwordx4 v37, s[4:7], s48 offen offset:1024 sc1 lds
    buffer_load_dwordx4 v37, s[4:7], s48 offen offset:2048 sc1 lds
    v_cvt_pk_bf16_f32 v220, v220, v221
    v_cvt_pk_bf16_f32 v221, v222, v223
    v_cvt_pk_bf16_f32 v222, v224, v225
    v_cvt_pk_bf16_f32 v223, v226, v227
    v_mfma_f32_16x16x32_bf16 v[148:151], a[96:99], a[0:3], 0
    s_add_u32 s56, s37, 1
    v_mov_b32 v47, v24
    v_mfma_f32_16x16x32_bf16 v[152:155], a[120:123], a[0:3], 0
    s_and_b32 s55, s56, 3
    s_mul_i32 s41, s55, 327680
    v_mfma_f32_16x16x32_bf16 v[156:159], a[96:99], a[24:27], 0
    s_mul_i32 s56, s55, 114688
    s_add_u32 s43, s38, s56
    v_mfma_f32_16x16x32_bf16 v[160:163], a[120:123], a[24:27], 0
    s_xor_b32 s55, s55, 2
    s_mul_i32 s42, s55, 327680
    v_mfma_f32_16x16x32_bf16 v[180:183], a[96:99], a[48:51], 0
    s_add_u32 s56, s37, 2
    v_mov_b32 v107, s56
    v_mfma_f32_16x16x32_bf16 v[184:187], a[120:123], a[48:51], 0
    s_and_b32 s55, s56, 3
    s_mul_i32 s44, s55, 24576
    v_mfma_f32_16x16x32_bf16 v[188:191], a[96:99], a[72:75], 0
    s_mov_b32 s50, s52
    s_add_u32 s56, s37, -2
    v_mfma_f32_16x16x32_bf16 v[192:195], a[120:123], a[72:75], 0
    buffer_load_dwordx4 a[96:99], v40, s[4:7], s45 offen offset:0 sc1
    v_mfma_f32_16x16x32_bf16 v[148:151], a[100:103], a[4:7], v[148:151]
    s_and_b32 s55, s56, 3
    s_mul_i32 s55, s55, 327680
    v_mfma_f32_16x16x32_bf16 v[152:155], a[124:127], a[4:7], v[152:155]
    buffer_load_dwordx4 a[120:123], v40, s[4:7], s46 offen offset:2048 sc1
    v_mfma_f32_16x16x32_bf16 v[156:159], a[100:103], a[28:31], v[156:159]
    s_add_u32 s49, s55, 4194304
    s_add_u32 s56, s37, -4
    v_mfma_f32_16x16x32_bf16 v[160:163], a[124:127], a[28:31], v[160:163]
    s_and_b32 s55, s56, 3
    s_mul_i32 s55, s55, 327680
    v_mfma_f32_16x16x32_bf16 v[180:183], a[100:103], a[52:55], v[180:183]
    s_add_u32 s51, s55, 4194304
    s_mul_i32 s52, s56, 81920
    v_mfma_f32_16x16x32_bf16 v[184:187], a[124:127], a[52:55], v[184:187]
    s_add_u32 s56, s37, -1
    s_and_b32 s55, s56, 3
    v_mfma_f32_16x16x32_bf16 v[188:191], a[100:103], a[76:79], v[188:191]
    s_mul_i32 s55, s55, 24576
    v_add_u32 v26, s55, v22
    v_mfma_f32_16x16x32_bf16 v[192:195], a[124:127], a[76:79], v[192:195]
    buffer_load_dwordx4 a[100:103], v40, s[4:7], s45 offen offset:1024 sc1
    v_mfma_f32_16x16x32_bf16 v[148:151], a[104:107], a[8:11], v[148:151]
    v_add_u32 v27, s55, v23
    s_and_b32 s55, s56, 1
    v_mfma_f32_16x16x32_bf16 v[152:155], a[128:131], a[8:11], v[152:155]
    buffer_load_dwordx4 a[124:127], v40, s[4:7], s46 offen offset:3072 sc1
    v_mfma_f32_16x16x32_bf16 v[156:159], a[104:107], a[32:35], v[156:159]
    s_mul_i32 s55, s55, 12288
    v_add_u32 v29, s55, v28
    v_mfma_f32_16x16x32_bf16 v[160:163], a[128:131], a[32:35], v[160:163]
    v_mfma_f32_16x16x32_bf16 v[180:183], a[104:107], a[56:59], v[180:183]
    v_mfma_f32_16x16x32_bf16 v[184:187], a[128:131], a[56:59], v[184:187]
    v_mfma_f32_16x16x32_bf16 v[188:191], a[104:107], a[80:83], v[188:191]
    v_mfma_f32_16x16x32_bf16 v[192:195], a[128:131], a[80:83], v[192:195]
    buffer_load_dwordx4 a[104:107], v40, s[4:7], s45 offen offset:2048 sc1
    v_mfma_f32_16x16x32_bf16 v[148:151], a[108:111], a[12:15], v[148:151]
    v_mfma_f32_16x16x32_bf16 v[152:155], a[132:135], a[12:15], v[152:155]
    buffer_load_dwordx4 a[128:131], v40, s[4:7], s47 offen offset:0 sc1
    v_mfma_f32_16x16x32_bf16 v[156:159], a[108:111], a[36:39], v[156:159]
    v_mfma_f32_16x16x32_bf16 v[160:163], a[132:135], a[36:39], v[160:163]
    v_mfma_f32_16x16x32_bf16 v[180:183], a[108:111], a[60:63], v[180:183]
    v_mfma_f32_16x16x32_bf16 v[184:187], a[132:135], a[60:63], v[184:187]
    v_mfma_f32_16x16x32_bf16 v[188:191], a[108:111], a[84:87], v[188:191]
    v_mfma_f32_16x16x32_bf16 v[192:195], a[132:135], a[84:87], v[192:195]
    buffer_load_dwordx4 a[108:111], v40, s[4:7], s45 offen offset:3072 sc1
    v_mfma_f32_16x16x32_bf16 v[148:151], a[112:115], a[16:19], v[148:151]
    v_mfma_f32_16x16x32_bf16 v[152:155], a[136:139], a[16:19], v[152:155]
    buffer_load_dwordx4 a[132:135], v40, s[4:7], s47 offen offset:1024 sc1
    v_mfma_f32_16x16x32_bf16 v[156:159], a[112:115], a[40:43], v[156:159]
    v_mfma_f32_16x16x32_bf16 v[160:163], a[136:139], a[40:43], v[160:163]
    v_mfma_f32_16x16x32_bf16 v[180:183], a[112:115], a[64:67], v[180:183]
    v_mfma_f32_16x16x32_bf16 v[184:187], a[136:139], a[64:67], v[184:187]
    v_mfma_f32_16x16x32_bf16 v[188:191], a[112:115], a[88:91], v[188:191]
    v_mfma_f32_16x16x32_bf16 v[192:195], a[136:139], a[88:91], v[192:195]
    buffer_load_dwordx4 a[112:115], v40, s[4:7], s46 offen offset:0 sc1
    v_mfma_f32_16x16x32_bf16 v[148:151], a[116:119], a[20:23], v[148:151]
    v_mfma_f32_16x16x32_bf16 v[152:155], a[140:143], a[20:23], v[152:155]
    buffer_load_dwordx4 a[136:139], v40, s[4:7], s47 offen offset:2048 sc1
    v_mfma_f32_16x16x32_bf16 v[156:159], a[116:119], a[44:47], v[156:159]
    v_mfma_f32_16x16x32_bf16 v[160:163], a[140:143], a[44:47], v[160:163]
    v_mfma_f32_16x16x32_bf16 v[180:183], a[116:119], a[68:71], v[180:183]
    v_mfma_f32_16x16x32_bf16 v[184:187], a[140:143], a[68:71], v[184:187]
    v_mfma_f32_16x16x32_bf16 v[188:191], a[116:119], a[92:95], v[188:191]
    v_mfma_f32_16x16x32_bf16 v[192:195], a[140:143], a[92:95], v[192:195]
    buffer_load_dwordx4 a[116:119], v40, s[4:7], s46 offen offset:1024 sc1
    buffer_load_dwordx4 a[140:143], v40, s[4:7], s47 offen offset:3072 sc1
    s_cmp_lt_u32 s37, 5
    s_nop 0
    s_cbranch_scc1 L_g_74
    s_waitcnt vmcnt(19)
    v_mfma_f32_16x16x32_bf16 v[232:235], a[144:147], v[228:231], 0
    s_nop 7
    v_cndmask_b32 v234, v232, v233, s[58:59]
    v_cndmask_b32 v235, v233, v232, s[58:59]
    s_nop 1
    v_add_f32_dpp v235, v234, v235 row_ror:8 row_mask:0xf bank_mask:0xf
    v_cvt_pk_bf16_f32 v235, v235, v235
    buffer_store_short v235, v32, s[28:31], s50 offen
L_g_74:
    v_cvt_pk_bf16_f32 v64, v180, v181
    v_cvt_pk_bf16_f32 v65, v182, v183
    ds_write_b64 v24, v[64:65] offset:12288
    v_cvt_pk_bf16_f32 v68, v184, v185
    v_cvt_pk_bf16_f32 v69, v186, v187
    ds_write_b64 v25, v[68:69] offset:12288
    v_cvt_pk_bf16_f32 v72, v188, v189
    v_cvt_pk_bf16_f32 v73, v190, v191
    ds_write_b64 v24, v[72:73] offset:18432
    v_cvt_pk_bf16_f32 v76, v192, v193
    v_cvt_pk_bf16_f32 v77, v194, v195
    ds_write_b64 v25, v[76:77] offset:18432
    v_cvt_pk_bf16_f32 v48, v148, v149
    v_cvt_pk_bf16_f32 v49, v150, v151
    ds_write_b64 v24, v[48:49] offset:0
    v_cvt_pk_bf16_f32 v52, v152, v153
    v_cvt_pk_bf16_f32 v53, v154, v155
    ds_write_b64 v25, v[52:53] offset:0
    v_cvt_pk_bf16_f32 v56, v156, v157
    v_cvt_pk_bf16_f32 v57, v158, v159
    ds_write_b64 v24, v[56:57] offset:6144
    v_cvt_pk_bf16_f32 v60, v160, v161
    v_cvt_pk_bf16_f32 v61, v162, v163
    ds_write_b64 v25, v[60:61] offset:6144
    s_add_u32 s37, s37, 1
    v_add_u32 v24, s44, v20
    v_add_u32 v25, s44, v21
    v_pk_mul_f32 v[148:149], v[210:211], v[210:211]
    v_pk_mul_f32 v[150:151], v[210:211], v[210:211]
    v_pk_mul_f32 v[152:153], v[210:211], v[210:211]
    v_pk_mul_f32 v[154:155], v[210:211], v[210:211]
    v_pk_mul_f32 v[156:157], v[210:211], v[210:211]
    v_pk_mul_f32 v[158:159], v[210:211], v[210:211]
    v_pk_mul_f32 v[160:161], v[210:211], v[210:211]
    v_pk_mul_f32 v[162:163], v[210:211], v[210:211]
    s_branch L_wo_loop_s
L_wo_tail_s:
    buffer_store_dwordx4 v[220:223], v30, s[4:7], s49 offen sc1
    s_waitcnt vmcnt(0) lgkmcnt(0)
    s_barrier
    s_add_u32 s56, s37, -1
    s_and_b32 s55, s56, 3
    s_mul_i32 s55, s55, 114688
    s_add_u32 s55, s55, 53248
    s_add_u32 s48, s38, s55
    s_and_b32 s55, s56, 1
    s_add_u32 m0, s55, 12
    s_add_u32 s56, s56, 1
    v_mov_b32 v35, -16
    v_writelane_b32 v35, s56, m0
    s_mul_i32 s55, s55, 12288
    s_add_u32 m0, s54, s55
    buffer_load_dword v36, v33, s[4:7], s38 offen sc1
    s_add_u32 s56, s37, -2
    s_and_b32 s55, s56, 3
    s_mul_i32 s55, s55, 24576
    v_add_u32 v26, s55, v22
    v_add_u32 v27, s55, v23
    s_and_b32 s55, s56, 1
    s_mul_i32 s55, s55, 12288
    v_add_u32 v29, s55, v28
    s_mov_b32 s49, 5505024
    ds_read_b128 v[204:207], v26 offset:0
    ds_read_b128 v[180:183], v29 offset:0
    ds_read_b128 v[184:187], v29 offset:1024
    ds_read_b64 v[208:209], v27 offset:0
    ds_read_b128 v[188:191], v29 offset:2048
    ds_read_b128 v[212:215], v26 offset:1536
    ds_read_b128 v[192:195], v29 offset:3072
    ds_read_b128 v[196:199], v29 offset:4096
    ds_read_b64 v[216:217], v27 offset:1536
    ds_read_b128 v[200:203], v29 offset:5120
    s_waitcnt lgkmcnt(5)
    v_mfma_f32_16x16x32_bf16 v[220:223], v[180:183], v[204:207], 0
    v_mfma_f32_16x16x32_bf16 v[224:227], v[184:187], v[204:207], 0
    v_mfma_f32_16x16x32_bf16 v[224:227], v[188:191], v[208:211], v[224:227]
    ds_read_b128 v[204:207], v26 offset:3072
    ds_read_b128 v[180:183], v29 offset:6144
    ds_read_b128 v[184:187], v29 offset:7168
    ds_read_b64 v[208:209], v27 offset:3072
    ds_read_b128 v[188:191], v29 offset:8192
    s_waitcnt lgkmcnt(5)
    v_mfma_f32_16x16x32_bf16 v[220:223], v[192:195], v[212:215], v[220:223]
    v_mfma_f32_16x16x32_bf16 v[224:227], v[196:199], v[212:215], v[224:227]
    v_mfma_f32_16x16x32_bf16 v[224:227], v[200:203], v[216:219], v[224:227]
    ds_read_b128 v[212:215], v26 offset:4608
    ds_read_b128 v[192:195], v29 offset:9216
    ds_read_b128 v[196:199], v29 offset:10240
    ds_read_b64 v[216:217], v27 offset:4608
    ds_read_b128 v[200:203], v29 offset:11264
    s_waitcnt lgkmcnt(5)
    v_mfma_f32_16x16x32_bf16 v[220:223], v[180:183], v[204:207], v[220:223]
    v_mfma_f32_16x16x32_bf16 v[224:227], v[184:187], v[204:207], v[224:227]
    v_mfma_f32_16x16x32_bf16 v[224:227], v[188:191], v[208:211], v[224:227]
    s_waitcnt lgkmcnt(0)
    v_mfma_f32_16x16x32_bf16 v[220:223], v[192:195], v[212:215], v[220:223]
    v_mfma_f32_16x16x32_bf16 v[224:227], v[196:199], v[212:215], v[224:227]
    v_mfma_f32_16x16x32_bf16 v[224:227], v[200:203], v[216:219], v[224:227]
    s_nop 0
    v_cvt_pk_bf16_f32 v220, v220, v221
    v_cvt_pk_bf16_f32 v221, v222, v223
    s_nop 4
    v_cvt_pk_bf16_f32 v222, v224, v225
    v_cvt_pk_bf16_f32 v223, v226, v227
    buffer_store_dwordx4 v[220:223], v30, s[4:7], s49 offen sc1
    s_waitcnt vmcnt(1)
    v_cmp_lt_i32 vcc, v36, v35
    s_cbranch_vccz L_fok_76
L_fw_75:
    buffer_load_dword v36, v33, s[4:7], s38 offen sc1
    s_sub_u32 s36, s36, 1
    s_cbranch_scc1 L_exit
    s_waitcnt vmcnt(0)
    v_cmp_lt_i32 vcc, v36, v35
    s_cbranch_vccnz L_fw_75
L_fok_76:
    buffer_load_dwordx4 v37, s[4:7], s48 offen offset:0 sc1 lds
    buffer_load_dwordx4 v37, s[4:7], s48 offen offset:1024 sc1 lds
    buffer_load_dwordx4 v37, s[4:7], s48 offen offset:2048 sc1 lds
    s_waitcnt vmcnt(0) lgkmcnt(0)
    s_barrier
    s_add_u32 s56, s37, -1
    s_and_b32 s55, s56, 3
    s_mul_i32 s55, s55, 24576
    v_add_u32 v26, s55, v22
    v_add_u32 v27, s55, v23
    s_and_b32 s55, s56, 1
    s_mul_i32 s55, s55, 12288
    v_add_u32 v29, s55, v28
    s_mov_b32 s49, 5832704
    ds_read_b128 v[204:207], v26 offset:0
    ds_read_b128 v[180:183], v29 offset:0
    ds_read_b128 v[184:187], v29 offset:1024
    ds_read_b64 v[208:209], v27 offset:0
    ds_read_b128 v[188:191], v29 offset:2048
    ds_read_b128 v[212:215], v26 offset:1536
    ds_read_b128 v[192:195], v29 offset:3072
    ds_read_b128 v[196:199], v29 offset:4096
    ds_read_b64 v[216:217], v27 offset:1536
    ds_read_b128 v[200:203], v29 offset:5120
    s_waitcnt lgkmcnt(5)
    v_mfma_f32_16x16x32_bf16 v[220:223], v[180:183], v[204:207], 0
    v_mfma_f32_16x16x32_bf16 v[224:227], v[184:187], v[204:207], 0
    v_mfma_f32_16x16x32_bf16 v[224:227], v[188:191], v[208:211], v[224:227]
    ds_read_b128 v[204:207], v26 offset:3072
    ds_read_b128 v[180:183], v29 offset:6144
    ds_read_b128 v[184:187], v29 offset:7168
    ds_read_b64 v[208:209], v27 offset:3072
    ds_read_b128 v[188:191], v29 offset:8192
    s_waitcnt lgkmcnt(5)
    v_mfma_f32_16x16x32_bf16 v[220:223], v[192:195], v[212:215], v[220:223]
    v_mfma_f32_16x16x32_bf16 v[224:227], v[196:199], v[212:215], v[224:227]
    v_mfma_f32_16x16x32_bf16 v[224:227], v[200:203], v[216:219], v[224:227]
    ds_read_b128 v[212:215], v26 offset:4608
    ds_read_b128 v[192:195], v29 offset:9216
    ds_read_b128 v[196:199], v29 offset:10240
    ds_read_b64 v[216:217], v27 offset:4608
    ds_read_b128 v[200:203], v29 offset:11264
    s_waitcnt lgkmcnt(5)
    v_mfma_f32_16x16x32_bf16 v[220:223], v[180:183], v[204:207], v[220:223]
    v_mfma_f32_16x16x32_bf16 v[224:227], v[184:187], v[204:207], v[224:227]
    v_mfma_f32_16x16x32_bf16 v[224:227], v[188:191], v[208:211], v[224:227]
    s_waitcnt lgkmcnt(0)
    v_mfma_f32_16x16x32_bf16 v[220:223], v[192:195], v[212:215], v[220:223]
    v_mfma_f32_16x16x32_bf16 v[224:227], v[196:199], v[212:215], v[224:227]
    v_mfma_f32_16x16x32_bf16 v[224:227], v[200:203], v[216:219], v[224:227]
    s_nop 0
    v_cvt_pk_bf16_f32 v220, v220, v221
    v_cvt_pk_bf16_f32 v221, v222, v223
    s_nop 4
    v_cvt_pk_bf16_f32 v222, v224, v225
    v_cvt_pk_bf16_f32 v223, v226, v227
    buffer_store_dwordx4 v[220:223], v30, s[4:7], s49 offen sc1
    s_mov_b32 s51, 5832704
L_fp_77:
    buffer_load_dwordx4 v[120:123], v31, s[4:7], s51 offen sc1
    s_sub_u32 s36, s36, 1
    s_cbranch_scc1 L_exit
    s_waitcnt vmcnt(0)
    v_max3_u32 v41, v120, v121, v122
    v_max_u32 v41, v41, v123
    v_cmp_eq_u32 vcc, -1, v41
    s_cbranch_vccnz L_fp_77
    s_mov_b32 s51, 4849664
    buffer_load_dwordx4 v[148:151], v31, s[4:7], s51 offen sc1
    s_mov_b32 s51, 5177344
    buffer_load_dwordx4 v[152:155], v31, s[4:7], s51 offen sc1
    s_mov_b32 s51, 4194304
    buffer_load_dwordx4 v[156:159], v31, s[4:7], s51 offen sc1
    s_mov_b32 s51, 5505024
    buffer_load_dwordx4 v[160:163], v31, s[4:7], s51 offen sc1
    s_mov_b32 s52, 5079040
    v_mfma_f32_16x16x32_bf16 v[232:235], a[144:147], v[120:123], 0
    s_nop 7
    v_cndmask_b32 v234, v232, v233, s[58:59]
    v_cndmask_b32 v235, v233, v232, s[58:59]
    s_nop 1
    v_add_f32_dpp v235, v234, v235 row_ror:8 row_mask:0xf bank_mask:0xf
    v_cvt_pk_bf16_f32 v235, v235, v235
    buffer_store_short v235, v32, s[28:31], s52 offen
    s_waitcnt vmcnt(1)
    s_mov_b32 s52, 4751360
    v_mfma_f32_16x16x32_bf16 v[232:235], a[144:147], v[148:151], 0
    s_nop 7
    v_cndmask_b32 v234, v232, v233, s[58:59]
    v_cndmask_b32 v235, v233, v232, s[58:59]
    s_nop 1
    v_add_f32_dpp v235, v234, v235 row_ror:8 row_mask:0xf bank_mask:0xf
    v_cvt_pk_bf16_f32 v235, v235, v235
    buffer_store_short v235, v32, s[28:31], s52 offen
    s_mov_b32 s52, 4833280
    v_mfma_f32_16x16x32_bf16 v[232:235], a[144:147], v[152:155], 0
    s_nop 7
    v_cndmask_b32 v234, v232, v233, s[58:59]
    v_cndmask_b32 v235, v233, v232, s[58:59]
    s_nop 1
    v_add_f32_dpp v235, v234, v235 row_ror:8 row_mask:0xf bank_mask:0xf
    v_cvt_pk_bf16_f32 v235, v235, v235
    buffer_store_short v235, v32, s[28:31], s52 offen
    s_mov_b32 s52, 4915200
    v_mfma_f32_16x16x32_bf16 v[232:235], a[144:147], v[156:159], 0
    s_nop 7
    v_cndmask_b32 v234, v232, v233, s[58:59]
    v_cndmask_b32 v235, v233, v232, s[58:59]
    s_nop 1
    v_add_f32_dpp v235, v234, v235 row_ror:8 row_mask:0xf bank_mask:0xf
    v_cvt_pk_bf16_f32 v235, v235, v235
    buffer_store_short v235, v32, s[28:31], s52 offen
    s_mov_b32 s52, 4997120
    v_mfma_f32_16x16x32_bf16 v[232:235], a[144:147], v[160:163], 0
    s_nop 7
    v_cndmask_b32 v234, v232, v233, s[58:59]
    v_cndmask_b32 v235, v233, v232, s[58:59]
    s_nop 1
    v_add_f32_dpp v235, v234, v235 row_ror:8 row_mask:0xf bank_mask:0xf
    v_cvt_pk_bf16_f32 v235, v235, v235
    buffer_store_short v235, v32, s[28:31], s52 offen
    s_add_u32 s56, s37, 0
    s_and_b32 s55, s56, 3
    s_mul_i32 s55, s55, 114688
    s_add_u32 s55, s55, 53248
    s_add_u32 s48, s38, s55
    s_and_b32 s55, s56, 1
    s_add_u32 m0, s55, 12
    s_add_u32 s56, s56, 1
    v_mov_b32 v35, -16
    v_writelane_b32 v35, s56, m0
    s_mul_i32 s55, s55, 12288
    s_add_u32 m0, s54, s55
    buffer_load_dword v36, v33, s[4:7], s38 offen sc1
    s_waitcnt vmcnt(0)
    v_cmp_lt_i32 vcc, v36, v35
    s_cbranch_vccz L_fok_79
L_fw_78:
    buffer_load_dword v36, v33, s[4:7], s38 offen sc1
    s_sub_u32 s36, s36, 1
    s_cbranch_scc1 L_exit
    s_waitcnt vmcnt(0)
    v_cmp_lt_i32 vcc, v36, v35
    s_cbranch_vccnz L_fw_78
L_fok_79:
    buffer_load_dwordx4 v37, s[4:7], s48 offen offset:0 sc1 lds
    buffer_load_dwordx4 v37, s[4:7], s48 offen offset:1024 sc1 lds
    buffer_load_dwordx4 v37, s[4:7], s48 offen offset:2048 sc1 lds
    s_waitcnt vmcnt(0) lgkmcnt(0)
    s_barrier
    s_add_u32 s56, s37, 0
    s_and_b32 s55, s56, 3
    s_mul_i32 s55, s55, 24576
    v_add_u32 v26, s55, v22
    v_add_u32 v27, s55, v23
    s_and_b32 s55, s56, 1
    s_mul_i32 s55, s55, 12288
    v_add_u32 v29, s55, v28
    s_mov_b32 s49, 6160384
    ds_read_b128 v[204:207], v26 offset:0
    ds_read_b128 v[180:183], v29 offset:0
    ds_read_b128 v[184:187], v29 offset:1024
    ds_read_b64 v[208:209], v27 offset:0
    ds_read_b128 v[188:191], v29 offset:2048
    ds_read_b128 v[212:215], v26 offset:1536
    ds_read_b128 v[192:195], v29 offset:3072
    ds_read_b128 v[196:199], v29 offset:4096
    ds_read_b64 v[216:217], v27 offset:1536
    ds_read_b128 v[200:203], v29 offset:5120
    s_waitcnt lgkmcnt(5)
    v_mfma_f32_16x16x32_bf16 v[220:223], v[180:183], v[204:207], 0
    v_mfma_f32_16x16x32_bf16 v[224:227], v[184:187], v[204:207], 0
    v_mfma_f32_16x16x32_bf16 v[224:227], v[188:191], v[208:211], v[224:227]
    ds_read_b128 v[204:207], v26 offset:3072
    ds_read_b128 v[180:183], v29 offset:6144
    ds_read_b128 v[184:187], v29 offset:7168
    ds_read_b64 v[208:209], v27 offset:3072
    ds_read_b128 v[188:191], v29 offset:8192
    s_waitcnt lgkmcnt(5)
    v_mfma_f32_16x16x32_bf16 v[220:223], v[192:195], v[212:215], v[220:223]
    v_mfma_f32_16x16x32_bf16 v[224:227], v[196:199], v[212:215], v[224:227]
    v_mfma_f32_16x16x32_bf16 v[224:227], v[200:203], v[216:219], v[224:227]
    ds_read_b128 v[212:215], v26 offset:4608
    ds_read_b128 v[192:195], v29 offset:9216
    ds_read_b128 v[196:199], v29 offset:10240
    ds_read_b64 v[216:217], v27 offset:4608
    ds_read_b128 v[200:203], v29 offset:11264
    s_waitcnt lgkmcnt(5)
    v_mfma_f32_16x16x32_bf16 v[220:223], v[180:183], v[204:207], v[220:223]
    v_mfma_f32_16x16x32_bf16 v[224:227], v[184:187], v[204:207], v[224:227]
    v_mfma_f32_16x16x32_bf16 v[224:227], v[188:191], v[208:211], v[224:227]
    s_waitcnt lgkmcnt(0)
    v_mfma_f32_16x16x32_bf16 v[220:223], v[192:195], v[212:215], v[220:223]
    v_mfma_f32_16x16x32_bf16 v[224:227], v[196:199], v[212:215], v[224:227]
    v_mfma_f32_16x16x32_bf16 v[224:227], v[200:203], v[216:219], v[224:227]
    s_nop 0
    v_cvt_pk_bf16_f32 v220, v220, v221
    v_cvt_pk_bf16_f32 v221, v222, v223
    s_nop 4
    v_cvt_pk_bf16_f32 v222, v224, v225
    v_cvt_pk_bf16_f32 v223, v226, v227
    buffer_store_dwordx4 v[220:223], v30, s[4:7], s49 offen sc1
    s_mov_b32 s51, 6160384
L_fp_80:
    buffer_load_dwordx4 v[120:123], v31, s[4:7], s51 offen sc1
    s_sub_u32 s36, s36, 1
    s_cbranch_scc1 L_exit
    s_waitcnt vmcnt(0)
    v_max3_u32 v41, v120, v121, v122
    v_max_u32 v41, v41, v123
    v_cmp_eq_u32 vcc, -1, v41
    s_cbranch_vccnz L_fp_80
    s_mov_b32 s52, 5160960
    v_mfma_f32_16x16x32_bf16 v[232:235], a[144:147], v[120:123], 0
    s_nop 7
    v_cndmask_b32 v234, v232, v233, s[58:59]
    v_cndmask_b32 v235, v233, v232, s[58:59]
    s_nop 1
    v_add_f32_dpp v235, v234, v235 row_ror:8 row_mask:0xf bank_mask:0xf
    v_cvt_pk_bf16_f32 v235, v235, v235
    buffer_store_short v235, v32, s[28:31], s52 offen
    s_endpgm
L_tw_56:
    buffer_load_dword v217, v216, s[4:7], s38 offen sc1
    buffer_load_dword v217, v216, s[4:7], s38 offen sc1
L_tw_56a:
    buffer_load_dword v217, v216, s[4:7], s38 offen sc1
    s_sub_u32 s36, s36, 1
    s_cbranch_scc1 L_exit
    s_waitcnt vmcnt(2)
    v_cmp_gt_u32 vcc, s37, v217
    s_cbranch_vccz L_tok_57
    s_branch L_tw_56a
L_pp_58:
L_pp_58a:
    s_waitcnt vmcnt(1)
    v_mfma_f32_16x16x32_bf16 v[196:199], v[210:213], v[188:191], 0
    v_mfma_f32_16x16x32_bf16 v[200:203], v[208:211], v[188:191], 0
    v_max3_u32 v221, v188, v189, v190
    s_waitcnt vmcnt(0)
    v_mfma_f32_16x16x32_bf16 v[196:199], v[210:213], v[192:195], v[196:199]
    v_max3_u32 v222, v191, v192, v193
    v_max3_u32 v221, v221, v194, v195
    v_mfma_f32_16x16x32_bf16 v[200:203], v[208:211], v[192:195], v[200:203]
    v_max_u32 v221, v221, v222
    v_cmp_eq_u32 vcc, -1, v221
    s_nop 2
    v_cvt_pk_bf16_f32 v204, v196, v197
    v_cvt_pk_bf16_f32 v205, v198, v199
    s_cbranch_vccnz L_pp_58b
    v_cvt_pk_bf16_f32 v206, v200, v201
    v_cvt_pk_bf16_f32 v207, v202, v203
    buffer_store_dwordx4 v[204:207], v218, s[4:7], s42 offen sc1
    s_branch L_pc_59
L_pp_58b:
    buffer_load_dwordx4 v[188:191], v214, s[4:7], s55 offen sc1
    buffer_load_dwordx4 v[192:195], v215, s[4:7], s55 offen sc1
    s_sub_u32 s36, s36, 1
    s_cbranch_scc1 L_exit
    s_branch L_pp_58a
L_vm_67:
    buffer_load_dwordx4 v[136:139], v44, s[4:7], s43 offen offset:0 sc1
    buffer_load_dwordx4 v[140:143], v44, s[4:7], s43 offen offset:1024 sc1
    buffer_load_dwordx4 v[144:147], v44, s[4:7], s43 offen offset:2048 sc1
    s_sub_u32 s36, s36, 1
    s_cbranch_scc1 L_exit
    s_waitcnt vmcnt(0)
    v_max_u32 v4, v136, v137
    v_max3_u32 v4, v4, v138, v139
    v_max3_u32 v4, v4, v140, v141
    v_max3_u32 v4, v4, v142, v143
    v_max3_u32 v4, v4, v144, v145
    v_max3_u32 v4, v4, v146, v147
    v_cmp_eq_u32 vcc, -1, v4
    s_cbranch_vccnz L_vm_67
    buffer_load_dwordx4 v[92:95], v38, s[4:7], s43 offen offset:0 sc1
    buffer_load_dword v104, v39, s[4:7], s43 offen offset:0 sc1
    buffer_load_dwordx4 v[96:99], v38, s[4:7], s43 offen offset:1280 sc1
    buffer_load_dword v105, v39, s[4:7], s43 offen offset:1280 sc1
    buffer_load_dwordx4 v[100:103], v38, s[4:7], s43 offen offset:2560 sc1
    buffer_load_dword v106, v39, s[4:7], s43 offen offset:2560 sc1
    v_mov_b32 v148, 0
    v_mov_b32 v149, 0
    v_mov_b32 v150, 0
    v_mov_b32 v151, 0
    v_mov_b32 v152, 0
    v_mov_b32 v153, 0
    v_mov_b32 v154, 0
    v_mov_b32 v155, 0
    v_mov_b32 v156, 0
    v_mov_b32 v157, 0
    v_mov_b32 v158, 0
    v_mov_b32 v159, 0
    v_mov_b32 v160, 0
    v_mov_b32 v161, 0
    v_mov_b32 v162, 0
    v_mov_b32 v163, 0
    v_smfmac_f32_16x16x64_bf16 v[148:151], v[136:139], a[0:7], v10
    v_smfmac_f32_16x16x64_bf16 v[152:155], v[136:139], a[24:31], v10
    v_smfmac_f32_16x16x64_bf16 v[156:159], v[136:139], a[48:55], v10
    v_smfmac_f32_16x16x64_bf16 v[160:163], v[136:139], a[72:79], v10
    v_smfmac_f32_16x16x64_bf16 v[148:151], v[140:143], a[8:15], v10
    v_smfmac_f32_16x16x64_bf16 v[152:155], v[140:143], a[32:39], v10
    v_smfmac_f32_16x16x64_bf16 v[156:159], v[140:143], a[56:63], v10
    v_smfmac_f32_16x16x64_bf16 v[160:163], v[140:143], a[80:87], v10
    v_smfmac_f32_16x16x64_bf16 v[148:151], v[144:147], a[16:23], v10
    v_smfmac_f32_16x16x64_bf16 v[152:155], v[144:147], a[40:47], v10
    v_smfmac_f32_16x16x64_bf16 v[156:159], v[144:147], a[64:71], v10
    v_smfmac_f32_16x16x64_bf16 v[160:163], v[144:147], a[88:95], v10
    v_pk_add_f32 v[148:149], v[148:149], v[150:151]
    v_cmp_u_f32 vcc, v148, v149
    v_cvt_pk_bf16_f32 v50, v148, v149
    v_cvt_pk_bf16_f32 v54, v148, v149
    v_pk_add_f32 v[152:153], v[152:153], v[154:155]
    v_cvt_pk_bf16_f32 v58, v152, v153
    v_cvt_pk_bf16_f32 v62, v152, v153
    v_pk_add_f32 v[156:157], v[156:157], v[158:159]
    v_cvt_pk_bf16_f32 v66, v156, v157
    v_cvt_pk_bf16_f32 v70, v156, v157
    v_pk_add_f32 v[160:161], v[160:161], v[162:163]
    v_cvt_pk_bf16_f32 v74, v160, v161
    v_cvt_pk_bf16_f32 v78, v160, v161
    s_branch L_u_68
L_sp_70:
    v_max3_u32 v4, v104, v105, v106
    v_max3_u32 v4, v4, v92, v93
    v_max3_u32 v4, v4, v94, v95
    v_max3_u32 v4, v4, v96, v97
    v_max3_u32 v4, v4, v98, v99
    v_max3_u32 v4, v4, v100, v101
    v_max3_u32 v4, v4, v102, v103
    v_cmp_eq_u32 vcc, -1, v4
    s_cbranch_vccz L_sg_71
    buffer_load_dwordx4 v[92:95], v38, s[4:7], s43 offen offset:0 sc1
    buffer_load_dword v104, v39, s[4:7], s43 offen offset:0 sc1
    buffer_load_dwordx4 v[96:99], v38, s[4:7], s43 offen offset:1280 sc1
    buffer_load_dword v105, v39, s[4:7], s43 offen offset:1280 sc1
    buffer_load_dwordx4 v[100:103], v38, s[4:7], s43 offen offset:2560 sc1
    buffer_load_dword v106, v39, s[4:7], s43 offen offset:2560 sc1
    s_sub_u32 s36, s36, 1
    s_cbranch_scc1 L_exit
    s_branch L_sc_69
L_px_s:
    s_sub_u32 s40, s35, 22
    v_and_b32 v1, 15, v0
    v_lshrrev_b32 v2, 4, v0
    s_mul_i32 s90, s32, 12288
    v_lshl_add_u32 v10, v0, 4, s90
    s_mul_i32 s90, s32, 3072
    v_lshl_add_u32 v12, v0, 4, s90
    v_lshrrev_b32 v3, 2, v1
    v_lshlrev_b32 v3, 1, v3
    v_and_b32 v4, 1, v1
    v_or_b32 v3, v3, v4
    v_lshl_add_u32 v3, v2, 3, v3
    v_lshl_add_u32 v11, v3, 4, s90
    s_lshl_b32 s90, s32, 7
    v_min_u32 v3, 11, v0
    v_lshl_add_u32 v3, v3, 2, s90
    v_add_u32 v13, 458752, v3
    v_min_u32 v3, 2, v0
    v_lshl_add_u32 v3, v3, 2, s90
    v_add_u32 v14, 459264, v3
    s_lshl_b32 s91, s40, 2
    s_add_u32 s90, s90, s91
    s_add_u32 s90, s90, 459776
    v_mov_b32 v15, s90
    v_cmp_eq_u32 vcc, 0, v0
    v_mov_b32 v9, 2146435072
    s_nop 0
    v_cndmask_b32 v15, v9, v15, vcc
    s_nop 0
    v_mov_b32 v21, 0xd04e79ff
    s_mov_b32 s44, 0x3dd53b95
    v_lshl_add_u32 v3, v2, 2, 0
    v_cmp_le_u32 s[48:49], v3, v1
    v_lshl_add_u32 v3, v2, 2, 1
    v_cmp_le_u32 s[50:51], v3, v1
    v_lshl_add_u32 v3, v2, 2, 2
    v_cmp_le_u32 s[52:53], v3, v1
    v_lshl_add_u32 v3, v2, 2, 3
    v_cmp_le_u32 s[54:55], v3, v1
    v_mov_b32 v167, 0
    v_mov_b32 v171, 0
    v_mov_b32 v174, 0
    v_mov_b32 v175, 0
    s_waitcnt vmcnt(0)
    s_barrier
    s_mov_b32 s24, s70
    s_and_b32 s25, s71, 0xffff
    s_mov_b32 s26, 2621440
    s_mov_b32 s27, 0x20000
    s_mul_i32 s90, s32, 10240
    v_lshl_add_u32 v22, v0, 4, s90
    s_mov_b32 s37, s40
    s_cmp_eq_u32 s40, 1
    s_cbranch_scc1 L_xp_81
    v_mov_b32 v1, 196
L_gw_83:
    buffer_load_dword v2, v1, s[8:11], 0 offen sc1
    s_sub_u32 s36, s36, 1
    s_cbranch_scc1 L_exit
    s_waitcnt vmcnt(0)
    v_readfirstlane_b32 s90, v2
    s_nop 0
    s_cmp_eq_u32 s90, 0
    s_cbranch_scc1 L_gw_83
    s_cmp_lg_u32 s32, 0
    s_cbranch_scc1 L_xg_82
    s_lshl_b32 s92, s34, 14
    s_add_u32 s92, s92, 1966080
    s_add_u32 s93, s92, 8192
    v_lshlrev_b32 v3, 4, v0
    buffer_store_dwordx4 v[24:27], v3, s[4:7], s92 offen offset:0 sc1
    buffer_store_dwordx4 v[24:27], v3, s[4:7], s93 offen offset:0 sc1
    buffer_store_dwordx4 v[24:27], v3, s[4:7], s92 offen offset:1024 sc1
    buffer_store_dwordx4 v[24:27], v3, s[4:7], s93 offen offset:1024 sc1
    buffer_store_dwordx4 v[24:27], v3, s[4:7], s92 offen offset:2048 sc1
    buffer_store_dwordx4 v[24:27], v3, s[4:7], s93 offen offset:2048 sc1
    buffer_store_dwordx4 v[24:27], v3, s[4:7], s92 offen offset:3072 sc1
    buffer_store_dwordx4 v[24:27], v3, s[4:7], s93 offen offset:3072 sc1
    v_mov_b32 v3, 0
    s_mov_b32 s56, -1
    s_mov_b32 s57, -1
    s_mov_b32 s62, 0
    s_mov_b32 s63, 0
    s_waitcnt vmcnt(0)
L_pr_84:
    s_memtime s[58:59]
    s_waitcnt lgkmcnt(0)
    buffer_load_dword v4, v3, s[4:7], s92 offen sc1
    s_waitcnt vmcnt(0)
    s_memtime s[60:61]
    s_waitcnt lgkmcnt(0)
    s_sub_u32 s60, s60, s58
    s_min_u32 s56, s56, s60
    s_memtime s[58:59]
    s_waitcnt lgkmcnt(0)
    buffer_load_dword v4, v3, s[4:7], s93 offen sc1
    s_waitcnt vmcnt(0)
    s_memtime s[60:61]
    s_waitcnt lgkmcnt(0)
    s_sub_u32 s60, s60, s58
    s_min_u32 s57, s57, s60
    buffer_load_dword v4, v13, s[4:7], s38 offen sc1
    v_add_u32 v3, 128, v3
    s_add_u32 s62, s62, 1
    s_waitcnt vmcnt(0)
    v_cmp_eq_u32 vcc, 0, v4
    s_nop 0
    s_cmp_eq_u64 vcc, 0
    s_addc_u32 s63, s63, 0
    s_cmp_ge_u32 s63, 2
    s_cselect_b32 s62, 32, s62
    s_cmp_lt_u32 s62, 32
    s_cbranch_scc1 L_pr_84
    s_cmp_lt_u32 s57, s56
    s_cselect_b32 s62, 2, 1
L_xg_82:
    s_barrier
    s_branch L_xg_82x
L_xp_81:
    s_or_b32 s90, s34, s32
    s_cbranch_scc1 L_xp_81c
    v_lshlrev_b32 v1, 2, v0
L_arp_86:
    buffer_load_dword v2, v1, s[8:11], 0 offen sc1
    s_sub_u32 s36, s36, 1
    s_cbranch_scc1 L_exit
    s_waitcnt vmcnt(0)
    v_readlane_b32 s92, v2, 17
    s_nop 0
    s_cmp_lg_u32 s92, 256
    s_cbranch_scc1 L_arp_86
    v_mov_b32 v1, 196
    v_mov_b32 v2, 1
    s_mov_b64 exec, 1
    buffer_store_dword v2, v1, s[8:11], 0 offen sc1
    s_mov_b64 exec, -1
L_arr_85:
L_xp_81c:
    s_barrier
    s_add_u32 s90, s37, 1
    s_min_u32 s90, s90, 63
    s_mul_i32 s90, s90, 40960
    buffer_load_dwordx4 v[248:251], v22, s[24:27], s90 offen offset:0
    buffer_load_dwordx4 v[248:251], v22, s[24:27], s90 offen offset:1024
    buffer_load_dwordx4 v[248:251], v22, s[24:27], s90 offen offset:2048
    buffer_load_dwordx4 v[248:251], v22, s[24:27], s90 offen offset:3072
    s_add_u32 s90, s90, 4096
    buffer_load_dwordx4 v[248:251], v22, s[24:27], s90 offen offset:0
    buffer_load_dwordx4 v[248:251], v22, s[24:27], s90 offen offset:1024
    buffer_load_dwordx4 v[248:251], v22, s[24:27], s90 offen offset:2048
    buffer_load_dwordx4 v[248:251], v22, s[24:27], s90 offen offset:3072
    s_add_u32 s90, s90, 4096
    buffer_load_dwordx4 v[248:251], v22, s[24:27], s90 offen offset:0
    buffer_load_dwordx4 v[248:251], v22, s[24:27], s90 offen offset:1024
    s_add_u32 s90, s37, 2
    s_min_u32 s90, s90, 63
    s_mul_i32 s90, s90, 40960
    buffer_load_dwordx4 v[248:251], v22, s[24:27], s90 offen offset:0
    buffer_load_dwordx4 v[248:251], v22, s[24:27], s90 offen offset:1024
    buffer_load_dwordx4 v[248:251], v22, s[24:27], s90 offen offset:2048
    buffer_load_dwordx4 v[248:251], v22, s[24:27], s90 offen offset:3072
    s_add_u32 s90, s90, 4096
    buffer_load_dwordx4 v[248:251], v22, s[24:27], s90 offen offset:0
    buffer_load_dwordx4 v[248:251], v22, s[24:27], s90 offen offset:1024
    buffer_load_dwordx4 v[248:251], v22, s[24:27], s90 offen offset:2048
    buffer_load_dwordx4 v[248:251], v22, s[24:27], s90 offen offset:3072
    s_add_u32 s90, s90, 4096
    buffer_load_dwordx4 v[248:251], v22, s[24:27], s90 offen offset:0
    buffer_load_dwordx4 v[248:251], v22, s[24:27], s90 offen offset:1024
    s_add_u32 s90, s37, 3
    s_min_u32 s90, s90, 63
    s_mul_i32 s90, s90, 40960
    buffer_load_dwordx4 v[248:251], v22, s[24:27], s90 offen offset:0
    buffer_load_dwordx4 v[248:251], v22, s[24:27], s90 offen offset:1024
    buffer_load_dwordx4 v[248:251], v22, s[24:27], s90 offen offset:2048
    buffer_load_dwordx4 v[248:251], v22, s[24:27], s90 offen offset:3072
    s_add_u32 s90, s90, 4096
    buffer_load_dwordx4 v[248:251], v22, s[24:27], s90 offen offset:0
    buffer_load_dwordx4 v[248:251], v22, s[24:27], s90 offen offset:1024
    buffer_load_dwordx4 v[248:251], v22, s[24:27], s90 offen offset:2048
    buffer_load_dwordx4 v[248:251], v22, s[24:27], s90 offen offset:3072
    s_add_u32 s90, s90, 4096
    buffer_load_dwordx4 v[248:251], v22, s[24:27], s90 offen offset:0
    buffer_load_dwordx4 v[248:251], v22, s[24:27], s90 offen offset:1024
    s_add_u32 s90, s37, 4
    s_min_u32 s90, s90, 63
    s_mul_i32 s90, s90, 40960
    buffer_load_dwordx4 v[248:251], v22, s[24:27], s90 offen offset:0
    buffer_load_dwordx4 v[248:251], v22, s[24:27], s90 offen offset:1024
    buffer_load_dwordx4 v[248:251], v22, s[24:27], s90 offen offset:2048
    buffer_load_dwordx4 v[248:251], v22, s[24:27], s90 offen offset:3072
    s_add_u32 s90, s90, 4096
    buffer_load_dwordx4 v[248:251], v22, s[24:27], s90 offen offset:0
    buffer_load_dwordx4 v[248:251], v22, s[24:27], s90 offen offset:1024
    buffer_load_dwordx4 v[248:251], v22, s[24:27], s90 offen offset:2048
    buffer_load_dwordx4 v[248:251], v22, s[24:27], s90 offen offset:3072
    s_add_u32 s90, s90, 4096
    buffer_load_dwordx4 v[248:251], v22, s[24:27], s90 offen offset:0
    buffer_load_dwordx4 v[248:251], v22, s[24:27], s90 offen offset:1024
    s_add_u32 s90, s37, 5
    s_min_u32 s90, s90, 63
    s_mul_i32 s90, s90, 40960
    buffer_load_dwordx4 v[248:251], v22, s[24:27], s90 offen offset:0
    buffer_load_dwordx4 v[248:251], v22, s[24:27], s90 offen offset:1024
    buffer_load_dwordx4 v[248:251], v22, s[24:27], s90 offen offset:2048
    buffer_load_dwordx4 v[248:251], v22, s[24:27], s90 offen offset:3072
    s_add_u32 s90, s90, 4096
    buffer_load_dwordx4 v[248:251], v22, s[24:27], s90 offen offset:0
    buffer_load_dwordx4 v[248:251], v22, s[24:27], s90 offen offset:1024
    buffer_load_dwordx4 v[248:251], v22, s[24:27], s90 offen offset:2048
    buffer_load_dwordx4 v[248:251], v22, s[24:27], s90 offen offset:3072
    s_add_u32 s90, s90, 4096
    buffer_load_dwordx4 v[248:251], v22, s[24:27], s90 offen offset:0
    buffer_load_dwordx4 v[248:251], v22, s[24:27], s90 offen offset:1024
    s_add_u32 s90, s37, 6
    s_min_u32 s90, s90, 63
    s_mul_i32 s90, s90, 40960
    buffer_load_dwordx4 v[248:251], v22, s[24:27], s90 offen offset:0
    buffer_load_dwordx4 v[248:251], v22, s[24:27], s90 offen offset:1024
    buffer_load_dwordx4 v[248:251], v22, s[24:27], s90 offen offset:2048
    buffer_load_dwordx4 v[248:251], v22, s[24:27], s90 offen offset:3072
    s_add_u32 s90, s90, 4096
    buffer_load_dwordx4 v[248:251], v22, s[24:27], s90 offen offset:0
    buffer_load_dwordx4 v[248:251], v22, s[24:27], s90 offen offset:1024
    buffer_load_dwordx4 v[248:251], v22, s[24:27], s90 offen offset:2048
    buffer_load_dwordx4 v[248:251], v22, s[24:27], s90 offen offset:3072
    s_add_u32 s90, s90, 4096
    buffer_load_dwordx4 v[248:251], v22, s[24:27], s90 offen offset:0
    buffer_load_dwordx4 v[248:251], v22, s[24:27], s90 offen offset:1024
L_xg_82x:
    v_mov_b32 v1, 196
L_gw_87:
    buffer_load_dword v2, v1, s[8:11], 0 offen sc1
    s_sub_u32 s36, s36, 1
    s_cbranch_scc1 L_exit
    s_waitcnt vmcnt(0)
    v_readfirstlane_b32 s90, v2
    s_nop 0
    s_cmp_eq_u32 s90, 0
    s_cbranch_scc1 L_gw_87
    s_or_b32 s90, s40, s32
    s_cbranch_scc1 L_xg_82y
    v_mov_b32 v3, 460288
    v_mov_b32 v4, s62
    buffer_store_dword v4, v3, s[4:7], s38 offen sc1
    s_cmp_lg_u32 s34, 0
    s_cbranch_scc1 L_xg_82y
    v_mov_b32 v3, 204
    buffer_store_dword v4, v3, s[8:11], 0 offen sc1
L_xg_82y:
L_px_loop_s:
    s_and_b32 s90, s37, 7
    s_mul_i32 s91, s90, 98304
    s_add_u32 s91, s91, 475136
    s_add_u32 s41, s38, s91
    s_and_b32 s90, s37, 3
    s_mul_i32 s91, s90, 114688
    s_add_u32 s91, s91, s38
    s_add_u32 s42, s91, 40960
    s_add_u32 s43, s91, 53248
    s_add_u32 s90, s37, 1
    v_mov_b32 v17, s90
    s_add_u32 s90, s37, 8
    s_min_u32 s90, s90, 63
    s_mul_i32 s90, s90, 40960
    buffer_load_dwordx4 v[248:251], v22, s[24:27], s90 offen offset:0
    buffer_load_dwordx4 v[248:251], v22, s[24:27], s90 offen offset:1024
    buffer_load_dwordx4 v[248:251], v22, s[24:27], s90 offen offset:2048
    buffer_load_dwordx4 v[248:251], v22, s[24:27], s90 offen offset:3072
    s_add_u32 s90, s90, 4096
    buffer_load_dwordx4 v[248:251], v22, s[24:27], s90 offen offset:0
    buffer_load_dwordx4 v[248:251], v22, s[24:27], s90 offen offset:1024
    buffer_load_dwordx4 v[248:251], v22, s[24:27], s90 offen offset:2048
    buffer_load_dwordx4 v[248:251], v22, s[24:27], s90 offen offset:3072
    s_add_u32 s90, s90, 4096
    buffer_load_dwordx4 v[248:251], v22, s[24:27], s90 offen offset:0
    buffer_load_dwordx4 v[248:251], v22, s[24:27], s90 offen offset:1024
L_pf_88:
    buffer_load_dword v16, v13, s[4:7], s38 offen sc1
    s_sub_u32 s36, s36, 1
    s_cbranch_scc1 L_exit
    s_waitcnt vmcnt(0)
    v_cmp_ge_u32 vcc, s37, v16
    s_cbranch_vccnz L_pf_88
    s_add_u32 s90, s41, 0
    buffer_load_dwordx4 v[24:27], v10, s[4:7], s90 offen offset:0 sc1
    buffer_load_dwordx4 v[28:31], v10, s[4:7], s90 offen offset:1024 sc1
    buffer_load_dwordx4 v[32:35], v10, s[4:7], s90 offen offset:2048 sc1
    buffer_load_dwordx4 v[36:39], v10, s[4:7], s90 offen offset:3072 sc1
    s_add_u32 s90, s41, 4096
    buffer_load_dwordx4 v[40:43], v10, s[4:7], s90 offen offset:0 sc1
    buffer_load_dwordx4 v[44:47], v10, s[4:7], s90 offen offset:1024 sc1
    buffer_load_dwordx4 v[48:51], v10, s[4:7], s90 offen offset:2048 sc1
    buffer_load_dwordx4 v[52:55], v10, s[4:7], s90 offen offset:3072 sc1
    s_add_u32 s90, s41, 8192
    buffer_load_dwordx4 v[56:59], v10, s[4:7], s90 offen offset:0 sc1
    buffer_load_dwordx4 v[60:63], v10, s[4:7], s90 offen offset:1024 sc1
    buffer_load_dwordx4 v[64:67], v10, s[4:7], s90 offen offset:2048 sc1
    buffer_load_dwordx4 v[68:71], v10, s[4:7], s90 offen offset:3072 sc1
    s_add_u32 s90, s41, 49152
    buffer_load_dwordx4 v[72:75], v10, s[4:7], s90 offen offset:0 sc1
    buffer_load_dwordx4 v[76:79], v10, s[4:7], s90 offen offset:1024 sc1
    buffer_load_dwordx4 v[80:83], v10, s[4:7], s90 offen offset:2048 sc1
    buffer_load_dwordx4 v[84:87], v10, s[4:7], s90 offen offset:3072 sc1
    s_add_u32 s90, s41, 53248
    buffer_load_dwordx4 v[88:91], v10, s[4:7], s90 offen offset:0 sc1
    buffer_load_dwordx4 v[92:95], v10, s[4:7], s90 offen offset:1024 sc1
    buffer_load_dwordx4 v[96:99], v10, s[4:7], s90 offen offset:2048 sc1
    buffer_load_dwordx4 v[100:103], v10, s[4:7], s90 offen offset:3072 sc1
    s_add_u32 s90, s41, 57344
    buffer_load_dwordx4 v[104:107], v10, s[4:7], s90 offen offset:0 sc1
    buffer_load_dwordx4 v[108:111], v10, s[4:7], s90 offen offset:1024 sc1
    buffer_load_dwordx4 v[112:115], v10, s[4:7], s90 offen offset:2048 sc1
    buffer_load_dwordx4 v[116:119], v10, s[4:7], s90 offen offset:3072 sc1
    s_waitcnt vmcnt(0)
    v_mfma_f32_16x16x32_bf16 v[144:147], v[72:75], v[24:27], 0
    v_mfma_f32_16x16x32_bf16 v[152:155], v[72:75], v[48:51], 0
    v_mfma_f32_16x16x32_bf16 v[156:159], v[96:99], v[48:51], 0
    v_mfma_f32_16x16x32_bf16 v[144:147], v[76:79], v[28:31], v[144:147]
    v_mfma_f32_16x16x32_bf16 v[152:155], v[76:79], v[52:55], v[152:155]
    v_mfma_f32_16x16x32_bf16 v[156:159], v[100:103], v[52:55], v[156:159]
    v_mfma_f32_16x16x32_bf16 v[144:147], v[80:83], v[32:35], v[144:147]
    v_mfma_f32_16x16x32_bf16 v[152:155], v[80:83], v[56:59], v[152:155]
    v_mfma_f32_16x16x32_bf16 v[156:159], v[104:107], v[56:59], v[156:159]
    v_mfma_f32_16x16x32_bf16 v[144:147], v[84:87], v[36:39], v[144:147]
    v_mfma_f32_16x16x32_bf16 v[152:155], v[84:87], v[60:63], v[152:155]
    v_mfma_f32_16x16x32_bf16 v[156:159], v[108:111], v[60:63], v[156:159]
    v_mfma_f32_16x16x32_bf16 v[144:147], v[88:91], v[40:43], v[144:147]
    v_mfma_f32_16x16x32_bf16 v[152:155], v[88:91], v[64:67], v[152:155]
    v_mfma_f32_16x16x32_bf16 v[156:159], v[112:115], v[64:67], v[156:159]
    v_mfma_f32_16x16x32_bf16 v[144:147], v[92:95], v[44:47], v[144:147]
    v_mfma_f32_16x16x32_bf16 v[152:155], v[92:95], v[68:71], v[152:155]
    v_mfma_f32_16x16x32_bf16 v[156:159], v[116:119], v[68:71], v[156:159]
    s_nop 0
    v_cndmask_b32 v144, v21, v144, s[48:49]
    v_cndmask_b32 v145, v21, v145, s[50:51]
    v_cndmask_b32 v146, v21, v146, s[52:53]
    v_cndmask_b32 v147, v21, v147, s[54:55]
    s_nop 2
    v_cndmask_b32 v156, v21, v156, s[48:49]
    v_cndmask_b32 v157, v21, v157, s[50:51]
    v_cndmask_b32 v158, v21, v158, s[52:53]
    v_cndmask_b32 v159, v21, v159, s[54:55]
L_pf_89:
    buffer_load_dword v16, v14, s[4:7], s38 offen sc1
    s_sub_u32 s36, s36, 1
    s_cbranch_scc1 L_exit
    s_waitcnt vmcnt(0)
    v_cmp_ge_u32 vcc, s37, v16
    s_cbranch_vccnz L_pf_89
    buffer_load_dwordx4 v[120:123], v11, s[4:7], s42 offen offset:0 sc1
    buffer_load_dwordx4 v[124:127], v11, s[4:7], s42 offen offset:512 sc1
    buffer_load_dwordx4 v[128:131], v11, s[4:7], s42 offen offset:1024 sc1
    buffer_load_dwordx4 v[132:135], v11, s[4:7], s42 offen offset:1536 sc1
    buffer_load_dwordx4 v[136:139], v11, s[4:7], s42 offen offset:2048 sc1
    buffer_load_dwordx4 v[140:143], v11, s[4:7], s42 offen offset:2560 sc1
    s_waitcnt vmcnt(5)
    v_mfma_f32_16x16x32_bf16 v[148:151], v[120:123], v[24:27], 0
    v_mfma_f32_16x16x32_bf16 v[160:163], v[120:123], v[48:51], 0
    s_waitcnt vmcnt(4)
    v_mfma_f32_16x16x32_bf16 v[148:151], v[124:127], v[28:31], v[148:151]
    v_mfma_f32_16x16x32_bf16 v[160:163], v[124:127], v[52:55], v[160:163]
    s_waitcnt vmcnt(3)
    v_mfma_f32_16x16x32_bf16 v[148:151], v[128:131], v[32:35], v[148:151]
    v_mfma_f32_16x16x32_bf16 v[160:163], v[128:131], v[56:59], v[160:163]
    s_waitcnt vmcnt(2)
    v_mfma_f32_16x16x32_bf16 v[148:151], v[132:135], v[36:39], v[148:151]
    v_mfma_f32_16x16x32_bf16 v[160:163], v[132:135], v[60:63], v[160:163]
    s_waitcnt vmcnt(1)
    v_mfma_f32_16x16x32_bf16 v[148:151], v[136:139], v[40:43], v[148:151]
    v_mfma_f32_16x16x32_bf16 v[160:163], v[136:139], v[64:67], v[160:163]
    s_waitcnt vmcnt(0)
    v_mfma_f32_16x16x32_bf16 v[148:151], v[140:143], v[44:47], v[148:151]
    v_mfma_f32_16x16x32_bf16 v[160:163], v[140:143], v[68:71], v[160:163]
    v_max_f32 v18, v144, v145
    v_max3_f32 v18, v18, v146, v147
    s_nop 2
    v_max3_f32 v18, v18, v148, v149
    v_mov_b32 v19, v18
    s_nop 1
    v_permlane16_swap_b32 v18, v19
    v_max_f32 v18, v18, v19
    v_mov_b32 v19, v18
    s_nop 1
    v_permlane32_swap_b32 v18, v19
    v_max_f32 v18, v18, v19
    v_mul_f32 v18, 0xbdd53b95, v18
    v_fma_f32 v144, v144, s44, v18
    v_fma_f32 v145, v145, s44, v18
    v_fma_f32 v146, v146, s44, v18
    v_fma_f32 v147, v147, s44, v18
    v_fma_f32 v148, v148, s44, v18
    v_fma_f32 v149, v149, s44, v18
    v_exp_f32 v144, v144
    v_exp_f32 v145, v145
    v_exp_f32 v146, v146
    v_exp_f32 v147, v147
    v_exp_f32 v148, v148
    v_exp_f32 v149, v149
    v_add_f32 v20, v144, v145
    v_add_f32 v20, v20, v146
    v_add_f32 v20, v20, v147
    v_add_f32 v20, v20, v148
    v_add_f32 v20, v20, v149
    v_mov_b32 v19, v20
    s_nop 1
    v_permlane16_swap_b32 v20, v19
    v_add_f32 v20, v20, v19
    v_mov_b32 v19, v20
    s_nop 1
    v_permlane32_swap_b32 v20, v19
    v_add_f32 v20, v20, v19
    v_rcp_f32 v20, v20
    s_nop 0
    v_mul_f32 v144, v144, v20
    v_mul_f32 v145, v145, v20
    v_mul_f32 v146, v146, v20
    v_mul_f32 v147, v147, v20
    v_mul_f32 v148, v148, v20
    v_mul_f32 v149, v149, v20
    v_cvt_pk_bf16_f32 v164, v144, v145
    v_cvt_pk_bf16_f32 v165, v146, v147
    v_cvt_pk_bf16_f32 v166, v148, v149
    v_max_f32 v18, v152, v153
    v_max3_f32 v18, v18, v154, v155
    v_max3_f32 v18, v18, v160, v161
    v_max3_f32 v18, v18, v156, v157
    v_max3_f32 v18, v18, v158, v159
    v_mov_b32 v19, v18
    s_nop 1
    v_permlane16_swap_b32 v18, v19
    v_max_f32 v18, v18, v19
    v_mov_b32 v19, v18
    s_nop 1
    v_permlane32_swap_b32 v18, v19
    v_max_f32 v18, v18, v19
    v_mul_f32 v18, 0xbdd53b95, v18
    v_fma_f32 v152, v152, s44, v18
    v_fma_f32 v153, v153, s44, v18
    v_fma_f32 v154, v154, s44, v18
    v_fma_f32 v155, v155, s44, v18
    v_fma_f32 v160, v160, s44, v18
    v_fma_f32 v161, v161, s44, v18
    v_fma_f32 v156, v156, s44, v18
    v_fma_f32 v157, v157, s44, v18
    v_fma_f32 v158, v158, s44, v18
    v_fma_f32 v159, v159, s44, v18
    v_exp_f32 v152, v152
    v_exp_f32 v153, v153
    v_exp_f32 v154, v154
    v_exp_f32 v155, v155
    v_exp_f32 v160, v160
    v_exp_f32 v161, v161
    v_exp_f32 v156, v156
    v_exp_f32 v157, v157
    v_exp_f32 v158, v158
    v_exp_f32 v159, v159
    v_add_f32 v20, v152, v153
    v_add_f32 v20, v20, v154
    v_add_f32 v20, v20, v155
    v_add_f32 v20, v20, v160
    v_add_f32 v20, v20, v161
    v_add_f32 v20, v20, v156
    v_add_f32 v20, v20, v157
    v_add_f32 v20, v20, v158
    v_add_f32 v20, v20, v159
    v_mov_b32 v19, v20
    s_nop 1
    v_permlane16_swap_b32 v20, v19
    v_add_f32 v20, v20, v19
    v_mov_b32 v19, v20
    s_nop 1
    v_permlane32_swap_b32 v20, v19
    v_add_f32 v20, v20, v19
    v_rcp_f32 v20, v20
    s_nop 0
    v_mul_f32 v152, v152, v20
    v_mul_f32 v153, v153, v20
    v_mul_f32 v154, v154, v20
    v_mul_f32 v155, v155, v20
    v_mul_f32 v160, v160, v20
    v_mul_f32 v161, v161, v20
    v_mul_f32 v156, v156, v20
    v_mul_f32 v157, v157, v20
    v_mul_f32 v158, v158, v20
    v_mul_f32 v159, v159, v20
    v_cvt_pk_bf16_f32 v168, v152, v153
    v_cvt_pk_bf16_f32 v169, v154, v155
    v_cvt_pk_bf16_f32 v170, v160, v161
    v_cvt_pk_bf16_f32 v172, v156, v157
    v_cvt_pk_bf16_f32 v173, v158, v159
    buffer_store_dwordx4 v[164:167], v12, s[4:7], s43 offen offset:0 sc1
    buffer_store_dwordx4 v[168:171], v12, s[4:7], s43 offen offset:1024 sc1
    buffer_store_dwordx4 v[172:175], v12, s[4:7], s43 offen offset:2048 sc1
    s_waitcnt vmcnt(0)
    buffer_store_dword v17, v15, s[4:7], s38 offen sc1
    s_add_u32 s37, s37, 2
    s_cmp_lt_u32 s37, 64
    s_cbranch_scc1 L_px_loop_s
    s_endpgm
L_pa_s:
    v_mov_b32 v1, 196
L_gw_90:
    buffer_load_dword v2, v1, s[8:11], 0 offen sc1
    s_sub_u32 s36, s36, 1
    s_cbranch_scc1 L_exit
    s_waitcnt vmcnt(0)
    v_readfirstlane_b32 s90, v2
    s_nop 0
    s_cmp_eq_u32 s90, 0
    s_cbranch_scc1 L_gw_90
    s_branch L_pa_body
.section .rodata,"a"
.p2align 6
.amdhsa_kernel concat_heads__sliding_local_dilated__memory_aug_recurrent_mem_tr__prompt_kernel
  .amdhsa_next_free_vgpr 512
  .amdhsa_next_free_sgpr 102
  .amdhsa_accum_offset 256
  .amdhsa_group_segment_fixed_size 0
  .amdhsa_kernarg_size 104
  .amdhsa_user_sgpr_count 2
  .amdhsa_user_sgpr_kernarg_segment_ptr 1
  .amdhsa_system_sgpr_workgroup_id_x 1
  .amdhsa_float_denorm_mode_32 3
.end_amdhsa_kernel
```

```asm
; @launch grid=(256,1,1) block=(256,1,1) lds=163840
.amdgcn_target "amdgcn-amd-amdhsa--gfx950"
.text
.globl concat_heads__sliding_local_dilated__memory_aug_recurrent_mem_tr__prompt_kernel
.p2align 8
.type concat_heads__sliding_local_dilated__memory_aug_recurrent_mem_tr__prompt_kernel,@function
concat_heads__sliding_local_dilated__memory_aug_recurrent_mem_tr__prompt_kernel:
    s_cmp_ge_u32 s2, 256
    s_cbranch_scc1 L_exit
    s_load_dwordx16 s[64:79], s[0:1], 0
    s_load_dwordx8 s[80:87], s[0:1], 64
    s_load_dwordx2 s[88:89], s[0:1], 96
    s_getreg_b32 s33, hwreg(HW_REG_XCC_ID, 0, 4)
    v_lshrrev_b32 v1, 6, v0
    v_and_b32 v0, 63, v0
    v_readfirstlane_b32 s32, v1
    s_mov_b32 s36, 0x40000
    s_mov_b32 s96, 0
    s_mov_b32 s97, 0
    s_and_b32 s90, s33, 4
    s_lshl_b32 s90, s90, 5
    s_and_b32 s91, s33, 3
    s_lshl_b32 s91, s91, 2
    s_add_u32 s90, s90, s91
    s_lshr_b32 s91, s33, 3
    s_lshl_b32 s91, s91, 4
    s_add_u32 s90, s90, s91
    v_mov_b32 v1, s90
    v_mov_b32 v2, 1
    v_mov_b32 v3, 0
    s_waitcnt lgkmcnt(0)
    s_mov_b32 s8, s86
    s_and_b32 s9, s87, 0xffff
    s_mov_b32 s10, 256
    s_mov_b32 s11, 0x20000
    s_mov_b32 s4, s88
    s_and_b32 s5, s89, 0xffff
    s_mov_b32 s6, 33554432
    s_mov_b32 s7, 0x20000
    s_mov_b32 s28, s84
    s_and_b32 s29, s85, 0xffff
    s_mov_b32 s30, 5242880
    s_mov_b32 s31, 0x20000
    s_cmp_lg_u32 s32, 0
    s_cbranch_scc1 L_norank
    s_mov_b64 exec, 1
    buffer_atomic_add v2, v1, s[8:11], 0 offen sc0 sc1
    s_mov_b64 exec, -1
    v_mov_b32 v240, -1
    v_mov_b32 v241, -1
    v_mov_b32 v242, -1
    v_mov_b32 v243, -1
    v_mov_b32 v244, 0
    v_lshlrev_b32 v4, 4, v0
    v_lshlrev_b32 v5, 2, v0
    s_mul_i32 s91, s2, 2560
    s_and_b32 s92, s2, 7
    s_lshl_b32 s92, s92, 21
    s_add_u32 s92, s92, 8388608
    s_lshr_b32 s93, s2, 3
    s_lshl_b32 s40, s93, 7
    s_add_u32 s40, s40, s92
    s_add_u32 s40, s40, 458752
    s_lshr_b32 s41, s93, 4
    s_mul_i32 s41, s41, 114688
    s_add_u32 s92, s92, s41
    s_and_b32 s93, s93, 15
    s_mul_i32 s93, s93, 2560
    s_add_u32 s92, s92, s93
    buffer_store_dwordx4 v[240:243], v4, s[4:7], s91 offen sc1
    buffer_store_dwordx4 v[240:243], v4, s[4:7], s91 offen offset:1024 sc1
    buffer_store_dword v240, v5, s[4:7], s91 offen offset:2048 sc1
    buffer_store_dword v240, v5, s[4:7], s91 offen offset:2304 sc1
    buffer_store_dwordx4 v[240:243], v4, s[4:7], s92 offen sc1
    buffer_store_dwordx4 v[240:243], v4, s[4:7], s92 offen offset:1024 sc1
    buffer_store_dword v240, v5, s[4:7], s92 offen offset:2048 sc1
    buffer_store_dword v240, v5, s[4:7], s92 offen offset:2304 sc1
    s_mov_b64 exec, 0xffffffff
    buffer_store_dword v244, v5, s[4:7], s40 offen sc1
    s_lshl_b32 s40, s2, 7
    s_add_u32 s40, s40, 1933312
    buffer_store_dword v244, v5, s[4:7], s40 offen sc1
    s_mov_b64 exec, -1
    s_waitcnt vmcnt(10)
    s_mov_b64 exec, 1
    ds_write_b32 v3, v2
    s_mov_b64 exec, -1
    s_waitcnt vmcnt(0) lgkmcnt(0)
    s_and_b32 s91, s33, 4
    s_lshl_b32 s91, s91, 5
    s_add_u32 s91, s91, 48
    v_mov_b32 v1, s91
    v_mov_b32 v4, 1
    s_mov_b64 exec, 1
    buffer_atomic_add v4, v1, s[8:11], 0 offen sc1
    s_mov_b64 exec, -1
    s_branch L_rank
L_norank:
    s_and_b32 s34, s33, 7
    s_lshr_b32 s93, s2, 3
    s_mul_i32 s93, s93, 3
    s_add_u32 s93, s93, s32
    s_sub_u32 s93, s93, 1
    v_add_u32 v4, 0, v0
    v_cmp_le_u32 vcc, 96, v4
    v_subrev_u32 v5, 96, v4
    s_nop 0
    v_cndmask_b32 v4, v4, v5, vcc
    v_lshlrev_b32 v4, 4, v4
    v_mov_b32 v5, 12288
    v_cndmask_b32 v5, 0, v5, vcc
    s_mul_i32 s90, s34, 1536
    v_add3_u32 v6, v4, v5, s90
    v_add_u32 v4, 64, v0
    v_cmp_le_u32 vcc, 96, v4
    v_subrev_u32 v5, 96, v4
    s_nop 0
    v_cndmask_b32 v4, v4, v5, vcc
    v_lshlrev_b32 v4, 4, v4
    v_mov_b32 v5, 12288
    v_cndmask_b32 v5, 0, v5, vcc
    s_mul_i32 s90, s34, 1536
    v_add3_u32 v7, v4, v5, s90
    v_add_u32 v4, 128, v0
    v_cmp_le_u32 vcc, 96, v4
    v_subrev_u32 v5, 96, v4
    s_nop 0
    v_cndmask_b32 v4, v4, v5, vcc
    v_lshlrev_b32 v4, 4, v4
    v_mov_b32 v5, 12288
    v_cndmask_b32 v5, 0, v5, vcc
    s_mul_i32 s90, s34, 1536
    v_add3_u32 v8, v4, v5, s90
    s_cmp_lt_u32 s93, 64
    s_cselect_b32 s12, s74, s76
    s_cselect_b32 s13, s75, s77
    s_cselect_b32 s91, 1, 0
    s_cmp_lt_u32 s93, 32
    s_cselect_b32 s12, s78, s12
    s_cselect_b32 s13, s79, s13
    s_cselect_b32 s91, 2, s91
    s_and_b32 s13, s13, 0xffff
    s_mov_b32 s14, 7864320
    s_mov_b32 s15, 0x20000
    s_mul_i32 s91, s91, 320
    s_mul_i32 s90, s93, 10
    s_add_u32 s90, s90, s91
    s_sub_u32 s90, s90, 640
    s_mul_i32 s90, s90, 12288
    buffer_load_dwordx4 v[248:251], v6, s[12:15], s90 offen
    buffer_load_dwordx4 v[248:251], v7, s[12:15], s90 offen
    buffer_load_dwordx4 v[248:251], v8, s[12:15], s90 offen
    s_add_u32 s90, s90, 24576
    buffer_load_dwordx4 v[248:251], v6, s[12:15], s90 offen
    buffer_load_dwordx4 v[248:251], v7, s[12:15], s90 offen
    buffer_load_dwordx4 v[248:251], v8, s[12:15], s90 offen
    s_add_u32 s90, s90, 24576
    buffer_load_dwordx4 v[248:251], v6, s[12:15], s90 offen
    buffer_load_dwordx4 v[248:251], v7, s[12:15], s90 offen
    buffer_load_dwordx4 v[248:251], v8, s[12:15], s90 offen
    s_add_u32 s90, s90, 24576
    buffer_load_dwordx4 v[248:251], v6, s[12:15], s90 offen
    buffer_load_dwordx4 v[248:251], v7, s[12:15], s90 offen
    buffer_load_dwordx4 v[248:251], v8, s[12:15], s90 offen
    s_add_u32 s90, s90, 24576
    buffer_load_dwordx4 v[248:251], v6, s[12:15], s90 offen
    buffer_load_dwordx4 v[248:251], v7, s[12:15], s90 offen
    buffer_load_dwordx4 v[248:251], v8, s[12:15], s90 offen
    s_add_u32 s90, s90, 24576
L_rank:
    s_barrier
    ds_read_b32 v2, v3
    s_waitcnt lgkmcnt(0)
    v_readfirstlane_b32 s35, v2
    s_mov_b32 s34, s33
    s_barrier
    s_cmp_ge_u32 s33, 8
    s_cbranch_scc1 L_norole
    s_cmp_ge_u32 s35, 32
    s_cbranch_scc1 L_norole
    s_lshl_b32 s38, s34, 21
    s_add_u32 s38, s38, 8388608
    s_cmp_lt_u32 s35, 12
    s_cbranch_scc1 L_qkv_f
    s_cmp_lt_u32 s35, 18
    s_cbranch_scc1 L_v_f
    s_cmp_lt_u32 s35, 28
    s_cbranch_scc1 L_wo_f
    s_cmp_lt_u32 s35, 29
    s_cbranch_scc1 L_px_f
    s_branch L_pa_f
L_norole:
    v_mov_b32 v1, 192
    v_mov_b32 v2, 2
    s_mov_b64 exec, 1
    buffer_store_dword v2, v1, s[8:11], 0 offen sc1
    s_mov_b64 exec, -1
    s_branch L_slow
L_exit:
    s_endpgm
L_qkv_f:
    s_mov_b32 s12, s74
    s_and_b32 s13, s75, 0xffff
    s_mov_b32 s14, 7864320
    s_mov_b32 s15, 0x20000
    s_mov_b32 s16, s76
    s_and_b32 s17, s77, 0xffff
    s_mov_b32 s18, 7864320
    s_mov_b32 s19, 0x20000
    s_mov_b32 s40, s35
    s_mov_b32 s24, s70
    s_and_b32 s25, s71, 0xffff
    s_mov_b32 s26, 2621440
    s_mov_b32 s27, 0x20000
    v_and_b32 v1, 15, v0
    v_lshrrev_b32 v2, 4, v0
    v_lshrrev_b32 v3, 3, v0
    v_and_b32 v4, 7, v0
    s_lshl_b32 s90, s32, 3
    v_add_u32 v5, s90, v3
    s_and_b32 s91, s32, 1
    s_lshl_b32 s91, s91, 2
    v_and_b32 v6, 2, v3
    v_or_b32 v6, s91, v6
    v_xor_b32 v6, v6, v4
    v_lshlrev_b32 v6, 4, v6
    v_mul_u32_u24 v7, 12288, v5
    s_mul_i32 s92, s34, 1536
    s_lshl_b32 s93, s40, 7
    s_add_u32 s92, s92, s93
    v_add3_u32 v124, v6, v7, s92
    v_lshrrev_b32 v6, 1, v3
    v_or_b32 v6, s91, v6
    v_xor_b32 v6, v6, v4
    v_lshlrev_b32 v6, 4, v6
    v_mul_u32_u24 v7, 1280, v5
    v_add_u32 v10, v6, v7
    s_lshl_b32 s90, s32, 10
    s_add_u32 m0, s90, 81920
    s_mov_b32 s91, 0
    buffer_load_dwordx4 v124, s[12:15], s91 offen nt lds
    s_add_u32 m0, m0, 4096
    s_add_u32 s91, s91, 393216
    buffer_load_dwordx4 v124, s[12:15], s91 offen nt lds
    s_add_u32 m0, m0, 4096
    s_add_u32 s91, s91, 393216
    buffer_load_dwordx4 v124, s[12:15], s91 offen nt lds
    s_add_u32 m0, m0, 4096
    s_add_u32 s91, s91, 393216
    buffer_load_dwordx4 v124, s[12:15], s91 offen nt lds
    s_add_u32 m0, m0, 4096
    s_add_u32 s91, s91, 393216
    buffer_load_dwordx4 v124, s[12:15], s91 offen nt lds
    s_add_u32 m0, m0, 4096
    s_add_u32 s91, s91, 393216
    buffer_load_dwordx4 v124, s[12:15], s91 offen nt lds
    s_add_u32 m0, m0, 4096
    s_add_u32 s91, s91, 393216
    buffer_load_dwordx4 v124, s[12:15], s91 offen nt lds
    s_add_u32 m0, m0, 4096
    s_add_u32 s91, s91, 393216
    buffer_load_dwordx4 v124, s[12:15], s91 offen nt lds
    s_add_u32 m0, m0, 4096
    s_add_u32 s91, s91, 393216
    buffer_load_dwordx4 v124, s[12:15], s91 offen nt lds
    s_add_u32 m0, m0, 4096
    s_add_u32 s91, s91, 393216
    buffer_load_dwordx4 v124, s[12:15], s91 offen nt lds
    s_lshl_b32 s90, s32, 10
    s_add_u32 m0, s90, 40960
    s_mov_b32 s91, 0
    buffer_load_dwordx4 v124, s[16:19], s91 offen nt lds
    s_add_u32 m0, m0, 4096
    s_add_u32 s91, s91, 393216
    buffer_load_dwordx4 v124, s[16:19], s91 offen nt lds
    s_add_u32 m0, m0, 4096
    s_add_u32 s91, s91, 393216
    buffer_load_dwordx4 v124, s[16:19], s91 offen nt lds
    s_add_u32 m0, m0, 4096
    s_add_u32 s91, s91, 393216
    buffer_load_dwordx4 v124, s[16:19], s91 offen nt lds
    s_add_u32 m0, m0, 4096
    s_add_u32 s91, s91, 393216
    buffer_load_dwordx4 v124, s[16:19], s91 offen nt lds
    s_add_u32 m0, m0, 4096
    s_add_u32 s91, s91, 393216
    buffer_load_dwordx4 v124, s[16:19], s91 offen nt lds
    s_add_u32 m0, m0, 4096
    s_add_u32 s91, s91, 393216
    buffer_load_dwordx4 v124, s[16:19], s91 offen nt lds
    s_add_u32 m0, m0, 4096
    s_add_u32 s91, s91, 393216
    buffer_load_dwordx4 v124, s[16:19], s91 offen nt lds
    s_add_u32 m0, m0, 4096
    s_add_u32 s91, s91, 393216
    buffer_load_dwordx4 v124, s[16:19], s91 offen nt lds
    s_add_u32 m0, m0, 4096
    s_add_u32 s91, s91, 393216
    buffer_load_dwordx4 v124, s[16:19], s91 offen nt lds
    s_lshl_b32 s90, s32, 10
    s_add_u32 m0, s90, 122880
    s_mov_b32 s91, 3932160
    buffer_load_dwordx4 v124, s[12:15], s91 offen nt lds
    s_add_u32 m0, m0, 4096
    s_add_u32 s91, s91, 393216
    buffer_load_dwordx4 v124, s[12:15], s91 offen nt lds
    s_add_u32 m0, m0, 4096
    s_add_u32 s91, s91, 393216
    buffer_load_dwordx4 v124, s[12:15], s91 offen nt lds
    s_add_u32 m0, m0, 4096
    s_add_u32 s91, s91, 393216
    buffer_load_dwordx4 v124, s[12:15], s91 offen nt lds
    s_add_u32 m0, m0, 4096
    s_add_u32 s91, s91, 393216
    buffer_load_dwordx4 v124, s[12:15], s91 offen nt lds
    s_add_u32 m0, m0, 4096
    s_add_u32 s91, s91, 393216
    buffer_load_dwordx4 v124, s[12:15], s91 offen nt lds
    s_add_u32 m0, m0, 4096
    s_add_u32 s91, s91, 393216
    buffer_load_dwordx4 v124, s[12:15], s91 offen nt lds
    s_add_u32 m0, m0, 4096
    s_add_u32 s91, s91, 393216
    buffer_load_dwordx4 v124, s[12:15], s91 offen nt lds
    s_add_u32 m0, m0, 4096
    s_add_u32 s91, s91, 393216
    buffer_load_dwordx4 v124, s[12:15], s91 offen nt lds
    s_add_u32 m0, m0, 4096
    s_add_u32 s91, s91, 393216
    buffer_load_dwordx4 v124, s[12:15], s91 offen nt lds
    s_mov_b32 s46, 0
    s_lshl_b32 s90, s32, 10
    s_add_u32 m0, s90, 0
    s_nop 0
    buffer_load_dwordx4 v10, s[24:27], s46 offen offset:0 lds
    s_add_u32 m0, m0, 3968
    s_nop 0
    buffer_load_dwordx4 v10, s[24:27], s46 offen offset:128 lds
    s_add_u32 m0, m0, 3968
    s_nop 0
    buffer_load_dwordx4 v10, s[24:27], s46 offen offset:256 lds
    s_add_u32 m0, m0, 3968
    s_nop 0
    buffer_load_dwordx4 v10, s[24:27], s46 offen offset:384 lds
    s_add_u32 m0, m0, 3968
    s_nop 0
    buffer_load_dwordx4 v10, s[24:27], s46 offen offset:512 lds
    s_add_u32 m0, m0, 3968
    s_nop 0
    buffer_load_dwordx4 v10, s[24:27], s46 offen offset:640 lds
    s_add_u32 m0, m0, 3968
    s_nop 0
    buffer_load_dwordx4 v10, s[24:27], s46 offen offset:768 lds
    s_add_u32 m0, m0, 3968
    s_nop 0
    buffer_load_dwordx4 v10, s[24:27], s46 offen offset:896 lds
    s_add_u32 m0, m0, 3968
    s_nop 0
    buffer_load_dwordx4 v10, s[24:27], s46 offen offset:1024 lds
    s_add_u32 m0, m0, 3968
    s_nop 0
    buffer_load_dwordx4 v10, s[24:27], s46 offen offset:1152 lds
    s_mul_i32 s60, s40, 86
    s_lshr_b32 s60, s60, 8
    s_mul_i32 s61, s60, 3
    s_sub_u32 s61, s40, s61
    s_add_u32 s90, s40, 1
    s_mul_i32 s62, s90, 86
    s_lshr_b32 s62, s62, 8
    s_mul_i32 s63, s62, 3
    s_sub_u32 s63, s90, s63
    v_lshrrev_b32 v3, 1, v2
    v_and_b32 v5, 1, v2
    s_lshl_b32 s90, s32, 9
    v_lshlrev_b32 v6, 4, v1
    v_lshl_add_u32 v6, v3, 8, v6
    v_add_u32 v6, s90, v6
    s_mul_i32 s90, s60, 12288
    s_lshl_b32 s91, s61, 11
    s_add_u32 s90, s90, s91
    v_mul_u32_u24 v7, 6144, v5
    v_add3_u32 v19, v6, v7, s90
    v_mov_b32 v22, -1
    s_mov_b32 s56, 49152
    v_lshl_add_u32 v137, v5, 11, v6
    v_add_u32 v137, 135168, v137
    s_mul_i32 s90, s40, 1280
    s_add_u32 s90, s90, 10240
    v_lshlrev_b32 v6, 1, v5
    v_or_b32 v7, v6, v3
    v_lshl_add_u32 v7, v7, 4, v1
    v_lshlrev_b32 v7, 2, v7
    v_add_u32 v7, 1024, v7
    v_or_b32 v6, v6, v1
    v_lshl_add_u32 v6, v3, 4, v6
    v_lshlrev_b32 v6, 4, v6
    s_sub_u32 s91, s32, 1
    s_lshl_b32 s91, s91, 9
    v_add_u32 v6, s91, v6
    s_cmp_eq_u32 s32, 0
    s_cselect_b64 vcc, -1, 0
    v_cndmask_b32 v6, v6, v7, vcc
    v_add_u32 v135, s90, v6
    s_lshl_b32 s91, s32, 8
    s_add_u32 s91, s91, s90
    v_lshl_add_u32 v150, v0, 2, s91
    v_and_b32 v4, 2, v1
    v_cmp_eq_u32 vcc, 0, v4
    v_mov_b32 v9, 2146435072
    s_nop 0
    v_cndmask_b32 v135, v9, v135, vcc
    s_lshl_b32 s90, s40, 10
    v_lshrrev_b32 v3, 2, v1
    v_lshlrev_b32 v3, 1, v3
    v_and_b32 v6, 1, v1
    v_or_b32 v3, v3, v6
    v_lshl_add_u32 v3, v2, 3, v3
    v_lshl_add_u32 v136, v3, 4, s90
    v_cmp_ne_u32 vcc, 0, v4
    v_mov_b32 v9, 2146435072
    s_nop 0
    v_cndmask_b32 v136, v9, v136, vcc
    v_and_b32 v6, 9, v1
    v_lshl_or_b32 v6, v4, 1, v6
    v_and_b32 v7, 4, v1
    v_lshrrev_b32 v7, 1, v7
    v_or_b32 v6, v6, v7
    v_lshlrev_b32 v6, 4, v6
    v_lshl_add_u32 v6, v2, 8, v6
    s_cmp_eq_u32 s32, 2
    s_cselect_b32 s90, 2048, 0
    s_add_u32 s90, s90, 135168
    v_add_u32 v138, s90, v6
    s_lshl_b32 s90, s60, 7
    s_lshl_b32 s91, s61, 2
    s_add_u32 s91, s91, s90
    s_add_u32 s91, s91, 459264
    s_cmp_eq_u32 s32, 3
    s_cselect_b32 s91, s91, 2146435072
    s_cselect_b32 s55, -1, 0
    v_mov_b32 v139, s91
    v_cmp_eq_u32 vcc, 0, v0
    v_mov_b32 v9, 2146435072
    s_nop 0
    v_cndmask_b32 v139, v9, v139, vcc
    v_add_u32 v21, 3072, v139
    s_mul_i32 s90, s35, 32768
    s_lshl_b32 s91, s32, 11
    s_add_u32 s90, s90, s91
    s_lshl_b32 s92, s35, 10
    s_lshl_b32 s91, s32, 8
    s_add_u32 s92, s92, s91
    s_cmp_lt_u32 s35, 10
    s_cselect_b32 s90, s90, 2146435072
    s_cselect_b32 s92, s92, 2146435072
    s_lshl_b32 s91, s34, 8
    v_lshlrev_b32 v3, 4, v0
    v_xor_b32 v3, s91, v3
    v_add_u32 v142, s90, v3
    v_xor_b32 v3, 1024, v3
    v_add_u32 v143, s90, v3
    s_min_u32 s90, s35, 9
    s_lshl_b32 s90, s90, 7
    s_add_u32 s90, s90, 460800
    s_add_u32 s90, s90, s38
    v_and_b32 v3, 3, v0
    v_lshl_add_u32 v146, v3, 2, s90
    v_lshl_add_u32 v149, v0, 2, s92
    v_lshl_add_u32 v148, v1, 4, s92
    v_cmp_eq_u32 vcc, 0, v2
    v_mov_b32 v9, 2146435072
    s_nop 0
    v_cndmask_b32 v148, v9, v148, vcc
    v_and_b32 v7, 1, v1
    v_cmp_ne_u32 vcc, 0, v7
    v_mov_b32 v5, 0x3f80
    v_mov_b32 v6, 0x3f800000
    v_cndmask_b32 v5, v5, v6, vcc
    v_bfe_u32 v6, v1, 1, 1
    v_cmp_eq_u32 vcc, 0, v6
    s_nop 1
    v_cndmask_b32 v198, 0, v5, vcc
    v_mov_b32 v196, 0
    v_mov_b32 v200, 0
    v_cmp_eq_u32 vcc, 1, v6
    s_nop 1
    v_cndmask_b32 v199, 0, v5, vcc
    v_mov_b32 v197, 0
    v_mov_b32 v201, 0
    v_lshrrev_b32 v3, 2, v1
    v_and_b32 v4, 3, v1
    v_and_b32 v5, 1, v2
    v_lshl_add_u32 v6, v2, 3, v3
    v_lshlrev_b32 v6, 7, v6
    v_and_b32 v7, 2, v3
    v_lshl_or_b32 v7, v5, 2, v7
    v_lshrrev_b32 v8, 1, v4
    s_lshl_b32 s90, s32, 1
    v_or_b32 v8, s90, v8
    v_xor_b32 v7, v7, v8
    v_lshl_add_u32 v6, v7, 4, v6
    v_and_b32 v7, 1, v4
    v_lshl_add_u32 v6, v7, 3, v6
    v_add_u32 v125, 81920, v6
    v_add_u32 v126, 40960, v6
    v_add_u32 v127, 122880, v6
    s_lshl_b32 s90, s32, 9
    s_add_u32 s90, s90, 133120
    v_xor_b32 v6, 0, v5
    v_lshl_add_u32 v6, v6, 2, v3
    v_lshl_add_u32 v6, v2, 3, v6
    v_lshlrev_b32 v6, 5, v6
    v_lshl_or_b32 v7, v5, 1, 0
    v_xor_b32 v7, v7, v4
    v_lshl_add_u32 v6, v7, 3, v6
    v_add_u32 v24, 133120, v6
    v_xor_b32 v6, 1, v5
    v_lshl_add_u32 v6, v6, 2, v3
    v_lshl_add_u32 v6, v2, 3, v6
    v_lshlrev_b32 v6, 5, v6
    v_lshl_or_b32 v7, v5, 1, 1
    v_xor_b32 v7, v7, v4
    v_lshl_add_u32 v6, v7, 3, v6
    v_add_u32 v134, 133120, v6
    v_lshrrev_b32 v6, 3, v1
    v_lshlrev_b32 v6, 2, v6
    v_xor_b32 v6, v6, v1
    v_lshlrev_b32 v6, 5, v6
    v_xor_b32 v7, v2, v3
    v_lshl_add_u32 v6, v7, 3, v6
    v_add_u32 v23, s90, v6
    v_and_b32 v7, 2, v1
    v_cmp_ne_u32 vcc, 0, v7
    v_mov_b32 v6, 0x4444
    v_mov_b32 v8, 0xeeee
    v_cndmask_b32 v17, v6, v8, vcc
    v_lshlrev_b32 v6, 4, v0
    v_add_u32 v16, 122880, v6
    s_mul_i32 s90, s32, 2560
    v_lshl_add_u32 v13, v0, 4, s90
    v_lshl_add_u32 v14, v0, 2, s90
    s_add_u32 s48, s90, 122880
    v_mul_u32_u24 v6, 40, v0
    v_add_u32 v15, s48, v6
    v_mul_u32_u24 v6, 164, v0
    v_min_u32 v6, 10236, v6
    v_add_u32 v25, 122880, v6
    v_lshrrev_b32 v6, 3, v1
    v_lshlrev_b32 v6, 10, v6
    v_and_b32 v7, 7, v1
    v_lshl_add_u32 v6, v7, 7, v6
    v_lshrrev_b32 v7, 1, v1
    v_xor_b32 v7, v7, v2
    v_lshl_add_u32 v11, v7, 4, v6
    v_xor_b32 v12, 64, v11
    s_waitcnt vmcnt(30)
    s_barrier
    ds_read_b64_tr_b16 a[0:1], v125 offset:0
    ds_read_b64_tr_b16 a[2:3], v125 offset:512
    ds_read_b64_tr_b16 a[4:5], v125 offset:4096
    ds_read_b64_tr_b16 a[6:7], v125 offset:4608
    ds_read_b64_tr_b16 a[8:9], v125 offset:8192
    ds_read_b64_tr_b16 a[10:11], v125 offset:8704
    ds_read_b64_tr_b16 a[12:13], v125 offset:12288
    ds_read_b64_tr_b16 a[14:15], v125 offset:12800
    ds_read_b64_tr_b16 a[16:17], v125 offset:16384
    ds_read_b64_tr_b16 a[18:19], v125 offset:16896
    ds_read_b64_tr_b16 a[20:21], v125 offset:20480
    ds_read_b64_tr_b16 a[22:23], v125 offset:20992
    ds_read_b64_tr_b16 a[24:25], v125 offset:24576
    ds_read_b64_tr_b16 a[26:27], v125 offset:25088
    ds_read_b64_tr_b16 a[28:29], v125 offset:28672
    ds_read_b64_tr_b16 a[30:31], v125 offset:29184
    ds_read_b64_tr_b16 a[32:33], v125 offset:32768
    ds_read_b64_tr_b16 a[34:35], v125 offset:33280
    ds_read_b64_tr_b16 a[36:37], v125 offset:36864
    ds_read_b64_tr_b16 a[38:39], v125 offset:37376
    s_waitcnt lgkmcnt(0)
    s_barrier
    s_lshl_b32 s90, s32, 10
    s_add_u32 m0, s90, 81920
    s_mov_b32 s91, 3932160
    buffer_load_dwordx4 v124, s[16:19], s91 offen nt lds
    s_add_u32 m0, m0, 4096
    s_add_u32 s91, s91, 393216
    buffer_load_dwordx4 v124, s[16:19], s91 offen nt lds
    s_add_u32 m0, m0, 4096
    s_add_u32 s91, s91, 393216
    buffer_load_dwordx4 v124, s[16:19], s91 offen nt lds
    s_add_u32 m0, m0, 4096
    s_add_u32 s91, s91, 393216
    buffer_load_dwordx4 v124, s[16:19], s91 offen nt lds
    s_add_u32 m0, m0, 4096
    s_add_u32 s91, s91, 393216
    buffer_load_dwordx4 v124, s[16:19], s91 offen nt lds
    s_add_u32 m0, m0, 4096
    s_add_u32 s91, s91, 393216
    buffer_load_dwordx4 v124, s[16:19], s91 offen nt lds
    s_add_u32 m0, m0, 4096
    s_add_u32 s91, s91, 393216
    buffer_load_dwordx4 v124, s[16:19], s91 offen nt lds
    s_add_u32 m0, m0, 4096
    s_add_u32 s91, s91, 393216
    buffer_load_dwordx4 v124, s[16:19], s91 offen nt lds
    s_add_u32 m0, m0, 4096
    s_add_u32 s91, s91, 393216
    buffer_load_dwordx4 v124, s[16:19], s91 offen nt lds
    s_add_u32 m0, m0, 4096
    s_add_u32 s91, s91, 393216
    buffer_load_dwordx4 v124, s[16:19], s91 offen nt lds
    s_waitcnt vmcnt(30)
    s_barrier
    ds_read_b64_tr_b16 a[80:81], v126 offset:0
    ds_read_b64_tr_b16 a[82:83], v126 offset:512
    ds_read_b64_tr_b16 a[84:85], v126 offset:4096
    ds_read_b64_tr_b16 a[86:87], v126 offset:4608
    ds_read_b64_tr_b16 a[88:89], v126 offset:8192
    ds_read_b64_tr_b16 a[90:91], v126 offset:8704
    ds_read_b64_tr_b16 a[92:93], v126 offset:12288
    ds_read_b64_tr_b16 a[94:95], v126 offset:12800
    ds_read_b64_tr_b16 a[96:97], v126 offset:16384
    ds_read_b64_tr_b16 a[98:99], v126 offset:16896
    ds_read_b64_tr_b16 a[100:101], v126 offset:20480
    ds_read_b64_tr_b16 a[102:103], v126 offset:20992
    ds_read_b64_tr_b16 a[104:105], v126 offset:24576
    ds_read_b64_tr_b16 a[106:107], v126 offset:25088
    ds_read_b64_tr_b16 a[108:109], v126 offset:28672
    ds_read_b64_tr_b16 a[110:111], v126 offset:29184
    ds_read_b64_tr_b16 a[112:113], v126 offset:32768
    ds_read_b64_tr_b16 a[114:115], v126 offset:33280
    ds_read_b64_tr_b16 a[116:117], v126 offset:36864
    ds_read_b64_tr_b16 a[118:119], v126 offset:37376
    s_waitcnt lgkmcnt(0)
    s_barrier
    s_mov_b32 s46, 40960
    s_lshl_b32 s90, s32, 10
    s_add_u32 m0, s90, 40960
    s_nop 0
    buffer_load_dwordx4 v10, s[24:27], s46 offen offset:0 lds
    s_add_u32 m0, m0, 3968
    s_nop 0
    buffer_load_dwordx4 v10, s[24:27], s46 offen offset:128 lds
    s_add_u32 m0, m0, 3968
    s_nop 0
    buffer_load_dwordx4 v10, s[24:27], s46 offen offset:256 lds
    s_add_u32 m0, m0, 3968
    s_nop 0
    buffer_load_dwordx4 v10, s[24:27], s46 offen offset:384 lds
    s_add_u32 m0, m0, 3968
    s_nop 0
    buffer_load_dwordx4 v10, s[24:27], s46 offen offset:512 lds
    s_add_u32 m0, m0, 3968
    s_nop 0
    buffer_load_dwordx4 v10, s[24:27], s46 offen offset:640 lds
    s_add_u32 m0, m0, 3968
    s_nop 0
    buffer_load_dwordx4 v10, s[24:27], s46 offen offset:768 lds
    s_add_u32 m0, m0, 3968
    s_nop 0
    buffer_load_dwordx4 v10, s[24:27], s46 offen offset:896 lds
    s_add_u32 m0, m0, 3968
    s_nop 0
    buffer_load_dwordx4 v10, s[24:27], s46 offen offset:1024 lds
    s_add_u32 m0, m0, 3968
    s_nop 0
    buffer_load_dwordx4 v10, s[24:27], s46 offen offset:1152 lds
    s_waitcnt vmcnt(30)
    s_barrier
    ds_read_b64_tr_b16 a[40:41], v127 offset:0
    ds_read_b64_tr_b16 a[42:43], v127 offset:512
    ds_read_b64_tr_b16 a[44:45], v127 offset:4096
    ds_read_b64_tr_b16 a[46:47], v127 offset:4608
    ds_read_b64_tr_b16 a[48:49], v127 offset:8192
    ds_read_b64_tr_b16 a[50:51], v127 offset:8704
    ds_read_b64_tr_b16 a[52:53], v127 offset:12288
    ds_read_b64_tr_b16 a[54:55], v127 offset:12800
    ds_read_b64_tr_b16 a[56:57], v127 offset:16384
    ds_read_b64_tr_b16 a[58:59], v127 offset:16896
    ds_read_b64_tr_b16 a[60:61], v127 offset:20480
    ds_read_b64_tr_b16 a[62:63], v127 offset:20992
    ds_read_b64_tr_b16 a[64:65], v127 offset:24576
    ds_read_b64_tr_b16 a[66:67], v127 offset:25088
    ds_read_b64_tr_b16 a[68:69], v127 offset:28672
    ds_read_b64_tr_b16 a[70:71], v127 offset:29184
    ds_read_b64_tr_b16 a[72:73], v127 offset:32768
    ds_read_b64_tr_b16 a[74:75], v127 offset:33280
    ds_read_b64_tr_b16 a[76:77], v127 offset:36864
    ds_read_b64_tr_b16 a[78:79], v127 offset:37376
    s_waitcnt lgkmcnt(0)
    s_waitcnt vmcnt(10)
    s_barrier
    ds_read_b64_tr_b16 a[120:121], v125 offset:0
    ds_read_b64_tr_b16 a[122:123], v125 offset:512
    ds_read_b64_tr_b16 a[124:125], v125 offset:4096
    ds_read_b64_tr_b16 a[126:127], v125 offset:4608
    ds_read_b64_tr_b16 a[128:129], v125 offset:8192
    ds_read_b64_tr_b16 a[130:131], v125 offset:8704
    ds_read_b64_tr_b16 a[132:133], v125 offset:12288
    ds_read_b64_tr_b16 a[134:135], v125 offset:12800
    ds_read_b64_tr_b16 a[136:137], v125 offset:16384
    ds_read_b64_tr_b16 a[138:139], v125 offset:16896
    ds_read_b64_tr_b16 a[140:141], v125 offset:20480
    ds_read_b64_tr_b16 a[142:143], v125 offset:20992
    ds_read_b64_tr_b16 a[144:145], v125 offset:24576
    ds_read_b64_tr_b16 a[146:147], v125 offset:25088
    ds_read_b64_tr_b16 a[148:149], v125 offset:28672
    ds_read_b64_tr_b16 a[150:151], v125 offset:29184
    ds_read_b64_tr_b16 a[152:153], v125 offset:32768
    ds_read_b64_tr_b16 a[154:155], v125 offset:33280
    ds_read_b64_tr_b16 a[156:157], v125 offset:36864
    ds_read_b64_tr_b16 a[158:159], v125 offset:37376
    s_waitcnt lgkmcnt(0)
    s_mov_b32 s49, 40960
    s_mov_b32 s47, 40960
    s_mov_b32 s37, -1
    s_add_u32 s44, s38, 475136
    s_add_u32 s45, s44, s56
    s_mov_b32 s46, 40960
    v_add_u32 v140, 0, v137
    ds_read_b128 v[84:87], v11 offset:0
    ds_read_b128 v[88:91], v11 offset:2048
    ds_read_b128 v[92:95], v12 offset:0
    ds_read_b128 v[96:99], v12 offset:2048
    s_waitcnt lgkmcnt(2)
    v_mfma_f32_16x16x32_bf16 v[108:111], a[0:3], v[84:87], 0
    ds_read_b128 v[100:103], v11 offset:4096
    v_mfma_f32_16x16x32_bf16 v[112:115], a[0:3], v[88:91], 0
    ds_read_b128 v[104:107], v11 offset:6144
    v_mfma_f32_16x16x32_bf16 v[116:119], a[80:83], v[84:87], 0
    v_mfma_f32_16x16x32_bf16 v[120:123], a[80:83], v[88:91], 0
    s_waitcnt lgkmcnt(2)
    v_mfma_f32_16x16x32_bf16 v[108:111], a[4:7], v[92:95], v[108:111]
    ds_read_b128 v[84:87], v12 offset:4096
    v_mfma_f32_16x16x32_bf16 v[112:115], a[4:7], v[96:99], v[112:115]
    ds_read_b128 v[88:91], v12 offset:6144
    v_mfma_f32_16x16x32_bf16 v[116:119], a[84:87], v[92:95], v[116:119]
    v_mfma_f32_16x16x32_bf16 v[120:123], a[84:87], v[96:99], v[120:123]
    s_waitcnt lgkmcnt(2)
    v_mfma_f32_16x16x32_bf16 v[108:111], a[8:11], v[100:103], v[108:111]
    ds_read_b128 v[92:95], v11 offset:8192
    v_mfma_f32_16x16x32_bf16 v[112:115], a[8:11], v[104:107], v[112:115]
    ds_read_b128 v[96:99], v11 offset:10240
    v_mfma_f32_16x16x32_bf16 v[116:119], a[88:91], v[100:103], v[116:119]
    v_mfma_f32_16x16x32_bf16 v[120:123], a[88:91], v[104:107], v[120:123]
    s_waitcnt lgkmcnt(2)
    v_mfma_f32_16x16x32_bf16 v[108:111], a[12:15], v[84:87], v[108:111]
    ds_read_b128 v[100:103], v12 offset:8192
    v_mfma_f32_16x16x32_bf16 v[112:115], a[12:15], v[88:91], v[112:115]
    ds_read_b128 v[104:107], v12 offset:10240
    v_mfma_f32_16x16x32_bf16 v[116:119], a[92:95], v[84:87], v[116:119]
    v_mfma_f32_16x16x32_bf16 v[120:123], a[92:95], v[88:91], v[120:123]
    s_waitcnt lgkmcnt(2)
    v_mfma_f32_16x16x32_bf16 v[108:111], a[16:19], v[92:95], v[108:111]
    ds_read_b128 v[84:87], v11 offset:12288
    v_mfma_f32_16x16x32_bf16 v[112:115], a[16:19], v[96:99], v[112:115]
    ds_read_b128 v[88:91], v11 offset:14336
    v_mfma_f32_16x16x32_bf16 v[116:119], a[96:99], v[92:95], v[116:119]
    v_mfma_f32_16x16x32_bf16 v[120:123], a[96:99], v[96:99], v[120:123]
    s_waitcnt lgkmcnt(2)
    v_mfma_f32_16x16x32_bf16 v[108:111], a[20:23], v[100:103], v[108:111]
    ds_read_b128 v[92:95], v12 offset:12288
    v_mfma_f32_16x16x32_bf16 v[112:115], a[20:23], v[104:107], v[112:115]
    ds_read_b128 v[96:99], v12 offset:14336
    v_mfma_f32_16x16x32_bf16 v[116:119], a[100:103], v[100:103], v[116:119]
    v_mfma_f32_16x16x32_bf16 v[120:123], a[100:103], v[104:107], v[120:123]
    s_waitcnt lgkmcnt(2)
    v_mfma_f32_16x16x32_bf16 v[108:111], a[24:27], v[84:87], v[108:111]
    ds_read_b128 v[100:103], v11 offset:16384
    v_mfma_f32_16x16x32_bf16 v[112:115], a[24:27], v[88:91], v[112:115]
    ds_read_b128 v[104:107], v11 offset:18432
    v_mfma_f32_16x16x32_bf16 v[116:119], a[104:107], v[84:87], v[116:119]
    v_mfma_f32_16x16x32_bf16 v[120:123], a[104:107], v[88:91], v[120:123]
    s_waitcnt lgkmcnt(2)
    v_mfma_f32_16x16x32_bf16 v[108:111], a[28:31], v[92:95], v[108:111]
    ds_read_b128 v[84:87], v12 offset:16384
    v_mfma_f32_16x16x32_bf16 v[112:115], a[28:31], v[96:99], v[112:115]
    ds_read_b128 v[88:91], v12 offset:18432
    v_mfma_f32_16x16x32_bf16 v[116:119], a[108:111], v[92:95], v[116:119]
    v_mfma_f32_16x16x32_bf16 v[120:123], a[108:111], v[96:99], v[120:123]
    s_waitcnt lgkmcnt(2)
    v_mfma_f32_16x16x32_bf16 v[108:111], a[32:35], v[100:103], v[108:111]
    ds_read_b128 v[92:95], v11 offset:20480
    v_mfma_f32_16x16x32_bf16 v[112:115], a[32:35], v[104:107], v[112:115]
    ds_read_b128 v[96:99], v11 offset:22528
    v_mfma_f32_16x16x32_bf16 v[116:119], a[112:115], v[100:103], v[116:119]
    v_mfma_f32_16x16x32_bf16 v[120:123], a[112:115], v[104:107], v[120:123]
    s_waitcnt lgkmcnt(2)
    v_mfma_f32_16x16x32_bf16 v[108:111], a[36:39], v[84:87], v[108:111]
    ds_read_b128 v[100:103], v12 offset:20480
    v_mfma_f32_16x16x32_bf16 v[112:115], a[36:39], v[88:91], v[112:115]
    ds_read_b128 v[104:107], v12 offset:22528
    v_mfma_f32_16x16x32_bf16 v[116:119], a[116:119], v[84:87], v[116:119]
    v_mfma_f32_16x16x32_bf16 v[120:123], a[116:119], v[88:91], v[120:123]
    s_waitcnt lgkmcnt(2)
    v_mfma_f32_16x16x32_bf16 v[108:111], a[40:43], v[92:95], v[108:111]
    ds_read_b128 v[84:87], v11 offset:24576
    v_mfma_f32_16x16x32_bf16 v[112:115], a[40:43], v[96:99], v[112:115]
    ds_read_b128 v[88:91], v11 offset:26624
    v_mfma_f32_16x16x32_bf16 v[116:119], a[120:123], v[92:95], v[116:119]
    v_mfma_f32_16x16x32_bf16 v[120:123], a[120:123], v[96:99], v[120:123]
    s_waitcnt lgkmcnt(2)
    v_mfma_f32_16x16x32_bf16 v[108:111], a[44:47], v[100:103], v[108:111]
    ds_read_b128 v[92:95], v12 offset:24576
    v_mfma_f32_16x16x32_bf16 v[112:115], a[44:47], v[104:107], v[112:115]
    ds_read_b128 v[96:99], v12 offset:26624
    v_mfma_f32_16x16x32_bf16 v[116:119], a[124:127], v[100:103], v[116:119]
    v_mfma_f32_16x16x32_bf16 v[120:123], a[124:127], v[104:107], v[120:123]
    s_waitcnt lgkmcnt(2)
    v_mfma_f32_16x16x32_bf16 v[108:111], a[48:51], v[84:87], v[108:111]
    ds_read_b128 v[100:103], v11 offset:28672
    v_mfma_f32_16x16x32_bf16 v[112:115], a[48:51], v[88:91], v[112:115]
    ds_read_b128 v[104:107], v11 offset:30720
    v_mfma_f32_16x16x32_bf16 v[116:119], a[128:131], v[84:87], v[116:119]
    v_mfma_f32_16x16x32_bf16 v[120:123], a[128:131], v[88:91], v[120:123]
    s_waitcnt lgkmcnt(2)
    v_mfma_f32_16x16x32_bf16 v[108:111], a[52:55], v[92:95], v[108:111]
    ds_read_b128 v[84:87], v12 offset:28672
    v_mfma_f32_16x16x32_bf16 v[112:115], a[52:55], v[96:99], v[112:115]
    ds_read_b128 v[88:91], v12 offset:30720
    v_mfma_f32_16x16x32_bf16 v[116:119], a[132:135], v[92:95], v[116:119]
    v_mfma_f32_16x16x32_bf16 v[120:123], a[132:135], v[96:99], v[120:123]
    s_waitcnt lgkmcnt(2)
    v_mfma_f32_16x16x32_bf16 v[108:111], a[56:59], v[100:103], v[108:111]
    ds_read_b128 v[92:95], v11 offset:32768
    v_mfma_f32_16x16x32_bf16 v[112:115], a[56:59], v[104:107], v[112:115]
    ds_read_b128 v[96:99], v11 offset:34816
    v_mfma_f32_16x16x32_bf16 v[116:119], a[136:139], v[100:103], v[116:119]
    v_mfma_f32_16x16x32_bf16 v[120:123], a[136:139], v[104:107], v[120:123]
    s_waitcnt lgkmcnt(2)
    v_mfma_f32_16x16x32_bf16 v[108:111], a[60:63], v[84:87], v[108:111]
    ds_read_b128 v[100:103], v12 offset:32768
    v_mfma_f32_16x16x32_bf16 v[112:115], a[60:63], v[88:91], v[112:115]
    ds_read_b128 v[104:107], v12 offset:34816
    v_mfma_f32_16x16x32_bf16 v[116:119], a[140:143], v[84:87], v[116:119]
    v_mfma_f32_16x16x32_bf16 v[120:123], a[140:143], v[88:91], v[120:123]
    s_waitcnt lgkmcnt(2)
    v_mfma_f32_16x16x32_bf16 v[108:111], a[64:67], v[92:95], v[108:111]
    ds_read_b128 v[84:87], v11 offset:36864
    v_mfma_f32_16x16x32_bf16 v[112:115], a[64:67], v[96:99], v[112:115]
    ds_read_b128 v[88:91], v11 offset:38912
    v_mfma_f32_16x16x32_bf16 v[116:119], a[144:147], v[92:95], v[116:119]
    v_mfma_f32_16x16x32_bf16 v[120:123], a[144:147], v[96:99], v[120:123]
    s_waitcnt lgkmcnt(2)
    v_mfma_f32_16x16x32_bf16 v[108:111], a[68:71], v[100:103], v[108:111]
    ds_read_b128 v[92:95], v12 offset:36864
    v_mfma_f32_16x16x32_bf16 v[112:115], a[68:71], v[104:107], v[112:115]
    ds_read_b128 v[96:99], v12 offset:38912
    v_mfma_f32_16x16x32_bf16 v[116:119], a[148:151], v[100:103], v[116:119]
    v_mfma_f32_16x16x32_bf16 v[120:123], a[148:151], v[104:107], v[120:123]
    s_waitcnt lgkmcnt(0)
    v_mfma_f32_16x16x32_bf16 v[108:111], a[72:75], v[84:87], v[108:111]
    v_add_u32 v11, s49, v11
    v_mfma_f32_16x16x32_bf16 v[112:115], a[72:75], v[88:91], v[112:115]
    v_add_u32 v12, s49, v12
    v_mfma_f32_16x16x32_bf16 v[108:111], a[76:79], v[92:95], v[108:111]
    s_sub_u32 s47, s47, s49
    v_mfma_f32_16x16x32_bf16 v[112:115], a[76:79], v[96:99], v[112:115]
    s_sub_u32 s49, 0, s49
    v_mfma_f32_16x16x32_bf16 v[116:119], a[152:155], v[84:87], v[116:119]
    v_mfma_f32_16x16x32_bf16 v[120:123], a[152:155], v[88:91], v[120:123]
    v_mfma_f32_16x16x32_bf16 v[116:119], a[156:159], v[92:95], v[116:119]
    v_mfma_f32_16x16x32_bf16 v[120:123], a[156:159], v[96:99], v[120:123]
    v_cvt_pk_bf16_f32 v124, v108, v109
    v_cvt_pk_bf16_f32 v125, v110, v111
    v_cvt_pk_bf16_f32 v126, v112, v113
    v_cvt_pk_bf16_f32 v127, v114, v115
    s_nop 0
    v_permlane16_swap_b32 v124, v126
    v_permlane16_swap_b32 v125, v127
    v_cvt_pk_bf16_f32 v128, v116, v117
    v_cvt_pk_bf16_f32 v129, v118, v119
    v_cvt_pk_bf16_f32 v130, v120, v121
    v_cvt_pk_bf16_f32 v131, v122, v123
    s_nop 0
    v_permlane16_swap_b32 v128, v130
    v_permlane16_swap_b32 v129, v131
    ds_write_b128 v140, v[128:131]
    buffer_store_dwordx4 v[124:127], v19, s[4:7], s44 offen
    buffer_store_dwordx4 v[128:131], v19, s[4:7], s45 offen
    v_mov_b32 v1, 192
L_gw_1:
    buffer_load_dword v2, v1, s[8:11], 0 offen sc1
    s_sub_u32 s36, s36, 1
    s_cbranch_scc1 L_exit
    s_waitcnt vmcnt(0)
    v_readfirstlane_b32 s90, v2
    s_nop 0
    s_cmp_eq_u32 s90, 0
    s_cbranch_scc1 L_gw_1
    s_cmp_lg_u32 s90, 1
    s_cbranch_scc1 L_slow
    s_waitcnt vmcnt(0) lgkmcnt(0)
    s_barrier
    s_add_u32 s44, s38, 573440
    s_add_u32 s45, s44, s56
    s_mov_b32 s46, 81920
    v_add_u32 v140, 4096, v137
    ds_read_b128 v[84:87], v11 offset:0
    ds_read_b128 v[88:91], v11 offset:2048
    ds_read_b128 v[92:95], v12 offset:0
    ds_read_b128 v[96:99], v12 offset:2048
    s_lshl_b32 s90, s32, 10
    s_add_u32 m0, s90, s47
    s_waitcnt lgkmcnt(2)
    v_mfma_f32_16x16x32_bf16 v[108:111], a[0:3], v[84:87], 0
    ds_read_b128 v[100:103], v11 offset:4096
    s_and_b32 s50, s37, 3
    v_mfma_f32_16x16x32_bf16 v[112:115], a[0:3], v[88:91], 0
    ds_read_b128 v[104:107], v11 offset:6144
    s_mul_i32 s53, s50, 327680
    v_mfma_f32_16x16x32_bf16 v[116:119], a[80:83], v[84:87], 0
    buffer_load_dwordx4 v10, s[24:27], s46 offen offset:0 lds
    s_add_u32 m0, m0, 3968
    v_mfma_f32_16x16x32_bf16 v[120:123], a[80:83], v[88:91], 0
    s_waitcnt lgkmcnt(2)
    s_add_u32 s51, s37, 2
    v_mfma_f32_16x16x32_bf16 v[108:111], a[4:7], v[92:95], v[108:111]
    ds_read_b128 v[84:87], v12 offset:4096
    s_and_b32 s50, s51, 3
    v_mfma_f32_16x16x32_bf16 v[112:115], a[4:7], v[96:99], v[112:115]
    ds_read_b128 v[88:91], v12 offset:6144
    s_mul_i32 s50, s50, 98304
    v_mfma_f32_16x16x32_bf16 v[116:119], a[84:87], v[92:95], v[116:119]
    buffer_load_dwordx4 v10, s[24:27], s46 offen offset:128 lds
    s_add_u32 m0, m0, 3968
    v_mfma_f32_16x16x32_bf16 v[120:123], a[84:87], v[96:99], v[120:123]
    s_waitcnt lgkmcnt(2)
    s_add_u32 s50, s50, 475136
    v_mfma_f32_16x16x32_bf16 v[108:111], a[8:11], v[100:103], v[108:111]
    ds_read_b128 v[92:95], v11 offset:8192
    s_add_u32 s44, s38, s50
    v_mfma_f32_16x16x32_bf16 v[112:115], a[8:11], v[104:107], v[112:115]
    ds_read_b128 v[96:99], v11 offset:10240
    s_add_u32 s45, s44, s56
    v_mfma_f32_16x16x32_bf16 v[116:119], a[88:91], v[100:103], v[116:119]
    buffer_load_dwordx4 v10, s[24:27], s46 offen offset:256 lds
    s_add_u32 m0, m0, 3968
    v_mfma_f32_16x16x32_bf16 v[120:123], a[88:91], v[104:107], v[120:123]
    s_waitcnt lgkmcnt(2)
    s_and_b32 s50, s51, 3
    v_mfma_f32_16x16x32_bf16 v[108:111], a[12:15], v[84:87], v[108:111]
    ds_read_b128 v[100:103], v12 offset:8192
    s_lshl_b32 s50, s50, 12
    v_mfma_f32_16x16x32_bf16 v[112:115], a[12:15], v[88:91], v[112:115]
    ds_read_b128 v[104:107], v12 offset:10240
    v_add_u32 v140, s50, v137
    v_mfma_f32_16x16x32_bf16 v[116:119], a[92:95], v[84:87], v[116:119]
    buffer_load_dwordx4 v10, s[24:27], s46 offen offset:384 lds
    s_add_u32 m0, m0, 3968
    v_mfma_f32_16x16x32_bf16 v[120:123], a[92:95], v[88:91], v[120:123]
    s_waitcnt lgkmcnt(2)
    s_add_u32 s37, s37, 1
    v_mfma_f32_16x16x32_bf16 v[108:111], a[16:19], v[92:95], v[108:111]
    ds_read_b128 v[84:87], v11 offset:12288
    s_mov_b32 s52, 0
    v_mfma_f32_16x16x32_bf16 v[112:115], a[16:19], v[96:99], v[112:115]
    ds_read_b128 v[88:91], v11 offset:14336
    s_and_b32 s50, s37, 3
    v_mfma_f32_16x16x32_bf16 v[116:119], a[96:99], v[92:95], v[116:119]
    buffer_load_dwordx4 v10, s[24:27], s46 offen offset:512 lds
    s_add_u32 m0, m0, 3968
    v_mfma_f32_16x16x32_bf16 v[120:123], a[96:99], v[96:99], v[120:123]
    s_waitcnt lgkmcnt(2)
    s_mul_i32 s51, s50, 114688
    v_mfma_f32_16x16x32_bf16 v[108:111], a[20:23], v[100:103], v[108:111]
    ds_read_b128 v[92:95], v12 offset:12288
    s_add_u32 s41, s38, s51
    v_mfma_f32_16x16x32_bf16 v[112:115], a[20:23], v[104:107], v[112:115]
    ds_read_b128 v[96:99], v12 offset:14336
    s_xor_b32 s51, s50, 2
    v_mfma_f32_16x16x32_bf16 v[116:119], a[100:103], v[100:103], v[116:119]
    buffer_load_dwordx4 v10, s[24:27], s46 offen offset:640 lds
    s_add_u32 m0, m0, 3968
    v_mfma_f32_16x16x32_bf16 v[120:123], a[100:103], v[104:107], v[120:123]
    s_waitcnt lgkmcnt(2)
    s_mul_i32 s51, s51, 114688
    v_mfma_f32_16x16x32_bf16 v[108:111], a[24:27], v[84:87], v[108:111]
    ds_read_b128 v[100:103], v11 offset:16384
    s_add_u32 s42, s38, s51
    v_mfma_f32_16x16x32_bf16 v[112:115], a[24:27], v[88:91], v[112:115]
    ds_read_b128 v[104:107], v11 offset:18432
    s_and_b32 s54, s37, s55
    v_mfma_f32_16x16x32_bf16 v[116:119], a[104:107], v[84:87], v[116:119]
    buffer_load_dwordx4 v10, s[24:27], s46 offen offset:768 lds
    s_add_u32 m0, m0, 3968
    v_mfma_f32_16x16x32_bf16 v[120:123], a[104:107], v[88:91], v[120:123]
    s_waitcnt lgkmcnt(2)
    s_lshl_b32 s50, s50, 12
    v_mfma_f32_16x16x32_bf16 v[108:111], a[28:31], v[92:95], v[108:111]
    ds_read_b128 v[84:87], v12 offset:16384
    v_add_u32 v141, s50, v138
    v_mfma_f32_16x16x32_bf16 v[112:115], a[28:31], v[96:99], v[112:115]
    ds_read_b128 v[88:91], v12 offset:18432
    s_add_u32 s43, s41, 40960
    v_mfma_f32_16x16x32_bf16 v[116:119], a[108:111], v[92:95], v[116:119]
    buffer_load_dwordx4 v10, s[24:27], s46 offen offset:896 lds
    s_add_u32 m0, m0, 3968
    v_mfma_f32_16x16x32_bf16 v[120:123], a[108:111], v[96:99], v[120:123]
    s_waitcnt lgkmcnt(2)
    v_mfma_f32_16x16x32_bf16 v[108:111], a[32:35], v[100:103], v[108:111]
    ds_read_b128 v[92:95], v11 offset:20480
    v_mfma_f32_16x16x32_bf16 v[112:115], a[32:35], v[104:107], v[112:115]
    ds_read_b128 v[96:99], v11 offset:22528
    v_mfma_f32_16x16x32_bf16 v[116:119], a[112:115], v[100:103], v[116:119]
    buffer_load_dwordx4 v10, s[24:27], s46 offen offset:1024 lds
    s_add_u32 m0, m0, 3968
    v_mfma_f32_16x16x32_bf16 v[120:123], a[112:115], v[104:107], v[120:123]
    s_waitcnt lgkmcnt(2)
    v_mfma_f32_16x16x32_bf16 v[108:111], a[36:39], v[84:87], v[108:111]
    ds_read_b128 v[100:103], v12 offset:20480
    v_mfma_f32_16x16x32_bf16 v[112:115], a[36:39], v[88:91], v[112:115]
    ds_read_b128 v[104:107], v12 offset:22528
    v_mfma_f32_16x16x32_bf16 v[116:119], a[116:119], v[84:87], v[116:119]
    buffer_load_dwordx4 v10, s[24:27], s46 offen offset:1152 lds
    v_mfma_f32_16x16x32_bf16 v[120:123], a[116:119], v[88:91], v[120:123]
    s_waitcnt lgkmcnt(2)
    v_mfma_f32_16x16x32_bf16 v[108:111], a[40:43], v[92:95], v[108:111]
    ds_read_b128 v[84:87], v11 offset:24576
    v_mfma_f32_16x16x32_bf16 v[112:115], a[40:43], v[96:99], v[112:115]
    ds_read_b128 v[88:91], v11 offset:26624
    v_mfma_f32_16x16x32_bf16 v[116:119], a[120:123], v[92:95], v[116:119]
    v_mfma_f32_16x16x32_bf16 v[120:123], a[120:123], v[96:99], v[120:123]
    s_waitcnt lgkmcnt(2)
    v_mfma_f32_16x16x32_bf16 v[108:111], a[44:47], v[100:103], v[108:111]
    ds_read_b128 v[92:95], v12 offset:24576
    v_mfma_f32_16x16x32_bf16 v[112:115], a[44:47], v[104:107], v[112:115]
    ds_read_b128 v[96:99], v12 offset:26624
    v_mfma_f32_16x16x32_bf16 v[116:119], a[124:127], v[100:103], v[116:119]
    v_mfma_f32_16x16x32_bf16 v[120:123], a[124:127], v[104:107], v[120:123]
    s_waitcnt lgkmcnt(2)
    v_mfma_f32_16x16x32_bf16 v[108:111], a[48:51], v[84:87], v[108:111]
    ds_read_b128 v[100:103], v11 offset:28672
    v_mfma_f32_16x16x32_bf16 v[112:115], a[48:51], v[88:91], v[112:115]
    ds_read_b128 v[104:107], v11 offset:30720
    v_mfma_f32_16x16x32_bf16 v[116:119], a[128:131], v[84:87], v[116:119]
    v_mfma_f32_16x16x32_bf16 v[120:123], a[128:131], v[88:91], v[120:123]
    s_waitcnt lgkmcnt(2)
    v_mfma_f32_16x16x32_bf16 v[108:111], a[52:55], v[92:95], v[108:111]
    ds_read_b128 v[84:87], v12 offset:28672
    v_mfma_f32_16x16x32_bf16 v[112:115], a[52:55], v[96:99], v[112:115]
    ds_read_b128 v[88:91], v12 offset:30720
    v_mfma_f32_16x16x32_bf16 v[116:119], a[132:135], v[92:95], v[116:119]
    v_mfma_f32_16x16x32_bf16 v[120:123], a[132:135], v[96:99], v[120:123]
    s_waitcnt lgkmcnt(2)
    v_mfma_f32_16x16x32_bf16 v[108:111], a[56:59], v[100:103], v[108:111]
    ds_read_b128 v[92:95], v11 offset:32768
    v_mfma_f32_16x16x32_bf16 v[112:115], a[56:59], v[104:107], v[112:115]
    ds_read_b128 v[96:99], v11 offset:34816
    v_mfma_f32_16x16x32_bf16 v[116:119], a[136:139], v[100:103], v[116:119]
    v_mfma_f32_16x16x32_bf16 v[120:123], a[136:139], v[104:107], v[120:123]
    s_waitcnt lgkmcnt(2)
    v_mfma_f32_16x16x32_bf16 v[108:111], a[60:63], v[84:87], v[108:111]
    ds_read_b128 v[100:103], v12 offset:32768
    v_mfma_f32_16x16x32_bf16 v[112:115], a[60:63], v[88:91], v[112:115]
    ds_read_b128 v[104:107], v12 offset:34816
    v_mfma_f32_16x16x32_bf16 v[116:119], a[140:143], v[84:87], v[116:119]
    v_mfma_f32_16x16x32_bf16 v[120:123], a[140:143], v[88:91], v[120:123]
    s_waitcnt lgkmcnt(2)
    v_mfma_f32_16x16x32_bf16 v[108:111], a[64:67], v[92:95], v[108:111]
    ds_read_b128 v[84:87], v11 offset:36864
    v_mfma_f32_16x16x32_bf16 v[112:115], a[64:67], v[96:99], v[112:115]
    ds_read_b128 v[88:91], v11 offset:38912
    v_mfma_f32_16x16x32_bf16 v[116:119], a[144:147], v[92:95], v[116:119]
    v_mfma_f32_16x16x32_bf16 v[120:123], a[144:147], v[96:99], v[120:123]
    s_waitcnt lgkmcnt(2)
    v_mfma_f32_16x16x32_bf16 v[108:111], a[68:71], v[100:103], v[108:111]
    ds_read_b128 v[92:95], v12 offset:36864
    v_mfma_f32_16x16x32_bf16 v[112:115], a[68:71], v[104:107], v[112:115]
    ds_read_b128 v[96:99], v12 offset:38912
    v_mfma_f32_16x16x32_bf16 v[116:119], a[148:151], v[100:103], v[116:119]
    v_mfma_f32_16x16x32_bf16 v[120:123], a[148:151], v[104:107], v[120:123]
    s_waitcnt lgkmcnt(0)
    v_mfma_f32_16x16x32_bf16 v[108:111], a[72:75], v[84:87], v[108:111]
    v_add_u32 v11, s49, v11
    v_mfma_f32_16x16x32_bf16 v[112:115], a[72:75], v[88:91], v[112:115]
    v_add_u32 v12, s49, v12
    v_mfma_f32_16x16x32_bf16 v[108:111], a[76:79], v[92:95], v[108:111]
    s_sub_u32 s47, s47, s49
    v_mfma_f32_16x16x32_bf16 v[112:115], a[76:79], v[96:99], v[112:115]
    s_sub_u32 s49, 0, s49
    v_mfma_f32_16x16x32_bf16 v[116:119], a[152:155], v[84:87], v[116:119]
    v_mfma_f32_16x16x32_bf16 v[120:123], a[152:155], v[88:91], v[120:123]
    v_mfma_f32_16x16x32_bf16 v[116:119], a[156:159], v[92:95], v[116:119]
    v_mfma_f32_16x16x32_bf16 v[120:123], a[156:159], v[96:99], v[120:123]
    v_cvt_pk_bf16_f32 v124, v108, v109
    v_cvt_pk_bf16_f32 v125, v110, v111
    v_cvt_pk_bf16_f32 v126, v112, v113
    v_cvt_pk_bf16_f32 v127, v114, v115
    s_nop 0
    v_permlane16_swap_b32 v124, v126
    v_permlane16_swap_b32 v125, v127
    v_cvt_pk_bf16_f32 v128, v116, v117
    v_cvt_pk_bf16_f32 v129, v118, v119
    v_cvt_pk_bf16_f32 v130, v120, v121
    v_cvt_pk_bf16_f32 v131, v122, v123
    s_nop 0
    v_permlane16_swap_b32 v128, v130
    v_permlane16_swap_b32 v129, v131
    ds_write_b128 v140, v[128:131]
    buffer_store_dwordx4 v[124:127], v19, s[4:7], s44 offen
    buffer_store_dwordx4 v[128:131], v19, s[4:7], s45 offen
    v_mov_b32 v3, 460288
L_pf_2:
    buffer_load_dword v4, v3, s[4:7], s38 offen sc1
    s_sub_u32 s36, s36, 1
    s_cbranch_scc1 L_exit
    s_waitcnt vmcnt(0)
    v_readfirstlane_b32 s90, v4
    s_nop 0
    s_cmp_eq_u32 s90, 0
    s_cbranch_scc1 L_pf_2
    s_and_b32 s90, s90, 2
    s_lshl_b32 s90, s90, 12
    v_mov_b32 v3, s90
    v_mov_b32 v4, v3
    v_cmp_gt_u32 vcc, 16, v0
    s_nop 1
    v_cndmask_b32 v3, v3, v4, vcc
    v_add_u32 v142, v3, v142
    v_add_u32 v143, s90, v143
    v_add_u32 v144, 0, v142
    v_add_u32 v145, 0, v143
    ds_read_b128 v[156:159], v141
    ds_read_b128 v[160:163], v141 offset:1024
    v_mov_b32 v3, 200
L_p0_3:
    buffer_load_dword v4, v3, s[8:11], 0 offen sc1
    s_sub_u32 s36, s36, 1
    s_cbranch_scc1 L_exit
    s_waitcnt vmcnt(0)
    v_readfirstlane_b32 s90, v4
    s_nop 0
    s_cmp_eq_u32 s90, 0
    s_cbranch_scc1 L_p0_3
    s_and_b32 s90, s90, 2
    s_lshl_b32 s90, s90, 12
    s_and_b32 s91, s34, 1
    s_lshl_b32 s91, s91, 12
    s_lshr_b32 s92, s34, 2
    s_lshl_b32 s92, s92, 13
    s_add_u32 s91, s91, s92
    s_and_b32 s92, s34, 2
    s_lshl_b32 s92, s92, 13
    s_add_u32 s91, s91, s92
    s_xor_b32 s91, s91, s90
    s_add_u32 s91, s91, 1933312
    v_lshrrev_b32 v4, 2, v0
    v_lshl_add_u32 v3, v4, 9, s91
    v_cmp_ne_u32 s[92:93], s34, v4
    v_cmp_gt_u32 vcc, 32, v0
    s_nop 0
    s_and_b64 vcc, vcc, s[92:93]
    s_and_b32 vcc_lo, vcc_lo, s55
    v_cndmask_b32 v146, v146, v3, vcc
    s_add_u32 s50, s37, 3
    s_min_u32 s50, s50, 63
    s_mul_i32 s46, s50, 40960
    s_add_u32 s51, s37, 1
    v_mov_b32 v20, s51
    s_mov_b32 m0, s48
    v_mov_b32 v68, 0
    v_mov_b32 v69, 0
    v_mov_b32 v70, 0
    v_mov_b32 v71, 0
    v_mov_b32 v72, 0
    v_mov_b32 v73, 0
    v_mov_b32 v74, 0
    v_mov_b32 v75, 0
L_qkv_loop_f:
    buffer_load_dwordx4 v13, s[4:7], s41 offen sc1 lds
    buffer_load_dwordx4 v13, s[4:7], s41 offen offset:1024 sc1 lds
    buffer_load_dword v14, s[4:7], s41 offen offset:2048 sc1 lds
    buffer_load_dword v14, s[4:7], s41 offen offset:2304 sc1 lds
L_poll_5:
    buffer_load_dwordx4 v13, s[4:7], s41 offen sc1 lds
    buffer_load_dwordx4 v13, s[4:7], s41 offen offset:1024 sc1 lds
    buffer_load_dword v14, s[4:7], s41 offen offset:2048 sc1 lds
    buffer_load_dword v14, s[4:7], s41 offen offset:2304 sc1 lds
    s_sub_u32 s36, s36, 1
    s_cbranch_scc1 L_exit
    s_waitcnt vmcnt(4)
    ds_read_b32 v18, v15
    s_waitcnt lgkmcnt(0)
    v_cmp_eq_u32 vcc, -1, v18
    s_cbranch_vccnz L_poll_5
    s_barrier
    ds_read_b128 v[28:31], v16 offset:0
    ds_read_b128 v[32:35], v16 offset:1024
    ds_read_b128 v[36:39], v16 offset:2048
    s_waitcnt lgkmcnt(2)
    v_smfmac_f32_16x16x64_bf16 v[68:71], v[28:31], a[0:7], v17
    ds_read_b128 v[40:43], v16 offset:3072
    v_smfmac_f32_16x16x64_bf16 v[72:75], v[28:31], a[80:87], v17
    ds_read_b128 v[44:47], v16 offset:4096
    s_waitcnt lgkmcnt(3)
    v_smfmac_f32_16x16x64_bf16 v[68:71], v[32:35], a[8:15], v17
    ds_read_b128 v[48:51], v16 offset:5120
    v_smfmac_f32_16x16x64_bf16 v[72:75], v[32:35], a[88:95], v17
    ds_read_b128 v[52:55], v16 offset:6144
    s_waitcnt lgkmcnt(4)
    v_smfmac_f32_16x16x64_bf16 v[68:71], v[36:39], a[16:23], v17
    ds_read_b128 v[56:59], v16 offset:7168
    v_smfmac_f32_16x16x64_bf16 v[72:75], v[36:39], a[96:103], v17
    ds_read_b128 v[60:63], v16 offset:8192
    s_waitcnt lgkmcnt(5)
    v_smfmac_f32_16x16x64_bf16 v[68:71], v[40:43], a[24:31], v17
    ds_read_b128 v[64:67], v16 offset:9216
    v_smfmac_f32_16x16x64_bf16 v[72:75], v[40:43], a[104:111], v17
    s_waitcnt lgkmcnt(5)
    v_smfmac_f32_16x16x64_bf16 v[68:71], v[44:47], a[32:39], v17
    v_smfmac_f32_16x16x64_bf16 v[72:75], v[44:47], a[112:119], v17
    s_waitcnt lgkmcnt(4)
    v_smfmac_f32_16x16x64_bf16 v[68:71], v[48:51], a[40:47], v17
    v_smfmac_f32_16x16x64_bf16 v[72:75], v[48:51], a[120:127], v17
    s_waitcnt lgkmcnt(3)
    v_smfmac_f32_16x16x64_bf16 v[68:71], v[52:55], a[48:55], v17
    s_waitcnt lgkmcnt(2)
    v_smfmac_f32_16x16x64_bf16 v[68:71], v[56:59], a[56:63], v17
    s_waitcnt lgkmcnt(1)
    v_smfmac_f32_16x16x64_bf16 v[68:71], v[60:63], a[64:71], v17
    s_waitcnt lgkmcnt(0)
    v_smfmac_f32_16x16x64_bf16 v[68:71], v[64:67], a[72:79], v17
L_redo_4:
    v_smfmac_f32_16x16x64_bf16 v[72:75], v[52:55], a[128:135], v17
    v_smfmac_f32_16x16x64_bf16 v[72:75], v[56:59], a[136:143], v17
    v_smfmac_f32_16x16x64_bf16 v[72:75], v[60:63], a[144:151], v17
    buffer_store_dword v20, v21, s[4:7], s38 offen
    v_add_f32 v68, v68, v70
    v_add_f32 v69, v69, v71
    v_smfmac_f32_16x16x64_bf16 v[72:75], v[64:67], a[152:159], v17
    v_cmp_u_f32 vcc, v68, v69
    v_cvt_pk_bf16_f32 v132, v68, v69
    s_cbranch_vccnz L_nan_6
L_cont_7:
    s_nop 4
    v_pk_add_f32 v[72:73], v[72:73], v[74:75]
    v_cvt_pk_bf16_f32 v133, v72, v73
    ds_write_b64 v23, v[132:133]
    s_cmp_eq_u32 s32, 0
    s_cbranch_scc1 L_w0_8
    s_cmp_eq_u32 s32, 3
    s_cbranch_scc1 L_w3_9
    s_waitcnt lgkmcnt(0)
    s_barrier
    ds_read_b64_tr_b16 v[76:77], v24 offset:0
    ds_read_b64_tr_b16 v[78:79], v134 offset:0
    ds_read_b64_tr_b16 v[80:81], v24 offset:1024
    ds_read_b64_tr_b16 v[82:83], v134 offset:1024
    s_waitcnt lgkmcnt(2)
    v_mfma_f32_16x16x32_bf16 v[164:167], v[156:159], v[76:79], 0
    s_waitcnt lgkmcnt(0)
    v_mfma_f32_16x16x32_bf16 v[164:167], v[160:163], v[80:83], v[164:167]
    ds_read_b128 v[84:87], v11 offset:0
    ds_read_b128 v[88:91], v11 offset:2048
    ds_read_b128 v[92:95], v12 offset:0
    ds_read_b128 v[96:99], v12 offset:2048
    s_nop 3
    buffer_store_dwordx4 v[164:167], v135, s[4:7], s41 offen
    s_branch L_join_10
L_w0_8:
    s_waitcnt lgkmcnt(0)
    s_barrier
    ds_read_b64_tr_b16 v[76:77], v24 offset:0
    ds_read_b64_tr_b16 v[78:79], v134 offset:0
    ds_read_b64_tr_b16 v[80:81], v24 offset:1024
    ds_read_b64_tr_b16 v[82:83], v134 offset:1024
    s_waitcnt lgkmcnt(2)
    v_mfma_f32_16x16x32_bf16 v[164:167], v[76:79], v[76:79], 0
    s_waitcnt lgkmcnt(0)
    v_mfma_f32_16x16x32_bf16 v[164:167], v[80:83], v[80:83], v[164:167]
    ds_read_b128 v[84:87], v11 offset:0
    ds_read_b128 v[88:91], v11 offset:2048
    ds_read_b128 v[92:95], v12 offset:0
    ds_read_b128 v[96:99], v12 offset:2048
    s_nop 3
    buffer_store_dword v166, v135, s[4:7], s41 offen
    buffer_store_dword v167, v135, s[4:7], s41 offen offset:8
    s_branch L_join_10
L_w3_9:
    s_waitcnt lgkmcnt(0)
    s_barrier
    ds_read_b64_tr_b16 v[76:77], v24 offset:0
    ds_read_b64_tr_b16 v[78:79], v134 offset:0
    ds_read_b64_tr_b16 v[80:81], v24 offset:1024
    ds_read_b64_tr_b16 v[82:83], v134 offset:1024
    s_waitcnt lgkmcnt(0)
    ds_read_b128 v[84:87], v11 offset:0
    ds_read_b128 v[88:91], v11 offset:2048
    ds_read_b128 v[92:95], v12 offset:0
    ds_read_b128 v[96:99], v12 offset:2048
    s_waitcnt lgkmcnt(0)
    buffer_store_dwordx4 v[76:79], v136, s[4:7], s43 offen
    buffer_store_dwordx4 v[80:83], v136, s[4:7], s43 offen offset:512
L_join_10:
    s_cmp_eq_u32 s37, 63
    s_cbranch_scc1 L_end_11
    s_lshl_b32 s90, s32, 10
    s_add_u32 m0, s90, s47
    s_waitcnt lgkmcnt(2)
    v_mfma_f32_16x16x32_bf16 v[108:111], a[0:3], v[84:87], 0
    ds_read_b128 v[100:103], v11 offset:4096
    v_mfma_f32_16x16x32_bf16 v[112:115], a[0:3], v[88:91], 0
    ds_read_b128 v[104:107], v11 offset:6144
    v_mfma_f32_16x16x32_bf16 v[116:119], a[80:83], v[84:87], 0
    v_mfma_f32_16x16x32_bf16 v[120:123], a[80:83], v[88:91], 0
    s_waitcnt lgkmcnt(2)
    v_mfma_f32_16x16x32_bf16 v[108:111], a[4:7], v[92:95], v[108:111]
    ds_read_b128 v[84:87], v12 offset:4096
    v_mfma_f32_16x16x32_bf16 v[112:115], a[4:7], v[96:99], v[112:115]
    ds_read_b128 v[88:91], v12 offset:6144
    v_mfma_f32_16x16x32_bf16 v[116:119], a[84:87], v[92:95], v[116:119]
    buffer_store_dword v22, v150, s[4:7], s42 offen offset:0
    buffer_store_dword v22, v149, s[4:7], s42 offen offset:0
    v_mfma_f32_16x16x32_bf16 v[120:123], a[84:87], v[96:99], v[120:123]
    s_waitcnt lgkmcnt(2)
    v_mfma_f32_16x16x32_bf16 v[108:111], a[8:11], v[100:103], v[108:111]
    ds_read_b128 v[92:95], v11 offset:8192
    v_mfma_f32_16x16x32_bf16 v[112:115], a[8:11], v[104:107], v[112:115]
    ds_read_b128 v[96:99], v11 offset:10240
    v_mfma_f32_16x16x32_bf16 v[116:119], a[88:91], v[100:103], v[116:119]
    buffer_store_dword v22, v150, s[4:7], s42 offen offset:256
    v_mfma_f32_16x16x32_bf16 v[120:123], a[88:91], v[104:107], v[120:123]
    s_waitcnt lgkmcnt(2)
    s_and_b32 s50, s37, 3
    v_mfma_f32_16x16x32_bf16 v[108:111], a[12:15], v[84:87], v[108:111]
    ds_read_b128 v[100:103], v12 offset:8192
    s_mul_i32 s53, s50, 327680
    v_mfma_f32_16x16x32_bf16 v[112:115], a[12:15], v[88:91], v[112:115]
    ds_read_b128 v[104:107], v12 offset:10240
    s_add_u32 s51, s37, 2
    v_mfma_f32_16x16x32_bf16 v[116:119], a[92:95], v[84:87], v[116:119]
    buffer_load_dwordx4 v10, s[24:27], s46 offen offset:0 lds
    s_add_u32 m0, m0, 3968
    v_mfma_f32_16x16x32_bf16 v[120:123], a[92:95], v[88:91], v[120:123]
    s_waitcnt lgkmcnt(2)
    s_and_b32 s50, s51, 3
    v_mfma_f32_16x16x32_bf16 v[108:111], a[16:19], v[92:95], v[108:111]
    ds_read_b128 v[84:87], v11 offset:12288
    s_mul_i32 s50, s50, 98304
    v_mfma_f32_16x16x32_bf16 v[112:115], a[16:19], v[96:99], v[112:115]
    ds_read_b128 v[88:91], v11 offset:14336
    s_add_u32 s50, s50, 475136
    v_mfma_f32_16x16x32_bf16 v[116:119], a[96:99], v[92:95], v[116:119]
    buffer_load_dwordx4 v10, s[24:27], s46 offen offset:128 lds
    s_add_u32 m0, m0, 3968
    v_mfma_f32_16x16x32_bf16 v[120:123], a[96:99], v[96:99], v[120:123]
    s_waitcnt lgkmcnt(2)
    s_add_u32 s44, s38, s50
    v_mfma_f32_16x16x32_bf16 v[108:111], a[20:23], v[100:103], v[108:111]
    ds_read_b128 v[92:95], v12 offset:12288
    s_add_u32 s45, s44, s56
    v_mfma_f32_16x16x32_bf16 v[112:115], a[20:23], v[104:107], v[112:115]
    ds_read_b128 v[96:99], v12 offset:14336
    s_and_b32 s50, s51, 3
    v_mfma_f32_16x16x32_bf16 v[116:119], a[100:103], v[100:103], v[116:119]
    buffer_load_dwordx4 v10, s[24:27], s46 offen offset:256 lds
    s_add_u32 m0, m0, 3968
    v_mfma_f32_16x16x32_bf16 v[120:123], a[100:103], v[104:107], v[120:123]
    s_waitcnt lgkmcnt(2)
    s_lshl_b32 s50, s50, 12
    v_mfma_f32_16x16x32_bf16 v[108:111], a[24:27], v[84:87], v[108:111]
    ds_read_b128 v[100:103], v11 offset:16384
    v_add_u32 v140, s50, v137
    v_mfma_f32_16x16x32_bf16 v[112:115], a[24:27], v[88:91], v[112:115]
    ds_read_b128 v[104:107], v11 offset:18432
    s_add_u32 s37, s37, 1
    v_mfma_f32_16x16x32_bf16 v[116:119], a[104:107], v[84:87], v[116:119]
    s_waitcnt vmcnt(6)
    buffer_store_dword v20, v139, s[4:7], s38 offen
    v_mfma_f32_16x16x32_bf16 v[120:123], a[104:107], v[88:91], v[120:123]
    s_waitcnt lgkmcnt(2)
    s_mov_b32 s52, 0
    v_mfma_f32_16x16x32_bf16 v[108:111], a[28:31], v[92:95], v[108:111]
    ds_read_b128 v[84:87], v12 offset:16384
    s_and_b32 s50, s37, 3
    v_mfma_f32_16x16x32_bf16 v[112:115], a[28:31], v[96:99], v[112:115]
    ds_read_b128 v[88:91], v12 offset:18432
    s_mul_i32 s51, s50, 114688
    v_mfma_f32_16x16x32_bf16 v[116:119], a[108:111], v[92:95], v[116:119]
    buffer_load_dwordx4 v10, s[24:27], s46 offen offset:384 lds
    s_add_u32 m0, m0, 3968
    v_mfma_f32_16x16x32_bf16 v[120:123], a[108:111], v[96:99], v[120:123]
    s_waitcnt lgkmcnt(2)
    s_add_u32 s41, s38, s51
    v_mfma_f32_16x16x32_bf16 v[108:111], a[32:35], v[100:103], v[108:111]
    ds_read_b128 v[92:95], v11 offset:20480
    s_xor_b32 s51, s50, 2
    v_mfma_f32_16x16x32_bf16 v[112:115], a[32:35], v[104:107], v[112:115]
    ds_read_b128 v[96:99], v11 offset:22528
    s_mul_i32 s51, s51, 114688
    v_mfma_f32_16x16x32_bf16 v[116:119], a[112:115], v[100:103], v[116:119]
    buffer_load_dwordx4 v10, s[24:27], s46 offen offset:512 lds
    s_add_u32 m0, m0, 3968
    v_mfma_f32_16x16x32_bf16 v[120:123], a[112:115], v[104:107], v[120:123]
    s_waitcnt lgkmcnt(2)
    s_add_u32 s42, s38, s51
    v_mfma_f32_16x16x32_bf16 v[108:111], a[36:39], v[84:87], v[108:111]
    ds_read_b128 v[100:103], v12 offset:20480
    s_and_b32 s54, s37, s55
    v_mfma_f32_16x16x32_bf16 v[112:115], a[36:39], v[88:91], v[112:115]
    ds_read_b128 v[104:107], v12 offset:22528
    s_lshl_b32 s50, s50, 12
    v_mfma_f32_16x16x32_bf16 v[116:119], a[116:119], v[84:87], v[116:119]
    buffer_load_dwordx4 v10, s[24:27], s46 offen offset:640 lds
    s_add_u32 m0, m0, 3968
    v_mfma_f32_16x16x32_bf16 v[120:123], a[116:119], v[88:91], v[120:123]
    s_waitcnt lgkmcnt(2)
    v_add_u32 v141, s50, v138
    v_mfma_f32_16x16x32_bf16 v[108:111], a[40:43], v[92:95], v[108:111]
    ds_read_b128 v[84:87], v11 offset:24576
    s_add_u32 s43, s41, 40960
    v_mfma_f32_16x16x32_bf16 v[112:115], a[40:43], v[96:99], v[112:115]
    ds_read_b128 v[88:91], v11 offset:26624
    v_mfma_f32_16x16x32_bf16 v[116:119], a[120:123], v[92:95], v[116:119]
    buffer_load_dwordx4 v10, s[24:27], s46 offen offset:768 lds
    s_add_u32 m0, m0, 3968
    v_mfma_f32_16x16x32_bf16 v[120:123], a[120:123], v[96:99], v[120:123]
    s_waitcnt lgkmcnt(2)
    v_mfma_f32_16x16x32_bf16 v[108:111], a[44:47], v[100:103], v[108:111]
    ds_read_b128 v[92:95], v12 offset:24576
    v_mfma_f32_16x16x32_bf16 v[112:115], a[44:47], v[104:107], v[112:115]
    buffer_load_dword v147, v146, s[4:7], 0 offen sc1
    ds_read_b128 v[96:99], v12 offset:26624
    v_mfma_f32_16x16x32_bf16 v[116:119], a[124:127], v[100:103], v[116:119]
    buffer_load_dwordx4 v10, s[24:27], s46 offen offset:896 lds
    s_add_u32 m0, m0, 3968
    v_mfma_f32_16x16x32_bf16 v[120:123], a[124:127], v[104:107], v[120:123]
    s_waitcnt lgkmcnt(2)
    v_mfma_f32_16x16x32_bf16 v[108:111], a[48:51], v[84:87], v[108:111]
    ds_read_b128 v[100:103], v11 offset:28672
    v_mfma_f32_16x16x32_bf16 v[112:115], a[48:51], v[88:91], v[112:115]
    buffer_load_dword v147, v146, s[4:7], 0 offen sc1
    ds_read_b128 v[104:107], v11 offset:30720
    v_mfma_f32_16x16x32_bf16 v[116:119], a[128:131], v[84:87], v[116:119]
    buffer_load_dwordx4 v10, s[24:27], s46 offen offset:1024 lds
    s_add_u32 m0, m0, 3968
    v_mfma_f32_16x16x32_bf16 v[120:123], a[128:131], v[88:91], v[120:123]
    s_waitcnt lgkmcnt(2)
    v_mfma_f32_16x16x32_bf16 v[108:111], a[52:55], v[92:95], v[108:111]
    ds_read_b128 v[84:87], v12 offset:28672
    v_mfma_f32_16x16x32_bf16 v[112:115], a[52:55], v[96:99], v[112:115]
    buffer_load_dword v147, v146, s[4:7], 0 offen sc1
    ds_read_b128 v[88:91], v12 offset:30720
    v_mfma_f32_16x16x32_bf16 v[116:119], a[132:135], v[92:95], v[116:119]
    buffer_load_dwordx4 v10, s[24:27], s46 offen offset:1152 lds
    v_mfma_f32_16x16x32_bf16 v[120:123], a[132:135], v[96:99], v[120:123]
    s_waitcnt lgkmcnt(2)
    v_mfma_f32_16x16x32_bf16 v[108:111], a[56:59], v[100:103], v[108:111]
    ds_read_b128 v[92:95], v11 offset:32768
    v_mfma_f32_16x16x32_bf16 v[112:115], a[56:59], v[104:107], v[112:115]
    buffer_load_dword v147, v146, s[4:7], 0 offen sc1
    ds_read_b128 v[96:99], v11 offset:34816
    v_mfma_f32_16x16x32_bf16 v[116:119], a[136:139], v[100:103], v[116:119]
    v_mfma_f32_16x16x32_bf16 v[120:123], a[136:139], v[104:107], v[120:123]
    s_waitcnt lgkmcnt(2)
    v_mfma_f32_16x16x32_bf16 v[108:111], a[60:63], v[84:87], v[108:111]
    ds_read_b128 v[100:103], v12 offset:32768
    v_mfma_f32_16x16x32_bf16 v[112:115], a[60:63], v[88:91], v[112:115]
L_tw_12:
    buffer_load_dword v147, v146, s[4:7], 0 offen sc1
    s_sub_u32 s36, s36, 1
    s_cbranch_scc1 L_exit
    s_waitcnt vmcnt(4)
    v_cmp_gt_u32 vcc, s54, v147
    s_cbranch_vccnz L_tw_12
    s_barrier
    buffer_load_dwordx4 v[168:171], v142, s[4:7], s53 offen sc1
    buffer_load_dwordx4 v[172:175], v143, s[4:7], s53 offen sc1
    ds_read_b128 v[104:107], v12 offset:34816
    v_mfma_f32_16x16x32_bf16 v[116:119], a[140:143], v[84:87], v[116:119]
    v_mfma_f32_16x16x32_bf16 v[120:123], a[140:143], v[88:91], v[120:123]
    s_waitcnt lgkmcnt(2)
    v_mfma_f32_16x16x32_bf16 v[108:111], a[64:67], v[92:95], v[108:111]
    ds_read_b128 v[84:87], v11 offset:36864
    v_mfma_f32_16x16x32_bf16 v[112:115], a[64:67], v[96:99], v[112:115]
    ds_read_b128 v[88:91], v11 offset:38912
    v_mfma_f32_16x16x32_bf16 v[116:119], a[144:147], v[92:95], v[116:119]
    v_mfma_f32_16x16x32_bf16 v[120:123], a[144:147], v[96:99], v[120:123]
    s_waitcnt lgkmcnt(2)
    v_mfma_f32_16x16x32_bf16 v[108:111], a[68:71], v[100:103], v[108:111]
    ds_read_b128 v[92:95], v12 offset:36864
    v_mfma_f32_16x16x32_bf16 v[112:115], a[68:71], v[104:107], v[112:115]
    ds_read_b128 v[96:99], v12 offset:38912
    v_mfma_f32_16x16x32_bf16 v[116:119], a[148:151], v[100:103], v[116:119]
    v_mfma_f32_16x16x32_bf16 v[120:123], a[148:151], v[104:107], v[120:123]
    s_waitcnt lgkmcnt(0)
    v_mfma_f32_16x16x32_bf16 v[108:111], a[72:75], v[84:87], v[108:111]
    v_add_u32 v11, s49, v11
    v_mfma_f32_16x16x32_bf16 v[112:115], a[72:75], v[88:91], v[112:115]
    v_add_u32 v12, s49, v12
    v_mfma_f32_16x16x32_bf16 v[108:111], a[76:79], v[92:95], v[108:111]
    s_sub_u32 s47, s47, s49
    v_mfma_f32_16x16x32_bf16 v[112:115], a[76:79], v[96:99], v[112:115]
    s_sub_u32 s49, 0, s49
    v_mfma_f32_16x16x32_bf16 v[116:119], a[152:155], v[84:87], v[116:119]
    v_mfma_f32_16x16x32_bf16 v[120:123], a[152:155], v[88:91], v[120:123]
    v_mfma_f32_16x16x32_bf16 v[116:119], a[156:159], v[92:95], v[116:119]
    v_mfma_f32_16x16x32_bf16 v[120:123], a[156:159], v[96:99], v[120:123]
    v_cvt_pk_bf16_f32 v124, v108, v109
    v_cvt_pk_bf16_f32 v125, v110, v111
    v_cvt_pk_bf16_f32 v126, v112, v113
    v_cvt_pk_bf16_f32 v127, v114, v115
    s_nop 0
    v_permlane16_swap_b32 v124, v126
    v_permlane16_swap_b32 v125, v127
    v_cvt_pk_bf16_f32 v128, v116, v117
    v_cvt_pk_bf16_f32 v129, v118, v119
    v_cvt_pk_bf16_f32 v130, v120, v121
    v_cvt_pk_bf16_f32 v131, v122, v123
    s_nop 0
    v_permlane16_swap_b32 v128, v130
    v_permlane16_swap_b32 v129, v131
    ds_write_b128 v140, v[128:131]
    buffer_store_dwordx4 v[124:127], v19, s[4:7], s44 offen
    buffer_store_dwordx4 v[128:131], v19, s[4:7], s45 offen
    s_waitcnt vmcnt(3)
    v_mfma_f32_16x16x32_bf16 v[184:187], v[198:201], v[168:171], 0
    v_mfma_f32_16x16x32_bf16 v[188:191], v[196:199], v[168:171], 0
    s_waitcnt vmcnt(2)
    v_mfma_f32_16x16x32_bf16 v[184:187], v[198:201], v[172:175], v[184:187]
    v_mfma_f32_16x16x32_bf16 v[188:191], v[196:199], v[172:175], v[188:191]
    s_nop 4
    v_cmp_u_f32 vcc, v184, v184
    v_cvt_pk_bf16_f32 v192, v184, v185
    v_cvt_pk_bf16_f32 v193, v186, v187
    v_cvt_pk_bf16_f32 v194, v188, v189
    v_cvt_pk_bf16_f32 v195, v190, v191
    s_cbranch_vccnz L_pp_13
L_pc_14:
    buffer_store_dwordx4 v[192:195], v148, s[4:7], s41 offen
    s_barrier
    ds_read_b128 v[156:159], v141
    ds_read_b128 v[160:163], v141 offset:1024
    s_add_u32 s50, s37, 3
    s_min_u32 s50, s50, 63
    s_mul_i32 s46, s50, 40960
    s_add_u32 s51, s37, 1
    v_mov_b32 v20, s51
    s_mov_b32 m0, s48
    v_mov_b32 v68, 0
    v_mov_b32 v69, 0
    v_mov_b32 v70, 0
    v_mov_b32 v71, 0
    v_mov_b32 v72, 0
    v_mov_b32 v73, 0
    v_mov_b32 v74, 0
    v_mov_b32 v75, 0
    s_branch L_qkv_loop_f
L_end_11:
    s_waitcnt vmcnt(0) lgkmcnt(0)
    buffer_store_dword v20, v139, s[4:7], s38 offen
    s_endpgm
L_nan_6:
    s_cmp_eq_u32 s52, 1
    s_cbranch_scc1 L_cont_7
    v_lshlrev_b32 v1, 4, v0
L_nan_6r:
    s_mov_b32 s90, s41
    v_mov_b32 v2, 0
    buffer_load_dwordx4 v[28:31], v1, s[4:7], s90 offen sc1
    s_add_u32 s90, s90, 1024
    buffer_load_dwordx4 v[32:35], v1, s[4:7], s90 offen sc1
    s_add_u32 s90, s90, 1024
    buffer_load_dwordx4 v[36:39], v1, s[4:7], s90 offen sc1
    s_add_u32 s90, s90, 1024
    buffer_load_dwordx4 v[40:43], v1, s[4:7], s90 offen sc1
    s_add_u32 s90, s90, 1024
    buffer_load_dwordx4 v[44:47], v1, s[4:7], s90 offen sc1
    s_add_u32 s90, s90, 1024
    buffer_load_dwordx4 v[48:51], v1, s[4:7], s90 offen sc1
    s_add_u32 s90, s90, 1024
    buffer_load_dwordx4 v[52:55], v1, s[4:7], s90 offen sc1
    s_add_u32 s90, s90, 1024
    buffer_load_dwordx4 v[56:59], v1, s[4:7], s90 offen sc1
    s_add_u32 s90, s90, 1024
    buffer_load_dwordx4 v[60:63], v1, s[4:7], s90 offen sc1
    s_add_u32 s90, s90, 1024
    buffer_load_dwordx4 v[64:67], v1, s[4:7], s90 offen sc1
    s_add_u32 s90, s90, 1024
    s_sub_u32 s36, s36, 1
    s_cbranch_scc1 L_exit
    s_waitcnt vmcnt(0) lgkmcnt(0)
    v_max3_u32 v2, v2, v28, v29
    v_max3_u32 v2, v2, v30, v31
    v_max3_u32 v2, v2, v32, v33
    v_max3_u32 v2, v2, v34, v35
    v_max3_u32 v2, v2, v36, v37
    v_max3_u32 v2, v2, v38, v39
    v_max3_u32 v2, v2, v40, v41
    v_max3_u32 v2, v2, v42, v43
    v_max3_u32 v2, v2, v44, v45
    v_max3_u32 v2, v2, v46, v47
    v_max3_u32 v2, v2, v48, v49
    v_max3_u32 v2, v2, v50, v51
    v_max3_u32 v2, v2, v52, v53
    v_max3_u32 v2, v2, v54, v55
    v_max3_u32 v2, v2, v56, v57
    v_max3_u32 v2, v2, v58, v59
    v_max3_u32 v2, v2, v60, v61
    v_max3_u32 v2, v2, v62, v63
    v_max3_u32 v2, v2, v64, v65
    v_max3_u32 v2, v2, v66, v67
    v_cmp_eq_u32 vcc, -1, v2
    s_cbranch_vccnz L_nan_6r
    s_mov_b32 s52, 1
    v_mov_b32 v68, 0
    v_mov_b32 v69, 0
    v_mov_b32 v70, 0
    v_mov_b32 v71, 0
    v_mov_b32 v72, 0
    v_mov_b32 v73, 0
    v_mov_b32 v74, 0
    v_mov_b32 v75, 0
    v_smfmac_f32_16x16x64_bf16 v[68:71], v[28:31], a[0:7], v17
    s_nop 0
    v_smfmac_f32_16x16x64_bf16 v[72:75], v[28:31], a[80:87], v17
    v_smfmac_f32_16x16x64_bf16 v[68:71], v[32:35], a[8:15], v17
    v_smfmac_f32_16x16x64_bf16 v[72:75], v[32:35], a[88:95], v17
    v_smfmac_f32_16x16x64_bf16 v[68:71], v[36:39], a[16:23], v17
    v_smfmac_f32_16x16x64_bf16 v[72:75], v[36:39], a[96:103], v17
    v_smfmac_f32_16x16x64_bf16 v[68:71], v[40:43], a[24:31], v17
    v_smfmac_f32_16x16x64_bf16 v[72:75], v[40:43], a[104:111], v17
    v_smfmac_f32_16x16x64_bf16 v[68:71], v[44:47], a[32:39], v17
    v_smfmac_f32_16x16x64_bf16 v[72:75], v[44:47], a[112:119], v17
    v_smfmac_f32_16x16x64_bf16 v[68:71], v[48:51], a[40:47], v17
    v_smfmac_f32_16x16x64_bf16 v[72:75], v[48:51], a[120:127], v17
    v_smfmac_f32_16x16x64_bf16 v[68:71], v[52:55], a[48:55], v17
    v_smfmac_f32_16x16x64_bf16 v[68:71], v[56:59], a[56:63], v17
    v_smfmac_f32_16x16x64_bf16 v[68:71], v[60:63], a[64:71], v17
    v_smfmac_f32_16x16x64_bf16 v[68:71], v[64:67], a[72:79], v17
    s_nop 2
    s_branch L_redo_4
L_pp_13:
    buffer_load_dwordx4 v[176:179], v144, s[4:7], s53 offen sc1
    buffer_load_dwordx4 v[180:183], v145, s[4:7], s53 offen sc1
    s_sub_u32 s36, s36, 1
    s_cbranch_scc1 L_exit
    v_max_u32 v151, v168, v169
    v_max3_u32 v151, v151, v170, v171
    v_max3_u32 v151, v151, v172, v173
    v_max3_u32 v151, v151, v174, v175
    v_cmp_eq_u32 vcc, -1, v151
    s_cbranch_vccz L_pc_14
    s_waitcnt vmcnt(1)
    v_mfma_f32_16x16x32_bf16 v[184:187], v[198:201], v[176:179], 0
    v_mfma_f32_16x16x32_bf16 v[188:191], v[196:199], v[176:179], 0
    s_waitcnt vmcnt(0)
    v_mfma_f32_16x16x32_bf16 v[184:187], v[198:201], v[180:183], v[184:187]
    v_mfma_f32_16x16x32_bf16 v[188:191], v[196:199], v[180:183], v[188:191]
    s_nop 4
    v_cmp_u_f32 vcc, v184, v184
    v_cvt_pk_bf16_f32 v192, v184, v185
    v_cvt_pk_bf16_f32 v193, v186, v187
    v_cvt_pk_bf16_f32 v194, v188, v189
    v_cvt_pk_bf16_f32 v195, v190, v191
    s_cbranch_vccnz L_pp_13_1
    s_branch L_pc_14
L_pp_13_1:
    buffer_load_dwordx4 v[168:171], v142, s[4:7], s53 offen sc1
    buffer_load_dwordx4 v[172:175], v143, s[4:7], s53 offen sc1
    s_sub_u32 s36, s36, 1
    s_cbranch_scc1 L_exit
    v_max_u32 v151, v176, v177
    v_max3_u32 v151, v151, v178, v179
    v_max3_u32 v151, v151, v180, v181
    v_max3_u32 v151, v151, v182, v183
    v_cmp_eq_u32 vcc, -1, v151
    s_cbranch_vccz L_pc_14
    s_waitcnt vmcnt(1)
    v_mfma_f32_16x16x32_bf16 v[184:187], v[198:201], v[168:171], 0
    v_mfma_f32_16x16x32_bf16 v[188:191], v[196:199], v[168:171], 0
    s_waitcnt vmcnt(0)
    v_mfma_f32_16x16x32_bf16 v[184:187], v[198:201], v[172:175], v[184:187]
    v_mfma_f32_16x16x32_bf16 v[188:191], v[196:199], v[172:175], v[188:191]
    s_nop 4
    v_cmp_u_f32 vcc, v184, v184
    v_cvt_pk_bf16_f32 v192, v184, v185
    v_cvt_pk_bf16_f32 v193, v186, v187
    v_cvt_pk_bf16_f32 v194, v188, v189
    v_cvt_pk_bf16_f32 v195, v190, v191
    s_cbranch_vccnz L_pp_13
    s_branch L_pc_14
L_v_f:
    s_mov_b32 s12, s78
    s_and_b32 s13, s79, 0xffff
    s_mov_b32 s14, 7864320
    s_mov_b32 s15, 0x20000
    s_sub_u32 s40, s35, 12
    s_lshl_b32 s40, s40, 1
    s_mov_b32 s24, s70
    s_and_b32 s25, s71, 0xffff
    s_mov_b32 s26, 2621440
    s_mov_b32 s27, 0x20000
    v_and_b32 v1, 15, v0
    v_lshrrev_b32 v2, 4, v0
    v_lshrrev_b32 v3, 3, v0
    v_and_b32 v4, 7, v0
    s_lshl_b32 s90, s32, 3
    v_add_u32 v5, s90, v3
    s_and_b32 s91, s32, 1
    s_lshl_b32 s91, s91, 2
    v_and_b32 v6, 2, v3
    v_or_b32 v6, s91, v6
    v_xor_b32 v6, v6, v4
    v_lshlrev_b32 v6, 4, v6
    v_mul_u32_u24 v7, 12288, v5
    s_mul_i32 s92, s34, 1536
    s_lshl_b32 s93, s40, 7
    s_add_u32 s92, s92, s93
    v_add3_u32 v124, v6, v7, s92
    v_lshrrev_b32 v6, 1, v3
    v_or_b32 v6, s91, v6
    v_xor_b32 v6, v6, v4
    v_lshlrev_b32 v6, 4, v6
    v_mul_u32_u24 v7, 1280, v5
    v_add_u32 v10, v6, v7
    s_lshl_b32 s90, s32, 10
    s_add_u32 m0, s90, 81920
    s_mov_b32 s91, 0
    buffer_load_dwordx4 v124, s[12:15], s91 offen nt lds
    s_add_u32 m0, m0, 4096
    s_add_u32 s91, s91, 393216
    buffer_load_dwordx4 v124, s[12:15], s91 offen nt lds
    s_add_u32 m0, m0, 4096
    s_add_u32 s91, s91, 393216
    buffer_load_dwordx4 v124, s[12:15], s91 offen nt lds
    s_add_u32 m0, m0, 4096
    s_add_u32 s91, s91, 393216
    buffer_load_dwordx4 v124, s[12:15], s91 offen nt lds
    s_add_u32 m0, m0, 4096
    s_add_u32 s91, s91, 393216
    buffer_load_dwordx4 v124, s[12:15], s91 offen nt lds
    s_add_u32 m0, m0, 4096
    s_add_u32 s91, s91, 393216
    buffer_load_dwordx4 v124, s[12:15], s91 offen nt lds
    s_add_u32 m0, m0, 4096
    s_add_u32 s91, s91, 393216
    buffer_load_dwordx4 v124, s[12:15], s91 offen nt lds
    s_add_u32 m0, m0, 4096
    s_add_u32 s91, s91, 393216
    buffer_load_dwordx4 v124, s[12:15], s91 offen nt lds
    s_add_u32 m0, m0, 4096
    s_add_u32 s91, s91, 393216
    buffer_load_dwordx4 v124, s[12:15], s91 offen nt lds
    s_add_u32 m0, m0, 4096
    s_add_u32 s91, s91, 393216
    buffer_load_dwordx4 v124, s[12:15], s91 offen nt lds
    s_lshl_b32 s90, s32, 10
    s_add_u32 m0, s90, 40960
    s_mov_b32 s91, 128
    buffer_load_dwordx4 v124, s[12:15], s91 offen nt lds
    s_add_u32 m0, m0, 4096
    s_add_u32 s91, s91, 393216
    buffer_load_dwordx4 v124, s[12:15], s91 offen nt lds
    s_add_u32 m0, m0, 4096
    s_add_u32 s91, s91, 393216
    buffer_load_dwordx4 v124, s[12:15], s91 offen nt lds
    s_add_u32 m0, m0, 4096
    s_add_u32 s91, s91, 393216
    buffer_load_dwordx4 v124, s[12:15], s91 offen nt lds
    s_add_u32 m0, m0, 4096
    s_add_u32 s91, s91, 393216
    buffer_load_dwordx4 v124, s[12:15], s91 offen nt lds
    s_add_u32 m0, m0, 4096
    s_add_u32 s91, s91, 393216
    buffer_load_dwordx4 v124, s[12:15], s91 offen nt lds
    s_add_u32 m0, m0, 4096
    s_add_u32 s91, s91, 393216
    buffer_load_dwordx4 v124, s[12:15], s91 offen nt lds
    s_add_u32 m0, m0, 4096
    s_add_u32 s91, s91, 393216
    buffer_load_dwordx4 v124, s[12:15], s91 offen nt lds
    s_add_u32 m0, m0, 4096
    s_add_u32 s91, s91, 393216
    buffer_load_dwordx4 v124, s[12:15], s91 offen nt lds
    s_add_u32 m0, m0, 4096
    s_add_u32 s91, s91, 393216
    buffer_load_dwordx4 v124, s[12:15], s91 offen nt lds
    s_lshl_b32 s90, s32, 10
    s_add_u32 m0, s90, 122880
    s_mov_b32 s91, 3932160
    buffer_load_dwordx4 v124, s[12:15], s91 offen nt lds
    s_add_u32 m0, m0, 4096
    s_add_u32 s91, s91, 393216
    buffer_load_dwordx4 v124, s[12:15], s91 offen nt lds
    s_add_u32 m0, m0, 4096
    s_add_u32 s91, s91, 393216
    buffer_load_dwordx4 v124, s[12:15], s91 offen nt lds
    s_add_u32 m0, m0, 4096
    s_add_u32 s91, s91, 393216
    buffer_load_dwordx4 v124, s[12:15], s91 offen nt lds
    s_add_u32 m0, m0, 4096
    s_add_u32 s91, s91, 393216
    buffer_load_dwordx4 v124, s[12:15], s91 offen nt lds
    s_add_u32 m0, m0, 4096
    s_add_u32 s91, s91, 393216
    buffer_load_dwordx4 v124, s[12:15], s91 offen nt lds
    s_add_u32 m0, m0, 4096
    s_add_u32 s91, s91, 393216
    buffer_load_dwordx4 v124, s[12:15], s91 offen nt lds
    s_add_u32 m0, m0, 4096
    s_add_u32 s91, s91, 393216
    buffer_load_dwordx4 v124, s[12:15], s91 offen nt lds
    s_add_u32 m0, m0, 4096
    s_add_u32 s91, s91, 393216
    buffer_load_dwordx4 v124, s[12:15], s91 offen nt lds
    s_add_u32 m0, m0, 4096
    s_add_u32 s91, s91, 393216
    buffer_load_dwordx4 v124, s[12:15], s91 offen nt lds
    s_mov_b32 s46, 0
    s_lshl_b32 s90, s32, 10
    s_add_u32 m0, s90, 0
    s_nop 0
    buffer_load_dwordx4 v10, s[24:27], s46 offen offset:0 lds
    s_add_u32 m0, m0, 3968
    s_nop 0
    buffer_load_dwordx4 v10, s[24:27], s46 offen offset:128 lds
    s_add_u32 m0, m0, 3968
    s_nop 0
    buffer_load_dwordx4 v10, s[24:27], s46 offen offset:256 lds
    s_add_u32 m0, m0, 3968
    s_nop 0
    buffer_load_dwordx4 v10, s[24:27], s46 offen offset:384 lds
    s_add_u32 m0, m0, 3968
    s_nop 0
    buffer_load_dwordx4 v10, s[24:27], s46 offen offset:512 lds
    s_add_u32 m0, m0, 3968
    s_nop 0
    buffer_load_dwordx4 v10, s[24:27], s46 offen offset:640 lds
    s_add_u32 m0, m0, 3968
    s_nop 0
    buffer_load_dwordx4 v10, s[24:27], s46 offen offset:768 lds
    s_add_u32 m0, m0, 3968
    s_nop 0
    buffer_load_dwordx4 v10, s[24:27], s46 offen offset:896 lds
    s_add_u32 m0, m0, 3968
    s_nop 0
    buffer_load_dwordx4 v10, s[24:27], s46 offen offset:1024 lds
    s_add_u32 m0, m0, 3968
    s_nop 0
    buffer_load_dwordx4 v10, s[24:27], s46 offen offset:1152 lds
    s_mul_i32 s60, s40, 86
    s_lshr_b32 s60, s60, 8
    s_mul_i32 s61, s60, 3
    s_sub_u32 s61, s40, s61
    s_add_u32 s90, s40, 1
    s_mul_i32 s62, s90, 86
    s_lshr_b32 s62, s62, 8
    s_mul_i32 s63, s62, 3
    s_sub_u32 s63, s90, s63
    v_lshrrev_b32 v3, 1, v2
    v_and_b32 v5, 1, v2
    s_lshl_b32 s90, s32, 9
    v_lshlrev_b32 v6, 4, v1
    v_lshl_add_u32 v6, v3, 8, v6
    v_add_u32 v6, s90, v6
    s_mul_i32 s90, s60, 12288
    s_lshl_b32 s91, s61, 11
    s_add_u32 s90, s90, s91
    v_mul_u32_u24 v7, 6144, v5
    v_add3_u32 v19, v6, v7, s90
    v_mov_b32 v22, -1
    s_mul_i32 s56, s62, 12288
    s_lshl_b32 s91, s63, 11
    s_add_u32 s56, s56, s91
    s_sub_u32 s56, s56, s90
    s_lshl_b32 s90, s40, 10
    s_lshl_b32 s91, s32, 8
    s_add_u32 s91, s91, s90
    s_add_u32 s91, s91, 25600
    v_lshl_add_u32 v135, v0, 2, s91
    v_lshlrev_b32 v6, 4, v1
    v_lshl_add_u32 v6, v2, 10, v6
    v_add_u32 v134, s91, v6
    v_cmp_gt_u32 vcc, 2, v2
    v_mov_b32 v9, 2146435072
    s_nop 0
    v_cndmask_b32 v134, v9, v134, vcc
    s_lshl_b32 s90, s60, 5
    s_lshl_b32 s91, s62, 5
    v_mov_b32 v3, s90
    v_mov_b32 v4, s91
    v_mov_b32 v6, s61
    v_mov_b32 v7, s63
    v_cmp_eq_u32 vcc, 0, v0
    s_nop 1
    v_cndmask_b32 v3, v4, v3, vcc
    v_cndmask_b32 v6, v7, v6, vcc
    v_add_u32 v4, v3, v6
    s_cmp_eq_u32 s32, 3
    s_cselect_b32 s91, 0, 2146435072
    s_add_u32 s91, s91, 462348
    v_lshl_add_u32 v21, v4, 2, s91
    v_lshl_add_u32 v4, v6, 2, v3
    s_lshl_b32 s91, s32, 2
    s_add_u32 s91, s91, 458752
    v_lshl_add_u32 v136, v4, 2, s91
    v_cmp_gt_u32 vcc, 2, v0
    v_mov_b32 v9, 2146435072
    s_nop 0
    v_cndmask_b32 v21, v9, v21, vcc
    v_cndmask_b32 v136, v9, v136, vcc
    s_lshl_b32 s90, s40, 1
    s_add_u32 s90, s90, s32
    s_min_u32 s90, s90, 19
    s_lshl_b32 s90, s90, 11
    v_lshl_add_u32 v137, v0, 4, s90
    s_mul_i32 s90, s32, 2560
    v_mov_b32 v138, s90
    v_lshrrev_b32 v3, 2, v1
    v_and_b32 v4, 3, v1
    v_and_b32 v5, 1, v2
    v_lshl_add_u32 v6, v2, 3, v3
    v_lshlrev_b32 v6, 7, v6
    v_and_b32 v7, 2, v3
    v_lshl_or_b32 v7, v5, 2, v7
    v_lshrrev_b32 v8, 1, v4
    s_lshl_b32 s90, s32, 1
    v_or_b32 v8, s90, v8
    v_xor_b32 v7, v7, v8
    v_lshl_add_u32 v6, v7, 4, v6
    v_and_b32 v7, 1, v4
    v_lshl_add_u32 v6, v7, 3, v6
    v_add_u32 v125, 81920, v6
    v_add_u32 v126, 40960, v6
    v_add_u32 v127, 122880, v6
    s_lshl_b32 s90, s32, 9
    s_add_u32 s90, s90, 133120
    v_lshlrev_b32 v6, 6, v3
    v_and_b32 v7, 1, v1
    v_lshl_add_u32 v6, v7, 5, v6
    v_lshl_add_u32 v6, v2, 3, v6
    v_and_b32 v7, 2, v1
    v_lshl_add_u32 v6, v7, 1, v6
    v_add_u32 v23, s90, v6
    v_lshlrev_b32 v6, 3, v1
    v_lshl_add_u32 v6, v5, 8, v6
    v_add_u32 v24, s90, v6
    v_and_b32 v7, 2, v1
    v_cmp_ne_u32 vcc, 0, v7
    v_mov_b32 v6, 0x4444
    v_mov_b32 v8, 0xeeee
    v_cndmask_b32 v17, v6, v8, vcc
    v_lshlrev_b32 v6, 4, v0
    v_add_u32 v16, 122880, v6
    s_mul_i32 s90, s32, 2560
    v_lshl_add_u32 v13, v0, 4, s90
    v_lshl_add_u32 v14, v0, 2, s90
    s_add_u32 s48, s90, 122880
    v_mul_u32_u24 v6, 40, v0
    v_add_u32 v15, s48, v6
    v_mul_u32_u24 v6, 164, v0
    v_min_u32 v6, 10236, v6
    v_add_u32 v25, 122880, v6
    v_lshrrev_b32 v6, 3, v1
    v_lshlrev_b32 v6, 10, v6
    v_and_b32 v7, 7, v1
    v_lshl_add_u32 v6, v7, 7, v6
    v_lshrrev_b32 v7, 1, v1
    v_xor_b32 v7, v7, v2
    v_lshl_add_u32 v11, v7, 4, v6
    v_xor_b32 v12, 64, v11
    s_waitcnt vmcnt(30)
    s_barrier
    ds_read_b64_tr_b16 a[0:1], v125 offset:0
    ds_read_b64_tr_b16 a[2:3], v125 offset:512
    ds_read_b64_tr_b16 a[4:5], v125 offset:4096
    ds_read_b64_tr_b16 a[6:7], v125 offset:4608
    ds_read_b64_tr_b16 a[8:9], v125 offset:8192
    ds_read_b64_tr_b16 a[10:11], v125 offset:8704
    ds_read_b64_tr_b16 a[12:13], v125 offset:12288
    ds_read_b64_tr_b16 a[14:15], v125 offset:12800
    ds_read_b64_tr_b16 a[16:17], v125 offset:16384
    ds_read_b64_tr_b16 a[18:19], v125 offset:16896
    ds_read_b64_tr_b16 a[20:21], v125 offset:20480
    ds_read_b64_tr_b16 a[22:23], v125 offset:20992
    ds_read_b64_tr_b16 a[24:25], v125 offset:24576
    ds_read_b64_tr_b16 a[26:27], v125 offset:25088
    ds_read_b64_tr_b16 a[28:29], v125 offset:28672
    ds_read_b64_tr_b16 a[30:31], v125 offset:29184
    ds_read_b64_tr_b16 a[32:33], v125 offset:32768
    ds_read_b64_tr_b16 a[34:35], v125 offset:33280
    ds_read_b64_tr_b16 a[36:37], v125 offset:36864
    ds_read_b64_tr_b16 a[38:39], v125 offset:37376
    s_waitcnt lgkmcnt(0)
    s_barrier
    s_lshl_b32 s90, s32, 10
    s_add_u32 m0, s90, 81920
    s_mov_b32 s91, 3932288
    buffer_load_dwordx4 v124, s[12:15], s91 offen nt lds
    s_add_u32 m0, m0, 4096
    s_add_u32 s91, s91, 393216
    buffer_load_dwordx4 v124, s[12:15], s91 offen nt lds
    s_add_u32 m0, m0, 4096
    s_add_u32 s91, s91, 393216
    buffer_load_dwordx4 v124, s[12:15], s91 offen nt lds
    s_add_u32 m0, m0, 4096
    s_add_u32 s91, s91, 393216
    buffer_load_dwordx4 v124, s[12:15], s91 offen nt lds
    s_add_u32 m0, m0, 4096
    s_add_u32 s91, s91, 393216
    buffer_load_dwordx4 v124, s[12:15], s91 offen nt lds
    s_add_u32 m0, m0, 4096
    s_add_u32 s91, s91, 393216
    buffer_load_dwordx4 v124, s[12:15], s91 offen nt lds
    s_add_u32 m0, m0, 4096
    s_add_u32 s91, s91, 393216
    buffer_load_dwordx4 v124, s[12:15], s91 offen nt lds
    s_add_u32 m0, m0, 4096
    s_add_u32 s91, s91, 393216
    buffer_load_dwordx4 v124, s[12:15], s91 offen nt lds
    s_add_u32 m0, m0, 4096
    s_add_u32 s91, s91, 393216
    buffer_load_dwordx4 v124, s[12:15], s91 offen nt lds
    s_add_u32 m0, m0, 4096
    s_add_u32 s91, s91, 393216
    buffer_load_dwordx4 v124, s[12:15], s91 offen nt lds
    s_waitcnt vmcnt(30)
    s_barrier
    ds_read_b64_tr_b16 a[80:81], v126 offset:0
    ds_read_b64_tr_b16 a[82:83], v126 offset:512
    ds_read_b64_tr_b16 a[84:85], v126 offset:4096
    ds_read_b64_tr_b16 a[86:87], v126 offset:4608
    ds_read_b64_tr_b16 a[88:89], v126 offset:8192
    ds_read_b64_tr_b16 a[90:91], v126 offset:8704
    ds_read_b64_tr_b16 a[92:93], v126 offset:12288
    ds_read_b64_tr_b16 a[94:95], v126 offset:12800
    ds_read_b64_tr_b16 a[96:97], v126 offset:16384
    ds_read_b64_tr_b16 a[98:99], v126 offset:16896
    ds_read_b64_tr_b16 a[100:101], v126 offset:20480
    ds_read_b64_tr_b16 a[102:103], v126 offset:20992
    ds_read_b64_tr_b16 a[104:105], v126 offset:24576
    ds_read_b64_tr_b16 a[106:107], v126 offset:25088
    ds_read_b64_tr_b16 a[108:109], v126 offset:28672
    ds_read_b64_tr_b16 a[110:111], v126 offset:29184
    ds_read_b64_tr_b16 a[112:113], v126 offset:32768
    ds_read_b64_tr_b16 a[114:115], v126 offset:33280
    ds_read_b64_tr_b16 a[116:117], v126 offset:36864
    ds_read_b64_tr_b16 a[118:119], v126 offset:37376
    s_waitcnt lgkmcnt(0)
    s_barrier
    s_mov_b32 s46, 40960
    s_lshl_b32 s90, s32, 10
    s_add_u32 m0, s90, 40960
    s_nop 0
    buffer_load_dwordx4 v10, s[24:27], s46 offen offset:0 lds
    s_add_u32 m0, m0, 3968
    s_nop 0
    buffer_load_dwordx4 v10, s[24:27], s46 offen offset:128 lds
    s_add_u32 m0, m0, 3968
    s_nop 0
    buffer_load_dwordx4 v10, s[24:27], s46 offen offset:256 lds
    s_add_u32 m0, m0, 3968
    s_nop 0
    buffer_load_dwordx4 v10, s[24:27], s46 offen offset:384 lds
    s_add_u32 m0, m0, 3968
    s_nop 0
    buffer_load_dwordx4 v10, s[24:27], s46 offen offset:512 lds
    s_add_u32 m0, m0, 3968
    s_nop 0
    buffer_load_dwordx4 v10, s[24:27], s46 offen offset:640 lds
    s_add_u32 m0, m0, 3968
    s_nop 0
    buffer_load_dwordx4 v10, s[24:27], s46 offen offset:768 lds
    s_add_u32 m0, m0, 3968
    s_nop 0
    buffer_load_dwordx4 v10, s[24:27], s46 offen offset:896 lds
    s_add_u32 m0, m0, 3968
    s_nop 0
    buffer_load_dwordx4 v10, s[24:27], s46 offen offset:1024 lds
    s_add_u32 m0, m0, 3968
    s_nop 0
    buffer_load_dwordx4 v10, s[24:27], s46 offen offset:1152 lds
    s_waitcnt vmcnt(30)
    s_barrier
    ds_read_b64_tr_b16 a[40:41], v127 offset:0
    ds_read_b64_tr_b16 a[42:43], v127 offset:512
    ds_read_b64_tr_b16 a[44:45], v127 offset:4096
    ds_read_b64_tr_b16 a[46:47], v127 offset:4608
    ds_read_b64_tr_b16 a[48:49], v127 offset:8192
    ds_read_b64_tr_b16 a[50:51], v127 offset:8704
    ds_read_b64_tr_b16 a[52:53], v127 offset:12288
    ds_read_b64_tr_b16 a[54:55], v127 offset:12800
    ds_read_b64_tr_b16 a[56:57], v127 offset:16384
    ds_read_b64_tr_b16 a[58:59], v127 offset:16896
    ds_read_b64_tr_b16 a[60:61], v127 offset:20480
    ds_read_b64_tr_b16 a[62:63], v127 offset:20992
    ds_read_b64_tr_b16 a[64:65], v127 offset:24576
    ds_read_b64_tr_b16 a[66:67], v127 offset:25088
    ds_read_b64_tr_b16 a[68:69], v127 offset:28672
    ds_read_b64_tr_b16 a[70:71], v127 offset:29184
    ds_read_b64_tr_b16 a[72:73], v127 offset:32768
    ds_read_b64_tr_b16 a[74:75], v127 offset:33280
    ds_read_b64_tr_b16 a[76:77], v127 offset:36864
    ds_read_b64_tr_b16 a[78:79], v127 offset:37376
    s_waitcnt lgkmcnt(0)
    s_waitcnt vmcnt(10)
    s_barrier
    ds_read_b64_tr_b16 a[120:121], v125 offset:0
    ds_read_b64_tr_b16 a[122:123], v125 offset:512
    ds_read_b64_tr_b16 a[124:125], v125 offset:4096
    ds_read_b64_tr_b16 a[126:127], v125 offset:4608
    ds_read_b64_tr_b16 a[128:129], v125 offset:8192
    ds_read_b64_tr_b16 a[130:131], v125 offset:8704
    ds_read_b64_tr_b16 a[132:133], v125 offset:12288
    ds_read_b64_tr_b16 a[134:135], v125 offset:12800
    ds_read_b64_tr_b16 a[136:137], v125 offset:16384
    ds_read_b64_tr_b16 a[138:139], v125 offset:16896
    ds_read_b64_tr_b16 a[140:141], v125 offset:20480
    ds_read_b64_tr_b16 a[142:143], v125 offset:20992
    ds_read_b64_tr_b16 a[144:145], v125 offset:24576
    ds_read_b64_tr_b16 a[146:147], v125 offset:25088
    ds_read_b64_tr_b16 a[148:149], v125 offset:28672
    ds_read_b64_tr_b16 a[150:151], v125 offset:29184
    ds_read_b64_tr_b16 a[152:153], v125 offset:32768
    ds_read_b64_tr_b16 a[154:155], v125 offset:33280
    ds_read_b64_tr_b16 a[156:157], v125 offset:36864
    ds_read_b64_tr_b16 a[158:159], v125 offset:37376
    s_waitcnt lgkmcnt(0)
    s_mov_b32 s49, 40960
    s_mov_b32 s47, 40960
    s_mov_b32 s37, -1
    s_add_u32 s44, s38, 65536
    s_add_u32 s45, s44, s56
    s_mov_b32 s46, 40960
    ds_read_b128 v[84:87], v11 offset:0
    ds_read_b128 v[88:91], v11 offset:2048
    ds_read_b128 v[92:95], v12 offset:0
    ds_read_b128 v[96:99], v12 offset:2048
    s_waitcnt lgkmcnt(2)
    v_mfma_f32_16x16x32_bf16 v[108:111], a[0:3], v[84:87], 0
    ds_read_b128 v[100:103], v11 offset:4096
    v_mfma_f32_16x16x32_bf16 v[112:115], a[0:3], v[88:91], 0
    ds_read_b128 v[104:107], v11 offset:6144
    v_mfma_f32_16x16x32_bf16 v[116:119], a[80:83], v[84:87], 0
    v_mfma_f32_16x16x32_bf16 v[120:123], a[80:83], v[88:91], 0
    s_waitcnt lgkmcnt(2)
    v_mfma_f32_16x16x32_bf16 v[108:111], a[4:7], v[92:95], v[108:111]
    ds_read_b128 v[84:87], v12 offset:4096
    v_mfma_f32_16x16x32_bf16 v[112:115], a[4:7], v[96:99], v[112:115]
    ds_read_b128 v[88:91], v12 offset:6144
    v_mfma_f32_16x16x32_bf16 v[116:119], a[84:87], v[92:95], v[116:119]
    v_mfma_f32_16x16x32_bf16 v[120:123], a[84:87], v[96:99], v[120:123]
    s_waitcnt lgkmcnt(2)
    v_mfma_f32_16x16x32_bf16 v[108:111], a[8:11], v[100:103], v[108:111]
    ds_read_b128 v[92:95], v11 offset:8192
    v_mfma_f32_16x16x32_bf16 v[112:115], a[8:11], v[104:107], v[112:115]
    ds_read_b128 v[96:99], v11 offset:10240
    v_mfma_f32_16x16x32_bf16 v[116:119], a[88:91], v[100:103], v[116:119]
    v_mfma_f32_16x16x32_bf16 v[120:123], a[88:91], v[104:107], v[120:123]
    s_waitcnt lgkmcnt(2)
    v_mfma_f32_16x16x32_bf16 v[108:111], a[12:15], v[84:87], v[108:111]
    ds_read_b128 v[100:103], v12 offset:8192
    v_mfma_f32_16x16x32_bf16 v[112:115], a[12:15], v[88:91], v[112:115]
    ds_read_b128 v[104:107], v12 offset:10240
    v_mfma_f32_16x16x32_bf16 v[116:119], a[92:95], v[84:87], v[116:119]
    v_mfma_f32_16x16x32_bf16 v[120:123], a[92:95], v[88:91], v[120:123]
    s_waitcnt lgkmcnt(2)
    v_mfma_f32_16x16x32_bf16 v[108:111], a[16:19], v[92:95], v[108:111]
    ds_read_b128 v[84:87], v11 offset:12288
    v_mfma_f32_16x16x32_bf16 v[112:115], a[16:19], v[96:99], v[112:115]
    ds_read_b128 v[88:91], v11 offset:14336
    v_mfma_f32_16x16x32_bf16 v[116:119], a[96:99], v[92:95], v[116:119]
    v_mfma_f32_16x16x32_bf16 v[120:123], a[96:99], v[96:99], v[120:123]
    s_waitcnt lgkmcnt(2)
    v_mfma_f32_16x16x32_bf16 v[108:111], a[20:23], v[100:103], v[108:111]
    ds_read_b128 v[92:95], v12 offset:12288
    v_mfma_f32_16x16x32_bf16 v[112:115], a[20:23], v[104:107], v[112:115]
    ds_read_b128 v[96:99], v12 offset:14336
    v_mfma_f32_16x16x32_bf16 v[116:119], a[100:103], v[100:103], v[116:119]
    v_mfma_f32_16x16x32_bf16 v[120:123], a[100:103], v[104:107], v[120:123]
    s_waitcnt lgkmcnt(2)
    v_mfma_f32_16x16x32_bf16 v[108:111], a[24:27], v[84:87], v[108:111]
    ds_read_b128 v[100:103], v11 offset:16384
    v_mfma_f32_16x16x32_bf16 v[112:115], a[24:27], v[88:91], v[112:115]
    ds_read_b128 v[104:107], v11 offset:18432
    v_mfma_f32_16x16x32_bf16 v[116:119], a[104:107], v[84:87], v[116:119]
    v_mfma_f32_16x16x32_bf16 v[120:123], a[104:107], v[88:91], v[120:123]
    s_waitcnt lgkmcnt(2)
    v_mfma_f32_16x16x32_bf16 v[108:111], a[28:31], v[92:95], v[108:111]
    ds_read_b128 v[84:87], v12 offset:16384
    v_mfma_f32_16x16x32_bf16 v[112:115], a[28:31], v[96:99], v[112:115]
    ds_read_b128 v[88:91], v12 offset:18432
    v_mfma_f32_16x16x32_bf16 v[116:119], a[108:111], v[92:95], v[116:119]
    v_mfma_f32_16x16x32_bf16 v[120:123], a[108:111], v[96:99], v[120:123]
    s_waitcnt lgkmcnt(2)
    v_mfma_f32_16x16x32_bf16 v[108:111], a[32:35], v[100:103], v[108:111]
    ds_read_b128 v[92:95], v11 offset:20480
    v_mfma_f32_16x16x32_bf16 v[112:115], a[32:35], v[104:107], v[112:115]
    ds_read_b128 v[96:99], v11 offset:22528
    v_mfma_f32_16x16x32_bf16 v[116:119], a[112:115], v[100:103], v[116:119]
    v_mfma_f32_16x16x32_bf16 v[120:123], a[112:115], v[104:107], v[120:123]
    s_waitcnt lgkmcnt(2)
    v_mfma_f32_16x16x32_bf16 v[108:111], a[36:39], v[84:87], v[108:111]
    ds_read_b128 v[100:103], v12 offset:20480
    v_mfma_f32_16x16x32_bf16 v[112:115], a[36:39], v[88:91], v[112:115]
    ds_read_b128 v[104:107], v12 offset:22528
    v_mfma_f32_16x16x32_bf16 v[116:119], a[116:119], v[84:87], v[116:119]
    v_mfma_f32_16x16x32_bf16 v[120:123], a[116:119], v[88:91], v[120:123]
    s_waitcnt lgkmcnt(2)
    v_mfma_f32_16x16x32_bf16 v[108:111], a[40:43], v[92:95], v[108:111]
    ds_read_b128 v[84:87], v11 offset:24576
    v_mfma_f32_16x16x32_bf16 v[112:115], a[40:43], v[96:99], v[112:115]
    ds_read_b128 v[88:91], v11 offset:26624
    v_mfma_f32_16x16x32_bf16 v[116:119], a[120:123], v[92:95], v[116:119]
    v_mfma_f32_16x16x32_bf16 v[120:123], a[120:123], v[96:99], v[120:123]
    s_waitcnt lgkmcnt(2)
    v_mfma_f32_16x16x32_bf16 v[108:111], a[44:47], v[100:103], v[108:111]
    ds_read_b128 v[92:95], v12 offset:24576
    v_mfma_f32_16x16x32_bf16 v[112:115], a[44:47], v[104:107], v[112:115]
    ds_read_b128 v[96:99], v12 offset:26624
    v_mfma_f32_16x16x32_bf16 v[116:119], a[124:127], v[100:103], v[116:119]
    v_mfma_f32_16x16x32_bf16 v[120:123], a[124:127], v[104:107], v[120:123]
    s_waitcnt lgkmcnt(2)
    v_mfma_f32_16x16x32_bf16 v[108:111], a[48:51], v[84:87], v[108:111]
    ds_read_b128 v[100:103], v11 offset:28672
    v_mfma_f32_16x16x32_bf16 v[112:115], a[48:51], v[88:91], v[112:115]
    ds_read_b128 v[104:107], v11 offset:30720
    v_mfma_f32_16x16x32_bf16 v[116:119], a[128:131], v[84:87], v[116:119]
    v_mfma_f32_16x16x32_bf16 v[120:123], a[128:131], v[88:91], v[120:123]
    s_waitcnt lgkmcnt(2)
    v_mfma_f32_16x16x32_bf16 v[108:111], a[52:55], v[92:95], v[108:111]
    ds_read_b128 v[84:87], v12 offset:28672
    v_mfma_f32_16x16x32_bf16 v[112:115], a[52:55], v[96:99], v[112:115]
    ds_read_b128 v[88:91], v12 offset:30720
    v_mfma_f32_16x16x32_bf16 v[116:119], a[132:135], v[92:95], v[116:119]
    v_mfma_f32_16x16x32_bf16 v[120:123], a[132:135], v[96:99], v[120:123]
    s_waitcnt lgkmcnt(2)
    v_mfma_f32_16x16x32_bf16 v[108:111], a[56:59], v[100:103], v[108:111]
    ds_read_b128 v[92:95], v11 offset:32768
    v_mfma_f32_16x16x32_bf16 v[112:115], a[56:59], v[104:107], v[112:115]
    ds_read_b128 v[96:99], v11 offset:34816
    v_mfma_f32_16x16x32_bf16 v[116:119], a[136:139], v[100:103], v[116:119]
    v_mfma_f32_16x16x32_bf16 v[120:123], a[136:139], v[104:107], v[120:123]
    s_waitcnt lgkmcnt(2)
    v_mfma_f32_16x16x32_bf16 v[108:111], a[60:63], v[84:87], v[108:111]
    ds_read_b128 v[100:103], v12 offset:32768
    v_mfma_f32_16x16x32_bf16 v[112:115], a[60:63], v[88:91], v[112:115]
    ds_read_b128 v[104:107], v12 offset:34816
    v_mfma_f32_16x16x32_bf16 v[116:119], a[140:143], v[84:87], v[116:119]
    v_mfma_f32_16x16x32_bf16 v[120:123], a[140:143], v[88:91], v[120:123]
    s_waitcnt lgkmcnt(2)
    v_mfma_f32_16x16x32_bf16 v[108:111], a[64:67], v[92:95], v[108:111]
    ds_read_b128 v[84:87], v11 offset:36864
    v_mfma_f32_16x16x32_bf16 v[112:115], a[64:67], v[96:99], v[112:115]
    ds_read_b128 v[88:91], v11 offset:38912
    v_mfma_f32_16x16x32_bf16 v[116:119], a[144:147], v[92:95], v[116:119]
    v_mfma_f32_16x16x32_bf16 v[120:123], a[144:147], v[96:99], v[120:123]
    s_waitcnt lgkmcnt(2)
    v_mfma_f32_16x16x32_bf16 v[108:111], a[68:71], v[100:103], v[108:111]
    ds_read_b128 v[92:95], v12 offset:36864
    v_mfma_f32_16x16x32_bf16 v[112:115], a[68:71], v[104:107], v[112:115]
    ds_read_b128 v[96:99], v12 offset:38912
    v_mfma_f32_16x16x32_bf16 v[116:119], a[148:151], v[100:103], v[116:119]
    v_mfma_f32_16x16x32_bf16 v[120:123], a[148:151], v[104:107], v[120:123]
    s_waitcnt lgkmcnt(0)
    v_mfma_f32_16x16x32_bf16 v[108:111], a[72:75], v[84:87], v[108:111]
    v_add_u32 v11, s49, v11
    v_mfma_f32_16x16x32_bf16 v[112:115], a[72:75], v[88:91], v[112:115]
    v_add_u32 v12, s49, v12
    v_mfma_f32_16x16x32_bf16 v[108:111], a[76:79], v[92:95], v[108:111]
    s_sub_u32 s47, s47, s49
    v_mfma_f32_16x16x32_bf16 v[112:115], a[76:79], v[96:99], v[112:115]
    s_sub_u32 s49, 0, s49
    v_mfma_f32_16x16x32_bf16 v[116:119], a[152:155], v[84:87], v[116:119]
    v_mfma_f32_16x16x32_bf16 v[120:123], a[152:155], v[88:91], v[120:123]
    v_mfma_f32_16x16x32_bf16 v[116:119], a[156:159], v[92:95], v[116:119]
    v_mfma_f32_16x16x32_bf16 v[120:123], a[156:159], v[96:99], v[120:123]
    v_cvt_pk_bf16_f32 v124, v108, v109
    v_cvt_pk_bf16_f32 v125, v110, v111
    v_cvt_pk_bf16_f32 v126, v112, v113
    v_cvt_pk_bf16_f32 v127, v114, v115
    s_nop 0
    v_permlane16_swap_b32 v124, v126
    v_permlane16_swap_b32 v125, v127
    v_cvt_pk_bf16_f32 v128, v116, v117
    v_cvt_pk_bf16_f32 v129, v118, v119
    v_cvt_pk_bf16_f32 v130, v120, v121
    v_cvt_pk_bf16_f32 v131, v122, v123
    s_nop 0
    v_permlane16_swap_b32 v128, v130
    v_permlane16_swap_b32 v129, v131
    buffer_store_dwordx4 v[124:127], v19, s[4:7], s44 offen
    buffer_store_dwordx4 v[128:131], v19, s[4:7], s45 offen
    v_mov_b32 v1, 192
L_gw_15:
    buffer_load_dword v2, v1, s[8:11], 0 offen sc1
    s_sub_u32 s36, s36, 1
    s_cbranch_scc1 L_exit
    s_waitcnt vmcnt(0)
    v_readfirstlane_b32 s90, v2
    s_nop 0
    s_cmp_eq_u32 s90, 0
    s_cbranch_scc1 L_gw_15
    s_cmp_lg_u32 s90, 1
    s_cbranch_scc1 L_slow
    s_waitcnt vmcnt(0) lgkmcnt(0)
    v_mov_b32 v20, 1
    buffer_store_dword v20, v136, s[4:7], s38 offen
    s_barrier
    s_add_u32 s44, s38, 180224
    s_add_u32 s45, s44, s56
    s_mov_b32 s46, 81920
    ds_read_b128 v[84:87], v11 offset:0
    ds_read_b128 v[88:91], v11 offset:2048
    ds_read_b128 v[92:95], v12 offset:0
    ds_read_b128 v[96:99], v12 offset:2048
    s_lshl_b32 s90, s32, 10
    s_add_u32 m0, s90, s47
    s_waitcnt lgkmcnt(2)
    v_mfma_f32_16x16x32_bf16 v[108:111], a[0:3], v[84:87], 0
    ds_read_b128 v[100:103], v11 offset:4096
    v_mfma_f32_16x16x32_bf16 v[112:115], a[0:3], v[88:91], 0
    ds_read_b128 v[104:107], v11 offset:6144
    v_mfma_f32_16x16x32_bf16 v[116:119], a[80:83], v[84:87], 0
    buffer_load_dwordx4 v10, s[24:27], s46 offen offset:0 lds
    s_add_u32 m0, m0, 3968
    v_mfma_f32_16x16x32_bf16 v[120:123], a[80:83], v[88:91], 0
    s_waitcnt lgkmcnt(2)
    v_mfma_f32_16x16x32_bf16 v[108:111], a[4:7], v[92:95], v[108:111]
    ds_read_b128 v[84:87], v12 offset:4096
    v_mfma_f32_16x16x32_bf16 v[112:115], a[4:7], v[96:99], v[112:115]
    ds_read_b128 v[88:91], v12 offset:6144
    v_mfma_f32_16x16x32_bf16 v[116:119], a[84:87], v[92:95], v[116:119]
    buffer_load_dwordx4 v10, s[24:27], s46 offen offset:128 lds
    s_add_u32 m0, m0, 3968
    v_mfma_f32_16x16x32_bf16 v[120:123], a[84:87], v[96:99], v[120:123]
    s_waitcnt lgkmcnt(2)
    v_mfma_f32_16x16x32_bf16 v[108:111], a[8:11], v[100:103], v[108:111]
    ds_read_b128 v[92:95], v11 offset:8192
    v_mfma_f32_16x16x32_bf16 v[112:115], a[8:11], v[104:107], v[112:115]
    ds_read_b128 v[96:99], v11 offset:10240
    v_mfma_f32_16x16x32_bf16 v[116:119], a[88:91], v[100:103], v[116:119]
    buffer_load_dwordx4 v10, s[24:27], s46 offen offset:256 lds
    s_add_u32 m0, m0, 3968
    v_mfma_f32_16x16x32_bf16 v[120:123], a[88:91], v[104:107], v[120:123]
    s_waitcnt lgkmcnt(2)
    v_mfma_f32_16x16x32_bf16 v[108:111], a[12:15], v[84:87], v[108:111]
    ds_read_b128 v[100:103], v12 offset:8192
    v_mfma_f32_16x16x32_bf16 v[112:115], a[12:15], v[88:91], v[112:115]
    ds_read_b128 v[104:107], v12 offset:10240
    v_mfma_f32_16x16x32_bf16 v[116:119], a[92:95], v[84:87], v[116:119]
    buffer_load_dwordx4 v10, s[24:27], s46 offen offset:384 lds
    s_add_u32 m0, m0, 3968
    v_mfma_f32_16x16x32_bf16 v[120:123], a[92:95], v[88:91], v[120:123]
    s_waitcnt lgkmcnt(2)
    v_mfma_f32_16x16x32_bf16 v[108:111], a[16:19], v[92:95], v[108:111]
    ds_read_b128 v[84:87], v11 offset:12288
    v_mfma_f32_16x16x32_bf16 v[112:115], a[16:19], v[96:99], v[112:115]
    ds_read_b128 v[88:91], v11 offset:14336
    v_mfma_f32_16x16x32_bf16 v[116:119], a[96:99], v[92:95], v[116:119]
    buffer_load_dwordx4 v10, s[24:27], s46 offen offset:512 lds
    s_add_u32 m0, m0, 3968
    v_mfma_f32_16x16x32_bf16 v[120:123], a[96:99], v[96:99], v[120:123]
    s_waitcnt lgkmcnt(2)
    v_mfma_f32_16x16x32_bf16 v[108:111], a[20:23], v[100:103], v[108:111]
    ds_read_b128 v[92:95], v12 offset:12288
    v_mfma_f32_16x16x32_bf16 v[112:115], a[20:23], v[104:107], v[112:115]
    ds_read_b128 v[96:99], v12 offset:14336
    v_mfma_f32_16x16x32_bf16 v[116:119], a[100:103], v[100:103], v[116:119]
    buffer_load_dwordx4 v10, s[24:27], s46 offen offset:640 lds
    s_add_u32 m0, m0, 3968
    v_mfma_f32_16x16x32_bf16 v[120:123], a[100:103], v[104:107], v[120:123]
    s_waitcnt lgkmcnt(2)
    v_mfma_f32_16x16x32_bf16 v[108:111], a[24:27], v[84:87], v[108:111]
    ds_read_b128 v[100:103], v11 offset:16384
    v_mfma_f32_16x16x32_bf16 v[112:115], a[24:27], v[88:91], v[112:115]
    ds_read_b128 v[104:107], v11 offset:18432
    v_mfma_f32_16x16x32_bf16 v[116:119], a[104:107], v[84:87], v[116:119]
    buffer_load_dwordx4 v10, s[24:27], s46 offen offset:768 lds
    s_add_u32 m0, m0, 3968
    v_mfma_f32_16x16x32_bf16 v[120:123], a[104:107], v[88:91], v[120:123]
    s_waitcnt lgkmcnt(2)
    v_mfma_f32_16x16x32_bf16 v[108:111], a[28:31], v[92:95], v[108:111]
    ds_read_b128 v[84:87], v12 offset:16384
    v_mfma_f32_16x16x32_bf16 v[112:115], a[28:31], v[96:99], v[112:115]
    ds_read_b128 v[88:91], v12 offset:18432
    v_mfma_f32_16x16x32_bf16 v[116:119], a[108:111], v[92:95], v[116:119]
    buffer_load_dwordx4 v10, s[24:27], s46 offen offset:896 lds
    s_add_u32 m0, m0, 3968
    v_mfma_f32_16x16x32_bf16 v[120:123], a[108:111], v[96:99], v[120:123]
    s_waitcnt lgkmcnt(2)
    v_mfma_f32_16x16x32_bf16 v[108:111], a[32:35], v[100:103], v[108:111]
    ds_read_b128 v[92:95], v11 offset:20480
    v_mfma_f32_16x16x32_bf16 v[112:115], a[32:35], v[104:107], v[112:115]
    ds_read_b128 v[96:99], v11 offset:22528
    v_mfma_f32_16x16x32_bf16 v[116:119], a[112:115], v[100:103], v[116:119]
    buffer_load_dwordx4 v10, s[24:27], s46 offen offset:1024 lds
    s_add_u32 m0, m0, 3968
    v_mfma_f32_16x16x32_bf16 v[120:123], a[112:115], v[104:107], v[120:123]
    s_waitcnt lgkmcnt(2)
    v_mfma_f32_16x16x32_bf16 v[108:111], a[36:39], v[84:87], v[108:111]
    ds_read_b128 v[100:103], v12 offset:20480
    v_mfma_f32_16x16x32_bf16 v[112:115], a[36:39], v[88:91], v[112:115]
    ds_read_b128 v[104:107], v12 offset:22528
    v_mfma_f32_16x16x32_bf16 v[116:119], a[116:119], v[84:87], v[116:119]
    buffer_load_dwordx4 v10, s[24:27], s46 offen offset:1152 lds
    v_mfma_f32_16x16x32_bf16 v[120:123], a[116:119], v[88:91], v[120:123]
    s_waitcnt lgkmcnt(2)
    v_mfma_f32_16x16x32_bf16 v[108:111], a[40:43], v[92:95], v[108:111]
    ds_read_b128 v[84:87], v11 offset:24576
    v_mfma_f32_16x16x32_bf16 v[112:115], a[40:43], v[96:99], v[112:115]
    ds_read_b128 v[88:91], v11 offset:26624
    v_mfma_f32_16x16x32_bf16 v[116:119], a[120:123], v[92:95], v[116:119]
    v_mfma_f32_16x16x32_bf16 v[120:123], a[120:123], v[96:99], v[120:123]
    s_waitcnt lgkmcnt(2)
    v_mfma_f32_16x16x32_bf16 v[108:111], a[44:47], v[100:103], v[108:111]
    ds_read_b128 v[92:95], v12 offset:24576
    v_mfma_f32_16x16x32_bf16 v[112:115], a[44:47], v[104:107], v[112:115]
    ds_read_b128 v[96:99], v12 offset:26624
    v_mfma_f32_16x16x32_bf16 v[116:119], a[124:127], v[100:103], v[116:119]
    v_mfma_f32_16x16x32_bf16 v[120:123], a[124:127], v[104:107], v[120:123]
    s_waitcnt lgkmcnt(2)
    v_mfma_f32_16x16x32_bf16 v[108:111], a[48:51], v[84:87], v[108:111]
    ds_read_b128 v[100:103], v11 offset:28672
    v_mfma_f32_16x16x32_bf16 v[112:115], a[48:51], v[88:91], v[112:115]
    ds_read_b128 v[104:107], v11 offset:30720
    v_mfma_f32_16x16x32_bf16 v[116:119], a[128:131], v[84:87], v[116:119]
    v_mfma_f32_16x16x32_bf16 v[120:123], a[128:131], v[88:91], v[120:123]
    s_waitcnt lgkmcnt(2)
    v_mfma_f32_16x16x32_bf16 v[108:111], a[52:55], v[92:95], v[108:111]
    ds_read_b128 v[84:87], v12 offset:28672
    v_mfma_f32_16x16x32_bf16 v[112:115], a[52:55], v[96:99], v[112:115]
    ds_read_b128 v[88:91], v12 offset:30720
    v_mfma_f32_16x16x32_bf16 v[116:119], a[132:135], v[92:95], v[116:119]
    v_mfma_f32_16x16x32_bf16 v[120:123], a[132:135], v[96:99], v[120:123]
    s_waitcnt lgkmcnt(2)
    v_mfma_f32_16x16x32_bf16 v[108:111], a[56:59], v[100:103], v[108:111]
    ds_read_b128 v[92:95], v11 offset:32768
    v_mfma_f32_16x16x32_bf16 v[112:115], a[56:59], v[104:107], v[112:115]
    ds_read_b128 v[96:99], v11 offset:34816
    v_mfma_f32_16x16x32_bf16 v[116:119], a[136:139], v[100:103], v[116:119]
    v_mfma_f32_16x16x32_bf16 v[120:123], a[136:139], v[104:107], v[120:123]
    s_waitcnt lgkmcnt(2)
    v_mfma_f32_16x16x32_bf16 v[108:111], a[60:63], v[84:87], v[108:111]
    ds_read_b128 v[100:103], v12 offset:32768
    v_mfma_f32_16x16x32_bf16 v[112:115], a[60:63], v[88:91], v[112:115]
    ds_read_b128 v[104:107], v12 offset:34816
    v_mfma_f32_16x16x32_bf16 v[116:119], a[140:143], v[84:87], v[116:119]
    v_mfma_f32_16x16x32_bf16 v[120:123], a[140:143], v[88:91], v[120:123]
    s_waitcnt lgkmcnt(2)
    v_mfma_f32_16x16x32_bf16 v[108:111], a[64:67], v[92:95], v[108:111]
    ds_read_b128 v[84:87], v11 offset:36864
    v_mfma_f32_16x16x32_bf16 v[112:115], a[64:67], v[96:99], v[112:115]
    ds_read_b128 v[88:91], v11 offset:38912
    v_mfma_f32_16x16x32_bf16 v[116:119], a[144:147], v[92:95], v[116:119]
    v_mfma_f32_16x16x32_bf16 v[120:123], a[144:147], v[96:99], v[120:123]
    s_waitcnt lgkmcnt(2)
    v_mfma_f32_16x16x32_bf16 v[108:111], a[68:71], v[100:103], v[108:111]
    ds_read_b128 v[92:95], v12 offset:36864
    v_mfma_f32_16x16x32_bf16 v[112:115], a[68:71], v[104:107], v[112:115]
    ds_read_b128 v[96:99], v12 offset:38912
    v_mfma_f32_16x16x32_bf16 v[116:119], a[148:151], v[100:103], v[116:119]
    v_mfma_f32_16x16x32_bf16 v[120:123], a[148:151], v[104:107], v[120:123]
    s_waitcnt lgkmcnt(0)
    v_mfma_f32_16x16x32_bf16 v[108:111], a[72:75], v[84:87], v[108:111]
    v_add_u32 v11, s49, v11
    v_mfma_f32_16x16x32_bf16 v[112:115], a[72:75], v[88:91], v[112:115]
    v_add_u32 v12, s49, v12
    v_mfma_f32_16x16x32_bf16 v[108:111], a[76:79], v[92:95], v[108:111]
    s_sub_u32 s47, s47, s49
    v_mfma_f32_16x16x32_bf16 v[112:115], a[76:79], v[96:99], v[112:115]
    s_sub_u32 s49, 0, s49
    v_mfma_f32_16x16x32_bf16 v[116:119], a[152:155], v[84:87], v[116:119]
    v_mfma_f32_16x16x32_bf16 v[120:123], a[152:155], v[88:91], v[120:123]
    v_mfma_f32_16x16x32_bf16 v[116:119], a[156:159], v[92:95], v[116:119]
    v_mfma_f32_16x16x32_bf16 v[120:123], a[156:159], v[96:99], v[120:123]
    v_cvt_pk_bf16_f32 v124, v108, v109
    v_cvt_pk_bf16_f32 v125, v110, v111
    v_cvt_pk_bf16_f32 v126, v112, v113
    v_cvt_pk_bf16_f32 v127, v114, v115
    s_nop 0
    v_permlane16_swap_b32 v124, v126
    v_permlane16_swap_b32 v125, v127
    v_cvt_pk_bf16_f32 v128, v116, v117
    v_cvt_pk_bf16_f32 v129, v118, v119
    v_cvt_pk_bf16_f32 v130, v120, v121
    v_cvt_pk_bf16_f32 v131, v122, v123
    s_nop 0
    v_permlane16_swap_b32 v128, v130
    v_permlane16_swap_b32 v129, v131
    buffer_store_dwordx4 v[124:127], v19, s[4:7], s44 offen
    buffer_store_dwordx4 v[128:131], v19, s[4:7], s45 offen
    s_waitcnt vmcnt(0) lgkmcnt(0)
    v_mov_b32 v20, 2
    buffer_store_dword v20, v136, s[4:7], s38 offen
    s_barrier
    s_add_u32 s44, s38, 294912
    s_add_u32 s45, s44, s56
    s_mov_b32 s46, 122880
    ds_read_b128 v[84:87], v11 offset:0
    ds_read_b128 v[88:91], v11 offset:2048
    ds_read_b128 v[92:95], v12 offset:0
    ds_read_b128 v[96:99], v12 offset:2048
    s_lshl_b32 s90, s32, 10
    s_add_u32 m0, s90, s47
    s_waitcnt lgkmcnt(2)
    v_mfma_f32_16x16x32_bf16 v[108:111], a[0:3], v[84:87], 0
    ds_read_b128 v[100:103], v11 offset:4096
    s_add_u32 s51, s37, 3
    v_mfma_f32_16x16x32_bf16 v[112:115], a[0:3], v[88:91], 0
    ds_read_b128 v[104:107], v11 offset:6144
    s_and_b32 s50, s51, 3
    v_mfma_f32_16x16x32_bf16 v[116:119], a[80:83], v[84:87], 0
    buffer_load_dwordx4 v10, s[24:27], s46 offen offset:0 lds
    s_add_u32 m0, m0, 3968
    v_mfma_f32_16x16x32_bf16 v[120:123], a[80:83], v[88:91], 0
    s_waitcnt lgkmcnt(2)
    s_mul_i32 s50, s50, 114688
    v_mfma_f32_16x16x32_bf16 v[108:111], a[4:7], v[92:95], v[108:111]
    ds_read_b128 v[84:87], v12 offset:4096
    s_add_u32 s50, s50, 65536
    v_mfma_f32_16x16x32_bf16 v[112:115], a[4:7], v[96:99], v[112:115]
    ds_read_b128 v[88:91], v12 offset:6144
    s_add_u32 s44, s38, s50
    v_mfma_f32_16x16x32_bf16 v[116:119], a[84:87], v[92:95], v[116:119]
    buffer_load_dwordx4 v10, s[24:27], s46 offen offset:128 lds
    s_add_u32 m0, m0, 3968
    v_mfma_f32_16x16x32_bf16 v[120:123], a[84:87], v[96:99], v[120:123]
    s_waitcnt lgkmcnt(2)
    s_add_u32 s45, s44, s56
    v_mfma_f32_16x16x32_bf16 v[108:111], a[8:11], v[100:103], v[108:111]
    ds_read_b128 v[92:95], v11 offset:8192
    s_add_u32 s37, s37, 1
    v_mfma_f32_16x16x32_bf16 v[112:115], a[8:11], v[104:107], v[112:115]
    ds_read_b128 v[96:99], v11 offset:10240
    s_mov_b32 s52, 0
    v_mfma_f32_16x16x32_bf16 v[116:119], a[88:91], v[100:103], v[116:119]
    buffer_load_dwordx4 v10, s[24:27], s46 offen offset:256 lds
    s_add_u32 m0, m0, 3968
    v_mfma_f32_16x16x32_bf16 v[120:123], a[88:91], v[104:107], v[120:123]
    s_waitcnt lgkmcnt(2)
    s_and_b32 s50, s37, 3
    v_mfma_f32_16x16x32_bf16 v[108:111], a[12:15], v[84:87], v[108:111]
    ds_read_b128 v[100:103], v12 offset:8192
    s_mul_i32 s51, s50, 114688
    v_mfma_f32_16x16x32_bf16 v[112:115], a[12:15], v[88:91], v[112:115]
    ds_read_b128 v[104:107], v12 offset:10240
    s_add_u32 s41, s38, s51
    v_mfma_f32_16x16x32_bf16 v[116:119], a[92:95], v[84:87], v[116:119]
    buffer_load_dwordx4 v10, s[24:27], s46 offen offset:384 lds
    s_add_u32 m0, m0, 3968
    v_mfma_f32_16x16x32_bf16 v[120:123], a[92:95], v[88:91], v[120:123]
    s_waitcnt lgkmcnt(2)
    s_xor_b32 s51, s50, 2
    v_mfma_f32_16x16x32_bf16 v[108:111], a[16:19], v[92:95], v[108:111]
    ds_read_b128 v[84:87], v11 offset:12288
    s_mul_i32 s51, s51, 114688
    v_mfma_f32_16x16x32_bf16 v[112:115], a[16:19], v[96:99], v[112:115]
    ds_read_b128 v[88:91], v11 offset:14336
    s_add_u32 s42, s38, s51
    v_mfma_f32_16x16x32_bf16 v[116:119], a[96:99], v[92:95], v[116:119]
    buffer_load_dwordx4 v10, s[24:27], s46 offen offset:512 lds
    s_add_u32 m0, m0, 3968
    v_mfma_f32_16x16x32_bf16 v[120:123], a[96:99], v[96:99], v[120:123]
    s_waitcnt lgkmcnt(2)
    v_mfma_f32_16x16x32_bf16 v[108:111], a[20:23], v[100:103], v[108:111]
    ds_read_b128 v[92:95], v12 offset:12288
    v_mfma_f32_16x16x32_bf16 v[112:115], a[20:23], v[104:107], v[112:115]
    ds_read_b128 v[96:99], v12 offset:14336
    v_mfma_f32_16x16x32_bf16 v[116:119], a[100:103], v[100:103], v[116:119]
    buffer_load_dwordx4 v10, s[24:27], s46 offen offset:640 lds
    s_add_u32 m0, m0, 3968
    v_mfma_f32_16x16x32_bf16 v[120:123], a[100:103], v[104:107], v[120:123]
    s_waitcnt lgkmcnt(2)
    v_mfma_f32_16x16x32_bf16 v[108:111], a[24:27], v[84:87], v[108:111]
    ds_read_b128 v[100:103], v11 offset:16384
    v_mfma_f32_16x16x32_bf16 v[112:115], a[24:27], v[88:91], v[112:115]
    ds_read_b128 v[104:107], v11 offset:18432
    v_mfma_f32_16x16x32_bf16 v[116:119], a[104:107], v[84:87], v[116:119]
    buffer_load_dwordx4 v10, s[24:27], s46 offen offset:768 lds
    s_add_u32 m0, m0, 3968
    v_mfma_f32_16x16x32_bf16 v[120:123], a[104:107], v[88:91], v[120:123]
    s_waitcnt lgkmcnt(2)
    v_mfma_f32_16x16x32_bf16 v[108:111], a[28:31], v[92:95], v[108:111]
    ds_read_b128 v[84:87], v12 offset:16384
    v_mfma_f32_16x16x32_bf16 v[112:115], a[28:31], v[96:99], v[112:115]
    ds_read_b128 v[88:91], v12 offset:18432
    v_mfma_f32_16x16x32_bf16 v[116:119], a[108:111], v[92:95], v[116:119]
    buffer_load_dwordx4 v10, s[24:27], s46 offen offset:896 lds
    s_add_u32 m0, m0, 3968
    v_mfma_f32_16x16x32_bf16 v[120:123], a[108:111], v[96:99], v[120:123]
    s_waitcnt lgkmcnt(2)
    v_mfma_f32_16x16x32_bf16 v[108:111], a[32:35], v[100:103], v[108:111]
    ds_read_b128 v[92:95], v11 offset:20480
    v_mfma_f32_16x16x32_bf16 v[112:115], a[32:35], v[104:107], v[112:115]
    ds_read_b128 v[96:99], v11 offset:22528
    v_mfma_f32_16x16x32_bf16 v[116:119], a[112:115], v[100:103], v[116:119]
    buffer_load_dwordx4 v10, s[24:27], s46 offen offset:1024 lds
    s_add_u32 m0, m0, 3968
    v_mfma_f32_16x16x32_bf16 v[120:123], a[112:115], v[104:107], v[120:123]
    s_waitcnt lgkmcnt(2)
    v_mfma_f32_16x16x32_bf16 v[108:111], a[36:39], v[84:87], v[108:111]
    ds_read_b128 v[100:103], v12 offset:20480
    v_mfma_f32_16x16x32_bf16 v[112:115], a[36:39], v[88:91], v[112:115]
    ds_read_b128 v[104:107], v12 offset:22528
    v_mfma_f32_16x16x32_bf16 v[116:119], a[116:119], v[84:87], v[116:119]
    buffer_load_dwordx4 v10, s[24:27], s46 offen offset:1152 lds
    v_mfma_f32_16x16x32_bf16 v[120:123], a[116:119], v[88:91], v[120:123]
    s_waitcnt lgkmcnt(2)
    v_mfma_f32_16x16x32_bf16 v[108:111], a[40:43], v[92:95], v[108:111]
    ds_read_b128 v[84:87], v11 offset:24576
    v_mfma_f32_16x16x32_bf16 v[112:115], a[40:43], v[96:99], v[112:115]
    ds_read_b128 v[88:91], v11 offset:26624
    v_mfma_f32_16x16x32_bf16 v[116:119], a[120:123], v[92:95], v[116:119]
    v_mfma_f32_16x16x32_bf16 v[120:123], a[120:123], v[96:99], v[120:123]
    s_waitcnt lgkmcnt(2)
    v_mfma_f32_16x16x32_bf16 v[108:111], a[44:47], v[100:103], v[108:111]
    ds_read_b128 v[92:95], v12 offset:24576
    v_mfma_f32_16x16x32_bf16 v[112:115], a[44:47], v[104:107], v[112:115]
    ds_read_b128 v[96:99], v12 offset:26624
    v_mfma_f32_16x16x32_bf16 v[116:119], a[124:127], v[100:103], v[116:119]
    v_mfma_f32_16x16x32_bf16 v[120:123], a[124:127], v[104:107], v[120:123]
    s_waitcnt lgkmcnt(2)
    v_mfma_f32_16x16x32_bf16 v[108:111], a[48:51], v[84:87], v[108:111]
    ds_read_b128 v[100:103], v11 offset:28672
    v_mfma_f32_16x16x32_bf16 v[112:115], a[48:51], v[88:91], v[112:115]
    ds_read_b128 v[104:107], v11 offset:30720
    v_mfma_f32_16x16x32_bf16 v[116:119], a[128:131], v[84:87], v[116:119]
    v_mfma_f32_16x16x32_bf16 v[120:123], a[128:131], v[88:91], v[120:123]
    s_waitcnt lgkmcnt(2)
    v_mfma_f32_16x16x32_bf16 v[108:111], a[52:55], v[92:95], v[108:111]
    ds_read_b128 v[84:87], v12 offset:28672
    v_mfma_f32_16x16x32_bf16 v[112:115], a[52:55], v[96:99], v[112:115]
    ds_read_b128 v[88:91], v12 offset:30720
    v_mfma_f32_16x16x32_bf16 v[116:119], a[132:135], v[92:95], v[116:119]
    v_mfma_f32_16x16x32_bf16 v[120:123], a[132:135], v[96:99], v[120:123]
    s_waitcnt lgkmcnt(2)
    v_mfma_f32_16x16x32_bf16 v[108:111], a[56:59], v[100:103], v[108:111]
    ds_read_b128 v[92:95], v11 offset:32768
    v_mfma_f32_16x16x32_bf16 v[112:115], a[56:59], v[104:107], v[112:115]
    ds_read_b128 v[96:99], v11 offset:34816
    v_mfma_f32_16x16x32_bf16 v[116:119], a[136:139], v[100:103], v[116:119]
    v_mfma_f32_16x16x32_bf16 v[120:123], a[136:139], v[104:107], v[120:123]
    s_waitcnt lgkmcnt(2)
    v_mfma_f32_16x16x32_bf16 v[108:111], a[60:63], v[84:87], v[108:111]
    ds_read_b128 v[100:103], v12 offset:32768
    v_mfma_f32_16x16x32_bf16 v[112:115], a[60:63], v[88:91], v[112:115]
    ds_read_b128 v[104:107], v12 offset:34816
    v_mfma_f32_16x16x32_bf16 v[116:119], a[140:143], v[84:87], v[116:119]
    v_mfma_f32_16x16x32_bf16 v[120:123], a[140:143], v[88:91], v[120:123]
    s_waitcnt lgkmcnt(2)
    v_mfma_f32_16x16x32_bf16 v[108:111], a[64:67], v[92:95], v[108:111]
    ds_read_b128 v[84:87], v11 offset:36864
    v_mfma_f32_16x16x32_bf16 v[112:115], a[64:67], v[96:99], v[112:115]
    ds_read_b128 v[88:91], v11 offset:38912
    v_mfma_f32_16x16x32_bf16 v[116:119], a[144:147], v[92:95], v[116:119]
    v_mfma_f32_16x16x32_bf16 v[120:123], a[144:147], v[96:99], v[120:123]
    s_waitcnt lgkmcnt(2)
    v_mfma_f32_16x16x32_bf16 v[108:111], a[68:71], v[100:103], v[108:111]
    ds_read_b128 v[92:95], v12 offset:36864
    v_mfma_f32_16x16x32_bf16 v[112:115], a[68:71], v[104:107], v[112:115]
    ds_read_b128 v[96:99], v12 offset:38912
    v_mfma_f32_16x16x32_bf16 v[116:119], a[148:151], v[100:103], v[116:119]
    v_mfma_f32_16x16x32_bf16 v[120:123], a[148:151], v[104:107], v[120:123]
    s_waitcnt lgkmcnt(0)
    v_mfma_f32_16x16x32_bf16 v[108:111], a[72:75], v[84:87], v[108:111]
    v_add_u32 v11, s49, v11
    v_mfma_f32_16x16x32_bf16 v[112:115], a[72:75], v[88:91], v[112:115]
    v_add_u32 v12, s49, v12
    v_mfma_f32_16x16x32_bf16 v[108:111], a[76:79], v[92:95], v[108:111]
    s_sub_u32 s47, s47, s49
    v_mfma_f32_16x16x32_bf16 v[112:115], a[76:79], v[96:99], v[112:115]
    s_sub_u32 s49, 0, s49
    v_mfma_f32_16x16x32_bf16 v[116:119], a[152:155], v[84:87], v[116:119]
    v_mfma_f32_16x16x32_bf16 v[120:123], a[152:155], v[88:91], v[120:123]
    v_mfma_f32_16x16x32_bf16 v[116:119], a[156:159], v[92:95], v[116:119]
    v_mfma_f32_16x16x32_bf16 v[120:123], a[156:159], v[96:99], v[120:123]
    v_cvt_pk_bf16_f32 v124, v108, v109
    v_cvt_pk_bf16_f32 v125, v110, v111
    v_cvt_pk_bf16_f32 v126, v112, v113
    v_cvt_pk_bf16_f32 v127, v114, v115
    s_nop 0
    v_permlane16_swap_b32 v124, v126
    v_permlane16_swap_b32 v125, v127
    v_cvt_pk_bf16_f32 v128, v116, v117
    v_cvt_pk_bf16_f32 v129, v118, v119
    v_cvt_pk_bf16_f32 v130, v120, v121
    v_cvt_pk_bf16_f32 v131, v122, v123
    s_nop 0
    v_permlane16_swap_b32 v128, v130
    v_permlane16_swap_b32 v129, v131
    buffer_store_dwordx4 v[124:127], v19, s[4:7], s44 offen
    buffer_store_dwordx4 v[128:131], v19, s[4:7], s45 offen
    v_mov_b32 v3, 200
L_p0_16:
    buffer_load_dword v4, v3, s[8:11], 0 offen sc1
    s_sub_u32 s36, s36, 1
    s_cbranch_scc1 L_exit
    s_waitcnt vmcnt(0)
    v_readfirstlane_b32 s90, v4
    s_nop 0
    s_cmp_eq_u32 s90, 0
    s_cbranch_scc1 L_p0_16
    s_and_b32 s90, s90, 2
    s_lshl_b32 s90, s90, 12
    v_and_b32 v3, 1, v0
    v_lshlrev_b32 v3, 12, v3
    v_bfe_u32 v5, v0, 2, 1
    v_lshl_add_u32 v3, v5, 13, v3
    v_bfe_u32 v4, v0, 1, 1
    v_lshl_add_u32 v3, v4, 14, v3
    v_xor_b32 v3, s90, v3
    s_lshl_b32 s91, s34, 9
    s_add_u32 s91, s91, 1933312
    s_xor_b32 s55, s32, 3
    s_or_b32 s55, s55, s40
    s_cselect_b32 s91, 2146435072, s91
    v_add_u32 v140, s91, v3
    v_cmp_gt_u32 vcc, 8, v0
    v_mov_b32 v9, 2146435072
    s_nop 0
    v_cndmask_b32 v140, v9, v140, vcc
    v_cmp_ne_u32 vcc, s34, v0
    v_mov_b32 v9, 2146435072
    s_nop 0
    v_cndmask_b32 v140, v9, v140, vcc
    s_lshr_b32 s91, s34, 2
    v_cmp_eq_u32 vcc, s91, v5
    s_nop 1
    v_cndmask_b32 v141, v9, v140, vcc
    v_cndmask_b32 v140, v140, v9, vcc
    v_and_b32 v3, 7, v0
    v_min_u32 v3, 5, v3
    v_bfe_u32 v4, v0, 3, 2
    v_lshlrev_b32 v4, 7, v4
    v_lshl_add_u32 v3, v3, 2, v4
    v_add_u32 v142, 462336, v3
L_v_loop_f:
    s_add_u32 s50, s37, 4
    s_min_u32 s50, s50, 63
    s_mul_i32 s46, s50, 40960
    s_add_u32 s51, s37, 1
    v_mov_b32 v20, s51
    s_mov_b32 m0, s48
    v_mov_b32 v68, 0
    v_mov_b32 v69, 0
    v_mov_b32 v70, 0
    v_mov_b32 v71, 0
    v_mov_b32 v72, 0
    v_mov_b32 v73, 0
    v_mov_b32 v74, 0
    v_mov_b32 v75, 0
    s_add_u32 s50, s37, 6
    s_min_u32 s50, s50, 63
    s_mul_i32 s57, s50, 40960
    buffer_load_dwordx4 v13, s[4:7], s41 offen sc1 lds
    buffer_load_dwordx4 v13, s[4:7], s41 offen offset:1024 sc1 lds
    buffer_load_dword v14, s[4:7], s41 offen offset:2048 sc1 lds
    buffer_load_dword v14, s[4:7], s41 offen offset:2304 sc1 lds
L_poll_18:
    buffer_load_dwordx4 v13, s[4:7], s41 offen sc1 lds
    buffer_load_dwordx4 v13, s[4:7], s41 offen offset:1024 sc1 lds
    buffer_load_dword v14, s[4:7], s41 offen offset:2048 sc1 lds
    buffer_load_dword v14, s[4:7], s41 offen offset:2304 sc1 lds
    s_sub_u32 s36, s36, 1
    s_cbranch_scc1 L_exit
    s_waitcnt vmcnt(4)
    ds_read_b32 v18, v15
    s_waitcnt lgkmcnt(0)
    v_cmp_eq_u32 vcc, -1, v18
    s_cbranch_vccnz L_poll_18
    s_barrier
    ds_read_b128 v[28:31], v16 offset:0
    ds_read_b128 v[32:35], v16 offset:1024
    ds_read_b128 v[36:39], v16 offset:2048
    s_waitcnt lgkmcnt(2)
    v_smfmac_f32_16x16x64_bf16 v[68:71], v[28:31], a[0:7], v17
    ds_read_b128 v[40:43], v16 offset:3072
    v_smfmac_f32_16x16x64_bf16 v[72:75], v[28:31], a[80:87], v17
    ds_read_b128 v[44:47], v16 offset:4096
    s_waitcnt lgkmcnt(3)
    v_smfmac_f32_16x16x64_bf16 v[68:71], v[32:35], a[8:15], v17
    ds_read_b128 v[48:51], v16 offset:5120
    v_smfmac_f32_16x16x64_bf16 v[72:75], v[32:35], a[88:95], v17
    ds_read_b128 v[52:55], v16 offset:6144
    s_waitcnt lgkmcnt(4)
    v_smfmac_f32_16x16x64_bf16 v[68:71], v[36:39], a[16:23], v17
    ds_read_b128 v[56:59], v16 offset:7168
    v_smfmac_f32_16x16x64_bf16 v[72:75], v[36:39], a[96:103], v17
    ds_read_b128 v[60:63], v16 offset:8192
    s_waitcnt lgkmcnt(5)
    v_smfmac_f32_16x16x64_bf16 v[68:71], v[40:43], a[24:31], v17
    ds_read_b128 v[64:67], v16 offset:9216
    v_smfmac_f32_16x16x64_bf16 v[72:75], v[40:43], a[104:111], v17
    s_waitcnt lgkmcnt(5)
    v_smfmac_f32_16x16x64_bf16 v[68:71], v[44:47], a[32:39], v17
    v_smfmac_f32_16x16x64_bf16 v[72:75], v[44:47], a[112:119], v17
    s_waitcnt lgkmcnt(4)
    v_smfmac_f32_16x16x64_bf16 v[68:71], v[48:51], a[40:47], v17
    v_smfmac_f32_16x16x64_bf16 v[72:75], v[48:51], a[120:127], v17
    s_waitcnt lgkmcnt(3)
    v_smfmac_f32_16x16x64_bf16 v[68:71], v[52:55], a[48:55], v17
    s_waitcnt lgkmcnt(2)
    v_smfmac_f32_16x16x64_bf16 v[68:71], v[56:59], a[56:63], v17
    s_waitcnt lgkmcnt(1)
    v_smfmac_f32_16x16x64_bf16 v[68:71], v[60:63], a[64:71], v17
    s_waitcnt lgkmcnt(0)
    v_smfmac_f32_16x16x64_bf16 v[68:71], v[64:67], a[72:79], v17
L_redo_17:
    v_smfmac_f32_16x16x64_bf16 v[72:75], v[52:55], a[128:135], v17
    v_smfmac_f32_16x16x64_bf16 v[72:75], v[56:59], a[136:143], v17
    v_smfmac_f32_16x16x64_bf16 v[72:75], v[60:63], a[144:151], v17
    v_add_f32 v68, v68, v70
    v_add_f32 v69, v69, v71
    v_smfmac_f32_16x16x64_bf16 v[72:75], v[64:67], a[152:159], v17
    v_cmp_u_f32 vcc, v68, v69
    v_cvt_pk_bf16_f32 v132, v68, v69
    s_cbranch_vccnz L_nan_19
L_cont_20:
    s_nop 4
    v_pk_add_f32 v[72:73], v[72:73], v[74:75]
    v_cvt_pk_bf16_f32 v133, v72, v73
    ds_write2st64_b32 v23, v132, v133 offset0:0 offset1:1
    ds_read_b64_tr_b16 v[76:77], v24
    ds_read_b64_tr_b16 v[78:79], v24 offset:128
    buffer_store_dword v20, v21, s[4:7], s38 offen
    s_waitcnt lgkmcnt(0)
    buffer_store_dwordx4 v[76:79], v134, s[4:7], s41 offen
    ds_read_b128 v[84:87], v11 offset:0
    ds_read_b128 v[88:91], v11 offset:2048
    ds_read_b128 v[92:95], v12 offset:0
    ds_read_b128 v[96:99], v12 offset:2048
    s_cmp_eq_u32 s37, 63
    s_cbranch_scc1 L_end_21
    s_cmp_lg_u32 s55, 0
    s_cbranch_scc1 L_an_22x
    buffer_load_dword v139, v142, s[4:7], s38 offen sc1
    buffer_load_dword v139, v142, s[4:7], s38 offen sc1
    buffer_load_dword v139, v142, s[4:7], s38 offen sc1
L_an_22:
    buffer_load_dword v139, v142, s[4:7], s38 offen sc1
    s_sub_u32 s36, s36, 1
    s_cbranch_scc1 L_exit
    s_waitcnt vmcnt(3)
    v_cmp_ge_u32 vcc, s37, v139
    s_cbranch_vccnz L_an_22
L_an_22x:
    s_barrier
    s_lshl_b32 s90, s32, 10
    s_add_u32 m0, s90, s47
    s_waitcnt lgkmcnt(2)
    v_mfma_f32_16x16x32_bf16 v[108:111], a[0:3], v[84:87], 0
    ds_read_b128 v[100:103], v11 offset:4096
    v_mfma_f32_16x16x32_bf16 v[112:115], a[0:3], v[88:91], 0
    ds_read_b128 v[104:107], v11 offset:6144
    v_mfma_f32_16x16x32_bf16 v[116:119], a[80:83], v[84:87], 0
    v_mfma_f32_16x16x32_bf16 v[120:123], a[80:83], v[88:91], 0
    s_waitcnt lgkmcnt(2)
    v_mfma_f32_16x16x32_bf16 v[108:111], a[4:7], v[92:95], v[108:111]
    ds_read_b128 v[84:87], v12 offset:4096
    v_mfma_f32_16x16x32_bf16 v[112:115], a[4:7], v[96:99], v[112:115]
    ds_read_b128 v[88:91], v12 offset:6144
    v_mfma_f32_16x16x32_bf16 v[116:119], a[84:87], v[92:95], v[116:119]
    buffer_store_dword v22, v135, s[4:7], s42 offen offset:0
    buffer_store_dword v22, v135, s[4:7], s42 offen offset:1024
    v_mfma_f32_16x16x32_bf16 v[120:123], a[84:87], v[96:99], v[120:123]
    s_waitcnt lgkmcnt(2)
    s_add_u32 s51, s37, 3
    v_mfma_f32_16x16x32_bf16 v[108:111], a[8:11], v[100:103], v[108:111]
    ds_read_b128 v[92:95], v11 offset:8192
    s_and_b32 s50, s51, 3
    v_mfma_f32_16x16x32_bf16 v[112:115], a[8:11], v[104:107], v[112:115]
    ds_read_b128 v[96:99], v11 offset:10240
    s_mul_i32 s50, s50, 114688
    v_mfma_f32_16x16x32_bf16 v[116:119], a[88:91], v[100:103], v[116:119]
    buffer_load_dwordx4 v[248:251], v137, s[24:27], s57 offen offset:0
    v_mfma_f32_16x16x32_bf16 v[120:123], a[88:91], v[104:107], v[120:123]
    s_waitcnt lgkmcnt(2)
    s_add_u32 s50, s50, 65536
    v_mfma_f32_16x16x32_bf16 v[108:111], a[12:15], v[84:87], v[108:111]
    ds_read_b128 v[100:103], v12 offset:8192
    s_add_u32 s44, s38, s50
    v_mfma_f32_16x16x32_bf16 v[112:115], a[12:15], v[88:91], v[112:115]
    ds_read_b128 v[104:107], v12 offset:10240
    s_add_u32 s45, s44, s56
    v_mfma_f32_16x16x32_bf16 v[116:119], a[92:95], v[84:87], v[116:119]
    buffer_load_dwordx4 v[248:251], v137, s[24:27], s57 offen offset:1024
    v_mfma_f32_16x16x32_bf16 v[120:123], a[92:95], v[88:91], v[120:123]
    s_waitcnt lgkmcnt(2)
    s_add_u32 s37, s37, 1
    v_mfma_f32_16x16x32_bf16 v[108:111], a[16:19], v[92:95], v[108:111]
    ds_read_b128 v[84:87], v11 offset:12288
    s_mov_b32 s52, 0
    v_mfma_f32_16x16x32_bf16 v[112:115], a[16:19], v[96:99], v[112:115]
    ds_read_b128 v[88:91], v11 offset:14336
    s_and_b32 s50, s37, 3
    v_mfma_f32_16x16x32_bf16 v[116:119], a[96:99], v[92:95], v[116:119]
    buffer_load_dwordx4 v10, s[24:27], s46 offen offset:0 lds
    s_add_u32 m0, m0, 3968
    v_mfma_f32_16x16x32_bf16 v[120:123], a[96:99], v[96:99], v[120:123]
    s_waitcnt lgkmcnt(2)
    s_mul_i32 s51, s50, 114688
    v_mfma_f32_16x16x32_bf16 v[108:111], a[20:23], v[100:103], v[108:111]
    ds_read_b128 v[92:95], v12 offset:12288
    s_add_u32 s41, s38, s51
    v_mfma_f32_16x16x32_bf16 v[112:115], a[20:23], v[104:107], v[112:115]
    ds_read_b128 v[96:99], v12 offset:14336
    s_xor_b32 s51, s50, 2
    v_mfma_f32_16x16x32_bf16 v[116:119], a[100:103], v[100:103], v[116:119]
    buffer_load_dwordx4 v10, s[24:27], s46 offen offset:128 lds
    s_add_u32 m0, m0, 3968
    v_mfma_f32_16x16x32_bf16 v[120:123], a[100:103], v[104:107], v[120:123]
    s_waitcnt lgkmcnt(2)
    s_mul_i32 s51, s51, 114688
    v_mfma_f32_16x16x32_bf16 v[108:111], a[24:27], v[84:87], v[108:111]
    ds_read_b128 v[100:103], v11 offset:16384
    s_add_u32 s42, s38, s51
    v_mfma_f32_16x16x32_bf16 v[112:115], a[24:27], v[88:91], v[112:115]
    ds_read_b128 v[104:107], v11 offset:18432
    v_mfma_f32_16x16x32_bf16 v[116:119], a[104:107], v[84:87], v[116:119]
    buffer_load_dwordx4 v10, s[24:27], s46 offen offset:256 lds
    s_add_u32 m0, m0, 3968
    v_mfma_f32_16x16x32_bf16 v[120:123], a[104:107], v[88:91], v[120:123]
    s_waitcnt lgkmcnt(2)
    v_mfma_f32_16x16x32_bf16 v[108:111], a[28:31], v[92:95], v[108:111]
    ds_read_b128 v[84:87], v12 offset:16384
    v_mfma_f32_16x16x32_bf16 v[112:115], a[28:31], v[96:99], v[112:115]
    ds_read_b128 v[88:91], v12 offset:18432
    v_mfma_f32_16x16x32_bf16 v[116:119], a[108:111], v[92:95], v[116:119]
    buffer_load_dwordx4 v10, s[24:27], s46 offen offset:384 lds
    s_add_u32 m0, m0, 3968
    v_mfma_f32_16x16x32_bf16 v[120:123], a[108:111], v[96:99], v[120:123]
    s_waitcnt lgkmcnt(2)
    v_mfma_f32_16x16x32_bf16 v[108:111], a[32:35], v[100:103], v[108:111]
    ds_read_b128 v[92:95], v11 offset:20480
    v_mfma_f32_16x16x32_bf16 v[112:115], a[32:35], v[104:107], v[112:115]
    ds_read_b128 v[96:99], v11 offset:22528
    v_mfma_f32_16x16x32_bf16 v[116:119], a[112:115], v[100:103], v[116:119]
    buffer_load_dwordx4 v10, s[24:27], s46 offen offset:512 lds
    s_add_u32 m0, m0, 3968
    v_mfma_f32_16x16x32_bf16 v[120:123], a[112:115], v[104:107], v[120:123]
    buffer_store_dword v20, v140, s[4:7], 0 offen sc1
    buffer_store_dword v20, v141, s[4:7], 0 offen sc1
    s_waitcnt lgkmcnt(2)
    v_mfma_f32_16x16x32_bf16 v[108:111], a[36:39], v[84:87], v[108:111]
    ds_read_b128 v[100:103], v12 offset:20480
    v_mfma_f32_16x16x32_bf16 v[112:115], a[36:39], v[88:91], v[112:115]
    ds_read_b128 v[104:107], v12 offset:22528
    v_mfma_f32_16x16x32_bf16 v[116:119], a[116:119], v[84:87], v[116:119]
    buffer_load_dwordx4 v10, s[24:27], s46 offen offset:640 lds
    s_add_u32 m0, m0, 3968
    v_mfma_f32_16x16x32_bf16 v[120:123], a[116:119], v[88:91], v[120:123]
    s_waitcnt lgkmcnt(2)
    v_mfma_f32_16x16x32_bf16 v[108:111], a[40:43], v[92:95], v[108:111]
    ds_read_b128 v[84:87], v11 offset:24576
    v_mfma_f32_16x16x32_bf16 v[112:115], a[40:43], v[96:99], v[112:115]
    ds_read_b128 v[88:91], v11 offset:26624
    v_mfma_f32_16x16x32_bf16 v[116:119], a[120:123], v[92:95], v[116:119]
    buffer_load_dwordx4 v10, s[24:27], s46 offen offset:768 lds
    s_add_u32 m0, m0, 3968
    v_mfma_f32_16x16x32_bf16 v[120:123], a[120:123], v[96:99], v[120:123]
    s_waitcnt lgkmcnt(2)
    v_mfma_f32_16x16x32_bf16 v[108:111], a[44:47], v[100:103], v[108:111]
    ds_read_b128 v[92:95], v12 offset:24576
    v_mfma_f32_16x16x32_bf16 v[112:115], a[44:47], v[104:107], v[112:115]
    ds_read_b128 v[96:99], v12 offset:26624
    v_mfma_f32_16x16x32_bf16 v[116:119], a[124:127], v[100:103], v[116:119]
    buffer_load_dwordx4 v10, s[24:27], s46 offen offset:896 lds
    s_add_u32 m0, m0, 3968
    v_mfma_f32_16x16x32_bf16 v[120:123], a[124:127], v[104:107], v[120:123]
    s_waitcnt lgkmcnt(2)
    v_mfma_f32_16x16x32_bf16 v[108:111], a[48:51], v[84:87], v[108:111]
    ds_read_b128 v[100:103], v11 offset:28672
    v_mfma_f32_16x16x32_bf16 v[112:115], a[48:51], v[88:91], v[112:115]
    ds_read_b128 v[104:107], v11 offset:30720
    v_mfma_f32_16x16x32_bf16 v[116:119], a[128:131], v[84:87], v[116:119]
    buffer_load_dwordx4 v10, s[24:27], s46 offen offset:1024 lds
    s_add_u32 m0, m0, 3968
    v_mfma_f32_16x16x32_bf16 v[120:123], a[128:131], v[88:91], v[120:123]
    s_waitcnt lgkmcnt(2)
    v_mfma_f32_16x16x32_bf16 v[108:111], a[52:55], v[92:95], v[108:111]
    ds_read_b128 v[84:87], v12 offset:28672
    v_mfma_f32_16x16x32_bf16 v[112:115], a[52:55], v[96:99], v[112:115]
    ds_read_b128 v[88:91], v12 offset:30720
    v_mfma_f32_16x16x32_bf16 v[116:119], a[132:135], v[92:95], v[116:119]
    buffer_load_dwordx4 v10, s[24:27], s46 offen offset:1152 lds
    v_mfma_f32_16x16x32_bf16 v[120:123], a[132:135], v[96:99], v[120:123]
    s_waitcnt lgkmcnt(2)
    v_mfma_f32_16x16x32_bf16 v[108:111], a[56:59], v[100:103], v[108:111]
    ds_read_b128 v[92:95], v11 offset:32768
    v_mfma_f32_16x16x32_bf16 v[112:115], a[56:59], v[104:107], v[112:115]
    ds_read_b128 v[96:99], v11 offset:34816
    v_mfma_f32_16x16x32_bf16 v[116:119], a[136:139], v[100:103], v[116:119]
    v_mfma_f32_16x16x32_bf16 v[120:123], a[136:139], v[104:107], v[120:123]
    s_waitcnt lgkmcnt(2)
    v_mfma_f32_16x16x32_bf16 v[108:111], a[60:63], v[84:87], v[108:111]
    ds_read_b128 v[100:103], v12 offset:32768
    v_mfma_f32_16x16x32_bf16 v[112:115], a[60:63], v[88:91], v[112:115]
    ds_read_b128 v[104:107], v12 offset:34816
    v_mfma_f32_16x16x32_bf16 v[116:119], a[140:143], v[84:87], v[116:119]
    v_mfma_f32_16x16x32_bf16 v[120:123], a[140:143], v[88:91], v[120:123]
    s_waitcnt lgkmcnt(2)
    v_mfma_f32_16x16x32_bf16 v[108:111], a[64:67], v[92:95], v[108:111]
    ds_read_b128 v[84:87], v11 offset:36864
    v_mfma_f32_16x16x32_bf16 v[112:115], a[64:67], v[96:99], v[112:115]
    ds_read_b128 v[88:91], v11 offset:38912
    v_mfma_f32_16x16x32_bf16 v[116:119], a[144:147], v[92:95], v[116:119]
    v_mfma_f32_16x16x32_bf16 v[120:123], a[144:147], v[96:99], v[120:123]
    s_waitcnt lgkmcnt(2)
    v_mfma_f32_16x16x32_bf16 v[108:111], a[68:71], v[100:103], v[108:111]
    ds_read_b128 v[92:95], v12 offset:36864
    v_mfma_f32_16x16x32_bf16 v[112:115], a[68:71], v[104:107], v[112:115]
    ds_read_b128 v[96:99], v12 offset:38912
    v_mfma_f32_16x16x32_bf16 v[116:119], a[148:151], v[100:103], v[116:119]
    v_mfma_f32_16x16x32_bf16 v[120:123], a[148:151], v[104:107], v[120:123]
    s_waitcnt lgkmcnt(0)
    v_mfma_f32_16x16x32_bf16 v[108:111], a[72:75], v[84:87], v[108:111]
    v_add_u32 v11, s49, v11
    v_mfma_f32_16x16x32_bf16 v[112:115], a[72:75], v[88:91], v[112:115]
    v_add_u32 v12, s49, v12
    v_mfma_f32_16x16x32_bf16 v[108:111], a[76:79], v[92:95], v[108:111]
    s_sub_u32 s47, s47, s49
    v_mfma_f32_16x16x32_bf16 v[112:115], a[76:79], v[96:99], v[112:115]
    s_sub_u32 s49, 0, s49
    v_mfma_f32_16x16x32_bf16 v[116:119], a[152:155], v[84:87], v[116:119]
    v_mfma_f32_16x16x32_bf16 v[120:123], a[152:155], v[88:91], v[120:123]
    v_mfma_f32_16x16x32_bf16 v[116:119], a[156:159], v[92:95], v[116:119]
    v_mfma_f32_16x16x32_bf16 v[120:123], a[156:159], v[96:99], v[120:123]
    v_cvt_pk_bf16_f32 v124, v108, v109
    v_cvt_pk_bf16_f32 v125, v110, v111
    v_cvt_pk_bf16_f32 v126, v112, v113
    v_cvt_pk_bf16_f32 v127, v114, v115
    s_nop 0
    v_permlane16_swap_b32 v124, v126
    v_permlane16_swap_b32 v125, v127
    v_cvt_pk_bf16_f32 v128, v116, v117
    v_cvt_pk_bf16_f32 v129, v118, v119
    v_cvt_pk_bf16_f32 v130, v120, v121
    v_cvt_pk_bf16_f32 v131, v122, v123
    s_nop 0
    v_permlane16_swap_b32 v128, v130
    v_permlane16_swap_b32 v129, v131
    buffer_store_dwordx4 v[124:127], v19, s[4:7], s44 offen
    buffer_store_dwordx4 v[128:131], v19, s[4:7], s45 offen
    s_branch L_v_loop_f
L_end_21:
    s_waitcnt vmcnt(0) lgkmcnt(0)
    s_endpgm
L_nan_19:
    s_cmp_eq_u32 s52, 1
    s_cbranch_scc1 L_cont_20
    v_lshlrev_b32 v1, 4, v0
L_nan_19r:
    s_mov_b32 s90, s41
    v_mov_b32 v2, 0
    buffer_load_dwordx4 v[28:31], v1, s[4:7], s90 offen sc1
    s_add_u32 s90, s90, 1024
    buffer_load_dwordx4 v[32:35], v1, s[4:7], s90 offen sc1
    s_add_u32 s90, s90, 1024
    buffer_load_dwordx4 v[36:39], v1, s[4:7], s90 offen sc1
    s_add_u32 s90, s90, 1024
    buffer_load_dwordx4 v[40:43], v1, s[4:7], s90 offen sc1
    s_add_u32 s90, s90, 1024
    buffer_load_dwordx4 v[44:47], v1, s[4:7], s90 offen sc1
    s_add_u32 s90, s90, 1024
    buffer_load_dwordx4 v[48:51], v1, s[4:7], s90 offen sc1
    s_add_u32 s90, s90, 1024
    buffer_load_dwordx4 v[52:55], v1, s[4:7], s90 offen sc1
    s_add_u32 s90, s90, 1024
    buffer_load_dwordx4 v[56:59], v1, s[4:7], s90 offen sc1
    s_add_u32 s90, s90, 1024
    buffer_load_dwordx4 v[60:63], v1, s[4:7], s90 offen sc1
    s_add_u32 s90, s90, 1024
    buffer_load_dwordx4 v[64:67], v1, s[4:7], s90 offen sc1
    s_add_u32 s90, s90, 1024
    s_sub_u32 s36, s36, 1
    s_cbranch_scc1 L_exit
    s_waitcnt vmcnt(0) lgkmcnt(0)
    v_max3_u32 v2, v2, v28, v29
    v_max3_u32 v2, v2, v30, v31
    v_max3_u32 v2, v2, v32, v33
    v_max3_u32 v2, v2, v34, v35
    v_max3_u32 v2, v2, v36, v37
    v_max3_u32 v2, v2, v38, v39
    v_max3_u32 v2, v2, v40, v41
    v_max3_u32 v2, v2, v42, v43
    v_max3_u32 v2, v2, v44, v45
    v_max3_u32 v2, v2, v46, v47
    v_max3_u32 v2, v2, v48, v49
    v_max3_u32 v2, v2, v50, v51
    v_max3_u32 v2, v2, v52, v53
    v_max3_u32 v2, v2, v54, v55
    v_max3_u32 v2, v2, v56, v57
    v_max3_u32 v2, v2, v58, v59
    v_max3_u32 v2, v2, v60, v61
    v_max3_u32 v2, v2, v62, v63
    v_max3_u32 v2, v2, v64, v65
    v_max3_u32 v2, v2, v66, v67
    v_cmp_eq_u32 vcc, -1, v2
    s_cbranch_vccnz L_nan_19r
    s_mov_b32 s52, 1
    v_mov_b32 v68, 0
    v_mov_b32 v69, 0
    v_mov_b32 v70, 0
    v_mov_b32 v71, 0
    v_mov_b32 v72, 0
    v_mov_b32 v73, 0
    v_mov_b32 v74, 0
    v_mov_b32 v75, 0
    v_smfmac_f32_16x16x64_bf16 v[68:71], v[28:31], a[0:7], v17
    s_nop 0
    v_smfmac_f32_16x16x64_bf16 v[72:75], v[28:31], a[80:87], v17
    v_smfmac_f32_16x16x64_bf16 v[68:71], v[32:35], a[8:15], v17
    v_smfmac_f32_16x16x64_bf16 v[72:75], v[32:35], a[88:95], v17
    v_smfmac_f32_16x16x64_bf16 v[68:71], v[36:39], a[16:23], v17
    v_smfmac_f32_16x16x64_bf16 v[72:75], v[36:39], a[96:103], v17
    v_smfmac_f32_16x16x64_bf16 v[68:71], v[40:43], a[24:31], v17
    v_smfmac_f32_16x16x64_bf16 v[72:75], v[40:43], a[104:111], v17
    v_smfmac_f32_16x16x64_bf16 v[68:71], v[44:47], a[32:39], v17
    v_smfmac_f32_16x16x64_bf16 v[72:75], v[44:47], a[112:119], v17
    v_smfmac_f32_16x16x64_bf16 v[68:71], v[48:51], a[40:47], v17
    v_smfmac_f32_16x16x64_bf16 v[72:75], v[48:51], a[120:127], v17
    v_smfmac_f32_16x16x64_bf16 v[68:71], v[52:55], a[48:55], v17
    v_smfmac_f32_16x16x64_bf16 v[68:71], v[56:59], a[56:63], v17
    v_smfmac_f32_16x16x64_bf16 v[68:71], v[60:63], a[64:71], v17
    v_smfmac_f32_16x16x64_bf16 v[68:71], v[64:67], a[72:79], v17
    s_nop 3
    s_branch L_redo_17
L_wo_f:
    s_mov_b32 s12, s80
    s_and_b32 s13, s81, 0xffff
    s_mov_b32 s14, 7864320
    s_mov_b32 s15, 0x20000
    s_mov_b32 s16, s72
    s_and_b32 s17, s73, 0xffff
    s_mov_b32 s18, 10240
    s_mov_b32 s19, 0x20000
    s_sub_u32 s40, s35, 18
    v_and_b32 v1, 15, v0
    v_lshrrev_b32 v2, 4, v0
    v_lshrrev_b32 v3, 3, v0
    v_and_b32 v4, 7, v0
    v_and_b32 v6, 2, v3
    v_xor_b32 v6, v6, v4
    v_lshlrev_b32 v6, 4, v6
    v_mul_u32_u24 v7, 1280, v3
    s_lshl_b32 s90, s34, 2
    s_add_u32 s90, s90, s32
    s_mul_i32 s90, s90, 245760
    s_lshl_b32 s91, s40, 7
    s_add_u32 s90, s90, s91
    v_add3_u32 v180, v6, v7, s90
    v_xor_b32 v181, 64, v180
    s_mul_i32 s90, s40, 32768
    s_lshl_b32 s91, s32, 11
    s_add_u32 s90, s90, s91
    s_lshr_b32 s91, s32, 1
    s_mul_i32 s91, s91, 0
    s_xor_b32 s91, s91, s34
    v_mul_u32_u24 v7, 0, v2
    v_xor_b32 v7, s91, v7
    v_lshlrev_b32 v6, 4, v1
    v_lshl_add_u32 v7, v7, 8, v6
    v_lshl_add_u32 v7, v2, 13, v7
    v_add_u32 v14, s90, v7
    v_lshlrev_b32 v12, 4, v0
    v_lshlrev_b32 v13, 2, v0
    v_add_u32 v46, s90, v13
    s_xor_b32 s92, s91, 0
    s_lshl_b32 s92, s92, 8
    s_add_u32 s60, s92, 0
    s_xor_b32 s92, s91, 0
    s_lshl_b32 s92, s92, 8
    s_add_u32 s61, s92, 8192
    s_xor_b32 s92, s91, 0
    s_lshl_b32 s92, s92, 8
    s_add_u32 s62, s92, 16384
    s_xor_b32 s92, s91, 0
    s_lshl_b32 s92, s92, 8
    s_add_u32 s63, s92, 24576
    v_cmp_gt_u32 vcc, 2, v2
    v_mov_b32 v9, 2146435072
    s_nop 0
    v_cndmask_b32 v14, v9, v14, vcc
    s_lshl_b32 s92, s40, 7
    s_lshl_b32 s93, s32, 2
    s_add_u32 s92, s92, s93
    s_add_u32 s92, s92, 460800
    v_mov_b32 v244, s92
    v_cmp_eq_u32 vcc, 0, v0
    v_mov_b32 v9, 2146435072
    s_nop 0
    v_cndmask_b32 v244, v9, v244, vcc
    s_lshl_b32 s92, s32, 7
    s_add_u32 s92, s92, 462336
    v_min_u32 v3, 5, v0
    v_lshl_add_u32 v245, v3, 2, s92
    s_lshl_b32 s90, s40, 2
    s_add_u32 s90, s90, s32
    s_lshl_b32 s91, s90, 8
    v_add_u32 v17, s91, v6
    v_cmp_eq_u32 vcc, 0, v2
    v_mov_b32 v9, 2146435072
    s_nop 0
    v_cndmask_b32 v17, v9, v17, vcc
    v_lshrrev_b32 v3, 2, v1
    v_and_b32 v7, 1, v1
    v_lshl_or_b32 v4, v3, 1, v7
    v_mul_u32_u24 v4, 1280, v4
    v_and_b32 v5, 2, v1
    v_lshl_add_u32 v4, v5, 1, v4
    s_lshl_b32 s91, s90, 5
    v_add_u32 v4, s91, v4
    v_lshlrev_b32 v6, 6, v3
    v_lshl_add_u32 v6, v7, 5, v6
    v_lshl_add_u32 v6, v2, 3, v6
    v_lshl_add_u32 v6, v5, 1, v6
    s_mul_i32 s92, s32, 1152
    s_add_u32 s92, s92, 122880
    v_add_u32 v18, s92, v6
    buffer_load_dword v164, v4, s[16:19], 0 offen offset:0
    buffer_load_dword v165, v4, s[16:19], 0 offen offset:8
    buffer_load_dword v166, v4, s[16:19], 0 offen offset:16
    buffer_load_dword v167, v4, s[16:19], 0 offen offset:24
    v_mov_b32 v168, -1
    v_mov_b32 v169, -1
    v_mov_b32 v170, -1
    v_mov_b32 v171, -1
    s_mul_i32 s90, s32, 24576
    s_mov_b32 m0, s90
    s_mov_b32 s91, 0
    buffer_load_dwordx4 v180, s[12:15], s91 offen nt lds
    s_add_u32 m0, m0, 1024
    s_add_u32 s91, s91, 10240
    buffer_load_dwordx4 v181, s[12:15], s91 offen nt lds
    s_add_u32 m0, m0, 1024
    s_add_u32 s91, s91, 10240
    buffer_load_dwordx4 v180, s[12:15], s91 offen nt lds
    s_add_u32 m0, m0, 1024
    s_add_u32 s91, s91, 10240
    buffer_load_dwordx4 v181, s[12:15], s91 offen nt lds
    s_add_u32 m0, m0, 1024
    s_add_u32 s91, s91, 10240
    buffer_load_dwordx4 v180, s[12:15], s91 offen nt lds
    s_add_u32 m0, m0, 1024
    s_add_u32 s91, s91, 10240
    buffer_load_dwordx4 v181, s[12:15], s91 offen nt lds
    s_add_u32 m0, m0, 1024
    s_add_u32 s91, s91, 10240
    buffer_load_dwordx4 v180, s[12:15], s91 offen nt lds
    s_add_u32 m0, m0, 1024
    s_add_u32 s91, s91, 10240
    buffer_load_dwordx4 v181, s[12:15], s91 offen nt lds
    s_add_u32 m0, m0, 1024
    s_add_u32 s91, s91, 10240
    buffer_load_dwordx4 v180, s[12:15], s91 offen nt lds
    s_add_u32 m0, m0, 1024
    s_add_u32 s91, s91, 10240
    buffer_load_dwordx4 v181, s[12:15], s91 offen nt lds
    s_add_u32 m0, m0, 1024
    s_add_u32 s91, s91, 10240
    buffer_load_dwordx4 v180, s[12:15], s91 offen nt lds
    s_add_u32 m0, m0, 1024
    s_add_u32 s91, s91, 10240
    buffer_load_dwordx4 v181, s[12:15], s91 offen nt lds
    s_add_u32 m0, m0, 1024
    s_add_u32 s91, s91, 10240
    buffer_load_dwordx4 v180, s[12:15], s91 offen nt lds
    s_add_u32 m0, m0, 1024
    s_add_u32 s91, s91, 10240
    buffer_load_dwordx4 v181, s[12:15], s91 offen nt lds
    s_add_u32 m0, m0, 1024
    s_add_u32 s91, s91, 10240
    buffer_load_dwordx4 v180, s[12:15], s91 offen nt lds
    s_add_u32 m0, m0, 1024
    s_add_u32 s91, s91, 10240
    buffer_load_dwordx4 v181, s[12:15], s91 offen nt lds
    s_add_u32 m0, m0, 1024
    s_add_u32 s91, s91, 10240
    buffer_load_dwordx4 v180, s[12:15], s91 offen nt lds
    s_add_u32 m0, m0, 1024
    s_add_u32 s91, s91, 10240
    buffer_load_dwordx4 v181, s[12:15], s91 offen nt lds
    s_add_u32 m0, m0, 1024
    s_add_u32 s91, s91, 10240
    buffer_load_dwordx4 v180, s[12:15], s91 offen nt lds
    s_add_u32 m0, m0, 1024
    s_add_u32 s91, s91, 10240
    buffer_load_dwordx4 v181, s[12:15], s91 offen nt lds
    s_add_u32 m0, m0, 1024
    s_add_u32 s91, s91, 10240
    buffer_load_dwordx4 v180, s[12:15], s91 offen nt lds
    s_add_u32 m0, m0, 1024
    s_add_u32 s91, s91, 10240
    buffer_load_dwordx4 v181, s[12:15], s91 offen nt lds
    s_add_u32 m0, m0, 1024
    s_add_u32 s91, s91, 10240
    buffer_load_dwordx4 v180, s[12:15], s91 offen nt lds
    s_add_u32 m0, m0, 1024
    s_add_u32 s91, s91, 10240
    buffer_load_dwordx4 v181, s[12:15], s91 offen nt lds
    s_waitcnt vmcnt(24)
    v_min_u32 v164, -2, v164
    v_min_u32 v165, -2, v165
    v_min_u32 v166, -2, v166
    v_min_u32 v167, -2, v167
    v_and_b32 v7, 2, v1
    v_cmp_ne_u32 vcc, 0, v7
    v_mov_b32 v5, 0x4444
    v_mov_b32 v6, 0xeeee
    v_cndmask_b32 v10, v5, v6, vcc
    v_mov_b32 v5, 0xe484
    v_mov_b32 v6, 0xee9e
    v_cndmask_b32 v7, v5, v6, vcc
    v_mov_b32 v5, 0x84e4
    v_mov_b32 v6, 0x9eee
    v_cndmask_b32 v8, v5, v6, vcc
    v_cmp_gt_u32 vcc, 2, v2
    s_nop 1
    v_cndmask_b32 v11, v8, v7, vcc
    v_mov_b32 v84, 1065369472
    v_mov_b32 v85, 1065369472
    v_mov_b32 v86, 1065369472
    v_mov_b32 v87, 0
    v_mov_b32 v88, 1065369472
    v_mov_b32 v89, 1065369472
    v_mov_b32 v90, 1065369472
    v_mov_b32 v91, 0
    v_mov_b32 v51, 0
    v_mov_b32 v55, 0
    v_mov_b32 v59, 0
    v_mov_b32 v63, 0
    v_mov_b32 v67, 0
    v_mov_b32 v71, 0
    v_mov_b32 v75, 0
    v_mov_b32 v79, 0
    v_mov_b32 v210, 0
    v_mov_b32 v211, 0
    v_mov_b32 v218, 0
    v_mov_b32 v219, 0
    v_and_b32 v7, 1, v1
    v_cmp_ne_u32 vcc, 0, v7
    v_mov_b32 v5, 0x3f80
    v_mov_b32 v6, 0x3f800000
    v_cndmask_b32 v5, v5, v6, vcc
    v_bfe_u32 v6, v1, 1, 1
    v_cmp_eq_u32 vcc, 0, v6
    s_nop 1
    v_cndmask_b32 v110, 0, v5, vcc
    v_mov_b32 v108, 0
    v_mov_b32 v112, 0
    v_cmp_eq_u32 vcc, 1, v6
    s_nop 1
    v_cndmask_b32 v111, 0, v5, vcc
    v_mov_b32 v109, 0
    v_mov_b32 v113, 0
    v_mov_b32 v240, 0x3dd53b95
    v_mov_b32 v241, 0x3dd53b95
    s_lshl_b32 s90, s32, 8
    s_add_u32 s90, s90, 122880
    v_mul_u32_u24 v6, 1152, v2
    v_lshl_add_u32 v6, v1, 3, v6
    v_add_u32 v19, s90, v6
    s_mul_i32 s90, s32, 1536
    v_add_u32 v20, s90, v12
    s_add_u32 s90, s90, 1024
    v_lshl_add_u32 v21, v0, 3, s90
    s_mul_i32 s90, s32, 6144
    v_add_u32 v22, s90, v12
    s_add_u32 s90, s90, 1024
    v_lshl_add_u32 v23, v0, 3, s90
    v_add_u32 v28, 98304, v12
    s_mul_i32 s90, s32, 3072
    v_add_u32 v37, s90, v12
    v_add_u32 v44, 25600, v37
    s_add_u32 s54, s90, 98304
    s_mul_i32 s90, s32, 3840
    s_add_u32 s90, s90, 10240
    v_add_u32 v38, s90, v12
    s_add_u32 s90, s90, 1024
    v_add_u32 v39, s90, v13
    s_mul_i32 s90, s32, 12288
    v_add_u32 v40, s90, v12
    s_lshl_b32 s90, s40, 15
    s_lshl_b32 s92, s32, 10
    s_add_u32 s90, s90, s92
    v_lshrrev_b32 v5, 3, v0
    v_mul_u32_u24 v5, 0, v5
    v_xor_b32 v5, s34, v5
    v_and_b32 v6, 7, v1
    v_lshlrev_b32 v6, 4, v6
    v_lshl_add_u32 v6, v5, 7, v6
    v_lshrrev_b32 v7, 3, v1
    v_lshl_add_u32 v6, v7, 12, v6
    v_lshrrev_b32 v5, 1, v2
    v_lshl_add_u32 v6, v5, 13, v6
    v_and_b32 v5, 1, v2
    v_lshl_add_u32 v6, v5, 14, v6
    v_add_u32 v30, s90, v6
    s_and_b32 s91, s34, 1
    s_lshl_b32 s91, s91, 12
    s_add_u32 s90, s90, s91
    s_lshr_b32 s91, s34, 2
    s_lshl_b32 s91, s91, 13
    s_add_u32 s90, s90, s91
    s_and_b32 s91, s34, 2
    s_lshl_b32 s91, s91, 13
    s_add_u32 s90, s90, s91
    v_add_u32 v31, s90, v12
    s_lshr_b32 s91, s34, 1
    s_mul_i32 s91, s91, 10240
    s_lshl_b32 s92, s40, 7
    s_add_u32 s91, s91, s92
    s_lshl_b32 s92, s32, 5
    s_add_u32 s91, s91, s92
    s_and_b32 s92, s34, 1
    s_lshl_b32 s92, s92, 4
    s_add_u32 s91, s91, s92
    s_add_u32 s91, s91, 1280
    v_lshl_add_u32 v6, v7, 4, v2
    v_mul_u32_u24 v6, 2560, v6
    v_and_b32 v5, 7, v1
    v_lshl_add_u32 v6, v5, 1, v6
    v_add_u32 v32, s91, v6
    v_cmp_gt_u32 s[58:59], 8, v1
    v_and_b32 v5, 1, v1
    v_lshrrev_b32 v6, 3, v1
    v_lshl_add_u32 v5, v5, 1, v6
    v_bfe_u32 v6, v1, 2, 1
    v_cmp_ne_u32 vcc, 0, v6
    v_mov_b32 v6, 0x3f80
    v_mov_b32 v7, 0x3f800000
    v_cndmask_b32 v6, v6, v7, vcc
    v_cmp_eq_u32 vcc, 0, v5
    s_nop 1
    v_cndmask_b32 v7, 0, v6, vcc
    v_accvgpr_write_b32 a144, v7
    v_cmp_eq_u32 vcc, 1, v5
    s_nop 1
    v_cndmask_b32 v7, 0, v6, vcc
    v_accvgpr_write_b32 a145, v7
    v_cmp_eq_u32 vcc, 2, v5
    s_nop 1
    v_cndmask_b32 v7, 0, v6, vcc
    v_accvgpr_write_b32 a146, v7
    v_cmp_eq_u32 vcc, 3, v5
    s_nop 1
    v_cndmask_b32 v7, 0, v6, vcc
    v_accvgpr_write_b32 a147, v7
    s_lshl_b32 s90, s32, 7
    v_add_u32 v5, s90, v13
    v_add_u32 v6, 458752, v5
    v_add_u32 v7, 459728, v5
    v_cmp_gt_u32 vcc, 12, v0
    s_nop 1
    v_cndmask_b32 v33, v7, v6, vcc
    v_mov_b32 v5, -2
    v_cndmask_b32 v34, v5, 3, vcc
    v_cmp_gt_u32 vcc, 14, v0
    v_mov_b32 v9, 2146435072
    s_nop 0
    v_cndmask_b32 v33, v9, v33, vcc
    v_mov_b32 v5, -1000
    v_cndmask_b32 v34, v5, v34, vcc
    v_and_b32 v4, 3, v1
    v_and_b32 v5, 1, v2
    v_lshl_add_u32 v6, v2, 3, v3
    v_lshlrev_b32 v6, 7, v6
    v_and_b32 v7, 2, v3
    v_lshl_or_b32 v7, v5, 2, v7
    v_lshrrev_b32 v8, 1, v4
    v_xor_b32 v7, v7, v8
    v_lshl_add_u32 v6, v7, 4, v6
    v_and_b32 v7, 1, v4
    v_lshl_add_u32 v6, v7, 3, v6
    s_mul_i32 s90, s32, 24576
    v_add_u32 v6, s90, v6
    v_xor_b32 v182, 0, v6
    v_xor_b32 v183, 32, v6
    v_xor_b32 v184, 64, v6
    v_xor_b32 v185, 96, v6
    s_waitcnt vmcnt(0)
    ds_read_b64_tr_b16 a[0:1], v182 offset:0
    ds_read_b64_tr_b16 a[2:3], v182 offset:512
    ds_read_b64_tr_b16 a[4:5], v182 offset:4096
    ds_read_b64_tr_b16 a[6:7], v182 offset:4608
    ds_read_b64_tr_b16 a[8:9], v182 offset:8192
    ds_read_b64_tr_b16 a[10:11], v182 offset:8704
    ds_read_b64_tr_b16 a[12:13], v182 offset:12288
    ds_read_b64_tr_b16 a[14:15], v182 offset:12800
    ds_read_b64_tr_b16 a[16:17], v182 offset:16384
    ds_read_b64_tr_b16 a[18:19], v182 offset:16896
    ds_read_b64_tr_b16 a[20:21], v182 offset:20480
    ds_read_b64_tr_b16 a[22:23], v182 offset:20992
    ds_read_b64_tr_b16 a[24:25], v183 offset:0
    ds_read_b64_tr_b16 a[26:27], v183 offset:512
    ds_read_b64_tr_b16 a[28:29], v183 offset:4096
    ds_read_b64_tr_b16 a[30:31], v183 offset:4608
    ds_read_b64_tr_b16 a[32:33], v183 offset:8192
    ds_read_b64_tr_b16 a[34:35], v183 offset:8704
    ds_read_b64_tr_b16 a[36:37], v183 offset:12288
    ds_read_b64_tr_b16 a[38:39], v183 offset:12800
    ds_read_b64_tr_b16 a[40:41], v183 offset:16384
    ds_read_b64_tr_b16 a[42:43], v183 offset:16896
    ds_read_b64_tr_b16 a[44:45], v183 offset:20480
    ds_read_b64_tr_b16 a[46:47], v183 offset:20992
    ds_read_b64_tr_b16 a[48:49], v184 offset:0
    ds_read_b64_tr_b16 a[50:51], v184 offset:512
    ds_read_b64_tr_b16 a[52:53], v184 offset:4096
    ds_read_b64_tr_b16 a[54:55], v184 offset:4608
    ds_read_b64_tr_b16 a[56:57], v184 offset:8192
    ds_read_b64_tr_b16 a[58:59], v184 offset:8704
    ds_read_b64_tr_b16 a[60:61], v184 offset:12288
    ds_read_b64_tr_b16 a[62:63], v184 offset:12800
    ds_read_b64_tr_b16 a[64:65], v184 offset:16384
    ds_read_b64_tr_b16 a[66:67], v184 offset:16896
    ds_read_b64_tr_b16 a[68:69], v184 offset:20480
    ds_read_b64_tr_b16 a[70:71], v184 offset:20992
    ds_read_b64_tr_b16 a[72:73], v185 offset:0
    ds_read_b64_tr_b16 a[74:75], v185 offset:512
    ds_read_b64_tr_b16 a[76:77], v185 offset:4096
    ds_read_b64_tr_b16 a[78:79], v185 offset:4608
    ds_read_b64_tr_b16 a[80:81], v185 offset:8192
    ds_read_b64_tr_b16 a[82:83], v185 offset:8704
    ds_read_b64_tr_b16 a[84:85], v185 offset:12288
    ds_read_b64_tr_b16 a[86:87], v185 offset:12800
    ds_read_b64_tr_b16 a[88:89], v185 offset:16384
    ds_read_b64_tr_b16 a[90:91], v185 offset:16896
    ds_read_b64_tr_b16 a[92:93], v185 offset:20480
    ds_read_b64_tr_b16 a[94:95], v185 offset:20992
    s_waitcnt lgkmcnt(0)
    s_barrier
    v_mov_b32 v1, 192
L_gw_23:
    buffer_load_dword v2, v1, s[8:11], 0 offen sc1
    s_sub_u32 s36, s36, 1
    s_cbranch_scc1 L_exit
    s_waitcnt vmcnt(0)
    v_readfirstlane_b32 s90, v2
    s_nop 0
    s_cmp_eq_u32 s90, 0
    s_cbranch_scc1 L_gw_23
    s_cmp_lg_u32 s90, 1
    s_cbranch_scc1 L_slow
    buffer_store_dwordx4 v[164:167], v17, s[4:7], s38 offen
    s_mov_b32 s24, s70
    s_and_b32 s25, s71, 0xffff
    s_mov_b32 s26, 2621440
    s_mov_b32 s27, 0x20000
    s_lshl_b32 s93, s40, 2
    s_add_u32 s93, s93, s32
    s_lshl_b32 s93, s93, 10
    s_add_u32 s92, s93, 81920
    s_add_u32 s93, s93, s38
    buffer_load_dwordx4 v[248:251], v12, s[24:27], s92 offen
    s_add_u32 s92, s92, 40960
    buffer_load_dwordx4 v[248:251], v12, s[24:27], s92 offen
    s_add_u32 s92, s92, 40960
    buffer_load_dwordx4 v[248:251], v12, s[24:27], s92 offen
    s_add_u32 s92, s92, 40960
    buffer_load_dwordx4 v[248:251], v12, s[24:27], s92 offen
    s_add_u32 s92, s92, 40960
    buffer_load_dwordx4 v[248:251], v12, s[4:7], s93 offen sc1
    s_add_u32 s93, s93, 40960
    buffer_load_dwordx4 v[248:251], v12, s[4:7], s93 offen sc1
    s_add_u32 s93, s93, 40960
    buffer_load_dwordx4 v[248:251], v12, s[4:7], s93 offen sc1
    s_add_u32 s93, s93, 40960
    buffer_load_dwordx4 v[248:251], v12, s[4:7], s93 offen sc1
    s_add_u32 s93, s93, 40960
    buffer_load_dwordx4 v[248:251], v12, s[4:7], s93 offen sc1
    s_add_u32 s93, s93, 40960
    buffer_load_dwordx4 v[248:251], v12, s[4:7], s93 offen sc1
    s_add_u32 s93, s93, 40960
    buffer_load_dwordx4 v[248:251], v12, s[4:7], s93 offen sc1
    s_add_u32 s93, s93, 40960
    buffer_load_dwordx4 v[248:251], v12, s[4:7], s93 offen sc1
    s_add_u32 s93, s93, 40960
    buffer_load_dwordx4 v[248:251], v12, s[4:7], s93 offen sc1
    s_add_u32 s93, s93, 40960
    buffer_load_dwordx4 v[248:251], v12, s[4:7], s93 offen sc1
    s_add_u32 s93, s93, 40960
    buffer_load_dwordx4 v[248:251], v12, s[4:7], s93 offen sc1
    s_add_u32 s93, s93, 40960
    buffer_load_dwordx4 v[248:251], v12, s[4:7], s93 offen sc1
    s_add_u32 s93, s93, 40960
    buffer_load_dwordx4 v[248:251], v12, s[4:7], s93 offen sc1
    s_add_u32 s93, s93, 40960
    buffer_load_dwordx4 v[248:251], v12, s[4:7], s93 offen sc1
    s_add_u32 s93, s93, 40960
    buffer_load_dwordx4 v[248:251], v12, s[4:7], s93 offen sc1
    s_add_u32 s93, s93, 40960
    buffer_load_dwordx4 v[248:251], v12, s[4:7], s93 offen sc1
    s_add_u32 s93, s93, 40960
    buffer_load_dwordx4 v[248:251], v12, s[4:7], s93 offen sc1
    s_add_u32 s93, s93, 40960
    buffer_load_dwordx4 v[248:251], v12, s[4:7], s93 offen sc1
    s_add_u32 s93, s93, 40960
    buffer_load_dwordx4 v[248:251], v12, s[4:7], s93 offen sc1
    s_add_u32 s93, s93, 40960
    buffer_load_dwordx4 v[248:251], v12, s[4:7], s93 offen sc1
    s_add_u32 s93, s93, 40960
    buffer_load_dwordx4 v[248:251], v12, s[4:7], s93 offen sc1
    s_add_u32 s93, s93, 40960
    buffer_load_dwordx4 v[248:251], v12, s[4:7], s93 offen sc1
    s_add_u32 s93, s93, 40960
    s_mov_b32 s37, -1
    v_add_u32 v35, -2, v34
    s_add_u32 s45, s38, 65536
    s_add_u32 s46, s45, 4096
    s_add_u32 s47, s45, 8192
    v_mov_b32 v24, v20
    v_mov_b32 v25, v21
    buffer_load_dword v36, v33, s[4:7], s38 offen sc1
    s_waitcnt vmcnt(0)
    v_cmp_lt_i32 vcc, v36, v35
    s_cbranch_vccz L_fok_25
L_fw_24:
    buffer_load_dword v36, v33, s[4:7], s38 offen sc1
    s_sub_u32 s36, s36, 1
    s_cbranch_scc1 L_exit
    s_waitcnt vmcnt(0)
    v_cmp_lt_i32 vcc, v36, v35
    s_cbranch_vccnz L_fw_24
L_fok_25:
    buffer_load_dwordx4 a[96:99], v40, s[4:7], s45 offen offset:0 sc1
    buffer_load_dwordx4 a[100:103], v40, s[4:7], s45 offen offset:1024 sc1
    buffer_load_dwordx4 a[104:107], v40, s[4:7], s45 offen offset:2048 sc1
    buffer_load_dwordx4 a[108:111], v40, s[4:7], s45 offen offset:3072 sc1
    buffer_load_dwordx4 a[112:115], v40, s[4:7], s46 offen offset:0 sc1
    buffer_load_dwordx4 a[116:119], v40, s[4:7], s46 offen offset:1024 sc1
    buffer_load_dwordx4 a[120:123], v40, s[4:7], s46 offen offset:2048 sc1
    buffer_load_dwordx4 a[124:127], v40, s[4:7], s46 offen offset:3072 sc1
    buffer_load_dwordx4 a[128:131], v40, s[4:7], s47 offen offset:0 sc1
    buffer_load_dwordx4 a[132:135], v40, s[4:7], s47 offen offset:1024 sc1
    buffer_load_dwordx4 a[136:139], v40, s[4:7], s47 offen offset:2048 sc1
    buffer_load_dwordx4 a[140:143], v40, s[4:7], s47 offen offset:3072 sc1
    s_waitcnt vmcnt(0)
    v_mfma_f32_16x16x32_bf16 v[148:151], a[96:99], a[0:3], 0
    v_mfma_f32_16x16x32_bf16 v[152:155], a[120:123], a[0:3], 0
    v_mfma_f32_16x16x32_bf16 v[156:159], a[96:99], a[24:27], 0
    v_mfma_f32_16x16x32_bf16 v[160:163], a[120:123], a[24:27], 0
    v_mfma_f32_16x16x32_bf16 v[180:183], a[96:99], a[48:51], 0
    v_mfma_f32_16x16x32_bf16 v[184:187], a[120:123], a[48:51], 0
    v_mfma_f32_16x16x32_bf16 v[188:191], a[96:99], a[72:75], 0
    v_mfma_f32_16x16x32_bf16 v[192:195], a[120:123], a[72:75], 0
    v_mfma_f32_16x16x32_bf16 v[148:151], a[100:103], a[4:7], v[148:151]
    v_mfma_f32_16x16x32_bf16 v[152:155], a[124:127], a[4:7], v[152:155]
    v_mfma_f32_16x16x32_bf16 v[156:159], a[100:103], a[28:31], v[156:159]
    v_mfma_f32_16x16x32_bf16 v[160:163], a[124:127], a[28:31], v[160:163]
    v_mfma_f32_16x16x32_bf16 v[180:183], a[100:103], a[52:55], v[180:183]
    v_mfma_f32_16x16x32_bf16 v[184:187], a[124:127], a[52:55], v[184:187]
    v_mfma_f32_16x16x32_bf16 v[188:191], a[100:103], a[76:79], v[188:191]
    v_mfma_f32_16x16x32_bf16 v[192:195], a[124:127], a[76:79], v[192:195]
    v_mfma_f32_16x16x32_bf16 v[148:151], a[104:107], a[8:11], v[148:151]
    v_mfma_f32_16x16x32_bf16 v[152:155], a[128:131], a[8:11], v[152:155]
    v_mfma_f32_16x16x32_bf16 v[156:159], a[104:107], a[32:35], v[156:159]
    v_mfma_f32_16x16x32_bf16 v[160:163], a[128:131], a[32:35], v[160:163]
    v_mfma_f32_16x16x32_bf16 v[180:183], a[104:107], a[56:59], v[180:183]
    v_mfma_f32_16x16x32_bf16 v[184:187], a[128:131], a[56:59], v[184:187]
    v_mfma_f32_16x16x32_bf16 v[188:191], a[104:107], a[80:83], v[188:191]
    v_mfma_f32_16x16x32_bf16 v[192:195], a[128:131], a[80:83], v[192:195]
    v_mfma_f32_16x16x32_bf16 v[148:151], a[108:111], a[12:15], v[148:151]
    v_mfma_f32_16x16x32_bf16 v[152:155], a[132:135], a[12:15], v[152:155]
    v_mfma_f32_16x16x32_bf16 v[156:159], a[108:111], a[36:39], v[156:159]
    v_mfma_f32_16x16x32_bf16 v[160:163], a[132:135], a[36:39], v[160:163]
    v_mfma_f32_16x16x32_bf16 v[180:183], a[108:111], a[60:63], v[180:183]
    v_mfma_f32_16x16x32_bf16 v[184:187], a[132:135], a[60:63], v[184:187]
    v_mfma_f32_16x16x32_bf16 v[188:191], a[108:111], a[84:87], v[188:191]
    v_mfma_f32_16x16x32_bf16 v[192:195], a[132:135], a[84:87], v[192:195]
    v_mfma_f32_16x16x32_bf16 v[148:151], a[112:115], a[16:19], v[148:151]
    v_mfma_f32_16x16x32_bf16 v[152:155], a[136:139], a[16:19], v[152:155]
    v_mfma_f32_16x16x32_bf16 v[156:159], a[112:115], a[40:43], v[156:159]
    v_mfma_f32_16x16x32_bf16 v[160:163], a[136:139], a[40:43], v[160:163]
    v_mfma_f32_16x16x32_bf16 v[180:183], a[112:115], a[64:67], v[180:183]
    v_mfma_f32_16x16x32_bf16 v[184:187], a[136:139], a[64:67], v[184:187]
    v_mfma_f32_16x16x32_bf16 v[188:191], a[112:115], a[88:91], v[188:191]
    v_mfma_f32_16x16x32_bf16 v[192:195], a[136:139], a[88:91], v[192:195]
    v_mfma_f32_16x16x32_bf16 v[148:151], a[116:119], a[20:23], v[148:151]
    v_mfma_f32_16x16x32_bf16 v[152:155], a[140:143], a[20:23], v[152:155]
    v_mfma_f32_16x16x32_bf16 v[156:159], a[116:119], a[44:47], v[156:159]
    v_mfma_f32_16x16x32_bf16 v[160:163], a[140:143], a[44:47], v[160:163]
    v_mfma_f32_16x16x32_bf16 v[180:183], a[116:119], a[68:71], v[180:183]
    v_mfma_f32_16x16x32_bf16 v[184:187], a[140:143], a[68:71], v[184:187]
    v_mfma_f32_16x16x32_bf16 v[188:191], a[116:119], a[92:95], v[188:191]
    v_mfma_f32_16x16x32_bf16 v[192:195], a[140:143], a[92:95], v[192:195]
    v_cvt_pk_bf16_f32 v64, v180, v181
    v_cvt_pk_bf16_f32 v65, v182, v183
    ds_write_b64 v24, v[64:65] offset:12288
    v_cvt_pk_bf16_f32 v68, v184, v185
    v_cvt_pk_bf16_f32 v69, v186, v187
    ds_write_b64 v25, v[68:69] offset:12288
    v_cvt_pk_bf16_f32 v72, v188, v189
    v_cvt_pk_bf16_f32 v73, v190, v191
    ds_write_b64 v24, v[72:73] offset:18432
    v_cvt_pk_bf16_f32 v76, v192, v193
    v_cvt_pk_bf16_f32 v77, v194, v195
    ds_write_b64 v25, v[76:77] offset:18432
    v_cvt_pk_bf16_f32 v48, v148, v149
    v_cvt_pk_bf16_f32 v49, v150, v151
    ds_write_b64 v24, v[48:49] offset:0
    v_cvt_pk_bf16_f32 v52, v152, v153
    v_cvt_pk_bf16_f32 v53, v154, v155
    ds_write_b64 v25, v[52:53] offset:0
    v_cvt_pk_bf16_f32 v56, v156, v157
    v_cvt_pk_bf16_f32 v57, v158, v159
    ds_write_b64 v24, v[56:57] offset:6144
    v_cvt_pk_bf16_f32 v60, v160, v161
    v_cvt_pk_bf16_f32 v61, v162, v163
    ds_write_b64 v25, v[60:61] offset:6144
    s_add_u32 s56, s37, 2
    s_and_b32 s55, s56, 3
    s_mul_i32 s55, s55, 114688
    s_add_u32 s55, s55, 65536
    s_add_u32 s45, s38, s55
    s_add_u32 s46, s45, 4096
    s_add_u32 s47, s45, 8192
    s_add_u32 s56, s37, -1
    s_and_b32 s55, s56, 3
    s_mul_i32 s55, s55, 114688
    s_add_u32 s55, s55, 53248
    s_add_u32 s48, s38, s55
    s_and_b32 s55, s56, 1
    s_add_u32 s56, s56, 1
    v_mov_b32 v35, -16
    v_writelane_b32 v35, s56, 12
    s_mul_i32 s55, s55, 12288
    s_add_u32 m0, s54, s55
    v_add_u32 v35, -1, v34
    buffer_load_dword v36, v33, s[4:7], s38 offen sc1
    s_waitcnt vmcnt(0)
    v_cmp_lt_i32 vcc, v36, v35
    s_cbranch_vccz L_fok_27
L_fw_26:
    buffer_load_dword v36, v33, s[4:7], s38 offen sc1
    s_sub_u32 s36, s36, 1
    s_cbranch_scc1 L_exit
    s_waitcnt vmcnt(0)
    v_cmp_lt_i32 vcc, v36, v35
    s_cbranch_vccnz L_fw_26
L_fok_27:
    buffer_load_dwordx4 a[96:99], v40, s[4:7], s45 offen offset:0 sc1
    buffer_load_dwordx4 a[100:103], v40, s[4:7], s45 offen offset:1024 sc1
    buffer_load_dwordx4 a[104:107], v40, s[4:7], s45 offen offset:2048 sc1
    buffer_load_dwordx4 a[108:111], v40, s[4:7], s45 offen offset:3072 sc1
    buffer_load_dwordx4 a[112:115], v40, s[4:7], s46 offen offset:0 sc1
    buffer_load_dwordx4 a[116:119], v40, s[4:7], s46 offen offset:1024 sc1
    buffer_load_dwordx4 a[120:123], v40, s[4:7], s46 offen offset:2048 sc1
    buffer_load_dwordx4 a[124:127], v40, s[4:7], s46 offen offset:3072 sc1
    buffer_load_dwordx4 a[128:131], v40, s[4:7], s47 offen offset:0 sc1
    buffer_load_dwordx4 a[132:135], v40, s[4:7], s47 offen offset:1024 sc1
    buffer_load_dwordx4 a[136:139], v40, s[4:7], s47 offen offset:2048 sc1
    buffer_load_dwordx4 a[140:143], v40, s[4:7], s47 offen offset:3072 sc1
    s_add_u32 s56, s37, 1
    v_mov_b32 v47, v24
    s_and_b32 s55, s56, 3
    s_mul_i32 s41, s55, 327680
    s_mul_i32 s56, s55, 114688
    s_add_u32 s43, s38, s56
    s_xor_b32 s55, s55, 2
    s_mul_i32 s42, s55, 327680
    s_add_u32 s56, s37, 2
    v_mov_b32 v107, s56
    s_and_b32 s55, s56, 3
    s_mul_i32 s44, s55, 24576
    s_mov_b32 s50, s52
    s_add_u32 s56, s37, -2
    s_and_b32 s55, s56, 3
    s_mul_i32 s55, s55, 327680
    s_add_u32 s49, s55, 4194304
    s_add_u32 s56, s37, -4
    s_and_b32 s55, s56, 3
    s_mul_i32 s55, s55, 327680
    s_add_u32 s51, s55, 4194304
    s_mul_i32 s52, s56, 81920
    s_add_u32 s56, s37, -1
    s_and_b32 s55, s56, 3
    s_mul_i32 s55, s55, 24576
    v_add_u32 v26, s55, v22
    v_add_u32 v27, s55, v23
    s_and_b32 s55, s56, 1
    s_mul_i32 s55, s55, 12288
    v_add_u32 v29, s55, v28
    s_add_u32 s37, s37, 1
    v_add_u32 v24, s44, v20
    v_add_u32 v25, s44, v21
    v_pk_mul_f32 v[148:149], v[210:211], v[210:211]
    v_pk_mul_f32 v[150:151], v[210:211], v[210:211]
    v_pk_mul_f32 v[152:153], v[210:211], v[210:211]
    v_pk_mul_f32 v[154:155], v[210:211], v[210:211]
    v_pk_mul_f32 v[156:157], v[210:211], v[210:211]
    v_pk_mul_f32 v[158:159], v[210:211], v[210:211]
    v_pk_mul_f32 v[160:161], v[210:211], v[210:211]
    v_pk_mul_f32 v[162:163], v[210:211], v[210:211]
    v_mov_b32 v120, 0
    v_mov_b32 v121, 0
    v_mov_b32 v122, 0
    v_mov_b32 v123, 0
    v_mov_b32 v124, 0
    v_mov_b32 v125, 0
    v_mov_b32 v126, 0
    v_mov_b32 v127, 0
    v_mov_b32 v128, 0
    v_mov_b32 v129, 0
    v_mov_b32 v130, 0
    v_mov_b32 v131, 0
    v_mov_b32 v132, 0
    v_mov_b32 v133, 0
    v_mov_b32 v134, 0
    v_mov_b32 v135, 0
    v_mov_b32 v116, 0
    v_mov_b32 v117, 0
    v_mov_b32 v118, 0
    v_mov_b32 v119, 0
    v_mov_b32 v3, 200
L_p0_28:
    buffer_load_dword v4, v3, s[8:11], 0 offen sc1
    s_sub_u32 s36, s36, 1
    s_cbranch_scc1 L_exit
    s_waitcnt vmcnt(0)
    v_readfirstlane_b32 s90, v4
    s_nop 0
    s_cmp_eq_u32 s90, 0
    s_cbranch_scc1 L_p0_28
    s_and_b32 s90, s90, 2
    s_lshl_b32 s90, s90, 12
    s_nop 0
    v_xor_b32 v30, s90, v30
    v_xor_b32 v31, s90, v31
    s_mov_b32 s90, 5832704
    buffer_store_dwordx4 v[168:171], v30, s[4:7], s90 offen sc1
    s_mov_b32 s90, 6160384
    buffer_store_dwordx4 v[168:171], v30, s[4:7], s90 offen sc1
L_wo_loop_f:
    buffer_load_dword v41, v245, s[4:7], s38 offen sc1
    buffer_load_dword v41, v245, s[4:7], s38 offen sc1
    buffer_load_dword v41, v245, s[4:7], s38 offen sc1
L_bf_29:
    buffer_load_dword v41, v245, s[4:7], s38 offen sc1
    s_sub_u32 s36, s36, 1
    s_cbranch_scc1 L_exit
    s_waitcnt vmcnt(3)
    v_cmp_ge_u32 vcc, s37, v41
    s_cbranch_vccnz L_bf_29
    buffer_load_dwordx4 v[136:139], v44, s[4:7], s43 offen offset:0 sc1
    buffer_load_dwordx4 v[140:143], v44, s[4:7], s43 offen offset:1024 sc1
    buffer_load_dwordx4 v[144:147], v44, s[4:7], s43 offen offset:2048 sc1
    s_waitcnt vmcnt(2)
    buffer_load_dwordx4 v[92:95], v38, s[4:7], s43 offen offset:0 sc1
    buffer_load_dword v104, v39, s[4:7], s43 offen offset:0 sc1
    v_smfmac_f32_16x16x64_bf16 v[148:151], v[136:139], a[0:7], v10
    buffer_load_dwordx4 v[96:99], v38, s[4:7], s43 offen offset:1280 sc1
    buffer_load_dword v105, v39, s[4:7], s43 offen offset:1280 sc1
    v_smfmac_f32_16x16x64_bf16 v[152:155], v[136:139], a[24:31], v10
    buffer_load_dwordx4 v[100:103], v38, s[4:7], s43 offen offset:2560 sc1
    buffer_load_dword v106, v39, s[4:7], s43 offen offset:2560 sc1
    v_smfmac_f32_16x16x64_bf16 v[156:159], v[136:139], a[48:55], v10
    v_smfmac_f32_16x16x64_bf16 v[160:163], v[136:139], a[72:79], v10
    s_waitcnt vmcnt(7)
    v_smfmac_f32_16x16x64_bf16 v[148:151], v[140:143], a[8:15], v10
    v_smfmac_f32_16x16x64_bf16 v[152:155], v[140:143], a[32:39], v10
    v_smfmac_f32_16x16x64_bf16 v[156:159], v[140:143], a[56:63], v10
    v_smfmac_f32_16x16x64_bf16 v[160:163], v[140:143], a[80:87], v10
    s_waitcnt vmcnt(6)
    v_smfmac_f32_16x16x64_bf16 v[148:151], v[144:147], a[16:23], v10
    v_smfmac_f32_16x16x64_bf16 v[152:155], v[144:147], a[40:47], v10
    v_smfmac_f32_16x16x64_bf16 v[156:159], v[144:147], a[64:71], v10
    v_smfmac_f32_16x16x64_bf16 v[160:163], v[144:147], a[88:95], v10
    v_pk_add_f32 v[148:149], v[148:149], v[150:151]
    v_cmp_u_f32 vcc, v148, v149
    v_cvt_pk_bf16_f32 v50, v148, v149
    v_cvt_pk_bf16_f32 v54, v148, v149
    v_pk_add_f32 v[152:153], v[152:153], v[154:155]
    v_cvt_pk_bf16_f32 v58, v152, v153
    v_cvt_pk_bf16_f32 v62, v152, v153
    v_pk_add_f32 v[156:157], v[156:157], v[158:159]
    v_cvt_pk_bf16_f32 v66, v156, v157
    v_cvt_pk_bf16_f32 v70, v156, v157
    v_pk_add_f32 v[160:161], v[160:161], v[162:163]
    v_cvt_pk_bf16_f32 v74, v160, v161
    v_cvt_pk_bf16_f32 v78, v160, v161
    s_cbranch_vccnz L_vm_30
L_u_31:
    ds_write_b32 v47, v50 offset:8
    ds_write_b32 v47, v58 offset:6152
    ds_write_b32 v47, v66 offset:12296
    ds_write_b32 v47, v74 offset:18440
    s_cmp_eq_u32 s37, 63
    s_cbranch_scc1 L_wo_tail_f
L_sc_32:
    s_waitcnt vmcnt(2)
    v_pk_add_f32 v[236:237], v[92:93], v[96:97]
    v_pk_add_f32 v[238:239], v[94:95], v[98:99]
    v_add_f32 v43, v104, v105
    s_waitcnt vmcnt(0)
    v_pk_add_f32 v[236:237], v[236:237], v[100:101]
    v_pk_add_f32 v[238:239], v[238:239], v[102:103]
    v_add_f32 v43, v43, v106
    v_max3_f32 v41, v236, v237, v238
    v_max3_f32 v41, v41, v239, v43
    v_pk_add_f32 v[242:243], v[236:237], v[238:239]
    v_add_f32 v242, v242, v43
    v_max_f32_dpp v42, v41, v41 quad_perm:[2,3,0,1] row_mask:0xf bank_mask:0xf
    v_max_f32_dpp v41, v41, v41 quad_perm:[2,3,0,1] row_mask:0xf bank_mask:0xf
    v_cmp_u_f32 vcc, v242, v243
    s_nop 0
    v_permlane16_swap_b32 v41, v42
    v_max_f32 v41, v41, v42
    v_mov_b32 v42, v41
    s_cbranch_vccnz L_sp_33
L_sg_34:
    s_nop 0
    v_permlane32_swap_b32 v41, v42
    v_max_f32 v41, v41, v42
    v_mul_f32 v242, 0xbdd53b95, v41
    v_pk_fma_f32 v[236:237], v[236:237], v[240:241], v[242:243] op_sel_hi:[1,1,0]
    v_pk_fma_f32 v[238:239], v[238:239], v[240:241], v[242:243] op_sel_hi:[1,1,0]
    v_fma_f32 v43, v43, v240, v242
    v_exp_f32 v236, v236
    v_exp_f32 v237, v237
    v_exp_f32 v238, v238
    v_exp_f32 v239, v239
    v_exp_f32 v43, v43
    v_cvt_pk_bf16_f32 v80, v236, v237
    v_cvt_pk_bf16_f32 v82, v238, v239
    v_cvt_pk_bf16_f32 v81, v43, 0
    v_cvt_pk_bf16_f32 v83, v43, 0
    s_nop 1
    v_smfmac_f32_16x16x64_bf16 v[116:119], v[80:83], v[84:91], v11
    v_smfmac_f32_16x16x64_bf16 v[120:123], v[80:83], v[48:55], v11
    v_smfmac_f32_16x16x64_bf16 v[124:127], v[80:83], v[56:63], v11
    v_smfmac_f32_16x16x64_bf16 v[128:131], v[80:83], v[64:71], v11
    v_add_f32 v116, v116, v118
    v_add_f32 v117, v117, v119
    v_smfmac_f32_16x16x64_bf16 v[132:135], v[80:83], v[72:79], v11
    v_rcp_f32 v116, v116
    v_rcp_f32 v117, v117
    v_pk_add_f32 v[120:121], v[120:121], v[122:123]
    v_pk_mul_f32 v[120:121], v[120:121], v[116:117]
    v_cvt_pk_bf16_f32 v236, v120, v121
    v_pk_add_f32 v[124:125], v[124:125], v[126:127]
    v_pk_mul_f32 v[124:125], v[124:125], v[116:117]
    v_cvt_pk_bf16_f32 v237, v124, v125
    ds_write2st64_b32 v18, v236, v237 offset0:0 offset1:1
    v_pk_add_f32 v[128:129], v[128:129], v[130:131]
    v_pk_mul_f32 v[128:129], v[128:129], v[116:117]
    v_cvt_pk_bf16_f32 v238, v128, v129
    v_pk_add_f32 v[132:133], v[132:133], v[134:135]
    v_pk_mul_f32 v[132:133], v[132:133], v[116:117]
    v_cvt_pk_bf16_f32 v239, v132, v133
    ds_write2st64_b32 v18, v238, v239 offset0:2 offset1:3
    v_mov_b32 v120, 0
    v_mov_b32 v121, 0
    v_mov_b32 v122, 0
    v_mov_b32 v123, 0
    v_mov_b32 v124, 0
    v_mov_b32 v125, 0
    v_mov_b32 v126, 0
    v_mov_b32 v127, 0
    v_mov_b32 v128, 0
    v_mov_b32 v129, 0
    s_waitcnt lgkmcnt(0)
    s_barrier
    ds_read_b64_tr_b16 v[80:81], v19
    ds_read_b64_tr_b16 v[82:83], v19 offset:128
    v_mov_b32 v130, 0
    v_mov_b32 v131, 0
    v_mov_b32 v132, 0
    v_mov_b32 v133, 0
    v_mov_b32 v134, 0
    v_mov_b32 v135, 0
    v_mov_b32 v116, 0
    v_mov_b32 v117, 0
    v_mov_b32 v118, 0
    v_mov_b32 v119, 0
    s_waitcnt lgkmcnt(0)
    v_mfma_f32_16x16x32_bf16 v[172:175], v[110:113], v[80:83], 0
    v_mfma_f32_16x16x32_bf16 v[176:179], v[108:111], v[80:83], 0
    buffer_store_dword v107, v244, s[4:7], s38 offen
    buffer_load_dword v36, v33, s[4:7], s38 offen sc1
    s_nop 2
    v_cvt_pk_bf16_f32 v236, v172, v173
    v_cvt_pk_bf16_f32 v237, v174, v175
    s_nop 0
    v_cvt_pk_bf16_f32 v238, v176, v177
    v_cvt_pk_bf16_f32 v239, v178, v179
    buffer_store_dwordx4 v[236:239], v14, s[4:7], s41 offen sc1
    ds_read_b128 v[204:207], v26 offset:0
    ds_read_b128 v[180:183], v29 offset:0
    ds_read_b128 v[184:187], v29 offset:1024
    ds_read_b64 v[208:209], v27 offset:0
    ds_read_b128 v[188:191], v29 offset:2048
    ds_read_b128 v[212:215], v26 offset:1536
    ds_read_b128 v[192:195], v29 offset:3072
    ds_read_b128 v[196:199], v29 offset:4096
    ds_read_b64 v[216:217], v27 offset:1536
    ds_read_b128 v[200:203], v29 offset:5120
    buffer_store_dwordx4 v[220:223], v30, s[4:7], s49 offen sc1
    buffer_load_dwordx4 v[228:231], v31, s[4:7], s51 offen sc1
    s_add_u32 s55, s42, s60
    buffer_store_dword v168, v46, s[4:7], s55 offen sc1
    s_add_u32 s55, s42, s61
    buffer_store_dword v168, v46, s[4:7], s55 offen sc1
    s_waitcnt lgkmcnt(5)
    v_mfma_f32_16x16x32_bf16 v[220:223], v[180:183], v[204:207], 0
    v_mfma_f32_16x16x32_bf16 v[224:227], v[184:187], v[204:207], 0
    v_mfma_f32_16x16x32_bf16 v[224:227], v[188:191], v[208:211], v[224:227]
    ds_read_b128 v[204:207], v26 offset:3072
    ds_read_b128 v[180:183], v29 offset:6144
    ds_read_b128 v[184:187], v29 offset:7168
    ds_read_b64 v[208:209], v27 offset:3072
    ds_read_b128 v[188:191], v29 offset:8192
    s_add_u32 s56, s37, 2
    s_and_b32 s55, s56, 3
    s_mul_i32 s55, s55, 114688
    s_add_u32 s55, s55, 65536
    s_add_u32 s45, s38, s55
    s_add_u32 s46, s45, 4096
    s_add_u32 s47, s45, 8192
    s_add_u32 s56, s37, -1
    s_and_b32 s55, s56, 3
    s_mul_i32 s55, s55, 114688
    s_add_u32 s55, s55, 53248
    s_add_u32 s48, s38, s55
    s_and_b32 s55, s56, 1
    s_add_u32 s56, s56, 1
    v_mov_b32 v35, -16
    v_writelane_b32 v35, s56, 12
    s_mul_i32 s55, s55, 12288
    s_add_u32 m0, s54, s55
    s_waitcnt lgkmcnt(5)
    v_mfma_f32_16x16x32_bf16 v[220:223], v[192:195], v[212:215], v[220:223]
    v_mfma_f32_16x16x32_bf16 v[224:227], v[196:199], v[212:215], v[224:227]
    v_mfma_f32_16x16x32_bf16 v[224:227], v[200:203], v[216:219], v[224:227]
    ds_read_b128 v[212:215], v26 offset:4608
    ds_read_b128 v[192:195], v29 offset:9216
    ds_read_b128 v[196:199], v29 offset:10240
    ds_read_b64 v[216:217], v27 offset:4608
    ds_read_b128 v[200:203], v29 offset:11264
    s_waitcnt lgkmcnt(5)
    v_mfma_f32_16x16x32_bf16 v[220:223], v[180:183], v[204:207], v[220:223]
    v_mfma_f32_16x16x32_bf16 v[224:227], v[184:187], v[204:207], v[224:227]
    v_mfma_f32_16x16x32_bf16 v[224:227], v[188:191], v[208:211], v[224:227]
    s_waitcnt lgkmcnt(0)
    v_mfma_f32_16x16x32_bf16 v[220:223], v[192:195], v[212:215], v[220:223]
    v_mfma_f32_16x16x32_bf16 v[224:227], v[196:199], v[212:215], v[224:227]
    v_mfma_f32_16x16x32_bf16 v[224:227], v[200:203], v[216:219], v[224:227]
    s_waitcnt vmcnt(5)
    v_cmp_lt_i32 vcc, v36, v35
    s_cbranch_vccz L_fok_36
L_fw_35:
    buffer_load_dword v36, v33, s[4:7], s38 offen sc1
    s_sub_u32 s36, s36, 1
    s_cbranch_scc1 L_exit
    s_waitcnt vmcnt(0)
    v_cmp_lt_i32 vcc, v36, v35
    s_cbranch_vccnz L_fw_35
L_fok_36:
    buffer_load_dwordx4 v37, s[4:7], s48 offen offset:0 sc1 lds
    buffer_load_dwordx4 v37, s[4:7], s48 offen offset:1024 sc1 lds
    buffer_load_dwordx4 v37, s[4:7], s48 offen offset:2048 sc1 lds
    v_cvt_pk_bf16_f32 v220, v220, v221
    v_cvt_pk_bf16_f32 v221, v222, v223
    v_cvt_pk_bf16_f32 v222, v224, v225
    v_cvt_pk_bf16_f32 v223, v226, v227
    v_mfma_f32_16x16x32_bf16 v[148:151], a[96:99], a[0:3], 0
    s_add_u32 s56, s37, 1
    v_mov_b32 v47, v24
    v_mfma_f32_16x16x32_bf16 v[152:155], a[120:123], a[0:3], 0
    s_and_b32 s55, s56, 3
    s_mul_i32 s41, s55, 327680
    v_mfma_f32_16x16x32_bf16 v[156:159], a[96:99], a[24:27], 0
    s_mul_i32 s56, s55, 114688
    s_add_u32 s43, s38, s56
    v_mfma_f32_16x16x32_bf16 v[160:163], a[120:123], a[24:27], 0
    s_xor_b32 s55, s55, 2
    s_mul_i32 s42, s55, 327680
    v_mfma_f32_16x16x32_bf16 v[180:183], a[96:99], a[48:51], 0
    s_add_u32 s56, s37, 2
    v_mov_b32 v107, s56
    v_mfma_f32_16x16x32_bf16 v[184:187], a[120:123], a[48:51], 0
    s_and_b32 s55, s56, 3
    s_mul_i32 s44, s55, 24576
    v_mfma_f32_16x16x32_bf16 v[188:191], a[96:99], a[72:75], 0
    s_mov_b32 s50, s52
    s_add_u32 s56, s37, -2
    v_mfma_f32_16x16x32_bf16 v[192:195], a[120:123], a[72:75], 0
    buffer_load_dwordx4 a[96:99], v40, s[4:7], s45 offen offset:0 sc1
    v_mfma_f32_16x16x32_bf16 v[148:151], a[100:103], a[4:7], v[148:151]
    s_and_b32 s55, s56, 3
    s_mul_i32 s55, s55, 327680
    v_mfma_f32_16x16x32_bf16 v[152:155], a[124:127], a[4:7], v[152:155]
    buffer_load_dwordx4 a[120:123], v40, s[4:7], s46 offen offset:2048 sc1
    v_mfma_f32_16x16x32_bf16 v[156:159], a[100:103], a[28:31], v[156:159]
    s_add_u32 s49, s55, 4194304
    s_add_u32 s56, s37, -4
    v_mfma_f32_16x16x32_bf16 v[160:163], a[124:127], a[28:31], v[160:163]
    s_and_b32 s55, s56, 3
    s_mul_i32 s55, s55, 327680
    v_mfma_f32_16x16x32_bf16 v[180:183], a[100:103], a[52:55], v[180:183]
    s_add_u32 s51, s55, 4194304
    s_mul_i32 s52, s56, 81920
    v_mfma_f32_16x16x32_bf16 v[184:187], a[124:127], a[52:55], v[184:187]
    s_add_u32 s56, s37, -1
    s_and_b32 s55, s56, 3
    v_mfma_f32_16x16x32_bf16 v[188:191], a[100:103], a[76:79], v[188:191]
    s_mul_i32 s55, s55, 24576
    v_add_u32 v26, s55, v22
    v_mfma_f32_16x16x32_bf16 v[192:195], a[124:127], a[76:79], v[192:195]
    buffer_load_dwordx4 a[100:103], v40, s[4:7], s45 offen offset:1024 sc1
    v_mfma_f32_16x16x32_bf16 v[148:151], a[104:107], a[8:11], v[148:151]
    v_add_u32 v27, s55, v23
    s_and_b32 s55, s56, 1
    v_mfma_f32_16x16x32_bf16 v[152:155], a[128:131], a[8:11], v[152:155]
    buffer_load_dwordx4 a[124:127], v40, s[4:7], s46 offen offset:3072 sc1
    v_mfma_f32_16x16x32_bf16 v[156:159], a[104:107], a[32:35], v[156:159]
    s_mul_i32 s55, s55, 12288
    v_add_u32 v29, s55, v28
    v_mfma_f32_16x16x32_bf16 v[160:163], a[128:131], a[32:35], v[160:163]
    v_mfma_f32_16x16x32_bf16 v[180:183], a[104:107], a[56:59], v[180:183]
    v_mfma_f32_16x16x32_bf16 v[184:187], a[128:131], a[56:59], v[184:187]
    v_mfma_f32_16x16x32_bf16 v[188:191], a[104:107], a[80:83], v[188:191]
    v_mfma_f32_16x16x32_bf16 v[192:195], a[128:131], a[80:83], v[192:195]
    buffer_load_dwordx4 a[104:107], v40, s[4:7], s45 offen offset:2048 sc1
    v_mfma_f32_16x16x32_bf16 v[148:151], a[108:111], a[12:15], v[148:151]
    v_mfma_f32_16x16x32_bf16 v[152:155], a[132:135], a[12:15], v[152:155]
    buffer_load_dwordx4 a[128:131], v40, s[4:7], s47 offen offset:0 sc1
    v_mfma_f32_16x16x32_bf16 v[156:159], a[108:111], a[36:39], v[156:159]
    v_mfma_f32_16x16x32_bf16 v[160:163], a[132:135], a[36:39], v[160:163]
    v_mfma_f32_16x16x32_bf16 v[180:183], a[108:111], a[60:63], v[180:183]
    v_mfma_f32_16x16x32_bf16 v[184:187], a[132:135], a[60:63], v[184:187]
    v_mfma_f32_16x16x32_bf16 v[188:191], a[108:111], a[84:87], v[188:191]
    v_mfma_f32_16x16x32_bf16 v[192:195], a[132:135], a[84:87], v[192:195]
    buffer_load_dwordx4 a[108:111], v40, s[4:7], s45 offen offset:3072 sc1
    v_mfma_f32_16x16x32_bf16 v[148:151], a[112:115], a[16:19], v[148:151]
    v_mfma_f32_16x16x32_bf16 v[152:155], a[136:139], a[16:19], v[152:155]
    buffer_load_dwordx4 a[132:135], v40, s[4:7], s47 offen offset:1024 sc1
    v_mfma_f32_16x16x32_bf16 v[156:159], a[112:115], a[40:43], v[156:159]
    v_mfma_f32_16x16x32_bf16 v[160:163], a[136:139], a[40:43], v[160:163]
    v_mfma_f32_16x16x32_bf16 v[180:183], a[112:115], a[64:67], v[180:183]
    v_mfma_f32_16x16x32_bf16 v[184:187], a[136:139], a[64:67], v[184:187]
    v_mfma_f32_16x16x32_bf16 v[188:191], a[112:115], a[88:91], v[188:191]
    v_mfma_f32_16x16x32_bf16 v[192:195], a[136:139], a[88:91], v[192:195]
    buffer_load_dwordx4 a[112:115], v40, s[4:7], s46 offen offset:0 sc1
    v_mfma_f32_16x16x32_bf16 v[148:151], a[116:119], a[20:23], v[148:151]
    v_mfma_f32_16x16x32_bf16 v[152:155], a[140:143], a[20:23], v[152:155]
    buffer_load_dwordx4 a[136:139], v40, s[4:7], s47 offen offset:2048 sc1
    v_mfma_f32_16x16x32_bf16 v[156:159], a[116:119], a[44:47], v[156:159]
    v_mfma_f32_16x16x32_bf16 v[160:163], a[140:143], a[44:47], v[160:163]
    v_mfma_f32_16x16x32_bf16 v[180:183], a[116:119], a[68:71], v[180:183]
    v_mfma_f32_16x16x32_bf16 v[184:187], a[140:143], a[68:71], v[184:187]
    v_mfma_f32_16x16x32_bf16 v[188:191], a[116:119], a[92:95], v[188:191]
    v_mfma_f32_16x16x32_bf16 v[192:195], a[140:143], a[92:95], v[192:195]
    buffer_load_dwordx4 a[116:119], v40, s[4:7], s46 offen offset:1024 sc1
    buffer_load_dwordx4 a[140:143], v40, s[4:7], s47 offen offset:3072 sc1
    s_cmp_lt_u32 s37, 5
    s_nop 0
    s_cbranch_scc1 L_g_37
    s_waitcnt vmcnt(17)
    v_mfma_f32_16x16x32_bf16 v[232:235], a[144:147], v[228:231], 0
    s_nop 7
    v_cndmask_b32 v234, v232, v233, s[58:59]
    v_cndmask_b32 v235, v233, v232, s[58:59]
    s_nop 1
    v_add_f32_dpp v235, v234, v235 row_ror:8 row_mask:0xf bank_mask:0xf
    v_cvt_pk_bf16_f32 v235, v235, v235
    buffer_store_short v235, v32, s[28:31], s50 offen
L_g_37:
    v_cvt_pk_bf16_f32 v64, v180, v181
    v_cvt_pk_bf16_f32 v65, v182, v183
    ds_write_b64 v24, v[64:65] offset:12288
    v_cvt_pk_bf16_f32 v68, v184, v185
    v_cvt_pk_bf16_f32 v69, v186, v187
    ds_write_b64 v25, v[68:69] offset:12288
    v_cvt_pk_bf16_f32 v72, v188, v189
    v_cvt_pk_bf16_f32 v73, v190, v191
    ds_write_b64 v24, v[72:73] offset:18432
    v_cvt_pk_bf16_f32 v76, v192, v193
    v_cvt_pk_bf16_f32 v77, v194, v195
    ds_write_b64 v25, v[76:77] offset:18432
    v_cvt_pk_bf16_f32 v48, v148, v149
    v_cvt_pk_bf16_f32 v49, v150, v151
    ds_write_b64 v24, v[48:49] offset:0
    v_cvt_pk_bf16_f32 v52, v152, v153
    v_cvt_pk_bf16_f32 v53, v154, v155
    ds_write_b64 v25, v[52:53] offset:0
    v_cvt_pk_bf16_f32 v56, v156, v157
    v_cvt_pk_bf16_f32 v57, v158, v159
    ds_write_b64 v24, v[56:57] offset:6144
    v_cvt_pk_bf16_f32 v60, v160, v161
    v_cvt_pk_bf16_f32 v61, v162, v163
    ds_write_b64 v25, v[60:61] offset:6144
    s_add_u32 s37, s37, 1
    v_add_u32 v24, s44, v20
    v_add_u32 v25, s44, v21
    v_pk_mul_f32 v[148:149], v[210:211], v[210:211]
    v_pk_mul_f32 v[150:151], v[210:211], v[210:211]
    v_pk_mul_f32 v[152:153], v[210:211], v[210:211]
    v_pk_mul_f32 v[154:155], v[210:211], v[210:211]
    v_pk_mul_f32 v[156:157], v[210:211], v[210:211]
    v_pk_mul_f32 v[158:159], v[210:211], v[210:211]
    v_pk_mul_f32 v[160:161], v[210:211], v[210:211]
    v_pk_mul_f32 v[162:163], v[210:211], v[210:211]
    s_branch L_wo_loop_f
L_wo_tail_f:
    buffer_store_dwordx4 v[220:223], v30, s[4:7], s49 offen sc1
    s_waitcnt vmcnt(0) lgkmcnt(0)
    s_barrier
    s_add_u32 s56, s37, -1
    s_and_b32 s55, s56, 3
    s_mul_i32 s55, s55, 114688
    s_add_u32 s55, s55, 53248
    s_add_u32 s48, s38, s55
    s_and_b32 s55, s56, 1
    s_add_u32 s56, s56, 1
    v_mov_b32 v35, -16
    v_writelane_b32 v35, s56, 12
    s_mul_i32 s55, s55, 12288
    s_add_u32 m0, s54, s55
    buffer_load_dword v36, v33, s[4:7], s38 offen sc1
    s_add_u32 s56, s37, -2
    s_and_b32 s55, s56, 3
    s_mul_i32 s55, s55, 24576
    v_add_u32 v26, s55, v22
    v_add_u32 v27, s55, v23
    s_and_b32 s55, s56, 1
    s_mul_i32 s55, s55, 12288
    v_add_u32 v29, s55, v28
    s_mov_b32 s49, 5505024
    ds_read_b128 v[204:207], v26 offset:0
    ds_read_b128 v[180:183], v29 offset:0
    ds_read_b128 v[184:187], v29 offset:1024
    ds_read_b64 v[208:209], v27 offset:0
    ds_read_b128 v[188:191], v29 offset:2048
    ds_read_b128 v[212:215], v26 offset:1536
    ds_read_b128 v[192:195], v29 offset:3072
    ds_read_b128 v[196:199], v29 offset:4096
    ds_read_b64 v[216:217], v27 offset:1536
    ds_read_b128 v[200:203], v29 offset:5120
    s_waitcnt lgkmcnt(5)
    v_mfma_f32_16x16x32_bf16 v[220:223], v[180:183], v[204:207], 0
    v_mfma_f32_16x16x32_bf16 v[224:227], v[184:187], v[204:207], 0
    v_mfma_f32_16x16x32_bf16 v[224:227], v[188:191], v[208:211], v[224:227]
    ds_read_b128 v[204:207], v26 offset:3072
    ds_read_b128 v[180:183], v29 offset:6144
    ds_read_b128 v[184:187], v29 offset:7168
    ds_read_b64 v[208:209], v27 offset:3072
    ds_read_b128 v[188:191], v29 offset:8192
    s_waitcnt lgkmcnt(5)
    v_mfma_f32_16x16x32_bf16 v[220:223], v[192:195], v[212:215], v[220:223]
    v_mfma_f32_16x16x32_bf16 v[224:227], v[196:199], v[212:215], v[224:227]
    v_mfma_f32_16x16x32_bf16 v[224:227], v[200:203], v[216:219], v[224:227]
    ds_read_b128 v[212:215], v26 offset:4608
    ds_read_b128 v[192:195], v29 offset:9216
    ds_read_b128 v[196:199], v29 offset:10240
    ds_read_b64 v[216:217], v27 offset:4608
    ds_read_b128 v[200:203], v29 offset:11264
    s_waitcnt lgkmcnt(5)
    v_mfma_f32_16x16x32_bf16 v[220:223], v[180:183], v[204:207], v[220:223]
    v_mfma_f32_16x16x32_bf16 v[224:227], v[184:187], v[204:207], v[224:227]
    v_mfma_f32_16x16x32_bf16 v[224:227], v[188:191], v[208:211], v[224:227]
    s_waitcnt lgkmcnt(0)
    v_mfma_f32_16x16x32_bf16 v[220:223], v[192:195], v[212:215], v[220:223]
    v_mfma_f32_16x16x32_bf16 v[224:227], v[196:199], v[212:215], v[224:227]
    v_mfma_f32_16x16x32_bf16 v[224:227], v[200:203], v[216:219], v[224:227]
    s_nop 0
    v_cvt_pk_bf16_f32 v220, v220, v221
    v_cvt_pk_bf16_f32 v221, v222, v223
    s_nop 4
    v_cvt_pk_bf16_f32 v222, v224, v225
    v_cvt_pk_bf16_f32 v223, v226, v227
    buffer_store_dwordx4 v[220:223], v30, s[4:7], s49 offen sc1
    s_waitcnt vmcnt(1)
    v_cmp_lt_i32 vcc, v36, v35
    s_cbranch_vccz L_fok_39
L_fw_38:
    buffer_load_dword v36, v33, s[4:7], s38 offen sc1
    s_sub_u32 s36, s36, 1
    s_cbranch_scc1 L_exit
    s_waitcnt vmcnt(0)
    v_cmp_lt_i32 vcc, v36, v35
    s_cbranch_vccnz L_fw_38
L_fok_39:
    buffer_load_dwordx4 v37, s[4:7], s48 offen offset:0 sc1 lds
    buffer_load_dwordx4 v37, s[4:7], s48 offen offset:1024 sc1 lds
    buffer_load_dwordx4 v37, s[4:7], s48 offen offset:2048 sc1 lds
    s_waitcnt vmcnt(0) lgkmcnt(0)
    s_barrier
    s_add_u32 s56, s37, -1
    s_and_b32 s55, s56, 3
    s_mul_i32 s55, s55, 24576
    v_add_u32 v26, s55, v22
    v_add_u32 v27, s55, v23
    s_and_b32 s55, s56, 1
    s_mul_i32 s55, s55, 12288
    v_add_u32 v29, s55, v28
    s_mov_b32 s49, 5832704
    ds_read_b128 v[204:207], v26 offset:0
    ds_read_b128 v[180:183], v29 offset:0
    ds_read_b128 v[184:187], v29 offset:1024
    ds_read_b64 v[208:209], v27 offset:0
    ds_read_b128 v[188:191], v29 offset:2048
    ds_read_b128 v[212:215], v26 offset:1536
    ds_read_b128 v[192:195], v29 offset:3072
    ds_read_b128 v[196:199], v29 offset:4096
    ds_read_b64 v[216:217], v27 offset:1536
    ds_read_b128 v[200:203], v29 offset:5120
    s_waitcnt lgkmcnt(5)
    v_mfma_f32_16x16x32_bf16 v[220:223], v[180:183], v[204:207], 0
    v_mfma_f32_16x16x32_bf16 v[224:227], v[184:187], v[204:207], 0
    v_mfma_f32_16x16x32_bf16 v[224:227], v[188:191], v[208:211], v[224:227]
    ds_read_b128 v[204:207], v26 offset:3072
    ds_read_b128 v[180:183], v29 offset:6144
    ds_read_b128 v[184:187], v29 offset:7168
    ds_read_b64 v[208:209], v27 offset:3072
    ds_read_b128 v[188:191], v29 offset:8192
    s_waitcnt lgkmcnt(5)
    v_mfma_f32_16x16x32_bf16 v[220:223], v[192:195], v[212:215], v[220:223]
    v_mfma_f32_16x16x32_bf16 v[224:227], v[196:199], v[212:215], v[224:227]
    v_mfma_f32_16x16x32_bf16 v[224:227], v[200:203], v[216:219], v[224:227]
    ds_read_b128 v[212:215], v26 offset:4608
    ds_read_b128 v[192:195], v29 offset:9216
    ds_read_b128 v[196:199], v29 offset:10240
    ds_read_b64 v[216:217], v27 offset:4608
    ds_read_b128 v[200:203], v29 offset:11264
    s_waitcnt lgkmcnt(5)
    v_mfma_f32_16x16x32_bf16 v[220:223], v[180:183], v[204:207], v[220:223]
    v_mfma_f32_16x16x32_bf16 v[224:227], v[184:187], v[204:207], v[224:227]
    v_mfma_f32_16x16x32_bf16 v[224:227], v[188:191], v[208:211], v[224:227]
    s_waitcnt lgkmcnt(0)
    v_mfma_f32_16x16x32_bf16 v[220:223], v[192:195], v[212:215], v[220:223]
    v_mfma_f32_16x16x32_bf16 v[224:227], v[196:199], v[212:215], v[224:227]
    v_mfma_f32_16x16x32_bf16 v[224:227], v[200:203], v[216:219], v[224:227]
    s_nop 0
    v_cvt_pk_bf16_f32 v220, v220, v221
    v_cvt_pk_bf16_f32 v221, v222, v223
    s_nop 4
    v_cvt_pk_bf16_f32 v222, v224, v225
    v_cvt_pk_bf16_f32 v223, v226, v227
    buffer_store_dwordx4 v[220:223], v30, s[4:7], s49 offen sc1
    s_mov_b32 s51, 5832704
L_fp_40:
    buffer_load_dwordx4 v[120:123], v31, s[4:7], s51 offen sc1
    s_sub_u32 s36, s36, 1
    s_cbranch_scc1 L_exit
    s_waitcnt vmcnt(0)
    v_max3_u32 v41, v120, v121, v122
    v_max_u32 v41, v41, v123
    v_cmp_eq_u32 vcc, -1, v41
    s_cbranch_vccnz L_fp_40
    s_mov_b32 s51, 4849664
    buffer_load_dwordx4 v[148:151], v31, s[4:7], s51 offen sc1
    s_mov_b32 s51, 5177344
    buffer_load_dwordx4 v[152:155], v31, s[4:7], s51 offen sc1
    s_mov_b32 s51, 4194304
    buffer_load_dwordx4 v[156:159], v31, s[4:7], s51 offen sc1
    s_mov_b32 s51, 5505024
    buffer_load_dwordx4 v[160:163], v31, s[4:7], s51 offen sc1
    s_mov_b32 s52, 5079040
    v_mfma_f32_16x16x32_bf16 v[232:235], a[144:147], v[120:123], 0
    s_nop 7
    v_cndmask_b32 v234, v232, v233, s[58:59]
    v_cndmask_b32 v235, v233, v232, s[58:59]
    s_nop 1
    v_add_f32_dpp v235, v234, v235 row_ror:8 row_mask:0xf bank_mask:0xf
    v_cvt_pk_bf16_f32 v235, v235, v235
    buffer_store_short v235, v32, s[28:31], s52 offen
    s_waitcnt vmcnt(1)
    s_mov_b32 s52, 4751360
    v_mfma_f32_16x16x32_bf16 v[232:235], a[144:147], v[148:151], 0
    s_nop 7
    v_cndmask_b32 v234, v232, v233, s[58:59]
    v_cndmask_b32 v235, v233, v232, s[58:59]
    s_nop 1
    v_add_f32_dpp v235, v234, v235 row_ror:8 row_mask:0xf bank_mask:0xf
    v_cvt_pk_bf16_f32 v235, v235, v235
    buffer_store_short v235, v32, s[28:31], s52 offen
    s_mov_b32 s52, 4833280
    v_mfma_f32_16x16x32_bf16 v[232:235], a[144:147], v[152:155], 0
    s_nop 7
    v_cndmask_b32 v234, v232, v233, s[58:59]
    v_cndmask_b32 v235, v233, v232, s[58:59]
    s_nop 1
    v_add_f32_dpp v235, v234, v235 row_ror:8 row_mask:0xf bank_mask:0xf
    v_cvt_pk_bf16_f32 v235, v235, v235
    buffer_store_short v235, v32, s[28:31], s52 offen
    s_mov_b32 s52, 4915200
    v_mfma_f32_16x16x32_bf16 v[232:235], a[144:147], v[156:159], 0
    s_nop 7
    v_cndmask_b32 v234, v232, v233, s[58:59]
    v_cndmask_b32 v235, v233, v232, s[58:59]
    s_nop 1
    v_add_f32_dpp v235, v234, v235 row_ror:8 row_mask:0xf bank_mask:0xf
    v_cvt_pk_bf16_f32 v235, v235, v235
    buffer_store_short v235, v32, s[28:31], s52 offen
    s_mov_b32 s52, 4997120
    v_mfma_f32_16x16x32_bf16 v[232:235], a[144:147], v[160:163], 0
    s_nop 7
    v_cndmask_b32 v234, v232, v233, s[58:59]
    v_cndmask_b32 v235, v233, v232, s[58:59]
    s_nop 1
    v_add_f32_dpp v235, v234, v235 row_ror:8 row_mask:0xf bank_mask:0xf
    v_cvt_pk_bf16_f32 v235, v235, v235
    buffer_store_short v235, v32, s[28:31], s52 offen
    s_add_u32 s56, s37, 0
    s_and_b32 s55, s56, 3
    s_mul_i32 s55, s55, 114688
    s_add_u32 s55, s55, 53248
    s_add_u32 s48, s38, s55
    s_and_b32 s55, s56, 1
    s_add_u32 s56, s56, 1
    v_mov_b32 v35, -16
    v_writelane_b32 v35, s56, 12
    s_mul_i32 s55, s55, 12288
    s_add_u32 m0, s54, s55
    buffer_load_dword v36, v33, s[4:7], s38 offen sc1
    s_waitcnt vmcnt(0)
    v_cmp_lt_i32 vcc, v36, v35
    s_cbranch_vccz L_fok_42
L_fw_41:
    buffer_load_dword v36, v33, s[4:7], s38 offen sc1
    s_sub_u32 s36, s36, 1
    s_cbranch_scc1 L_exit
    s_waitcnt vmcnt(0)
    v_cmp_lt_i32 vcc, v36, v35
    s_cbranch_vccnz L_fw_41
L_fok_42:
    buffer_load_dwordx4 v37, s[4:7], s48 offen offset:0 sc1 lds
    buffer_load_dwordx4 v37, s[4:7], s48 offen offset:1024 sc1 lds
    buffer_load_dwordx4 v37, s[4:7], s48 offen offset:2048 sc1 lds
    s_waitcnt vmcnt(0) lgkmcnt(0)
    s_barrier
    s_add_u32 s56, s37, 0
    s_and_b32 s55, s56, 3
    s_mul_i32 s55, s55, 24576
    v_add_u32 v26, s55, v22
    v_add_u32 v27, s55, v23
    s_and_b32 s55, s56, 1
    s_mul_i32 s55, s55, 12288
    v_add_u32 v29, s55, v28
    s_mov_b32 s49, 6160384
    ds_read_b128 v[204:207], v26 offset:0
    ds_read_b128 v[180:183], v29 offset:0
    ds_read_b128 v[184:187], v29 offset:1024
    ds_read_b64 v[208:209], v27 offset:0
    ds_read_b128 v[188:191], v29 offset:2048
    ds_read_b128 v[212:215], v26 offset:1536
    ds_read_b128 v[192:195], v29 offset:3072
    ds_read_b128 v[196:199], v29 offset:4096
    ds_read_b64 v[216:217], v27 offset:1536
    ds_read_b128 v[200:203], v29 offset:5120
    s_waitcnt lgkmcnt(5)
    v_mfma_f32_16x16x32_bf16 v[220:223], v[180:183], v[204:207], 0
    v_mfma_f32_16x16x32_bf16 v[224:227], v[184:187], v[204:207], 0
    v_mfma_f32_16x16x32_bf16 v[224:227], v[188:191], v[208:211], v[224:227]
    ds_read_b128 v[204:207], v26 offset:3072
    ds_read_b128 v[180:183], v29 offset:6144
    ds_read_b128 v[184:187], v29 offset:7168
    ds_read_b64 v[208:209], v27 offset:3072
    ds_read_b128 v[188:191], v29 offset:8192
    s_waitcnt lgkmcnt(5)
    v_mfma_f32_16x16x32_bf16 v[220:223], v[192:195], v[212:215], v[220:223]
    v_mfma_f32_16x16x32_bf16 v[224:227], v[196:199], v[212:215], v[224:227]
    v_mfma_f32_16x16x32_bf16 v[224:227], v[200:203], v[216:219], v[224:227]
    ds_read_b128 v[212:215], v26 offset:4608
    ds_read_b128 v[192:195], v29 offset:9216
    ds_read_b128 v[196:199], v29 offset:10240
    ds_read_b64 v[216:217], v27 offset:4608
    ds_read_b128 v[200:203], v29 offset:11264
    s_waitcnt lgkmcnt(5)
    v_mfma_f32_16x16x32_bf16 v[220:223], v[180:183], v[204:207], v[220:223]
    v_mfma_f32_16x16x32_bf16 v[224:227], v[184:187], v[204:207], v[224:227]
    v_mfma_f32_16x16x32_bf16 v[224:227], v[188:191], v[208:211], v[224:227]
    s_waitcnt lgkmcnt(0)
    v_mfma_f32_16x16x32_bf16 v[220:223], v[192:195], v[212:215], v[220:223]
    v_mfma_f32_16x16x32_bf16 v[224:227], v[196:199], v[212:215], v[224:227]
    v_mfma_f32_16x16x32_bf16 v[224:227], v[200:203], v[216:219], v[224:227]
    s_nop 0
    v_cvt_pk_bf16_f32 v220, v220, v221
    v_cvt_pk_bf16_f32 v221, v222, v223
    s_nop 4
    v_cvt_pk_bf16_f32 v222, v224, v225
    v_cvt_pk_bf16_f32 v223, v226, v227
    buffer_store_dwordx4 v[220:223], v30, s[4:7], s49 offen sc1
    s_mov_b32 s51, 6160384
L_fp_43:
    buffer_load_dwordx4 v[120:123], v31, s[4:7], s51 offen sc1
    s_sub_u32 s36, s36, 1
    s_cbranch_scc1 L_exit
    s_waitcnt vmcnt(0)
    v_max3_u32 v41, v120, v121, v122
    v_max_u32 v41, v41, v123
    v_cmp_eq_u32 vcc, -1, v41
    s_cbranch_vccnz L_fp_43
    s_mov_b32 s52, 5160960
    v_mfma_f32_16x16x32_bf16 v[232:235], a[144:147], v[120:123], 0
    s_nop 7
    v_cndmask_b32 v234, v232, v233, s[58:59]
    v_cndmask_b32 v235, v233, v232, s[58:59]
    s_nop 1
    v_add_f32_dpp v235, v234, v235 row_ror:8 row_mask:0xf bank_mask:0xf
    v_cvt_pk_bf16_f32 v235, v235, v235
    buffer_store_short v235, v32, s[28:31], s52 offen
    s_endpgm
L_vm_30:
    buffer_load_dwordx4 v[136:139], v44, s[4:7], s43 offen offset:0 sc1
    buffer_load_dwordx4 v[140:143], v44, s[4:7], s43 offen offset:1024 sc1
    buffer_load_dwordx4 v[144:147], v44, s[4:7], s43 offen offset:2048 sc1
    s_sub_u32 s36, s36, 1
    s_cbranch_scc1 L_exit
    s_waitcnt vmcnt(0)
    v_max_u32 v4, v136, v137
    v_max3_u32 v4, v4, v138, v139
    v_max3_u32 v4, v4, v140, v141
    v_max3_u32 v4, v4, v142, v143
    v_max3_u32 v4, v4, v144, v145
    v_max3_u32 v4, v4, v146, v147
    v_cmp_eq_u32 vcc, -1, v4
    s_cbranch_vccnz L_vm_30
    buffer_load_dwordx4 v[92:95], v38, s[4:7], s43 offen offset:0 sc1
    buffer_load_dword v104, v39, s[4:7], s43 offen offset:0 sc1
    buffer_load_dwordx4 v[96:99], v38, s[4:7], s43 offen offset:1280 sc1
    buffer_load_dword v105, v39, s[4:7], s43 offen offset:1280 sc1
    buffer_load_dwordx4 v[100:103], v38, s[4:7], s43 offen offset:2560 sc1
    buffer_load_dword v106, v39, s[4:7], s43 offen offset:2560 sc1
    v_mov_b32 v148, 0
    v_mov_b32 v149, 0
    v_mov_b32 v150, 0
    v_mov_b32 v151, 0
    v_mov_b32 v152, 0
    v_mov_b32 v153, 0
    v_mov_b32 v154, 0
    v_mov_b32 v155, 0
    v_mov_b32 v156, 0
    v_mov_b32 v157, 0
    v_mov_b32 v158, 0
    v_mov_b32 v159, 0
    v_mov_b32 v160, 0
    v_mov_b32 v161, 0
    v_mov_b32 v162, 0
    v_mov_b32 v163, 0
    v_smfmac_f32_16x16x64_bf16 v[148:151], v[136:139], a[0:7], v10
    v_smfmac_f32_16x16x64_bf16 v[152:155], v[136:139], a[24:31], v10
    v_smfmac_f32_16x16x64_bf16 v[156:159], v[136:139], a[48:55], v10
    v_smfmac_f32_16x16x64_bf16 v[160:163], v[136:139], a[72:79], v10
    v_smfmac_f32_16x16x64_bf16 v[148:151], v[140:143], a[8:15], v10
    v_smfmac_f32_16x16x64_bf16 v[152:155], v[140:143], a[32:39], v10
    v_smfmac_f32_16x16x64_bf16 v[156:159], v[140:143], a[56:63], v10
    v_smfmac_f32_16x16x64_bf16 v[160:163], v[140:143], a[80:87], v10
    v_smfmac_f32_16x16x64_bf16 v[148:151], v[144:147], a[16:23], v10
    v_smfmac_f32_16x16x64_bf16 v[152:155], v[144:147], a[40:47], v10
    v_smfmac_f32_16x16x64_bf16 v[156:159], v[144:147], a[64:71], v10
    v_smfmac_f32_16x16x64_bf16 v[160:163], v[144:147], a[88:95], v10
    v_pk_add_f32 v[148:149], v[148:149], v[150:151]
    v_cmp_u_f32 vcc, v148, v149
    v_cvt_pk_bf16_f32 v50, v148, v149
    v_cvt_pk_bf16_f32 v54, v148, v149
    v_pk_add_f32 v[152:153], v[152:153], v[154:155]
    v_cvt_pk_bf16_f32 v58, v152, v153
    v_cvt_pk_bf16_f32 v62, v152, v153
    v_pk_add_f32 v[156:157], v[156:157], v[158:159]
    v_cvt_pk_bf16_f32 v66, v156, v157
    v_cvt_pk_bf16_f32 v70, v156, v157
    v_pk_add_f32 v[160:161], v[160:161], v[162:163]
    v_cvt_pk_bf16_f32 v74, v160, v161
    v_cvt_pk_bf16_f32 v78, v160, v161
    s_branch L_u_31
L_sp_33:
    v_max3_u32 v4, v104, v105, v106
    v_max3_u32 v4, v4, v92, v93
    v_max3_u32 v4, v4, v94, v95
    v_max3_u32 v4, v4, v96, v97
    v_max3_u32 v4, v4, v98, v99
    v_max3_u32 v4, v4, v100, v101
    v_max3_u32 v4, v4, v102, v103
    v_cmp_eq_u32 vcc, -1, v4
    s_cbranch_vccz L_sg_34
    buffer_load_dwordx4 v[92:95], v38, s[4:7], s43 offen offset:0 sc1
    buffer_load_dword v104, v39, s[4:7], s43 offen offset:0 sc1
    buffer_load_dwordx4 v[96:99], v38, s[4:7], s43 offen offset:1280 sc1
    buffer_load_dword v105, v39, s[4:7], s43 offen offset:1280 sc1
    buffer_load_dwordx4 v[100:103], v38, s[4:7], s43 offen offset:2560 sc1
    buffer_load_dword v106, v39, s[4:7], s43 offen offset:2560 sc1
    s_sub_u32 s36, s36, 1
    s_cbranch_scc1 L_exit
    s_branch L_sc_32
L_px_f:
    v_and_b32 v1, 15, v0
    v_lshrrev_b32 v2, 4, v0
    s_mul_i32 s90, s32, 12288
    v_lshl_add_u32 v10, v0, 4, s90
    s_mul_i32 s90, s32, 3072
    v_lshl_add_u32 v12, v0, 4, s90
    v_lshrrev_b32 v3, 2, v1
    v_lshlrev_b32 v3, 1, v3
    v_and_b32 v4, 1, v1
    v_or_b32 v3, v3, v4
    v_lshl_add_u32 v3, v2, 3, v3
    v_lshl_add_u32 v11, v3, 4, s90
    s_lshl_b32 s90, s32, 7
    v_min_u32 v3, 11, v0
    v_lshl_add_u32 v3, v3, 2, s90
    v_add_u32 v13, 458752, v3
    v_min_u32 v3, 2, v0
    v_lshl_add_u32 v3, v3, 2, s90
    v_add_u32 v14, 459264, v3
    v_add_u32 v22, 462336, v3
    s_add_u32 s90, s90, 459776
    v_mov_b32 v15, s90
    v_cmp_eq_u32 vcc, 0, v0
    v_mov_b32 v9, 2146435072
    s_nop 0
    v_cndmask_b32 v15, v9, v15, vcc
    s_nop 0
    v_mov_b32 v21, 0xd04e79ff
    s_mov_b32 s44, 0x3dd53b95
    v_lshl_add_u32 v3, v2, 2, 0
    v_cmp_le_u32 s[48:49], v3, v1
    v_lshl_add_u32 v3, v2, 2, 1
    v_cmp_le_u32 s[50:51], v3, v1
    v_lshl_add_u32 v3, v2, 2, 2
    v_cmp_le_u32 s[52:53], v3, v1
    v_lshl_add_u32 v3, v2, 2, 3
    v_cmp_le_u32 s[54:55], v3, v1
    v_mov_b32 v167, 0
    v_mov_b32 v171, 0
    v_mov_b32 v174, 0
    v_mov_b32 v175, 0
    s_waitcnt vmcnt(0)
    s_barrier
    s_mov_b32 s37, 0
    s_or_b32 s90, s34, s32
    s_cbranch_scc1 L_xg_44c
    v_lshlrev_b32 v1, 2, v0
L_arp_46:
    buffer_load_dword v2, v1, s[8:11], 0 offen sc1
    s_sub_u32 s36, s36, 1
    s_cbranch_scc1 L_exit
    s_waitcnt vmcnt(0)
    v_readlane_b32 s92, v2, 12
    v_readlane_b32 s93, v2, 44
    v_cmp_eq_u32 s[90:91], 32, v2
    s_add_u32 s92, s92, s93
    s_cmp_lg_u32 s92, 256
    s_cbranch_scc1 L_arp_46
    s_and_b32 s90, s90, s91
    s_and_b32 s90, s90, 15
    s_cmp_lg_u32 s90, 15
    s_cbranch_scc1 L_arr_45
    v_mov_b32 v1, 192
    v_mov_b32 v2, 1
    s_mov_b64 exec, 1
    buffer_store_dword v2, v1, s[8:11], 0 offen sc1
    s_mov_b64 exec, -1
L_arr_45:
L_xg_44c:
    s_barrier
    v_mov_b32 v1, 192
L_gw_47:
    buffer_load_dword v2, v1, s[8:11], 0 offen sc1
    s_sub_u32 s36, s36, 1
    s_cbranch_scc1 L_exit
    s_waitcnt vmcnt(0)
    v_readfirstlane_b32 s90, v2
    s_nop 0
    s_cmp_eq_u32 s90, 0
    s_cbranch_scc1 L_gw_47
    s_cmp_lg_u32 s90, 1
    s_cbranch_scc1 L_slow
    s_cmp_lg_u32 s32, 0
    s_cbranch_scc1 L_xg_44
    s_lshl_b32 s92, s34, 14
    s_add_u32 s92, s92, 1966080
    s_add_u32 s93, s92, 8192
    v_lshlrev_b32 v3, 4, v0
    buffer_store_dwordx4 v[24:27], v3, s[4:7], s92 offen offset:0 sc1
    buffer_store_dwordx4 v[24:27], v3, s[4:7], s93 offen offset:0 sc1
    buffer_store_dwordx4 v[24:27], v3, s[4:7], s92 offen offset:1024 sc1
    buffer_store_dwordx4 v[24:27], v3, s[4:7], s93 offen offset:1024 sc1
    buffer_store_dwordx4 v[24:27], v3, s[4:7], s92 offen offset:2048 sc1
    buffer_store_dwordx4 v[24:27], v3, s[4:7], s93 offen offset:2048 sc1
    buffer_store_dwordx4 v[24:27], v3, s[4:7], s92 offen offset:3072 sc1
    buffer_store_dwordx4 v[24:27], v3, s[4:7], s93 offen offset:3072 sc1
    v_mov_b32 v3, 0
    s_mov_b32 s56, -1
    s_mov_b32 s57, -1
    s_mov_b32 s62, 0
    s_mov_b32 s63, 0
    s_waitcnt vmcnt(0)
L_pr_48:
    s_memtime s[58:59]
    s_waitcnt lgkmcnt(0)
    buffer_load_dword v4, v3, s[4:7], s92 offen sc1
    s_waitcnt vmcnt(0)
    s_memtime s[60:61]
    s_waitcnt lgkmcnt(0)
    s_sub_u32 s60, s60, s58
    s_min_u32 s56, s56, s60
    s_memtime s[58:59]
    s_waitcnt lgkmcnt(0)
    buffer_load_dword v4, v3, s[4:7], s93 offen sc1
    s_waitcnt vmcnt(0)
    s_memtime s[60:61]
    s_waitcnt lgkmcnt(0)
    s_sub_u32 s60, s60, s58
    s_min_u32 s57, s57, s60
    buffer_load_dword v4, v13, s[4:7], s38 offen sc1
    v_add_u32 v3, 128, v3
    s_add_u32 s62, s62, 1
    s_waitcnt vmcnt(0)
    v_cmp_eq_u32 vcc, 0, v4
    s_nop 0
    s_cmp_eq_u64 vcc, 0
    s_addc_u32 s63, s63, 0
    s_cmp_ge_u32 s63, 2
    s_cselect_b32 s62, 32, s62
    s_cmp_lt_u32 s62, 32
    s_cbranch_scc1 L_pr_48
    s_cmp_lt_u32 s57, s56
    s_cselect_b32 s62, 2, 1
    s_nop 0
    v_mov_b32 v3, 460288
    v_mov_b32 v4, s62
    buffer_store_dword v4, v3, s[4:7], s38 offen
    s_cmp_lg_u32 s34, 0
    s_cbranch_scc1 L_xg_44
    v_mov_b32 v3, 200
    buffer_store_dword v4, v3, s[8:11], 0 offen sc1
L_xg_44:
    s_barrier
    s_add_u32 s41, s38, 475136
L_pf_49:
    buffer_load_dword v16, v22, s[4:7], s38 offen sc1
    s_sub_u32 s36, s36, 1
    s_cbranch_scc1 L_exit
    s_waitcnt vmcnt(0)
    v_cmp_ge_u32 vcc, s37, v16
    s_cbranch_vccnz L_pf_49
    s_add_u32 s90, s41, 49152
    buffer_load_dwordx4 v[72:75], v10, s[4:7], s90 offen offset:0 sc1
    buffer_load_dwordx4 v[76:79], v10, s[4:7], s90 offen offset:1024 sc1
    buffer_load_dwordx4 v[80:83], v10, s[4:7], s90 offen offset:2048 sc1
    buffer_load_dwordx4 v[84:87], v10, s[4:7], s90 offen offset:3072 sc1
    s_add_u32 s90, s41, 53248
    buffer_load_dwordx4 v[88:91], v10, s[4:7], s90 offen offset:0 sc1
    buffer_load_dwordx4 v[92:95], v10, s[4:7], s90 offen offset:1024 sc1
    buffer_load_dwordx4 v[96:99], v10, s[4:7], s90 offen offset:2048 sc1
    buffer_load_dwordx4 v[100:103], v10, s[4:7], s90 offen offset:3072 sc1
    s_add_u32 s90, s41, 57344
    buffer_load_dwordx4 v[104:107], v10, s[4:7], s90 offen offset:0 sc1
    buffer_load_dwordx4 v[108:111], v10, s[4:7], s90 offen offset:1024 sc1
    buffer_load_dwordx4 v[112:115], v10, s[4:7], s90 offen offset:2048 sc1
    buffer_load_dwordx4 v[116:119], v10, s[4:7], s90 offen offset:3072 sc1
    s_add_u32 s90, s41, 0
    buffer_load_dwordx4 v[24:27], v10, s[4:7], s90 offen offset:0 sc1
    buffer_load_dwordx4 v[28:31], v10, s[4:7], s90 offen offset:1024 sc1
    buffer_load_dwordx4 v[32:35], v10, s[4:7], s90 offen offset:2048 sc1
    buffer_load_dwordx4 v[36:39], v10, s[4:7], s90 offen offset:3072 sc1
    s_add_u32 s90, s41, 4096
    buffer_load_dwordx4 v[40:43], v10, s[4:7], s90 offen offset:0 sc1
    buffer_load_dwordx4 v[44:47], v10, s[4:7], s90 offen offset:1024 sc1
    buffer_load_dwordx4 v[48:51], v10, s[4:7], s90 offen offset:2048 sc1
    buffer_load_dwordx4 v[52:55], v10, s[4:7], s90 offen offset:3072 sc1
    s_add_u32 s90, s41, 8192
    buffer_load_dwordx4 v[56:59], v10, s[4:7], s90 offen offset:0 sc1
    buffer_load_dwordx4 v[60:63], v10, s[4:7], s90 offen offset:1024 sc1
    buffer_load_dwordx4 v[64:67], v10, s[4:7], s90 offen offset:2048 sc1
    buffer_load_dwordx4 v[68:71], v10, s[4:7], s90 offen offset:3072 sc1
    s_waitcnt vmcnt(0)
L_px_loop_f:
    s_and_b32 s90, s37, 3
    s_mul_i32 s91, s90, 114688
    s_add_u32 s91, s91, s38
    s_add_u32 s42, s91, 40960
    s_add_u32 s43, s91, 53248
    s_add_u32 s90, s37, 1
    v_mov_b32 v17, s90
    s_and_b32 s90, s90, 3
    s_mul_i32 s91, s90, 98304
    s_add_u32 s91, s91, 475136
    s_add_u32 s41, s38, s91
    v_mfma_f32_16x16x32_bf16 v[144:147], v[72:75], v[24:27], 0
    v_mfma_f32_16x16x32_bf16 v[152:155], v[72:75], v[48:51], 0
    v_mfma_f32_16x16x32_bf16 v[156:159], v[96:99], v[48:51], 0
    v_mfma_f32_16x16x32_bf16 v[144:147], v[76:79], v[28:31], v[144:147]
    v_mfma_f32_16x16x32_bf16 v[152:155], v[76:79], v[52:55], v[152:155]
    v_mfma_f32_16x16x32_bf16 v[156:159], v[100:103], v[52:55], v[156:159]
    v_mfma_f32_16x16x32_bf16 v[144:147], v[80:83], v[32:35], v[144:147]
    v_mfma_f32_16x16x32_bf16 v[152:155], v[80:83], v[56:59], v[152:155]
    v_mfma_f32_16x16x32_bf16 v[156:159], v[104:107], v[56:59], v[156:159]
    v_mfma_f32_16x16x32_bf16 v[144:147], v[84:87], v[36:39], v[144:147]
    v_mfma_f32_16x16x32_bf16 v[152:155], v[84:87], v[60:63], v[152:155]
    v_mfma_f32_16x16x32_bf16 v[156:159], v[108:111], v[60:63], v[156:159]
    v_mfma_f32_16x16x32_bf16 v[144:147], v[88:91], v[40:43], v[144:147]
    v_mfma_f32_16x16x32_bf16 v[152:155], v[88:91], v[64:67], v[152:155]
    v_mfma_f32_16x16x32_bf16 v[156:159], v[112:115], v[64:67], v[156:159]
    v_mfma_f32_16x16x32_bf16 v[144:147], v[92:95], v[44:47], v[144:147]
    v_mfma_f32_16x16x32_bf16 v[152:155], v[92:95], v[68:71], v[152:155]
    v_mfma_f32_16x16x32_bf16 v[156:159], v[116:119], v[68:71], v[156:159]
    s_nop 0
    v_cndmask_b32 v144, v21, v144, s[48:49]
    v_cndmask_b32 v145, v21, v145, s[50:51]
    v_cndmask_b32 v146, v21, v146, s[52:53]
    v_cndmask_b32 v147, v21, v147, s[54:55]
    s_nop 2
    v_cndmask_b32 v156, v21, v156, s[48:49]
    v_cndmask_b32 v157, v21, v157, s[50:51]
    v_cndmask_b32 v158, v21, v158, s[52:53]
    v_cndmask_b32 v159, v21, v159, s[54:55]
L_pf_50:
    buffer_load_dword v16, v14, s[4:7], s38 offen sc1
    s_sub_u32 s36, s36, 1
    s_cbranch_scc1 L_exit
    s_waitcnt vmcnt(0)
    v_cmp_ge_u32 vcc, s37, v16
    s_cbranch_vccnz L_pf_50
    buffer_load_dwordx4 v[120:123], v11, s[4:7], s42 offen offset:0 sc1
    buffer_load_dwordx4 v[124:127], v11, s[4:7], s42 offen offset:512 sc1
    buffer_load_dwordx4 v[128:131], v11, s[4:7], s42 offen offset:1024 sc1
    buffer_load_dwordx4 v[132:135], v11, s[4:7], s42 offen offset:1536 sc1
    buffer_load_dwordx4 v[136:139], v11, s[4:7], s42 offen offset:2048 sc1
    buffer_load_dwordx4 v[140:143], v11, s[4:7], s42 offen offset:2560 sc1
    s_waitcnt vmcnt(5)
    v_mfma_f32_16x16x32_bf16 v[148:151], v[120:123], v[24:27], 0
    v_mfma_f32_16x16x32_bf16 v[160:163], v[120:123], v[48:51], 0
    s_waitcnt vmcnt(4)
    v_mfma_f32_16x16x32_bf16 v[148:151], v[124:127], v[28:31], v[148:151]
    v_mfma_f32_16x16x32_bf16 v[160:163], v[124:127], v[52:55], v[160:163]
    s_waitcnt vmcnt(3)
    v_mfma_f32_16x16x32_bf16 v[148:151], v[128:131], v[32:35], v[148:151]
    v_mfma_f32_16x16x32_bf16 v[160:163], v[128:131], v[56:59], v[160:163]
    s_waitcnt vmcnt(2)
    v_mfma_f32_16x16x32_bf16 v[148:151], v[132:135], v[36:39], v[148:151]
    v_mfma_f32_16x16x32_bf16 v[160:163], v[132:135], v[60:63], v[160:163]
    s_waitcnt vmcnt(1)
    v_mfma_f32_16x16x32_bf16 v[148:151], v[136:139], v[40:43], v[148:151]
    v_mfma_f32_16x16x32_bf16 v[160:163], v[136:139], v[64:67], v[160:163]
    s_waitcnt vmcnt(0)
    v_mfma_f32_16x16x32_bf16 v[148:151], v[140:143], v[44:47], v[148:151]
    v_mfma_f32_16x16x32_bf16 v[160:163], v[140:143], v[68:71], v[160:163]
    s_cmp_eq_u32 s37, 63
    s_nop 2
    s_cbranch_scc1 L_pxl_51
    s_add_u32 s90, s41, 49152
    v_max_f32 v18, v144, v145
    v_max3_f32 v18, v18, v146, v147
    v_max3_f32 v18, v18, v148, v149
    v_mov_b32 v19, v18
    buffer_load_dwordx4 v[72:75], v10, s[4:7], s90 offen offset:0 sc1
    s_nop 0
    v_permlane16_swap_b32 v18, v19
    v_max_f32 v18, v18, v19
    v_mov_b32 v19, v18
    s_nop 1
    v_permlane32_swap_b32 v18, v19
    buffer_load_dwordx4 v[76:79], v10, s[4:7], s90 offen offset:1024 sc1
    v_max_f32 v18, v18, v19
    v_mul_f32 v18, 0xbdd53b95, v18
    v_fma_f32 v144, v144, s44, v18
    v_fma_f32 v145, v145, s44, v18
    buffer_load_dwordx4 v[80:83], v10, s[4:7], s90 offen offset:2048 sc1
    v_fma_f32 v146, v146, s44, v18
    v_fma_f32 v147, v147, s44, v18
    v_fma_f32 v148, v148, s44, v18
    v_fma_f32 v149, v149, s44, v18
    buffer_load_dwordx4 v[84:87], v10, s[4:7], s90 offen offset:3072 sc1
    v_exp_f32 v144, v144
    v_exp_f32 v145, v145
    v_exp_f32 v146, v146
    v_exp_f32 v147, v147
    s_add_u32 s90, s41, 53248
    v_exp_f32 v148, v148
    v_exp_f32 v149, v149
    v_add_f32 v20, v144, v145
    v_add_f32 v20, v20, v146
    buffer_load_dwordx4 v[88:91], v10, s[4:7], s90 offen offset:0 sc1
    v_add_f32 v20, v20, v147
    v_add_f32 v20, v20, v148
    v_add_f32 v20, v20, v149
    v_mov_b32 v19, v20
    buffer_load_dwordx4 v[92:95], v10, s[4:7], s90 offen offset:1024 sc1
    s_nop 0
    v_permlane16_swap_b32 v20, v19
    v_add_f32 v20, v20, v19
    v_mov_b32 v19, v20
    s_nop 1
    v_permlane32_swap_b32 v20, v19
    buffer_load_dwordx4 v[96:99], v10, s[4:7], s90 offen offset:2048 sc1
    v_add_f32 v20, v20, v19
    v_rcp_f32 v20, v20
    s_nop 0
    v_mul_f32 v144, v144, v20
    v_mul_f32 v145, v145, v20
    buffer_load_dwordx4 v[100:103], v10, s[4:7], s90 offen offset:3072 sc1
    v_mul_f32 v146, v146, v20
    v_mul_f32 v147, v147, v20
    v_mul_f32 v148, v148, v20
    v_mul_f32 v149, v149, v20
    s_add_u32 s90, s41, 57344
    v_cvt_pk_bf16_f32 v164, v144, v145
    v_cvt_pk_bf16_f32 v165, v146, v147
    v_cvt_pk_bf16_f32 v166, v148, v149
    v_max_f32 v18, v152, v153
    buffer_load_dwordx4 v[104:107], v10, s[4:7], s90 offen offset:0 sc1
    v_max3_f32 v18, v18, v154, v155
    v_max3_f32 v18, v18, v160, v161
    v_max3_f32 v18, v18, v156, v157
    v_max3_f32 v18, v18, v158, v159
    buffer_load_dwordx4 v[108:111], v10, s[4:7], s90 offen offset:1024 sc1
    v_mov_b32 v19, v18
    s_nop 1
    v_permlane16_swap_b32 v18, v19
    v_max_f32 v18, v18, v19
    v_mov_b32 v19, v18
    buffer_load_dwordx4 v[112:115], v10, s[4:7], s90 offen offset:2048 sc1
    s_nop 0
    v_permlane32_swap_b32 v18, v19
    v_max_f32 v18, v18, v19
    v_mul_f32 v18, 0xbdd53b95, v18
    v_fma_f32 v152, v152, s44, v18
    buffer_load_dwordx4 v[116:119], v10, s[4:7], s90 offen offset:3072 sc1
    v_fma_f32 v153, v153, s44, v18
    v_fma_f32 v154, v154, s44, v18
    v_fma_f32 v155, v155, s44, v18
    v_fma_f32 v160, v160, s44, v18
    s_add_u32 s90, s41, 0
    v_fma_f32 v161, v161, s44, v18
    v_fma_f32 v156, v156, s44, v18
    v_fma_f32 v157, v157, s44, v18
    v_fma_f32 v158, v158, s44, v18
    buffer_load_dwordx4 v[24:27], v10, s[4:7], s90 offen offset:0 sc1
    v_fma_f32 v159, v159, s44, v18
    v_exp_f32 v152, v152
    v_exp_f32 v153, v153
    v_exp_f32 v154, v154
    buffer_load_dwordx4 v[28:31], v10, s[4:7], s90 offen offset:1024 sc1
    v_exp_f32 v155, v155
    v_exp_f32 v160, v160
    v_exp_f32 v161, v161
    v_exp_f32 v156, v156
    buffer_load_dwordx4 v[32:35], v10, s[4:7], s90 offen offset:2048 sc1
    v_exp_f32 v157, v157
    v_exp_f32 v158, v158
    v_exp_f32 v159, v159
    v_add_f32 v20, v152, v153
    buffer_load_dwordx4 v[36:39], v10, s[4:7], s90 offen offset:3072 sc1
    v_add_f32 v20, v20, v154
    v_add_f32 v20, v20, v155
    v_add_f32 v20, v20, v160
    v_add_f32 v20, v20, v161
    s_add_u32 s90, s41, 4096
    v_add_f32 v20, v20, v156
    v_add_f32 v20, v20, v157
    v_add_f32 v20, v20, v158
    v_add_f32 v20, v20, v159
    buffer_load_dwordx4 v[40:43], v10, s[4:7], s90 offen offset:0 sc1
    v_mov_b32 v19, v20
    s_nop 1
    v_permlane16_swap_b32 v20, v19
    v_add_f32 v20, v20, v19
    v_mov_b32 v19, v20
    buffer_load_dwordx4 v[44:47], v10, s[4:7], s90 offen offset:1024 sc1
    s_nop 0
    v_permlane32_swap_b32 v20, v19
    v_add_f32 v20, v20, v19
    v_rcp_f32 v20, v20
    s_nop 0
    v_mul_f32 v152, v152, v20
    buffer_load_dwordx4 v[48:51], v10, s[4:7], s90 offen offset:2048 sc1
    v_mul_f32 v153, v153, v20
    v_mul_f32 v154, v154, v20
    v_mul_f32 v155, v155, v20
    v_mul_f32 v160, v160, v20
    buffer_load_dwordx4 v[52:55], v10, s[4:7], s90 offen offset:3072 sc1
    v_mul_f32 v161, v161, v20
    v_mul_f32 v156, v156, v20
    v_mul_f32 v157, v157, v20
    v_mul_f32 v158, v158, v20
    s_add_u32 s90, s41, 8192
    v_mul_f32 v159, v159, v20
    v_cvt_pk_bf16_f32 v168, v152, v153
    v_cvt_pk_bf16_f32 v169, v154, v155
    v_cvt_pk_bf16_f32 v170, v160, v161
    buffer_load_dwordx4 v[56:59], v10, s[4:7], s90 offen offset:0 sc1
    v_cvt_pk_bf16_f32 v172, v156, v157
    v_cvt_pk_bf16_f32 v173, v158, v159
    buffer_load_dwordx4 v[60:63], v10, s[4:7], s90 offen offset:1024 sc1
    buffer_load_dwordx4 v[64:67], v10, s[4:7], s90 offen offset:2048 sc1
    buffer_load_dwordx4 v[68:71], v10, s[4:7], s90 offen offset:3072 sc1
    buffer_store_dwordx4 v[164:167], v12, s[4:7], s43 offen offset:0
    buffer_store_dwordx4 v[168:171], v12, s[4:7], s43 offen offset:1024
    buffer_store_dwordx4 v[172:175], v12, s[4:7], s43 offen offset:2048
    s_waitcnt vmcnt(0)
    buffer_store_dword v17, v15, s[4:7], s38 offen
    s_add_u32 s37, s37, 1
    s_branch L_px_loop_f
L_pxl_51:
    v_max_f32 v18, v144, v145
    v_max3_f32 v18, v18, v146, v147
    v_max3_f32 v18, v18, v148, v149
    v_mov_b32 v19, v18
    s_nop 1
    v_permlane16_swap_b32 v18, v19
    v_max_f32 v18, v18, v19
    v_mov_b32 v19, v18
    s_nop 1
    v_permlane32_swap_b32 v18, v19
    v_max_f32 v18, v18, v19
    v_mul_f32 v18, 0xbdd53b95, v18
    v_fma_f32 v144, v144, s44, v18
    v_fma_f32 v145, v145, s44, v18
    v_fma_f32 v146, v146, s44, v18
    v_fma_f32 v147, v147, s44, v18
    v_fma_f32 v148, v148, s44, v18
    v_fma_f32 v149, v149, s44, v18
    v_exp_f32 v144, v144
    v_exp_f32 v145, v145
    v_exp_f32 v146, v146
    v_exp_f32 v147, v147
    v_exp_f32 v148, v148
    v_exp_f32 v149, v149
    v_add_f32 v20, v144, v145
    v_add_f32 v20, v20, v146
    v_add_f32 v20, v20, v147
    v_add_f32 v20, v20, v148
    v_add_f32 v20, v20, v149
    v_mov_b32 v19, v20
    s_nop 1
    v_permlane16_swap_b32 v20, v19
    v_add_f32 v20, v20, v19
    v_mov_b32 v19, v20
    s_nop 1
    v_permlane32_swap_b32 v20, v19
    v_add_f32 v20, v20, v19
    v_rcp_f32 v20, v20
    s_nop 0
    v_mul_f32 v144, v144, v20
    v_mul_f32 v145, v145, v20
    v_mul_f32 v146, v146, v20
    v_mul_f32 v147, v147, v20
    v_mul_f32 v148, v148, v20
    v_mul_f32 v149, v149, v20
    v_cvt_pk_bf16_f32 v164, v144, v145
    v_cvt_pk_bf16_f32 v165, v146, v147
    v_cvt_pk_bf16_f32 v166, v148, v149
    v_max_f32 v18, v152, v153
    v_max3_f32 v18, v18, v154, v155
    v_max3_f32 v18, v18, v160, v161
    v_max3_f32 v18, v18, v156, v157
    v_max3_f32 v18, v18, v158, v159
    v_mov_b32 v19, v18
    s_nop 1
    v_permlane16_swap_b32 v18, v19
    v_max_f32 v18, v18, v19
    v_mov_b32 v19, v18
    s_nop 1
    v_permlane32_swap_b32 v18, v19
    v_max_f32 v18, v18, v19
    v_mul_f32 v18, 0xbdd53b95, v18
    v_fma_f32 v152, v152, s44, v18
    v_fma_f32 v153, v153, s44, v18
    v_fma_f32 v154, v154, s44, v18
    v_fma_f32 v155, v155, s44, v18
    v_fma_f32 v160, v160, s44, v18
    v_fma_f32 v161, v161, s44, v18
    v_fma_f32 v156, v156, s44, v18
    v_fma_f32 v157, v157, s44, v18
    v_fma_f32 v158, v158, s44, v18
    v_fma_f32 v159, v159, s44, v18
    v_exp_f32 v152, v152
    v_exp_f32 v153, v153
    v_exp_f32 v154, v154
    v_exp_f32 v155, v155
    v_exp_f32 v160, v160
    v_exp_f32 v161, v161
    v_exp_f32 v156, v156
    v_exp_f32 v157, v157
    v_exp_f32 v158, v158
    v_exp_f32 v159, v159
    v_add_f32 v20, v152, v153
    v_add_f32 v20, v20, v154
    v_add_f32 v20, v20, v155
    v_add_f32 v20, v20, v160
    v_add_f32 v20, v20, v161
    v_add_f32 v20, v20, v156
    v_add_f32 v20, v20, v157
    v_add_f32 v20, v20, v158
    v_add_f32 v20, v20, v159
    v_mov_b32 v19, v20
    s_nop 1
    v_permlane16_swap_b32 v20, v19
    v_add_f32 v20, v20, v19
    v_mov_b32 v19, v20
    s_nop 1
    v_permlane32_swap_b32 v20, v19
    v_add_f32 v20, v20, v19
    v_rcp_f32 v20, v20
    s_nop 0
    v_mul_f32 v152, v152, v20
    v_mul_f32 v153, v153, v20
    v_mul_f32 v154, v154, v20
    v_mul_f32 v155, v155, v20
    v_mul_f32 v160, v160, v20
    v_mul_f32 v161, v161, v20
    v_mul_f32 v156, v156, v20
    v_mul_f32 v157, v157, v20
    v_mul_f32 v158, v158, v20
    v_mul_f32 v159, v159, v20
    v_cvt_pk_bf16_f32 v168, v152, v153
    v_cvt_pk_bf16_f32 v169, v154, v155
    v_cvt_pk_bf16_f32 v170, v160, v161
    v_cvt_pk_bf16_f32 v172, v156, v157
    v_cvt_pk_bf16_f32 v173, v158, v159
    buffer_store_dwordx4 v[164:167], v12, s[4:7], s43 offen offset:0
    buffer_store_dwordx4 v[168:171], v12, s[4:7], s43 offen offset:1024
    buffer_store_dwordx4 v[172:175], v12, s[4:7], s43 offen offset:2048
    s_waitcnt vmcnt(0)
    buffer_store_dword v17, v15, s[4:7], s38 offen
    s_endpgm
L_pa_f:
    v_mov_b32 v1, 192
L_gw_52:
    buffer_load_dword v2, v1, s[8:11], 0 offen sc1
    s_sub_u32 s36, s36, 1
    s_cbranch_scc1 L_exit
    s_waitcnt vmcnt(0)
    v_readfirstlane_b32 s90, v2
    s_nop 0
    s_cmp_eq_u32 s90, 0
    s_cbranch_scc1 L_gw_52
    s_cmp_lg_u32 s90, 1
    s_cbranch_scc1 L_slow
    s_branch L_pa_body
L_pa_body:
    s_sub_u32 s90, s35, 29
    s_cmp_ge_u32 s90, 3
    s_cbranch_scc1 L_pa_end
    s_mul_i32 s52, s90, 3
    s_add_u32 s52, s52, s34
    s_and_b32 s52, s52, 7
    s_lshl_b32 s90, s90, 3
    s_add_u32 s54, s90, s34
    s_mul_i32 s40, s54, 112
    s_lshl_b32 s90, s32, 5
    s_add_u32 s40, s40, s90
    s_sub_u32 s40, s40, 16
    s_mov_b32 s12, s64
    s_and_b32 s13, s65, 0xffff
    s_mov_b32 s14, 2621440
    s_mov_b32 s15, 0x20000
    s_mov_b32 s16, s66
    s_and_b32 s17, s67, 0xffff
    s_mov_b32 s18, 2457600
    s_mov_b32 s19, 0x20000
    s_mov_b32 s20, s68
    s_and_b32 s21, s69, 0xffff
    s_mov_b32 s22, 819200
    s_mov_b32 s23, 0x20000
    v_and_b32 v1, 15, v0
    v_lshrrev_b32 v2, 4, v0
    s_add_u32 s90, s40, 0
    v_add_u32 v3, s90, v1
    v_cmp_gt_u32 vcc, 2048, v3
    v_mul_u32_u24 v3, 1280, v3
    v_lshl_add_u32 v3, v2, 4, v3
    v_mov_b32 v4, 2146435072
    v_cndmask_b32 v3, v4, v3, vcc
    buffer_load_dwordx4 a[0:3], v3, s[12:15], 0 offen offset:0
    buffer_load_dwordx4 a[4:7], v3, s[12:15], 0 offen offset:64
    buffer_load_dwordx4 a[8:11], v3, s[12:15], 0 offen offset:128
    buffer_load_dwordx4 a[12:15], v3, s[12:15], 0 offen offset:192
    buffer_load_dwordx4 a[16:19], v3, s[12:15], 0 offen offset:256
    buffer_load_dwordx4 a[20:23], v3, s[12:15], 0 offen offset:320
    buffer_load_dwordx4 a[24:27], v3, s[12:15], 0 offen offset:384
    buffer_load_dwordx4 a[28:31], v3, s[12:15], 0 offen offset:448
    buffer_load_dwordx4 a[32:35], v3, s[12:15], 0 offen offset:512
    buffer_load_dwordx4 a[36:39], v3, s[12:15], 0 offen offset:576
    buffer_load_dwordx4 a[40:43], v3, s[12:15], 0 offen offset:640
    buffer_load_dwordx4 a[44:47], v3, s[12:15], 0 offen offset:704
    buffer_load_dwordx4 a[48:51], v3, s[12:15], 0 offen offset:768
    buffer_load_dwordx4 a[52:55], v3, s[12:15], 0 offen offset:832
    buffer_load_dwordx4 a[56:59], v3, s[12:15], 0 offen offset:896
    buffer_load_dwordx4 a[60:63], v3, s[12:15], 0 offen offset:960
    buffer_load_dwordx4 a[64:67], v3, s[12:15], 0 offen offset:1024
    buffer_load_dwordx4 a[68:71], v3, s[12:15], 0 offen offset:1088
    buffer_load_dwordx4 a[72:75], v3, s[12:15], 0 offen offset:1152
    buffer_load_dwordx4 a[76:79], v3, s[12:15], 0 offen offset:1216
    s_add_u32 s90, s40, 16
    v_add_u32 v3, s90, v1
    v_cmp_gt_u32 vcc, 2048, v3
    v_mul_u32_u24 v3, 1280, v3
    v_lshl_add_u32 v3, v2, 4, v3
    v_mov_b32 v4, 2146435072
    v_cndmask_b32 v3, v4, v3, vcc
    buffer_load_dwordx4 a[80:83], v3, s[12:15], 0 offen offset:0
    buffer_load_dwordx4 a[84:87], v3, s[12:15], 0 offen offset:64
    buffer_load_dwordx4 a[88:91], v3, s[12:15], 0 offen offset:128
    buffer_load_dwordx4 a[92:95], v3, s[12:15], 0 offen offset:192
    buffer_load_dwordx4 a[96:99], v3, s[12:15], 0 offen offset:256
    buffer_load_dwordx4 a[100:103], v3, s[12:15], 0 offen offset:320
    buffer_load_dwordx4 a[104:107], v3, s[12:15], 0 offen offset:384
    buffer_load_dwordx4 a[108:111], v3, s[12:15], 0 offen offset:448
    buffer_load_dwordx4 a[112:115], v3, s[12:15], 0 offen offset:512
    buffer_load_dwordx4 a[116:119], v3, s[12:15], 0 offen offset:576
    buffer_load_dwordx4 a[120:123], v3, s[12:15], 0 offen offset:640
    buffer_load_dwordx4 a[124:127], v3, s[12:15], 0 offen offset:704
    buffer_load_dwordx4 a[128:131], v3, s[12:15], 0 offen offset:768
    buffer_load_dwordx4 a[132:135], v3, s[12:15], 0 offen offset:832
    buffer_load_dwordx4 a[136:139], v3, s[12:15], 0 offen offset:896
    buffer_load_dwordx4 a[140:143], v3, s[12:15], 0 offen offset:960
    buffer_load_dwordx4 a[144:147], v3, s[12:15], 0 offen offset:1024
    buffer_load_dwordx4 a[148:151], v3, s[12:15], 0 offen offset:1088
    buffer_load_dwordx4 a[152:155], v3, s[12:15], 0 offen offset:1152
    buffer_load_dwordx4 a[156:159], v3, s[12:15], 0 offen offset:1216
    v_add_u32 v3, 0, v0
    v_mul_u32_u24 v4, 6554, v3
    v_lshrrev_b32 v4, 16, v4
    v_mul_u32_u24 v5, 10, v4
    v_sub_u32 v5, v3, v5
    v_and_b32 v6, 19, v4
    v_and_b32 v7, 4, v4
    v_lshl_or_b32 v6, v7, 1, v6
    v_and_b32 v7, 8, v4
    v_lshrrev_b32 v7, 1, v7
    v_or_b32 v6, v6, v7
    s_lshl_b32 s90, s32, 5
    v_add_u32 v6, s90, v6
    v_mul_u32_u24 v6, 3840, v6
    v_lshl_add_u32 v10, v5, 4, v6
    v_add_u32 v3, 64, v0
    v_mul_u32_u24 v4, 6554, v3
    v_lshrrev_b32 v4, 16, v4
    v_mul_u32_u24 v5, 10, v4
    v_sub_u32 v5, v3, v5
    v_and_b32 v6, 19, v4
    v_and_b32 v7, 4, v4
    v_lshl_or_b32 v6, v7, 1, v6
    v_and_b32 v7, 8, v4
    v_lshrrev_b32 v7, 1, v7
    v_or_b32 v6, v6, v7
    s_lshl_b32 s90, s32, 5
    v_add_u32 v6, s90, v6
    v_mul_u32_u24 v6, 3840, v6
    v_lshl_add_u32 v11, v5, 4, v6
    v_add_u32 v3, 128, v0
    v_mul_u32_u24 v4, 6554, v3
    v_lshrrev_b32 v4, 16, v4
    v_mul_u32_u24 v5, 10, v4
    v_sub_u32 v5, v3, v5
    v_and_b32 v6, 19, v4
    v_and_b32 v7, 4, v4
    v_lshl_or_b32 v6, v7, 1, v6
    v_and_b32 v7, 8, v4
    v_lshrrev_b32 v7, 1, v7
    v_or_b32 v6, v6, v7
    s_lshl_b32 s90, s32, 5
    v_add_u32 v6, s90, v6
    v_mul_u32_u24 v6, 3840, v6
    v_lshl_add_u32 v12, v5, 4, v6
    v_add_u32 v3, 192, v0
    v_mul_u32_u24 v4, 6554, v3
    v_lshrrev_b32 v4, 16, v4
    v_mul_u32_u24 v5, 10, v4
    v_sub_u32 v5, v3, v5
    v_and_b32 v6, 19, v4
    v_and_b32 v7, 4, v4
    v_lshl_or_b32 v6, v7, 1, v6
    v_and_b32 v7, 8, v4
    v_lshrrev_b32 v7, 1, v7
    v_or_b32 v6, v6, v7
    s_lshl_b32 s90, s32, 5
    v_add_u32 v6, s90, v6
    v_mul_u32_u24 v6, 3840, v6
    v_lshl_add_u32 v13, v5, 4, v6
    v_add_u32 v3, 256, v0
    v_mul_u32_u24 v4, 6554, v3
    v_lshrrev_b32 v4, 16, v4
    v_mul_u32_u24 v5, 10, v4
    v_sub_u32 v5, v3, v5
    v_and_b32 v6, 19, v4
    v_and_b32 v7, 4, v4
    v_lshl_or_b32 v6, v7, 1, v6
    v_and_b32 v7, 8, v4
    v_lshrrev_b32 v7, 1, v7
    v_or_b32 v6, v6, v7
    s_lshl_b32 s90, s32, 5
    v_add_u32 v6, s90, v6
    v_mul_u32_u24 v6, 3840, v6
    v_lshl_add_u32 v14, v5, 4, v6
    v_lshrrev_b32 v3, 2, v1
    v_and_b32 v4, 3, v1
    v_and_b32 v5, 1, v2
    v_lshl_add_u32 v3, v5, 2, v3
    v_lshrrev_b32 v6, 1, v2
    v_lshl_add_u32 v3, v6, 4, v3
    v_mul_u32_u24 v3, 160, v3
    v_lshl_add_u32 v15, v4, 3, v3
    s_lshl_b32 s90, s32, 5
    v_add_u32 v3, s90, v1
    v_mul_u32_u24 v3, 168, v3
    v_add_u32 v3, 81920, v3
    v_lshl_add_u32 v17, v2, 3, v3
    v_lshl_add_u32 v28, v2, 4, v3
    v_add_u32 v28, -32, v28
    v_lshl_add_u32 v3, v5, 4, v1
    v_add_u32 v4, s90, v3
    v_add_u32 v3, s40, v3
    v_cmp_le_u32 s[92:93], 16, v4
    v_cmp_gt_u32 vcc, 2048, v3
    s_nop 0
    s_and_b64 vcc, vcc, s[92:93]
    v_mul_u32_u24 v3, 2560, v3
    v_lshl_add_u32 v3, v6, 4, v3
    v_mov_b32 v4, 2146435072
    v_cndmask_b32 v19, v4, v3, vcc
    v_and_b32 v3, 31, v0
    v_add_u32 v24, s40, v3
    v_add_u32 v3, s90, v3
    v_mul_u32_u24 v3, 168, v3
    v_lshrrev_b32 v4, 5, v0
    v_mul_u32_u24 v4, 40, v4
    v_add_u32 v3, v3, v4
    v_add_u32 v20, 81920, v3
    v_add_u32 v21, 101072, v3
    v_mov_b32 v27, 0xcf8547b1
    s_mov_b32 s49, 0x3ea52b5c
    s_cmp_lt_u32 s54, 19
    s_cbranch_scc1 L_pa_rows
    s_mov_b32 s24, s70
    s_and_b32 s25, s71, 0xffff
    s_mov_b32 s26, 2621440
    s_mov_b32 s27, 0x20000
    s_sub_u32 s90, s54, 19
    s_lshl_b32 s90, s90, 2
    s_add_u32 s90, s90, s32
    s_lshl_b32 s90, s90, 11
    v_lshl_add_u32 v3, v0, 4, s90
    s_mov_b32 s91, 245760
L_pa_xw:
    buffer_load_dwordx4 v[248:251], v3, s[24:27], s91 offen
    buffer_load_dwordx4 v[248:251], v3, s[24:27], s91 offen offset:1024
    s_add_u32 s91, s91, 40960
    s_waitcnt vmcnt(20)
    s_cmp_lt_u32 s91, 2621440
    s_cbranch_scc1 L_pa_xw
    s_mov_b32 s46, 0
    s_mov_b32 s47, 0
    s_mul_i32 s43, s52, 160
    s_mov_b32 s44, 0
    s_mov_b32 s45, 0
    s_mov_b32 s51, 45
    s_mov_b32 s48, s52
    s_mov_b32 s53, 0
L_pa_pf_53:
    s_mul_i32 s90, s32, 5120
    s_add_u32 m0, s90, s47
    s_mul_i32 s91, s44, 491520
    s_add_u32 s91, s91, s43
    buffer_load_dwordx4 v[248:251], v10, s[16:19], s91 offen
    s_add_u32 s47, s47, 20480
    s_cmp_eq_u32 s47, 81920
    s_cselect_b32 s47, 0, s47
    s_cmp_lg_u32 s51, 0
    s_cselect_b32 s90, 1, 0
    s_sub_u32 s51, s51, s90
    s_add_u32 s44, s44, s90
    s_cmp_eq_u32 s44, 5
    s_cselect_b32 s44, 0, s44
    s_cselect_b32 s90, 1280, 0
    s_addc_u32 s45, s45, 0
    s_add_u32 s43, s43, s90
    s_cmp_eq_u32 s45, 3
    s_cselect_b32 s45, 0, s45
    s_cselect_b32 s90, 3680, 0
    s_cmp_eq_u32 s43, 4960
    s_cselect_b32 s90, s43, s90
    s_sub_u32 s43, s43, s90
    s_add_u32 m0, m0, 1024
    buffer_load_dwordx4 v[248:251], v11, s[16:19], s91 offen
    s_add_u32 m0, m0, 1024
    buffer_load_dwordx4 v[248:251], v12, s[16:19], s91 offen
    s_add_u32 m0, m0, 1024
    buffer_load_dwordx4 v[248:251], v13, s[16:19], s91 offen
    s_add_u32 m0, m0, 1024
    buffer_load_dwordx4 v[248:251], v14, s[16:19], s91 offen
    s_waitcnt vmcnt(20)
    s_cmp_lg_u32 s51, 0
    s_cbranch_scc1 L_pa_pf_53
    v_add_u32 v3, 0, v0
    v_mul_u32_u24 v4, 6554, v3
    v_lshrrev_b32 v4, 16, v4
    v_mul_u32_u24 v5, 10, v4
    v_sub_u32 v5, v3, v5
    v_and_b32 v6, 19, v4
    v_and_b32 v7, 4, v4
    v_lshl_or_b32 v6, v7, 1, v6
    v_and_b32 v7, 8, v4
    v_lshrrev_b32 v7, 1, v7
    v_or_b32 v6, v6, v7
    s_lshl_b32 s90, s32, 5
    v_add_u32 v6, s90, v6
    v_mul_u32_u24 v6, 1280, v6
    v_lshl_add_u32 v10, v5, 4, v6
    v_add_u32 v3, 64, v0
    v_mul_u32_u24 v4, 6554, v3
    v_lshrrev_b32 v4, 16, v4
    v_mul_u32_u24 v5, 10, v4
    v_sub_u32 v5, v3, v5
    v_and_b32 v6, 19, v4
    v_and_b32 v7, 4, v4
    v_lshl_or_b32 v6, v7, 1, v6
    v_and_b32 v7, 8, v4
    v_lshrrev_b32 v7, 1, v7
    v_or_b32 v6, v6, v7
    s_lshl_b32 s90, s32, 5
    v_add_u32 v6, s90, v6
    v_mul_u32_u24 v6, 1280, v6
    v_lshl_add_u32 v11, v5, 4, v6
    v_add_u32 v3, 128, v0
    v_mul_u32_u24 v4, 6554, v3
    v_lshrrev_b32 v4, 16, v4
    v_mul_u32_u24 v5, 10, v4
    v_sub_u32 v5, v3, v5
    v_and_b32 v6, 19, v4
    v_and_b32 v7, 4, v4
    v_lshl_or_b32 v6, v7, 1, v6
    v_and_b32 v7, 8, v4
    v_lshrrev_b32 v7, 1, v7
    v_or_b32 v6, v6, v7
    s_lshl_b32 s90, s32, 5
    v_add_u32 v6, s90, v6
    v_mul_u32_u24 v6, 1280, v6
    v_lshl_add_u32 v12, v5, 4, v6
    v_add_u32 v3, 192, v0
    v_mul_u32_u24 v4, 6554, v3
    v_lshrrev_b32 v4, 16, v4
    v_mul_u32_u24 v5, 10, v4
    v_sub_u32 v5, v3, v5
    v_and_b32 v6, 19, v4
    v_and_b32 v7, 4, v4
    v_lshl_or_b32 v6, v7, 1, v6
    v_and_b32 v7, 8, v4
    v_lshrrev_b32 v7, 1, v7
    v_or_b32 v6, v6, v7
    s_lshl_b32 s90, s32, 5
    v_add_u32 v6, s90, v6
    v_mul_u32_u24 v6, 1280, v6
    v_lshl_add_u32 v13, v5, 4, v6
    v_add_u32 v3, 256, v0
    v_mul_u32_u24 v4, 6554, v3
    v_lshrrev_b32 v4, 16, v4
    v_mul_u32_u24 v5, 10, v4
    v_sub_u32 v5, v3, v5
    v_and_b32 v6, 19, v4
    v_and_b32 v7, 4, v4
    v_lshl_or_b32 v6, v7, 1, v6
    v_and_b32 v7, 8, v4
    v_lshrrev_b32 v7, 1, v7
    v_or_b32 v6, v6, v7
    s_lshl_b32 s90, s32, 5
    v_add_u32 v6, s90, v6
    v_mul_u32_u24 v6, 1280, v6
    v_lshl_add_u32 v14, v5, 4, v6
    s_mov_b32 s46, 0
    s_mov_b32 s47, 0
    s_mul_i32 s43, s52, 160
    s_mov_b32 s44, 0
    s_mov_b32 s45, 0
    s_mov_b32 s51, 40
    s_mov_b32 s48, s52
    s_mov_b32 s53, 0
L_pa_pf_54:
    s_mul_i32 s90, s32, 5120
    s_add_u32 m0, s90, s47
    s_mul_i32 s91, s44, 163840
    s_add_u32 s91, s91, s43
    buffer_load_dwordx4 v[248:251], v10, s[20:23], s91 offen
    s_add_u32 s47, s47, 20480
    s_cmp_eq_u32 s47, 81920
    s_cselect_b32 s47, 0, s47
    s_cmp_lg_u32 s51, 0
    s_cselect_b32 s90, 1, 0
    s_sub_u32 s51, s51, s90
    s_add_u32 s44, s44, s90
    s_cmp_eq_u32 s44, 5
    s_cselect_b32 s44, 0, s44
    s_cselect_b32 s90, 160, 0
    s_add_u32 s43, s43, s90
    s_cmp_eq_u32 s43, 1280
    s_cselect_b32 s43, 0, s43
    s_add_u32 m0, m0, 1024
    buffer_load_dwordx4 v[248:251], v11, s[20:23], s91 offen
    s_add_u32 m0, m0, 1024
    buffer_load_dwordx4 v[248:251], v12, s[20:23], s91 offen
    s_add_u32 m0, m0, 1024
    buffer_load_dwordx4 v[248:251], v13, s[20:23], s91 offen
    s_add_u32 m0, m0, 1024
    buffer_load_dwordx4 v[248:251], v14, s[20:23], s91 offen
    s_waitcnt vmcnt(20)
    s_cmp_lg_u32 s51, 0
    s_cbranch_scc1 L_pa_pf_54
    s_branch L_pa_end
L_pa_rows:
    s_mov_b32 s46, 0
    s_mov_b32 s47, 0
    s_mul_i32 s43, s52, 160
    s_mov_b32 s44, 0
    s_mov_b32 s45, 0
    s_mov_b32 s51, 119
    s_mov_b32 s48, s52
    s_mov_b32 s53, 0
    s_mul_i32 s90, s32, 5120
    s_add_u32 m0, s90, s47
    s_mul_i32 s91, s44, 491520
    s_add_u32 s91, s91, s43
    buffer_load_dwordx4 v10, s[16:19], s91 offen lds
    s_add_u32 s47, s47, 20480
    s_cmp_eq_u32 s47, 81920
    s_cselect_b32 s47, 0, s47
    s_cmp_lg_u32 s51, 0
    s_cselect_b32 s90, 1, 0
    s_sub_u32 s51, s51, s90
    s_add_u32 s44, s44, s90
    s_cmp_eq_u32 s44, 5
    s_cselect_b32 s44, 0, s44
    s_cselect_b32 s90, 1280, 0
    s_addc_u32 s45, s45, 0
    s_add_u32 s43, s43, s90
    s_cmp_eq_u32 s45, 3
    s_cselect_b32 s45, 0, s45
    s_cselect_b32 s90, 3680, 0
    s_cmp_eq_u32 s43, 4960
    s_cselect_b32 s90, s43, s90
    s_sub_u32 s43, s43, s90
    s_add_u32 m0, m0, 1024
    s_nop 0
    buffer_load_dwordx4 v11, s[16:19], s91 offen lds
    s_add_u32 m0, m0, 1024
    s_nop 0
    buffer_load_dwordx4 v12, s[16:19], s91 offen lds
    s_add_u32 m0, m0, 1024
    s_nop 0
    buffer_load_dwordx4 v13, s[16:19], s91 offen lds
    s_add_u32 m0, m0, 1024
    s_nop 0
    buffer_load_dwordx4 v14, s[16:19], s91 offen lds
    s_mul_i32 s90, s32, 5120
    s_add_u32 m0, s90, s47
    s_mul_i32 s91, s44, 491520
    s_add_u32 s91, s91, s43
    buffer_load_dwordx4 v10, s[16:19], s91 offen lds
    s_add_u32 s47, s47, 20480
    s_cmp_eq_u32 s47, 81920
    s_cselect_b32 s47, 0, s47
    s_cmp_lg_u32 s51, 0
    s_cselect_b32 s90, 1, 0
    s_sub_u32 s51, s51, s90
    s_add_u32 s44, s44, s90
    s_cmp_eq_u32 s44, 5
    s_cselect_b32 s44, 0, s44
    s_cselect_b32 s90, 1280, 0
    s_addc_u32 s45, s45, 0
    s_add_u32 s43, s43, s90
    s_cmp_eq_u32 s45, 3
    s_cselect_b32 s45, 0, s45
    s_cselect_b32 s90, 3680, 0
    s_cmp_eq_u32 s43, 4960
    s_cselect_b32 s90, s43, s90
    s_sub_u32 s43, s43, s90
    s_add_u32 m0, m0, 1024
    s_nop 0
    buffer_load_dwordx4 v11, s[16:19], s91 offen lds
    s_add_u32 m0, m0, 1024
    s_nop 0
    buffer_load_dwordx4 v12, s[16:19], s91 offen lds
    s_add_u32 m0, m0, 1024
    s_nop 0
    buffer_load_dwordx4 v13, s[16:19], s91 offen lds
    s_add_u32 m0, m0, 1024
    s_nop 0
    buffer_load_dwordx4 v14, s[16:19], s91 offen lds
    s_mul_i32 s90, s32, 5120
    s_add_u32 m0, s90, s47
    s_mul_i32 s91, s44, 491520
    s_add_u32 s91, s91, s43
    buffer_load_dwordx4 v10, s[16:19], s91 offen lds
    s_add_u32 s47, s47, 20480
    s_cmp_eq_u32 s47, 81920
    s_cselect_b32 s47, 0, s47
    s_cmp_lg_u32 s51, 0
    s_cselect_b32 s90, 1, 0
    s_sub_u32 s51, s51, s90
    s_add_u32 s44, s44, s90
    s_cmp_eq_u32 s44, 5
    s_cselect_b32 s44, 0, s44
    s_cselect_b32 s90, 1280, 0
    s_addc_u32 s45, s45, 0
    s_add_u32 s43, s43, s90
    s_cmp_eq_u32 s45, 3
    s_cselect_b32 s45, 0, s45
    s_cselect_b32 s90, 3680, 0
    s_cmp_eq_u32 s43, 4960
    s_cselect_b32 s90, s43, s90
    s_sub_u32 s43, s43, s90
    s_add_u32 m0, m0, 1024
    s_nop 0
    buffer_load_dwordx4 v11, s[16:19], s91 offen lds
    s_add_u32 m0, m0, 1024
    s_nop 0
    buffer_load_dwordx4 v12, s[16:19], s91 offen lds
    s_add_u32 m0, m0, 1024
    s_nop 0
    buffer_load_dwordx4 v13, s[16:19], s91 offen lds
    s_add_u32 m0, m0, 1024
    s_nop 0
    buffer_load_dwordx4 v14, s[16:19], s91 offen lds
    v_add_u32 v16, s46, v15
    s_waitcnt vmcnt(10) lgkmcnt(0)
    s_barrier
    ds_read_b64_tr_b16 v[96:97], v16 offset:0
    ds_read_b64_tr_b16 v[98:99], v16 offset:1280
    ds_read_b64_tr_b16 v[100:101], v16 offset:32
    ds_read_b64_tr_b16 v[102:103], v16 offset:1312
    ds_read_b64_tr_b16 v[104:105], v16 offset:64
    ds_read_b64_tr_b16 v[106:107], v16 offset:1344
    ds_read_b64_tr_b16 v[108:109], v16 offset:96
    ds_read_b64_tr_b16 v[110:111], v16 offset:1376
    ds_read_b64_tr_b16 v[112:113], v16 offset:128
    ds_read_b64_tr_b16 v[114:115], v16 offset:1408
L_pa_grp:
    s_mov_b32 s41, 0
L_pa_blk:
    s_waitcnt lgkmcnt(8)
    v_mfma_f32_16x16x32_bf16 v[136:139], v[96:99], a[0:3], 0
    ds_read_b64_tr_b16 v[116:117], v16 offset:5120
    s_add_u32 s46, s46, 20480
    s_cmp_eq_u32 s46, 81920
    v_mfma_f32_16x16x32_bf16 v[140:143], v[96:99], a[80:83], 0
    ds_read_b64_tr_b16 v[118:119], v16 offset:6400
    s_cselect_b32 s46, 0, s46
    s_mul_i32 s90, s32, 5120
    s_waitcnt lgkmcnt(8)
    v_mfma_f32_16x16x32_bf16 v[144:147], v[100:103], a[0:3], 0
    ds_read_b64_tr_b16 v[120:121], v16 offset:5152
    s_add_u32 m0, s90, s47
    s_mul_i32 s91, s44, 491520
    v_mfma_f32_16x16x32_bf16 v[148:151], v[100:103], a[80:83], 0
    ds_read_b64_tr_b16 v[122:123], v16 offset:6432
    s_add_u32 s91, s91, s43
    buffer_load_dwordx4 v10, s[16:19], s91 offen lds
    s_waitcnt lgkmcnt(8)
    v_mfma_f32_16x16x32_bf16 v[152:155], v[104:107], a[0:3], 0
    ds_read_b64_tr_b16 v[124:125], v16 offset:5184
    s_add_u32 s47, s47, 20480
    s_cmp_eq_u32 s47, 81920
    v_mfma_f32_16x16x32_bf16 v[156:159], v[104:107], a[80:83], 0
    ds_read_b64_tr_b16 v[126:127], v16 offset:6464
    s_cselect_b32 s47, 0, s47
    s_cmp_lg_u32 s51, 0
    s_waitcnt lgkmcnt(8)
    v_mfma_f32_16x16x32_bf16 v[160:163], v[108:111], a[0:3], 0
    ds_read_b64_tr_b16 v[128:129], v16 offset:5216
    s_cselect_b32 s90, 1, 0
    s_sub_u32 s51, s51, s90
    v_mfma_f32_16x16x32_bf16 v[164:167], v[108:111], a[80:83], 0
    ds_read_b64_tr_b16 v[130:131], v16 offset:6496
    s_add_u32 s44, s44, s90
    s_cmp_eq_u32 s44, 5
    s_waitcnt lgkmcnt(8)
    v_mfma_f32_16x16x32_bf16 v[168:171], v[112:115], a[0:3], 0
    ds_read_b64_tr_b16 v[132:133], v16 offset:5248
    s_cselect_b32 s44, 0, s44
    s_cselect_b32 s90, 1280, 0
    v_mfma_f32_16x16x32_bf16 v[172:175], v[112:115], a[80:83], 0
    ds_read_b64_tr_b16 v[134:135], v16 offset:6528
    s_addc_u32 s45, s45, 0
    s_add_u32 s43, s43, s90
    s_waitcnt lgkmcnt(8)
    v_mfma_f32_16x16x32_bf16 v[136:139], v[116:119], a[4:7], v[136:139]
    ds_read_b64_tr_b16 v[96:97], v16 offset:10240
    s_cmp_eq_u32 s45, 3
    s_cselect_b32 s45, 0, s45
    v_mfma_f32_16x16x32_bf16 v[140:143], v[116:119], a[84:87], v[140:143]
    ds_read_b64_tr_b16 v[98:99], v16 offset:11520
    s_cselect_b32 s90, 3680, 0
    s_cmp_eq_u32 s43, 4960
    s_waitcnt lgkmcnt(8)
    v_mfma_f32_16x16x32_bf16 v[144:147], v[120:123], a[4:7], v[144:147]
    ds_read_b64_tr_b16 v[100:101], v16 offset:10272
    s_cselect_b32 s90, s43, s90
    s_sub_u32 s43, s43, s90
    v_mfma_f32_16x16x32_bf16 v[148:151], v[120:123], a[84:87], v[148:151]
    ds_read_b64_tr_b16 v[102:103], v16 offset:11552
    s_add_u32 m0, m0, 1024
    s_nop 0
    buffer_load_dwordx4 v11, s[16:19], s91 offen lds
    s_waitcnt lgkmcnt(8)
    v_mfma_f32_16x16x32_bf16 v[152:155], v[124:127], a[4:7], v[152:155]
    ds_read_b64_tr_b16 v[104:105], v16 offset:10304
    s_add_u32 m0, m0, 1024
    v_mfma_f32_16x16x32_bf16 v[156:159], v[124:127], a[84:87], v[156:159]
    ds_read_b64_tr_b16 v[106:107], v16 offset:11584
    s_waitcnt lgkmcnt(8)
    v_mfma_f32_16x16x32_bf16 v[160:163], v[128:131], a[4:7], v[160:163]
    ds_read_b64_tr_b16 v[108:109], v16 offset:10336
    v_mfma_f32_16x16x32_bf16 v[164:167], v[128:131], a[84:87], v[164:167]
    ds_read_b64_tr_b16 v[110:111], v16 offset:11616
    s_waitcnt lgkmcnt(8)
    v_mfma_f32_16x16x32_bf16 v[168:171], v[132:135], a[4:7], v[168:171]
    ds_read_b64_tr_b16 v[112:113], v16 offset:10368
    buffer_load_dwordx4 v12, s[16:19], s91 offen lds
    s_add_u32 m0, m0, 1024
    v_mfma_f32_16x16x32_bf16 v[172:175], v[132:135], a[84:87], v[172:175]
    ds_read_b64_tr_b16 v[114:115], v16 offset:11648
    s_waitcnt lgkmcnt(8)
    v_mfma_f32_16x16x32_bf16 v[136:139], v[96:99], a[8:11], v[136:139]
    ds_read_b64_tr_b16 v[116:117], v16 offset:15360
    v_mfma_f32_16x16x32_bf16 v[140:143], v[96:99], a[88:91], v[140:143]
    ds_read_b64_tr_b16 v[118:119], v16 offset:16640
    s_waitcnt lgkmcnt(8)
    v_mfma_f32_16x16x32_bf16 v[144:147], v[100:103], a[8:11], v[144:147]
    ds_read_b64_tr_b16 v[120:121], v16 offset:15392
    v_mfma_f32_16x16x32_bf16 v[148:151], v[100:103], a[88:91], v[148:151]
    ds_read_b64_tr_b16 v[122:123], v16 offset:16672
    buffer_load_dwordx4 v13, s[16:19], s91 offen lds
    s_add_u32 m0, m0, 1024
    s_waitcnt lgkmcnt(8)
    v_mfma_f32_16x16x32_bf16 v[152:155], v[104:107], a[8:11], v[152:155]
    ds_read_b64_tr_b16 v[124:125], v16 offset:15424
    v_mfma_f32_16x16x32_bf16 v[156:159], v[104:107], a[88:91], v[156:159]
    ds_read_b64_tr_b16 v[126:127], v16 offset:16704
    s_waitcnt lgkmcnt(8)
    v_mfma_f32_16x16x32_bf16 v[160:163], v[108:111], a[8:11], v[160:163]
    ds_read_b64_tr_b16 v[128:129], v16 offset:15456
    v_mfma_f32_16x16x32_bf16 v[164:167], v[108:111], a[88:91], v[164:167]
    ds_read_b64_tr_b16 v[130:131], v16 offset:16736
    s_waitcnt lgkmcnt(8)
    v_mfma_f32_16x16x32_bf16 v[168:171], v[112:115], a[8:11], v[168:171]
    ds_read_b64_tr_b16 v[132:133], v16 offset:15488
    buffer_load_dwordx4 v14, s[16:19], s91 offen lds
    v_mfma_f32_16x16x32_bf16 v[172:175], v[112:115], a[88:91], v[172:175]
    ds_read_b64_tr_b16 v[134:135], v16 offset:16768
    s_waitcnt lgkmcnt(8)
    v_mfma_f32_16x16x32_bf16 v[136:139], v[116:119], a[12:15], v[136:139]
    v_mfma_f32_16x16x32_bf16 v[140:143], v[116:119], a[92:95], v[140:143]
    s_waitcnt lgkmcnt(6)
    v_mfma_f32_16x16x32_bf16 v[144:147], v[120:123], a[12:15], v[144:147]
    v_mfma_f32_16x16x32_bf16 v[148:151], v[120:123], a[92:95], v[148:151]
    v_add_u32 v16, s46, v15
    s_waitcnt vmcnt(10) lgkmcnt(0)
    s_barrier
    v_mfma_f32_16x16x32_bf16 v[152:155], v[124:127], a[12:15], v[152:155]
    ds_read_b64_tr_b16 v[96:97], v16 offset:0
    ds_read_b64_tr_b16 v[98:99], v16 offset:1280
    v_mfma_f32_16x16x32_bf16 v[156:159], v[124:127], a[92:95], v[156:159]
    ds_read_b64_tr_b16 v[100:101], v16 offset:32
    ds_read_b64_tr_b16 v[102:103], v16 offset:1312
    v_mfma_f32_16x16x32_bf16 v[160:163], v[128:131], a[12:15], v[160:163]
    ds_read_b64_tr_b16 v[104:105], v16 offset:64
    ds_read_b64_tr_b16 v[106:107], v16 offset:1344
    v_mfma_f32_16x16x32_bf16 v[164:167], v[128:131], a[92:95], v[164:167]
    ds_read_b64_tr_b16 v[108:109], v16 offset:96
    ds_read_b64_tr_b16 v[110:111], v16 offset:1376
    v_mfma_f32_16x16x32_bf16 v[168:171], v[132:135], a[12:15], v[168:171]
    ds_read_b64_tr_b16 v[112:113], v16 offset:128
    ds_read_b64_tr_b16 v[114:115], v16 offset:1408
    v_mfma_f32_16x16x32_bf16 v[172:175], v[132:135], a[92:95], v[172:175]
    s_waitcnt lgkmcnt(8)
    v_mfma_f32_16x16x32_bf16 v[136:139], v[96:99], a[16:19], v[136:139]
    ds_read_b64_tr_b16 v[116:117], v16 offset:5120
    s_add_u32 s46, s46, 20480
    s_cmp_eq_u32 s46, 81920
    v_mfma_f32_16x16x32_bf16 v[140:143], v[96:99], a[96:99], v[140:143]
    ds_read_b64_tr_b16 v[118:119], v16 offset:6400
    s_cselect_b32 s46, 0, s46
    s_mul_i32 s90, s32, 5120
    s_waitcnt lgkmcnt(8)
    v_mfma_f32_16x16x32_bf16 v[144:147], v[100:103], a[16:19], v[144:147]
    ds_read_b64_tr_b16 v[120:121], v16 offset:5152
    s_add_u32 m0, s90, s47
    s_mul_i32 s91, s44, 491520
    v_mfma_f32_16x16x32_bf16 v[148:151], v[100:103], a[96:99], v[148:151]
    ds_read_b64_tr_b16 v[122:123], v16 offset:6432
    s_add_u32 s91, s91, s43
    buffer_load_dwordx4 v10, s[16:19], s91 offen lds
    s_waitcnt lgkmcnt(8)
    v_mfma_f32_16x16x32_bf16 v[152:155], v[104:107], a[16:19], v[152:155]
    ds_read_b64_tr_b16 v[124:125], v16 offset:5184
    s_add_u32 s47, s47, 20480
    s_cmp_eq_u32 s47, 81920
    v_mfma_f32_16x16x32_bf16 v[156:159], v[104:107], a[96:99], v[156:159]
    ds_read_b64_tr_b16 v[126:127], v16 offset:6464
    s_cselect_b32 s47, 0, s47
    s_cmp_lg_u32 s51, 0
    s_waitcnt lgkmcnt(8)
    v_mfma_f32_16x16x32_bf16 v[160:163], v[108:111], a[16:19], v[160:163]
    ds_read_b64_tr_b16 v[128:129], v16 offset:5216
    s_cselect_b32 s90, 1, 0
    s_sub_u32 s51, s51, s90
    v_mfma_f32_16x16x32_bf16 v[164:167], v[108:111], a[96:99], v[164:167]
    ds_read_b64_tr_b16 v[130:131], v16 offset:6496
    s_add_u32 s44, s44, s90
    s_cmp_eq_u32 s44, 5
    s_waitcnt lgkmcnt(8)
    v_mfma_f32_16x16x32_bf16 v[168:171], v[112:115], a[16:19], v[168:171]
    ds_read_b64_tr_b16 v[132:133], v16 offset:5248
    s_cselect_b32 s44, 0, s44
    s_cselect_b32 s90, 1280, 0
    v_mfma_f32_16x16x32_bf16 v[172:175], v[112:115], a[96:99], v[172:175]
    ds_read_b64_tr_b16 v[134:135], v16 offset:6528
    s_addc_u32 s45, s45, 0
    s_add_u32 s43, s43, s90
    s_waitcnt lgkmcnt(8)
    v_mfma_f32_16x16x32_bf16 v[136:139], v[116:119], a[20:23], v[136:139]
    ds_read_b64_tr_b16 v[96:97], v16 offset:10240
    s_cmp_eq_u32 s45, 3
    s_cselect_b32 s45, 0, s45
    v_mfma_f32_16x16x32_bf16 v[140:143], v[116:119], a[100:103], v[140:143]
    ds_read_b64_tr_b16 v[98:99], v16 offset:11520
    s_cselect_b32 s90, 3680, 0
    s_cmp_eq_u32 s43, 4960
    s_waitcnt lgkmcnt(8)
    v_mfma_f32_16x16x32_bf16 v[144:147], v[120:123], a[20:23], v[144:147]
    ds_read_b64_tr_b16 v[100:101], v16 offset:10272
    s_cselect_b32 s90, s43, s90
    s_sub_u32 s43, s43, s90
    v_mfma_f32_16x16x32_bf16 v[148:151], v[120:123], a[100:103], v[148:151]
    ds_read_b64_tr_b16 v[102:103], v16 offset:11552
    s_add_u32 m0, m0, 1024
    s_nop 0
    buffer_load_dwordx4 v11, s[16:19], s91 offen lds
    s_waitcnt lgkmcnt(8)
    v_mfma_f32_16x16x32_bf16 v[152:155], v[124:127], a[20:23], v[152:155]
    ds_read_b64_tr_b16 v[104:105], v16 offset:10304
    s_add_u32 m0, m0, 1024
    v_mfma_f32_16x16x32_bf16 v[156:159], v[124:127], a[100:103], v[156:159]
    ds_read_b64_tr_b16 v[106:107], v16 offset:11584
    s_waitcnt lgkmcnt(8)
    v_mfma_f32_16x16x32_bf16 v[160:163], v[128:131], a[20:23], v[160:163]
    ds_read_b64_tr_b16 v[108:109], v16 offset:10336
    v_mfma_f32_16x16x32_bf16 v[164:167], v[128:131], a[100:103], v[164:167]
    ds_read_b64_tr_b16 v[110:111], v16 offset:11616
    s_waitcnt lgkmcnt(8)
    v_mfma_f32_16x16x32_bf16 v[168:171], v[132:135], a[20:23], v[168:171]
    ds_read_b64_tr_b16 v[112:113], v16 offset:10368
    buffer_load_dwordx4 v12, s[16:19], s91 offen lds
    s_add_u32 m0, m0, 1024
    v_mfma_f32_16x16x32_bf16 v[172:175], v[132:135], a[100:103], v[172:175]
    ds_read_b64_tr_b16 v[114:115], v16 offset:11648
    s_waitcnt lgkmcnt(8)
    v_mfma_f32_16x16x32_bf16 v[136:139], v[96:99], a[24:27], v[136:139]
    ds_read_b64_tr_b16 v[116:117], v16 offset:15360
    v_mfma_f32_16x16x32_bf16 v[140:143], v[96:99], a[104:107], v[140:143]
    ds_read_b64_tr_b16 v[118:119], v16 offset:16640
    s_waitcnt lgkmcnt(8)
    v_mfma_f32_16x16x32_bf16 v[144:147], v[100:103], a[24:27], v[144:147]
    ds_read_b64_tr_b16 v[120:121], v16 offset:15392
    v_mfma_f32_16x16x32_bf16 v[148:151], v[100:103], a[104:107], v[148:151]
    ds_read_b64_tr_b16 v[122:123], v16 offset:16672
    buffer_load_dwordx4 v13, s[16:19], s91 offen lds
    s_add_u32 m0, m0, 1024
    s_waitcnt lgkmcnt(8)
    v_mfma_f32_16x16x32_bf16 v[152:155], v[104:107], a[24:27], v[152:155]
    ds_read_b64_tr_b16 v[124:125], v16 offset:15424
    v_mfma_f32_16x16x32_bf16 v[156:159], v[104:107], a[104:107], v[156:159]
    ds_read_b64_tr_b16 v[126:127], v16 offset:16704
    s_waitcnt lgkmcnt(8)
    v_mfma_f32_16x16x32_bf16 v[160:163], v[108:111], a[24:27], v[160:163]
    ds_read_b64_tr_b16 v[128:129], v16 offset:15456
    v_mfma_f32_16x16x32_bf16 v[164:167], v[108:111], a[104:107], v[164:167]
    ds_read_b64_tr_b16 v[130:131], v16 offset:16736
    s_waitcnt lgkmcnt(8)
    v_mfma_f32_16x16x32_bf16 v[168:171], v[112:115], a[24:27], v[168:171]
    ds_read_b64_tr_b16 v[132:133], v16 offset:15488
    buffer_load_dwordx4 v14, s[16:19], s91 offen lds
    v_mfma_f32_16x16x32_bf16 v[172:175], v[112:115], a[104:107], v[172:175]
    ds_read_b64_tr_b16 v[134:135], v16 offset:16768
    s_waitcnt lgkmcnt(8)
    v_mfma_f32_16x16x32_bf16 v[136:139], v[116:119], a[28:31], v[136:139]
    v_mfma_f32_16x16x32_bf16 v[140:143], v[116:119], a[108:111], v[140:143]
    s_waitcnt lgkmcnt(6)
    v_mfma_f32_16x16x32_bf16 v[144:147], v[120:123], a[28:31], v[144:147]
    v_mfma_f32_16x16x32_bf16 v[148:151], v[120:123], a[108:111], v[148:151]
    v_add_u32 v16, s46, v15
    s_waitcnt vmcnt(10) lgkmcnt(0)
    s_barrier
    v_mfma_f32_16x16x32_bf16 v[152:155], v[124:127], a[28:31], v[152:155]
    ds_read_b64_tr_b16 v[96:97], v16 offset:0
    ds_read_b64_tr_b16 v[98:99], v16 offset:1280
    v_mfma_f32_16x16x32_bf16 v[156:159], v[124:127], a[108:111], v[156:159]
    ds_read_b64_tr_b16 v[100:101], v16 offset:32
    ds_read_b64_tr_b16 v[102:103], v16 offset:1312
    v_mfma_f32_16x16x32_bf16 v[160:163], v[128:131], a[28:31], v[160:163]
    ds_read_b64_tr_b16 v[104:105], v16 offset:64
    ds_read_b64_tr_b16 v[106:107], v16 offset:1344
    v_mfma_f32_16x16x32_bf16 v[164:167], v[128:131], a[108:111], v[164:167]
    ds_read_b64_tr_b16 v[108:109], v16 offset:96
    ds_read_b64_tr_b16 v[110:111], v16 offset:1376
    v_mfma_f32_16x16x32_bf16 v[168:171], v[132:135], a[28:31], v[168:171]
    ds_read_b64_tr_b16 v[112:113], v16 offset:128
    ds_read_b64_tr_b16 v[114:115], v16 offset:1408
    v_mfma_f32_16x16x32_bf16 v[172:175], v[132:135], a[108:111], v[172:175]
    s_waitcnt lgkmcnt(8)
    v_mfma_f32_16x16x32_bf16 v[136:139], v[96:99], a[32:35], v[136:139]
    ds_read_b64_tr_b16 v[116:117], v16 offset:5120
    s_add_u32 s46, s46, 20480
    s_cmp_eq_u32 s46, 81920
    v_mfma_f32_16x16x32_bf16 v[140:143], v[96:99], a[112:115], v[140:143]
    ds_read_b64_tr_b16 v[118:119], v16 offset:6400
    s_cselect_b32 s46, 0, s46
    s_mul_i32 s90, s32, 5120
    s_waitcnt lgkmcnt(8)
    v_mfma_f32_16x16x32_bf16 v[144:147], v[100:103], a[32:35], v[144:147]
    ds_read_b64_tr_b16 v[120:121], v16 offset:5152
    s_add_u32 m0, s90, s47
    s_mul_i32 s91, s44, 491520
    v_mfma_f32_16x16x32_bf16 v[148:151], v[100:103], a[112:115], v[148:151]
    ds_read_b64_tr_b16 v[122:123], v16 offset:6432
    s_add_u32 s91, s91, s43
    buffer_load_dwordx4 v10, s[16:19], s91 offen lds
    s_waitcnt lgkmcnt(8)
    v_mfma_f32_16x16x32_bf16 v[152:155], v[104:107], a[32:35], v[152:155]
    ds_read_b64_tr_b16 v[124:125], v16 offset:5184
    s_add_u32 s47, s47, 20480
    s_cmp_eq_u32 s47, 81920
    v_mfma_f32_16x16x32_bf16 v[156:159], v[104:107], a[112:115], v[156:159]
    ds_read_b64_tr_b16 v[126:127], v16 offset:6464
    s_cselect_b32 s47, 0, s47
    s_cmp_lg_u32 s51, 0
    s_waitcnt lgkmcnt(8)
    v_mfma_f32_16x16x32_bf16 v[160:163], v[108:111], a[32:35], v[160:163]
    ds_read_b64_tr_b16 v[128:129], v16 offset:5216
    s_cselect_b32 s90, 1, 0
    s_sub_u32 s51, s51, s90
    v_mfma_f32_16x16x32_bf16 v[164:167], v[108:111], a[112:115], v[164:167]
    ds_read_b64_tr_b16 v[130:131], v16 offset:6496
    s_add_u32 s44, s44, s90
    s_cmp_eq_u32 s44, 5
    s_waitcnt lgkmcnt(8)
    v_mfma_f32_16x16x32_bf16 v[168:171], v[112:115], a[32:35], v[168:171]
    ds_read_b64_tr_b16 v[132:133], v16 offset:5248
    s_cselect_b32 s44, 0, s44
    s_cselect_b32 s90, 1280, 0
    v_mfma_f32_16x16x32_bf16 v[172:175], v[112:115], a[112:115], v[172:175]
    ds_read_b64_tr_b16 v[134:135], v16 offset:6528
    s_addc_u32 s45, s45, 0
    s_add_u32 s43, s43, s90
    s_waitcnt lgkmcnt(8)
    v_mfma_f32_16x16x32_bf16 v[136:139], v[116:119], a[36:39], v[136:139]
    ds_read_b64_tr_b16 v[96:97], v16 offset:10240
    s_cmp_eq_u32 s45, 3
    s_cselect_b32 s45, 0, s45
    v_mfma_f32_16x16x32_bf16 v[140:143], v[116:119], a[116:119], v[140:143]
    ds_read_b64_tr_b16 v[98:99], v16 offset:11520
    s_cselect_b32 s90, 3680, 0
    s_cmp_eq_u32 s43, 4960
    s_waitcnt lgkmcnt(8)
    v_mfma_f32_16x16x32_bf16 v[144:147], v[120:123], a[36:39], v[144:147]
    ds_read_b64_tr_b16 v[100:101], v16 offset:10272
    s_cselect_b32 s90, s43, s90
    s_sub_u32 s43, s43, s90
    v_mfma_f32_16x16x32_bf16 v[148:151], v[120:123], a[116:119], v[148:151]
    ds_read_b64_tr_b16 v[102:103], v16 offset:11552
    s_add_u32 m0, m0, 1024
    s_nop 0
    buffer_load_dwordx4 v11, s[16:19], s91 offen lds
    s_waitcnt lgkmcnt(8)
    v_mfma_f32_16x16x32_bf16 v[152:155], v[124:127], a[36:39], v[152:155]
    ds_read_b64_tr_b16 v[104:105], v16 offset:10304
    s_add_u32 m0, m0, 1024
    v_mfma_f32_16x16x32_bf16 v[156:159], v[124:127], a[116:119], v[156:159]
    ds_read_b64_tr_b16 v[106:107], v16 offset:11584
    s_waitcnt lgkmcnt(8)
    v_mfma_f32_16x16x32_bf16 v[160:163], v[128:131], a[36:39], v[160:163]
    ds_read_b64_tr_b16 v[108:109], v16 offset:10336
    v_mfma_f32_16x16x32_bf16 v[164:167], v[128:131], a[116:119], v[164:167]
    ds_read_b64_tr_b16 v[110:111], v16 offset:11616
    s_waitcnt lgkmcnt(8)
    v_mfma_f32_16x16x32_bf16 v[168:171], v[132:135], a[36:39], v[168:171]
    ds_read_b64_tr_b16 v[112:113], v16 offset:10368
    buffer_load_dwordx4 v12, s[16:19], s91 offen lds
    s_add_u32 m0, m0, 1024
    v_mfma_f32_16x16x32_bf16 v[172:175], v[132:135], a[116:119], v[172:175]
    ds_read_b64_tr_b16 v[114:115], v16 offset:11648
    s_waitcnt lgkmcnt(8)
    v_mfma_f32_16x16x32_bf16 v[136:139], v[96:99], a[40:43], v[136:139]
    ds_read_b64_tr_b16 v[116:117], v16 offset:15360
    v_mfma_f32_16x16x32_bf16 v[140:143], v[96:99], a[120:123], v[140:143]
    ds_read_b64_tr_b16 v[118:119], v16 offset:16640
    s_waitcnt lgkmcnt(8)
    v_mfma_f32_16x16x32_bf16 v[144:147], v[100:103], a[40:43], v[144:147]
    ds_read_b64_tr_b16 v[120:121], v16 offset:15392
    v_mfma_f32_16x16x32_bf16 v[148:151], v[100:103], a[120:123], v[148:151]
    ds_read_b64_tr_b16 v[122:123], v16 offset:16672
    buffer_load_dwordx4 v13, s[16:19], s91 offen lds
    s_add_u32 m0, m0, 1024
    s_waitcnt lgkmcnt(8)
    v_mfma_f32_16x16x32_bf16 v[152:155], v[104:107], a[40:43], v[152:155]
    ds_read_b64_tr_b16 v[124:125], v16 offset:15424
    v_mfma_f32_16x16x32_bf16 v[156:159], v[104:107], a[120:123], v[156:159]
    ds_read_b64_tr_b16 v[126:127], v16 offset:16704
    s_waitcnt lgkmcnt(8)
    v_mfma_f32_16x16x32_bf16 v[160:163], v[108:111], a[40:43], v[160:163]
    ds_read_b64_tr_b16 v[128:129], v16 offset:15456
    v_mfma_f32_16x16x32_bf16 v[164:167], v[108:111], a[120:123], v[164:167]
    ds_read_b64_tr_b16 v[130:131], v16 offset:16736
    s_waitcnt lgkmcnt(8)
    v_mfma_f32_16x16x32_bf16 v[168:171], v[112:115], a[40:43], v[168:171]
    ds_read_b64_tr_b16 v[132:133], v16 offset:15488
    buffer_load_dwordx4 v14, s[16:19], s91 offen lds
    v_mfma_f32_16x16x32_bf16 v[172:175], v[112:115], a[120:123], v[172:175]
    ds_read_b64_tr_b16 v[134:135], v16 offset:16768
    s_waitcnt lgkmcnt(8)
    v_mfma_f32_16x16x32_bf16 v[136:139], v[116:119], a[44:47], v[136:139]
    v_mfma_f32_16x16x32_bf16 v[140:143], v[116:119], a[124:127], v[140:143]
    s_waitcnt lgkmcnt(6)
    v_mfma_f32_16x16x32_bf16 v[144:147], v[120:123], a[44:47], v[144:147]
    v_mfma_f32_16x16x32_bf16 v[148:151], v[120:123], a[124:127], v[148:151]
    v_add_u32 v16, s46, v15
    s_waitcnt vmcnt(10) lgkmcnt(0)
    s_barrier
    v_mfma_f32_16x16x32_bf16 v[152:155], v[124:127], a[44:47], v[152:155]
    ds_read_b64_tr_b16 v[96:97], v16 offset:0
    ds_read_b64_tr_b16 v[98:99], v16 offset:1280
    v_mfma_f32_16x16x32_bf16 v[156:159], v[124:127], a[124:127], v[156:159]
    ds_read_b64_tr_b16 v[100:101], v16 offset:32
    ds_read_b64_tr_b16 v[102:103], v16 offset:1312
    v_mfma_f32_16x16x32_bf16 v[160:163], v[128:131], a[44:47], v[160:163]
    ds_read_b64_tr_b16 v[104:105], v16 offset:64
    ds_read_b64_tr_b16 v[106:107], v16 offset:1344
    v_mfma_f32_16x16x32_bf16 v[164:167], v[128:131], a[124:127], v[164:167]
    ds_read_b64_tr_b16 v[108:109], v16 offset:96
    ds_read_b64_tr_b16 v[110:111], v16 offset:1376
    v_mfma_f32_16x16x32_bf16 v[168:171], v[132:135], a[44:47], v[168:171]
    ds_read_b64_tr_b16 v[112:113], v16 offset:128
    ds_read_b64_tr_b16 v[114:115], v16 offset:1408
    v_mfma_f32_16x16x32_bf16 v[172:175], v[132:135], a[124:127], v[172:175]
    s_waitcnt lgkmcnt(8)
    v_mfma_f32_16x16x32_bf16 v[136:139], v[96:99], a[48:51], v[136:139]
    ds_read_b64_tr_b16 v[116:117], v16 offset:5120
    s_add_u32 s46, s46, 20480
    s_cmp_eq_u32 s46, 81920
    v_mfma_f32_16x16x32_bf16 v[140:143], v[96:99], a[128:131], v[140:143]
    ds_read_b64_tr_b16 v[118:119], v16 offset:6400
    s_cselect_b32 s46, 0, s46
    s_mul_i32 s90, s32, 5120
    s_waitcnt lgkmcnt(8)
    v_mfma_f32_16x16x32_bf16 v[144:147], v[100:103], a[48:51], v[144:147]
    ds_read_b64_tr_b16 v[120:121], v16 offset:5152
    s_add_u32 m0, s90, s47
    s_mul_i32 s91, s44, 491520
    v_mfma_f32_16x16x32_bf16 v[148:151], v[100:103], a[128:131], v[148:151]
    ds_read_b64_tr_b16 v[122:123], v16 offset:6432
    s_add_u32 s91, s91, s43
    buffer_load_dwordx4 v10, s[16:19], s91 offen lds
    s_waitcnt lgkmcnt(8)
    v_mfma_f32_16x16x32_bf16 v[152:155], v[104:107], a[48:51], v[152:155]
    ds_read_b64_tr_b16 v[124:125], v16 offset:5184
    s_add_u32 s47, s47, 20480
    s_cmp_eq_u32 s47, 81920
    v_mfma_f32_16x16x32_bf16 v[156:159], v[104:107], a[128:131], v[156:159]
    ds_read_b64_tr_b16 v[126:127], v16 offset:6464
    s_cselect_b32 s47, 0, s47
    s_cmp_lg_u32 s51, 0
    s_waitcnt lgkmcnt(8)
    v_mfma_f32_16x16x32_bf16 v[160:163], v[108:111], a[48:51], v[160:163]
    ds_read_b64_tr_b16 v[128:129], v16 offset:5216
    s_cselect_b32 s90, 1, 0
    s_sub_u32 s51, s51, s90
    v_mfma_f32_16x16x32_bf16 v[164:167], v[108:111], a[128:131], v[164:167]
    ds_read_b64_tr_b16 v[130:131], v16 offset:6496
    s_add_u32 s44, s44, s90
    s_cmp_eq_u32 s44, 5
    s_waitcnt lgkmcnt(8)
    v_mfma_f32_16x16x32_bf16 v[168:171], v[112:115], a[48:51], v[168:171]
    ds_read_b64_tr_b16 v[132:133], v16 offset:5248
    s_cselect_b32 s44, 0, s44
    s_cselect_b32 s90, 1280, 0
    v_mfma_f32_16x16x32_bf16 v[172:175], v[112:115], a[128:131], v[172:175]
    ds_read_b64_tr_b16 v[134:135], v16 offset:6528
    s_addc_u32 s45, s45, 0
    s_add_u32 s43, s43, s90
    s_waitcnt lgkmcnt(8)
    v_mfma_f32_16x16x32_bf16 v[136:139], v[116:119], a[52:55], v[136:139]
    ds_read_b64_tr_b16 v[96:97], v16 offset:10240
    s_cmp_eq_u32 s45, 3
    s_cselect_b32 s45, 0, s45
    v_mfma_f32_16x16x32_bf16 v[140:143], v[116:119], a[132:135], v[140:143]
    ds_read_b64_tr_b16 v[98:99], v16 offset:11520
    s_cselect_b32 s90, 3680, 0
    s_cmp_eq_u32 s43, 4960
    s_waitcnt lgkmcnt(8)
    v_mfma_f32_16x16x32_bf16 v[144:147], v[120:123], a[52:55], v[144:147]
    ds_read_b64_tr_b16 v[100:101], v16 offset:10272
    s_cselect_b32 s90, s43, s90
    s_sub_u32 s43, s43, s90
    v_mfma_f32_16x16x32_bf16 v[148:151], v[120:123], a[132:135], v[148:151]
    ds_read_b64_tr_b16 v[102:103], v16 offset:11552
    s_add_u32 m0, m0, 1024
    s_nop 0
    buffer_load_dwordx4 v11, s[16:19], s91 offen lds
    s_waitcnt lgkmcnt(8)
    v_mfma_f32_16x16x32_bf16 v[152:155], v[124:127], a[52:55], v[152:155]
    ds_read_b64_tr_b16 v[104:105], v16 offset:10304
    s_add_u32 m0, m0, 1024
    v_mfma_f32_16x16x32_bf16 v[156:159], v[124:127], a[132:135], v[156:159]
    ds_read_b64_tr_b16 v[106:107], v16 offset:11584
    s_waitcnt lgkmcnt(8)
    v_mfma_f32_16x16x32_bf16 v[160:163], v[128:131], a[52:55], v[160:163]
    ds_read_b64_tr_b16 v[108:109], v16 offset:10336
    v_mfma_f32_16x16x32_bf16 v[164:167], v[128:131], a[132:135], v[164:167]
    ds_read_b64_tr_b16 v[110:111], v16 offset:11616
    s_waitcnt lgkmcnt(8)
    v_mfma_f32_16x16x32_bf16 v[168:171], v[132:135], a[52:55], v[168:171]
    ds_read_b64_tr_b16 v[112:113], v16 offset:10368
    buffer_load_dwordx4 v12, s[16:19], s91 offen lds
    s_add_u32 m0, m0, 1024
    v_mfma_f32_16x16x32_bf16 v[172:175], v[132:135], a[132:135], v[172:175]
    ds_read_b64_tr_b16 v[114:115], v16 offset:11648
    s_waitcnt lgkmcnt(8)
    v_mfma_f32_16x16x32_bf16 v[136:139], v[96:99], a[56:59], v[136:139]
    ds_read_b64_tr_b16 v[116:117], v16 offset:15360
    v_mfma_f32_16x16x32_bf16 v[140:143], v[96:99], a[136:139], v[140:143]
    ds_read_b64_tr_b16 v[118:119], v16 offset:16640
    s_waitcnt lgkmcnt(8)
    v_mfma_f32_16x16x32_bf16 v[144:147], v[100:103], a[56:59], v[144:147]
    ds_read_b64_tr_b16 v[120:121], v16 offset:15392
    v_mfma_f32_16x16x32_bf16 v[148:151], v[100:103], a[136:139], v[148:151]
    ds_read_b64_tr_b16 v[122:123], v16 offset:16672
    buffer_load_dwordx4 v13, s[16:19], s91 offen lds
    s_add_u32 m0, m0, 1024
    s_waitcnt lgkmcnt(8)
    v_mfma_f32_16x16x32_bf16 v[152:155], v[104:107], a[56:59], v[152:155]
    ds_read_b64_tr_b16 v[124:125], v16 offset:15424
    v_mfma_f32_16x16x32_bf16 v[156:159], v[104:107], a[136:139], v[156:159]
    ds_read_b64_tr_b16 v[126:127], v16 offset:16704
    s_waitcnt lgkmcnt(8)
    v_mfma_f32_16x16x32_bf16 v[160:163], v[108:111], a[56:59], v[160:163]
    ds_read_b64_tr_b16 v[128:129], v16 offset:15456
    v_mfma_f32_16x16x32_bf16 v[164:167], v[108:111], a[136:139], v[164:167]
    ds_read_b64_tr_b16 v[130:131], v16 offset:16736
    s_waitcnt lgkmcnt(8)
    v_mfma_f32_16x16x32_bf16 v[168:171], v[112:115], a[56:59], v[168:171]
    ds_read_b64_tr_b16 v[132:133], v16 offset:15488
    buffer_load_dwordx4 v14, s[16:19], s91 offen lds
    v_mfma_f32_16x16x32_bf16 v[172:175], v[112:115], a[136:139], v[172:175]
    ds_read_b64_tr_b16 v[134:135], v16 offset:16768
    s_waitcnt lgkmcnt(8)
    v_mfma_f32_16x16x32_bf16 v[136:139], v[116:119], a[60:63], v[136:139]
    v_mfma_f32_16x16x32_bf16 v[140:143], v[116:119], a[140:143], v[140:143]
    s_waitcnt lgkmcnt(6)
    v_mfma_f32_16x16x32_bf16 v[144:147], v[120:123], a[60:63], v[144:147]
    v_mfma_f32_16x16x32_bf16 v[148:151], v[120:123], a[140:143], v[148:151]
    v_add_u32 v16, s46, v15
    s_waitcnt vmcnt(10) lgkmcnt(0)
    s_barrier
    v_mfma_f32_16x16x32_bf16 v[152:155], v[124:127], a[60:63], v[152:155]
    ds_read_b64_tr_b16 v[96:97], v16 offset:0
    ds_read_b64_tr_b16 v[98:99], v16 offset:1280
    v_mfma_f32_16x16x32_bf16 v[156:159], v[124:127], a[140:143], v[156:159]
    ds_read_b64_tr_b16 v[100:101], v16 offset:32
    ds_read_b64_tr_b16 v[102:103], v16 offset:1312
    v_mfma_f32_16x16x32_bf16 v[160:163], v[128:131], a[60:63], v[160:163]
    ds_read_b64_tr_b16 v[104:105], v16 offset:64
    ds_read_b64_tr_b16 v[106:107], v16 offset:1344
    v_mfma_f32_16x16x32_bf16 v[164:167], v[128:131], a[140:143], v[164:167]
    ds_read_b64_tr_b16 v[108:109], v16 offset:96
    ds_read_b64_tr_b16 v[110:111], v16 offset:1376
    v_mfma_f32_16x16x32_bf16 v[168:171], v[132:135], a[60:63], v[168:171]
    ds_read_b64_tr_b16 v[112:113], v16 offset:128
    ds_read_b64_tr_b16 v[114:115], v16 offset:1408
    v_mfma_f32_16x16x32_bf16 v[172:175], v[132:135], a[140:143], v[172:175]
    s_waitcnt lgkmcnt(8)
    v_mfma_f32_16x16x32_bf16 v[136:139], v[96:99], a[64:67], v[136:139]
    ds_read_b64_tr_b16 v[116:117], v16 offset:5120
    s_add_u32 s46, s46, 20480
    s_cmp_eq_u32 s46, 81920
    v_mfma_f32_16x16x32_bf16 v[140:143], v[96:99], a[144:147], v[140:143]
    ds_read_b64_tr_b16 v[118:119], v16 offset:6400
    s_cselect_b32 s46, 0, s46
    s_mul_i32 s90, s32, 5120
    s_waitcnt lgkmcnt(8)
    v_mfma_f32_16x16x32_bf16 v[144:147], v[100:103], a[64:67], v[144:147]
    ds_read_b64_tr_b16 v[120:121], v16 offset:5152
    s_add_u32 m0, s90, s47
    s_mul_i32 s91, s44, 491520
    v_mfma_f32_16x16x32_bf16 v[148:151], v[100:103], a[144:147], v[148:151]
    ds_read_b64_tr_b16 v[122:123], v16 offset:6432
    s_add_u32 s91, s91, s43
    buffer_load_dwordx4 v10, s[16:19], s91 offen lds
    s_waitcnt lgkmcnt(8)
    v_mfma_f32_16x16x32_bf16 v[152:155], v[104:107], a[64:67], v[152:155]
    ds_read_b64_tr_b16 v[124:125], v16 offset:5184
    s_add_u32 s47, s47, 20480
    s_cmp_eq_u32 s47, 81920
    v_mfma_f32_16x16x32_bf16 v[156:159], v[104:107], a[144:147], v[156:159]
    ds_read_b64_tr_b16 v[126:127], v16 offset:6464
    s_cselect_b32 s47, 0, s47
    s_cmp_lg_u32 s51, 0
    s_waitcnt lgkmcnt(8)
    v_mfma_f32_16x16x32_bf16 v[160:163], v[108:111], a[64:67], v[160:163]
    ds_read_b64_tr_b16 v[128:129], v16 offset:5216
    s_cselect_b32 s90, 1, 0
    s_sub_u32 s51, s51, s90
    v_mfma_f32_16x16x32_bf16 v[164:167], v[108:111], a[144:147], v[164:167]
    ds_read_b64_tr_b16 v[130:131], v16 offset:6496
    s_add_u32 s44, s44, s90
    s_cmp_eq_u32 s44, 5
    s_waitcnt lgkmcnt(8)
    v_mfma_f32_16x16x32_bf16 v[168:171], v[112:115], a[64:67], v[168:171]
    ds_read_b64_tr_b16 v[132:133], v16 offset:5248
    s_cselect_b32 s44, 0, s44
    s_cselect_b32 s90, 1280, 0
    v_mfma_f32_16x16x32_bf16 v[172:175], v[112:115], a[144:147], v[172:175]
    ds_read_b64_tr_b16 v[134:135], v16 offset:6528
    s_addc_u32 s45, s45, 0
    s_add_u32 s43, s43, s90
    s_waitcnt lgkmcnt(8)
    v_mfma_f32_16x16x32_bf16 v[136:139], v[116:119], a[68:71], v[136:139]
    ds_read_b64_tr_b16 v[96:97], v16 offset:10240
    s_cmp_eq_u32 s45, 3
    s_cselect_b32 s45, 0, s45
    v_mfma_f32_16x16x32_bf16 v[140:143], v[116:119], a[148:151], v[140:143]
    ds_read_b64_tr_b16 v[98:99], v16 offset:11520
    s_cselect_b32 s90, 3680, 0
    s_cmp_eq_u32 s43, 4960
    s_waitcnt lgkmcnt(8)
    v_mfma_f32_16x16x32_bf16 v[144:147], v[120:123], a[68:71], v[144:147]
    ds_read_b64_tr_b16 v[100:101], v16 offset:10272
    s_cselect_b32 s90, s43, s90
    s_sub_u32 s43, s43, s90
    v_mfma_f32_16x16x32_bf16 v[148:151], v[120:123], a[148:151], v[148:151]
    ds_read_b64_tr_b16 v[102:103], v16 offset:11552
    s_add_u32 m0, m0, 1024
    s_nop 0
    buffer_load_dwordx4 v11, s[16:19], s91 offen lds
    s_waitcnt lgkmcnt(8)
    v_mfma_f32_16x16x32_bf16 v[152:155], v[124:127], a[68:71], v[152:155]
    ds_read_b64_tr_b16 v[104:105], v16 offset:10304
    s_add_u32 m0, m0, 1024
    v_mfma_f32_16x16x32_bf16 v[156:159], v[124:127], a[148:151], v[156:159]
    ds_read_b64_tr_b16 v[106:107], v16 offset:11584
    s_waitcnt lgkmcnt(8)
    v_mfma_f32_16x16x32_bf16 v[160:163], v[128:131], a[68:71], v[160:163]
    ds_read_b64_tr_b16 v[108:109], v16 offset:10336
    v_mfma_f32_16x16x32_bf16 v[164:167], v[128:131], a[148:151], v[164:167]
    ds_read_b64_tr_b16 v[110:111], v16 offset:11616
    s_waitcnt lgkmcnt(8)
    v_mfma_f32_16x16x32_bf16 v[168:171], v[132:135], a[68:71], v[168:171]
    ds_read_b64_tr_b16 v[112:113], v16 offset:10368
    buffer_load_dwordx4 v12, s[16:19], s91 offen lds
    s_add_u32 m0, m0, 1024
    v_mfma_f32_16x16x32_bf16 v[172:175], v[132:135], a[148:151], v[172:175]
    ds_read_b64_tr_b16 v[114:115], v16 offset:11648
    s_waitcnt lgkmcnt(8)
    v_mfma_f32_16x16x32_bf16 v[136:139], v[96:99], a[72:75], v[136:139]
    ds_read_b64_tr_b16 v[116:117], v16 offset:15360
    v_mfma_f32_16x16x32_bf16 v[140:143], v[96:99], a[152:155], v[140:143]
    ds_read_b64_tr_b16 v[118:119], v16 offset:16640
    s_waitcnt lgkmcnt(8)
    v_mfma_f32_16x16x32_bf16 v[144:147], v[100:103], a[72:75], v[144:147]
    ds_read_b64_tr_b16 v[120:121], v16 offset:15392
    v_mfma_f32_16x16x32_bf16 v[148:151], v[100:103], a[152:155], v[148:151]
    ds_read_b64_tr_b16 v[122:123], v16 offset:16672
    buffer_load_dwordx4 v13, s[16:19], s91 offen lds
    s_add_u32 m0, m0, 1024
    s_waitcnt lgkmcnt(8)
    v_mfma_f32_16x16x32_bf16 v[152:155], v[104:107], a[72:75], v[152:155]
    ds_read_b64_tr_b16 v[124:125], v16 offset:15424
    v_mfma_f32_16x16x32_bf16 v[156:159], v[104:107], a[152:155], v[156:159]
    ds_read_b64_tr_b16 v[126:127], v16 offset:16704
    s_waitcnt lgkmcnt(8)
    v_mfma_f32_16x16x32_bf16 v[160:163], v[108:111], a[72:75], v[160:163]
    ds_read_b64_tr_b16 v[128:129], v16 offset:15456
    v_mfma_f32_16x16x32_bf16 v[164:167], v[108:111], a[152:155], v[164:167]
    ds_read_b64_tr_b16 v[130:131], v16 offset:16736
    s_waitcnt lgkmcnt(8)
    v_mfma_f32_16x16x32_bf16 v[168:171], v[112:115], a[72:75], v[168:171]
    ds_read_b64_tr_b16 v[132:133], v16 offset:15488
    buffer_load_dwordx4 v14, s[16:19], s91 offen lds
    v_mfma_f32_16x16x32_bf16 v[172:175], v[112:115], a[152:155], v[172:175]
    ds_read_b64_tr_b16 v[134:135], v16 offset:16768
    s_waitcnt lgkmcnt(8)
    v_mfma_f32_16x16x32_bf16 v[136:139], v[116:119], a[76:79], v[136:139]
    v_mfma_f32_16x16x32_bf16 v[140:143], v[116:119], a[156:159], v[140:143]
    s_waitcnt lgkmcnt(6)
    v_mfma_f32_16x16x32_bf16 v[144:147], v[120:123], a[76:79], v[144:147]
    v_mfma_f32_16x16x32_bf16 v[148:151], v[120:123], a[156:159], v[148:151]
    v_add_u32 v16, s46, v15
    s_waitcnt vmcnt(10) lgkmcnt(0)
    s_barrier
    v_mfma_f32_16x16x32_bf16 v[152:155], v[124:127], a[76:79], v[152:155]
    ds_read_b64_tr_b16 v[96:97], v16 offset:0
    ds_read_b64_tr_b16 v[98:99], v16 offset:1280
    v_mfma_f32_16x16x32_bf16 v[156:159], v[124:127], a[156:159], v[156:159]
    ds_read_b64_tr_b16 v[100:101], v16 offset:32
    ds_read_b64_tr_b16 v[102:103], v16 offset:1312
    v_mfma_f32_16x16x32_bf16 v[160:163], v[128:131], a[76:79], v[160:163]
    ds_read_b64_tr_b16 v[104:105], v16 offset:64
    ds_read_b64_tr_b16 v[106:107], v16 offset:1344
    v_mfma_f32_16x16x32_bf16 v[164:167], v[128:131], a[156:159], v[164:167]
    ds_read_b64_tr_b16 v[108:109], v16 offset:96
    ds_read_b64_tr_b16 v[110:111], v16 offset:1376
    v_mfma_f32_16x16x32_bf16 v[168:171], v[132:135], a[76:79], v[168:171]
    ds_read_b64_tr_b16 v[112:113], v16 offset:128
    ds_read_b64_tr_b16 v[114:115], v16 offset:1408
    v_mfma_f32_16x16x32_bf16 v[172:175], v[132:135], a[156:159], v[172:175]
    v_add_u32 v18, s41, v17
    v_cvt_pk_bf16_f32 v176, v136, v137
    v_cvt_pk_bf16_f32 v177, v138, v139
    v_cvt_pk_bf16_f32 v178, v140, v141
    v_cvt_pk_bf16_f32 v179, v142, v143
    ds_write_b64 v18, v[176:177] offset:0
    ds_write_b64 v18, v[178:179] offset:2688
    v_cvt_pk_bf16_f32 v176, v144, v145
    v_cvt_pk_bf16_f32 v177, v146, v147
    v_cvt_pk_bf16_f32 v178, v148, v149
    v_cvt_pk_bf16_f32 v179, v150, v151
    ds_write_b64 v18, v[176:177] offset:32
    ds_write_b64 v18, v[178:179] offset:2720
    v_cvt_pk_bf16_f32 v176, v152, v153
    v_cvt_pk_bf16_f32 v177, v154, v155
    v_cvt_pk_bf16_f32 v178, v156, v157
    v_cvt_pk_bf16_f32 v179, v158, v159
    ds_write_b64 v18, v[176:177] offset:64
    ds_write_b64 v18, v[178:179] offset:2752
    v_cvt_pk_bf16_f32 v176, v160, v161
    v_cvt_pk_bf16_f32 v177, v162, v163
    v_cvt_pk_bf16_f32 v178, v164, v165
    v_cvt_pk_bf16_f32 v179, v166, v167
    ds_write_b64 v18, v[176:177] offset:96
    ds_write_b64 v18, v[178:179] offset:2784
    v_cvt_pk_bf16_f32 v176, v168, v169
    v_cvt_pk_bf16_f32 v177, v170, v171
    v_cvt_pk_bf16_f32 v178, v172, v173
    v_cvt_pk_bf16_f32 v179, v174, v175
    ds_write_b64 v18, v[176:177] offset:128
    ds_write_b64 v18, v[178:179] offset:2816
    s_waitcnt lgkmcnt(0)
    s_add_u32 s41, s41, 21504
    s_cmp_lt_u32 s41, 64512
    s_cbranch_scc1 L_pa_blk
    s_barrier
    s_mov_b32 s50, 0
L_pa_att:
    v_add_u32 v23, s50, v21
    v_add_u32 v22, s50, v20
    ds_read_b64 v[116:117], v22 offset:0
    ds_read_b64 v[118:119], v22 offset:8
    ds_read_b64 v[120:121], v22 offset:16
    ds_read_b64 v[122:123], v22 offset:24
    ds_read_b64 v[124:125], v22 offset:32
    ds_read_b64 v[126:127], v23 offset:2352
    ds_read_b64 v[128:129], v23 offset:2360
    ds_read_b64 v[130:131], v23 offset:2368
    ds_read_b64 v[132:133], v23 offset:2376
    ds_read_b64 v[134:135], v23 offset:2384
    ds_read_b64 v[136:137], v23 offset:2016
    ds_read_b64 v[138:139], v23 offset:2024
    ds_read_b64 v[140:141], v23 offset:2032
    ds_read_b64 v[142:143], v23 offset:2040
    ds_read_b64 v[144:145], v23 offset:2048
    s_waitcnt lgkmcnt(5)
    v_dot2_f32_bf16 v146, v116, v126, 0
    v_dot2_f32_bf16 v146, v117, v127, v146
    v_dot2_f32_bf16 v146, v118, v128, v146
    v_dot2_f32_bf16 v146, v119, v129, v146
    v_dot2_f32_bf16 v146, v120, v130, v146
    v_dot2_f32_bf16 v146, v121, v131, v146
    v_dot2_f32_bf16 v146, v122, v132, v146
    v_dot2_f32_bf16 v146, v123, v133, v146
    v_dot2_f32_bf16 v146, v124, v134, v146
    v_dot2_f32_bf16 v146, v125, v135, v146
    ds_read_b64 v[126:127], v23 offset:1680
    ds_read_b64 v[128:129], v23 offset:1688
    ds_read_b64 v[130:131], v23 offset:1696
    ds_read_b64 v[132:133], v23 offset:1704
    ds_read_b64 v[134:135], v23 offset:1712
    s_waitcnt lgkmcnt(5)
    v_dot2_f32_bf16 v147, v116, v136, 0
    v_dot2_f32_bf16 v147, v117, v137, v147
    v_dot2_f32_bf16 v147, v118, v138, v147
    v_dot2_f32_bf16 v147, v119, v139, v147
    v_dot2_f32_bf16 v147, v120, v140, v147
    v_dot2_f32_bf16 v147, v121, v141, v147
    v_dot2_f32_bf16 v147, v122, v142, v147
    v_dot2_f32_bf16 v147, v123, v143, v147
    v_dot2_f32_bf16 v147, v124, v144, v147
    v_dot2_f32_bf16 v147, v125, v145, v147
    ds_read_b64 v[136:137], v23 offset:1344
    ds_read_b64 v[138:139], v23 offset:1352
    ds_read_b64 v[140:141], v23 offset:1360
    ds_read_b64 v[142:143], v23 offset:1368
    ds_read_b64 v[144:145], v23 offset:1376
    s_waitcnt lgkmcnt(5)
    v_dot2_f32_bf16 v148, v116, v126, 0
    v_dot2_f32_bf16 v148, v117, v127, v148
    v_dot2_f32_bf16 v148, v118, v128, v148
    v_dot2_f32_bf16 v148, v119, v129, v148
    v_dot2_f32_bf16 v148, v120, v130, v148
    v_dot2_f32_bf16 v148, v121, v131, v148
    v_dot2_f32_bf16 v148, v122, v132, v148
    v_dot2_f32_bf16 v148, v123, v133, v148
    v_dot2_f32_bf16 v148, v124, v134, v148
    v_dot2_f32_bf16 v148, v125, v135, v148
    ds_read_b64 v[126:127], v23 offset:1008
    ds_read_b64 v[128:129], v23 offset:1016
    ds_read_b64 v[130:131], v23 offset:1024
    ds_read_b64 v[132:133], v23 offset:1032
    ds_read_b64 v[134:135], v23 offset:1040
    s_waitcnt lgkmcnt(5)
    v_dot2_f32_bf16 v149, v116, v136, 0
    v_dot2_f32_bf16 v149, v117, v137, v149
    v_dot2_f32_bf16 v149, v118, v138, v149
    v_dot2_f32_bf16 v149, v119, v139, v149
    v_dot2_f32_bf16 v149, v120, v140, v149
    v_dot2_f32_bf16 v149, v121, v141, v149
    v_dot2_f32_bf16 v149, v122, v142, v149
    v_dot2_f32_bf16 v149, v123, v143, v149
    v_dot2_f32_bf16 v149, v124, v144, v149
    v_dot2_f32_bf16 v149, v125, v145, v149
    ds_read_b64 v[136:137], v23 offset:672
    ds_read_b64 v[138:139], v23 offset:680
    ds_read_b64 v[140:141], v23 offset:688
    ds_read_b64 v[142:143], v23 offset:696
    ds_read_b64 v[144:145], v23 offset:704
    s_waitcnt lgkmcnt(5)
    v_dot2_f32_bf16 v150, v116, v126, 0
    v_dot2_f32_bf16 v150, v117, v127, v150
    v_dot2_f32_bf16 v150, v118, v128, v150
    v_dot2_f32_bf16 v150, v119, v129, v150
    v_dot2_f32_bf16 v150, v120, v130, v150
    v_dot2_f32_bf16 v150, v121, v131, v150
    v_dot2_f32_bf16 v150, v122, v132, v150
    v_dot2_f32_bf16 v150, v123, v133, v150
    v_dot2_f32_bf16 v150, v124, v134, v150
    v_dot2_f32_bf16 v150, v125, v135, v150
    ds_read_b64 v[126:127], v23 offset:336
    ds_read_b64 v[128:129], v23 offset:344
    ds_read_b64 v[130:131], v23 offset:352
    ds_read_b64 v[132:133], v23 offset:360
    ds_read_b64 v[134:135], v23 offset:368
    s_waitcnt lgkmcnt(5)
    v_dot2_f32_bf16 v151, v116, v136, 0
    v_dot2_f32_bf16 v151, v117, v137, v151
    v_dot2_f32_bf16 v151, v118, v138, v151
    v_dot2_f32_bf16 v151, v119, v139, v151
    v_dot2_f32_bf16 v151, v120, v140, v151
    v_dot2_f32_bf16 v151, v121, v141, v151
    v_dot2_f32_bf16 v151, v122, v142, v151
    v_dot2_f32_bf16 v151, v123, v143, v151
    v_dot2_f32_bf16 v151, v124, v144, v151
    v_dot2_f32_bf16 v151, v125, v145, v151
    ds_read_b64 v[136:137], v23 offset:0
    ds_read_b64 v[138:139], v23 offset:8
    ds_read_b64 v[140:141], v23 offset:16
    ds_read_b64 v[142:143], v23 offset:24
    ds_read_b64 v[144:145], v23 offset:32
    s_waitcnt lgkmcnt(5)
    v_dot2_f32_bf16 v152, v116, v126, 0
    v_dot2_f32_bf16 v152, v117, v127, v152
    v_dot2_f32_bf16 v152, v118, v128, v152
    v_dot2_f32_bf16 v152, v119, v129, v152
    v_dot2_f32_bf16 v152, v120, v130, v152
    v_dot2_f32_bf16 v152, v121, v131, v152
    v_dot2_f32_bf16 v152, v122, v132, v152
    v_dot2_f32_bf16 v152, v123, v133, v152
    v_dot2_f32_bf16 v152, v124, v134, v152
    v_dot2_f32_bf16 v152, v125, v135, v152
    ds_read_b64 v[126:127], v23 offset:23856
    ds_read_b64 v[128:129], v23 offset:23864
    ds_read_b64 v[130:131], v23 offset:23872
    ds_read_b64 v[132:133], v23 offset:23880
    ds_read_b64 v[134:135], v23 offset:23888
    s_waitcnt lgkmcnt(5)
    v_dot2_f32_bf16 v153, v116, v136, 0
    v_dot2_f32_bf16 v153, v117, v137, v153
    v_dot2_f32_bf16 v153, v118, v138, v153
    v_dot2_f32_bf16 v153, v119, v139, v153
    v_dot2_f32_bf16 v153, v120, v140, v153
    v_dot2_f32_bf16 v153, v121, v141, v153
    v_dot2_f32_bf16 v153, v122, v142, v153
    v_dot2_f32_bf16 v153, v123, v143, v153
    v_dot2_f32_bf16 v153, v124, v144, v153
    v_dot2_f32_bf16 v153, v125, v145, v153
    v_cmp_le_i32 vcc, 2, v24
    s_nop 1
    v_cndmask_b32 v147, v27, v147, vcc
    v_cmp_le_i32 vcc, 4, v24
    s_nop 1
    v_cndmask_b32 v148, v27, v148, vcc
    v_cmp_le_i32 vcc, 6, v24
    s_nop 1
    v_cndmask_b32 v149, v27, v149, vcc
    v_cmp_le_i32 vcc, 8, v24
    s_nop 1
    v_cndmask_b32 v150, v27, v150, vcc
    v_cmp_le_i32 vcc, 10, v24
    s_nop 1
    v_cndmask_b32 v151, v27, v151, vcc
    v_cmp_le_i32 vcc, 12, v24
    s_nop 1
    v_cndmask_b32 v152, v27, v152, vcc
    v_cmp_le_i32 vcc, 14, v24
    s_nop 1
    v_cndmask_b32 v153, v27, v153, vcc
    v_max_f32 v25, v146, v147
    v_max3_f32 v25, v25, v148, v149
    v_max3_f32 v25, v25, v150, v151
    v_max3_f32 v25, v25, v152, v153
    v_mul_f32 v25, 0xbea52b5c, v25
    v_fma_f32 v146, v146, s49, v25
    v_fma_f32 v147, v147, s49, v25
    v_fma_f32 v148, v148, s49, v25
    v_fma_f32 v149, v149, s49, v25
    v_fma_f32 v150, v150, s49, v25
    v_fma_f32 v151, v151, s49, v25
    v_fma_f32 v152, v152, s49, v25
    v_fma_f32 v153, v153, s49, v25
    v_exp_f32 v146, v146
    v_exp_f32 v147, v147
    v_exp_f32 v148, v148
    v_exp_f32 v149, v149
    v_exp_f32 v150, v150
    v_exp_f32 v151, v151
    v_exp_f32 v152, v152
    v_exp_f32 v153, v153
    v_add_f32 v26, v146, v147
    v_add_f32 v26, v26, v148
    v_add_f32 v26, v26, v149
    v_add_f32 v26, v26, v150
    v_add_f32 v26, v26, v151
    v_add_f32 v26, v26, v152
    v_add_f32 v26, v26, v153
    v_rcp_f32 v26, v26
    s_nop 0
    v_mul_f32 v146, v146, v26
    v_cvt_pk_bf16_f32 v154, v146, 0
    v_cvt_pk_bf16_f32 v155, 0, v146
    v_mul_f32 v147, v147, v26
    v_cvt_pk_bf16_f32 v156, v147, 0
    v_cvt_pk_bf16_f32 v157, 0, v147
    v_mul_f32 v148, v148, v26
    v_cvt_pk_bf16_f32 v158, v148, 0
    v_cvt_pk_bf16_f32 v159, 0, v148
    v_mul_f32 v149, v149, v26
    v_cvt_pk_bf16_f32 v160, v149, 0
    v_cvt_pk_bf16_f32 v161, 0, v149
    v_mul_f32 v150, v150, v26
    v_cvt_pk_bf16_f32 v162, v150, 0
    v_cvt_pk_bf16_f32 v163, 0, v150
    v_mul_f32 v151, v151, v26
    v_cvt_pk_bf16_f32 v164, v151, 0
    v_cvt_pk_bf16_f32 v165, 0, v151
    v_mul_f32 v152, v152, v26
    v_cvt_pk_bf16_f32 v166, v152, 0
    v_cvt_pk_bf16_f32 v167, 0, v152
    v_mul_f32 v153, v153, v26
    v_cvt_pk_bf16_f32 v168, v153, 0
    v_cvt_pk_bf16_f32 v169, 0, v153
    ds_read_b64 v[136:137], v23 offset:23520
    ds_read_b64 v[138:139], v23 offset:23528
    ds_read_b64 v[140:141], v23 offset:23536
    ds_read_b64 v[142:143], v23 offset:23544
    ds_read_b64 v[144:145], v23 offset:23552
    s_waitcnt lgkmcnt(5)
    v_dot2_f32_bf16 v170, v126, v154, 0
    v_dot2_f32_bf16 v171, v126, v155, 0
    v_dot2_f32_bf16 v172, v127, v154, 0
    v_dot2_f32_bf16 v173, v127, v155, 0
    v_dot2_f32_bf16 v174, v128, v154, 0
    v_dot2_f32_bf16 v175, v128, v155, 0
    v_dot2_f32_bf16 v176, v129, v154, 0
    v_dot2_f32_bf16 v177, v129, v155, 0
    v_dot2_f32_bf16 v178, v130, v154, 0
    v_dot2_f32_bf16 v179, v130, v155, 0
    v_dot2_f32_bf16 v180, v131, v154, 0
    v_dot2_f32_bf16 v181, v131, v155, 0
    v_dot2_f32_bf16 v182, v132, v154, 0
    v_dot2_f32_bf16 v183, v132, v155, 0
    v_dot2_f32_bf16 v184, v133, v154, 0
    v_dot2_f32_bf16 v185, v133, v155, 0
    v_dot2_f32_bf16 v186, v134, v154, 0
    v_dot2_f32_bf16 v187, v134, v155, 0
    v_dot2_f32_bf16 v188, v135, v154, 0
    v_dot2_f32_bf16 v189, v135, v155, 0
    ds_read_b64 v[126:127], v23 offset:23184
    ds_read_b64 v[128:129], v23 offset:23192
    ds_read_b64 v[130:131], v23 offset:23200
    ds_read_b64 v[132:133], v23 offset:23208
    ds_read_b64 v[134:135], v23 offset:23216
    s_waitcnt lgkmcnt(5)
    v_dot2_f32_bf16 v170, v136, v156, v170
    v_dot2_f32_bf16 v171, v136, v157, v171
    v_dot2_f32_bf16 v172, v137, v156, v172
    v_dot2_f32_bf16 v173, v137, v157, v173
    v_dot2_f32_bf16 v174, v138, v156, v174
    v_dot2_f32_bf16 v175, v138, v157, v175
    v_dot2_f32_bf16 v176, v139, v156, v176
    v_dot2_f32_bf16 v177, v139, v157, v177
    v_dot2_f32_bf16 v178, v140, v156, v178
    v_dot2_f32_bf16 v179, v140, v157, v179
    v_dot2_f32_bf16 v180, v141, v156, v180
    v_dot2_f32_bf16 v181, v141, v157, v181
    v_dot2_f32_bf16 v182, v142, v156, v182
    v_dot2_f32_bf16 v183, v142, v157, v183
    v_dot2_f32_bf16 v184, v143, v156, v184
    v_dot2_f32_bf16 v185, v143, v157, v185
    v_dot2_f32_bf16 v186, v144, v156, v186
    v_dot2_f32_bf16 v187, v144, v157, v187
    v_dot2_f32_bf16 v188, v145, v156, v188
    v_dot2_f32_bf16 v189, v145, v157, v189
    ds_read_b64 v[136:137], v23 offset:22848
    ds_read_b64 v[138:139], v23 offset:22856
    ds_read_b64 v[140:141], v23 offset:22864
    ds_read_b64 v[142:143], v23 offset:22872
    ds_read_b64 v[144:145], v23 offset:22880
    s_waitcnt lgkmcnt(5)
    v_dot2_f32_bf16 v170, v126, v158, v170
    v_dot2_f32_bf16 v171, v126, v159, v171
    v_dot2_f32_bf16 v172, v127, v158, v172
    v_dot2_f32_bf16 v173, v127, v159, v173
    v_dot2_f32_bf16 v174, v128, v158, v174
    v_dot2_f32_bf16 v175, v128, v159, v175
    v_dot2_f32_bf16 v176, v129, v158, v176
    v_dot2_f32_bf16 v177, v129, v159, v177
    v_dot2_f32_bf16 v178, v130, v158, v178
    v_dot2_f32_bf16 v179, v130, v159, v179
    v_dot2_f32_bf16 v180, v131, v158, v180
    v_dot2_f32_bf16 v181, v131, v159, v181
    v_dot2_f32_bf16 v182, v132, v158, v182
    v_dot2_f32_bf16 v183, v132, v159, v183
    v_dot2_f32_bf16 v184, v133, v158, v184
    v_dot2_f32_bf16 v185, v133, v159, v185
    v_dot2_f32_bf16 v186, v134, v158, v186
    v_dot2_f32_bf16 v187, v134, v159, v187
    v_dot2_f32_bf16 v188, v135, v158, v188
    v_dot2_f32_bf16 v189, v135, v159, v189
    ds_read_b64 v[126:127], v23 offset:22512
    ds_read_b64 v[128:129], v23 offset:22520
    ds_read_b64 v[130:131], v23 offset:22528
    ds_read_b64 v[132:133], v23 offset:22536
    ds_read_b64 v[134:135], v23 offset:22544
    s_waitcnt lgkmcnt(5)
    v_dot2_f32_bf16 v170, v136, v160, v170
    v_dot2_f32_bf16 v171, v136, v161, v171
    v_dot2_f32_bf16 v172, v137, v160, v172
    v_dot2_f32_bf16 v173, v137, v161, v173
    v_dot2_f32_bf16 v174, v138, v160, v174
    v_dot2_f32_bf16 v175, v138, v161, v175
    v_dot2_f32_bf16 v176, v139, v160, v176
    v_dot2_f32_bf16 v177, v139, v161, v177
    v_dot2_f32_bf16 v178, v140, v160, v178
    v_dot2_f32_bf16 v179, v140, v161, v179
    v_dot2_f32_bf16 v180, v141, v160, v180
    v_dot2_f32_bf16 v181, v141, v161, v181
    v_dot2_f32_bf16 v182, v142, v160, v182
    v_dot2_f32_bf16 v183, v142, v161, v183
    v_dot2_f32_bf16 v184, v143, v160, v184
    v_dot2_f32_bf16 v185, v143, v161, v185
    v_dot2_f32_bf16 v186, v144, v160, v186
    v_dot2_f32_bf16 v187, v144, v161, v187
    v_dot2_f32_bf16 v188, v145, v160, v188
    v_dot2_f32_bf16 v189, v145, v161, v189
    ds_read_b64 v[136:137], v23 offset:22176
    ds_read_b64 v[138:139], v23 offset:22184
    ds_read_b64 v[140:141], v23 offset:22192
    ds_read_b64 v[142:143], v23 offset:22200
    ds_read_b64 v[144:145], v23 offset:22208
    s_waitcnt lgkmcnt(5)
    v_dot2_f32_bf16 v170, v126, v162, v170
    v_dot2_f32_bf16 v171, v126, v163, v171
    v_dot2_f32_bf16 v172, v127, v162, v172
    v_dot2_f32_bf16 v173, v127, v163, v173
    v_dot2_f32_bf16 v174, v128, v162, v174
    v_dot2_f32_bf16 v175, v128, v163, v175
    v_dot2_f32_bf16 v176, v129, v162, v176
    v_dot2_f32_bf16 v177, v129, v163, v177
    v_dot2_f32_bf16 v178, v130, v162, v178
    v_dot2_f32_bf16 v179, v130, v163, v179
    v_dot2_f32_bf16 v180, v131, v162, v180
    v_dot2_f32_bf16 v181, v131, v163, v181
    v_dot2_f32_bf16 v182, v132, v162, v182
    v_dot2_f32_bf16 v183, v132, v163, v183
    v_dot2_f32_bf16 v184, v133, v162, v184
    v_dot2_f32_bf16 v185, v133, v163, v185
    v_dot2_f32_bf16 v186, v134, v162, v186
    v_dot2_f32_bf16 v187, v134, v163, v187
    v_dot2_f32_bf16 v188, v135, v162, v188
    v_dot2_f32_bf16 v189, v135, v163, v189
    ds_read_b64 v[126:127], v23 offset:21840
    ds_read_b64 v[128:129], v23 offset:21848
    ds_read_b64 v[130:131], v23 offset:21856
    ds_read_b64 v[132:133], v23 offset:21864
    ds_read_b64 v[134:135], v23 offset:21872
    s_waitcnt lgkmcnt(5)
    v_dot2_f32_bf16 v170, v136, v164, v170
    v_dot2_f32_bf16 v171, v136, v165, v171
    v_dot2_f32_bf16 v172, v137, v164, v172
    v_dot2_f32_bf16 v173, v137, v165, v173
    v_dot2_f32_bf16 v174, v138, v164, v174
    v_dot2_f32_bf16 v175, v138, v165, v175
    v_dot2_f32_bf16 v176, v139, v164, v176
    v_dot2_f32_bf16 v177, v139, v165, v177
    v_dot2_f32_bf16 v178, v140, v164, v178
    v_dot2_f32_bf16 v179, v140, v165, v179
    v_dot2_f32_bf16 v180, v141, v164, v180
    v_dot2_f32_bf16 v181, v141, v165, v181
    v_dot2_f32_bf16 v182, v142, v164, v182
    v_dot2_f32_bf16 v183, v142, v165, v183
    v_dot2_f32_bf16 v184, v143, v164, v184
    v_dot2_f32_bf16 v185, v143, v165, v185
    v_dot2_f32_bf16 v186, v144, v164, v186
    v_dot2_f32_bf16 v187, v144, v165, v187
    v_dot2_f32_bf16 v188, v145, v164, v188
    v_dot2_f32_bf16 v189, v145, v165, v189
    ds_read_b64 v[136:137], v23 offset:21504
    ds_read_b64 v[138:139], v23 offset:21512
    ds_read_b64 v[140:141], v23 offset:21520
    ds_read_b64 v[142:143], v23 offset:21528
    ds_read_b64 v[144:145], v23 offset:21536
    s_waitcnt lgkmcnt(5)
    v_dot2_f32_bf16 v170, v126, v166, v170
    v_dot2_f32_bf16 v171, v126, v167, v171
    v_dot2_f32_bf16 v172, v127, v166, v172
    v_dot2_f32_bf16 v173, v127, v167, v173
    v_dot2_f32_bf16 v174, v128, v166, v174
    v_dot2_f32_bf16 v175, v128, v167, v175
    v_dot2_f32_bf16 v176, v129, v166, v176
    v_dot2_f32_bf16 v177, v129, v167, v177
    v_dot2_f32_bf16 v178, v130, v166, v178
    v_dot2_f32_bf16 v179, v130, v167, v179
    v_dot2_f32_bf16 v180, v131, v166, v180
    v_dot2_f32_bf16 v181, v131, v167, v181
    v_dot2_f32_bf16 v182, v132, v166, v182
    v_dot2_f32_bf16 v183, v132, v167, v183
    v_dot2_f32_bf16 v184, v133, v166, v184
    v_dot2_f32_bf16 v185, v133, v167, v185
    v_dot2_f32_bf16 v186, v134, v166, v186
    v_dot2_f32_bf16 v187, v134, v167, v187
    v_dot2_f32_bf16 v188, v135, v166, v188
    v_dot2_f32_bf16 v189, v135, v167, v189
    s_waitcnt lgkmcnt(0)
    v_dot2_f32_bf16 v170, v136, v168, v170
    v_dot2_f32_bf16 v171, v136, v169, v171
    v_dot2_f32_bf16 v172, v137, v168, v172
    v_dot2_f32_bf16 v173, v137, v169, v173
    v_dot2_f32_bf16 v174, v138, v168, v174
    v_dot2_f32_bf16 v175, v138, v169, v175
    v_dot2_f32_bf16 v176, v139, v168, v176
    v_dot2_f32_bf16 v177, v139, v169, v177
    v_dot2_f32_bf16 v178, v140, v168, v178
    v_dot2_f32_bf16 v179, v140, v169, v179
    v_dot2_f32_bf16 v180, v141, v168, v180
    v_dot2_f32_bf16 v181, v141, v169, v181
    v_dot2_f32_bf16 v182, v142, v168, v182
    v_dot2_f32_bf16 v183, v142, v169, v183
    v_dot2_f32_bf16 v184, v143, v168, v184
    v_dot2_f32_bf16 v185, v143, v169, v185
    v_dot2_f32_bf16 v186, v144, v168, v186
    v_dot2_f32_bf16 v187, v144, v169, v187
    v_dot2_f32_bf16 v188, v145, v168, v188
    v_dot2_f32_bf16 v189, v145, v169, v189
    v_cvt_pk_bf16_f32 v116, v170, v171
    v_cvt_pk_bf16_f32 v117, v172, v173
    v_cvt_pk_bf16_f32 v118, v174, v175
    v_cvt_pk_bf16_f32 v119, v176, v177
    v_cvt_pk_bf16_f32 v120, v178, v179
    v_cvt_pk_bf16_f32 v121, v180, v181
    v_cvt_pk_bf16_f32 v122, v182, v183
    v_cvt_pk_bf16_f32 v123, v184, v185
    v_cvt_pk_bf16_f32 v124, v186, v187
    v_cvt_pk_bf16_f32 v125, v188, v189
    ds_write_b64 v22, v[116:117] offset:0
    ds_write_b64 v22, v[118:119] offset:8
    ds_write_b64 v22, v[120:121] offset:16
    ds_write_b64 v22, v[122:123] offset:24
    ds_write_b64 v22, v[124:125] offset:32
    s_waitcnt lgkmcnt(0)
    s_add_u32 s50, s50, 80
    s_cmp_lt_u32 s50, 160
    s_cbranch_scc1 L_pa_att
    s_cmp_lg_u32 s48, 0
    s_cbranch_scc1 L_pa_o1
    ds_read_b64 a[160:161], v28 offset:32
    ds_read_b64 a[162:163], v28 offset:40
    ds_read_b64 a[240:241], v28 offset:2720
    ds_read_b64 a[242:243], v28 offset:2728
    ds_read_b64 a[164:165], v28 offset:96
    ds_read_b64 a[166:167], v28 offset:104
    ds_read_b64 a[244:245], v28 offset:2784
    ds_read_b64 a[246:247], v28 offset:2792
    s_mov_b32 exec_hi, 0
    ds_read_b64 a[168:169], v28 offset:160
    ds_read_b64 a[170:171], v28 offset:168
    ds_read_b64 a[248:249], v28 offset:2848
    ds_read_b64 a[250:251], v28 offset:2856
    s_mov_b64 exec, -1
    s_branch L_pa_oe
L_pa_o1:
    s_cmp_lg_u32 s48, 1
    s_cbranch_scc1 L_pa_o2
    s_mov_b32 exec_lo, 0
    ds_read_b64 a[168:169], v28 offset:0
    ds_read_b64 a[170:171], v28 offset:8
    ds_read_b64 a[248:249], v28 offset:2688
    ds_read_b64 a[250:251], v28 offset:2696
    s_mov_b64 exec, -1
    ds_read_b64 a[172:173], v28 offset:64
    ds_read_b64 a[174:175], v28 offset:72
    ds_read_b64 a[252:253], v28 offset:2752
    ds_read_b64 a[254:255], v28 offset:2760
    ds_read_b64 a[176:177], v28 offset:128
    ds_read_b64 a[178:179], v28 offset:136
    ds_read_b64 v[32:33], v28 offset:2816
    ds_read_b64 v[34:35], v28 offset:2824
    s_branch L_pa_oe
L_pa_o2:
    s_cmp_lg_u32 s48, 2
    s_cbranch_scc1 L_pa_o3
    ds_read_b64 a[180:181], v28 offset:32
    ds_read_b64 a[182:183], v28 offset:40
    ds_read_b64 v[36:37], v28 offset:2720
    ds_read_b64 v[38:39], v28 offset:2728
    ds_read_b64 a[184:185], v28 offset:96
    ds_read_b64 a[186:187], v28 offset:104
    ds_read_b64 v[40:41], v28 offset:2784
    ds_read_b64 v[42:43], v28 offset:2792
    s_mov_b32 exec_hi, 0
    ds_read_b64 a[188:189], v28 offset:160
    ds_read_b64 a[190:191], v28 offset:168
    ds_read_b64 v[44:45], v28 offset:2848
    ds_read_b64 v[46:47], v28 offset:2856
    s_mov_b64 exec, -1
    s_branch L_pa_oe
L_pa_o3:
    s_cmp_lg_u32 s48, 3
    s_cbranch_scc1 L_pa_o4
    s_mov_b32 exec_lo, 0
    ds_read_b64 a[188:189], v28 offset:0
    ds_read_b64 a[190:191], v28 offset:8
    ds_read_b64 v[44:45], v28 offset:2688
    ds_read_b64 v[46:47], v28 offset:2696
    s_mov_b64 exec, -1
    ds_read_b64 a[192:193], v28 offset:64
    ds_read_b64 a[194:195], v28 offset:72
    ds_read_b64 v[48:49], v28 offset:2752
    ds_read_b64 v[50:51], v28 offset:2760
    ds_read_b64 a[196:197], v28 offset:128
    ds_read_b64 a[198:199], v28 offset:136
    ds_read_b64 v[52:53], v28 offset:2816
    ds_read_b64 v[54:55], v28 offset:2824
    s_branch L_pa_oe
L_pa_o4:
    s_cmp_lg_u32 s48, 4
    s_cbranch_scc1 L_pa_o5
    ds_read_b64 a[200:201], v28 offset:32
    ds_read_b64 a[202:203], v28 offset:40
    ds_read_b64 v[56:57], v28 offset:2720
    ds_read_b64 v[58:59], v28 offset:2728
    ds_read_b64 a[204:205], v28 offset:96
    ds_read_b64 a[206:207], v28 offset:104
    ds_read_b64 v[60:61], v28 offset:2784
    ds_read_b64 v[62:63], v28 offset:2792
    s_mov_b32 exec_hi, 0
    ds_read_b64 a[208:209], v28 offset:160
    ds_read_b64 a[210:211], v28 offset:168
    ds_read_b64 v[64:65], v28 offset:2848
    ds_read_b64 v[66:67], v28 offset:2856
    s_mov_b64 exec, -1
    s_branch L_pa_oe
L_pa_o5:
    s_cmp_lg_u32 s48, 5
    s_cbranch_scc1 L_pa_o6
    s_mov_b32 exec_lo, 0
    ds_read_b64 a[208:209], v28 offset:0
    ds_read_b64 a[210:211], v28 offset:8
    ds_read_b64 v[64:65], v28 offset:2688
    ds_read_b64 v[66:67], v28 offset:2696
    s_mov_b64 exec, -1
    ds_read_b64 a[212:213], v28 offset:64
    ds_read_b64 a[214:215], v28 offset:72
    ds_read_b64 v[68:69], v28 offset:2752
    ds_read_b64 v[70:71], v28 offset:2760
    ds_read_b64 a[216:217], v28 offset:128
    ds_read_b64 a[218:219], v28 offset:136
    ds_read_b64 v[72:73], v28 offset:2816
    ds_read_b64 v[74:75], v28 offset:2824
    s_branch L_pa_oe
L_pa_o6:
    s_cmp_lg_u32 s48, 6
    s_cbranch_scc1 L_pa_o7
    ds_read_b64 a[220:221], v28 offset:32
    ds_read_b64 a[222:223], v28 offset:40
    ds_read_b64 v[76:77], v28 offset:2720
    ds_read_b64 v[78:79], v28 offset:2728
    ds_read_b64 a[224:225], v28 offset:96
    ds_read_b64 a[226:227], v28 offset:104
    ds_read_b64 v[80:81], v28 offset:2784
    ds_read_b64 v[82:83], v28 offset:2792
    s_mov_b32 exec_hi, 0
    ds_read_b64 a[228:229], v28 offset:160
    ds_read_b64 a[230:231], v28 offset:168
    ds_read_b64 v[84:85], v28 offset:2848
    ds_read_b64 v[86:87], v28 offset:2856
    s_mov_b64 exec, -1
    s_branch L_pa_oe
L_pa_o7:
    s_mov_b32 exec_lo, 0
    ds_read_b64 a[228:229], v28 offset:0
    ds_read_b64 a[230:231], v28 offset:8
    ds_read_b64 v[84:85], v28 offset:2688
    ds_read_b64 v[86:87], v28 offset:2696
    s_mov_b64 exec, -1
    ds_read_b64 a[232:233], v28 offset:64
    ds_read_b64 a[234:235], v28 offset:72
    ds_read_b64 v[88:89], v28 offset:2752
    ds_read_b64 v[90:91], v28 offset:2760
    ds_read_b64 a[236:237], v28 offset:128
    ds_read_b64 a[238:239], v28 offset:136
    ds_read_b64 v[92:93], v28 offset:2816
    ds_read_b64 v[94:95], v28 offset:2824
L_pa_oe:
    s_waitcnt lgkmcnt(0)
    s_add_u32 s48, s48, 1
    s_and_b32 s48, s48, 7
    s_cmp_lg_u32 s48, s52
    s_cbranch_scc1 L_pa_grp
    v_add_u32 v3, 0, v0
    v_mul_u32_u24 v4, 6554, v3
    v_lshrrev_b32 v4, 16, v4
    v_mul_u32_u24 v5, 10, v4
    v_sub_u32 v5, v3, v5
    v_and_b32 v6, 19, v4
    v_and_b32 v7, 4, v4
    v_lshl_or_b32 v6, v7, 1, v6
    v_and_b32 v7, 8, v4
    v_lshrrev_b32 v7, 1, v7
    v_or_b32 v6, v6, v7
    s_lshl_b32 s90, s32, 5
    v_add_u32 v6, s90, v6
    v_mul_u32_u24 v6, 1280, v6
    v_lshl_add_u32 v10, v5, 4, v6
    v_add_u32 v3, 64, v0
    v_mul_u32_u24 v4, 6554, v3
    v_lshrrev_b32 v4, 16, v4
    v_mul_u32_u24 v5, 10, v4
    v_sub_u32 v5, v3, v5
    v_and_b32 v6, 19, v4
    v_and_b32 v7, 4, v4
    v_lshl_or_b32 v6, v7, 1, v6
    v_and_b32 v7, 8, v4
    v_lshrrev_b32 v7, 1, v7
    v_or_b32 v6, v6, v7
    s_lshl_b32 s90, s32, 5
    v_add_u32 v6, s90, v6
    v_mul_u32_u24 v6, 1280, v6
    v_lshl_add_u32 v11, v5, 4, v6
    v_add_u32 v3, 128, v0
    v_mul_u32_u24 v4, 6554, v3
    v_lshrrev_b32 v4, 16, v4
    v_mul_u32_u24 v5, 10, v4
    v_sub_u32 v5, v3, v5
    v_and_b32 v6, 19, v4
    v_and_b32 v7, 4, v4
    v_lshl_or_b32 v6, v7, 1, v6
    v_and_b32 v7, 8, v4
    v_lshrrev_b32 v7, 1, v7
    v_or_b32 v6, v6, v7
    s_lshl_b32 s90, s32, 5
    v_add_u32 v6, s90, v6
    v_mul_u32_u24 v6, 1280, v6
    v_lshl_add_u32 v12, v5, 4, v6
    v_add_u32 v3, 192, v0
    v_mul_u32_u24 v4, 6554, v3
    v_lshrrev_b32 v4, 16, v4
    v_mul_u32_u24 v5, 10, v4
    v_sub_u32 v5, v3, v5
    v_and_b32 v6, 19, v4
    v_and_b32 v7, 4, v4
    v_lshl_or_b32 v6, v7, 1, v6
    v_and_b32 v7, 8, v4
    v_lshrrev_b32 v7, 1, v7
    v_or_b32 v6, v6, v7
    s_lshl_b32 s90, s32, 5
    v_add_u32 v6, s90, v6
    v_mul_u32_u24 v6, 1280, v6
    v_lshl_add_u32 v13, v5, 4, v6
    v_add_u32 v3, 256, v0
    v_mul_u32_u24 v4, 6554, v3
    v_lshrrev_b32 v4, 16, v4
    v_mul_u32_u24 v5, 10, v4
    v_sub_u32 v5, v3, v5
    v_and_b32 v6, 19, v4
    v_and_b32 v7, 4, v4
    v_lshl_or_b32 v6, v7, 1, v6
    v_and_b32 v7, 8, v4
    v_lshrrev_b32 v7, 1, v7
    v_or_b32 v6, v6, v7
    s_lshl_b32 s90, s32, 5
    v_add_u32 v6, s90, v6
    v_mul_u32_u24 v6, 1280, v6
    v_lshl_add_u32 v14, v5, 4, v6
    s_waitcnt vmcnt(0) lgkmcnt(0)
    s_barrier
    s_mov_b32 s46, 0
    s_mov_b32 s47, 0
    s_mul_i32 s43, s52, 160
    s_mov_b32 s44, 0
    s_mov_b32 s45, 0
    s_mov_b32 s51, 39
    s_mov_b32 s48, s52
    s_mov_b32 s53, 0
    s_mul_i32 s90, s32, 5120
    s_add_u32 m0, s90, s47
    s_mul_i32 s91, s44, 163840
    s_add_u32 s91, s91, s43
    buffer_load_dwordx4 v10, s[20:23], s91 offen lds
    s_add_u32 s47, s47, 20480
    s_cmp_eq_u32 s47, 81920
    s_cselect_b32 s47, 0, s47
    s_cmp_lg_u32 s51, 0
    s_cselect_b32 s90, 1, 0
    s_sub_u32 s51, s51, s90
    s_add_u32 s44, s44, s90
    s_cmp_eq_u32 s44, 5
    s_cselect_b32 s44, 0, s44
    s_cselect_b32 s90, 160, 0
    s_add_u32 s43, s43, s90
    s_cmp_eq_u32 s43, 1280
    s_cselect_b32 s43, 0, s43
    s_add_u32 m0, m0, 1024
    s_nop 0
    buffer_load_dwordx4 v11, s[20:23], s91 offen lds
    s_add_u32 m0, m0, 1024
    s_nop 0
    buffer_load_dwordx4 v12, s[20:23], s91 offen lds
    s_add_u32 m0, m0, 1024
    s_nop 0
    buffer_load_dwordx4 v13, s[20:23], s91 offen lds
    s_add_u32 m0, m0, 1024
    s_nop 0
    buffer_load_dwordx4 v14, s[20:23], s91 offen lds
    s_mul_i32 s90, s32, 5120
    s_add_u32 m0, s90, s47
    s_mul_i32 s91, s44, 163840
    s_add_u32 s91, s91, s43
    buffer_load_dwordx4 v10, s[20:23], s91 offen lds
    s_add_u32 s47, s47, 20480
    s_cmp_eq_u32 s47, 81920
    s_cselect_b32 s47, 0, s47
    s_cmp_lg_u32 s51, 0
    s_cselect_b32 s90, 1, 0
    s_sub_u32 s51, s51, s90
    s_add_u32 s44, s44, s90
    s_cmp_eq_u32 s44, 5
    s_cselect_b32 s44, 0, s44
    s_cselect_b32 s90, 160, 0
    s_add_u32 s43, s43, s90
    s_cmp_eq_u32 s43, 1280
    s_cselect_b32 s43, 0, s43
    s_add_u32 m0, m0, 1024
    s_nop 0
    buffer_load_dwordx4 v11, s[20:23], s91 offen lds
    s_add_u32 m0, m0, 1024
    s_nop 0
    buffer_load_dwordx4 v12, s[20:23], s91 offen lds
    s_add_u32 m0, m0, 1024
    s_nop 0
    buffer_load_dwordx4 v13, s[20:23], s91 offen lds
    s_add_u32 m0, m0, 1024
    s_nop 0
    buffer_load_dwordx4 v14, s[20:23], s91 offen lds
    s_mul_i32 s90, s32, 5120
    s_add_u32 m0, s90, s47
    s_mul_i32 s91, s44, 163840
    s_add_u32 s91, s91, s43
    buffer_load_dwordx4 v10, s[20:23], s91 offen lds
    s_add_u32 s47, s47, 20480
    s_cmp_eq_u32 s47, 81920
    s_cselect_b32 s47, 0, s47
    s_cmp_lg_u32 s51, 0
    s_cselect_b32 s90, 1, 0
    s_sub_u32 s51, s51, s90
    s_add_u32 s44, s44, s90
    s_cmp_eq_u32 s44, 5
    s_cselect_b32 s44, 0, s44
    s_cselect_b32 s90, 160, 0
    s_add_u32 s43, s43, s90
    s_cmp_eq_u32 s43, 1280
    s_cselect_b32 s43, 0, s43
    s_add_u32 m0, m0, 1024
    s_nop 0
    buffer_load_dwordx4 v11, s[20:23], s91 offen lds
    s_add_u32 m0, m0, 1024
    s_nop 0
    buffer_load_dwordx4 v12, s[20:23], s91 offen lds
    s_add_u32 m0, m0, 1024
    s_nop 0
    buffer_load_dwordx4 v13, s[20:23], s91 offen lds
    s_add_u32 m0, m0, 1024
    s_nop 0
    buffer_load_dwordx4 v14, s[20:23], s91 offen lds
    v_add_u32 v16, s46, v15
    s_waitcnt vmcnt(10) lgkmcnt(0)
    s_barrier
    ds_read_b64_tr_b16 v[96:97], v16 offset:0
    ds_read_b64_tr_b16 v[98:99], v16 offset:1280
    ds_read_b64_tr_b16 v[100:101], v16 offset:32
    ds_read_b64_tr_b16 v[102:103], v16 offset:1312
    ds_read_b64_tr_b16 v[104:105], v16 offset:64
    ds_read_b64_tr_b16 v[106:107], v16 offset:1344
    ds_read_b64_tr_b16 v[108:109], v16 offset:96
    ds_read_b64_tr_b16 v[110:111], v16 offset:1376
    ds_read_b64_tr_b16 v[112:113], v16 offset:128
    ds_read_b64_tr_b16 v[114:115], v16 offset:1408
    s_mul_i32 s42, s52, 160
L_pa_oblk:
    s_waitcnt lgkmcnt(8)
    v_mfma_f32_16x16x32_bf16 v[136:139], v[96:99], a[160:163], 0
    ds_read_b64_tr_b16 v[116:117], v16 offset:5120
    s_add_u32 s46, s46, 20480
    s_cmp_eq_u32 s46, 81920
    v_mfma_f32_16x16x32_bf16 v[140:143], v[96:99], a[240:243], 0
    ds_read_b64_tr_b16 v[118:119], v16 offset:6400
    s_cselect_b32 s46, 0, s46
    s_mul_i32 s90, s32, 5120
    s_waitcnt lgkmcnt(8)
    v_mfma_f32_16x16x32_bf16 v[144:147], v[100:103], a[160:163], 0
    ds_read_b64_tr_b16 v[120:121], v16 offset:5152
    s_add_u32 m0, s90, s47
    s_mul_i32 s91, s44, 163840
    v_mfma_f32_16x16x32_bf16 v[148:151], v[100:103], a[240:243], 0
    ds_read_b64_tr_b16 v[122:123], v16 offset:6432
    s_add_u32 s91, s91, s43
    buffer_load_dwordx4 v10, s[20:23], s91 offen lds
    s_waitcnt lgkmcnt(8)
    v_mfma_f32_16x16x32_bf16 v[152:155], v[104:107], a[160:163], 0
    ds_read_b64_tr_b16 v[124:125], v16 offset:5184
    s_add_u32 s47, s47, 20480
    s_cmp_eq_u32 s47, 81920
    v_mfma_f32_16x16x32_bf16 v[156:159], v[104:107], a[240:243], 0
    ds_read_b64_tr_b16 v[126:127], v16 offset:6464
    s_cselect_b32 s47, 0, s47
    s_cmp_lg_u32 s51, 0
    s_waitcnt lgkmcnt(8)
    v_mfma_f32_16x16x32_bf16 v[160:163], v[108:111], a[160:163], 0
    ds_read_b64_tr_b16 v[128:129], v16 offset:5216
    s_cselect_b32 s90, 1, 0
    s_sub_u32 s51, s51, s90
    v_mfma_f32_16x16x32_bf16 v[164:167], v[108:111], a[240:243], 0
    ds_read_b64_tr_b16 v[130:131], v16 offset:6496
    s_add_u32 s44, s44, s90
    s_cmp_eq_u32 s44, 5
    s_waitcnt lgkmcnt(8)
    v_mfma_f32_16x16x32_bf16 v[168:171], v[112:115], a[160:163], 0
    ds_read_b64_tr_b16 v[132:133], v16 offset:5248
    s_cselect_b32 s44, 0, s44
    s_cselect_b32 s90, 160, 0
    v_mfma_f32_16x16x32_bf16 v[172:175], v[112:115], a[240:243], 0
    ds_read_b64_tr_b16 v[134:135], v16 offset:6528
    s_add_u32 s43, s43, s90
    s_cmp_eq_u32 s43, 1280
    s_waitcnt lgkmcnt(8)
    v_mfma_f32_16x16x32_bf16 v[136:139], v[116:119], a[164:167], v[136:139]
    ds_read_b64_tr_b16 v[96:97], v16 offset:10240
    s_cselect_b32 s43, 0, s43
    s_add_u32 m0, m0, 1024
    v_mfma_f32_16x16x32_bf16 v[140:143], v[116:119], a[244:247], v[140:143]
    ds_read_b64_tr_b16 v[98:99], v16 offset:11520
    buffer_load_dwordx4 v11, s[20:23], s91 offen lds
    s_add_u32 m0, m0, 1024
    s_waitcnt lgkmcnt(8)
    v_mfma_f32_16x16x32_bf16 v[144:147], v[120:123], a[164:167], v[144:147]
    ds_read_b64_tr_b16 v[100:101], v16 offset:10272
    v_mfma_f32_16x16x32_bf16 v[148:151], v[120:123], a[244:247], v[148:151]
    ds_read_b64_tr_b16 v[102:103], v16 offset:11552
    s_waitcnt lgkmcnt(8)
    v_mfma_f32_16x16x32_bf16 v[152:155], v[124:127], a[164:167], v[152:155]
    ds_read_b64_tr_b16 v[104:105], v16 offset:10304
    v_mfma_f32_16x16x32_bf16 v[156:159], v[124:127], a[244:247], v[156:159]
    ds_read_b64_tr_b16 v[106:107], v16 offset:11584
    s_waitcnt lgkmcnt(8)
    v_mfma_f32_16x16x32_bf16 v[160:163], v[128:131], a[164:167], v[160:163]
    ds_read_b64_tr_b16 v[108:109], v16 offset:10336
    buffer_load_dwordx4 v12, s[20:23], s91 offen lds
    s_add_u32 m0, m0, 1024
    v_mfma_f32_16x16x32_bf16 v[164:167], v[128:131], a[244:247], v[164:167]
    ds_read_b64_tr_b16 v[110:111], v16 offset:11616
    s_waitcnt lgkmcnt(8)
    v_mfma_f32_16x16x32_bf16 v[168:171], v[132:135], a[164:167], v[168:171]
    ds_read_b64_tr_b16 v[112:113], v16 offset:10368
    v_mfma_f32_16x16x32_bf16 v[172:175], v[132:135], a[244:247], v[172:175]
    ds_read_b64_tr_b16 v[114:115], v16 offset:11648
    s_waitcnt lgkmcnt(8)
    v_mfma_f32_16x16x32_bf16 v[136:139], v[96:99], a[168:171], v[136:139]
    ds_read_b64_tr_b16 v[116:117], v16 offset:15360
    v_mfma_f32_16x16x32_bf16 v[140:143], v[96:99], a[248:251], v[140:143]
    ds_read_b64_tr_b16 v[118:119], v16 offset:16640
    buffer_load_dwordx4 v13, s[20:23], s91 offen lds
    s_add_u32 m0, m0, 1024
    s_waitcnt lgkmcnt(8)
    v_mfma_f32_16x16x32_bf16 v[144:147], v[100:103], a[168:171], v[144:147]
    ds_read_b64_tr_b16 v[120:121], v16 offset:15392
    v_mfma_f32_16x16x32_bf16 v[148:151], v[100:103], a[248:251], v[148:151]
    ds_read_b64_tr_b16 v[122:123], v16 offset:16672
    s_waitcnt lgkmcnt(8)
    v_mfma_f32_16x16x32_bf16 v[152:155], v[104:107], a[168:171], v[152:155]
    ds_read_b64_tr_b16 v[124:125], v16 offset:15424
    v_mfma_f32_16x16x32_bf16 v[156:159], v[104:107], a[248:251], v[156:159]
    ds_read_b64_tr_b16 v[126:127], v16 offset:16704
    s_waitcnt lgkmcnt(8)
    v_mfma_f32_16x16x32_bf16 v[160:163], v[108:111], a[168:171], v[160:163]
    ds_read_b64_tr_b16 v[128:129], v16 offset:15456
    buffer_load_dwordx4 v14, s[20:23], s91 offen lds
    v_mfma_f32_16x16x32_bf16 v[164:167], v[108:111], a[248:251], v[164:167]
    ds_read_b64_tr_b16 v[130:131], v16 offset:16736
    s_waitcnt lgkmcnt(8)
    v_mfma_f32_16x16x32_bf16 v[168:171], v[112:115], a[168:171], v[168:171]
    ds_read_b64_tr_b16 v[132:133], v16 offset:15488
    v_mfma_f32_16x16x32_bf16 v[172:175], v[112:115], a[248:251], v[172:175]
    ds_read_b64_tr_b16 v[134:135], v16 offset:16768
    s_waitcnt lgkmcnt(8)
    v_mfma_f32_16x16x32_bf16 v[136:139], v[116:119], a[172:175], v[136:139]
    v_mfma_f32_16x16x32_bf16 v[140:143], v[116:119], a[252:255], v[140:143]
    s_waitcnt lgkmcnt(6)
    v_mfma_f32_16x16x32_bf16 v[144:147], v[120:123], a[172:175], v[144:147]
    v_mfma_f32_16x16x32_bf16 v[148:151], v[120:123], a[252:255], v[148:151]
    v_add_u32 v16, s46, v15
    s_waitcnt vmcnt(10) lgkmcnt(0)
    s_barrier
    v_mfma_f32_16x16x32_bf16 v[152:155], v[124:127], a[172:175], v[152:155]
    ds_read_b64_tr_b16 v[96:97], v16 offset:0
    ds_read_b64_tr_b16 v[98:99], v16 offset:1280
    v_mfma_f32_16x16x32_bf16 v[156:159], v[124:127], a[252:255], v[156:159]
    ds_read_b64_tr_b16 v[100:101], v16 offset:32
    ds_read_b64_tr_b16 v[102:103], v16 offset:1312
    v_mfma_f32_16x16x32_bf16 v[160:163], v[128:131], a[172:175], v[160:163]
    ds_read_b64_tr_b16 v[104:105], v16 offset:64
    ds_read_b64_tr_b16 v[106:107], v16 offset:1344
    v_mfma_f32_16x16x32_bf16 v[164:167], v[128:131], a[252:255], v[164:167]
    ds_read_b64_tr_b16 v[108:109], v16 offset:96
    ds_read_b64_tr_b16 v[110:111], v16 offset:1376
    v_mfma_f32_16x16x32_bf16 v[168:171], v[132:135], a[172:175], v[168:171]
    ds_read_b64_tr_b16 v[112:113], v16 offset:128
    ds_read_b64_tr_b16 v[114:115], v16 offset:1408
    v_mfma_f32_16x16x32_bf16 v[172:175], v[132:135], a[252:255], v[172:175]
    s_waitcnt lgkmcnt(8)
    v_mfma_f32_16x16x32_bf16 v[136:139], v[96:99], a[176:179], v[136:139]
    ds_read_b64_tr_b16 v[116:117], v16 offset:5120
    s_add_u32 s46, s46, 20480
    s_cmp_eq_u32 s46, 81920
    v_mfma_f32_16x16x32_bf16 v[140:143], v[96:99], v[32:35], v[140:143]
    ds_read_b64_tr_b16 v[118:119], v16 offset:6400
    s_cselect_b32 s46, 0, s46
    s_mul_i32 s90, s32, 5120
    s_waitcnt lgkmcnt(8)
    v_mfma_f32_16x16x32_bf16 v[144:147], v[100:103], a[176:179], v[144:147]
    ds_read_b64_tr_b16 v[120:121], v16 offset:5152
    s_add_u32 m0, s90, s47
    s_mul_i32 s91, s44, 163840
    v_mfma_f32_16x16x32_bf16 v[148:151], v[100:103], v[32:35], v[148:151]
    ds_read_b64_tr_b16 v[122:123], v16 offset:6432
    s_add_u32 s91, s91, s43
    buffer_load_dwordx4 v10, s[20:23], s91 offen lds
    s_waitcnt lgkmcnt(8)
    v_mfma_f32_16x16x32_bf16 v[152:155], v[104:107], a[176:179], v[152:155]
    ds_read_b64_tr_b16 v[124:125], v16 offset:5184
    s_add_u32 s47, s47, 20480
    s_cmp_eq_u32 s47, 81920
    v_mfma_f32_16x16x32_bf16 v[156:159], v[104:107], v[32:35], v[156:159]
    ds_read_b64_tr_b16 v[126:127], v16 offset:6464
    s_cselect_b32 s47, 0, s47
    s_cmp_lg_u32 s51, 0
    s_waitcnt lgkmcnt(8)
    v_mfma_f32_16x16x32_bf16 v[160:163], v[108:111], a[176:179], v[160:163]
    ds_read_b64_tr_b16 v[128:129], v16 offset:5216
    s_cselect_b32 s90, 1, 0
    s_sub_u32 s51, s51, s90
    v_mfma_f32_16x16x32_bf16 v[164:167], v[108:111], v[32:35], v[164:167]
    ds_read_b64_tr_b16 v[130:131], v16 offset:6496
    s_add_u32 s44, s44, s90
    s_cmp_eq_u32 s44, 5
    s_waitcnt lgkmcnt(8)
    v_mfma_f32_16x16x32_bf16 v[168:171], v[112:115], a[176:179], v[168:171]
    ds_read_b64_tr_b16 v[132:133], v16 offset:5248
    s_cselect_b32 s44, 0, s44
    s_cselect_b32 s90, 160, 0
    v_mfma_f32_16x16x32_bf16 v[172:175], v[112:115], v[32:35], v[172:175]
    ds_read_b64_tr_b16 v[134:135], v16 offset:6528
    s_add_u32 s43, s43, s90
    s_cmp_eq_u32 s43, 1280
    s_waitcnt lgkmcnt(8)
    v_mfma_f32_16x16x32_bf16 v[136:139], v[116:119], a[180:183], v[136:139]
    ds_read_b64_tr_b16 v[96:97], v16 offset:10240
    s_cselect_b32 s43, 0, s43
    s_add_u32 m0, m0, 1024
    v_mfma_f32_16x16x32_bf16 v[140:143], v[116:119], v[36:39], v[140:143]
    ds_read_b64_tr_b16 v[98:99], v16 offset:11520
    buffer_load_dwordx4 v11, s[20:23], s91 offen lds
    s_add_u32 m0, m0, 1024
    s_waitcnt lgkmcnt(8)
    v_mfma_f32_16x16x32_bf16 v[144:147], v[120:123], a[180:183], v[144:147]
    ds_read_b64_tr_b16 v[100:101], v16 offset:10272
    v_mfma_f32_16x16x32_bf16 v[148:151], v[120:123], v[36:39], v[148:151]
    ds_read_b64_tr_b16 v[102:103], v16 offset:11552
    s_waitcnt lgkmcnt(8)
    v_mfma_f32_16x16x32_bf16 v[152:155], v[124:127], a[180:183], v[152:155]
    ds_read_b64_tr_b16 v[104:105], v16 offset:10304
    v_mfma_f32_16x16x32_bf16 v[156:159], v[124:127], v[36:39], v[156:159]
    ds_read_b64_tr_b16 v[106:107], v16 offset:11584
    s_waitcnt lgkmcnt(8)
    v_mfma_f32_16x16x32_bf16 v[160:163], v[128:131], a[180:183], v[160:163]
    ds_read_b64_tr_b16 v[108:109], v16 offset:10336
    buffer_load_dwordx4 v12, s[20:23], s91 offen lds
    s_add_u32 m0, m0, 1024
    v_mfma_f32_16x16x32_bf16 v[164:167], v[128:131], v[36:39], v[164:167]
    ds_read_b64_tr_b16 v[110:111], v16 offset:11616
    s_waitcnt lgkmcnt(8)
    v_mfma_f32_16x16x32_bf16 v[168:171], v[132:135], a[180:183], v[168:171]
    ds_read_b64_tr_b16 v[112:113], v16 offset:10368
    v_mfma_f32_16x16x32_bf16 v[172:175], v[132:135], v[36:39], v[172:175]
    ds_read_b64_tr_b16 v[114:115], v16 offset:11648
    s_waitcnt lgkmcnt(8)
    v_mfma_f32_16x16x32_bf16 v[136:139], v[96:99], a[184:187], v[136:139]
    ds_read_b64_tr_b16 v[116:117], v16 offset:15360
    v_mfma_f32_16x16x32_bf16 v[140:143], v[96:99], v[40:43], v[140:143]
    ds_read_b64_tr_b16 v[118:119], v16 offset:16640
    buffer_load_dwordx4 v13, s[20:23], s91 offen lds
    s_add_u32 m0, m0, 1024
    s_waitcnt lgkmcnt(8)
    v_mfma_f32_16x16x32_bf16 v[144:147], v[100:103], a[184:187], v[144:147]
    ds_read_b64_tr_b16 v[120:121], v16 offset:15392
    v_mfma_f32_16x16x32_bf16 v[148:151], v[100:103], v[40:43], v[148:151]
    ds_read_b64_tr_b16 v[122:123], v16 offset:16672
    s_waitcnt lgkmcnt(8)
    v_mfma_f32_16x16x32_bf16 v[152:155], v[104:107], a[184:187], v[152:155]
    ds_read_b64_tr_b16 v[124:125], v16 offset:15424
    v_mfma_f32_16x16x32_bf16 v[156:159], v[104:107], v[40:43], v[156:159]
    ds_read_b64_tr_b16 v[126:127], v16 offset:16704
    s_waitcnt lgkmcnt(8)
    v_mfma_f32_16x16x32_bf16 v[160:163], v[108:111], a[184:187], v[160:163]
    ds_read_b64_tr_b16 v[128:129], v16 offset:15456
    buffer_load_dwordx4 v14, s[20:23], s91 offen lds
    v_mfma_f32_16x16x32_bf16 v[164:167], v[108:111], v[40:43], v[164:167]
    ds_read_b64_tr_b16 v[130:131], v16 offset:16736
    s_waitcnt lgkmcnt(8)
    v_mfma_f32_16x16x32_bf16 v[168:171], v[112:115], a[184:187], v[168:171]
    ds_read_b64_tr_b16 v[132:133], v16 offset:15488
    v_mfma_f32_16x16x32_bf16 v[172:175], v[112:115], v[40:43], v[172:175]
    ds_read_b64_tr_b16 v[134:135], v16 offset:16768
    s_waitcnt lgkmcnt(8)
    v_mfma_f32_16x16x32_bf16 v[136:139], v[116:119], a[188:191], v[136:139]
    v_mfma_f32_16x16x32_bf16 v[140:143], v[116:119], v[44:47], v[140:143]
    s_waitcnt lgkmcnt(6)
    v_mfma_f32_16x16x32_bf16 v[144:147], v[120:123], a[188:191], v[144:147]
    v_mfma_f32_16x16x32_bf16 v[148:151], v[120:123], v[44:47], v[148:151]
    v_add_u32 v16, s46, v15
    s_waitcnt vmcnt(10) lgkmcnt(0)
    s_barrier
    v_mfma_f32_16x16x32_bf16 v[152:155], v[124:127], a[188:191], v[152:155]
    ds_read_b64_tr_b16 v[96:97], v16 offset:0
    ds_read_b64_tr_b16 v[98:99], v16 offset:1280
    v_mfma_f32_16x16x32_bf16 v[156:159], v[124:127], v[44:47], v[156:159]
    ds_read_b64_tr_b16 v[100:101], v16 offset:32
    ds_read_b64_tr_b16 v[102:103], v16 offset:1312
    v_mfma_f32_16x16x32_bf16 v[160:163], v[128:131], a[188:191], v[160:163]
    ds_read_b64_tr_b16 v[104:105], v16 offset:64
    ds_read_b64_tr_b16 v[106:107], v16 offset:1344
    v_mfma_f32_16x16x32_bf16 v[164:167], v[128:131], v[44:47], v[164:167]
    ds_read_b64_tr_b16 v[108:109], v16 offset:96
    ds_read_b64_tr_b16 v[110:111], v16 offset:1376
    v_mfma_f32_16x16x32_bf16 v[168:171], v[132:135], a[188:191], v[168:171]
    ds_read_b64_tr_b16 v[112:113], v16 offset:128
    ds_read_b64_tr_b16 v[114:115], v16 offset:1408
    v_mfma_f32_16x16x32_bf16 v[172:175], v[132:135], v[44:47], v[172:175]
    s_waitcnt lgkmcnt(8)
    v_mfma_f32_16x16x32_bf16 v[136:139], v[96:99], a[192:195], v[136:139]
    ds_read_b64_tr_b16 v[116:117], v16 offset:5120
    s_add_u32 s46, s46, 20480
    s_cmp_eq_u32 s46, 81920
    v_mfma_f32_16x16x32_bf16 v[140:143], v[96:99], v[48:51], v[140:143]
    ds_read_b64_tr_b16 v[118:119], v16 offset:6400
    s_cselect_b32 s46, 0, s46
    s_mul_i32 s90, s32, 5120
    s_waitcnt lgkmcnt(8)
    v_mfma_f32_16x16x32_bf16 v[144:147], v[100:103], a[192:195], v[144:147]
    ds_read_b64_tr_b16 v[120:121], v16 offset:5152
    s_add_u32 m0, s90, s47
    s_mul_i32 s91, s44, 163840
    v_mfma_f32_16x16x32_bf16 v[148:151], v[100:103], v[48:51], v[148:151]
    ds_read_b64_tr_b16 v[122:123], v16 offset:6432
    s_add_u32 s91, s91, s43
    buffer_load_dwordx4 v10, s[20:23], s91 offen lds
    s_waitcnt lgkmcnt(8)
    v_mfma_f32_16x16x32_bf16 v[152:155], v[104:107], a[192:195], v[152:155]
    ds_read_b64_tr_b16 v[124:125], v16 offset:5184
    s_add_u32 s47, s47, 20480
    s_cmp_eq_u32 s47, 81920
    v_mfma_f32_16x16x32_bf16 v[156:159], v[104:107], v[48:51], v[156:159]
    ds_read_b64_tr_b16 v[126:127], v16 offset:6464
    s_cselect_b32 s47, 0, s47
    s_cmp_lg_u32 s51, 0
    s_waitcnt lgkmcnt(8)
    v_mfma_f32_16x16x32_bf16 v[160:163], v[108:111], a[192:195], v[160:163]
    ds_read_b64_tr_b16 v[128:129], v16 offset:5216
    s_cselect_b32 s90, 1, 0
    s_sub_u32 s51, s51, s90
    v_mfma_f32_16x16x32_bf16 v[164:167], v[108:111], v[48:51], v[164:167]
    ds_read_b64_tr_b16 v[130:131], v16 offset:6496
    s_add_u32 s44, s44, s90
    s_cmp_eq_u32 s44, 5
    s_waitcnt lgkmcnt(8)
    v_mfma_f32_16x16x32_bf16 v[168:171], v[112:115], a[192:195], v[168:171]
    ds_read_b64_tr_b16 v[132:133], v16 offset:5248
    s_cselect_b32 s44, 0, s44
    s_cselect_b32 s90, 160, 0
    v_mfma_f32_16x16x32_bf16 v[172:175], v[112:115], v[48:51], v[172:175]
    ds_read_b64_tr_b16 v[134:135], v16 offset:6528
    s_add_u32 s43, s43, s90
    s_cmp_eq_u32 s43, 1280
    s_waitcnt lgkmcnt(8)
    v_mfma_f32_16x16x32_bf16 v[136:139], v[116:119], a[196:199], v[136:139]
    ds_read_b64_tr_b16 v[96:97], v16 offset:10240
    s_cselect_b32 s43, 0, s43
    s_add_u32 m0, m0, 1024
    v_mfma_f32_16x16x32_bf16 v[140:143], v[116:119], v[52:55], v[140:143]
    ds_read_b64_tr_b16 v[98:99], v16 offset:11520
    buffer_load_dwordx4 v11, s[20:23], s91 offen lds
    s_add_u32 m0, m0, 1024
    s_waitcnt lgkmcnt(8)
    v_mfma_f32_16x16x32_bf16 v[144:147], v[120:123], a[196:199], v[144:147]
    ds_read_b64_tr_b16 v[100:101], v16 offset:10272
    v_mfma_f32_16x16x32_bf16 v[148:151], v[120:123], v[52:55], v[148:151]
    ds_read_b64_tr_b16 v[102:103], v16 offset:11552
    s_waitcnt lgkmcnt(8)
    v_mfma_f32_16x16x32_bf16 v[152:155], v[124:127], a[196:199], v[152:155]
    ds_read_b64_tr_b16 v[104:105], v16 offset:10304
    v_mfma_f32_16x16x32_bf16 v[156:159], v[124:127], v[52:55], v[156:159]
    ds_read_b64_tr_b16 v[106:107], v16 offset:11584
    s_waitcnt lgkmcnt(8)
    v_mfma_f32_16x16x32_bf16 v[160:163], v[128:131], a[196:199], v[160:163]
    ds_read_b64_tr_b16 v[108:109], v16 offset:10336
    buffer_load_dwordx4 v12, s[20:23], s91 offen lds
    s_add_u32 m0, m0, 1024
    v_mfma_f32_16x16x32_bf16 v[164:167], v[128:131], v[52:55], v[164:167]
    ds_read_b64_tr_b16 v[110:111], v16 offset:11616
    s_waitcnt lgkmcnt(8)
    v_mfma_f32_16x16x32_bf16 v[168:171], v[132:135], a[196:199], v[168:171]
    ds_read_b64_tr_b16 v[112:113], v16 offset:10368
    v_mfma_f32_16x16x32_bf16 v[172:175], v[132:135], v[52:55], v[172:175]
    ds_read_b64_tr_b16 v[114:115], v16 offset:11648
    s_waitcnt lgkmcnt(8)
    v_mfma_f32_16x16x32_bf16 v[136:139], v[96:99], a[200:203], v[136:139]
    ds_read_b64_tr_b16 v[116:117], v16 offset:15360
    v_mfma_f32_16x16x32_bf16 v[140:143], v[96:99], v[56:59], v[140:143]
    ds_read_b64_tr_b16 v[118:119], v16 offset:16640
    buffer_load_dwordx4 v13, s[20:23], s91 offen lds
    s_add_u32 m0, m0, 1024
    s_waitcnt lgkmcnt(8)
    v_mfma_f32_16x16x32_bf16 v[144:147], v[100:103], a[200:203], v[144:147]
    ds_read_b64_tr_b16 v[120:121], v16 offset:15392
    v_mfma_f32_16x16x32_bf16 v[148:151], v[100:103], v[56:59], v[148:151]
    ds_read_b64_tr_b16 v[122:123], v16 offset:16672
    s_waitcnt lgkmcnt(8)
    v_mfma_f32_16x16x32_bf16 v[152:155], v[104:107], a[200:203], v[152:155]
    ds_read_b64_tr_b16 v[124:125], v16 offset:15424
    v_mfma_f32_16x16x32_bf16 v[156:159], v[104:107], v[56:59], v[156:159]
    ds_read_b64_tr_b16 v[126:127], v16 offset:16704
    s_waitcnt lgkmcnt(8)
    v_mfma_f32_16x16x32_bf16 v[160:163], v[108:111], a[200:203], v[160:163]
    ds_read_b64_tr_b16 v[128:129], v16 offset:15456
    buffer_load_dwordx4 v14, s[20:23], s91 offen lds
    v_mfma_f32_16x16x32_bf16 v[164:167], v[108:111], v[56:59], v[164:167]
    ds_read_b64_tr_b16 v[130:131], v16 offset:16736
    s_waitcnt lgkmcnt(8)
    v_mfma_f32_16x16x32_bf16 v[168:171], v[112:115], a[200:203], v[168:171]
    ds_read_b64_tr_b16 v[132:133], v16 offset:15488
    v_mfma_f32_16x16x32_bf16 v[172:175], v[112:115], v[56:59], v[172:175]
    ds_read_b64_tr_b16 v[134:135], v16 offset:16768
    s_waitcnt lgkmcnt(8)
    v_mfma_f32_16x16x32_bf16 v[136:139], v[116:119], a[204:207], v[136:139]
    v_mfma_f32_16x16x32_bf16 v[140:143], v[116:119], v[60:63], v[140:143]
    s_waitcnt lgkmcnt(6)
    v_mfma_f32_16x16x32_bf16 v[144:147], v[120:123], a[204:207], v[144:147]
    v_mfma_f32_16x16x32_bf16 v[148:151], v[120:123], v[60:63], v[148:151]
    v_add_u32 v16, s46, v15
    s_waitcnt vmcnt(10) lgkmcnt(0)
    s_barrier
    v_mfma_f32_16x16x32_bf16 v[152:155], v[124:127], a[204:207], v[152:155]
    ds_read_b64_tr_b16 v[96:97], v16 offset:0
    ds_read_b64_tr_b16 v[98:99], v16 offset:1280
    v_mfma_f32_16x16x32_bf16 v[156:159], v[124:127], v[60:63], v[156:159]
    ds_read_b64_tr_b16 v[100:101], v16 offset:32
    ds_read_b64_tr_b16 v[102:103], v16 offset:1312
    v_mfma_f32_16x16x32_bf16 v[160:163], v[128:131], a[204:207], v[160:163]
    ds_read_b64_tr_b16 v[104:105], v16 offset:64
    ds_read_b64_tr_b16 v[106:107], v16 offset:1344
    v_mfma_f32_16x16x32_bf16 v[164:167], v[128:131], v[60:63], v[164:167]
    ds_read_b64_tr_b16 v[108:109], v16 offset:96
    ds_read_b64_tr_b16 v[110:111], v16 offset:1376
    v_mfma_f32_16x16x32_bf16 v[168:171], v[132:135], a[204:207], v[168:171]
    ds_read_b64_tr_b16 v[112:113], v16 offset:128
    ds_read_b64_tr_b16 v[114:115], v16 offset:1408
    v_mfma_f32_16x16x32_bf16 v[172:175], v[132:135], v[60:63], v[172:175]
    s_waitcnt lgkmcnt(8)
    v_mfma_f32_16x16x32_bf16 v[136:139], v[96:99], a[208:211], v[136:139]
    ds_read_b64_tr_b16 v[116:117], v16 offset:5120
    s_add_u32 s46, s46, 20480
    s_cmp_eq_u32 s46, 81920
    v_mfma_f32_16x16x32_bf16 v[140:143], v[96:99], v[64:67], v[140:143]
    ds_read_b64_tr_b16 v[118:119], v16 offset:6400
    s_cselect_b32 s46, 0, s46
    s_mul_i32 s90, s32, 5120
    s_waitcnt lgkmcnt(8)
    v_mfma_f32_16x16x32_bf16 v[144:147], v[100:103], a[208:211], v[144:147]
    ds_read_b64_tr_b16 v[120:121], v16 offset:5152
    s_add_u32 m0, s90, s47
    s_mul_i32 s91, s44, 163840
    v_mfma_f32_16x16x32_bf16 v[148:151], v[100:103], v[64:67], v[148:151]
    ds_read_b64_tr_b16 v[122:123], v16 offset:6432
    s_add_u32 s91, s91, s43
    buffer_load_dwordx4 v10, s[20:23], s91 offen lds
    s_waitcnt lgkmcnt(8)
    v_mfma_f32_16x16x32_bf16 v[152:155], v[104:107], a[208:211], v[152:155]
    ds_read_b64_tr_b16 v[124:125], v16 offset:5184
    s_add_u32 s47, s47, 20480
    s_cmp_eq_u32 s47, 81920
    v_mfma_f32_16x16x32_bf16 v[156:159], v[104:107], v[64:67], v[156:159]
    ds_read_b64_tr_b16 v[126:127], v16 offset:6464
    s_cselect_b32 s47, 0, s47
    s_cmp_lg_u32 s51, 0
    s_waitcnt lgkmcnt(8)
    v_mfma_f32_16x16x32_bf16 v[160:163], v[108:111], a[208:211], v[160:163]
    ds_read_b64_tr_b16 v[128:129], v16 offset:5216
    s_cselect_b32 s90, 1, 0
    s_sub_u32 s51, s51, s90
    v_mfma_f32_16x16x32_bf16 v[164:167], v[108:111], v[64:67], v[164:167]
    ds_read_b64_tr_b16 v[130:131], v16 offset:6496
    s_add_u32 s44, s44, s90
    s_cmp_eq_u32 s44, 5
    s_waitcnt lgkmcnt(8)
    v_mfma_f32_16x16x32_bf16 v[168:171], v[112:115], a[208:211], v[168:171]
    ds_read_b64_tr_b16 v[132:133], v16 offset:5248
    s_cselect_b32 s44, 0, s44
    s_cselect_b32 s90, 160, 0
    v_mfma_f32_16x16x32_bf16 v[172:175], v[112:115], v[64:67], v[172:175]
    ds_read_b64_tr_b16 v[134:135], v16 offset:6528
    s_add_u32 s43, s43, s90
    s_cmp_eq_u32 s43, 1280
    s_waitcnt lgkmcnt(8)
    v_mfma_f32_16x16x32_bf16 v[136:139], v[116:119], a[212:215], v[136:139]
    ds_read_b64_tr_b16 v[96:97], v16 offset:10240
    s_cselect_b32 s43, 0, s43
    s_add_u32 m0, m0, 1024
    v_mfma_f32_16x16x32_bf16 v[140:143], v[116:119], v[68:71], v[140:143]
    ds_read_b64_tr_b16 v[98:99], v16 offset:11520
    buffer_load_dwordx4 v11, s[20:23], s91 offen lds
    s_add_u32 m0, m0, 1024
    s_waitcnt lgkmcnt(8)
    v_mfma_f32_16x16x32_bf16 v[144:147], v[120:123], a[212:215], v[144:147]
    ds_read_b64_tr_b16 v[100:101], v16 offset:10272
    v_mfma_f32_16x16x32_bf16 v[148:151], v[120:123], v[68:71], v[148:151]
    ds_read_b64_tr_b16 v[102:103], v16 offset:11552
    s_waitcnt lgkmcnt(8)
    v_mfma_f32_16x16x32_bf16 v[152:155], v[124:127], a[212:215], v[152:155]
    ds_read_b64_tr_b16 v[104:105], v16 offset:10304
    v_mfma_f32_16x16x32_bf16 v[156:159], v[124:127], v[68:71], v[156:159]
    ds_read_b64_tr_b16 v[106:107], v16 offset:11584
    s_waitcnt lgkmcnt(8)
    v_mfma_f32_16x16x32_bf16 v[160:163], v[128:131], a[212:215], v[160:163]
    ds_read_b64_tr_b16 v[108:109], v16 offset:10336
    buffer_load_dwordx4 v12, s[20:23], s91 offen lds
    s_add_u32 m0, m0, 1024
    v_mfma_f32_16x16x32_bf16 v[164:167], v[128:131], v[68:71], v[164:167]
    ds_read_b64_tr_b16 v[110:111], v16 offset:11616
    s_waitcnt lgkmcnt(8)
    v_mfma_f32_16x16x32_bf16 v[168:171], v[132:135], a[212:215], v[168:171]
    ds_read_b64_tr_b16 v[112:113], v16 offset:10368
    v_mfma_f32_16x16x32_bf16 v[172:175], v[132:135], v[68:71], v[172:175]
    ds_read_b64_tr_b16 v[114:115], v16 offset:11648
    s_waitcnt lgkmcnt(8)
    v_mfma_f32_16x16x32_bf16 v[136:139], v[96:99], a[216:219], v[136:139]
    ds_read_b64_tr_b16 v[116:117], v16 offset:15360
    v_mfma_f32_16x16x32_bf16 v[140:143], v[96:99], v[72:75], v[140:143]
    ds_read_b64_tr_b16 v[118:119], v16 offset:16640
    buffer_load_dwordx4 v13, s[20:23], s91 offen lds
    s_add_u32 m0, m0, 1024
    s_waitcnt lgkmcnt(8)
    v_mfma_f32_16x16x32_bf16 v[144:147], v[100:103], a[216:219], v[144:147]
    ds_read_b64_tr_b16 v[120:121], v16 offset:15392
    v_mfma_f32_16x16x32_bf16 v[148:151], v[100:103], v[72:75], v[148:151]
    ds_read_b64_tr_b16 v[122:123], v16 offset:16672
    s_waitcnt lgkmcnt(8)
    v_mfma_f32_16x16x32_bf16 v[152:155], v[104:107], a[216:219], v[152:155]
    ds_read_b64_tr_b16 v[124:125], v16 offset:15424
    v_mfma_f32_16x16x32_bf16 v[156:159], v[104:107], v[72:75], v[156:159]
    ds_read_b64_tr_b16 v[126:127], v16 offset:16704
    s_waitcnt lgkmcnt(8)
    v_mfma_f32_16x16x32_bf16 v[160:163], v[108:111], a[216:219], v[160:163]
    ds_read_b64_tr_b16 v[128:129], v16 offset:15456
    buffer_load_dwordx4 v14, s[20:23], s91 offen lds
    v_mfma_f32_16x16x32_bf16 v[164:167], v[108:111], v[72:75], v[164:167]
    ds_read_b64_tr_b16 v[130:131], v16 offset:16736
    s_waitcnt lgkmcnt(8)
    v_mfma_f32_16x16x32_bf16 v[168:171], v[112:115], a[216:219], v[168:171]
    ds_read_b64_tr_b16 v[132:133], v16 offset:15488
    v_mfma_f32_16x16x32_bf16 v[172:175], v[112:115], v[72:75], v[172:175]
    ds_read_b64_tr_b16 v[134:135], v16 offset:16768
    s_waitcnt lgkmcnt(8)
    v_mfma_f32_16x16x32_bf16 v[136:139], v[116:119], a[220:223], v[136:139]
    v_mfma_f32_16x16x32_bf16 v[140:143], v[116:119], v[76:79], v[140:143]
    s_waitcnt lgkmcnt(6)
    v_mfma_f32_16x16x32_bf16 v[144:147], v[120:123], a[220:223], v[144:147]
    v_mfma_f32_16x16x32_bf16 v[148:151], v[120:123], v[76:79], v[148:151]
    v_add_u32 v16, s46, v15
    s_waitcnt vmcnt(10) lgkmcnt(0)
    s_barrier
    v_mfma_f32_16x16x32_bf16 v[152:155], v[124:127], a[220:223], v[152:155]
    ds_read_b64_tr_b16 v[96:97], v16 offset:0
    ds_read_b64_tr_b16 v[98:99], v16 offset:1280
    v_mfma_f32_16x16x32_bf16 v[156:159], v[124:127], v[76:79], v[156:159]
    ds_read_b64_tr_b16 v[100:101], v16 offset:32
    ds_read_b64_tr_b16 v[102:103], v16 offset:1312
    v_mfma_f32_16x16x32_bf16 v[160:163], v[128:131], a[220:223], v[160:163]
    ds_read_b64_tr_b16 v[104:105], v16 offset:64
    ds_read_b64_tr_b16 v[106:107], v16 offset:1344
    v_mfma_f32_16x16x32_bf16 v[164:167], v[128:131], v[76:79], v[164:167]
    ds_read_b64_tr_b16 v[108:109], v16 offset:96
    ds_read_b64_tr_b16 v[110:111], v16 offset:1376
    v_mfma_f32_16x16x32_bf16 v[168:171], v[132:135], a[220:223], v[168:171]
    ds_read_b64_tr_b16 v[112:113], v16 offset:128
    ds_read_b64_tr_b16 v[114:115], v16 offset:1408
    v_mfma_f32_16x16x32_bf16 v[172:175], v[132:135], v[76:79], v[172:175]
    s_waitcnt lgkmcnt(8)
    v_mfma_f32_16x16x32_bf16 v[136:139], v[96:99], a[224:227], v[136:139]
    ds_read_b64_tr_b16 v[116:117], v16 offset:5120
    s_add_u32 s46, s46, 20480
    s_cmp_eq_u32 s46, 81920
    v_mfma_f32_16x16x32_bf16 v[140:143], v[96:99], v[80:83], v[140:143]
    ds_read_b64_tr_b16 v[118:119], v16 offset:6400
    s_cselect_b32 s46, 0, s46
    s_mul_i32 s90, s32, 5120
    s_waitcnt lgkmcnt(8)
    v_mfma_f32_16x16x32_bf16 v[144:147], v[100:103], a[224:227], v[144:147]
    ds_read_b64_tr_b16 v[120:121], v16 offset:5152
    s_add_u32 m0, s90, s47
    s_mul_i32 s91, s44, 163840
    v_mfma_f32_16x16x32_bf16 v[148:151], v[100:103], v[80:83], v[148:151]
    ds_read_b64_tr_b16 v[122:123], v16 offset:6432
    s_add_u32 s91, s91, s43
    buffer_load_dwordx4 v10, s[20:23], s91 offen lds
    s_waitcnt lgkmcnt(8)
    v_mfma_f32_16x16x32_bf16 v[152:155], v[104:107], a[224:227], v[152:155]
    ds_read_b64_tr_b16 v[124:125], v16 offset:5184
    s_add_u32 s47, s47, 20480
    s_cmp_eq_u32 s47, 81920
    v_mfma_f32_16x16x32_bf16 v[156:159], v[104:107], v[80:83], v[156:159]
    ds_read_b64_tr_b16 v[126:127], v16 offset:6464
    s_cselect_b32 s47, 0, s47
    s_cmp_lg_u32 s51, 0
    s_waitcnt lgkmcnt(8)
    v_mfma_f32_16x16x32_bf16 v[160:163], v[108:111], a[224:227], v[160:163]
    ds_read_b64_tr_b16 v[128:129], v16 offset:5216
    s_cselect_b32 s90, 1, 0
    s_sub_u32 s51, s51, s90
    v_mfma_f32_16x16x32_bf16 v[164:167], v[108:111], v[80:83], v[164:167]
    ds_read_b64_tr_b16 v[130:131], v16 offset:6496
    s_add_u32 s44, s44, s90
    s_cmp_eq_u32 s44, 5
    s_waitcnt lgkmcnt(8)
    v_mfma_f32_16x16x32_bf16 v[168:171], v[112:115], a[224:227], v[168:171]
    ds_read_b64_tr_b16 v[132:133], v16 offset:5248
    s_cselect_b32 s44, 0, s44
    s_cselect_b32 s90, 160, 0
    v_mfma_f32_16x16x32_bf16 v[172:175], v[112:115], v[80:83], v[172:175]
    ds_read_b64_tr_b16 v[134:135], v16 offset:6528
    s_add_u32 s43, s43, s90
    s_cmp_eq_u32 s43, 1280
    s_waitcnt lgkmcnt(8)
    v_mfma_f32_16x16x32_bf16 v[136:139], v[116:119], a[228:231], v[136:139]
    ds_read_b64_tr_b16 v[96:97], v16 offset:10240
    s_cselect_b32 s43, 0, s43
    s_add_u32 m0, m0, 1024
    v_mfma_f32_16x16x32_bf16 v[140:143], v[116:119], v[84:87], v[140:143]
    ds_read_b64_tr_b16 v[98:99], v16 offset:11520
    buffer_load_dwordx4 v11, s[20:23], s91 offen lds
    s_add_u32 m0, m0, 1024
    s_waitcnt lgkmcnt(8)
    v_mfma_f32_16x16x32_bf16 v[144:147], v[120:123], a[228:231], v[144:147]
    ds_read_b64_tr_b16 v[100:101], v16 offset:10272
    v_mfma_f32_16x16x32_bf16 v[148:151], v[120:123], v[84:87], v[148:151]
    ds_read_b64_tr_b16 v[102:103], v16 offset:11552
    s_waitcnt lgkmcnt(8)
    v_mfma_f32_16x16x32_bf16 v[152:155], v[124:127], a[228:231], v[152:155]
    ds_read_b64_tr_b16 v[104:105], v16 offset:10304
    v_mfma_f32_16x16x32_bf16 v[156:159], v[124:127], v[84:87], v[156:159]
    ds_read_b64_tr_b16 v[106:107], v16 offset:11584
    s_waitcnt lgkmcnt(8)
    v_mfma_f32_16x16x32_bf16 v[160:163], v[128:131], a[228:231], v[160:163]
    ds_read_b64_tr_b16 v[108:109], v16 offset:10336
    buffer_load_dwordx4 v12, s[20:23], s91 offen lds
    s_add_u32 m0, m0, 1024
    v_mfma_f32_16x16x32_bf16 v[164:167], v[128:131], v[84:87], v[164:167]
    ds_read_b64_tr_b16 v[110:111], v16 offset:11616
    s_waitcnt lgkmcnt(8)
    v_mfma_f32_16x16x32_bf16 v[168:171], v[132:135], a[228:231], v[168:171]
    ds_read_b64_tr_b16 v[112:113], v16 offset:10368
    v_mfma_f32_16x16x32_bf16 v[172:175], v[132:135], v[84:87], v[172:175]
    ds_read_b64_tr_b16 v[114:115], v16 offset:11648
    s_waitcnt lgkmcnt(8)
    v_mfma_f32_16x16x32_bf16 v[136:139], v[96:99], a[232:235], v[136:139]
    ds_read_b64_tr_b16 v[116:117], v16 offset:15360
    v_mfma_f32_16x16x32_bf16 v[140:143], v[96:99], v[88:91], v[140:143]
    ds_read_b64_tr_b16 v[118:119], v16 offset:16640
    buffer_load_dwordx4 v13, s[20:23], s91 offen lds
    s_add_u32 m0, m0, 1024
    s_waitcnt lgkmcnt(8)
    v_mfma_f32_16x16x32_bf16 v[144:147], v[100:103], a[232:235], v[144:147]
    ds_read_b64_tr_b16 v[120:121], v16 offset:15392
    v_mfma_f32_16x16x32_bf16 v[148:151], v[100:103], v[88:91], v[148:151]
    ds_read_b64_tr_b16 v[122:123], v16 offset:16672
    s_waitcnt lgkmcnt(8)
    v_mfma_f32_16x16x32_bf16 v[152:155], v[104:107], a[232:235], v[152:155]
    ds_read_b64_tr_b16 v[124:125], v16 offset:15424
    v_mfma_f32_16x16x32_bf16 v[156:159], v[104:107], v[88:91], v[156:159]
    ds_read_b64_tr_b16 v[126:127], v16 offset:16704
    s_waitcnt lgkmcnt(8)
    v_mfma_f32_16x16x32_bf16 v[160:163], v[108:111], a[232:235], v[160:163]
    ds_read_b64_tr_b16 v[128:129], v16 offset:15456
    buffer_load_dwordx4 v14, s[20:23], s91 offen lds
    v_mfma_f32_16x16x32_bf16 v[164:167], v[108:111], v[88:91], v[164:167]
    ds_read_b64_tr_b16 v[130:131], v16 offset:16736
    s_waitcnt lgkmcnt(8)
    v_mfma_f32_16x16x32_bf16 v[168:171], v[112:115], a[232:235], v[168:171]
    ds_read_b64_tr_b16 v[132:133], v16 offset:15488
    v_mfma_f32_16x16x32_bf16 v[172:175], v[112:115], v[88:91], v[172:175]
    ds_read_b64_tr_b16 v[134:135], v16 offset:16768
    s_waitcnt lgkmcnt(8)
    v_mfma_f32_16x16x32_bf16 v[136:139], v[116:119], a[236:239], v[136:139]
    v_mfma_f32_16x16x32_bf16 v[140:143], v[116:119], v[92:95], v[140:143]
    s_waitcnt lgkmcnt(6)
    v_mfma_f32_16x16x32_bf16 v[144:147], v[120:123], a[236:239], v[144:147]
    v_mfma_f32_16x16x32_bf16 v[148:151], v[120:123], v[92:95], v[148:151]
    v_add_u32 v16, s46, v15
    s_waitcnt vmcnt(10) lgkmcnt(0)
    s_barrier
    v_mfma_f32_16x16x32_bf16 v[152:155], v[124:127], a[236:239], v[152:155]
    ds_read_b64_tr_b16 v[96:97], v16 offset:0
    ds_read_b64_tr_b16 v[98:99], v16 offset:1280
    v_mfma_f32_16x16x32_bf16 v[156:159], v[124:127], v[92:95], v[156:159]
    ds_read_b64_tr_b16 v[100:101], v16 offset:32
    ds_read_b64_tr_b16 v[102:103], v16 offset:1312
    v_mfma_f32_16x16x32_bf16 v[160:163], v[128:131], a[236:239], v[160:163]
    ds_read_b64_tr_b16 v[104:105], v16 offset:64
    ds_read_b64_tr_b16 v[106:107], v16 offset:1344
    v_mfma_f32_16x16x32_bf16 v[164:167], v[128:131], v[92:95], v[164:167]
    ds_read_b64_tr_b16 v[108:109], v16 offset:96
    ds_read_b64_tr_b16 v[110:111], v16 offset:1376
    v_mfma_f32_16x16x32_bf16 v[168:171], v[132:135], a[236:239], v[168:171]
    ds_read_b64_tr_b16 v[112:113], v16 offset:128
    ds_read_b64_tr_b16 v[114:115], v16 offset:1408
    v_mfma_f32_16x16x32_bf16 v[172:175], v[132:135], v[92:95], v[172:175]
    v_cvt_pk_bf16_f32 v176, v136, v137
    v_cvt_pk_bf16_f32 v177, v138, v139
    v_cvt_pk_bf16_f32 v178, v140, v141
    v_cvt_pk_bf16_f32 v179, v142, v143
    s_nop 0
    v_permlane16_swap_b32 v176, v178
    v_permlane16_swap_b32 v177, v179
    buffer_store_dwordx4 v[176:179], v19, s[28:31], s42 offen offset:0
    s_nop 1
    v_cvt_pk_bf16_f32 v176, v144, v145
    v_cvt_pk_bf16_f32 v177, v146, v147
    v_cvt_pk_bf16_f32 v178, v148, v149
    v_cvt_pk_bf16_f32 v179, v150, v151
    s_nop 0
    v_permlane16_swap_b32 v176, v178
    v_permlane16_swap_b32 v177, v179
    buffer_store_dwordx4 v[176:179], v19, s[28:31], s42 offen offset:32
    s_nop 1
    v_cvt_pk_bf16_f32 v176, v152, v153
    v_cvt_pk_bf16_f32 v177, v154, v155
    v_cvt_pk_bf16_f32 v178, v156, v157
    v_cvt_pk_bf16_f32 v179, v158, v159
    s_nop 0
    v_permlane16_swap_b32 v176, v178
    v_permlane16_swap_b32 v177, v179
    buffer_store_dwordx4 v[176:179], v19, s[28:31], s42 offen offset:64
    s_nop 1
    v_cvt_pk_bf16_f32 v176, v160, v161
    v_cvt_pk_bf16_f32 v177, v162, v163
    v_cvt_pk_bf16_f32 v178, v164, v165
    v_cvt_pk_bf16_f32 v179, v166, v167
    s_nop 0
    v_permlane16_swap_b32 v176, v178
    v_permlane16_swap_b32 v177, v179
    buffer_store_dwordx4 v[176:179], v19, s[28:31], s42 offen offset:96
    s_nop 1
    v_cvt_pk_bf16_f32 v176, v168, v169
    v_cvt_pk_bf16_f32 v177, v170, v171
    v_cvt_pk_bf16_f32 v178, v172, v173
    v_cvt_pk_bf16_f32 v179, v174, v175
    s_nop 0
    v_permlane16_swap_b32 v176, v178
    v_permlane16_swap_b32 v177, v179
    buffer_store_dwordx4 v[176:179], v19, s[28:31], s42 offen offset:128
    s_add_u32 s42, s42, 160
    s_cmp_eq_u32 s42, 1280
    s_cselect_b32 s42, 0, s42
    s_add_u32 s53, s53, 1
    s_cmp_lt_u32 s53, 8
    s_cbranch_scc1 L_pa_oblk
L_pa_end:
    s_waitcnt vmcnt(0)
    s_endpgm
L_slow:
    s_waitcnt vmcnt(0) lgkmcnt(0)
    s_barrier
    s_and_b32 s34, s2, 7
    s_lshr_b32 s35, s2, 3
    s_add_u32 s4, s88, 33554432
    s_addc_u32 s5, s89, 0
    s_and_b32 s5, s5, 0xffff
    s_cmp_lg_u32 s32, 0
    s_cbranch_scc1 L_slow_go
    v_mov_b32 v240, -1
    v_mov_b32 v241, -1
    v_mov_b32 v242, -1
    v_mov_b32 v243, -1
    v_mov_b32 v244, 0
    v_lshlrev_b32 v4, 4, v0
    v_lshlrev_b32 v5, 2, v0
    s_mul_i32 s91, s2, 2560
    s_and_b32 s92, s2, 7
    s_lshl_b32 s92, s92, 21
    s_add_u32 s92, s92, 8388608
    s_lshr_b32 s93, s2, 3
    s_lshl_b32 s40, s93, 7
    s_add_u32 s40, s40, s92
    s_add_u32 s40, s40, 458752
    s_lshr_b32 s41, s93, 4
    s_mul_i32 s41, s41, 114688
    s_add_u32 s92, s92, s41
    s_and_b32 s93, s93, 15
    s_mul_i32 s93, s93, 2560
    s_add_u32 s92, s92, s93
    buffer_store_dwordx4 v[240:243], v4, s[4:7], s91 offen sc1
    buffer_store_dwordx4 v[240:243], v4, s[4:7], s91 offen offset:1024 sc1
    buffer_store_dword v240, v5, s[4:7], s91 offen offset:2048 sc1
    buffer_store_dword v240, v5, s[4:7], s91 offen offset:2304 sc1
    buffer_store_dwordx4 v[240:243], v4, s[4:7], s92 offen sc1
    buffer_store_dwordx4 v[240:243], v4, s[4:7], s92 offen offset:1024 sc1
    buffer_store_dword v240, v5, s[4:7], s92 offen offset:2048 sc1
    buffer_store_dword v240, v5, s[4:7], s92 offen offset:2304 sc1
    s_mov_b64 exec, 0xffffffff
    buffer_store_dword v244, v5, s[4:7], s40 offen sc1
    s_lshl_b32 s40, s2, 7
    s_add_u32 s40, s40, 1933312
    buffer_store_dword v244, v5, s[4:7], s40 offen sc1
    s_mov_b64 exec, -1
    s_waitcnt vmcnt(0)
    v_mov_b32 v1, 68
    v_mov_b32 v4, 1
    s_mov_b64 exec, 1
    buffer_atomic_add v4, v1, s[8:11], 0 offen sc1
    s_mov_b64 exec, -1
L_slow_go:
    s_lshl_b32 s38, s34, 21
    s_add_u32 s38, s38, 8388608
    s_cmp_lt_u32 s35, 12
    s_cbranch_scc1 L_qkv_s
    s_cmp_lt_u32 s35, 18
    s_cbranch_scc1 L_v_s
    s_cmp_lt_u32 s35, 28
    s_cbranch_scc1 L_wo_s
    s_cmp_lt_u32 s35, 29
    s_cbranch_scc1 L_px_s
    s_branch L_pa_s
L_qkv_s:
    s_mov_b32 s12, s74
    s_and_b32 s13, s75, 0xffff
    s_mov_b32 s14, 7864320
    s_mov_b32 s15, 0x20000
    s_mov_b32 s16, s76
    s_and_b32 s17, s77, 0xffff
    s_mov_b32 s18, 7864320
    s_mov_b32 s19, 0x20000
    s_mov_b32 s40, s35
    s_mov_b32 s24, s70
    s_and_b32 s25, s71, 0xffff
    s_mov_b32 s26, 2621440
    s_mov_b32 s27, 0x20000
    v_and_b32 v1, 15, v0
    v_lshrrev_b32 v2, 4, v0
    v_lshrrev_b32 v3, 3, v0
    v_and_b32 v4, 7, v0
    s_lshl_b32 s90, s32, 3
    v_add_u32 v5, s90, v3
    s_and_b32 s91, s32, 1
    s_lshl_b32 s91, s91, 2
    v_and_b32 v6, 2, v3
    v_or_b32 v6, s91, v6
    v_xor_b32 v6, v6, v4
    v_lshlrev_b32 v6, 4, v6
    v_mul_u32_u24 v7, 12288, v5
    s_mul_i32 s92, s34, 1536
    s_lshl_b32 s93, s40, 7
    s_add_u32 s92, s92, s93
    v_add3_u32 v124, v6, v7, s92
    v_lshrrev_b32 v6, 1, v3
    v_or_b32 v6, s91, v6
    v_xor_b32 v6, v6, v4
    v_lshlrev_b32 v6, 4, v6
    v_mul_u32_u24 v7, 1280, v5
    v_add_u32 v10, v6, v7
    s_lshl_b32 s90, s32, 10
    s_add_u32 m0, s90, 81920
    s_mov_b32 s91, 0
    buffer_load_dwordx4 v124, s[12:15], s91 offen nt lds
    s_add_u32 m0, m0, 4096
    s_add_u32 s91, s91, 393216
    buffer_load_dwordx4 v124, s[12:15], s91 offen nt lds
    s_add_u32 m0, m0, 4096
    s_add_u32 s91, s91, 393216
    buffer_load_dwordx4 v124, s[12:15], s91 offen nt lds
    s_add_u32 m0, m0, 4096
    s_add_u32 s91, s91, 393216
    buffer_load_dwordx4 v124, s[12:15], s91 offen nt lds
    s_add_u32 m0, m0, 4096
    s_add_u32 s91, s91, 393216
    buffer_load_dwordx4 v124, s[12:15], s91 offen nt lds
    s_add_u32 m0, m0, 4096
    s_add_u32 s91, s91, 393216
    buffer_load_dwordx4 v124, s[12:15], s91 offen nt lds
    s_add_u32 m0, m0, 4096
    s_add_u32 s91, s91, 393216
    buffer_load_dwordx4 v124, s[12:15], s91 offen nt lds
    s_add_u32 m0, m0, 4096
    s_add_u32 s91, s91, 393216
    buffer_load_dwordx4 v124, s[12:15], s91 offen nt lds
    s_add_u32 m0, m0, 4096
    s_add_u32 s91, s91, 393216
    buffer_load_dwordx4 v124, s[12:15], s91 offen nt lds
    s_add_u32 m0, m0, 4096
    s_add_u32 s91, s91, 393216
    buffer_load_dwordx4 v124, s[12:15], s91 offen nt lds
    s_lshl_b32 s90, s32, 10
    s_add_u32 m0, s90, 40960
    s_mov_b32 s91, 0
    buffer_load_dwordx4 v124, s[16:19], s91 offen nt lds
    s_add_u32 m0, m0, 4096
    s_add_u32 s91, s91, 393216
    buffer_load_dwordx4 v124, s[16:19], s91 offen nt lds
    s_add_u32 m0, m0, 4096
    s_add_u32 s91, s91, 393216
    buffer_load_dwordx4 v124, s[16:19], s91 offen nt lds
    s_add_u32 m0, m0, 4096
    s_add_u32 s91, s91, 393216
    buffer_load_dwordx4 v124, s[16:19], s91 offen nt lds
    s_add_u32 m0, m0, 4096
    s_add_u32 s91, s91, 393216
    buffer_load_dwordx4 v124, s[16:19], s91 offen nt lds
    s_add_u32 m0, m0, 4096
    s_add_u32 s91, s91, 393216
    buffer_load_dwordx4 v124, s[16:19], s91 offen nt lds
    s_add_u32 m0, m0, 4096
    s_add_u32 s91, s91, 393216
    buffer_load_dwordx4 v124, s[16:19], s91 offen nt lds
    s_add_u32 m0, m0, 4096
    s_add_u32 s91, s91, 393216
    buffer_load_dwordx4 v124, s[16:19], s91 offen nt lds
    s_add_u32 m0, m0, 4096
    s_add_u32 s91, s91, 393216
    buffer_load_dwordx4 v124, s[16:19], s91 offen nt lds
    s_add_u32 m0, m0, 4096
    s_add_u32 s91, s91, 393216
    buffer_load_dwordx4 v124, s[16:19], s91 offen nt lds
    s_lshl_b32 s90, s32, 10
    s_add_u32 m0, s90, 122880
    s_mov_b32 s91, 3932160
    buffer_load_dwordx4 v124, s[12:15], s91 offen nt lds
    s_add_u32 m0, m0, 4096
    s_add_u32 s91, s91, 393216
    buffer_load_dwordx4 v124, s[12:15], s91 offen nt lds
    s_add_u32 m0, m0, 4096
    s_add_u32 s91, s91, 393216
    buffer_load_dwordx4 v124, s[12:15], s91 offen nt lds
    s_add_u32 m0, m0, 4096
    s_add_u32 s91, s91, 393216
    buffer_load_dwordx4 v124, s[12:15], s91 offen nt lds
    s_add_u32 m0, m0, 4096
    s_add_u32 s91, s91, 393216
    buffer_load_dwordx4 v124, s[12:15], s91 offen nt lds
    s_add_u32 m0, m0, 4096
    s_add_u32 s91, s91, 393216
    buffer_load_dwordx4 v124, s[12:15], s91 offen nt lds
    s_add_u32 m0, m0, 4096
    s_add_u32 s91, s91, 393216
    buffer_load_dwordx4 v124, s[12:15], s91 offen nt lds
    s_add_u32 m0, m0, 4096
    s_add_u32 s91, s91, 393216
    buffer_load_dwordx4 v124, s[12:15], s91 offen nt lds
    s_add_u32 m0, m0, 4096
    s_add_u32 s91, s91, 393216
    buffer_load_dwordx4 v124, s[12:15], s91 offen nt lds
    s_add_u32 m0, m0, 4096
    s_add_u32 s91, s91, 393216
    buffer_load_dwordx4 v124, s[12:15], s91 offen nt lds
    s_mov_b32 s46, 0
    s_lshl_b32 s90, s32, 10
    s_add_u32 m0, s90, 0
    s_nop 0
    buffer_load_dwordx4 v10, s[24:27], s46 offen offset:0 lds
    s_add_u32 m0, m0, 3968
    s_nop 0
    buffer_load_dwordx4 v10, s[24:27], s46 offen offset:128 lds
    s_add_u32 m0, m0, 3968
    s_nop 0
    buffer_load_dwordx4 v10, s[24:27], s46 offen offset:256 lds
    s_add_u32 m0, m0, 3968
    s_nop 0
    buffer_load_dwordx4 v10, s[24:27], s46 offen offset:384 lds
    s_add_u32 m0, m0, 3968
    s_nop 0
    buffer_load_dwordx4 v10, s[24:27], s46 offen offset:512 lds
    s_add_u32 m0, m0, 3968
    s_nop 0
    buffer_load_dwordx4 v10, s[24:27], s46 offen offset:640 lds
    s_add_u32 m0, m0, 3968
    s_nop 0
    buffer_load_dwordx4 v10, s[24:27], s46 offen offset:768 lds
    s_add_u32 m0, m0, 3968
    s_nop 0
    buffer_load_dwordx4 v10, s[24:27], s46 offen offset:896 lds
    s_add_u32 m0, m0, 3968
    s_nop 0
    buffer_load_dwordx4 v10, s[24:27], s46 offen offset:1024 lds
    s_add_u32 m0, m0, 3968
    s_nop 0
    buffer_load_dwordx4 v10, s[24:27], s46 offen offset:1152 lds
    s_mul_i32 s60, s40, 86
    s_lshr_b32 s60, s60, 8
    s_mul_i32 s61, s60, 3
    s_sub_u32 s61, s40, s61
    s_add_u32 s90, s40, 1
    s_mul_i32 s62, s90, 86
    s_lshr_b32 s62, s62, 8
    s_mul_i32 s63, s62, 3
    s_sub_u32 s63, s90, s63
    v_lshrrev_b32 v3, 1, v2
    v_and_b32 v5, 1, v2
    s_lshl_b32 s90, s32, 9
    v_lshlrev_b32 v6, 4, v1
    v_lshl_add_u32 v6, v3, 8, v6
    v_add_u32 v6, s90, v6
    s_mul_i32 s90, s60, 12288
    s_lshl_b32 s91, s61, 11
    s_add_u32 s90, s90, s91
    v_mul_u32_u24 v7, 6144, v5
    v_add3_u32 v19, v6, v7, s90
    v_mov_b32 v22, -1
    s_mov_b32 s56, 49152
    v_lshl_add_u32 v137, v5, 11, v6
    v_add_u32 v137, 135168, v137
    s_mul_i32 s90, s40, 1280
    s_add_u32 s90, s90, 10240
    v_lshlrev_b32 v6, 1, v5
    v_or_b32 v7, v6, v3
    v_lshl_add_u32 v7, v7, 4, v1
    v_lshlrev_b32 v7, 2, v7
    v_add_u32 v7, 1024, v7
    v_or_b32 v6, v6, v1
    v_lshl_add_u32 v6, v3, 4, v6
    v_lshlrev_b32 v6, 4, v6
    s_sub_u32 s91, s32, 1
    s_lshl_b32 s91, s91, 9
    v_add_u32 v6, s91, v6
    s_cmp_eq_u32 s32, 0
    s_cselect_b64 vcc, -1, 0
    v_cndmask_b32 v6, v6, v7, vcc
    v_add_u32 v135, s90, v6
    s_lshl_b32 s91, s32, 8
    s_add_u32 s91, s91, s90
    v_lshl_add_u32 v150, v0, 2, s91
    v_and_b32 v4, 2, v1
    v_cmp_eq_u32 vcc, 0, v4
    v_mov_b32 v9, 2146435072
    s_nop 0
    v_cndmask_b32 v135, v9, v135, vcc
    s_lshl_b32 s90, s40, 10
    v_lshrrev_b32 v3, 2, v1
    v_lshlrev_b32 v3, 1, v3
    v_and_b32 v6, 1, v1
    v_or_b32 v3, v3, v6
    v_lshl_add_u32 v3, v2, 3, v3
    v_lshl_add_u32 v136, v3, 4, s90
    v_cmp_ne_u32 vcc, 0, v4
    v_mov_b32 v9, 2146435072
    s_nop 0
    v_cndmask_b32 v136, v9, v136, vcc
    v_and_b32 v6, 9, v1
    v_lshl_or_b32 v6, v4, 1, v6
    v_and_b32 v7, 4, v1
    v_lshrrev_b32 v7, 1, v7
    v_or_b32 v6, v6, v7
    v_lshlrev_b32 v6, 4, v6
    v_lshl_add_u32 v6, v2, 8, v6
    s_cmp_eq_u32 s32, 2
    s_cselect_b32 s90, 2048, 0
    s_add_u32 s90, s90, 135168
    v_add_u32 v138, s90, v6
    s_lshl_b32 s90, s60, 7
    s_lshl_b32 s91, s61, 2
    s_add_u32 s91, s91, s90
    s_add_u32 s91, s91, 459264
    s_cmp_eq_u32 s32, 3
    s_cselect_b32 s91, s91, 2146435072
    s_cselect_b32 s55, -1, 0
    v_mov_b32 v139, s91
    v_cmp_eq_u32 vcc, 0, v0
    v_mov_b32 v9, 2146435072
    s_nop 0
    v_cndmask_b32 v139, v9, v139, vcc
    v_add_u32 v21, 3072, v139
    s_mul_i32 s90, s35, 32768
    s_lshl_b32 s91, s32, 11
    s_add_u32 s90, s90, s91
    s_lshl_b32 s92, s35, 10
    s_lshl_b32 s91, s32, 8
    s_add_u32 s92, s92, s91
    s_cmp_lt_u32 s35, 10
    s_cselect_b32 s90, s90, 2146435072
    s_cselect_b32 s92, s92, 2146435072
    s_lshl_b32 s91, s34, 8
    v_lshlrev_b32 v3, 4, v0
    v_xor_b32 v3, s91, v3
    v_add_u32 v142, s90, v3
    v_xor_b32 v3, 1024, v3
    v_add_u32 v143, s90, v3
    s_min_u32 s90, s35, 9
    s_lshl_b32 s90, s90, 7
    s_add_u32 s90, s90, 460800
    s_add_u32 s90, s90, s38
    v_and_b32 v3, 3, v0
    v_lshl_add_u32 v146, v3, 2, s90
    v_lshl_add_u32 v149, v0, 2, s92
    v_lshl_add_u32 v148, v1, 4, s92
    v_cmp_eq_u32 vcc, 0, v2
    v_mov_b32 v9, 2146435072
    s_nop 0
    v_cndmask_b32 v148, v9, v148, vcc
    v_and_b32 v7, 1, v1
    v_cmp_ne_u32 vcc, 0, v7
    v_mov_b32 v5, 0x3f80
    v_mov_b32 v6, 0x3f800000
    v_cndmask_b32 v5, v5, v6, vcc
    v_bfe_u32 v6, v1, 1, 1
    v_cmp_eq_u32 vcc, 0, v6
    s_nop 1
    v_cndmask_b32 v198, 0, v5, vcc
    v_mov_b32 v196, 0
    v_mov_b32 v200, 0
    v_cmp_eq_u32 vcc, 1, v6
    s_nop 1
    v_cndmask_b32 v199, 0, v5, vcc
    v_mov_b32 v197, 0
    v_mov_b32 v201, 0
    v_lshrrev_b32 v3, 2, v1
    v_and_b32 v4, 3, v1
    v_and_b32 v5, 1, v2
    v_lshl_add_u32 v6, v2, 3, v3
    v_lshlrev_b32 v6, 7, v6
    v_and_b32 v7, 2, v3
    v_lshl_or_b32 v7, v5, 2, v7
    v_lshrrev_b32 v8, 1, v4
    s_lshl_b32 s90, s32, 1
    v_or_b32 v8, s90, v8
    v_xor_b32 v7, v7, v8
    v_lshl_add_u32 v6, v7, 4, v6
    v_and_b32 v7, 1, v4
    v_lshl_add_u32 v6, v7, 3, v6
    v_add_u32 v125, 81920, v6
    v_add_u32 v126, 40960, v6
    v_add_u32 v127, 122880, v6
    s_lshl_b32 s90, s32, 9
    s_add_u32 s90, s90, 133120
    v_xor_b32 v6, 0, v5
    v_lshl_add_u32 v6, v6, 2, v3
    v_lshl_add_u32 v6, v2, 3, v6
    v_lshlrev_b32 v6, 5, v6
    v_lshl_or_b32 v7, v5, 1, 0
    v_xor_b32 v7, v7, v4
    v_lshl_add_u32 v6, v7, 3, v6
    v_add_u32 v24, 133120, v6
    v_xor_b32 v6, 1, v5
    v_lshl_add_u32 v6, v6, 2, v3
    v_lshl_add_u32 v6, v2, 3, v6
    v_lshlrev_b32 v6, 5, v6
    v_lshl_or_b32 v7, v5, 1, 1
    v_xor_b32 v7, v7, v4
    v_lshl_add_u32 v6, v7, 3, v6
    v_add_u32 v134, 133120, v6
    v_lshrrev_b32 v6, 3, v1
    v_lshlrev_b32 v6, 2, v6
    v_xor_b32 v6, v6, v1
    v_lshlrev_b32 v6, 5, v6
    v_xor_b32 v7, v2, v3
    v_lshl_add_u32 v6, v7, 3, v6
    v_add_u32 v23, s90, v6
    v_and_b32 v7, 2, v1
    v_cmp_ne_u32 vcc, 0, v7
    v_mov_b32 v6, 0x4444
    v_mov_b32 v8, 0xeeee
    v_cndmask_b32 v17, v6, v8, vcc
    v_lshlrev_b32 v6, 4, v0
    v_add_u32 v16, 122880, v6
    s_mul_i32 s90, s32, 2560
    v_lshl_add_u32 v13, v0, 4, s90
    v_lshl_add_u32 v14, v0, 2, s90
    s_add_u32 s48, s90, 122880
    v_mul_u32_u24 v6, 40, v0
    v_add_u32 v15, s48, v6
    v_mul_u32_u24 v6, 164, v0
    v_min_u32 v6, 10236, v6
    v_add_u32 v25, 122880, v6
    v_lshrrev_b32 v6, 3, v1
    v_lshlrev_b32 v6, 10, v6
    v_and_b32 v7, 7, v1
    v_lshl_add_u32 v6, v7, 7, v6
    v_lshrrev_b32 v7, 1, v1
    v_xor_b32 v7, v7, v2
    v_lshl_add_u32 v11, v7, 4, v6
    v_xor_b32 v12, 64, v11
    s_waitcnt vmcnt(30)
    s_barrier
    ds_read_b64_tr_b16 a[0:1], v125 offset:0
    ds_read_b64_tr_b16 a[2:3], v125 offset:512
    ds_read_b64_tr_b16 a[4:5], v125 offset:4096
    ds_read_b64_tr_b16 a[6:7], v125 offset:4608
    ds_read_b64_tr_b16 a[8:9], v125 offset:8192
    ds_read_b64_tr_b16 a[10:11], v125 offset:8704
    ds_read_b64_tr_b16 a[12:13], v125 offset:12288
    ds_read_b64_tr_b16 a[14:15], v125 offset:12800
    ds_read_b64_tr_b16 a[16:17], v125 offset:16384
    ds_read_b64_tr_b16 a[18:19], v125 offset:16896
    ds_read_b64_tr_b16 a[20:21], v125 offset:20480
    ds_read_b64_tr_b16 a[22:23], v125 offset:20992
    ds_read_b64_tr_b16 a[24:25], v125 offset:24576
    ds_read_b64_tr_b16 a[26:27], v125 offset:25088
    ds_read_b64_tr_b16 a[28:29], v125 offset:28672
    ds_read_b64_tr_b16 a[30:31], v125 offset:29184
    ds_read_b64_tr_b16 a[32:33], v125 offset:32768
    ds_read_b64_tr_b16 a[34:35], v125 offset:33280
    ds_read_b64_tr_b16 a[36:37], v125 offset:36864
    ds_read_b64_tr_b16 a[38:39], v125 offset:37376
    s_waitcnt lgkmcnt(0)
    s_barrier
    s_lshl_b32 s90, s32, 10
    s_add_u32 m0, s90, 81920
    s_mov_b32 s91, 3932160
    buffer_load_dwordx4 v124, s[16:19], s91 offen nt lds
    s_add_u32 m0, m0, 4096
    s_add_u32 s91, s91, 393216
    buffer_load_dwordx4 v124, s[16:19], s91 offen nt lds
    s_add_u32 m0, m0, 4096
    s_add_u32 s91, s91, 393216
    buffer_load_dwordx4 v124, s[16:19], s91 offen nt lds
    s_add_u32 m0, m0, 4096
    s_add_u32 s91, s91, 393216
    buffer_load_dwordx4 v124, s[16:19], s91 offen nt lds
    s_add_u32 m0, m0, 4096
    s_add_u32 s91, s91, 393216
    buffer_load_dwordx4 v124, s[16:19], s91 offen nt lds
    s_add_u32 m0, m0, 4096
    s_add_u32 s91, s91, 393216
    buffer_load_dwordx4 v124, s[16:19], s91 offen nt lds
    s_add_u32 m0, m0, 4096
    s_add_u32 s91, s91, 393216
    buffer_load_dwordx4 v124, s[16:19], s91 offen nt lds
    s_add_u32 m0, m0, 4096
    s_add_u32 s91, s91, 393216
    buffer_load_dwordx4 v124, s[16:19], s91 offen nt lds
    s_add_u32 m0, m0, 4096
    s_add_u32 s91, s91, 393216
    buffer_load_dwordx4 v124, s[16:19], s91 offen nt lds
    s_add_u32 m0, m0, 4096
    s_add_u32 s91, s91, 393216
    buffer_load_dwordx4 v124, s[16:19], s91 offen nt lds
    s_waitcnt vmcnt(30)
    s_barrier
    ds_read_b64_tr_b16 a[80:81], v126 offset:0
    ds_read_b64_tr_b16 a[82:83], v126 offset:512
    ds_read_b64_tr_b16 a[84:85], v126 offset:4096
    ds_read_b64_tr_b16 a[86:87], v126 offset:4608
    ds_read_b64_tr_b16 a[88:89], v126 offset:8192
    ds_read_b64_tr_b16 a[90:91], v126 offset:8704
    ds_read_b64_tr_b16 a[92:93], v126 offset:12288
    ds_read_b64_tr_b16 a[94:95], v126 offset:12800
    ds_read_b64_tr_b16 a[96:97], v126 offset:16384
    ds_read_b64_tr_b16 a[98:99], v126 offset:16896
    ds_read_b64_tr_b16 a[100:101], v126 offset:20480
    ds_read_b64_tr_b16 a[102:103], v126 offset:20992
    ds_read_b64_tr_b16 a[104:105], v126 offset:24576
    ds_read_b64_tr_b16 a[106:107], v126 offset:25088
    ds_read_b64_tr_b16 a[108:109], v126 offset:28672
    ds_read_b64_tr_b16 a[110:111], v126 offset:29184
    ds_read_b64_tr_b16 a[112:113], v126 offset:32768
    ds_read_b64_tr_b16 a[114:115], v126 offset:33280
    ds_read_b64_tr_b16 a[116:117], v126 offset:36864
    ds_read_b64_tr_b16 a[118:119], v126 offset:37376
    s_waitcnt lgkmcnt(0)
    s_barrier
    s_mov_b32 s46, 40960
    s_lshl_b32 s90, s32, 10
    s_add_u32 m0, s90, 40960
    s_nop 0
    buffer_load_dwordx4 v10, s[24:27], s46 offen offset:0 lds
    s_add_u32 m0, m0, 3968
    s_nop 0
    buffer_load_dwordx4 v10, s[24:27], s46 offen offset:128 lds
    s_add_u32 m0, m0, 3968
    s_nop 0
    buffer_load_dwordx4 v10, s[24:27], s46 offen offset:256 lds
    s_add_u32 m0, m0, 3968
    s_nop 0
    buffer_load_dwordx4 v10, s[24:27], s46 offen offset:384 lds
    s_add_u32 m0, m0, 3968
    s_nop 0
    buffer_load_dwordx4 v10, s[24:27], s46 offen offset:512 lds
    s_add_u32 m0, m0, 3968
    s_nop 0
    buffer_load_dwordx4 v10, s[24:27], s46 offen offset:640 lds
    s_add_u32 m0, m0, 3968
    s_nop 0
    buffer_load_dwordx4 v10, s[24:27], s46 offen offset:768 lds
    s_add_u32 m0, m0, 3968
    s_nop 0
    buffer_load_dwordx4 v10, s[24:27], s46 offen offset:896 lds
    s_add_u32 m0, m0, 3968
    s_nop 0
    buffer_load_dwordx4 v10, s[24:27], s46 offen offset:1024 lds
    s_add_u32 m0, m0, 3968
    s_nop 0
    buffer_load_dwordx4 v10, s[24:27], s46 offen offset:1152 lds
    s_waitcnt vmcnt(30)
    s_barrier
    ds_read_b64_tr_b16 a[40:41], v127 offset:0
    ds_read_b64_tr_b16 a[42:43], v127 offset:512
    ds_read_b64_tr_b16 a[44:45], v127 offset:4096
    ds_read_b64_tr_b16 a[46:47], v127 offset:4608
    ds_read_b64_tr_b16 a[48:49], v127 offset:8192
    ds_read_b64_tr_b16 a[50:51], v127 offset:8704
    ds_read_b64_tr_b16 a[52:53], v127 offset:12288
    ds_read_b64_tr_b16 a[54:55], v127 offset:12800
    ds_read_b64_tr_b16 a[56:57], v127 offset:16384
    ds_read_b64_tr_b16 a[58:59], v127 offset:16896
    ds_read_b64_tr_b16 a[60:61], v127 offset:20480
    ds_read_b64_tr_b16 a[62:63], v127 offset:20992
    ds_read_b64_tr_b16 a[64:65], v127 offset:24576
    ds_read_b64_tr_b16 a[66:67], v127 offset:25088
    ds_read_b64_tr_b16 a[68:69], v127 offset:28672
    ds_read_b64_tr_b16 a[70:71], v127 offset:29184
    ds_read_b64_tr_b16 a[72:73], v127 offset:32768
    ds_read_b64_tr_b16 a[74:75], v127 offset:33280
    ds_read_b64_tr_b16 a[76:77], v127 offset:36864
    ds_read_b64_tr_b16 a[78:79], v127 offset:37376
    s_waitcnt lgkmcnt(0)
    s_waitcnt vmcnt(10)
    s_barrier
    ds_read_b64_tr_b16 a[120:121], v125 offset:0
    ds_read_b64_tr_b16 a[122:123], v125 offset:512
    ds_read_b64_tr_b16 a[124:125], v125 offset:4096
    ds_read_b64_tr_b16 a[126:127], v125 offset:4608
    ds_read_b64_tr_b16 a[128:129], v125 offset:8192
    ds_read_b64_tr_b16 a[130:131], v125 offset:8704
    ds_read_b64_tr_b16 a[132:133], v125 offset:12288
    ds_read_b64_tr_b16 a[134:135], v125 offset:12800
    ds_read_b64_tr_b16 a[136:137], v125 offset:16384
    ds_read_b64_tr_b16 a[138:139], v125 offset:16896
    ds_read_b64_tr_b16 a[140:141], v125 offset:20480
    ds_read_b64_tr_b16 a[142:143], v125 offset:20992
    ds_read_b64_tr_b16 a[144:145], v125 offset:24576
    ds_read_b64_tr_b16 a[146:147], v125 offset:25088
    ds_read_b64_tr_b16 a[148:149], v125 offset:28672
    ds_read_b64_tr_b16 a[150:151], v125 offset:29184
    ds_read_b64_tr_b16 a[152:153], v125 offset:32768
    ds_read_b64_tr_b16 a[154:155], v125 offset:33280
    ds_read_b64_tr_b16 a[156:157], v125 offset:36864
    ds_read_b64_tr_b16 a[158:159], v125 offset:37376
    s_waitcnt lgkmcnt(0)
    s_mov_b32 s49, 40960
    s_mov_b32 s47, 40960
    s_mov_b32 s37, -1
    s_add_u32 s44, s38, 475136
    s_add_u32 s45, s44, s56
    s_mov_b32 s46, 40960
    v_add_u32 v140, 0, v137
    ds_read_b128 v[84:87], v11 offset:0
    ds_read_b128 v[88:91], v11 offset:2048
    ds_read_b128 v[92:95], v12 offset:0
    ds_read_b128 v[96:99], v12 offset:2048
    s_waitcnt lgkmcnt(2)
    v_mfma_f32_16x16x32_bf16 v[108:111], a[0:3], v[84:87], 0
    ds_read_b128 v[100:103], v11 offset:4096
    v_mfma_f32_16x16x32_bf16 v[112:115], a[0:3], v[88:91], 0
    ds_read_b128 v[104:107], v11 offset:6144
    v_mfma_f32_16x16x32_bf16 v[116:119], a[80:83], v[84:87], 0
    v_mfma_f32_16x16x32_bf16 v[120:123], a[80:83], v[88:91], 0
    s_waitcnt lgkmcnt(2)
    v_mfma_f32_16x16x32_bf16 v[108:111], a[4:7], v[92:95], v[108:111]
    ds_read_b128 v[84:87], v12 offset:4096
    v_mfma_f32_16x16x32_bf16 v[112:115], a[4:7], v[96:99], v[112:115]
    ds_read_b128 v[88:91], v12 offset:6144
    v_mfma_f32_16x16x32_bf16 v[116:119], a[84:87], v[92:95], v[116:119]
    v_mfma_f32_16x16x32_bf16 v[120:123], a[84:87], v[96:99], v[120:123]
    s_waitcnt lgkmcnt(2)
    v_mfma_f32_16x16x32_bf16 v[108:111], a[8:11], v[100:103], v[108:111]
    ds_read_b128 v[92:95], v11 offset:8192
    v_mfma_f32_16x16x32_bf16 v[112:115], a[8:11], v[104:107], v[112:115]
    ds_read_b128 v[96:99], v11 offset:10240
    v_mfma_f32_16x16x32_bf16 v[116:119], a[88:91], v[100:103], v[116:119]
    v_mfma_f32_16x16x32_bf16 v[120:123], a[88:91], v[104:107], v[120:123]
    s_waitcnt lgkmcnt(2)
    v_mfma_f32_16x16x32_bf16 v[108:111], a[12:15], v[84:87], v[108:111]
    ds_read_b128 v[100:103], v12 offset:8192
    v_mfma_f32_16x16x32_bf16 v[112:115], a[12:15], v[88:91], v[112:115]
    ds_read_b128 v[104:107], v12 offset:10240
    v_mfma_f32_16x16x32_bf16 v[116:119], a[92:95], v[84:87], v[116:119]
    v_mfma_f32_16x16x32_bf16 v[120:123], a[92:95], v[88:91], v[120:123]
    s_waitcnt lgkmcnt(2)
    v_mfma_f32_16x16x32_bf16 v[108:111], a[16:19], v[92:95], v[108:111]
    ds_read_b128 v[84:87], v11 offset:12288
    v_mfma_f32_16x16x32_bf16 v[112:115], a[16:19], v[96:99], v[112:115]
    ds_read_b128 v[88:91], v11 offset:14336
    v_mfma_f32_16x16x32_bf16 v[116:119], a[96:99], v[92:95], v[116:119]
    v_mfma_f32_16x16x32_bf16 v[120:123], a[96:99], v[96:99], v[120:123]
    s_waitcnt lgkmcnt(2)
    v_mfma_f32_16x16x32_bf16 v[108:111], a[20:23], v[100:103], v[108:111]
    ds_read_b128 v[92:95], v12 offset:12288
    v_mfma_f32_16x16x32_bf16 v[112:115], a[20:23], v[104:107], v[112:115]
    ds_read_b128 v[96:99], v12 offset:14336
    v_mfma_f32_16x16x32_bf16 v[116:119], a[100:103], v[100:103], v[116:119]
    v_mfma_f32_16x16x32_bf16 v[120:123], a[100:103], v[104:107], v[120:123]
    s_waitcnt lgkmcnt(2)
    v_mfma_f32_16x16x32_bf16 v[108:111], a[24:27], v[84:87], v[108:111]
    ds_read_b128 v[100:103], v11 offset:16384
    v_mfma_f32_16x16x32_bf16 v[112:115], a[24:27], v[88:91], v[112:115]
    ds_read_b128 v[104:107], v11 offset:18432
    v_mfma_f32_16x16x32_bf16 v[116:119], a[104:107], v[84:87], v[116:119]
    v_mfma_f32_16x16x32_bf16 v[120:123], a[104:107], v[88:91], v[120:123]
    s_waitcnt lgkmcnt(2)
    v_mfma_f32_16x16x32_bf16 v[108:111], a[28:31], v[92:95], v[108:111]
    ds_read_b128 v[84:87], v12 offset:16384
    v_mfma_f32_16x16x32_bf16 v[112:115], a[28:31], v[96:99], v[112:115]
    ds_read_b128 v[88:91], v12 offset:18432
    v_mfma_f32_16x16x32_bf16 v[116:119], a[108:111], v[92:95], v[116:119]
    v_mfma_f32_16x16x32_bf16 v[120:123], a[108:111], v[96:99], v[120:123]
    s_waitcnt lgkmcnt(2)
    v_mfma_f32_16x16x32_bf16 v[108:111], a[32:35], v[100:103], v[108:111]
    ds_read_b128 v[92:95], v11 offset:20480
    v_mfma_f32_16x16x32_bf16 v[112:115], a[32:35], v[104:107], v[112:115]
    ds_read_b128 v[96:99], v11 offset:22528
    v_mfma_f32_16x16x32_bf16 v[116:119], a[112:115], v[100:103], v[116:119]
    v_mfma_f32_16x16x32_bf16 v[120:123], a[112:115], v[104:107], v[120:123]
    s_waitcnt lgkmcnt(2)
    v_mfma_f32_16x16x32_bf16 v[108:111], a[36:39], v[84:87], v[108:111]
    ds_read_b128 v[100:103], v12 offset:20480
    v_mfma_f32_16x16x32_bf16 v[112:115], a[36:39], v[88:91], v[112:115]
    ds_read_b128 v[104:107], v12 offset:22528
    v_mfma_f32_16x16x32_bf16 v[116:119], a[116:119], v[84:87], v[116:119]
    v_mfma_f32_16x16x32_bf16 v[120:123], a[116:119], v[88:91], v[120:123]
    s_waitcnt lgkmcnt(2)
    v_mfma_f32_16x16x32_bf16 v[108:111], a[40:43], v[92:95], v[108:111]
    ds_read_b128 v[84:87], v11 offset:24576
    v_mfma_f32_16x16x32_bf16 v[112:115], a[40:43], v[96:99], v[112:115]
    ds_read_b128 v[88:91], v11 offset:26624
    v_mfma_f32_16x16x32_bf16 v[116:119], a[120:123], v[92:95], v[116:119]
    v_mfma_f32_16x16x32_bf16 v[120:123], a[120:123], v[96:99], v[120:123]
    s_waitcnt lgkmcnt(2)
    v_mfma_f32_16x16x32_bf16 v[108:111], a[44:47], v[100:103], v[108:111]
    ds_read_b128 v[92:95], v12 offset:24576
    v_mfma_f32_16x16x32_bf16 v[112:115], a[44:47], v[104:107], v[112:115]
    ds_read_b128 v[96:99], v12 offset:26624
    v_mfma_f32_16x16x32_bf16 v[116:119], a[124:127], v[100:103], v[116:119]
    v_mfma_f32_16x16x32_bf16 v[120:123], a[124:127], v[104:107], v[120:123]
    s_waitcnt lgkmcnt(2)
    v_mfma_f32_16x16x32_bf16 v[108:111], a[48:51], v[84:87], v[108:111]
    ds_read_b128 v[100:103], v11 offset:28672
    v_mfma_f32_16x16x32_bf16 v[112:115], a[48:51], v[88:91], v[112:115]
    ds_read_b128 v[104:107], v11 offset:30720
    v_mfma_f32_16x16x32_bf16 v[116:119], a[128:131], v[84:87], v[116:119]
    v_mfma_f32_16x16x32_bf16 v[120:123], a[128:131], v[88:91], v[120:123]
    s_waitcnt lgkmcnt(2)
    v_mfma_f32_16x16x32_bf16 v[108:111], a[52:55], v[92:95], v[108:111]
    ds_read_b128 v[84:87], v12 offset:28672
    v_mfma_f32_16x16x32_bf16 v[112:115], a[52:55], v[96:99], v[112:115]
    ds_read_b128 v[88:91], v12 offset:30720
    v_mfma_f32_16x16x32_bf16 v[116:119], a[132:135], v[92:95], v[116:119]
    v_mfma_f32_16x16x32_bf16 v[120:123], a[132:135], v[96:99], v[120:123]
    s_waitcnt lgkmcnt(2)
    v_mfma_f32_16x16x32_bf16 v[108:111], a[56:59], v[100:103], v[108:111]
    ds_read_b128 v[92:95], v11 offset:32768
    v_mfma_f32_16x16x32_bf16 v[112:115], a[56:59], v[104:107], v[112:115]
    ds_read_b128 v[96:99], v11 offset:34816
    v_mfma_f32_16x16x32_bf16 v[116:119], a[136:139], v[100:103], v[116:119]
    v_mfma_f32_16x16x32_bf16 v[120:123], a[136:139], v[104:107], v[120:123]
    s_waitcnt lgkmcnt(2)
    v_mfma_f32_16x16x32_bf16 v[108:111], a[60:63], v[84:87], v[108:111]
    ds_read_b128 v[100:103], v12 offset:32768
    v_mfma_f32_16x16x32_bf16 v[112:115], a[60:63], v[88:91], v[112:115]
    ds_read_b128 v[104:107], v12 offset:34816
    v_mfma_f32_16x16x32_bf16 v[116:119], a[140:143], v[84:87], v[116:119]
    v_mfma_f32_16x16x32_bf16 v[120:123], a[140:143], v[88:91], v[120:123]
    s_waitcnt lgkmcnt(2)
    v_mfma_f32_16x16x32_bf16 v[108:111], a[64:67], v[92:95], v[108:111]
    ds_read_b128 v[84:87], v11 offset:36864
    v_mfma_f32_16x16x32_bf16 v[112:115], a[64:67], v[96:99], v[112:115]
    ds_read_b128 v[88:91], v11 offset:38912
    v_mfma_f32_16x16x32_bf16 v[116:119], a[144:147], v[92:95], v[116:119]
    v_mfma_f32_16x16x32_bf16 v[120:123], a[144:147], v[96:99], v[120:123]
    s_waitcnt lgkmcnt(2)
    v_mfma_f32_16x16x32_bf16 v[108:111], a[68:71], v[100:103], v[108:111]
    ds_read_b128 v[92:95], v12 offset:36864
    v_mfma_f32_16x16x32_bf16 v[112:115], a[68:71], v[104:107], v[112:115]
    ds_read_b128 v[96:99], v12 offset:38912
    v_mfma_f32_16x16x32_bf16 v[116:119], a[148:151], v[100:103], v[116:119]
    v_mfma_f32_16x16x32_bf16 v[120:123], a[148:151], v[104:107], v[120:123]
    s_waitcnt lgkmcnt(0)
    v_mfma_f32_16x16x32_bf16 v[108:111], a[72:75], v[84:87], v[108:111]
    v_add_u32 v11, s49, v11
    v_mfma_f32_16x16x32_bf16 v[112:115], a[72:75], v[88:91], v[112:115]
    v_add_u32 v12, s49, v12
    v_mfma_f32_16x16x32_bf16 v[108:111], a[76:79], v[92:95], v[108:111]
    s_sub_u32 s47, s47, s49
    v_mfma_f32_16x16x32_bf16 v[112:115], a[76:79], v[96:99], v[112:115]
    s_sub_u32 s49, 0, s49
    v_mfma_f32_16x16x32_bf16 v[116:119], a[152:155], v[84:87], v[116:119]
    v_mfma_f32_16x16x32_bf16 v[120:123], a[152:155], v[88:91], v[120:123]
    v_mfma_f32_16x16x32_bf16 v[116:119], a[156:159], v[92:95], v[116:119]
    v_mfma_f32_16x16x32_bf16 v[120:123], a[156:159], v[96:99], v[120:123]
    v_cvt_pk_bf16_f32 v124, v108, v109
    v_cvt_pk_bf16_f32 v125, v110, v111
    v_cvt_pk_bf16_f32 v126, v112, v113
    v_cvt_pk_bf16_f32 v127, v114, v115
    s_nop 0
    v_permlane16_swap_b32 v124, v126
    v_permlane16_swap_b32 v125, v127
    v_cvt_pk_bf16_f32 v128, v116, v117
    v_cvt_pk_bf16_f32 v129, v118, v119
    v_cvt_pk_bf16_f32 v130, v120, v121
    v_cvt_pk_bf16_f32 v131, v122, v123
    s_nop 0
    v_permlane16_swap_b32 v128, v130
    v_permlane16_swap_b32 v129, v131
    ds_write_b128 v140, v[128:131]
    buffer_store_dwordx4 v[124:127], v19, s[4:7], s44 offen sc1
    buffer_store_dwordx4 v[128:131], v19, s[4:7], s45 offen sc1
    v_mov_b32 v1, 196
L_gw_55:
    buffer_load_dword v2, v1, s[8:11], 0 offen sc1
    s_sub_u32 s36, s36, 1
    s_cbranch_scc1 L_exit
    s_waitcnt vmcnt(0)
    v_readfirstlane_b32 s90, v2
    s_nop 0
    s_cmp_eq_u32 s90, 0
    s_cbranch_scc1 L_gw_55
    s_waitcnt vmcnt(0) lgkmcnt(0)
    s_barrier
    s_add_u32 s44, s38, 573440
    s_add_u32 s45, s44, s56
    s_mov_b32 s46, 81920
    v_add_u32 v140, 4096, v137
    ds_read_b128 v[84:87], v11 offset:0
    ds_read_b128 v[88:91], v11 offset:2048
    ds_read_b128 v[92:95], v12 offset:0
    ds_read_b128 v[96:99], v12 offset:2048
    s_lshl_b32 s90, s32, 10
    s_add_u32 m0, s90, s47
    s_waitcnt lgkmcnt(2)
    v_mfma_f32_16x16x32_bf16 v[108:111], a[0:3], v[84:87], 0
    ds_read_b128 v[100:103], v11 offset:4096
    s_and_b32 s50, s37, 3
    v_mfma_f32_16x16x32_bf16 v[112:115], a[0:3], v[88:91], 0
    ds_read_b128 v[104:107], v11 offset:6144
    s_mul_i32 s53, s50, 327680
    v_mfma_f32_16x16x32_bf16 v[116:119], a[80:83], v[84:87], 0
    buffer_load_dwordx4 v10, s[24:27], s46 offen offset:0 lds
    s_add_u32 m0, m0, 3968
    v_mfma_f32_16x16x32_bf16 v[120:123], a[80:83], v[88:91], 0
    s_waitcnt lgkmcnt(2)
    s_add_u32 s51, s37, 2
    v_mfma_f32_16x16x32_bf16 v[108:111], a[4:7], v[92:95], v[108:111]
    ds_read_b128 v[84:87], v12 offset:4096
    s_and_b32 s50, s51, 3
    v_mfma_f32_16x16x32_bf16 v[112:115], a[4:7], v[96:99], v[112:115]
    ds_read_b128 v[88:91], v12 offset:6144
    s_mul_i32 s50, s50, 98304
    v_mfma_f32_16x16x32_bf16 v[116:119], a[84:87], v[92:95], v[116:119]
    buffer_load_dwordx4 v10, s[24:27], s46 offen offset:128 lds
    s_add_u32 m0, m0, 3968
    v_mfma_f32_16x16x32_bf16 v[120:123], a[84:87], v[96:99], v[120:123]
    s_waitcnt lgkmcnt(2)
    s_add_u32 s50, s50, 475136
    v_mfma_f32_16x16x32_bf16 v[108:111], a[8:11], v[100:103], v[108:111]
    ds_read_b128 v[92:95], v11 offset:8192
    s_add_u32 s44, s38, s50
    v_mfma_f32_16x16x32_bf16 v[112:115], a[8:11], v[104:107], v[112:115]
    ds_read_b128 v[96:99], v11 offset:10240
    s_add_u32 s45, s44, s56
    v_mfma_f32_16x16x32_bf16 v[116:119], a[88:91], v[100:103], v[116:119]
    buffer_load_dwordx4 v10, s[24:27], s46 offen offset:256 lds
    s_add_u32 m0, m0, 3968
    v_mfma_f32_16x16x32_bf16 v[120:123], a[88:91], v[104:107], v[120:123]
    s_waitcnt lgkmcnt(2)
    s_and_b32 s50, s51, 3
    v_mfma_f32_16x16x32_bf16 v[108:111], a[12:15], v[84:87], v[108:111]
    ds_read_b128 v[100:103], v12 offset:8192
    s_lshl_b32 s50, s50, 12
    v_mfma_f32_16x16x32_bf16 v[112:115], a[12:15], v[88:91], v[112:115]
    ds_read_b128 v[104:107], v12 offset:10240
    v_add_u32 v140, s50, v137
    v_mfma_f32_16x16x32_bf16 v[116:119], a[92:95], v[84:87], v[116:119]
    buffer_load_dwordx4 v10, s[24:27], s46 offen offset:384 lds
    s_add_u32 m0, m0, 3968
    v_mfma_f32_16x16x32_bf16 v[120:123], a[92:95], v[88:91], v[120:123]
    s_waitcnt lgkmcnt(2)
    s_add_u32 s37, s37, 1
    v_mfma_f32_16x16x32_bf16 v[108:111], a[16:19], v[92:95], v[108:111]
    ds_read_b128 v[84:87], v11 offset:12288
    s_mov_b32 s52, 0
    v_mfma_f32_16x16x32_bf16 v[112:115], a[16:19], v[96:99], v[112:115]
    ds_read_b128 v[88:91], v11 offset:14336
    s_and_b32 s50, s37, 3
    v_mfma_f32_16x16x32_bf16 v[116:119], a[96:99], v[92:95], v[116:119]
    buffer_load_dwordx4 v10, s[24:27], s46 offen offset:512 lds
    s_add_u32 m0, m0, 3968
    v_mfma_f32_16x16x32_bf16 v[120:123], a[96:99], v[96:99], v[120:123]
    s_waitcnt lgkmcnt(2)
    s_mul_i32 s51, s50, 114688
    v_mfma_f32_16x16x32_bf16 v[108:111], a[20:23], v[100:103], v[108:111]
    ds_read_b128 v[92:95], v12 offset:12288
    s_add_u32 s41, s38, s51
    v_mfma_f32_16x16x32_bf16 v[112:115], a[20:23], v[104:107], v[112:115]
    ds_read_b128 v[96:99], v12 offset:14336
    s_xor_b32 s51, s50, 2
    v_mfma_f32_16x16x32_bf16 v[116:119], a[100:103], v[100:103], v[116:119]
    buffer_load_dwordx4 v10, s[24:27], s46 offen offset:640 lds
    s_add_u32 m0, m0, 3968
    v_mfma_f32_16x16x32_bf16 v[120:123], a[100:103], v[104:107], v[120:123]
    s_waitcnt lgkmcnt(2)
    s_mul_i32 s51, s51, 114688
    v_mfma_f32_16x16x32_bf16 v[108:111], a[24:27], v[84:87], v[108:111]
    ds_read_b128 v[100:103], v11 offset:16384
    s_add_u32 s42, s38, s51
    v_mfma_f32_16x16x32_bf16 v[112:115], a[24:27], v[88:91], v[112:115]
    ds_read_b128 v[104:107], v11 offset:18432
    s_and_b32 s54, s37, s55
    v_mfma_f32_16x16x32_bf16 v[116:119], a[104:107], v[84:87], v[116:119]
    buffer_load_dwordx4 v10, s[24:27], s46 offen offset:768 lds
    s_add_u32 m0, m0, 3968
    v_mfma_f32_16x16x32_bf16 v[120:123], a[104:107], v[88:91], v[120:123]
    s_waitcnt lgkmcnt(2)
    s_lshl_b32 s50, s50, 12
    v_mfma_f32_16x16x32_bf16 v[108:111], a[28:31], v[92:95], v[108:111]
    ds_read_b128 v[84:87], v12 offset:16384
    v_add_u32 v141, s50, v138
    v_mfma_f32_16x16x32_bf16 v[112:115], a[28:31], v[96:99], v[112:115]
    ds_read_b128 v[88:91], v12 offset:18432
    s_add_u32 s43, s41, 40960
    v_mfma_f32_16x16x32_bf16 v[116:119], a[108:111], v[92:95], v[116:119]
    buffer_load_dwordx4 v10, s[24:27], s46 offen offset:896 lds
    s_add_u32 m0, m0, 3968
    v_mfma_f32_16x16x32_bf16 v[120:123], a[108:111], v[96:99], v[120:123]
    s_waitcnt lgkmcnt(2)
    v_mfma_f32_16x16x32_bf16 v[108:111], a[32:35], v[100:103], v[108:111]
    ds_read_b128 v[92:95], v11 offset:20480
    v_mfma_f32_16x16x32_bf16 v[112:115], a[32:35], v[104:107], v[112:115]
    ds_read_b128 v[96:99], v11 offset:22528
    v_mfma_f32_16x16x32_bf16 v[116:119], a[112:115], v[100:103], v[116:119]
    buffer_load_dwordx4 v10, s[24:27], s46 offen offset:1024 lds
    s_add_u32 m0, m0, 3968
    v_mfma_f32_16x16x32_bf16 v[120:123], a[112:115], v[104:107], v[120:123]
    s_waitcnt lgkmcnt(2)
    v_mfma_f32_16x16x32_bf16 v[108:111], a[36:39], v[84:87], v[108:111]
    ds_read_b128 v[100:103], v12 offset:20480
    v_mfma_f32_16x16x32_bf16 v[112:115], a[36:39], v[88:91], v[112:115]
    ds_read_b128 v[104:107], v12 offset:22528
    v_mfma_f32_16x16x32_bf16 v[116:119], a[116:119], v[84:87], v[116:119]
    buffer_load_dwordx4 v10, s[24:27], s46 offen offset:1152 lds
    v_mfma_f32_16x16x32_bf16 v[120:123], a[116:119], v[88:91], v[120:123]
    s_waitcnt lgkmcnt(2)
    v_mfma_f32_16x16x32_bf16 v[108:111], a[40:43], v[92:95], v[108:111]
    ds_read_b128 v[84:87], v11 offset:24576
    v_mfma_f32_16x16x32_bf16 v[112:115], a[40:43], v[96:99], v[112:115]
    ds_read_b128 v[88:91], v11 offset:26624
    v_mfma_f32_16x16x32_bf16 v[116:119], a[120:123], v[92:95], v[116:119]
    v_mfma_f32_16x16x32_bf16 v[120:123], a[120:123], v[96:99], v[120:123]
    s_waitcnt lgkmcnt(2)
    v_mfma_f32_16x16x32_bf16 v[108:111], a[44:47], v[100:103], v[108:111]
    ds_read_b128 v[92:95], v12 offset:24576
    v_mfma_f32_16x16x32_bf16 v[112:115], a[44:47], v[104:107], v[112:115]
    ds_read_b128 v[96:99], v12 offset:26624
    v_mfma_f32_16x16x32_bf16 v[116:119], a[124:127], v[100:103], v[116:119]
    v_mfma_f32_16x16x32_bf16 v[120:123], a[124:127], v[104:107], v[120:123]
    s_waitcnt lgkmcnt(2)
    v_mfma_f32_16x16x32_bf16 v[108:111], a[48:51], v[84:87], v[108:111]
    ds_read_b128 v[100:103], v11 offset:28672
    v_mfma_f32_16x16x32_bf16 v[112:115], a[48:51], v[88:91], v[112:115]
    ds_read_b128 v[104:107], v11 offset:30720
    v_mfma_f32_16x16x32_bf16 v[116:119], a[128:131], v[84:87], v[116:119]
    v_mfma_f32_16x16x32_bf16 v[120:123], a[128:131], v[88:91], v[120:123]
    s_waitcnt lgkmcnt(2)
    v_mfma_f32_16x16x32_bf16 v[108:111], a[52:55], v[92:95], v[108:111]
    ds_read_b128 v[84:87], v12 offset:28672
    v_mfma_f32_16x16x32_bf16 v[112:115], a[52:55], v[96:99], v[112:115]
    ds_read_b128 v[88:91], v12 offset:30720
    v_mfma_f32_16x16x32_bf16 v[116:119], a[132:135], v[92:95], v[116:119]
    v_mfma_f32_16x16x32_bf16 v[120:123], a[132:135], v[96:99], v[120:123]
    s_waitcnt lgkmcnt(2)
    v_mfma_f32_16x16x32_bf16 v[108:111], a[56:59], v[100:103], v[108:111]
    ds_read_b128 v[92:95], v11 offset:32768
    v_mfma_f32_16x16x32_bf16 v[112:115], a[56:59], v[104:107], v[112:115]
    ds_read_b128 v[96:99], v11 offset:34816
    v_mfma_f32_16x16x32_bf16 v[116:119], a[136:139], v[100:103], v[116:119]
    v_mfma_f32_16x16x32_bf16 v[120:123], a[136:139], v[104:107], v[120:123]
    s_waitcnt lgkmcnt(2)
    v_mfma_f32_16x16x32_bf16 v[108:111], a[60:63], v[84:87], v[108:111]
    ds_read_b128 v[100:103], v12 offset:32768
    v_mfma_f32_16x16x32_bf16 v[112:115], a[60:63], v[88:91], v[112:115]
    ds_read_b128 v[104:107], v12 offset:34816
    v_mfma_f32_16x16x32_bf16 v[116:119], a[140:143], v[84:87], v[116:119]
    v_mfma_f32_16x16x32_bf16 v[120:123], a[140:143], v[88:91], v[120:123]
    s_waitcnt lgkmcnt(2)
    v_mfma_f32_16x16x32_bf16 v[108:111], a[64:67], v[92:95], v[108:111]
    ds_read_b128 v[84:87], v11 offset:36864
    v_mfma_f32_16x16x32_bf16 v[112:115], a[64:67], v[96:99], v[112:115]
    ds_read_b128 v[88:91], v11 offset:38912
    v_mfma_f32_16x16x32_bf16 v[116:119], a[144:147], v[92:95], v[116:119]
    v_mfma_f32_16x16x32_bf16 v[120:123], a[144:147], v[96:99], v[120:123]
    s_waitcnt lgkmcnt(2)
    v_mfma_f32_16x16x32_bf16 v[108:111], a[68:71], v[100:103], v[108:111]
    ds_read_b128 v[92:95], v12 offset:36864
    v_mfma_f32_16x16x32_bf16 v[112:115], a[68:71], v[104:107], v[112:115]
    ds_read_b128 v[96:99], v12 offset:38912
    v_mfma_f32_16x16x32_bf16 v[116:119], a[148:151], v[100:103], v[116:119]
    v_mfma_f32_16x16x32_bf16 v[120:123], a[148:151], v[104:107], v[120:123]
    s_waitcnt lgkmcnt(0)
    v_mfma_f32_16x16x32_bf16 v[108:111], a[72:75], v[84:87], v[108:111]
    v_add_u32 v11, s49, v11
    v_mfma_f32_16x16x32_bf16 v[112:115], a[72:75], v[88:91], v[112:115]
    v_add_u32 v12, s49, v12
    v_mfma_f32_16x16x32_bf16 v[108:111], a[76:79], v[92:95], v[108:111]
    s_sub_u32 s47, s47, s49
    v_mfma_f32_16x16x32_bf16 v[112:115], a[76:79], v[96:99], v[112:115]
    s_sub_u32 s49, 0, s49
    v_mfma_f32_16x16x32_bf16 v[116:119], a[152:155], v[84:87], v[116:119]
    v_mfma_f32_16x16x32_bf16 v[120:123], a[152:155], v[88:91], v[120:123]
    v_mfma_f32_16x16x32_bf16 v[116:119], a[156:159], v[92:95], v[116:119]
    v_mfma_f32_16x16x32_bf16 v[120:123], a[156:159], v[96:99], v[120:123]
    v_cvt_pk_bf16_f32 v124, v108, v109
    v_cvt_pk_bf16_f32 v125, v110, v111
    v_cvt_pk_bf16_f32 v126, v112, v113
    v_cvt_pk_bf16_f32 v127, v114, v115
    s_nop 0
    v_permlane16_swap_b32 v124, v126
    v_permlane16_swap_b32 v125, v127
    v_cvt_pk_bf16_f32 v128, v116, v117
    v_cvt_pk_bf16_f32 v129, v118, v119
    v_cvt_pk_bf16_f32 v130, v120, v121
    v_cvt_pk_bf16_f32 v131, v122, v123
    s_nop 0
    v_permlane16_swap_b32 v128, v130
    v_permlane16_swap_b32 v129, v131
    ds_write_b128 v140, v[128:131]
    buffer_store_dwordx4 v[124:127], v19, s[4:7], s44 offen sc1
    buffer_store_dwordx4 v[128:131], v19, s[4:7], s45 offen sc1
    v_mov_b32 v3, 460288
L_pf_56:
    buffer_load_dword v4, v3, s[4:7], s38 offen sc1
    s_sub_u32 s36, s36, 1
    s_cbranch_scc1 L_exit
    s_waitcnt vmcnt(0)
    v_readfirstlane_b32 s90, v4
    s_nop 0
    s_cmp_eq_u32 s90, 0
    s_cbranch_scc1 L_pf_56
    s_and_b32 s90, s90, 2
    s_lshl_b32 s90, s90, 12
    v_mov_b32 v3, s90
    v_mov_b32 v4, v3
    v_cmp_gt_u32 vcc, 16, v0
    s_nop 1
    v_cndmask_b32 v3, v3, v4, vcc
    v_add_u32 v142, v3, v142
    v_add_u32 v143, s90, v143
    v_add_u32 v144, 0, v142
    v_add_u32 v145, 0, v143
    ds_read_b128 v[156:159], v141
    ds_read_b128 v[160:163], v141 offset:1024
    v_mov_b32 v3, 204
L_p0_57:
    buffer_load_dword v4, v3, s[8:11], 0 offen sc1
    s_sub_u32 s36, s36, 1
    s_cbranch_scc1 L_exit
    s_waitcnt vmcnt(0)
    v_readfirstlane_b32 s90, v4
    s_nop 0
    s_cmp_eq_u32 s90, 0
    s_cbranch_scc1 L_p0_57
    s_and_b32 s90, s90, 2
    s_lshl_b32 s90, s90, 12
    s_and_b32 s91, s34, 1
    s_lshl_b32 s91, s91, 12
    s_lshr_b32 s92, s34, 2
    s_lshl_b32 s92, s92, 13
    s_add_u32 s91, s91, s92
    s_and_b32 s92, s34, 2
    s_lshl_b32 s92, s92, 13
    s_add_u32 s91, s91, s92
    s_xor_b32 s91, s91, s90
    s_add_u32 s91, s91, 1933312
    v_lshrrev_b32 v4, 2, v0
    v_lshl_add_u32 v3, v4, 9, s91
    v_cmp_ne_u32 s[92:93], s34, v4
    v_cmp_gt_u32 vcc, 32, v0
    s_nop 0
    s_and_b64 vcc, vcc, s[92:93]
    s_and_b32 vcc_lo, vcc_lo, s55
    v_cndmask_b32 v146, v146, v3, vcc
    s_add_u32 s50, s37, 3
    s_min_u32 s50, s50, 63
    s_mul_i32 s46, s50, 40960
    s_add_u32 s51, s37, 1
    v_mov_b32 v20, s51
    s_mov_b32 m0, s48
    v_mov_b32 v68, 0
    v_mov_b32 v69, 0
    v_mov_b32 v70, 0
    v_mov_b32 v71, 0
    v_mov_b32 v72, 0
    v_mov_b32 v73, 0
    v_mov_b32 v74, 0
    v_mov_b32 v75, 0
L_qkv_loop_s:
    buffer_load_dwordx4 v13, s[4:7], s41 offen sc1 lds
    buffer_load_dwordx4 v13, s[4:7], s41 offen offset:1024 sc1 lds
    buffer_load_dword v14, s[4:7], s41 offen offset:2048 sc1 lds
    buffer_load_dword v14, s[4:7], s41 offen offset:2304 sc1 lds
L_poll_59:
    buffer_load_dwordx4 v13, s[4:7], s41 offen sc1 lds
    buffer_load_dwordx4 v13, s[4:7], s41 offen offset:1024 sc1 lds
    buffer_load_dword v14, s[4:7], s41 offen offset:2048 sc1 lds
    buffer_load_dword v14, s[4:7], s41 offen offset:2304 sc1 lds
    s_sub_u32 s36, s36, 1
    s_cbranch_scc1 L_exit
    s_waitcnt vmcnt(4)
    ds_read_b32 v18, v15
    s_waitcnt lgkmcnt(0)
    v_cmp_eq_u32 vcc, -1, v18
    s_cbranch_vccnz L_poll_59
    s_barrier
    ds_read_b128 v[28:31], v16 offset:0
    ds_read_b128 v[32:35], v16 offset:1024
    ds_read_b128 v[36:39], v16 offset:2048
    s_waitcnt lgkmcnt(2)
    v_smfmac_f32_16x16x64_bf16 v[68:71], v[28:31], a[0:7], v17
    ds_read_b128 v[40:43], v16 offset:3072
    v_smfmac_f32_16x16x64_bf16 v[72:75], v[28:31], a[80:87], v17
    ds_read_b128 v[44:47], v16 offset:4096
    s_waitcnt lgkmcnt(3)
    v_smfmac_f32_16x16x64_bf16 v[68:71], v[32:35], a[8:15], v17
    ds_read_b128 v[48:51], v16 offset:5120
    v_smfmac_f32_16x16x64_bf16 v[72:75], v[32:35], a[88:95], v17
    ds_read_b128 v[52:55], v16 offset:6144
    s_waitcnt lgkmcnt(4)
    v_smfmac_f32_16x16x64_bf16 v[68:71], v[36:39], a[16:23], v17
    ds_read_b128 v[56:59], v16 offset:7168
    v_smfmac_f32_16x16x64_bf16 v[72:75], v[36:39], a[96:103], v17
    ds_read_b128 v[60:63], v16 offset:8192
    s_waitcnt lgkmcnt(5)
    v_smfmac_f32_16x16x64_bf16 v[68:71], v[40:43], a[24:31], v17
    ds_read_b128 v[64:67], v16 offset:9216
    v_smfmac_f32_16x16x64_bf16 v[72:75], v[40:43], a[104:111], v17
    s_waitcnt lgkmcnt(5)
    v_smfmac_f32_16x16x64_bf16 v[68:71], v[44:47], a[32:39], v17
    v_smfmac_f32_16x16x64_bf16 v[72:75], v[44:47], a[112:119], v17
    s_waitcnt lgkmcnt(4)
    v_smfmac_f32_16x16x64_bf16 v[68:71], v[48:51], a[40:47], v17
    v_smfmac_f32_16x16x64_bf16 v[72:75], v[48:51], a[120:127], v17
    s_waitcnt lgkmcnt(3)
    v_smfmac_f32_16x16x64_bf16 v[68:71], v[52:55], a[48:55], v17
    s_waitcnt lgkmcnt(2)
    v_smfmac_f32_16x16x64_bf16 v[68:71], v[56:59], a[56:63], v17
    s_waitcnt lgkmcnt(1)
    v_smfmac_f32_16x16x64_bf16 v[68:71], v[60:63], a[64:71], v17
    s_waitcnt lgkmcnt(0)
    v_smfmac_f32_16x16x64_bf16 v[68:71], v[64:67], a[72:79], v17
L_redo_58:
    v_smfmac_f32_16x16x64_bf16 v[72:75], v[52:55], a[128:135], v17
    v_smfmac_f32_16x16x64_bf16 v[72:75], v[56:59], a[136:143], v17
    v_smfmac_f32_16x16x64_bf16 v[72:75], v[60:63], a[144:151], v17
    buffer_store_dword v20, v21, s[4:7], s38 offen sc1
    v_add_f32 v68, v68, v70
    v_add_f32 v69, v69, v71
    v_smfmac_f32_16x16x64_bf16 v[72:75], v[64:67], a[152:159], v17
    v_cmp_u_f32 vcc, v68, v69
    v_cvt_pk_bf16_f32 v132, v68, v69
    s_cbranch_vccnz L_nan_60
L_cont_61:
    s_nop 4
    v_pk_add_f32 v[72:73], v[72:73], v[74:75]
    v_cvt_pk_bf16_f32 v133, v72, v73
    ds_write_b64 v23, v[132:133]
    s_cmp_eq_u32 s32, 0
    s_cbranch_scc1 L_w0_62
    s_cmp_eq_u32 s32, 3
    s_cbranch_scc1 L_w3_63
    s_waitcnt lgkmcnt(0)
    s_barrier
    ds_read_b64_tr_b16 v[76:77], v24 offset:0
    ds_read_b64_tr_b16 v[78:79], v134 offset:0
    ds_read_b64_tr_b16 v[80:81], v24 offset:1024
    ds_read_b64_tr_b16 v[82:83], v134 offset:1024
    s_waitcnt lgkmcnt(2)
    v_mfma_f32_16x16x32_bf16 v[164:167], v[156:159], v[76:79], 0
    s_waitcnt lgkmcnt(0)
    v_mfma_f32_16x16x32_bf16 v[164:167], v[160:163], v[80:83], v[164:167]
    ds_read_b128 v[84:87], v11 offset:0
    ds_read_b128 v[88:91], v11 offset:2048
    ds_read_b128 v[92:95], v12 offset:0
    ds_read_b128 v[96:99], v12 offset:2048
    s_nop 3
    buffer_store_dwordx4 v[164:167], v135, s[4:7], s41 offen sc1
    s_branch L_join_64
L_w0_62:
    s_waitcnt lgkmcnt(0)
    s_barrier
    ds_read_b64_tr_b16 v[76:77], v24 offset:0
    ds_read_b64_tr_b16 v[78:79], v134 offset:0
    ds_read_b64_tr_b16 v[80:81], v24 offset:1024
    ds_read_b64_tr_b16 v[82:83], v134 offset:1024
    s_waitcnt lgkmcnt(2)
    v_mfma_f32_16x16x32_bf16 v[164:167], v[76:79], v[76:79], 0
    s_waitcnt lgkmcnt(0)
    v_mfma_f32_16x16x32_bf16 v[164:167], v[80:83], v[80:83], v[164:167]
    ds_read_b128 v[84:87], v11 offset:0
    ds_read_b128 v[88:91], v11 offset:2048
    ds_read_b128 v[92:95], v12 offset:0
    ds_read_b128 v[96:99], v12 offset:2048
    s_nop 3
    buffer_store_dword v166, v135, s[4:7], s41 offen sc1
    buffer_store_dword v167, v135, s[4:7], s41 offen offset:8 sc1
    s_branch L_join_64
L_w3_63:
    s_waitcnt lgkmcnt(0)
    s_barrier
    ds_read_b64_tr_b16 v[76:77], v24 offset:0
    ds_read_b64_tr_b16 v[78:79], v134 offset:0
    ds_read_b64_tr_b16 v[80:81], v24 offset:1024
    ds_read_b64_tr_b16 v[82:83], v134 offset:1024
    s_waitcnt lgkmcnt(0)
    ds_read_b128 v[84:87], v11 offset:0
    ds_read_b128 v[88:91], v11 offset:2048
    ds_read_b128 v[92:95], v12 offset:0
    ds_read_b128 v[96:99], v12 offset:2048
    s_waitcnt lgkmcnt(0)
    buffer_store_dwordx4 v[76:79], v136, s[4:7], s43 offen sc1
    buffer_store_dwordx4 v[80:83], v136, s[4:7], s43 offen offset:512 sc1
L_join_64:
    s_cmp_eq_u32 s37, 63
    s_cbranch_scc1 L_end_65
    s_lshl_b32 s90, s32, 10
    s_add_u32 m0, s90, s47
    s_waitcnt lgkmcnt(2)
    v_mfma_f32_16x16x32_bf16 v[108:111], a[0:3], v[84:87], 0
    ds_read_b128 v[100:103], v11 offset:4096
    v_mfma_f32_16x16x32_bf16 v[112:115], a[0:3], v[88:91], 0
    ds_read_b128 v[104:107], v11 offset:6144
    v_mfma_f32_16x16x32_bf16 v[116:119], a[80:83], v[84:87], 0
    v_mfma_f32_16x16x32_bf16 v[120:123], a[80:83], v[88:91], 0
    s_waitcnt lgkmcnt(2)
    v_mfma_f32_16x16x32_bf16 v[108:111], a[4:7], v[92:95], v[108:111]
    ds_read_b128 v[84:87], v12 offset:4096
    v_mfma_f32_16x16x32_bf16 v[112:115], a[4:7], v[96:99], v[112:115]
    ds_read_b128 v[88:91], v12 offset:6144
    v_mfma_f32_16x16x32_bf16 v[116:119], a[84:87], v[92:95], v[116:119]
    buffer_store_dword v22, v150, s[4:7], s42 offen offset:0 sc1
    buffer_store_dword v22, v149, s[4:7], s42 offen offset:0 sc1
    v_mfma_f32_16x16x32_bf16 v[120:123], a[84:87], v[96:99], v[120:123]
    s_waitcnt lgkmcnt(2)
    v_mfma_f32_16x16x32_bf16 v[108:111], a[8:11], v[100:103], v[108:111]
    ds_read_b128 v[92:95], v11 offset:8192
    v_mfma_f32_16x16x32_bf16 v[112:115], a[8:11], v[104:107], v[112:115]
    ds_read_b128 v[96:99], v11 offset:10240
    v_mfma_f32_16x16x32_bf16 v[116:119], a[88:91], v[100:103], v[116:119]
    buffer_store_dword v22, v150, s[4:7], s42 offen offset:256 sc1
    v_mfma_f32_16x16x32_bf16 v[120:123], a[88:91], v[104:107], v[120:123]
    s_waitcnt lgkmcnt(2)
    s_and_b32 s50, s37, 3
    v_mfma_f32_16x16x32_bf16 v[108:111], a[12:15], v[84:87], v[108:111]
    ds_read_b128 v[100:103], v12 offset:8192
    s_mul_i32 s53, s50, 327680
    v_mfma_f32_16x16x32_bf16 v[112:115], a[12:15], v[88:91], v[112:115]
    ds_read_b128 v[104:107], v12 offset:10240
    s_add_u32 s51, s37, 2
    v_mfma_f32_16x16x32_bf16 v[116:119], a[92:95], v[84:87], v[116:119]
    buffer_load_dwordx4 v10, s[24:27], s46 offen offset:0 lds
    s_add_u32 m0, m0, 3968
    v_mfma_f32_16x16x32_bf16 v[120:123], a[92:95], v[88:91], v[120:123]
    s_waitcnt lgkmcnt(2)
    s_and_b32 s50, s51, 3
    v_mfma_f32_16x16x32_bf16 v[108:111], a[16:19], v[92:95], v[108:111]
    ds_read_b128 v[84:87], v11 offset:12288
    s_mul_i32 s50, s50, 98304
    v_mfma_f32_16x16x32_bf16 v[112:115], a[16:19], v[96:99], v[112:115]
    ds_read_b128 v[88:91], v11 offset:14336
    s_add_u32 s50, s50, 475136
    v_mfma_f32_16x16x32_bf16 v[116:119], a[96:99], v[92:95], v[116:119]
    buffer_load_dwordx4 v10, s[24:27], s46 offen offset:128 lds
    s_add_u32 m0, m0, 3968
    v_mfma_f32_16x16x32_bf16 v[120:123], a[96:99], v[96:99], v[120:123]
    s_waitcnt lgkmcnt(2)
    s_add_u32 s44, s38, s50
    v_mfma_f32_16x16x32_bf16 v[108:111], a[20:23], v[100:103], v[108:111]
    ds_read_b128 v[92:95], v12 offset:12288
    s_add_u32 s45, s44, s56
    v_mfma_f32_16x16x32_bf16 v[112:115], a[20:23], v[104:107], v[112:115]
    ds_read_b128 v[96:99], v12 offset:14336
    s_and_b32 s50, s51, 3
    v_mfma_f32_16x16x32_bf16 v[116:119], a[100:103], v[100:103], v[116:119]
    buffer_load_dwordx4 v10, s[24:27], s46 offen offset:256 lds
    s_add_u32 m0, m0, 3968
    v_mfma_f32_16x16x32_bf16 v[120:123], a[100:103], v[104:107], v[120:123]
    s_waitcnt lgkmcnt(2)
    s_lshl_b32 s50, s50, 12
    v_mfma_f32_16x16x32_bf16 v[108:111], a[24:27], v[84:87], v[108:111]
    ds_read_b128 v[100:103], v11 offset:16384
    v_add_u32 v140, s50, v137
    v_mfma_f32_16x16x32_bf16 v[112:115], a[24:27], v[88:91], v[112:115]
    ds_read_b128 v[104:107], v11 offset:18432
    s_add_u32 s37, s37, 1
    v_mfma_f32_16x16x32_bf16 v[116:119], a[104:107], v[84:87], v[116:119]
    s_waitcnt vmcnt(6)
    buffer_store_dword v20, v139, s[4:7], s38 offen sc1
    v_mfma_f32_16x16x32_bf16 v[120:123], a[104:107], v[88:91], v[120:123]
    s_waitcnt lgkmcnt(2)
    s_mov_b32 s52, 0
    v_mfma_f32_16x16x32_bf16 v[108:111], a[28:31], v[92:95], v[108:111]
    ds_read_b128 v[84:87], v12 offset:16384
    s_and_b32 s50, s37, 3
    v_mfma_f32_16x16x32_bf16 v[112:115], a[28:31], v[96:99], v[112:115]
    ds_read_b128 v[88:91], v12 offset:18432
    s_mul_i32 s51, s50, 114688
    v_mfma_f32_16x16x32_bf16 v[116:119], a[108:111], v[92:95], v[116:119]
    buffer_load_dwordx4 v10, s[24:27], s46 offen offset:384 lds
    s_add_u32 m0, m0, 3968
    v_mfma_f32_16x16x32_bf16 v[120:123], a[108:111], v[96:99], v[120:123]
    s_waitcnt lgkmcnt(2)
    s_add_u32 s41, s38, s51
    v_mfma_f32_16x16x32_bf16 v[108:111], a[32:35], v[100:103], v[108:111]
    ds_read_b128 v[92:95], v11 offset:20480
    s_xor_b32 s51, s50, 2
    v_mfma_f32_16x16x32_bf16 v[112:115], a[32:35], v[104:107], v[112:115]
    ds_read_b128 v[96:99], v11 offset:22528
    s_mul_i32 s51, s51, 114688
    v_mfma_f32_16x16x32_bf16 v[116:119], a[112:115], v[100:103], v[116:119]
    buffer_load_dwordx4 v10, s[24:27], s46 offen offset:512 lds
    s_add_u32 m0, m0, 3968
    v_mfma_f32_16x16x32_bf16 v[120:123], a[112:115], v[104:107], v[120:123]
    s_waitcnt lgkmcnt(2)
    s_add_u32 s42, s38, s51
    v_mfma_f32_16x16x32_bf16 v[108:111], a[36:39], v[84:87], v[108:111]
    ds_read_b128 v[100:103], v12 offset:20480
    s_and_b32 s54, s37, s55
    v_mfma_f32_16x16x32_bf16 v[112:115], a[36:39], v[88:91], v[112:115]
    ds_read_b128 v[104:107], v12 offset:22528
    s_lshl_b32 s50, s50, 12
    v_mfma_f32_16x16x32_bf16 v[116:119], a[116:119], v[84:87], v[116:119]
    buffer_load_dwordx4 v10, s[24:27], s46 offen offset:640 lds
    s_add_u32 m0, m0, 3968
    v_mfma_f32_16x16x32_bf16 v[120:123], a[116:119], v[88:91], v[120:123]
    s_waitcnt lgkmcnt(2)
    v_add_u32 v141, s50, v138
    v_mfma_f32_16x16x32_bf16 v[108:111], a[40:43], v[92:95], v[108:111]
    ds_read_b128 v[84:87], v11 offset:24576
    s_add_u32 s43, s41, 40960
    v_mfma_f32_16x16x32_bf16 v[112:115], a[40:43], v[96:99], v[112:115]
    ds_read_b128 v[88:91], v11 offset:26624
    v_mfma_f32_16x16x32_bf16 v[116:119], a[120:123], v[92:95], v[116:119]
    buffer_load_dwordx4 v10, s[24:27], s46 offen offset:768 lds
    s_add_u32 m0, m0, 3968
    v_mfma_f32_16x16x32_bf16 v[120:123], a[120:123], v[96:99], v[120:123]
    s_waitcnt lgkmcnt(2)
    v_mfma_f32_16x16x32_bf16 v[108:111], a[44:47], v[100:103], v[108:111]
    ds_read_b128 v[92:95], v12 offset:24576
    v_mfma_f32_16x16x32_bf16 v[112:115], a[44:47], v[104:107], v[112:115]
    buffer_load_dword v147, v146, s[4:7], 0 offen sc1
    ds_read_b128 v[96:99], v12 offset:26624
    v_mfma_f32_16x16x32_bf16 v[116:119], a[124:127], v[100:103], v[116:119]
    buffer_load_dwordx4 v10, s[24:27], s46 offen offset:896 lds
    s_add_u32 m0, m0, 3968
    v_mfma_f32_16x16x32_bf16 v[120:123], a[124:127], v[104:107], v[120:123]
    s_waitcnt lgkmcnt(2)
    v_mfma_f32_16x16x32_bf16 v[108:111], a[48:51], v[84:87], v[108:111]
    ds_read_b128 v[100:103], v11 offset:28672
    v_mfma_f32_16x16x32_bf16 v[112:115], a[48:51], v[88:91], v[112:115]
    buffer_load_dword v147, v146, s[4:7], 0 offen sc1
    ds_read_b128 v[104:107], v11 offset:30720
    v_mfma_f32_16x16x32_bf16 v[116:119], a[128:131], v[84:87], v[116:119]
    buffer_load_dwordx4 v10, s[24:27], s46 offen offset:1024 lds
    s_add_u32 m0, m0, 3968
    v_mfma_f32_16x16x32_bf16 v[120:123], a[128:131], v[88:91], v[120:123]
    s_waitcnt lgkmcnt(2)
    v_mfma_f32_16x16x32_bf16 v[108:111], a[52:55], v[92:95], v[108:111]
    ds_read_b128 v[84:87], v12 offset:28672
    v_mfma_f32_16x16x32_bf16 v[112:115], a[52:55], v[96:99], v[112:115]
    buffer_load_dword v147, v146, s[4:7], 0 offen sc1
    ds_read_b128 v[88:91], v12 offset:30720
    v_mfma_f32_16x16x32_bf16 v[116:119], a[132:135], v[92:95], v[116:119]
    buffer_load_dwordx4 v10, s[24:27], s46 offen offset:1152 lds
    v_mfma_f32_16x16x32_bf16 v[120:123], a[132:135], v[96:99], v[120:123]
    s_waitcnt lgkmcnt(2)
    v_mfma_f32_16x16x32_bf16 v[108:111], a[56:59], v[100:103], v[108:111]
    ds_read_b128 v[92:95], v11 offset:32768
    v_mfma_f32_16x16x32_bf16 v[112:115], a[56:59], v[104:107], v[112:115]
    buffer_load_dword v147, v146, s[4:7], 0 offen sc1
    ds_read_b128 v[96:99], v11 offset:34816
    v_mfma_f32_16x16x32_bf16 v[116:119], a[136:139], v[100:103], v[116:119]
    v_mfma_f32_16x16x32_bf16 v[120:123], a[136:139], v[104:107], v[120:123]
    s_waitcnt lgkmcnt(2)
    v_mfma_f32_16x16x32_bf16 v[108:111], a[60:63], v[84:87], v[108:111]
    ds_read_b128 v[100:103], v12 offset:32768
    v_mfma_f32_16x16x32_bf16 v[112:115], a[60:63], v[88:91], v[112:115]
L_tw_66:
    buffer_load_dword v147, v146, s[4:7], 0 offen sc1
    s_sub_u32 s36, s36, 1
    s_cbranch_scc1 L_exit
    s_waitcnt vmcnt(4)
    v_cmp_gt_u32 vcc, s54, v147
    s_cbranch_vccnz L_tw_66
    s_barrier
    buffer_load_dwordx4 v[168:171], v142, s[4:7], s53 offen sc1
    buffer_load_dwordx4 v[172:175], v143, s[4:7], s53 offen sc1
    ds_read_b128 v[104:107], v12 offset:34816
    v_mfma_f32_16x16x32_bf16 v[116:119], a[140:143], v[84:87], v[116:119]
    v_mfma_f32_16x16x32_bf16 v[120:123], a[140:143], v[88:91], v[120:123]
    s_waitcnt lgkmcnt(2)
    v_mfma_f32_16x16x32_bf16 v[108:111], a[64:67], v[92:95], v[108:111]
    ds_read_b128 v[84:87], v11 offset:36864
    v_mfma_f32_16x16x32_bf16 v[112:115], a[64:67], v[96:99], v[112:115]
    ds_read_b128 v[88:91], v11 offset:38912
    v_mfma_f32_16x16x32_bf16 v[116:119], a[144:147], v[92:95], v[116:119]
    v_mfma_f32_16x16x32_bf16 v[120:123], a[144:147], v[96:99], v[120:123]
    s_waitcnt lgkmcnt(2)
    v_mfma_f32_16x16x32_bf16 v[108:111], a[68:71], v[100:103], v[108:111]
    ds_read_b128 v[92:95], v12 offset:36864
    v_mfma_f32_16x16x32_bf16 v[112:115], a[68:71], v[104:107], v[112:115]
    ds_read_b128 v[96:99], v12 offset:38912
    v_mfma_f32_16x16x32_bf16 v[116:119], a[148:151], v[100:103], v[116:119]
    v_mfma_f32_16x16x32_bf16 v[120:123], a[148:151], v[104:107], v[120:123]
    s_waitcnt lgkmcnt(0)
    v_mfma_f32_16x16x32_bf16 v[108:111], a[72:75], v[84:87], v[108:111]
    v_add_u32 v11, s49, v11
    v_mfma_f32_16x16x32_bf16 v[112:115], a[72:75], v[88:91], v[112:115]
    v_add_u32 v12, s49, v12
    v_mfma_f32_16x16x32_bf16 v[108:111], a[76:79], v[92:95], v[108:111]
    s_sub_u32 s47, s47, s49
    v_mfma_f32_16x16x32_bf16 v[112:115], a[76:79], v[96:99], v[112:115]
    s_sub_u32 s49, 0, s49
    v_mfma_f32_16x16x32_bf16 v[116:119], a[152:155], v[84:87], v[116:119]
    v_mfma_f32_16x16x32_bf16 v[120:123], a[152:155], v[88:91], v[120:123]
    v_mfma_f32_16x16x32_bf16 v[116:119], a[156:159], v[92:95], v[116:119]
    v_mfma_f32_16x16x32_bf16 v[120:123], a[156:159], v[96:99], v[120:123]
    v_cvt_pk_bf16_f32 v124, v108, v109
    v_cvt_pk_bf16_f32 v125, v110, v111
    v_cvt_pk_bf16_f32 v126, v112, v113
    v_cvt_pk_bf16_f32 v127, v114, v115
    s_nop 0
    v_permlane16_swap_b32 v124, v126
    v_permlane16_swap_b32 v125, v127
    v_cvt_pk_bf16_f32 v128, v116, v117
    v_cvt_pk_bf16_f32 v129, v118, v119
    v_cvt_pk_bf16_f32 v130, v120, v121
    v_cvt_pk_bf16_f32 v131, v122, v123
    s_nop 0
    v_permlane16_swap_b32 v128, v130
    v_permlane16_swap_b32 v129, v131
    ds_write_b128 v140, v[128:131]
    buffer_store_dwordx4 v[124:127], v19, s[4:7], s44 offen sc1
    buffer_store_dwordx4 v[128:131], v19, s[4:7], s45 offen sc1
    s_waitcnt vmcnt(3)
    v_mfma_f32_16x16x32_bf16 v[184:187], v[198:201], v[168:171], 0
    v_mfma_f32_16x16x32_bf16 v[188:191], v[196:199], v[168:171], 0
    s_waitcnt vmcnt(2)
    v_mfma_f32_16x16x32_bf16 v[184:187], v[198:201], v[172:175], v[184:187]
    v_mfma_f32_16x16x32_bf16 v[188:191], v[196:199], v[172:175], v[188:191]
    s_nop 4
    v_cmp_u_f32 vcc, v184, v184
    v_cvt_pk_bf16_f32 v192, v184, v185
    v_cvt_pk_bf16_f32 v193, v186, v187
    v_cvt_pk_bf16_f32 v194, v188, v189
    v_cvt_pk_bf16_f32 v195, v190, v191
    s_cbranch_vccnz L_pp_67
L_pc_68:
    buffer_store_dwordx4 v[192:195], v148, s[4:7], s41 offen sc1
    s_barrier
    ds_read_b128 v[156:159], v141
    ds_read_b128 v[160:163], v141 offset:1024
    s_add_u32 s50, s37, 3
    s_min_u32 s50, s50, 63
    s_mul_i32 s46, s50, 40960
    s_add_u32 s51, s37, 1
    v_mov_b32 v20, s51
    s_mov_b32 m0, s48
    v_mov_b32 v68, 0
    v_mov_b32 v69, 0
    v_mov_b32 v70, 0
    v_mov_b32 v71, 0
    v_mov_b32 v72, 0
    v_mov_b32 v73, 0
    v_mov_b32 v74, 0
    v_mov_b32 v75, 0
    s_branch L_qkv_loop_s
L_end_65:
    s_waitcnt vmcnt(0) lgkmcnt(0)
    buffer_store_dword v20, v139, s[4:7], s38 offen sc1
    s_endpgm
L_nan_60:
    s_cmp_eq_u32 s52, 1
    s_cbranch_scc1 L_cont_61
    v_lshlrev_b32 v1, 4, v0
L_nan_60r:
    s_mov_b32 s90, s41
    v_mov_b32 v2, 0
    buffer_load_dwordx4 v[28:31], v1, s[4:7], s90 offen sc1
    s_add_u32 s90, s90, 1024
    buffer_load_dwordx4 v[32:35], v1, s[4:7], s90 offen sc1
    s_add_u32 s90, s90, 1024
    buffer_load_dwordx4 v[36:39], v1, s[4:7], s90 offen sc1
    s_add_u32 s90, s90, 1024
    buffer_load_dwordx4 v[40:43], v1, s[4:7], s90 offen sc1
    s_add_u32 s90, s90, 1024
    buffer_load_dwordx4 v[44:47], v1, s[4:7], s90 offen sc1
    s_add_u32 s90, s90, 1024
    buffer_load_dwordx4 v[48:51], v1, s[4:7], s90 offen sc1
    s_add_u32 s90, s90, 1024
    buffer_load_dwordx4 v[52:55], v1, s[4:7], s90 offen sc1
    s_add_u32 s90, s90, 1024
    buffer_load_dwordx4 v[56:59], v1, s[4:7], s90 offen sc1
    s_add_u32 s90, s90, 1024
    buffer_load_dwordx4 v[60:63], v1, s[4:7], s90 offen sc1
    s_add_u32 s90, s90, 1024
    buffer_load_dwordx4 v[64:67], v1, s[4:7], s90 offen sc1
    s_add_u32 s90, s90, 1024
    s_sub_u32 s36, s36, 1
    s_cbranch_scc1 L_exit
    s_waitcnt vmcnt(0) lgkmcnt(0)
    v_max3_u32 v2, v2, v28, v29
    v_max3_u32 v2, v2, v30, v31
    v_max3_u32 v2, v2, v32, v33
    v_max3_u32 v2, v2, v34, v35
    v_max3_u32 v2, v2, v36, v37
    v_max3_u32 v2, v2, v38, v39
    v_max3_u32 v2, v2, v40, v41
    v_max3_u32 v2, v2, v42, v43
    v_max3_u32 v2, v2, v44, v45
    v_max3_u32 v2, v2, v46, v47
    v_max3_u32 v2, v2, v48, v49
    v_max3_u32 v2, v2, v50, v51
    v_max3_u32 v2, v2, v52, v53
    v_max3_u32 v2, v2, v54, v55
    v_max3_u32 v2, v2, v56, v57
    v_max3_u32 v2, v2, v58, v59
    v_max3_u32 v2, v2, v60, v61
    v_max3_u32 v2, v2, v62, v63
    v_max3_u32 v2, v2, v64, v65
    v_max3_u32 v2, v2, v66, v67
    v_cmp_eq_u32 vcc, -1, v2
    s_cbranch_vccnz L_nan_60r
    s_mov_b32 s52, 1
    v_mov_b32 v68, 0
    v_mov_b32 v69, 0
    v_mov_b32 v70, 0
    v_mov_b32 v71, 0
    v_mov_b32 v72, 0
    v_mov_b32 v73, 0
    v_mov_b32 v74, 0
    v_mov_b32 v75, 0
    v_smfmac_f32_16x16x64_bf16 v[68:71], v[28:31], a[0:7], v17
    s_nop 0
    v_smfmac_f32_16x16x64_bf16 v[72:75], v[28:31], a[80:87], v17
    v_smfmac_f32_16x16x64_bf16 v[68:71], v[32:35], a[8:15], v17
    v_smfmac_f32_16x16x64_bf16 v[72:75], v[32:35], a[88:95], v17
    v_smfmac_f32_16x16x64_bf16 v[68:71], v[36:39], a[16:23], v17
    v_smfmac_f32_16x16x64_bf16 v[72:75], v[36:39], a[96:103], v17
    v_smfmac_f32_16x16x64_bf16 v[68:71], v[40:43], a[24:31], v17
    v_smfmac_f32_16x16x64_bf16 v[72:75], v[40:43], a[104:111], v17
    v_smfmac_f32_16x16x64_bf16 v[68:71], v[44:47], a[32:39], v17
    v_smfmac_f32_16x16x64_bf16 v[72:75], v[44:47], a[112:119], v17
    v_smfmac_f32_16x16x64_bf16 v[68:71], v[48:51], a[40:47], v17
    v_smfmac_f32_16x16x64_bf16 v[72:75], v[48:51], a[120:127], v17
    v_smfmac_f32_16x16x64_bf16 v[68:71], v[52:55], a[48:55], v17
    v_smfmac_f32_16x16x64_bf16 v[68:71], v[56:59], a[56:63], v17
    v_smfmac_f32_16x16x64_bf16 v[68:71], v[60:63], a[64:71], v17
    v_smfmac_f32_16x16x64_bf16 v[68:71], v[64:67], a[72:79], v17
    s_nop 2
    s_branch L_redo_58
L_pp_67:
    buffer_load_dwordx4 v[176:179], v144, s[4:7], s53 offen sc1
    buffer_load_dwordx4 v[180:183], v145, s[4:7], s53 offen sc1
    s_sub_u32 s36, s36, 1
    s_cbranch_scc1 L_exit
    v_max_u32 v151, v168, v169
    v_max3_u32 v151, v151, v170, v171
    v_max3_u32 v151, v151, v172, v173
    v_max3_u32 v151, v151, v174, v175
    v_cmp_eq_u32 vcc, -1, v151
    s_cbranch_vccz L_pc_68
    s_waitcnt vmcnt(1)
    v_mfma_f32_16x16x32_bf16 v[184:187], v[198:201], v[176:179], 0
    v_mfma_f32_16x16x32_bf16 v[188:191], v[196:199], v[176:179], 0
    s_waitcnt vmcnt(0)
    v_mfma_f32_16x16x32_bf16 v[184:187], v[198:201], v[180:183], v[184:187]
    v_mfma_f32_16x16x32_bf16 v[188:191], v[196:199], v[180:183], v[188:191]
    s_nop 4
    v_cmp_u_f32 vcc, v184, v184
    v_cvt_pk_bf16_f32 v192, v184, v185
    v_cvt_pk_bf16_f32 v193, v186, v187
    v_cvt_pk_bf16_f32 v194, v188, v189
    v_cvt_pk_bf16_f32 v195, v190, v191
    s_cbranch_vccnz L_pp_67_1
    s_branch L_pc_68
L_pp_67_1:
    buffer_load_dwordx4 v[168:171], v142, s[4:7], s53 offen sc1
    buffer_load_dwordx4 v[172:175], v143, s[4:7], s53 offen sc1
    s_sub_u32 s36, s36, 1
    s_cbranch_scc1 L_exit
    v_max_u32 v151, v176, v177
    v_max3_u32 v151, v151, v178, v179
    v_max3_u32 v151, v151, v180, v181
    v_max3_u32 v151, v151, v182, v183
    v_cmp_eq_u32 vcc, -1, v151
    s_cbranch_vccz L_pc_68
    s_waitcnt vmcnt(1)
    v_mfma_f32_16x16x32_bf16 v[184:187], v[198:201], v[168:171], 0
    v_mfma_f32_16x16x32_bf16 v[188:191], v[196:199], v[168:171], 0
    s_waitcnt vmcnt(0)
    v_mfma_f32_16x16x32_bf16 v[184:187], v[198:201], v[172:175], v[184:187]
    v_mfma_f32_16x16x32_bf16 v[188:191], v[196:199], v[172:175], v[188:191]
    s_nop 4
    v_cmp_u_f32 vcc, v184, v184
    v_cvt_pk_bf16_f32 v192, v184, v185
    v_cvt_pk_bf16_f32 v193, v186, v187
    v_cvt_pk_bf16_f32 v194, v188, v189
    v_cvt_pk_bf16_f32 v195, v190, v191
    s_cbranch_vccnz L_pp_67
    s_branch L_pc_68
L_v_s:
    s_mov_b32 s12, s78
    s_and_b32 s13, s79, 0xffff
    s_mov_b32 s14, 7864320
    s_mov_b32 s15, 0x20000
    s_sub_u32 s40, s35, 12
    s_lshl_b32 s40, s40, 1
    s_mov_b32 s24, s70
    s_and_b32 s25, s71, 0xffff
    s_mov_b32 s26, 2621440
    s_mov_b32 s27, 0x20000
    v_and_b32 v1, 15, v0
    v_lshrrev_b32 v2, 4, v0
    v_lshrrev_b32 v3, 3, v0
    v_and_b32 v4, 7, v0
    s_lshl_b32 s90, s32, 3
    v_add_u32 v5, s90, v3
    s_and_b32 s91, s32, 1
    s_lshl_b32 s91, s91, 2
    v_and_b32 v6, 2, v3
    v_or_b32 v6, s91, v6
    v_xor_b32 v6, v6, v4
    v_lshlrev_b32 v6, 4, v6
    v_mul_u32_u24 v7, 12288, v5
    s_mul_i32 s92, s34, 1536
    s_lshl_b32 s93, s40, 7
    s_add_u32 s92, s92, s93
    v_add3_u32 v124, v6, v7, s92
    v_lshrrev_b32 v6, 1, v3
    v_or_b32 v6, s91, v6
    v_xor_b32 v6, v6, v4
    v_lshlrev_b32 v6, 4, v6
    v_mul_u32_u24 v7, 1280, v5
    v_add_u32 v10, v6, v7
    s_lshl_b32 s90, s32, 10
    s_add_u32 m0, s90, 81920
    s_mov_b32 s91, 0
    buffer_load_dwordx4 v124, s[12:15], s91 offen nt lds
    s_add_u32 m0, m0, 4096
    s_add_u32 s91, s91, 393216
    buffer_load_dwordx4 v124, s[12:15], s91 offen nt lds
    s_add_u32 m0, m0, 4096
    s_add_u32 s91, s91, 393216
    buffer_load_dwordx4 v124, s[12:15], s91 offen nt lds
    s_add_u32 m0, m0, 4096
    s_add_u32 s91, s91, 393216
    buffer_load_dwordx4 v124, s[12:15], s91 offen nt lds
    s_add_u32 m0, m0, 4096
    s_add_u32 s91, s91, 393216
    buffer_load_dwordx4 v124, s[12:15], s91 offen nt lds
    s_add_u32 m0, m0, 4096
    s_add_u32 s91, s91, 393216
    buffer_load_dwordx4 v124, s[12:15], s91 offen nt lds
    s_add_u32 m0, m0, 4096
    s_add_u32 s91, s91, 393216
    buffer_load_dwordx4 v124, s[12:15], s91 offen nt lds
    s_add_u32 m0, m0, 4096
    s_add_u32 s91, s91, 393216
    buffer_load_dwordx4 v124, s[12:15], s91 offen nt lds
    s_add_u32 m0, m0, 4096
    s_add_u32 s91, s91, 393216
    buffer_load_dwordx4 v124, s[12:15], s91 offen nt lds
    s_add_u32 m0, m0, 4096
    s_add_u32 s91, s91, 393216
    buffer_load_dwordx4 v124, s[12:15], s91 offen nt lds
    s_lshl_b32 s90, s32, 10
    s_add_u32 m0, s90, 40960
    s_mov_b32 s91, 128
    buffer_load_dwordx4 v124, s[12:15], s91 offen nt lds
    s_add_u32 m0, m0, 4096
    s_add_u32 s91, s91, 393216
    buffer_load_dwordx4 v124, s[12:15], s91 offen nt lds
    s_add_u32 m0, m0, 4096
    s_add_u32 s91, s91, 393216
    buffer_load_dwordx4 v124, s[12:15], s91 offen nt lds
    s_add_u32 m0, m0, 4096
    s_add_u32 s91, s91, 393216
    buffer_load_dwordx4 v124, s[12:15], s91 offen nt lds
    s_add_u32 m0, m0, 4096
    s_add_u32 s91, s91, 393216
    buffer_load_dwordx4 v124, s[12:15], s91 offen nt lds
    s_add_u32 m0, m0, 4096
    s_add_u32 s91, s91, 393216
    buffer_load_dwordx4 v124, s[12:15], s91 offen nt lds
    s_add_u32 m0, m0, 4096
    s_add_u32 s91, s91, 393216
    buffer_load_dwordx4 v124, s[12:15], s91 offen nt lds
    s_add_u32 m0, m0, 4096
    s_add_u32 s91, s91, 393216
    buffer_load_dwordx4 v124, s[12:15], s91 offen nt lds
    s_add_u32 m0, m0, 4096
    s_add_u32 s91, s91, 393216
    buffer_load_dwordx4 v124, s[12:15], s91 offen nt lds
    s_add_u32 m0, m0, 4096
    s_add_u32 s91, s91, 393216
    buffer_load_dwordx4 v124, s[12:15], s91 offen nt lds
    s_lshl_b32 s90, s32, 10
    s_add_u32 m0, s90, 122880
    s_mov_b32 s91, 3932160
    buffer_load_dwordx4 v124, s[12:15], s91 offen nt lds
    s_add_u32 m0, m0, 4096
    s_add_u32 s91, s91, 393216
    buffer_load_dwordx4 v124, s[12:15], s91 offen nt lds
    s_add_u32 m0, m0, 4096
    s_add_u32 s91, s91, 393216
    buffer_load_dwordx4 v124, s[12:15], s91 offen nt lds
    s_add_u32 m0, m0, 4096
    s_add_u32 s91, s91, 393216
    buffer_load_dwordx4 v124, s[12:15], s91 offen nt lds
    s_add_u32 m0, m0, 4096
    s_add_u32 s91, s91, 393216
    buffer_load_dwordx4 v124, s[12:15], s91 offen nt lds
    s_add_u32 m0, m0, 4096
    s_add_u32 s91, s91, 393216
    buffer_load_dwordx4 v124, s[12:15], s91 offen nt lds
    s_add_u32 m0, m0, 4096
    s_add_u32 s91, s91, 393216
    buffer_load_dwordx4 v124, s[12:15], s91 offen nt lds
    s_add_u32 m0, m0, 4096
    s_add_u32 s91, s91, 393216
    buffer_load_dwordx4 v124, s[12:15], s91 offen nt lds
    s_add_u32 m0, m0, 4096
    s_add_u32 s91, s91, 393216
    buffer_load_dwordx4 v124, s[12:15], s91 offen nt lds
    s_add_u32 m0, m0, 4096
    s_add_u32 s91, s91, 393216
    buffer_load_dwordx4 v124, s[12:15], s91 offen nt lds
    s_mov_b32 s46, 0
    s_lshl_b32 s90, s32, 10
    s_add_u32 m0, s90, 0
    s_nop 0
    buffer_load_dwordx4 v10, s[24:27], s46 offen offset:0 lds
    s_add_u32 m0, m0, 3968
    s_nop 0
    buffer_load_dwordx4 v10, s[24:27], s46 offen offset:128 lds
    s_add_u32 m0, m0, 3968
    s_nop 0
    buffer_load_dwordx4 v10, s[24:27], s46 offen offset:256 lds
    s_add_u32 m0, m0, 3968
    s_nop 0
    buffer_load_dwordx4 v10, s[24:27], s46 offen offset:384 lds
    s_add_u32 m0, m0, 3968
    s_nop 0
    buffer_load_dwordx4 v10, s[24:27], s46 offen offset:512 lds
    s_add_u32 m0, m0, 3968
    s_nop 0
    buffer_load_dwordx4 v10, s[24:27], s46 offen offset:640 lds
    s_add_u32 m0, m0, 3968
    s_nop 0
    buffer_load_dwordx4 v10, s[24:27], s46 offen offset:768 lds
    s_add_u32 m0, m0, 3968
    s_nop 0
    buffer_load_dwordx4 v10, s[24:27], s46 offen offset:896 lds
    s_add_u32 m0, m0, 3968
    s_nop 0
    buffer_load_dwordx4 v10, s[24:27], s46 offen offset:1024 lds
    s_add_u32 m0, m0, 3968
    s_nop 0
    buffer_load_dwordx4 v10, s[24:27], s46 offen offset:1152 lds
    s_mul_i32 s60, s40, 86
    s_lshr_b32 s60, s60, 8
    s_mul_i32 s61, s60, 3
    s_sub_u32 s61, s40, s61
    s_add_u32 s90, s40, 1
    s_mul_i32 s62, s90, 86
    s_lshr_b32 s62, s62, 8
    s_mul_i32 s63, s62, 3
    s_sub_u32 s63, s90, s63
    v_lshrrev_b32 v3, 1, v2
    v_and_b32 v5, 1, v2
    s_lshl_b32 s90, s32, 9
    v_lshlrev_b32 v6, 4, v1
    v_lshl_add_u32 v6, v3, 8, v6
    v_add_u32 v6, s90, v6
    s_mul_i32 s90, s60, 12288
    s_lshl_b32 s91, s61, 11
    s_add_u32 s90, s90, s91
    v_mul_u32_u24 v7, 6144, v5
    v_add3_u32 v19, v6, v7, s90
    v_mov_b32 v22, -1
    s_mul_i32 s56, s62, 12288
    s_lshl_b32 s91, s63, 11
    s_add_u32 s56, s56, s91
    s_sub_u32 s56, s56, s90
    s_lshl_b32 s90, s40, 10
    s_lshl_b32 s91, s32, 8
    s_add_u32 s91, s91, s90
    s_add_u32 s91, s91, 25600
    v_lshl_add_u32 v135, v0, 2, s91
    v_lshlrev_b32 v6, 4, v1
    v_lshl_add_u32 v6, v2, 10, v6
    v_add_u32 v134, s91, v6
    v_cmp_gt_u32 vcc, 2, v2
    v_mov_b32 v9, 2146435072
    s_nop 0
    v_cndmask_b32 v134, v9, v134, vcc
    s_lshl_b32 s90, s60, 5
    s_lshl_b32 s91, s62, 5
    v_mov_b32 v3, s90
    v_mov_b32 v4, s91
    v_mov_b32 v6, s61
    v_mov_b32 v7, s63
    v_cmp_eq_u32 vcc, 0, v0
    s_nop 1
    v_cndmask_b32 v3, v4, v3, vcc
    v_cndmask_b32 v6, v7, v6, vcc
    v_add_u32 v4, v3, v6
    s_cmp_eq_u32 s32, 3
    s_cselect_b32 s91, 0, 2146435072
    s_add_u32 s91, s91, 462348
    v_lshl_add_u32 v21, v4, 2, s91
    v_lshl_add_u32 v4, v6, 2, v3
    s_lshl_b32 s91, s32, 2
    s_add_u32 s91, s91, 458752
    v_lshl_add_u32 v136, v4, 2, s91
    v_cmp_gt_u32 vcc, 2, v0
    v_mov_b32 v9, 2146435072
    s_nop 0
    v_cndmask_b32 v21, v9, v21, vcc
    v_cndmask_b32 v136, v9, v136, vcc
    s_lshl_b32 s90, s40, 1
    s_add_u32 s90, s90, s32
    s_min_u32 s90, s90, 19
    s_lshl_b32 s90, s90, 11
    v_lshl_add_u32 v137, v0, 4, s90
    s_mul_i32 s90, s32, 2560
    v_mov_b32 v138, s90
    v_lshrrev_b32 v3, 2, v1
    v_and_b32 v4, 3, v1
    v_and_b32 v5, 1, v2
    v_lshl_add_u32 v6, v2, 3, v3
    v_lshlrev_b32 v6, 7, v6
    v_and_b32 v7, 2, v3
    v_lshl_or_b32 v7, v5, 2, v7
    v_lshrrev_b32 v8, 1, v4
    s_lshl_b32 s90, s32, 1
    v_or_b32 v8, s90, v8
    v_xor_b32 v7, v7, v8
    v_lshl_add_u32 v6, v7, 4, v6
    v_and_b32 v7, 1, v4
    v_lshl_add_u32 v6, v7, 3, v6
    v_add_u32 v125, 81920, v6
    v_add_u32 v126, 40960, v6
    v_add_u32 v127, 122880, v6
    s_lshl_b32 s90, s32, 9
    s_add_u32 s90, s90, 133120
    v_lshlrev_b32 v6, 6, v3
    v_and_b32 v7, 1, v1
    v_lshl_add_u32 v6, v7, 5, v6
    v_lshl_add_u32 v6, v2, 3, v6
    v_and_b32 v7, 2, v1
    v_lshl_add_u32 v6, v7, 1, v6
    v_add_u32 v23, s90, v6
    v_lshlrev_b32 v6, 3, v1
    v_lshl_add_u32 v6, v5, 8, v6
    v_add_u32 v24, s90, v6
    v_and_b32 v7, 2, v1
    v_cmp_ne_u32 vcc, 0, v7
    v_mov_b32 v6, 0x4444
    v_mov_b32 v8, 0xeeee
    v_cndmask_b32 v17, v6, v8, vcc
    v_lshlrev_b32 v6, 4, v0
    v_add_u32 v16, 122880, v6
    s_mul_i32 s90, s32, 2560
    v_lshl_add_u32 v13, v0, 4, s90
    v_lshl_add_u32 v14, v0, 2, s90
    s_add_u32 s48, s90, 122880
    v_mul_u32_u24 v6, 40, v0
    v_add_u32 v15, s48, v6
    v_mul_u32_u24 v6, 164, v0
    v_min_u32 v6, 10236, v6
    v_add_u32 v25, 122880, v6
    v_lshrrev_b32 v6, 3, v1
    v_lshlrev_b32 v6, 10, v6
    v_and_b32 v7, 7, v1
    v_lshl_add_u32 v6, v7, 7, v6
    v_lshrrev_b32 v7, 1, v1
    v_xor_b32 v7, v7, v2
    v_lshl_add_u32 v11, v7, 4, v6
    v_xor_b32 v12, 64, v11
    s_waitcnt vmcnt(30)
    s_barrier
    ds_read_b64_tr_b16 a[0:1], v125 offset:0
    ds_read_b64_tr_b16 a[2:3], v125 offset:512
    ds_read_b64_tr_b16 a[4:5], v125 offset:4096
    ds_read_b64_tr_b16 a[6:7], v125 offset:4608
    ds_read_b64_tr_b16 a[8:9], v125 offset:8192
    ds_read_b64_tr_b16 a[10:11], v125 offset:8704
    ds_read_b64_tr_b16 a[12:13], v125 offset:12288
    ds_read_b64_tr_b16 a[14:15], v125 offset:12800
    ds_read_b64_tr_b16 a[16:17], v125 offset:16384
    ds_read_b64_tr_b16 a[18:19], v125 offset:16896
    ds_read_b64_tr_b16 a[20:21], v125 offset:20480
    ds_read_b64_tr_b16 a[22:23], v125 offset:20992
    ds_read_b64_tr_b16 a[24:25], v125 offset:24576
    ds_read_b64_tr_b16 a[26:27], v125 offset:25088
    ds_read_b64_tr_b16 a[28:29], v125 offset:28672
    ds_read_b64_tr_b16 a[30:31], v125 offset:29184
    ds_read_b64_tr_b16 a[32:33], v125 offset:32768
    ds_read_b64_tr_b16 a[34:35], v125 offset:33280
    ds_read_b64_tr_b16 a[36:37], v125 offset:36864
    ds_read_b64_tr_b16 a[38:39], v125 offset:37376
    s_waitcnt lgkmcnt(0)
    s_barrier
    s_lshl_b32 s90, s32, 10
    s_add_u32 m0, s90, 81920
    s_mov_b32 s91, 3932288
    buffer_load_dwordx4 v124, s[12:15], s91 offen nt lds
    s_add_u32 m0, m0, 4096
    s_add_u32 s91, s91, 393216
    buffer_load_dwordx4 v124, s[12:15], s91 offen nt lds
    s_add_u32 m0, m0, 4096
    s_add_u32 s91, s91, 393216
    buffer_load_dwordx4 v124, s[12:15], s91 offen nt lds
    s_add_u32 m0, m0, 4096
    s_add_u32 s91, s91, 393216
    buffer_load_dwordx4 v124, s[12:15], s91 offen nt lds
    s_add_u32 m0, m0, 4096
    s_add_u32 s91, s91, 393216
    buffer_load_dwordx4 v124, s[12:15], s91 offen nt lds
    s_add_u32 m0, m0, 4096
    s_add_u32 s91, s91, 393216
    buffer_load_dwordx4 v124, s[12:15], s91 offen nt lds
    s_add_u32 m0, m0, 4096
    s_add_u32 s91, s91, 393216
    buffer_load_dwordx4 v124, s[12:15], s91 offen nt lds
    s_add_u32 m0, m0, 4096
    s_add_u32 s91, s91, 393216
    buffer_load_dwordx4 v124, s[12:15], s91 offen nt lds
    s_add_u32 m0, m0, 4096
    s_add_u32 s91, s91, 393216
    buffer_load_dwordx4 v124, s[12:15], s91 offen nt lds
    s_add_u32 m0, m0, 4096
    s_add_u32 s91, s91, 393216
    buffer_load_dwordx4 v124, s[12:15], s91 offen nt lds
    s_waitcnt vmcnt(30)
    s_barrier
    ds_read_b64_tr_b16 a[80:81], v126 offset:0
    ds_read_b64_tr_b16 a[82:83], v126 offset:512
    ds_read_b64_tr_b16 a[84:85], v126 offset:4096
    ds_read_b64_tr_b16 a[86:87], v126 offset:4608
    ds_read_b64_tr_b16 a[88:89], v126 offset:8192
    ds_read_b64_tr_b16 a[90:91], v126 offset:8704
    ds_read_b64_tr_b16 a[92:93], v126 offset:12288
    ds_read_b64_tr_b16 a[94:95], v126 offset:12800
    ds_read_b64_tr_b16 a[96:97], v126 offset:16384
    ds_read_b64_tr_b16 a[98:99], v126 offset:16896
    ds_read_b64_tr_b16 a[100:101], v126 offset:20480
    ds_read_b64_tr_b16 a[102:103], v126 offset:20992
    ds_read_b64_tr_b16 a[104:105], v126 offset:24576
    ds_read_b64_tr_b16 a[106:107], v126 offset:25088
    ds_read_b64_tr_b16 a[108:109], v126 offset:28672
    ds_read_b64_tr_b16 a[110:111], v126 offset:29184
    ds_read_b64_tr_b16 a[112:113], v126 offset:32768
    ds_read_b64_tr_b16 a[114:115], v126 offset:33280
    ds_read_b64_tr_b16 a[116:117], v126 offset:36864
    ds_read_b64_tr_b16 a[118:119], v126 offset:37376
    s_waitcnt lgkmcnt(0)
    s_barrier
    s_mov_b32 s46, 40960
    s_lshl_b32 s90, s32, 10
    s_add_u32 m0, s90, 40960
    s_nop 0
    buffer_load_dwordx4 v10, s[24:27], s46 offen offset:0 lds
    s_add_u32 m0, m0, 3968
    s_nop 0
    buffer_load_dwordx4 v10, s[24:27], s46 offen offset:128 lds
    s_add_u32 m0, m0, 3968
    s_nop 0
    buffer_load_dwordx4 v10, s[24:27], s46 offen offset:256 lds
    s_add_u32 m0, m0, 3968
    s_nop 0
    buffer_load_dwordx4 v10, s[24:27], s46 offen offset:384 lds
    s_add_u32 m0, m0, 3968
    s_nop 0
    buffer_load_dwordx4 v10, s[24:27], s46 offen offset:512 lds
    s_add_u32 m0, m0, 3968
    s_nop 0
    buffer_load_dwordx4 v10, s[24:27], s46 offen offset:640 lds
    s_add_u32 m0, m0, 3968
    s_nop 0
    buffer_load_dwordx4 v10, s[24:27], s46 offen offset:768 lds
    s_add_u32 m0, m0, 3968
    s_nop 0
    buffer_load_dwordx4 v10, s[24:27], s46 offen offset:896 lds
    s_add_u32 m0, m0, 3968
    s_nop 0
    buffer_load_dwordx4 v10, s[24:27], s46 offen offset:1024 lds
    s_add_u32 m0, m0, 3968
    s_nop 0
    buffer_load_dwordx4 v10, s[24:27], s46 offen offset:1152 lds
    s_waitcnt vmcnt(30)
    s_barrier
    ds_read_b64_tr_b16 a[40:41], v127 offset:0
    ds_read_b64_tr_b16 a[42:43], v127 offset:512
    ds_read_b64_tr_b16 a[44:45], v127 offset:4096
    ds_read_b64_tr_b16 a[46:47], v127 offset:4608
    ds_read_b64_tr_b16 a[48:49], v127 offset:8192
    ds_read_b64_tr_b16 a[50:51], v127 offset:8704
    ds_read_b64_tr_b16 a[52:53], v127 offset:12288
    ds_read_b64_tr_b16 a[54:55], v127 offset:12800
    ds_read_b64_tr_b16 a[56:57], v127 offset:16384
    ds_read_b64_tr_b16 a[58:59], v127 offset:16896
    ds_read_b64_tr_b16 a[60:61], v127 offset:20480
    ds_read_b64_tr_b16 a[62:63], v127 offset:20992
    ds_read_b64_tr_b16 a[64:65], v127 offset:24576
    ds_read_b64_tr_b16 a[66:67], v127 offset:25088
    ds_read_b64_tr_b16 a[68:69], v127 offset:28672
    ds_read_b64_tr_b16 a[70:71], v127 offset:29184
    ds_read_b64_tr_b16 a[72:73], v127 offset:32768
    ds_read_b64_tr_b16 a[74:75], v127 offset:33280
    ds_read_b64_tr_b16 a[76:77], v127 offset:36864
    ds_read_b64_tr_b16 a[78:79], v127 offset:37376
    s_waitcnt lgkmcnt(0)
    s_waitcnt vmcnt(10)
    s_barrier
    ds_read_b64_tr_b16 a[120:121], v125 offset:0
    ds_read_b64_tr_b16 a[122:123], v125 offset:512
    ds_read_b64_tr_b16 a[124:125], v125 offset:4096
    ds_read_b64_tr_b16 a[126:127], v125 offset:4608
    ds_read_b64_tr_b16 a[128:129], v125 offset:8192
    ds_read_b64_tr_b16 a[130:131], v125 offset:8704
    ds_read_b64_tr_b16 a[132:133], v125 offset:12288
    ds_read_b64_tr_b16 a[134:135], v125 offset:12800
    ds_read_b64_tr_b16 a[136:137], v125 offset:16384
    ds_read_b64_tr_b16 a[138:139], v125 offset:16896
    ds_read_b64_tr_b16 a[140:141], v125 offset:20480
    ds_read_b64_tr_b16 a[142:143], v125 offset:20992
    ds_read_b64_tr_b16 a[144:145], v125 offset:24576
    ds_read_b64_tr_b16 a[146:147], v125 offset:25088
    ds_read_b64_tr_b16 a[148:149], v125 offset:28672
    ds_read_b64_tr_b16 a[150:151], v125 offset:29184
    ds_read_b64_tr_b16 a[152:153], v125 offset:32768
    ds_read_b64_tr_b16 a[154:155], v125 offset:33280
    ds_read_b64_tr_b16 a[156:157], v125 offset:36864
    ds_read_b64_tr_b16 a[158:159], v125 offset:37376
    s_waitcnt lgkmcnt(0)
    s_mov_b32 s49, 40960
    s_mov_b32 s47, 40960
    s_mov_b32 s37, -1
    s_add_u32 s44, s38, 65536
    s_add_u32 s45, s44, s56
    s_mov_b32 s46, 40960
    ds_read_b128 v[84:87], v11 offset:0
    ds_read_b128 v[88:91], v11 offset:2048
    ds_read_b128 v[92:95], v12 offset:0
    ds_read_b128 v[96:99], v12 offset:2048
    s_waitcnt lgkmcnt(2)
    v_mfma_f32_16x16x32_bf16 v[108:111], a[0:3], v[84:87], 0
    ds_read_b128 v[100:103], v11 offset:4096
    v_mfma_f32_16x16x32_bf16 v[112:115], a[0:3], v[88:91], 0
    ds_read_b128 v[104:107], v11 offset:6144
    v_mfma_f32_16x16x32_bf16 v[116:119], a[80:83], v[84:87], 0
    v_mfma_f32_16x16x32_bf16 v[120:123], a[80:83], v[88:91], 0
    s_waitcnt lgkmcnt(2)
    v_mfma_f32_16x16x32_bf16 v[108:111], a[4:7], v[92:95], v[108:111]
    ds_read_b128 v[84:87], v12 offset:4096
    v_mfma_f32_16x16x32_bf16 v[112:115], a[4:7], v[96:99], v[112:115]
    ds_read_b128 v[88:91], v12 offset:6144
    v_mfma_f32_16x16x32_bf16 v[116:119], a[84:87], v[92:95], v[116:119]
    v_mfma_f32_16x16x32_bf16 v[120:123], a[84:87], v[96:99], v[120:123]
    s_waitcnt lgkmcnt(2)
    v_mfma_f32_16x16x32_bf16 v[108:111], a[8:11], v[100:103], v[108:111]
    ds_read_b128 v[92:95], v11 offset:8192
    v_mfma_f32_16x16x32_bf16 v[112:115], a[8:11], v[104:107], v[112:115]
    ds_read_b128 v[96:99], v11 offset:10240
    v_mfma_f32_16x16x32_bf16 v[116:119], a[88:91], v[100:103], v[116:119]
    v_mfma_f32_16x16x32_bf16 v[120:123], a[88:91], v[104:107], v[120:123]
    s_waitcnt lgkmcnt(2)
    v_mfma_f32_16x16x32_bf16 v[108:111], a[12:15], v[84:87], v[108:111]
    ds_read_b128 v[100:103], v12 offset:8192
    v_mfma_f32_16x16x32_bf16 v[112:115], a[12:15], v[88:91], v[112:115]
    ds_read_b128 v[104:107], v12 offset:10240
    v_mfma_f32_16x16x32_bf16 v[116:119], a[92:95], v[84:87], v[116:119]
    v_mfma_f32_16x16x32_bf16 v[120:123], a[92:95], v[88:91], v[120:123]
    s_waitcnt lgkmcnt(2)
    v_mfma_f32_16x16x32_bf16 v[108:111], a[16:19], v[92:95], v[108:111]
    ds_read_b128 v[84:87], v11 offset:12288
    v_mfma_f32_16x16x32_bf16 v[112:115], a[16:19], v[96:99], v[112:115]
    ds_read_b128 v[88:91], v11 offset:14336
    v_mfma_f32_16x16x32_bf16 v[116:119], a[96:99], v[92:95], v[116:119]
    v_mfma_f32_16x16x32_bf16 v[120:123], a[96:99], v[96:99], v[120:123]
    s_waitcnt lgkmcnt(2)
    v_mfma_f32_16x16x32_bf16 v[108:111], a[20:23], v[100:103], v[108:111]
    ds_read_b128 v[92:95], v12 offset:12288
    v_mfma_f32_16x16x32_bf16 v[112:115], a[20:23], v[104:107], v[112:115]
    ds_read_b128 v[96:99], v12 offset:14336
    v_mfma_f32_16x16x32_bf16 v[116:119], a[100:103], v[100:103], v[116:119]
    v_mfma_f32_16x16x32_bf16 v[120:123], a[100:103], v[104:107], v[120:123]
    s_waitcnt lgkmcnt(2)
    v_mfma_f32_16x16x32_bf16 v[108:111], a[24:27], v[84:87], v[108:111]
    ds_read_b128 v[100:103], v11 offset:16384
    v_mfma_f32_16x16x32_bf16 v[112:115], a[24:27], v[88:91], v[112:115]
    ds_read_b128 v[104:107], v11 offset:18432
    v_mfma_f32_16x16x32_bf16 v[116:119], a[104:107], v[84:87], v[116:119]
    v_mfma_f32_16x16x32_bf16 v[120:123], a[104:107], v[88:91], v[120:123]
    s_waitcnt lgkmcnt(2)
    v_mfma_f32_16x16x32_bf16 v[108:111], a[28:31], v[92:95], v[108:111]
    ds_read_b128 v[84:87], v12 offset:16384
    v_mfma_f32_16x16x32_bf16 v[112:115], a[28:31], v[96:99], v[112:115]
    ds_read_b128 v[88:91], v12 offset:18432
    v_mfma_f32_16x16x32_bf16 v[116:119], a[108:111], v[92:95], v[116:119]
    v_mfma_f32_16x16x32_bf16 v[120:123], a[108:111], v[96:99], v[120:123]
    s_waitcnt lgkmcnt(2)
    v_mfma_f32_16x16x32_bf16 v[108:111], a[32:35], v[100:103], v[108:111]
    ds_read_b128 v[92:95], v11 offset:20480
    v_mfma_f32_16x16x32_bf16 v[112:115], a[32:35], v[104:107], v[112:115]
    ds_read_b128 v[96:99], v11 offset:22528
    v_mfma_f32_16x16x32_bf16 v[116:119], a[112:115], v[100:103], v[116:119]
    v_mfma_f32_16x16x32_bf16 v[120:123], a[112:115], v[104:107], v[120:123]
    s_waitcnt lgkmcnt(2)
    v_mfma_f32_16x16x32_bf16 v[108:111], a[36:39], v[84:87], v[108:111]
    ds_read_b128 v[100:103], v12 offset:20480
    v_mfma_f32_16x16x32_bf16 v[112:115], a[36:39], v[88:91], v[112:115]
    ds_read_b128 v[104:107], v12 offset:22528
    v_mfma_f32_16x16x32_bf16 v[116:119], a[116:119], v[84:87], v[116:119]
    v_mfma_f32_16x16x32_bf16 v[120:123], a[116:119], v[88:91], v[120:123]
    s_waitcnt lgkmcnt(2)
    v_mfma_f32_16x16x32_bf16 v[108:111], a[40:43], v[92:95], v[108:111]
    ds_read_b128 v[84:87], v11 offset:24576
    v_mfma_f32_16x16x32_bf16 v[112:115], a[40:43], v[96:99], v[112:115]
    ds_read_b128 v[88:91], v11 offset:26624
    v_mfma_f32_16x16x32_bf16 v[116:119], a[120:123], v[92:95], v[116:119]
    v_mfma_f32_16x16x32_bf16 v[120:123], a[120:123], v[96:99], v[120:123]
    s_waitcnt lgkmcnt(2)
    v_mfma_f32_16x16x32_bf16 v[108:111], a[44:47], v[100:103], v[108:111]
    ds_read_b128 v[92:95], v12 offset:24576
    v_mfma_f32_16x16x32_bf16 v[112:115], a[44:47], v[104:107], v[112:115]
    ds_read_b128 v[96:99], v12 offset:26624
    v_mfma_f32_16x16x32_bf16 v[116:119], a[124:127], v[100:103], v[116:119]
    v_mfma_f32_16x16x32_bf16 v[120:123], a[124:127], v[104:107], v[120:123]
    s_waitcnt lgkmcnt(2)
    v_mfma_f32_16x16x32_bf16 v[108:111], a[48:51], v[84:87], v[108:111]
    ds_read_b128 v[100:103], v11 offset:28672
    v_mfma_f32_16x16x32_bf16 v[112:115], a[48:51], v[88:91], v[112:115]
    ds_read_b128 v[104:107], v11 offset:30720
    v_mfma_f32_16x16x32_bf16 v[116:119], a[128:131], v[84:87], v[116:119]
    v_mfma_f32_16x16x32_bf16 v[120:123], a[128:131], v[88:91], v[120:123]
    s_waitcnt lgkmcnt(2)
    v_mfma_f32_16x16x32_bf16 v[108:111], a[52:55], v[92:95], v[108:111]
    ds_read_b128 v[84:87], v12 offset:28672
    v_mfma_f32_16x16x32_bf16 v[112:115], a[52:55], v[96:99], v[112:115]
    ds_read_b128 v[88:91], v12 offset:30720
    v_mfma_f32_16x16x32_bf16 v[116:119], a[132:135], v[92:95], v[116:119]
    v_mfma_f32_16x16x32_bf16 v[120:123], a[132:135], v[96:99], v[120:123]
    s_waitcnt lgkmcnt(2)
    v_mfma_f32_16x16x32_bf16 v[108:111], a[56:59], v[100:103], v[108:111]
    ds_read_b128 v[92:95], v11 offset:32768
    v_mfma_f32_16x16x32_bf16 v[112:115], a[56:59], v[104:107], v[112:115]
    ds_read_b128 v[96:99], v11 offset:34816
    v_mfma_f32_16x16x32_bf16 v[116:119], a[136:139], v[100:103], v[116:119]
    v_mfma_f32_16x16x32_bf16 v[120:123], a[136:139], v[104:107], v[120:123]
    s_waitcnt lgkmcnt(2)
    v_mfma_f32_16x16x32_bf16 v[108:111], a[60:63], v[84:87], v[108:111]
    ds_read_b128 v[100:103], v12 offset:32768
    v_mfma_f32_16x16x32_bf16 v[112:115], a[60:63], v[88:91], v[112:115]
    ds_read_b128 v[104:107], v12 offset:34816
    v_mfma_f32_16x16x32_bf16 v[116:119], a[140:143], v[84:87], v[116:119]
    v_mfma_f32_16x16x32_bf16 v[120:123], a[140:143], v[88:91], v[120:123]
    s_waitcnt lgkmcnt(2)
    v_mfma_f32_16x16x32_bf16 v[108:111], a[64:67], v[92:95], v[108:111]
    ds_read_b128 v[84:87], v11 offset:36864
    v_mfma_f32_16x16x32_bf16 v[112:115], a[64:67], v[96:99], v[112:115]
    ds_read_b128 v[88:91], v11 offset:38912
    v_mfma_f32_16x16x32_bf16 v[116:119], a[144:147], v[92:95], v[116:119]
    v_mfma_f32_16x16x32_bf16 v[120:123], a[144:147], v[96:99], v[120:123]
    s_waitcnt lgkmcnt(2)
    v_mfma_f32_16x16x32_bf16 v[108:111], a[68:71], v[100:103], v[108:111]
    ds_read_b128 v[92:95], v12 offset:36864
    v_mfma_f32_16x16x32_bf16 v[112:115], a[68:71], v[104:107], v[112:115]
    ds_read_b128 v[96:99], v12 offset:38912
    v_mfma_f32_16x16x32_bf16 v[116:119], a[148:151], v[100:103], v[116:119]
    v_mfma_f32_16x16x32_bf16 v[120:123], a[148:151], v[104:107], v[120:123]
    s_waitcnt lgkmcnt(0)
    v_mfma_f32_16x16x32_bf16 v[108:111], a[72:75], v[84:87], v[108:111]
    v_add_u32 v11, s49, v11
    v_mfma_f32_16x16x32_bf16 v[112:115], a[72:75], v[88:91], v[112:115]
    v_add_u32 v12, s49, v12
    v_mfma_f32_16x16x32_bf16 v[108:111], a[76:79], v[92:95], v[108:111]
    s_sub_u32 s47, s47, s49
    v_mfma_f32_16x16x32_bf16 v[112:115], a[76:79], v[96:99], v[112:115]
    s_sub_u32 s49, 0, s49
    v_mfma_f32_16x16x32_bf16 v[116:119], a[152:155], v[84:87], v[116:119]
    v_mfma_f32_16x16x32_bf16 v[120:123], a[152:155], v[88:91], v[120:123]
    v_mfma_f32_16x16x32_bf16 v[116:119], a[156:159], v[92:95], v[116:119]
    v_mfma_f32_16x16x32_bf16 v[120:123], a[156:159], v[96:99], v[120:123]
    v_cvt_pk_bf16_f32 v124, v108, v109
    v_cvt_pk_bf16_f32 v125, v110, v111
    v_cvt_pk_bf16_f32 v126, v112, v113
    v_cvt_pk_bf16_f32 v127, v114, v115
    s_nop 0
    v_permlane16_swap_b32 v124, v126
    v_permlane16_swap_b32 v125, v127
    v_cvt_pk_bf16_f32 v128, v116, v117
    v_cvt_pk_bf16_f32 v129, v118, v119
    v_cvt_pk_bf16_f32 v130, v120, v121
    v_cvt_pk_bf16_f32 v131, v122, v123
    s_nop 0
    v_permlane16_swap_b32 v128, v130
    v_permlane16_swap_b32 v129, v131
    buffer_store_dwordx4 v[124:127], v19, s[4:7], s44 offen sc1
    buffer_store_dwordx4 v[128:131], v19, s[4:7], s45 offen sc1
    v_mov_b32 v1, 196
L_gw_69:
    buffer_load_dword v2, v1, s[8:11], 0 offen sc1
    s_sub_u32 s36, s36, 1
    s_cbranch_scc1 L_exit
    s_waitcnt vmcnt(0)
    v_readfirstlane_b32 s90, v2
    s_nop 0
    s_cmp_eq_u32 s90, 0
    s_cbranch_scc1 L_gw_69
    s_waitcnt vmcnt(0) lgkmcnt(0)
    v_mov_b32 v20, 1
    buffer_store_dword v20, v136, s[4:7], s38 offen sc1
    s_barrier
    s_add_u32 s44, s38, 180224
    s_add_u32 s45, s44, s56
    s_mov_b32 s46, 81920
    ds_read_b128 v[84:87], v11 offset:0
    ds_read_b128 v[88:91], v11 offset:2048
    ds_read_b128 v[92:95], v12 offset:0
    ds_read_b128 v[96:99], v12 offset:2048
    s_lshl_b32 s90, s32, 10
    s_add_u32 m0, s90, s47
    s_waitcnt lgkmcnt(2)
    v_mfma_f32_16x16x32_bf16 v[108:111], a[0:3], v[84:87], 0
    ds_read_b128 v[100:103], v11 offset:4096
    v_mfma_f32_16x16x32_bf16 v[112:115], a[0:3], v[88:91], 0
    ds_read_b128 v[104:107], v11 offset:6144
    v_mfma_f32_16x16x32_bf16 v[116:119], a[80:83], v[84:87], 0
    buffer_load_dwordx4 v10, s[24:27], s46 offen offset:0 lds
    s_add_u32 m0, m0, 3968
    v_mfma_f32_16x16x32_bf16 v[120:123], a[80:83], v[88:91], 0
    s_waitcnt lgkmcnt(2)
    v_mfma_f32_16x16x32_bf16 v[108:111], a[4:7], v[92:95], v[108:111]
    ds_read_b128 v[84:87], v12 offset:4096
    v_mfma_f32_16x16x32_bf16 v[112:115], a[4:7], v[96:99], v[112:115]
    ds_read_b128 v[88:91], v12 offset:6144
    v_mfma_f32_16x16x32_bf16 v[116:119], a[84:87], v[92:95], v[116:119]
    buffer_load_dwordx4 v10, s[24:27], s46 offen offset:128 lds
    s_add_u32 m0, m0, 3968
    v_mfma_f32_16x16x32_bf16 v[120:123], a[84:87], v[96:99], v[120:123]
    s_waitcnt lgkmcnt(2)
    v_mfma_f32_16x16x32_bf16 v[108:111], a[8:11], v[100:103], v[108:111]
    ds_read_b128 v[92:95], v11 offset:8192
    v_mfma_f32_16x16x32_bf16 v[112:115], a[8:11], v[104:107], v[112:115]
    ds_read_b128 v[96:99], v11 offset:10240
    v_mfma_f32_16x16x32_bf16 v[116:119], a[88:91], v[100:103], v[116:119]
    buffer_load_dwordx4 v10, s[24:27], s46 offen offset:256 lds
    s_add_u32 m0, m0, 3968
    v_mfma_f32_16x16x32_bf16 v[120:123], a[88:91], v[104:107], v[120:123]
    s_waitcnt lgkmcnt(2)
    v_mfma_f32_16x16x32_bf16 v[108:111], a[12:15], v[84:87], v[108:111]
    ds_read_b128 v[100:103], v12 offset:8192
    v_mfma_f32_16x16x32_bf16 v[112:115], a[12:15], v[88:91], v[112:115]
    ds_read_b128 v[104:107], v12 offset:10240
    v_mfma_f32_16x16x32_bf16 v[116:119], a[92:95], v[84:87], v[116:119]
    buffer_load_dwordx4 v10, s[24:27], s46 offen offset:384 lds
    s_add_u32 m0, m0, 3968
    v_mfma_f32_16x16x32_bf16 v[120:123], a[92:95], v[88:91], v[120:123]
    s_waitcnt lgkmcnt(2)
    v_mfma_f32_16x16x32_bf16 v[108:111], a[16:19], v[92:95], v[108:111]
    ds_read_b128 v[84:87], v11 offset:12288
    v_mfma_f32_16x16x32_bf16 v[112:115], a[16:19], v[96:99], v[112:115]
    ds_read_b128 v[88:91], v11 offset:14336
    v_mfma_f32_16x16x32_bf16 v[116:119], a[96:99], v[92:95], v[116:119]
    buffer_load_dwordx4 v10, s[24:27], s46 offen offset:512 lds
    s_add_u32 m0, m0, 3968
    v_mfma_f32_16x16x32_bf16 v[120:123], a[96:99], v[96:99], v[120:123]
    s_waitcnt lgkmcnt(2)
    v_mfma_f32_16x16x32_bf16 v[108:111], a[20:23], v[100:103], v[108:111]
    ds_read_b128 v[92:95], v12 offset:12288
    v_mfma_f32_16x16x32_bf16 v[112:115], a[20:23], v[104:107], v[112:115]
    ds_read_b128 v[96:99], v12 offset:14336
    v_mfma_f32_16x16x32_bf16 v[116:119], a[100:103], v[100:103], v[116:119]
    buffer_load_dwordx4 v10, s[24:27], s46 offen offset:640 lds
    s_add_u32 m0, m0, 3968
    v_mfma_f32_16x16x32_bf16 v[120:123], a[100:103], v[104:107], v[120:123]
    s_waitcnt lgkmcnt(2)
    v_mfma_f32_16x16x32_bf16 v[108:111], a[24:27], v[84:87], v[108:111]
    ds_read_b128 v[100:103], v11 offset:16384
    v_mfma_f32_16x16x32_bf16 v[112:115], a[24:27], v[88:91], v[112:115]
    ds_read_b128 v[104:107], v11 offset:18432
    v_mfma_f32_16x16x32_bf16 v[116:119], a[104:107], v[84:87], v[116:119]
    buffer_load_dwordx4 v10, s[24:27], s46 offen offset:768 lds
    s_add_u32 m0, m0, 3968
    v_mfma_f32_16x16x32_bf16 v[120:123], a[104:107], v[88:91], v[120:123]
    s_waitcnt lgkmcnt(2)
    v_mfma_f32_16x16x32_bf16 v[108:111], a[28:31], v[92:95], v[108:111]
    ds_read_b128 v[84:87], v12 offset:16384
    v_mfma_f32_16x16x32_bf16 v[112:115], a[28:31], v[96:99], v[112:115]
    ds_read_b128 v[88:91], v12 offset:18432
    v_mfma_f32_16x16x32_bf16 v[116:119], a[108:111], v[92:95], v[116:119]
    buffer_load_dwordx4 v10, s[24:27], s46 offen offset:896 lds
    s_add_u32 m0, m0, 3968
    v_mfma_f32_16x16x32_bf16 v[120:123], a[108:111], v[96:99], v[120:123]
    s_waitcnt lgkmcnt(2)
    v_mfma_f32_16x16x32_bf16 v[108:111], a[32:35], v[100:103], v[108:111]
    ds_read_b128 v[92:95], v11 offset:20480
    v_mfma_f32_16x16x32_bf16 v[112:115], a[32:35], v[104:107], v[112:115]
    ds_read_b128 v[96:99], v11 offset:22528
    v_mfma_f32_16x16x32_bf16 v[116:119], a[112:115], v[100:103], v[116:119]
    buffer_load_dwordx4 v10, s[24:27], s46 offen offset:1024 lds
    s_add_u32 m0, m0, 3968
    v_mfma_f32_16x16x32_bf16 v[120:123], a[112:115], v[104:107], v[120:123]
    s_waitcnt lgkmcnt(2)
    v_mfma_f32_16x16x32_bf16 v[108:111], a[36:39], v[84:87], v[108:111]
    ds_read_b128 v[100:103], v12 offset:20480
    v_mfma_f32_16x16x32_bf16 v[112:115], a[36:39], v[88:91], v[112:115]
    ds_read_b128 v[104:107], v12 offset:22528
    v_mfma_f32_16x16x32_bf16 v[116:119], a[116:119], v[84:87], v[116:119]
    buffer_load_dwordx4 v10, s[24:27], s46 offen offset:1152 lds
    v_mfma_f32_16x16x32_bf16 v[120:123], a[116:119], v[88:91], v[120:123]
    s_waitcnt lgkmcnt(2)
    v_mfma_f32_16x16x32_bf16 v[108:111], a[40:43], v[92:95], v[108:111]
    ds_read_b128 v[84:87], v11 offset:24576
    v_mfma_f32_16x16x32_bf16 v[112:115], a[40:43], v[96:99], v[112:115]
    ds_read_b128 v[88:91], v11 offset:26624
    v_mfma_f32_16x16x32_bf16 v[116:119], a[120:123], v[92:95], v[116:119]
    v_mfma_f32_16x16x32_bf16 v[120:123], a[120:123], v[96:99], v[120:123]
    s_waitcnt lgkmcnt(2)
    v_mfma_f32_16x16x32_bf16 v[108:111], a[44:47], v[100:103], v[108:111]
    ds_read_b128 v[92:95], v12 offset:24576
    v_mfma_f32_16x16x32_bf16 v[112:115], a[44:47], v[104:107], v[112:115]
    ds_read_b128 v[96:99], v12 offset:26624
    v_mfma_f32_16x16x32_bf16 v[116:119], a[124:127], v[100:103], v[116:119]
    v_mfma_f32_16x16x32_bf16 v[120:123], a[124:127], v[104:107], v[120:123]
    s_waitcnt lgkmcnt(2)
    v_mfma_f32_16x16x32_bf16 v[108:111], a[48:51], v[84:87], v[108:111]
    ds_read_b128 v[100:103], v11 offset:28672
    v_mfma_f32_16x16x32_bf16 v[112:115], a[48:51], v[88:91], v[112:115]
    ds_read_b128 v[104:107], v11 offset:30720
    v_mfma_f32_16x16x32_bf16 v[116:119], a[128:131], v[84:87], v[116:119]
    v_mfma_f32_16x16x32_bf16 v[120:123], a[128:131], v[88:91], v[120:123]
    s_waitcnt lgkmcnt(2)
    v_mfma_f32_16x16x32_bf16 v[108:111], a[52:55], v[92:95], v[108:111]
    ds_read_b128 v[84:87], v12 offset:28672
    v_mfma_f32_16x16x32_bf16 v[112:115], a[52:55], v[96:99], v[112:115]
    ds_read_b128 v[88:91], v12 offset:30720
    v_mfma_f32_16x16x32_bf16 v[116:119], a[132:135], v[92:95], v[116:119]
    v_mfma_f32_16x16x32_bf16 v[120:123], a[132:135], v[96:99], v[120:123]
    s_waitcnt lgkmcnt(2)
    v_mfma_f32_16x16x32_bf16 v[108:111], a[56:59], v[100:103], v[108:111]
    ds_read_b128 v[92:95], v11 offset:32768
    v_mfma_f32_16x16x32_bf16 v[112:115], a[56:59], v[104:107], v[112:115]
    ds_read_b128 v[96:99], v11 offset:34816
    v_mfma_f32_16x16x32_bf16 v[116:119], a[136:139], v[100:103], v[116:119]
    v_mfma_f32_16x16x32_bf16 v[120:123], a[136:139], v[104:107], v[120:123]
    s_waitcnt lgkmcnt(2)
    v_mfma_f32_16x16x32_bf16 v[108:111], a[60:63], v[84:87], v[108:111]
    ds_read_b128 v[100:103], v12 offset:32768
    v_mfma_f32_16x16x32_bf16 v[112:115], a[60:63], v[88:91], v[112:115]
    ds_read_b128 v[104:107], v12 offset:34816
    v_mfma_f32_16x16x32_bf16 v[116:119], a[140:143], v[84:87], v[116:119]
    v_mfma_f32_16x16x32_bf16 v[120:123], a[140:143], v[88:91], v[120:123]
    s_waitcnt lgkmcnt(2)
    v_mfma_f32_16x16x32_bf16 v[108:111], a[64:67], v[92:95], v[108:111]
    ds_read_b128 v[84:87], v11 offset:36864
    v_mfma_f32_16x16x32_bf16 v[112:115], a[64:67], v[96:99], v[112:115]
    ds_read_b128 v[88:91], v11 offset:38912
    v_mfma_f32_16x16x32_bf16 v[116:119], a[144:147], v[92:95], v[116:119]
    v_mfma_f32_16x16x32_bf16 v[120:123], a[144:147], v[96:99], v[120:123]
    s_waitcnt lgkmcnt(2)
    v_mfma_f32_16x16x32_bf16 v[108:111], a[68:71], v[100:103], v[108:111]
    ds_read_b128 v[92:95], v12 offset:36864
    v_mfma_f32_16x16x32_bf16 v[112:115], a[68:71], v[104:107], v[112:115]
    ds_read_b128 v[96:99], v12 offset:38912
    v_mfma_f32_16x16x32_bf16 v[116:119], a[148:151], v[100:103], v[116:119]
    v_mfma_f32_16x16x32_bf16 v[120:123], a[148:151], v[104:107], v[120:123]
    s_waitcnt lgkmcnt(0)
    v_mfma_f32_16x16x32_bf16 v[108:111], a[72:75], v[84:87], v[108:111]
    v_add_u32 v11, s49, v11
    v_mfma_f32_16x16x32_bf16 v[112:115], a[72:75], v[88:91], v[112:115]
    v_add_u32 v12, s49, v12
    v_mfma_f32_16x16x32_bf16 v[108:111], a[76:79], v[92:95], v[108:111]
    s_sub_u32 s47, s47, s49
    v_mfma_f32_16x16x32_bf16 v[112:115], a[76:79], v[96:99], v[112:115]
    s_sub_u32 s49, 0, s49
    v_mfma_f32_16x16x32_bf16 v[116:119], a[152:155], v[84:87], v[116:119]
    v_mfma_f32_16x16x32_bf16 v[120:123], a[152:155], v[88:91], v[120:123]
    v_mfma_f32_16x16x32_bf16 v[116:119], a[156:159], v[92:95], v[116:119]
    v_mfma_f32_16x16x32_bf16 v[120:123], a[156:159], v[96:99], v[120:123]
    v_cvt_pk_bf16_f32 v124, v108, v109
    v_cvt_pk_bf16_f32 v125, v110, v111
    v_cvt_pk_bf16_f32 v126, v112, v113
    v_cvt_pk_bf16_f32 v127, v114, v115
    s_nop 0
    v_permlane16_swap_b32 v124, v126
    v_permlane16_swap_b32 v125, v127
    v_cvt_pk_bf16_f32 v128, v116, v117
    v_cvt_pk_bf16_f32 v129, v118, v119
    v_cvt_pk_bf16_f32 v130, v120, v121
    v_cvt_pk_bf16_f32 v131, v122, v123
    s_nop 0
    v_permlane16_swap_b32 v128, v130
    v_permlane16_swap_b32 v129, v131
    buffer_store_dwordx4 v[124:127], v19, s[4:7], s44 offen sc1
    buffer_store_dwordx4 v[128:131], v19, s[4:7], s45 offen sc1
    s_waitcnt vmcnt(0) lgkmcnt(0)
    v_mov_b32 v20, 2
    buffer_store_dword v20, v136, s[4:7], s38 offen sc1
    s_barrier
    s_add_u32 s44, s38, 294912
    s_add_u32 s45, s44, s56
    s_mov_b32 s46, 122880
    ds_read_b128 v[84:87], v11 offset:0
    ds_read_b128 v[88:91], v11 offset:2048
    ds_read_b128 v[92:95], v12 offset:0
    ds_read_b128 v[96:99], v12 offset:2048
    s_lshl_b32 s90, s32, 10
    s_add_u32 m0, s90, s47
    s_waitcnt lgkmcnt(2)
    v_mfma_f32_16x16x32_bf16 v[108:111], a[0:3], v[84:87], 0
    ds_read_b128 v[100:103], v11 offset:4096
    s_add_u32 s51, s37, 3
    v_mfma_f32_16x16x32_bf16 v[112:115], a[0:3], v[88:91], 0
    ds_read_b128 v[104:107], v11 offset:6144
    s_and_b32 s50, s51, 3
    v_mfma_f32_16x16x32_bf16 v[116:119], a[80:83], v[84:87], 0
    buffer_load_dwordx4 v10, s[24:27], s46 offen offset:0 lds
    s_add_u32 m0, m0, 3968
    v_mfma_f32_16x16x32_bf16 v[120:123], a[80:83], v[88:91], 0
    s_waitcnt lgkmcnt(2)
    s_mul_i32 s50, s50, 114688
    v_mfma_f32_16x16x32_bf16 v[108:111], a[4:7], v[92:95], v[108:111]
    ds_read_b128 v[84:87], v12 offset:4096
    s_add_u32 s50, s50, 65536
    v_mfma_f32_16x16x32_bf16 v[112:115], a[4:7], v[96:99], v[112:115]
    ds_read_b128 v[88:91], v12 offset:6144
    s_add_u32 s44, s38, s50
    v_mfma_f32_16x16x32_bf16 v[116:119], a[84:87], v[92:95], v[116:119]
    buffer_load_dwordx4 v10, s[24:27], s46 offen offset:128 lds
    s_add_u32 m0, m0, 3968
    v_mfma_f32_16x16x32_bf16 v[120:123], a[84:87], v[96:99], v[120:123]
    s_waitcnt lgkmcnt(2)
    s_add_u32 s45, s44, s56
    v_mfma_f32_16x16x32_bf16 v[108:111], a[8:11], v[100:103], v[108:111]
    ds_read_b128 v[92:95], v11 offset:8192
    s_add_u32 s37, s37, 1
    v_mfma_f32_16x16x32_bf16 v[112:115], a[8:11], v[104:107], v[112:115]
    ds_read_b128 v[96:99], v11 offset:10240
    s_mov_b32 s52, 0
    v_mfma_f32_16x16x32_bf16 v[116:119], a[88:91], v[100:103], v[116:119]
    buffer_load_dwordx4 v10, s[24:27], s46 offen offset:256 lds
    s_add_u32 m0, m0, 3968
    v_mfma_f32_16x16x32_bf16 v[120:123], a[88:91], v[104:107], v[120:123]
    s_waitcnt lgkmcnt(2)
    s_and_b32 s50, s37, 3
    v_mfma_f32_16x16x32_bf16 v[108:111], a[12:15], v[84:87], v[108:111]
    ds_read_b128 v[100:103], v12 offset:8192
    s_mul_i32 s51, s50, 114688
    v_mfma_f32_16x16x32_bf16 v[112:115], a[12:15], v[88:91], v[112:115]
    ds_read_b128 v[104:107], v12 offset:10240
    s_add_u32 s41, s38, s51
    v_mfma_f32_16x16x32_bf16 v[116:119], a[92:95], v[84:87], v[116:119]
    buffer_load_dwordx4 v10, s[24:27], s46 offen offset:384 lds
    s_add_u32 m0, m0, 3968
    v_mfma_f32_16x16x32_bf16 v[120:123], a[92:95], v[88:91], v[120:123]
    s_waitcnt lgkmcnt(2)
    s_xor_b32 s51, s50, 2
    v_mfma_f32_16x16x32_bf16 v[108:111], a[16:19], v[92:95], v[108:111]
    ds_read_b128 v[84:87], v11 offset:12288
    s_mul_i32 s51, s51, 114688
    v_mfma_f32_16x16x32_bf16 v[112:115], a[16:19], v[96:99], v[112:115]
    ds_read_b128 v[88:91], v11 offset:14336
    s_add_u32 s42, s38, s51
    v_mfma_f32_16x16x32_bf16 v[116:119], a[96:99], v[92:95], v[116:119]
    buffer_load_dwordx4 v10, s[24:27], s46 offen offset:512 lds
    s_add_u32 m0, m0, 3968
    v_mfma_f32_16x16x32_bf16 v[120:123], a[96:99], v[96:99], v[120:123]
    s_waitcnt lgkmcnt(2)
    v_mfma_f32_16x16x32_bf16 v[108:111], a[20:23], v[100:103], v[108:111]
    ds_read_b128 v[92:95], v12 offset:12288
    v_mfma_f32_16x16x32_bf16 v[112:115], a[20:23], v[104:107], v[112:115]
    ds_read_b128 v[96:99], v12 offset:14336
    v_mfma_f32_16x16x32_bf16 v[116:119], a[100:103], v[100:103], v[116:119]
    buffer_load_dwordx4 v10, s[24:27], s46 offen offset:640 lds
    s_add_u32 m0, m0, 3968
    v_mfma_f32_16x16x32_bf16 v[120:123], a[100:103], v[104:107], v[120:123]
    s_waitcnt lgkmcnt(2)
    v_mfma_f32_16x16x32_bf16 v[108:111], a[24:27], v[84:87], v[108:111]
    ds_read_b128 v[100:103], v11 offset:16384
    v_mfma_f32_16x16x32_bf16 v[112:115], a[24:27], v[88:91], v[112:115]
    ds_read_b128 v[104:107], v11 offset:18432
    v_mfma_f32_16x16x32_bf16 v[116:119], a[104:107], v[84:87], v[116:119]
    buffer_load_dwordx4 v10, s[24:27], s46 offen offset:768 lds
    s_add_u32 m0, m0, 3968
    v_mfma_f32_16x16x32_bf16 v[120:123], a[104:107], v[88:91], v[120:123]
    s_waitcnt lgkmcnt(2)
    v_mfma_f32_16x16x32_bf16 v[108:111], a[28:31], v[92:95], v[108:111]
    ds_read_b128 v[84:87], v12 offset:16384
    v_mfma_f32_16x16x32_bf16 v[112:115], a[28:31], v[96:99], v[112:115]
    ds_read_b128 v[88:91], v12 offset:18432
    v_mfma_f32_16x16x32_bf16 v[116:119], a[108:111], v[92:95], v[116:119]
    buffer_load_dwordx4 v10, s[24:27], s46 offen offset:896 lds
    s_add_u32 m0, m0, 3968
    v_mfma_f32_16x16x32_bf16 v[120:123], a[108:111], v[96:99], v[120:123]
    s_waitcnt lgkmcnt(2)
    v_mfma_f32_16x16x32_bf16 v[108:111], a[32:35], v[100:103], v[108:111]
    ds_read_b128 v[92:95], v11 offset:20480
    v_mfma_f32_16x16x32_bf16 v[112:115], a[32:35], v[104:107], v[112:115]
    ds_read_b128 v[96:99], v11 offset:22528
    v_mfma_f32_16x16x32_bf16 v[116:119], a[112:115], v[100:103], v[116:119]
    buffer_load_dwordx4 v10, s[24:27], s46 offen offset:1024 lds
    s_add_u32 m0, m0, 3968
    v_mfma_f32_16x16x32_bf16 v[120:123], a[112:115], v[104:107], v[120:123]
    s_waitcnt lgkmcnt(2)
    v_mfma_f32_16x16x32_bf16 v[108:111], a[36:39], v[84:87], v[108:111]
    ds_read_b128 v[100:103], v12 offset:20480
    v_mfma_f32_16x16x32_bf16 v[112:115], a[36:39], v[88:91], v[112:115]
    ds_read_b128 v[104:107], v12 offset:22528
    v_mfma_f32_16x16x32_bf16 v[116:119], a[116:119], v[84:87], v[116:119]
    buffer_load_dwordx4 v10, s[24:27], s46 offen offset:1152 lds
    v_mfma_f32_16x16x32_bf16 v[120:123], a[116:119], v[88:91], v[120:123]
    s_waitcnt lgkmcnt(2)
    v_mfma_f32_16x16x32_bf16 v[108:111], a[40:43], v[92:95], v[108:111]
    ds_read_b128 v[84:87], v11 offset:24576
    v_mfma_f32_16x16x32_bf16 v[112:115], a[40:43], v[96:99], v[112:115]
    ds_read_b128 v[88:91], v11 offset:26624
    v_mfma_f32_16x16x32_bf16 v[116:119], a[120:123], v[92:95], v[116:119]
    v_mfma_f32_16x16x32_bf16 v[120:123], a[120:123], v[96:99], v[120:123]
    s_waitcnt lgkmcnt(2)
    v_mfma_f32_16x16x32_bf16 v[108:111], a[44:47], v[100:103], v[108:111]
    ds_read_b128 v[92:95], v12 offset:24576
    v_mfma_f32_16x16x32_bf16 v[112:115], a[44:47], v[104:107], v[112:115]
    ds_read_b128 v[96:99], v12 offset:26624
    v_mfma_f32_16x16x32_bf16 v[116:119], a[124:127], v[100:103], v[116:119]
    v_mfma_f32_16x16x32_bf16 v[120:123], a[124:127], v[104:107], v[120:123]
    s_waitcnt lgkmcnt(2)
    v_mfma_f32_16x16x32_bf16 v[108:111], a[48:51], v[84:87], v[108:111]
    ds_read_b128 v[100:103], v11 offset:28672
    v_mfma_f32_16x16x32_bf16 v[112:115], a[48:51], v[88:91], v[112:115]
    ds_read_b128 v[104:107], v11 offset:30720
    v_mfma_f32_16x16x32_bf16 v[116:119], a[128:131], v[84:87], v[116:119]
    v_mfma_f32_16x16x32_bf16 v[120:123], a[128:131], v[88:91], v[120:123]
    s_waitcnt lgkmcnt(2)
    v_mfma_f32_16x16x32_bf16 v[108:111], a[52:55], v[92:95], v[108:111]
    ds_read_b128 v[84:87], v12 offset:28672
    v_mfma_f32_16x16x32_bf16 v[112:115], a[52:55], v[96:99], v[112:115]
    ds_read_b128 v[88:91], v12 offset:30720
    v_mfma_f32_16x16x32_bf16 v[116:119], a[132:135], v[92:95], v[116:119]
    v_mfma_f32_16x16x32_bf16 v[120:123], a[132:135], v[96:99], v[120:123]
    s_waitcnt lgkmcnt(2)
    v_mfma_f32_16x16x32_bf16 v[108:111], a[56:59], v[100:103], v[108:111]
    ds_read_b128 v[92:95], v11 offset:32768
    v_mfma_f32_16x16x32_bf16 v[112:115], a[56:59], v[104:107], v[112:115]
    ds_read_b128 v[96:99], v11 offset:34816
    v_mfma_f32_16x16x32_bf16 v[116:119], a[136:139], v[100:103], v[116:119]
    v_mfma_f32_16x16x32_bf16 v[120:123], a[136:139], v[104:107], v[120:123]
    s_waitcnt lgkmcnt(2)
    v_mfma_f32_16x16x32_bf16 v[108:111], a[60:63], v[84:87], v[108:111]
    ds_read_b128 v[100:103], v12 offset:32768
    v_mfma_f32_16x16x32_bf16 v[112:115], a[60:63], v[88:91], v[112:115]
    ds_read_b128 v[104:107], v12 offset:34816
    v_mfma_f32_16x16x32_bf16 v[116:119], a[140:143], v[84:87], v[116:119]
    v_mfma_f32_16x16x32_bf16 v[120:123], a[140:143], v[88:91], v[120:123]
    s_waitcnt lgkmcnt(2)
    v_mfma_f32_16x16x32_bf16 v[108:111], a[64:67], v[92:95], v[108:111]
    ds_read_b128 v[84:87], v11 offset:36864
    v_mfma_f32_16x16x32_bf16 v[112:115], a[64:67], v[96:99], v[112:115]
    ds_read_b128 v[88:91], v11 offset:38912
    v_mfma_f32_16x16x32_bf16 v[116:119], a[144:147], v[92:95], v[116:119]
    v_mfma_f32_16x16x32_bf16 v[120:123], a[144:147], v[96:99], v[120:123]
    s_waitcnt lgkmcnt(2)
    v_mfma_f32_16x16x32_bf16 v[108:111], a[68:71], v[100:103], v[108:111]
    ds_read_b128 v[92:95], v12 offset:36864
    v_mfma_f32_16x16x32_bf16 v[112:115], a[68:71], v[104:107], v[112:115]
    ds_read_b128 v[96:99], v12 offset:38912
    v_mfma_f32_16x16x32_bf16 v[116:119], a[148:151], v[100:103], v[116:119]
    v_mfma_f32_16x16x32_bf16 v[120:123], a[148:151], v[104:107], v[120:123]
    s_waitcnt lgkmcnt(0)
    v_mfma_f32_16x16x32_bf16 v[108:111], a[72:75], v[84:87], v[108:111]
    v_add_u32 v11, s49, v11
    v_mfma_f32_16x16x32_bf16 v[112:115], a[72:75], v[88:91], v[112:115]
    v_add_u32 v12, s49, v12
    v_mfma_f32_16x16x32_bf16 v[108:111], a[76:79], v[92:95], v[108:111]
    s_sub_u32 s47, s47, s49
    v_mfma_f32_16x16x32_bf16 v[112:115], a[76:79], v[96:99], v[112:115]
    s_sub_u32 s49, 0, s49
    v_mfma_f32_16x16x32_bf16 v[116:119], a[152:155], v[84:87], v[116:119]
    v_mfma_f32_16x16x32_bf16 v[120:123], a[152:155], v[88:91], v[120:123]
    v_mfma_f32_16x16x32_bf16 v[116:119], a[156:159], v[92:95], v[116:119]
    v_mfma_f32_16x16x32_bf16 v[120:123], a[156:159], v[96:99], v[120:123]
    v_cvt_pk_bf16_f32 v124, v108, v109
    v_cvt_pk_bf16_f32 v125, v110, v111
    v_cvt_pk_bf16_f32 v126, v112, v113
    v_cvt_pk_bf16_f32 v127, v114, v115
    s_nop 0
    v_permlane16_swap_b32 v124, v126
    v_permlane16_swap_b32 v125, v127
    v_cvt_pk_bf16_f32 v128, v116, v117
    v_cvt_pk_bf16_f32 v129, v118, v119
    v_cvt_pk_bf16_f32 v130, v120, v121
    v_cvt_pk_bf16_f32 v131, v122, v123
    s_nop 0
    v_permlane16_swap_b32 v128, v130
    v_permlane16_swap_b32 v129, v131
    buffer_store_dwordx4 v[124:127], v19, s[4:7], s44 offen sc1
    buffer_store_dwordx4 v[128:131], v19, s[4:7], s45 offen sc1
    v_mov_b32 v3, 204
L_p0_70:
    buffer_load_dword v4, v3, s[8:11], 0 offen sc1
    s_sub_u32 s36, s36, 1
    s_cbranch_scc1 L_exit
    s_waitcnt vmcnt(0)
    v_readfirstlane_b32 s90, v4
    s_nop 0
    s_cmp_eq_u32 s90, 0
    s_cbranch_scc1 L_p0_70
    s_and_b32 s90, s90, 2
    s_lshl_b32 s90, s90, 12
    v_and_b32 v3, 1, v0
    v_lshlrev_b32 v3, 12, v3
    v_bfe_u32 v5, v0, 2, 1
    v_lshl_add_u32 v3, v5, 13, v3
    v_bfe_u32 v4, v0, 1, 1
    v_lshl_add_u32 v3, v4, 14, v3
    v_xor_b32 v3, s90, v3
    s_lshl_b32 s91, s34, 9
    s_add_u32 s91, s91, 1933312
    s_xor_b32 s55, s32, 3
    s_or_b32 s55, s55, s40
    s_cselect_b32 s91, 2146435072, s91
    v_add_u32 v140, s91, v3
    v_cmp_gt_u32 vcc, 8, v0
    v_mov_b32 v9, 2146435072
    s_nop 0
    v_cndmask_b32 v140, v9, v140, vcc
    v_cmp_ne_u32 vcc, s34, v0
    v_mov_b32 v9, 2146435072
    s_nop 0
    v_cndmask_b32 v140, v9, v140, vcc
    s_lshr_b32 s91, s34, 2
    v_cmp_eq_u32 vcc, s91, v5
    s_nop 1
    v_cndmask_b32 v141, v9, v140, vcc
    v_cndmask_b32 v140, v140, v9, vcc
    v_and_b32 v3, 7, v0
    v_min_u32 v3, 5, v3
    v_bfe_u32 v4, v0, 3, 2
    v_lshlrev_b32 v4, 7, v4
    v_lshl_add_u32 v3, v3, 2, v4
    v_add_u32 v142, 462336, v3
L_v_loop_s:
    s_add_u32 s50, s37, 4
    s_min_u32 s50, s50, 63
    s_mul_i32 s46, s50, 40960
    s_add_u32 s51, s37, 1
    v_mov_b32 v20, s51
    s_mov_b32 m0, s48
    v_mov_b32 v68, 0
    v_mov_b32 v69, 0
    v_mov_b32 v70, 0
    v_mov_b32 v71, 0
    v_mov_b32 v72, 0
    v_mov_b32 v73, 0
    v_mov_b32 v74, 0
    v_mov_b32 v75, 0
    s_add_u32 s50, s37, 6
    s_min_u32 s50, s50, 63
    s_mul_i32 s57, s50, 40960
    buffer_load_dwordx4 v13, s[4:7], s41 offen sc1 lds
    buffer_load_dwordx4 v13, s[4:7], s41 offen offset:1024 sc1 lds
    buffer_load_dword v14, s[4:7], s41 offen offset:2048 sc1 lds
    buffer_load_dword v14, s[4:7], s41 offen offset:2304 sc1 lds
L_poll_72:
    buffer_load_dwordx4 v13, s[4:7], s41 offen sc1 lds
    buffer_load_dwordx4 v13, s[4:7], s41 offen offset:1024 sc1 lds
    buffer_load_dword v14, s[4:7], s41 offen offset:2048 sc1 lds
    buffer_load_dword v14, s[4:7], s41 offen offset:2304 sc1 lds
    s_sub_u32 s36, s36, 1
    s_cbranch_scc1 L_exit
    s_waitcnt vmcnt(4)
    ds_read_b32 v18, v15
    s_waitcnt lgkmcnt(0)
    v_cmp_eq_u32 vcc, -1, v18
    s_cbranch_vccnz L_poll_72
    s_barrier
    ds_read_b128 v[28:31], v16 offset:0
    ds_read_b128 v[32:35], v16 offset:1024
    ds_read_b128 v[36:39], v16 offset:2048
    s_waitcnt lgkmcnt(2)
    v_smfmac_f32_16x16x64_bf16 v[68:71], v[28:31], a[0:7], v17
    ds_read_b128 v[40:43], v16 offset:3072
    v_smfmac_f32_16x16x64_bf16 v[72:75], v[28:31], a[80:87], v17
    ds_read_b128 v[44:47], v16 offset:4096
    s_waitcnt lgkmcnt(3)
    v_smfmac_f32_16x16x64_bf16 v[68:71], v[32:35], a[8:15], v17
    ds_read_b128 v[48:51], v16 offset:5120
    v_smfmac_f32_16x16x64_bf16 v[72:75], v[32:35], a[88:95], v17
    ds_read_b128 v[52:55], v16 offset:6144
    s_waitcnt lgkmcnt(4)
    v_smfmac_f32_16x16x64_bf16 v[68:71], v[36:39], a[16:23], v17
    ds_read_b128 v[56:59], v16 offset:7168
    v_smfmac_f32_16x16x64_bf16 v[72:75], v[36:39], a[96:103], v17
    ds_read_b128 v[60:63], v16 offset:8192
    s_waitcnt lgkmcnt(5)
    v_smfmac_f32_16x16x64_bf16 v[68:71], v[40:43], a[24:31], v17
    ds_read_b128 v[64:67], v16 offset:9216
    v_smfmac_f32_16x16x64_bf16 v[72:75], v[40:43], a[104:111], v17
    s_waitcnt lgkmcnt(5)
    v_smfmac_f32_16x16x64_bf16 v[68:71], v[44:47], a[32:39], v17
    v_smfmac_f32_16x16x64_bf16 v[72:75], v[44:47], a[112:119], v17
    s_waitcnt lgkmcnt(4)
    v_smfmac_f32_16x16x64_bf16 v[68:71], v[48:51], a[40:47], v17
    v_smfmac_f32_16x16x64_bf16 v[72:75], v[48:51], a[120:127], v17
    s_waitcnt lgkmcnt(3)
    v_smfmac_f32_16x16x64_bf16 v[68:71], v[52:55], a[48:55], v17
    s_waitcnt lgkmcnt(2)
    v_smfmac_f32_16x16x64_bf16 v[68:71], v[56:59], a[56:63], v17
    s_waitcnt lgkmcnt(1)
    v_smfmac_f32_16x16x64_bf16 v[68:71], v[60:63], a[64:71], v17
    s_waitcnt lgkmcnt(0)
    v_smfmac_f32_16x16x64_bf16 v[68:71], v[64:67], a[72:79], v17
L_redo_71:
    v_smfmac_f32_16x16x64_bf16 v[72:75], v[52:55], a[128:135], v17
    v_smfmac_f32_16x16x64_bf16 v[72:75], v[56:59], a[136:143], v17
    v_smfmac_f32_16x16x64_bf16 v[72:75], v[60:63], a[144:151], v17
    v_add_f32 v68, v68, v70
    v_add_f32 v69, v69, v71
    v_smfmac_f32_16x16x64_bf16 v[72:75], v[64:67], a[152:159], v17
    v_cmp_u_f32 vcc, v68, v69
    v_cvt_pk_bf16_f32 v132, v68, v69
    s_cbranch_vccnz L_nan_73
L_cont_74:
    s_nop 4
    v_pk_add_f32 v[72:73], v[72:73], v[74:75]
    v_cvt_pk_bf16_f32 v133, v72, v73
    ds_write2st64_b32 v23, v132, v133 offset0:0 offset1:1
    ds_read_b64_tr_b16 v[76:77], v24
    ds_read_b64_tr_b16 v[78:79], v24 offset:128
    buffer_store_dword v20, v21, s[4:7], s38 offen sc1
    s_waitcnt lgkmcnt(0)
    buffer_store_dwordx4 v[76:79], v134, s[4:7], s41 offen sc1
    ds_read_b128 v[84:87], v11 offset:0
    ds_read_b128 v[88:91], v11 offset:2048
    ds_read_b128 v[92:95], v12 offset:0
    ds_read_b128 v[96:99], v12 offset:2048
    s_cmp_eq_u32 s37, 63
    s_cbranch_scc1 L_end_75
    s_cmp_lg_u32 s55, 0
    s_cbranch_scc1 L_an_76x
    buffer_load_dword v139, v142, s[4:7], s38 offen sc1
    buffer_load_dword v139, v142, s[4:7], s38 offen sc1
    buffer_load_dword v139, v142, s[4:7], s38 offen sc1
L_an_76:
    buffer_load_dword v139, v142, s[4:7], s38 offen sc1
    s_sub_u32 s36, s36, 1
    s_cbranch_scc1 L_exit
    s_waitcnt vmcnt(3)
    v_cmp_ge_u32 vcc, s37, v139
    s_cbranch_vccnz L_an_76
L_an_76x:
    s_barrier
    s_lshl_b32 s90, s32, 10
    s_add_u32 m0, s90, s47
    s_waitcnt lgkmcnt(2)
    v_mfma_f32_16x16x32_bf16 v[108:111], a[0:3], v[84:87], 0
    ds_read_b128 v[100:103], v11 offset:4096
    v_mfma_f32_16x16x32_bf16 v[112:115], a[0:3], v[88:91], 0
    ds_read_b128 v[104:107], v11 offset:6144
    v_mfma_f32_16x16x32_bf16 v[116:119], a[80:83], v[84:87], 0
    v_mfma_f32_16x16x32_bf16 v[120:123], a[80:83], v[88:91], 0
    s_waitcnt lgkmcnt(2)
    v_mfma_f32_16x16x32_bf16 v[108:111], a[4:7], v[92:95], v[108:111]
    ds_read_b128 v[84:87], v12 offset:4096
    v_mfma_f32_16x16x32_bf16 v[112:115], a[4:7], v[96:99], v[112:115]
    ds_read_b128 v[88:91], v12 offset:6144
    v_mfma_f32_16x16x32_bf16 v[116:119], a[84:87], v[92:95], v[116:119]
    buffer_store_dword v22, v135, s[4:7], s42 offen offset:0 sc1
    buffer_store_dword v22, v135, s[4:7], s42 offen offset:1024 sc1
    v_mfma_f32_16x16x32_bf16 v[120:123], a[84:87], v[96:99], v[120:123]
    s_waitcnt lgkmcnt(2)
    s_add_u32 s51, s37, 3
    v_mfma_f32_16x16x32_bf16 v[108:111], a[8:11], v[100:103], v[108:111]
    ds_read_b128 v[92:95], v11 offset:8192
    s_and_b32 s50, s51, 3
    v_mfma_f32_16x16x32_bf16 v[112:115], a[8:11], v[104:107], v[112:115]
    ds_read_b128 v[96:99], v11 offset:10240
    s_mul_i32 s50, s50, 114688
    v_mfma_f32_16x16x32_bf16 v[116:119], a[88:91], v[100:103], v[116:119]
    buffer_load_dwordx4 v[248:251], v137, s[24:27], s57 offen offset:0
    v_mfma_f32_16x16x32_bf16 v[120:123], a[88:91], v[104:107], v[120:123]
    s_waitcnt lgkmcnt(2)
    s_add_u32 s50, s50, 65536
    v_mfma_f32_16x16x32_bf16 v[108:111], a[12:15], v[84:87], v[108:111]
    ds_read_b128 v[100:103], v12 offset:8192
    s_add_u32 s44, s38, s50
    v_mfma_f32_16x16x32_bf16 v[112:115], a[12:15], v[88:91], v[112:115]
    ds_read_b128 v[104:107], v12 offset:10240
    s_add_u32 s45, s44, s56
    v_mfma_f32_16x16x32_bf16 v[116:119], a[92:95], v[84:87], v[116:119]
    buffer_load_dwordx4 v[248:251], v137, s[24:27], s57 offen offset:1024
    v_mfma_f32_16x16x32_bf16 v[120:123], a[92:95], v[88:91], v[120:123]
    s_waitcnt lgkmcnt(2)
    s_add_u32 s37, s37, 1
    v_mfma_f32_16x16x32_bf16 v[108:111], a[16:19], v[92:95], v[108:111]
    ds_read_b128 v[84:87], v11 offset:12288
    s_mov_b32 s52, 0
    v_mfma_f32_16x16x32_bf16 v[112:115], a[16:19], v[96:99], v[112:115]
    ds_read_b128 v[88:91], v11 offset:14336
    s_and_b32 s50, s37, 3
    v_mfma_f32_16x16x32_bf16 v[116:119], a[96:99], v[92:95], v[116:119]
    buffer_load_dwordx4 v10, s[24:27], s46 offen offset:0 lds
    s_add_u32 m0, m0, 3968
    v_mfma_f32_16x16x32_bf16 v[120:123], a[96:99], v[96:99], v[120:123]
    s_waitcnt lgkmcnt(2)
    s_mul_i32 s51, s50, 114688
    v_mfma_f32_16x16x32_bf16 v[108:111], a[20:23], v[100:103], v[108:111]
    ds_read_b128 v[92:95], v12 offset:12288
    s_add_u32 s41, s38, s51
    v_mfma_f32_16x16x32_bf16 v[112:115], a[20:23], v[104:107], v[112:115]
    ds_read_b128 v[96:99], v12 offset:14336
    s_xor_b32 s51, s50, 2
    v_mfma_f32_16x16x32_bf16 v[116:119], a[100:103], v[100:103], v[116:119]
    buffer_load_dwordx4 v10, s[24:27], s46 offen offset:128 lds
    s_add_u32 m0, m0, 3968
    v_mfma_f32_16x16x32_bf16 v[120:123], a[100:103], v[104:107], v[120:123]
    s_waitcnt lgkmcnt(2)
    s_mul_i32 s51, s51, 114688
    v_mfma_f32_16x16x32_bf16 v[108:111], a[24:27], v[84:87], v[108:111]
    ds_read_b128 v[100:103], v11 offset:16384
    s_add_u32 s42, s38, s51
    v_mfma_f32_16x16x32_bf16 v[112:115], a[24:27], v[88:91], v[112:115]
    ds_read_b128 v[104:107], v11 offset:18432
    v_mfma_f32_16x16x32_bf16 v[116:119], a[104:107], v[84:87], v[116:119]
    buffer_load_dwordx4 v10, s[24:27], s46 offen offset:256 lds
    s_add_u32 m0, m0, 3968
    v_mfma_f32_16x16x32_bf16 v[120:123], a[104:107], v[88:91], v[120:123]
    s_waitcnt lgkmcnt(2)
    v_mfma_f32_16x16x32_bf16 v[108:111], a[28:31], v[92:95], v[108:111]
    ds_read_b128 v[84:87], v12 offset:16384
    v_mfma_f32_16x16x32_bf16 v[112:115], a[28:31], v[96:99], v[112:115]
    ds_read_b128 v[88:91], v12 offset:18432
    v_mfma_f32_16x16x32_bf16 v[116:119], a[108:111], v[92:95], v[116:119]
    buffer_load_dwordx4 v10, s[24:27], s46 offen offset:384 lds
    s_add_u32 m0, m0, 3968
    v_mfma_f32_16x16x32_bf16 v[120:123], a[108:111], v[96:99], v[120:123]
    s_waitcnt lgkmcnt(2)
    v_mfma_f32_16x16x32_bf16 v[108:111], a[32:35], v[100:103], v[108:111]
    ds_read_b128 v[92:95], v11 offset:20480
    v_mfma_f32_16x16x32_bf16 v[112:115], a[32:35], v[104:107], v[112:115]
    ds_read_b128 v[96:99], v11 offset:22528
    v_mfma_f32_16x16x32_bf16 v[116:119], a[112:115], v[100:103], v[116:119]
    buffer_load_dwordx4 v10, s[24:27], s46 offen offset:512 lds
    s_add_u32 m0, m0, 3968
    v_mfma_f32_16x16x32_bf16 v[120:123], a[112:115], v[104:107], v[120:123]
    buffer_store_dword v20, v140, s[4:7], 0 offen sc1
    buffer_store_dword v20, v141, s[4:7], 0 offen sc1
    s_waitcnt lgkmcnt(2)
    v_mfma_f32_16x16x32_bf16 v[108:111], a[36:39], v[84:87], v[108:111]
    ds_read_b128 v[100:103], v12 offset:20480
    v_mfma_f32_16x16x32_bf16 v[112:115], a[36:39], v[88:91], v[112:115]
    ds_read_b128 v[104:107], v12 offset:22528
    v_mfma_f32_16x16x32_bf16 v[116:119], a[116:119], v[84:87], v[116:119]
    buffer_load_dwordx4 v10, s[24:27], s46 offen offset:640 lds
    s_add_u32 m0, m0, 3968
    v_mfma_f32_16x16x32_bf16 v[120:123], a[116:119], v[88:91], v[120:123]
    s_waitcnt lgkmcnt(2)
    v_mfma_f32_16x16x32_bf16 v[108:111], a[40:43], v[92:95], v[108:111]
    ds_read_b128 v[84:87], v11 offset:24576
    v_mfma_f32_16x16x32_bf16 v[112:115], a[40:43], v[96:99], v[112:115]
    ds_read_b128 v[88:91], v11 offset:26624
    v_mfma_f32_16x16x32_bf16 v[116:119], a[120:123], v[92:95], v[116:119]
    buffer_load_dwordx4 v10, s[24:27], s46 offen offset:768 lds
    s_add_u32 m0, m0, 3968
    v_mfma_f32_16x16x32_bf16 v[120:123], a[120:123], v[96:99], v[120:123]
    s_waitcnt lgkmcnt(2)
    v_mfma_f32_16x16x32_bf16 v[108:111], a[44:47], v[100:103], v[108:111]
    ds_read_b128 v[92:95], v12 offset:24576
    v_mfma_f32_16x16x32_bf16 v[112:115], a[44:47], v[104:107], v[112:115]
    ds_read_b128 v[96:99], v12 offset:26624
    v_mfma_f32_16x16x32_bf16 v[116:119], a[124:127], v[100:103], v[116:119]
    buffer_load_dwordx4 v10, s[24:27], s46 offen offset:896 lds
    s_add_u32 m0, m0, 3968
    v_mfma_f32_16x16x32_bf16 v[120:123], a[124:127], v[104:107], v[120:123]
    s_waitcnt lgkmcnt(2)
    v_mfma_f32_16x16x32_bf16 v[108:111], a[48:51], v[84:87], v[108:111]
    ds_read_b128 v[100:103], v11 offset:28672
    v_mfma_f32_16x16x32_bf16 v[112:115], a[48:51], v[88:91], v[112:115]
    ds_read_b128 v[104:107], v11 offset:30720
    v_mfma_f32_16x16x32_bf16 v[116:119], a[128:131], v[84:87], v[116:119]
    buffer_load_dwordx4 v10, s[24:27], s46 offen offset:1024 lds
    s_add_u32 m0, m0, 3968
    v_mfma_f32_16x16x32_bf16 v[120:123], a[128:131], v[88:91], v[120:123]
    s_waitcnt lgkmcnt(2)
    v_mfma_f32_16x16x32_bf16 v[108:111], a[52:55], v[92:95], v[108:111]
    ds_read_b128 v[84:87], v12 offset:28672
    v_mfma_f32_16x16x32_bf16 v[112:115], a[52:55], v[96:99], v[112:115]
    ds_read_b128 v[88:91], v12 offset:30720
    v_mfma_f32_16x16x32_bf16 v[116:119], a[132:135], v[92:95], v[116:119]
    buffer_load_dwordx4 v10, s[24:27], s46 offen offset:1152 lds
    v_mfma_f32_16x16x32_bf16 v[120:123], a[132:135], v[96:99], v[120:123]
    s_waitcnt lgkmcnt(2)
    v_mfma_f32_16x16x32_bf16 v[108:111], a[56:59], v[100:103], v[108:111]
    ds_read_b128 v[92:95], v11 offset:32768
    v_mfma_f32_16x16x32_bf16 v[112:115], a[56:59], v[104:107], v[112:115]
    ds_read_b128 v[96:99], v11 offset:34816
    v_mfma_f32_16x16x32_bf16 v[116:119], a[136:139], v[100:103], v[116:119]
    v_mfma_f32_16x16x32_bf16 v[120:123], a[136:139], v[104:107], v[120:123]
    s_waitcnt lgkmcnt(2)
    v_mfma_f32_16x16x32_bf16 v[108:111], a[60:63], v[84:87], v[108:111]
    ds_read_b128 v[100:103], v12 offset:32768
    v_mfma_f32_16x16x32_bf16 v[112:115], a[60:63], v[88:91], v[112:115]
    ds_read_b128 v[104:107], v12 offset:34816
    v_mfma_f32_16x16x32_bf16 v[116:119], a[140:143], v[84:87], v[116:119]
    v_mfma_f32_16x16x32_bf16 v[120:123], a[140:143], v[88:91], v[120:123]
    s_waitcnt lgkmcnt(2)
    v_mfma_f32_16x16x32_bf16 v[108:111], a[64:67], v[92:95], v[108:111]
    ds_read_b128 v[84:87], v11 offset:36864
    v_mfma_f32_16x16x32_bf16 v[112:115], a[64:67], v[96:99], v[112:115]
    ds_read_b128 v[88:91], v11 offset:38912
    v_mfma_f32_16x16x32_bf16 v[116:119], a[144:147], v[92:95], v[116:119]
    v_mfma_f32_16x16x32_bf16 v[120:123], a[144:147], v[96:99], v[120:123]
    s_waitcnt lgkmcnt(2)
    v_mfma_f32_16x16x32_bf16 v[108:111], a[68:71], v[100:103], v[108:111]
    ds_read_b128 v[92:95], v12 offset:36864
    v_mfma_f32_16x16x32_bf16 v[112:115], a[68:71], v[104:107], v[112:115]
    ds_read_b128 v[96:99], v12 offset:38912
    v_mfma_f32_16x16x32_bf16 v[116:119], a[148:151], v[100:103], v[116:119]
    v_mfma_f32_16x16x32_bf16 v[120:123], a[148:151], v[104:107], v[120:123]
    s_waitcnt lgkmcnt(0)
    v_mfma_f32_16x16x32_bf16 v[108:111], a[72:75], v[84:87], v[108:111]
    v_add_u32 v11, s49, v11
    v_mfma_f32_16x16x32_bf16 v[112:115], a[72:75], v[88:91], v[112:115]
    v_add_u32 v12, s49, v12
    v_mfma_f32_16x16x32_bf16 v[108:111], a[76:79], v[92:95], v[108:111]
    s_sub_u32 s47, s47, s49
    v_mfma_f32_16x16x32_bf16 v[112:115], a[76:79], v[96:99], v[112:115]
    s_sub_u32 s49, 0, s49
    v_mfma_f32_16x16x32_bf16 v[116:119], a[152:155], v[84:87], v[116:119]
    v_mfma_f32_16x16x32_bf16 v[120:123], a[152:155], v[88:91], v[120:123]
    v_mfma_f32_16x16x32_bf16 v[116:119], a[156:159], v[92:95], v[116:119]
    v_mfma_f32_16x16x32_bf16 v[120:123], a[156:159], v[96:99], v[120:123]
    v_cvt_pk_bf16_f32 v124, v108, v109
    v_cvt_pk_bf16_f32 v125, v110, v111
    v_cvt_pk_bf16_f32 v126, v112, v113
    v_cvt_pk_bf16_f32 v127, v114, v115
    s_nop 0
    v_permlane16_swap_b32 v124, v126
    v_permlane16_swap_b32 v125, v127
    v_cvt_pk_bf16_f32 v128, v116, v117
    v_cvt_pk_bf16_f32 v129, v118, v119
    v_cvt_pk_bf16_f32 v130, v120, v121
    v_cvt_pk_bf16_f32 v131, v122, v123
    s_nop 0
    v_permlane16_swap_b32 v128, v130
    v_permlane16_swap_b32 v129, v131
    buffer_store_dwordx4 v[124:127], v19, s[4:7], s44 offen sc1
    buffer_store_dwordx4 v[128:131], v19, s[4:7], s45 offen sc1
    s_branch L_v_loop_s
L_end_75:
    s_waitcnt vmcnt(0) lgkmcnt(0)
    s_endpgm
L_nan_73:
    s_cmp_eq_u32 s52, 1
    s_cbranch_scc1 L_cont_74
    v_lshlrev_b32 v1, 4, v0
L_nan_73r:
    s_mov_b32 s90, s41
    v_mov_b32 v2, 0
    buffer_load_dwordx4 v[28:31], v1, s[4:7], s90 offen sc1
    s_add_u32 s90, s90, 1024
    buffer_load_dwordx4 v[32:35], v1, s[4:7], s90 offen sc1
    s_add_u32 s90, s90, 1024
    buffer_load_dwordx4 v[36:39], v1, s[4:7], s90 offen sc1
    s_add_u32 s90, s90, 1024
    buffer_load_dwordx4 v[40:43], v1, s[4:7], s90 offen sc1
    s_add_u32 s90, s90, 1024
    buffer_load_dwordx4 v[44:47], v1, s[4:7], s90 offen sc1
    s_add_u32 s90, s90, 1024
    buffer_load_dwordx4 v[48:51], v1, s[4:7], s90 offen sc1
    s_add_u32 s90, s90, 1024
    buffer_load_dwordx4 v[52:55], v1, s[4:7], s90 offen sc1
    s_add_u32 s90, s90, 1024
    buffer_load_dwordx4 v[56:59], v1, s[4:7], s90 offen sc1
    s_add_u32 s90, s90, 1024
    buffer_load_dwordx4 v[60:63], v1, s[4:7], s90 offen sc1
    s_add_u32 s90, s90, 1024
    buffer_load_dwordx4 v[64:67], v1, s[4:7], s90 offen sc1
    s_add_u32 s90, s90, 1024
    s_sub_u32 s36, s36, 1
    s_cbranch_scc1 L_exit
    s_waitcnt vmcnt(0) lgkmcnt(0)
    v_max3_u32 v2, v2, v28, v29
    v_max3_u32 v2, v2, v30, v31
    v_max3_u32 v2, v2, v32, v33
    v_max3_u32 v2, v2, v34, v35
    v_max3_u32 v2, v2, v36, v37
    v_max3_u32 v2, v2, v38, v39
    v_max3_u32 v2, v2, v40, v41
    v_max3_u32 v2, v2, v42, v43
    v_max3_u32 v2, v2, v44, v45
    v_max3_u32 v2, v2, v46, v47
    v_max3_u32 v2, v2, v48, v49
    v_max3_u32 v2, v2, v50, v51
    v_max3_u32 v2, v2, v52, v53
    v_max3_u32 v2, v2, v54, v55
    v_max3_u32 v2, v2, v56, v57
    v_max3_u32 v2, v2, v58, v59
    v_max3_u32 v2, v2, v60, v61
    v_max3_u32 v2, v2, v62, v63
    v_max3_u32 v2, v2, v64, v65
    v_max3_u32 v2, v2, v66, v67
    v_cmp_eq_u32 vcc, -1, v2
    s_cbranch_vccnz L_nan_73r
    s_mov_b32 s52, 1
    v_mov_b32 v68, 0
    v_mov_b32 v69, 0
    v_mov_b32 v70, 0
    v_mov_b32 v71, 0
    v_mov_b32 v72, 0
    v_mov_b32 v73, 0
    v_mov_b32 v74, 0
    v_mov_b32 v75, 0
    v_smfmac_f32_16x16x64_bf16 v[68:71], v[28:31], a[0:7], v17
    s_nop 0
    v_smfmac_f32_16x16x64_bf16 v[72:75], v[28:31], a[80:87], v17
    v_smfmac_f32_16x16x64_bf16 v[68:71], v[32:35], a[8:15], v17
    v_smfmac_f32_16x16x64_bf16 v[72:75], v[32:35], a[88:95], v17
    v_smfmac_f32_16x16x64_bf16 v[68:71], v[36:39], a[16:23], v17
    v_smfmac_f32_16x16x64_bf16 v[72:75], v[36:39], a[96:103], v17
    v_smfmac_f32_16x16x64_bf16 v[68:71], v[40:43], a[24:31], v17
    v_smfmac_f32_16x16x64_bf16 v[72:75], v[40:43], a[104:111], v17
    v_smfmac_f32_16x16x64_bf16 v[68:71], v[44:47], a[32:39], v17
    v_smfmac_f32_16x16x64_bf16 v[72:75], v[44:47], a[112:119], v17
    v_smfmac_f32_16x16x64_bf16 v[68:71], v[48:51], a[40:47], v17
    v_smfmac_f32_16x16x64_bf16 v[72:75], v[48:51], a[120:127], v17
    v_smfmac_f32_16x16x64_bf16 v[68:71], v[52:55], a[48:55], v17
    v_smfmac_f32_16x16x64_bf16 v[68:71], v[56:59], a[56:63], v17
    v_smfmac_f32_16x16x64_bf16 v[68:71], v[60:63], a[64:71], v17
    v_smfmac_f32_16x16x64_bf16 v[68:71], v[64:67], a[72:79], v17
    s_nop 3
    s_branch L_redo_71
L_wo_s:
    s_mov_b32 s12, s80
    s_and_b32 s13, s81, 0xffff
    s_mov_b32 s14, 7864320
    s_mov_b32 s15, 0x20000
    s_mov_b32 s16, s72
    s_and_b32 s17, s73, 0xffff
    s_mov_b32 s18, 10240
    s_mov_b32 s19, 0x20000
    s_sub_u32 s40, s35, 18
    v_and_b32 v1, 15, v0
    v_lshrrev_b32 v2, 4, v0
    v_lshrrev_b32 v3, 3, v0
    v_and_b32 v4, 7, v0
    v_and_b32 v6, 2, v3
    v_xor_b32 v6, v6, v4
    v_lshlrev_b32 v6, 4, v6
    v_mul_u32_u24 v7, 1280, v3
    s_lshl_b32 s90, s34, 2
    s_add_u32 s90, s90, s32
    s_mul_i32 s90, s90, 245760
    s_lshl_b32 s91, s40, 7
    s_add_u32 s90, s90, s91
    v_add3_u32 v180, v6, v7, s90
    v_xor_b32 v181, 64, v180
    s_mul_i32 s90, s40, 32768
    s_lshl_b32 s91, s32, 11
    s_add_u32 s90, s90, s91
    s_lshr_b32 s91, s32, 1
    s_mul_i32 s91, s91, 0
    s_xor_b32 s91, s91, s34
    v_mul_u32_u24 v7, 0, v2
    v_xor_b32 v7, s91, v7
    v_lshlrev_b32 v6, 4, v1
    v_lshl_add_u32 v7, v7, 8, v6
    v_lshl_add_u32 v7, v2, 13, v7
    v_add_u32 v14, s90, v7
    v_lshlrev_b32 v12, 4, v0
    v_lshlrev_b32 v13, 2, v0
    v_add_u32 v46, s90, v13
    s_xor_b32 s92, s91, 0
    s_lshl_b32 s92, s92, 8
    s_add_u32 s60, s92, 0
    s_xor_b32 s92, s91, 0
    s_lshl_b32 s92, s92, 8
    s_add_u32 s61, s92, 8192
    s_xor_b32 s92, s91, 0
    s_lshl_b32 s92, s92, 8
    s_add_u32 s62, s92, 16384
    s_xor_b32 s92, s91, 0
    s_lshl_b32 s92, s92, 8
    s_add_u32 s63, s92, 24576
    v_cmp_gt_u32 vcc, 2, v2
    v_mov_b32 v9, 2146435072
    s_nop 0
    v_cndmask_b32 v14, v9, v14, vcc
    s_lshl_b32 s92, s40, 7
    s_lshl_b32 s93, s32, 2
    s_add_u32 s92, s92, s93
    s_add_u32 s92, s92, 460800
    v_mov_b32 v244, s92
    v_cmp_eq_u32 vcc, 0, v0
    v_mov_b32 v9, 2146435072
    s_nop 0
    v_cndmask_b32 v244, v9, v244, vcc
    s_lshl_b32 s92, s32, 7
    s_add_u32 s92, s92, 462336
    v_min_u32 v3, 5, v0
    v_lshl_add_u32 v245, v3, 2, s92
    s_lshl_b32 s90, s40, 2
    s_add_u32 s90, s90, s32
    s_lshl_b32 s91, s90, 8
    v_add_u32 v17, s91, v6
    v_cmp_eq_u32 vcc, 0, v2
    v_mov_b32 v9, 2146435072
    s_nop 0
    v_cndmask_b32 v17, v9, v17, vcc
    v_lshrrev_b32 v3, 2, v1
    v_and_b32 v7, 1, v1
    v_lshl_or_b32 v4, v3, 1, v7
    v_mul_u32_u24 v4, 1280, v4
    v_and_b32 v5, 2, v1
    v_lshl_add_u32 v4, v5, 1, v4
    s_lshl_b32 s91, s90, 5
    v_add_u32 v4, s91, v4
    v_lshlrev_b32 v6, 6, v3
    v_lshl_add_u32 v6, v7, 5, v6
    v_lshl_add_u32 v6, v2, 3, v6
    v_lshl_add_u32 v6, v5, 1, v6
    s_mul_i32 s92, s32, 1152
    s_add_u32 s92, s92, 122880
    v_add_u32 v18, s92, v6
    buffer_load_dword v164, v4, s[16:19], 0 offen offset:0
    buffer_load_dword v165, v4, s[16:19], 0 offen offset:8
    buffer_load_dword v166, v4, s[16:19], 0 offen offset:16
    buffer_load_dword v167, v4, s[16:19], 0 offen offset:24
    v_mov_b32 v168, -1
    v_mov_b32 v169, -1
    v_mov_b32 v170, -1
    v_mov_b32 v171, -1
    s_mul_i32 s90, s32, 24576
    s_mov_b32 m0, s90
    s_mov_b32 s91, 0
    buffer_load_dwordx4 v180, s[12:15], s91 offen nt lds
    s_add_u32 m0, m0, 1024
    s_add_u32 s91, s91, 10240
    buffer_load_dwordx4 v181, s[12:15], s91 offen nt lds
    s_add_u32 m0, m0, 1024
    s_add_u32 s91, s91, 10240
    buffer_load_dwordx4 v180, s[12:15], s91 offen nt lds
    s_add_u32 m0, m0, 1024
    s_add_u32 s91, s91, 10240
    buffer_load_dwordx4 v181, s[12:15], s91 offen nt lds
    s_add_u32 m0, m0, 1024
    s_add_u32 s91, s91, 10240
    buffer_load_dwordx4 v180, s[12:15], s91 offen nt lds
    s_add_u32 m0, m0, 1024
    s_add_u32 s91, s91, 10240
    buffer_load_dwordx4 v181, s[12:15], s91 offen nt lds
    s_add_u32 m0, m0, 1024
    s_add_u32 s91, s91, 10240
    buffer_load_dwordx4 v180, s[12:15], s91 offen nt lds
    s_add_u32 m0, m0, 1024
    s_add_u32 s91, s91, 10240
    buffer_load_dwordx4 v181, s[12:15], s91 offen nt lds
    s_add_u32 m0, m0, 1024
    s_add_u32 s91, s91, 10240
    buffer_load_dwordx4 v180, s[12:15], s91 offen nt lds
    s_add_u32 m0, m0, 1024
    s_add_u32 s91, s91, 10240
    buffer_load_dwordx4 v181, s[12:15], s91 offen nt lds
    s_add_u32 m0, m0, 1024
    s_add_u32 s91, s91, 10240
    buffer_load_dwordx4 v180, s[12:15], s91 offen nt lds
    s_add_u32 m0, m0, 1024
    s_add_u32 s91, s91, 10240
    buffer_load_dwordx4 v181, s[12:15], s91 offen nt lds
    s_add_u32 m0, m0, 1024
    s_add_u32 s91, s91, 10240
    buffer_load_dwordx4 v180, s[12:15], s91 offen nt lds
    s_add_u32 m0, m0, 1024
    s_add_u32 s91, s91, 10240
    buffer_load_dwordx4 v181, s[12:15], s91 offen nt lds
    s_add_u32 m0, m0, 1024
    s_add_u32 s91, s91, 10240
    buffer_load_dwordx4 v180, s[12:15], s91 offen nt lds
    s_add_u32 m0, m0, 1024
    s_add_u32 s91, s91, 10240
    buffer_load_dwordx4 v181, s[12:15], s91 offen nt lds
    s_add_u32 m0, m0, 1024
    s_add_u32 s91, s91, 10240
    buffer_load_dwordx4 v180, s[12:15], s91 offen nt lds
    s_add_u32 m0, m0, 1024
    s_add_u32 s91, s91, 10240
    buffer_load_dwordx4 v181, s[12:15], s91 offen nt lds
    s_add_u32 m0, m0, 1024
    s_add_u32 s91, s91, 10240
    buffer_load_dwordx4 v180, s[12:15], s91 offen nt lds
    s_add_u32 m0, m0, 1024
    s_add_u32 s91, s91, 10240
    buffer_load_dwordx4 v181, s[12:15], s91 offen nt lds
    s_add_u32 m0, m0, 1024
    s_add_u32 s91, s91, 10240
    buffer_load_dwordx4 v180, s[12:15], s91 offen nt lds
    s_add_u32 m0, m0, 1024
    s_add_u32 s91, s91, 10240
    buffer_load_dwordx4 v181, s[12:15], s91 offen nt lds
    s_add_u32 m0, m0, 1024
    s_add_u32 s91, s91, 10240
    buffer_load_dwordx4 v180, s[12:15], s91 offen nt lds
    s_add_u32 m0, m0, 1024
    s_add_u32 s91, s91, 10240
    buffer_load_dwordx4 v181, s[12:15], s91 offen nt lds
    s_waitcnt vmcnt(24)
    v_min_u32 v164, -2, v164
    v_min_u32 v165, -2, v165
    v_min_u32 v166, -2, v166
    v_min_u32 v167, -2, v167
    v_and_b32 v7, 2, v1
    v_cmp_ne_u32 vcc, 0, v7
    v_mov_b32 v5, 0x4444
    v_mov_b32 v6, 0xeeee
    v_cndmask_b32 v10, v5, v6, vcc
    v_mov_b32 v5, 0xe484
    v_mov_b32 v6, 0xee9e
    v_cndmask_b32 v7, v5, v6, vcc
    v_mov_b32 v5, 0x84e4
    v_mov_b32 v6, 0x9eee
    v_cndmask_b32 v8, v5, v6, vcc
    v_cmp_gt_u32 vcc, 2, v2
    s_nop 1
    v_cndmask_b32 v11, v8, v7, vcc
    v_mov_b32 v84, 1065369472
    v_mov_b32 v85, 1065369472
    v_mov_b32 v86, 1065369472
    v_mov_b32 v87, 0
    v_mov_b32 v88, 1065369472
    v_mov_b32 v89, 1065369472
    v_mov_b32 v90, 1065369472
    v_mov_b32 v91, 0
    v_mov_b32 v51, 0
    v_mov_b32 v55, 0
    v_mov_b32 v59, 0
    v_mov_b32 v63, 0
    v_mov_b32 v67, 0
    v_mov_b32 v71, 0
    v_mov_b32 v75, 0
    v_mov_b32 v79, 0
    v_mov_b32 v210, 0
    v_mov_b32 v211, 0
    v_mov_b32 v218, 0
    v_mov_b32 v219, 0
    v_and_b32 v7, 1, v1
    v_cmp_ne_u32 vcc, 0, v7
    v_mov_b32 v5, 0x3f80
    v_mov_b32 v6, 0x3f800000
    v_cndmask_b32 v5, v5, v6, vcc
    v_bfe_u32 v6, v1, 1, 1
    v_cmp_eq_u32 vcc, 0, v6
    s_nop 1
    v_cndmask_b32 v110, 0, v5, vcc
    v_mov_b32 v108, 0
    v_mov_b32 v112, 0
    v_cmp_eq_u32 vcc, 1, v6
    s_nop 1
    v_cndmask_b32 v111, 0, v5, vcc
    v_mov_b32 v109, 0
    v_mov_b32 v113, 0
    v_mov_b32 v240, 0x3dd53b95
    v_mov_b32 v241, 0x3dd53b95
    s_lshl_b32 s90, s32, 8
    s_add_u32 s90, s90, 122880
    v_mul_u32_u24 v6, 1152, v2
    v_lshl_add_u32 v6, v1, 3, v6
    v_add_u32 v19, s90, v6
    s_mul_i32 s90, s32, 1536
    v_add_u32 v20, s90, v12
    s_add_u32 s90, s90, 1024
    v_lshl_add_u32 v21, v0, 3, s90
    s_mul_i32 s90, s32, 6144
    v_add_u32 v22, s90, v12
    s_add_u32 s90, s90, 1024
    v_lshl_add_u32 v23, v0, 3, s90
    v_add_u32 v28, 98304, v12
    s_mul_i32 s90, s32, 3072
    v_add_u32 v37, s90, v12
    v_add_u32 v44, 25600, v37
    s_add_u32 s54, s90, 98304
    s_mul_i32 s90, s32, 3840
    s_add_u32 s90, s90, 10240
    v_add_u32 v38, s90, v12
    s_add_u32 s90, s90, 1024
    v_add_u32 v39, s90, v13
    s_mul_i32 s90, s32, 12288
    v_add_u32 v40, s90, v12
    s_lshl_b32 s90, s40, 15
    s_lshl_b32 s92, s32, 10
    s_add_u32 s90, s90, s92
    v_lshrrev_b32 v5, 3, v0
    v_mul_u32_u24 v5, 0, v5
    v_xor_b32 v5, s34, v5
    v_and_b32 v6, 7, v1
    v_lshlrev_b32 v6, 4, v6
    v_lshl_add_u32 v6, v5, 7, v6
    v_lshrrev_b32 v7, 3, v1
    v_lshl_add_u32 v6, v7, 12, v6
    v_lshrrev_b32 v5, 1, v2
    v_lshl_add_u32 v6, v5, 13, v6
    v_and_b32 v5, 1, v2
    v_lshl_add_u32 v6, v5, 14, v6
    v_add_u32 v30, s90, v6
    s_and_b32 s91, s34, 1
    s_lshl_b32 s91, s91, 12
    s_add_u32 s90, s90, s91
    s_lshr_b32 s91, s34, 2
    s_lshl_b32 s91, s91, 13
    s_add_u32 s90, s90, s91
    s_and_b32 s91, s34, 2
    s_lshl_b32 s91, s91, 13
    s_add_u32 s90, s90, s91
    v_add_u32 v31, s90, v12
    s_lshr_b32 s91, s34, 1
    s_mul_i32 s91, s91, 10240
    s_lshl_b32 s92, s40, 7
    s_add_u32 s91, s91, s92
    s_lshl_b32 s92, s32, 5
    s_add_u32 s91, s91, s92
    s_and_b32 s92, s34, 1
    s_lshl_b32 s92, s92, 4
    s_add_u32 s91, s91, s92
    s_add_u32 s91, s91, 1280
    v_lshl_add_u32 v6, v7, 4, v2
    v_mul_u32_u24 v6, 2560, v6
    v_and_b32 v5, 7, v1
    v_lshl_add_u32 v6, v5, 1, v6
    v_add_u32 v32, s91, v6
    v_cmp_gt_u32 s[58:59], 8, v1
    v_and_b32 v5, 1, v1
    v_lshrrev_b32 v6, 3, v1
    v_lshl_add_u32 v5, v5, 1, v6
    v_bfe_u32 v6, v1, 2, 1
    v_cmp_ne_u32 vcc, 0, v6
    v_mov_b32 v6, 0x3f80
    v_mov_b32 v7, 0x3f800000
    v_cndmask_b32 v6, v6, v7, vcc
    v_cmp_eq_u32 vcc, 0, v5
    s_nop 1
    v_cndmask_b32 v7, 0, v6, vcc
    v_accvgpr_write_b32 a144, v7
    v_cmp_eq_u32 vcc, 1, v5
    s_nop 1
    v_cndmask_b32 v7, 0, v6, vcc
    v_accvgpr_write_b32 a145, v7
    v_cmp_eq_u32 vcc, 2, v5
    s_nop 1
    v_cndmask_b32 v7, 0, v6, vcc
    v_accvgpr_write_b32 a146, v7
    v_cmp_eq_u32 vcc, 3, v5
    s_nop 1
    v_cndmask_b32 v7, 0, v6, vcc
    v_accvgpr_write_b32 a147, v7
    s_lshl_b32 s90, s32, 7
    v_add_u32 v5, s90, v13
    v_add_u32 v6, 458752, v5
    v_add_u32 v7, 459728, v5
    v_cmp_gt_u32 vcc, 12, v0
    s_nop 1
    v_cndmask_b32 v33, v7, v6, vcc
    v_mov_b32 v5, -2
    v_cndmask_b32 v34, v5, 3, vcc
    v_cmp_gt_u32 vcc, 14, v0
    v_mov_b32 v9, 2146435072
    s_nop 0
    v_cndmask_b32 v33, v9, v33, vcc
    v_mov_b32 v5, -1000
    v_cndmask_b32 v34, v5, v34, vcc
    v_and_b32 v4, 3, v1
    v_and_b32 v5, 1, v2
    v_lshl_add_u32 v6, v2, 3, v3
    v_lshlrev_b32 v6, 7, v6
    v_and_b32 v7, 2, v3
    v_lshl_or_b32 v7, v5, 2, v7
    v_lshrrev_b32 v8, 1, v4
    v_xor_b32 v7, v7, v8
    v_lshl_add_u32 v6, v7, 4, v6
    v_and_b32 v7, 1, v4
    v_lshl_add_u32 v6, v7, 3, v6
    s_mul_i32 s90, s32, 24576
    v_add_u32 v6, s90, v6
    v_xor_b32 v182, 0, v6
    v_xor_b32 v183, 32, v6
    v_xor_b32 v184, 64, v6
    v_xor_b32 v185, 96, v6
    s_waitcnt vmcnt(0)
    ds_read_b64_tr_b16 a[0:1], v182 offset:0
    ds_read_b64_tr_b16 a[2:3], v182 offset:512
    ds_read_b64_tr_b16 a[4:5], v182 offset:4096
    ds_read_b64_tr_b16 a[6:7], v182 offset:4608
    ds_read_b64_tr_b16 a[8:9], v182 offset:8192
    ds_read_b64_tr_b16 a[10:11], v182 offset:8704
    ds_read_b64_tr_b16 a[12:13], v182 offset:12288
    ds_read_b64_tr_b16 a[14:15], v182 offset:12800
    ds_read_b64_tr_b16 a[16:17], v182 offset:16384
    ds_read_b64_tr_b16 a[18:19], v182 offset:16896
    ds_read_b64_tr_b16 a[20:21], v182 offset:20480
    ds_read_b64_tr_b16 a[22:23], v182 offset:20992
    ds_read_b64_tr_b16 a[24:25], v183 offset:0
    ds_read_b64_tr_b16 a[26:27], v183 offset:512
    ds_read_b64_tr_b16 a[28:29], v183 offset:4096
    ds_read_b64_tr_b16 a[30:31], v183 offset:4608
    ds_read_b64_tr_b16 a[32:33], v183 offset:8192
    ds_read_b64_tr_b16 a[34:35], v183 offset:8704
    ds_read_b64_tr_b16 a[36:37], v183 offset:12288
    ds_read_b64_tr_b16 a[38:39], v183 offset:12800
    ds_read_b64_tr_b16 a[40:41], v183 offset:16384
    ds_read_b64_tr_b16 a[42:43], v183 offset:16896
    ds_read_b64_tr_b16 a[44:45], v183 offset:20480
    ds_read_b64_tr_b16 a[46:47], v183 offset:20992
    ds_read_b64_tr_b16 a[48:49], v184 offset:0
    ds_read_b64_tr_b16 a[50:51], v184 offset:512
    ds_read_b64_tr_b16 a[52:53], v184 offset:4096
    ds_read_b64_tr_b16 a[54:55], v184 offset:4608
    ds_read_b64_tr_b16 a[56:57], v184 offset:8192
    ds_read_b64_tr_b16 a[58:59], v184 offset:8704
    ds_read_b64_tr_b16 a[60:61], v184 offset:12288
    ds_read_b64_tr_b16 a[62:63], v184 offset:12800
    ds_read_b64_tr_b16 a[64:65], v184 offset:16384
    ds_read_b64_tr_b16 a[66:67], v184 offset:16896
    ds_read_b64_tr_b16 a[68:69], v184 offset:20480
    ds_read_b64_tr_b16 a[70:71], v184 offset:20992
    ds_read_b64_tr_b16 a[72:73], v185 offset:0
    ds_read_b64_tr_b16 a[74:75], v185 offset:512
    ds_read_b64_tr_b16 a[76:77], v185 offset:4096
    ds_read_b64_tr_b16 a[78:79], v185 offset:4608
    ds_read_b64_tr_b16 a[80:81], v185 offset:8192
    ds_read_b64_tr_b16 a[82:83], v185 offset:8704
    ds_read_b64_tr_b16 a[84:85], v185 offset:12288
    ds_read_b64_tr_b16 a[86:87], v185 offset:12800
    ds_read_b64_tr_b16 a[88:89], v185 offset:16384
    ds_read_b64_tr_b16 a[90:91], v185 offset:16896
    ds_read_b64_tr_b16 a[92:93], v185 offset:20480
    ds_read_b64_tr_b16 a[94:95], v185 offset:20992
    s_waitcnt lgkmcnt(0)
    s_barrier
    v_mov_b32 v1, 196
L_gw_77:
    buffer_load_dword v2, v1, s[8:11], 0 offen sc1
    s_sub_u32 s36, s36, 1
    s_cbranch_scc1 L_exit
    s_waitcnt vmcnt(0)
    v_readfirstlane_b32 s90, v2
    s_nop 0
    s_cmp_eq_u32 s90, 0
    s_cbranch_scc1 L_gw_77
    buffer_store_dwordx4 v[164:167], v17, s[4:7], s38 offen sc1
    s_mov_b32 s37, -1
    v_add_u32 v35, -2, v34
    s_add_u32 s45, s38, 65536
    s_add_u32 s46, s45, 4096
    s_add_u32 s47, s45, 8192
    v_mov_b32 v24, v20
    v_mov_b32 v25, v21
    buffer_load_dword v36, v33, s[4:7], s38 offen sc1
    s_waitcnt vmcnt(0)
    v_cmp_lt_i32 vcc, v36, v35
    s_cbranch_vccz L_fok_79
L_fw_78:
    buffer_load_dword v36, v33, s[4:7], s38 offen sc1
    s_sub_u32 s36, s36, 1
    s_cbranch_scc1 L_exit
    s_waitcnt vmcnt(0)
    v_cmp_lt_i32 vcc, v36, v35
    s_cbranch_vccnz L_fw_78
L_fok_79:
    buffer_load_dwordx4 a[96:99], v40, s[4:7], s45 offen offset:0 sc1
    buffer_load_dwordx4 a[100:103], v40, s[4:7], s45 offen offset:1024 sc1
    buffer_load_dwordx4 a[104:107], v40, s[4:7], s45 offen offset:2048 sc1
    buffer_load_dwordx4 a[108:111], v40, s[4:7], s45 offen offset:3072 sc1
    buffer_load_dwordx4 a[112:115], v40, s[4:7], s46 offen offset:0 sc1
    buffer_load_dwordx4 a[116:119], v40, s[4:7], s46 offen offset:1024 sc1
    buffer_load_dwordx4 a[120:123], v40, s[4:7], s46 offen offset:2048 sc1
    buffer_load_dwordx4 a[124:127], v40, s[4:7], s46 offen offset:3072 sc1
    buffer_load_dwordx4 a[128:131], v40, s[4:7], s47 offen offset:0 sc1
    buffer_load_dwordx4 a[132:135], v40, s[4:7], s47 offen offset:1024 sc1
    buffer_load_dwordx4 a[136:139], v40, s[4:7], s47 offen offset:2048 sc1
    buffer_load_dwordx4 a[140:143], v40, s[4:7], s47 offen offset:3072 sc1
    s_waitcnt vmcnt(0)
    v_mfma_f32_16x16x32_bf16 v[148:151], a[96:99], a[0:3], 0
    v_mfma_f32_16x16x32_bf16 v[152:155], a[120:123], a[0:3], 0
    v_mfma_f32_16x16x32_bf16 v[156:159], a[96:99], a[24:27], 0
    v_mfma_f32_16x16x32_bf16 v[160:163], a[120:123], a[24:27], 0
    v_mfma_f32_16x16x32_bf16 v[180:183], a[96:99], a[48:51], 0
    v_mfma_f32_16x16x32_bf16 v[184:187], a[120:123], a[48:51], 0
    v_mfma_f32_16x16x32_bf16 v[188:191], a[96:99], a[72:75], 0
    v_mfma_f32_16x16x32_bf16 v[192:195], a[120:123], a[72:75], 0
    v_mfma_f32_16x16x32_bf16 v[148:151], a[100:103], a[4:7], v[148:151]
    v_mfma_f32_16x16x32_bf16 v[152:155], a[124:127], a[4:7], v[152:155]
    v_mfma_f32_16x16x32_bf16 v[156:159], a[100:103], a[28:31], v[156:159]
    v_mfma_f32_16x16x32_bf16 v[160:163], a[124:127], a[28:31], v[160:163]
    v_mfma_f32_16x16x32_bf16 v[180:183], a[100:103], a[52:55], v[180:183]
    v_mfma_f32_16x16x32_bf16 v[184:187], a[124:127], a[52:55], v[184:187]
    v_mfma_f32_16x16x32_bf16 v[188:191], a[100:103], a[76:79], v[188:191]
    v_mfma_f32_16x16x32_bf16 v[192:195], a[124:127], a[76:79], v[192:195]
    v_mfma_f32_16x16x32_bf16 v[148:151], a[104:107], a[8:11], v[148:151]
    v_mfma_f32_16x16x32_bf16 v[152:155], a[128:131], a[8:11], v[152:155]
    v_mfma_f32_16x16x32_bf16 v[156:159], a[104:107], a[32:35], v[156:159]
    v_mfma_f32_16x16x32_bf16 v[160:163], a[128:131], a[32:35], v[160:163]
    v_mfma_f32_16x16x32_bf16 v[180:183], a[104:107], a[56:59], v[180:183]
    v_mfma_f32_16x16x32_bf16 v[184:187], a[128:131], a[56:59], v[184:187]
    v_mfma_f32_16x16x32_bf16 v[188:191], a[104:107], a[80:83], v[188:191]
    v_mfma_f32_16x16x32_bf16 v[192:195], a[128:131], a[80:83], v[192:195]
    v_mfma_f32_16x16x32_bf16 v[148:151], a[108:111], a[12:15], v[148:151]
    v_mfma_f32_16x16x32_bf16 v[152:155], a[132:135], a[12:15], v[152:155]
    v_mfma_f32_16x16x32_bf16 v[156:159], a[108:111], a[36:39], v[156:159]
    v_mfma_f32_16x16x32_bf16 v[160:163], a[132:135], a[36:39], v[160:163]
    v_mfma_f32_16x16x32_bf16 v[180:183], a[108:111], a[60:63], v[180:183]
    v_mfma_f32_16x16x32_bf16 v[184:187], a[132:135], a[60:63], v[184:187]
    v_mfma_f32_16x16x32_bf16 v[188:191], a[108:111], a[84:87], v[188:191]
    v_mfma_f32_16x16x32_bf16 v[192:195], a[132:135], a[84:87], v[192:195]
    v_mfma_f32_16x16x32_bf16 v[148:151], a[112:115], a[16:19], v[148:151]
    v_mfma_f32_16x16x32_bf16 v[152:155], a[136:139], a[16:19], v[152:155]
    v_mfma_f32_16x16x32_bf16 v[156:159], a[112:115], a[40:43], v[156:159]
    v_mfma_f32_16x16x32_bf16 v[160:163], a[136:139], a[40:43], v[160:163]
    v_mfma_f32_16x16x32_bf16 v[180:183], a[112:115], a[64:67], v[180:183]
    v_mfma_f32_16x16x32_bf16 v[184:187], a[136:139], a[64:67], v[184:187]
    v_mfma_f32_16x16x32_bf16 v[188:191], a[112:115], a[88:91], v[188:191]
    v_mfma_f32_16x16x32_bf16 v[192:195], a[136:139], a[88:91], v[192:195]
    v_mfma_f32_16x16x32_bf16 v[148:151], a[116:119], a[20:23], v[148:151]
    v_mfma_f32_16x16x32_bf16 v[152:155], a[140:143], a[20:23], v[152:155]
    v_mfma_f32_16x16x32_bf16 v[156:159], a[116:119], a[44:47], v[156:159]
    v_mfma_f32_16x16x32_bf16 v[160:163], a[140:143], a[44:47], v[160:163]
    v_mfma_f32_16x16x32_bf16 v[180:183], a[116:119], a[68:71], v[180:183]
    v_mfma_f32_16x16x32_bf16 v[184:187], a[140:143], a[68:71], v[184:187]
    v_mfma_f32_16x16x32_bf16 v[188:191], a[116:119], a[92:95], v[188:191]
    v_mfma_f32_16x16x32_bf16 v[192:195], a[140:143], a[92:95], v[192:195]
    v_cvt_pk_bf16_f32 v64, v180, v181
    v_cvt_pk_bf16_f32 v65, v182, v183
    ds_write_b64 v24, v[64:65] offset:12288
    v_cvt_pk_bf16_f32 v68, v184, v185
    v_cvt_pk_bf16_f32 v69, v186, v187
    ds_write_b64 v25, v[68:69] offset:12288
    v_cvt_pk_bf16_f32 v72, v188, v189
    v_cvt_pk_bf16_f32 v73, v190, v191
    ds_write_b64 v24, v[72:73] offset:18432
    v_cvt_pk_bf16_f32 v76, v192, v193
    v_cvt_pk_bf16_f32 v77, v194, v195
    ds_write_b64 v25, v[76:77] offset:18432
    v_cvt_pk_bf16_f32 v48, v148, v149
    v_cvt_pk_bf16_f32 v49, v150, v151
    ds_write_b64 v24, v[48:49] offset:0
    v_cvt_pk_bf16_f32 v52, v152, v153
    v_cvt_pk_bf16_f32 v53, v154, v155
    ds_write_b64 v25, v[52:53] offset:0
    v_cvt_pk_bf16_f32 v56, v156, v157
    v_cvt_pk_bf16_f32 v57, v158, v159
    ds_write_b64 v24, v[56:57] offset:6144
    v_cvt_pk_bf16_f32 v60, v160, v161
    v_cvt_pk_bf16_f32 v61, v162, v163
    ds_write_b64 v25, v[60:61] offset:6144
    s_add_u32 s56, s37, 2
    s_and_b32 s55, s56, 3
    s_mul_i32 s55, s55, 114688
    s_add_u32 s55, s55, 65536
    s_add_u32 s45, s38, s55
    s_add_u32 s46, s45, 4096
    s_add_u32 s47, s45, 8192
    s_add_u32 s56, s37, -1
    s_and_b32 s55, s56, 3
    s_mul_i32 s55, s55, 114688
    s_add_u32 s55, s55, 53248
    s_add_u32 s48, s38, s55
    s_and_b32 s55, s56, 1
    s_add_u32 s56, s56, 1
    v_mov_b32 v35, -16
    v_writelane_b32 v35, s56, 12
    s_mul_i32 s55, s55, 12288
    s_add_u32 m0, s54, s55
    v_add_u32 v35, -1, v34
    buffer_load_dword v36, v33, s[4:7], s38 offen sc1
    s_waitcnt vmcnt(0)
    v_cmp_lt_i32 vcc, v36, v35
    s_cbranch_vccz L_fok_81
L_fw_80:
    buffer_load_dword v36, v33, s[4:7], s38 offen sc1
    s_sub_u32 s36, s36, 1
    s_cbranch_scc1 L_exit
    s_waitcnt vmcnt(0)
    v_cmp_lt_i32 vcc, v36, v35
    s_cbranch_vccnz L_fw_80
L_fok_81:
    buffer_load_dwordx4 a[96:99], v40, s[4:7], s45 offen offset:0 sc1
    buffer_load_dwordx4 a[100:103], v40, s[4:7], s45 offen offset:1024 sc1
    buffer_load_dwordx4 a[104:107], v40, s[4:7], s45 offen offset:2048 sc1
    buffer_load_dwordx4 a[108:111], v40, s[4:7], s45 offen offset:3072 sc1
    buffer_load_dwordx4 a[112:115], v40, s[4:7], s46 offen offset:0 sc1
    buffer_load_dwordx4 a[116:119], v40, s[4:7], s46 offen offset:1024 sc1
    buffer_load_dwordx4 a[120:123], v40, s[4:7], s46 offen offset:2048 sc1
    buffer_load_dwordx4 a[124:127], v40, s[4:7], s46 offen offset:3072 sc1
    buffer_load_dwordx4 a[128:131], v40, s[4:7], s47 offen offset:0 sc1
    buffer_load_dwordx4 a[132:135], v40, s[4:7], s47 offen offset:1024 sc1
    buffer_load_dwordx4 a[136:139], v40, s[4:7], s47 offen offset:2048 sc1
    buffer_load_dwordx4 a[140:143], v40, s[4:7], s47 offen offset:3072 sc1
    s_add_u32 s56, s37, 1
    v_mov_b32 v47, v24
    s_and_b32 s55, s56, 3
    s_mul_i32 s41, s55, 327680
    s_mul_i32 s56, s55, 114688
    s_add_u32 s43, s38, s56
    s_xor_b32 s55, s55, 2
    s_mul_i32 s42, s55, 327680
    s_add_u32 s56, s37, 2
    v_mov_b32 v107, s56
    s_and_b32 s55, s56, 3
    s_mul_i32 s44, s55, 24576
    s_mov_b32 s50, s52
    s_add_u32 s56, s37, -2
    s_and_b32 s55, s56, 3
    s_mul_i32 s55, s55, 327680
    s_add_u32 s49, s55, 4194304
    s_add_u32 s56, s37, -4
    s_and_b32 s55, s56, 3
    s_mul_i32 s55, s55, 327680
    s_add_u32 s51, s55, 4194304
    s_mul_i32 s52, s56, 81920
    s_add_u32 s56, s37, -1
    s_and_b32 s55, s56, 3
    s_mul_i32 s55, s55, 24576
    v_add_u32 v26, s55, v22
    v_add_u32 v27, s55, v23
    s_and_b32 s55, s56, 1
    s_mul_i32 s55, s55, 12288
    v_add_u32 v29, s55, v28
    s_add_u32 s37, s37, 1
    v_add_u32 v24, s44, v20
    v_add_u32 v25, s44, v21
    v_pk_mul_f32 v[148:149], v[210:211], v[210:211]
    v_pk_mul_f32 v[150:151], v[210:211], v[210:211]
    v_pk_mul_f32 v[152:153], v[210:211], v[210:211]
    v_pk_mul_f32 v[154:155], v[210:211], v[210:211]
    v_pk_mul_f32 v[156:157], v[210:211], v[210:211]
    v_pk_mul_f32 v[158:159], v[210:211], v[210:211]
    v_pk_mul_f32 v[160:161], v[210:211], v[210:211]
    v_pk_mul_f32 v[162:163], v[210:211], v[210:211]
    v_mov_b32 v120, 0
    v_mov_b32 v121, 0
    v_mov_b32 v122, 0
    v_mov_b32 v123, 0
    v_mov_b32 v124, 0
    v_mov_b32 v125, 0
    v_mov_b32 v126, 0
    v_mov_b32 v127, 0
    v_mov_b32 v128, 0
    v_mov_b32 v129, 0
    v_mov_b32 v130, 0
    v_mov_b32 v131, 0
    v_mov_b32 v132, 0
    v_mov_b32 v133, 0
    v_mov_b32 v134, 0
    v_mov_b32 v135, 0
    v_mov_b32 v116, 0
    v_mov_b32 v117, 0
    v_mov_b32 v118, 0
    v_mov_b32 v119, 0
    v_mov_b32 v3, 204
L_p0_82:
    buffer_load_dword v4, v3, s[8:11], 0 offen sc1
    s_sub_u32 s36, s36, 1
    s_cbranch_scc1 L_exit
    s_waitcnt vmcnt(0)
    v_readfirstlane_b32 s90, v4
    s_nop 0
    s_cmp_eq_u32 s90, 0
    s_cbranch_scc1 L_p0_82
    s_and_b32 s90, s90, 2
    s_lshl_b32 s90, s90, 12
    s_nop 0
    v_xor_b32 v30, s90, v30
    v_xor_b32 v31, s90, v31
    s_mov_b32 s90, 5832704
    buffer_store_dwordx4 v[168:171], v30, s[4:7], s90 offen sc1
    s_mov_b32 s90, 6160384
    buffer_store_dwordx4 v[168:171], v30, s[4:7], s90 offen sc1
L_wo_loop_s:
    buffer_load_dword v41, v245, s[4:7], s38 offen sc1
    buffer_load_dword v41, v245, s[4:7], s38 offen sc1
    buffer_load_dword v41, v245, s[4:7], s38 offen sc1
L_bf_83:
    buffer_load_dword v41, v245, s[4:7], s38 offen sc1
    s_sub_u32 s36, s36, 1
    s_cbranch_scc1 L_exit
    s_waitcnt vmcnt(3)
    v_cmp_ge_u32 vcc, s37, v41
    s_cbranch_vccnz L_bf_83
    buffer_load_dwordx4 v[136:139], v44, s[4:7], s43 offen offset:0 sc1
    buffer_load_dwordx4 v[140:143], v44, s[4:7], s43 offen offset:1024 sc1
    buffer_load_dwordx4 v[144:147], v44, s[4:7], s43 offen offset:2048 sc1
    s_waitcnt vmcnt(2)
    buffer_load_dwordx4 v[92:95], v38, s[4:7], s43 offen offset:0 sc1
    buffer_load_dword v104, v39, s[4:7], s43 offen offset:0 sc1
    v_smfmac_f32_16x16x64_bf16 v[148:151], v[136:139], a[0:7], v10
    buffer_load_dwordx4 v[96:99], v38, s[4:7], s43 offen offset:1280 sc1
    buffer_load_dword v105, v39, s[4:7], s43 offen offset:1280 sc1
    v_smfmac_f32_16x16x64_bf16 v[152:155], v[136:139], a[24:31], v10
    buffer_load_dwordx4 v[100:103], v38, s[4:7], s43 offen offset:2560 sc1
    buffer_load_dword v106, v39, s[4:7], s43 offen offset:2560 sc1
    v_smfmac_f32_16x16x64_bf16 v[156:159], v[136:139], a[48:55], v10
    v_smfmac_f32_16x16x64_bf16 v[160:163], v[136:139], a[72:79], v10
    s_waitcnt vmcnt(7)
    v_smfmac_f32_16x16x64_bf16 v[148:151], v[140:143], a[8:15], v10
    v_smfmac_f32_16x16x64_bf16 v[152:155], v[140:143], a[32:39], v10
    v_smfmac_f32_16x16x64_bf16 v[156:159], v[140:143], a[56:63], v10
    v_smfmac_f32_16x16x64_bf16 v[160:163], v[140:143], a[80:87], v10
    s_waitcnt vmcnt(6)
    v_smfmac_f32_16x16x64_bf16 v[148:151], v[144:147], a[16:23], v10
    v_smfmac_f32_16x16x64_bf16 v[152:155], v[144:147], a[40:47], v10
    v_smfmac_f32_16x16x64_bf16 v[156:159], v[144:147], a[64:71], v10
    v_smfmac_f32_16x16x64_bf16 v[160:163], v[144:147], a[88:95], v10
    v_pk_add_f32 v[148:149], v[148:149], v[150:151]
    v_cmp_u_f32 vcc, v148, v149
    v_cvt_pk_bf16_f32 v50, v148, v149
    v_cvt_pk_bf16_f32 v54, v148, v149
    v_pk_add_f32 v[152:153], v[152:153], v[154:155]
    v_cvt_pk_bf16_f32 v58, v152, v153
    v_cvt_pk_bf16_f32 v62, v152, v153
    v_pk_add_f32 v[156:157], v[156:157], v[158:159]
    v_cvt_pk_bf16_f32 v66, v156, v157
    v_cvt_pk_bf16_f32 v70, v156, v157
    v_pk_add_f32 v[160:161], v[160:161], v[162:163]
    v_cvt_pk_bf16_f32 v74, v160, v161
    v_cvt_pk_bf16_f32 v78, v160, v161
    s_cbranch_vccnz L_vm_84
L_u_85:
    ds_write_b32 v47, v50 offset:8
    ds_write_b32 v47, v58 offset:6152
    ds_write_b32 v47, v66 offset:12296
    ds_write_b32 v47, v74 offset:18440
    s_cmp_eq_u32 s37, 63
    s_cbranch_scc1 L_wo_tail_s
L_sc_86:
    s_waitcnt vmcnt(2)
    v_pk_add_f32 v[236:237], v[92:93], v[96:97]
    v_pk_add_f32 v[238:239], v[94:95], v[98:99]
    v_add_f32 v43, v104, v105
    s_waitcnt vmcnt(0)
    v_pk_add_f32 v[236:237], v[236:237], v[100:101]
    v_pk_add_f32 v[238:239], v[238:239], v[102:103]
    v_add_f32 v43, v43, v106
    v_max3_f32 v41, v236, v237, v238
    v_max3_f32 v41, v41, v239, v43
    v_pk_add_f32 v[242:243], v[236:237], v[238:239]
    v_add_f32 v242, v242, v43
    v_max_f32_dpp v42, v41, v41 quad_perm:[2,3,0,1] row_mask:0xf bank_mask:0xf
    v_max_f32_dpp v41, v41, v41 quad_perm:[2,3,0,1] row_mask:0xf bank_mask:0xf
    v_cmp_u_f32 vcc, v242, v243
    s_nop 0
    v_permlane16_swap_b32 v41, v42
    v_max_f32 v41, v41, v42
    v_mov_b32 v42, v41
    s_cbranch_vccnz L_sp_87
L_sg_88:
    s_nop 0
    v_permlane32_swap_b32 v41, v42
    v_max_f32 v41, v41, v42
    v_mul_f32 v242, 0xbdd53b95, v41
    v_pk_fma_f32 v[236:237], v[236:237], v[240:241], v[242:243] op_sel_hi:[1,1,0]
    v_pk_fma_f32 v[238:239], v[238:239], v[240:241], v[242:243] op_sel_hi:[1,1,0]
    v_fma_f32 v43, v43, v240, v242
    v_exp_f32 v236, v236
    v_exp_f32 v237, v237
    v_exp_f32 v238, v238
    v_exp_f32 v239, v239
    v_exp_f32 v43, v43
    v_cvt_pk_bf16_f32 v80, v236, v237
    v_cvt_pk_bf16_f32 v82, v238, v239
    v_cvt_pk_bf16_f32 v81, v43, 0
    v_cvt_pk_bf16_f32 v83, v43, 0
    s_nop 1
    v_smfmac_f32_16x16x64_bf16 v[116:119], v[80:83], v[84:91], v11
    v_smfmac_f32_16x16x64_bf16 v[120:123], v[80:83], v[48:55], v11
    v_smfmac_f32_16x16x64_bf16 v[124:127], v[80:83], v[56:63], v11
    v_smfmac_f32_16x16x64_bf16 v[128:131], v[80:83], v[64:71], v11
    v_add_f32 v116, v116, v118
    v_add_f32 v117, v117, v119
    v_smfmac_f32_16x16x64_bf16 v[132:135], v[80:83], v[72:79], v11
    v_rcp_f32 v116, v116
    v_rcp_f32 v117, v117
    v_pk_add_f32 v[120:121], v[120:121], v[122:123]
    v_pk_mul_f32 v[120:121], v[120:121], v[116:117]
    v_cvt_pk_bf16_f32 v236, v120, v121
    v_pk_add_f32 v[124:125], v[124:125], v[126:127]
    v_pk_mul_f32 v[124:125], v[124:125], v[116:117]
    v_cvt_pk_bf16_f32 v237, v124, v125
    ds_write2st64_b32 v18, v236, v237 offset0:0 offset1:1
    v_pk_add_f32 v[128:129], v[128:129], v[130:131]
    v_pk_mul_f32 v[128:129], v[128:129], v[116:117]
    v_cvt_pk_bf16_f32 v238, v128, v129
    v_pk_add_f32 v[132:133], v[132:133], v[134:135]
    v_pk_mul_f32 v[132:133], v[132:133], v[116:117]
    v_cvt_pk_bf16_f32 v239, v132, v133
    ds_write2st64_b32 v18, v238, v239 offset0:2 offset1:3
    v_mov_b32 v120, 0
    v_mov_b32 v121, 0
    v_mov_b32 v122, 0
    v_mov_b32 v123, 0
    v_mov_b32 v124, 0
    v_mov_b32 v125, 0
    v_mov_b32 v126, 0
    v_mov_b32 v127, 0
    v_mov_b32 v128, 0
    v_mov_b32 v129, 0
    s_waitcnt lgkmcnt(0)
    s_barrier
    ds_read_b64_tr_b16 v[80:81], v19
    ds_read_b64_tr_b16 v[82:83], v19 offset:128
    v_mov_b32 v130, 0
    v_mov_b32 v131, 0
    v_mov_b32 v132, 0
    v_mov_b32 v133, 0
    v_mov_b32 v134, 0
    v_mov_b32 v135, 0
    v_mov_b32 v116, 0
    v_mov_b32 v117, 0
    v_mov_b32 v118, 0
    v_mov_b32 v119, 0
    s_waitcnt lgkmcnt(0)
    v_mfma_f32_16x16x32_bf16 v[172:175], v[110:113], v[80:83], 0
    v_mfma_f32_16x16x32_bf16 v[176:179], v[108:111], v[80:83], 0
    buffer_store_dword v107, v244, s[4:7], s38 offen sc1
    buffer_load_dword v36, v33, s[4:7], s38 offen sc1
    s_nop 2
    v_cvt_pk_bf16_f32 v236, v172, v173
    v_cvt_pk_bf16_f32 v237, v174, v175
    s_nop 0
    v_cvt_pk_bf16_f32 v238, v176, v177
    v_cvt_pk_bf16_f32 v239, v178, v179
    buffer_store_dwordx4 v[236:239], v14, s[4:7], s41 offen sc1
    ds_read_b128 v[204:207], v26 offset:0
    ds_read_b128 v[180:183], v29 offset:0
    ds_read_b128 v[184:187], v29 offset:1024
    ds_read_b64 v[208:209], v27 offset:0
    ds_read_b128 v[188:191], v29 offset:2048
    ds_read_b128 v[212:215], v26 offset:1536
    ds_read_b128 v[192:195], v29 offset:3072
    ds_read_b128 v[196:199], v29 offset:4096
    ds_read_b64 v[216:217], v27 offset:1536
    ds_read_b128 v[200:203], v29 offset:5120
    buffer_store_dwordx4 v[220:223], v30, s[4:7], s49 offen sc1
    buffer_load_dwordx4 v[228:231], v31, s[4:7], s51 offen sc1
    s_add_u32 s55, s42, s60
    buffer_store_dword v168, v46, s[4:7], s55 offen sc1
    s_add_u32 s55, s42, s61
    buffer_store_dword v168, v46, s[4:7], s55 offen sc1
    s_waitcnt lgkmcnt(5)
    v_mfma_f32_16x16x32_bf16 v[220:223], v[180:183], v[204:207], 0
    v_mfma_f32_16x16x32_bf16 v[224:227], v[184:187], v[204:207], 0
    v_mfma_f32_16x16x32_bf16 v[224:227], v[188:191], v[208:211], v[224:227]
    ds_read_b128 v[204:207], v26 offset:3072
    ds_read_b128 v[180:183], v29 offset:6144
    ds_read_b128 v[184:187], v29 offset:7168
    ds_read_b64 v[208:209], v27 offset:3072
    ds_read_b128 v[188:191], v29 offset:8192
    s_add_u32 s56, s37, 2
    s_and_b32 s55, s56, 3
    s_mul_i32 s55, s55, 114688
    s_add_u32 s55, s55, 65536
    s_add_u32 s45, s38, s55
    s_add_u32 s46, s45, 4096
    s_add_u32 s47, s45, 8192
    s_add_u32 s56, s37, -1
    s_and_b32 s55, s56, 3
    s_mul_i32 s55, s55, 114688
    s_add_u32 s55, s55, 53248
    s_add_u32 s48, s38, s55
    s_and_b32 s55, s56, 1
    s_add_u32 s56, s56, 1
    v_mov_b32 v35, -16
    v_writelane_b32 v35, s56, 12
    s_mul_i32 s55, s55, 12288
    s_add_u32 m0, s54, s55
    s_waitcnt lgkmcnt(5)
    v_mfma_f32_16x16x32_bf16 v[220:223], v[192:195], v[212:215], v[220:223]
    v_mfma_f32_16x16x32_bf16 v[224:227], v[196:199], v[212:215], v[224:227]
    v_mfma_f32_16x16x32_bf16 v[224:227], v[200:203], v[216:219], v[224:227]
    ds_read_b128 v[212:215], v26 offset:4608
    ds_read_b128 v[192:195], v29 offset:9216
    ds_read_b128 v[196:199], v29 offset:10240
    ds_read_b64 v[216:217], v27 offset:4608
    ds_read_b128 v[200:203], v29 offset:11264
    s_waitcnt lgkmcnt(5)
    v_mfma_f32_16x16x32_bf16 v[220:223], v[180:183], v[204:207], v[220:223]
    v_mfma_f32_16x16x32_bf16 v[224:227], v[184:187], v[204:207], v[224:227]
    v_mfma_f32_16x16x32_bf16 v[224:227], v[188:191], v[208:211], v[224:227]
    s_waitcnt lgkmcnt(0)
    v_mfma_f32_16x16x32_bf16 v[220:223], v[192:195], v[212:215], v[220:223]
    v_mfma_f32_16x16x32_bf16 v[224:227], v[196:199], v[212:215], v[224:227]
    v_mfma_f32_16x16x32_bf16 v[224:227], v[200:203], v[216:219], v[224:227]
    s_waitcnt vmcnt(5)
    v_cmp_lt_i32 vcc, v36, v35
    s_cbranch_vccz L_fok_90
L_fw_89:
    buffer_load_dword v36, v33, s[4:7], s38 offen sc1
    s_sub_u32 s36, s36, 1
    s_cbranch_scc1 L_exit
    s_waitcnt vmcnt(0)
    v_cmp_lt_i32 vcc, v36, v35
    s_cbranch_vccnz L_fw_89
L_fok_90:
    buffer_load_dwordx4 v37, s[4:7], s48 offen offset:0 sc1 lds
    buffer_load_dwordx4 v37, s[4:7], s48 offen offset:1024 sc1 lds
    buffer_load_dwordx4 v37, s[4:7], s48 offen offset:2048 sc1 lds
    v_cvt_pk_bf16_f32 v220, v220, v221
    v_cvt_pk_bf16_f32 v221, v222, v223
    v_cvt_pk_bf16_f32 v222, v224, v225
    v_cvt_pk_bf16_f32 v223, v226, v227
    v_mfma_f32_16x16x32_bf16 v[148:151], a[96:99], a[0:3], 0
    s_add_u32 s56, s37, 1
    v_mov_b32 v47, v24
    v_mfma_f32_16x16x32_bf16 v[152:155], a[120:123], a[0:3], 0
    s_and_b32 s55, s56, 3
    s_mul_i32 s41, s55, 327680
    v_mfma_f32_16x16x32_bf16 v[156:159], a[96:99], a[24:27], 0
    s_mul_i32 s56, s55, 114688
    s_add_u32 s43, s38, s56
    v_mfma_f32_16x16x32_bf16 v[160:163], a[120:123], a[24:27], 0
    s_xor_b32 s55, s55, 2
    s_mul_i32 s42, s55, 327680
    v_mfma_f32_16x16x32_bf16 v[180:183], a[96:99], a[48:51], 0
    s_add_u32 s56, s37, 2
    v_mov_b32 v107, s56
    v_mfma_f32_16x16x32_bf16 v[184:187], a[120:123], a[48:51], 0
    s_and_b32 s55, s56, 3
    s_mul_i32 s44, s55, 24576
    v_mfma_f32_16x16x32_bf16 v[188:191], a[96:99], a[72:75], 0
    s_mov_b32 s50, s52
    s_add_u32 s56, s37, -2
    v_mfma_f32_16x16x32_bf16 v[192:195], a[120:123], a[72:75], 0
    buffer_load_dwordx4 a[96:99], v40, s[4:7], s45 offen offset:0 sc1
    v_mfma_f32_16x16x32_bf16 v[148:151], a[100:103], a[4:7], v[148:151]
    s_and_b32 s55, s56, 3
    s_mul_i32 s55, s55, 327680
    v_mfma_f32_16x16x32_bf16 v[152:155], a[124:127], a[4:7], v[152:155]
    buffer_load_dwordx4 a[120:123], v40, s[4:7], s46 offen offset:2048 sc1
    v_mfma_f32_16x16x32_bf16 v[156:159], a[100:103], a[28:31], v[156:159]
    s_add_u32 s49, s55, 4194304
    s_add_u32 s56, s37, -4
    v_mfma_f32_16x16x32_bf16 v[160:163], a[124:127], a[28:31], v[160:163]
    s_and_b32 s55, s56, 3
    s_mul_i32 s55, s55, 327680
    v_mfma_f32_16x16x32_bf16 v[180:183], a[100:103], a[52:55], v[180:183]
    s_add_u32 s51, s55, 4194304
    s_mul_i32 s52, s56, 81920
    v_mfma_f32_16x16x32_bf16 v[184:187], a[124:127], a[52:55], v[184:187]
    s_add_u32 s56, s37, -1
    s_and_b32 s55, s56, 3
    v_mfma_f32_16x16x32_bf16 v[188:191], a[100:103], a[76:79], v[188:191]
    s_mul_i32 s55, s55, 24576
    v_add_u32 v26, s55, v22
    v_mfma_f32_16x16x32_bf16 v[192:195], a[124:127], a[76:79], v[192:195]
    buffer_load_dwordx4 a[100:103], v40, s[4:7], s45 offen offset:1024 sc1
    v_mfma_f32_16x16x32_bf16 v[148:151], a[104:107], a[8:11], v[148:151]
    v_add_u32 v27, s55, v23
    s_and_b32 s55, s56, 1
    v_mfma_f32_16x16x32_bf16 v[152:155], a[128:131], a[8:11], v[152:155]
    buffer_load_dwordx4 a[124:127], v40, s[4:7], s46 offen offset:3072 sc1
    v_mfma_f32_16x16x32_bf16 v[156:159], a[104:107], a[32:35], v[156:159]
    s_mul_i32 s55, s55, 12288
    v_add_u32 v29, s55, v28
    v_mfma_f32_16x16x32_bf16 v[160:163], a[128:131], a[32:35], v[160:163]
    v_mfma_f32_16x16x32_bf16 v[180:183], a[104:107], a[56:59], v[180:183]
    v_mfma_f32_16x16x32_bf16 v[184:187], a[128:131], a[56:59], v[184:187]
    v_mfma_f32_16x16x32_bf16 v[188:191], a[104:107], a[80:83], v[188:191]
    v_mfma_f32_16x16x32_bf16 v[192:195], a[128:131], a[80:83], v[192:195]
    buffer_load_dwordx4 a[104:107], v40, s[4:7], s45 offen offset:2048 sc1
    v_mfma_f32_16x16x32_bf16 v[148:151], a[108:111], a[12:15], v[148:151]
    v_mfma_f32_16x16x32_bf16 v[152:155], a[132:135], a[12:15], v[152:155]
    buffer_load_dwordx4 a[128:131], v40, s[4:7], s47 offen offset:0 sc1
    v_mfma_f32_16x16x32_bf16 v[156:159], a[108:111], a[36:39], v[156:159]
    v_mfma_f32_16x16x32_bf16 v[160:163], a[132:135], a[36:39], v[160:163]
    v_mfma_f32_16x16x32_bf16 v[180:183], a[108:111], a[60:63], v[180:183]
    v_mfma_f32_16x16x32_bf16 v[184:187], a[132:135], a[60:63], v[184:187]
    v_mfma_f32_16x16x32_bf16 v[188:191], a[108:111], a[84:87], v[188:191]
    v_mfma_f32_16x16x32_bf16 v[192:195], a[132:135], a[84:87], v[192:195]
    buffer_load_dwordx4 a[108:111], v40, s[4:7], s45 offen offset:3072 sc1
    v_mfma_f32_16x16x32_bf16 v[148:151], a[112:115], a[16:19], v[148:151]
    v_mfma_f32_16x16x32_bf16 v[152:155], a[136:139], a[16:19], v[152:155]
    buffer_load_dwordx4 a[132:135], v40, s[4:7], s47 offen offset:1024 sc1
    v_mfma_f32_16x16x32_bf16 v[156:159], a[112:115], a[40:43], v[156:159]
    v_mfma_f32_16x16x32_bf16 v[160:163], a[136:139], a[40:43], v[160:163]
    v_mfma_f32_16x16x32_bf16 v[180:183], a[112:115], a[64:67], v[180:183]
    v_mfma_f32_16x16x32_bf16 v[184:187], a[136:139], a[64:67], v[184:187]
    v_mfma_f32_16x16x32_bf16 v[188:191], a[112:115], a[88:91], v[188:191]
    v_mfma_f32_16x16x32_bf16 v[192:195], a[136:139], a[88:91], v[192:195]
    buffer_load_dwordx4 a[112:115], v40, s[4:7], s46 offen offset:0 sc1
    v_mfma_f32_16x16x32_bf16 v[148:151], a[116:119], a[20:23], v[148:151]
    v_mfma_f32_16x16x32_bf16 v[152:155], a[140:143], a[20:23], v[152:155]
    buffer_load_dwordx4 a[136:139], v40, s[4:7], s47 offen offset:2048 sc1
    v_mfma_f32_16x16x32_bf16 v[156:159], a[116:119], a[44:47], v[156:159]
    v_mfma_f32_16x16x32_bf16 v[160:163], a[140:143], a[44:47], v[160:163]
    v_mfma_f32_16x16x32_bf16 v[180:183], a[116:119], a[68:71], v[180:183]
    v_mfma_f32_16x16x32_bf16 v[184:187], a[140:143], a[68:71], v[184:187]
    v_mfma_f32_16x16x32_bf16 v[188:191], a[116:119], a[92:95], v[188:191]
    v_mfma_f32_16x16x32_bf16 v[192:195], a[140:143], a[92:95], v[192:195]
    buffer_load_dwordx4 a[116:119], v40, s[4:7], s46 offen offset:1024 sc1
    buffer_load_dwordx4 a[140:143], v40, s[4:7], s47 offen offset:3072 sc1
    s_cmp_lt_u32 s37, 5
    s_nop 0
    s_cbranch_scc1 L_g_91
    s_waitcnt vmcnt(17)
    v_mfma_f32_16x16x32_bf16 v[232:235], a[144:147], v[228:231], 0
    s_nop 7
    v_cndmask_b32 v234, v232, v233, s[58:59]
    v_cndmask_b32 v235, v233, v232, s[58:59]
    s_nop 1
    v_add_f32_dpp v235, v234, v235 row_ror:8 row_mask:0xf bank_mask:0xf
    v_cvt_pk_bf16_f32 v235, v235, v235
    buffer_store_short v235, v32, s[28:31], s50 offen
L_g_91:
    v_cvt_pk_bf16_f32 v64, v180, v181
    v_cvt_pk_bf16_f32 v65, v182, v183
    ds_write_b64 v24, v[64:65] offset:12288
    v_cvt_pk_bf16_f32 v68, v184, v185
    v_cvt_pk_bf16_f32 v69, v186, v187
    ds_write_b64 v25, v[68:69] offset:12288
    v_cvt_pk_bf16_f32 v72, v188, v189
    v_cvt_pk_bf16_f32 v73, v190, v191
    ds_write_b64 v24, v[72:73] offset:18432
    v_cvt_pk_bf16_f32 v76, v192, v193
    v_cvt_pk_bf16_f32 v77, v194, v195
    ds_write_b64 v25, v[76:77] offset:18432
    v_cvt_pk_bf16_f32 v48, v148, v149
    v_cvt_pk_bf16_f32 v49, v150, v151
    ds_write_b64 v24, v[48:49] offset:0
    v_cvt_pk_bf16_f32 v52, v152, v153
    v_cvt_pk_bf16_f32 v53, v154, v155
    ds_write_b64 v25, v[52:53] offset:0
    v_cvt_pk_bf16_f32 v56, v156, v157
    v_cvt_pk_bf16_f32 v57, v158, v159
    ds_write_b64 v24, v[56:57] offset:6144
    v_cvt_pk_bf16_f32 v60, v160, v161
    v_cvt_pk_bf16_f32 v61, v162, v163
    ds_write_b64 v25, v[60:61] offset:6144
    s_add_u32 s37, s37, 1
    v_add_u32 v24, s44, v20
    v_add_u32 v25, s44, v21
    v_pk_mul_f32 v[148:149], v[210:211], v[210:211]
    v_pk_mul_f32 v[150:151], v[210:211], v[210:211]
    v_pk_mul_f32 v[152:153], v[210:211], v[210:211]
    v_pk_mul_f32 v[154:155], v[210:211], v[210:211]
    v_pk_mul_f32 v[156:157], v[210:211], v[210:211]
    v_pk_mul_f32 v[158:159], v[210:211], v[210:211]
    v_pk_mul_f32 v[160:161], v[210:211], v[210:211]
    v_pk_mul_f32 v[162:163], v[210:211], v[210:211]
    s_branch L_wo_loop_s
L_wo_tail_s:
    buffer_store_dwordx4 v[220:223], v30, s[4:7], s49 offen sc1
    s_waitcnt vmcnt(0) lgkmcnt(0)
    s_barrier
    s_add_u32 s56, s37, -1
    s_and_b32 s55, s56, 3
    s_mul_i32 s55, s55, 114688
    s_add_u32 s55, s55, 53248
    s_add_u32 s48, s38, s55
    s_and_b32 s55, s56, 1
    s_add_u32 s56, s56, 1
    v_mov_b32 v35, -16
    v_writelane_b32 v35, s56, 12
    s_mul_i32 s55, s55, 12288
    s_add_u32 m0, s54, s55
    buffer_load_dword v36, v33, s[4:7], s38 offen sc1
    s_add_u32 s56, s37, -2
    s_and_b32 s55, s56, 3
    s_mul_i32 s55, s55, 24576
    v_add_u32 v26, s55, v22
    v_add_u32 v27, s55, v23
    s_and_b32 s55, s56, 1
    s_mul_i32 s55, s55, 12288
    v_add_u32 v29, s55, v28
    s_mov_b32 s49, 5505024
    ds_read_b128 v[204:207], v26 offset:0
    ds_read_b128 v[180:183], v29 offset:0
    ds_read_b128 v[184:187], v29 offset:1024
    ds_read_b64 v[208:209], v27 offset:0
    ds_read_b128 v[188:191], v29 offset:2048
    ds_read_b128 v[212:215], v26 offset:1536
    ds_read_b128 v[192:195], v29 offset:3072
    ds_read_b128 v[196:199], v29 offset:4096
    ds_read_b64 v[216:217], v27 offset:1536
    ds_read_b128 v[200:203], v29 offset:5120
    s_waitcnt lgkmcnt(5)
    v_mfma_f32_16x16x32_bf16 v[220:223], v[180:183], v[204:207], 0
    v_mfma_f32_16x16x32_bf16 v[224:227], v[184:187], v[204:207], 0
    v_mfma_f32_16x16x32_bf16 v[224:227], v[188:191], v[208:211], v[224:227]
    ds_read_b128 v[204:207], v26 offset:3072
    ds_read_b128 v[180:183], v29 offset:6144
    ds_read_b128 v[184:187], v29 offset:7168
    ds_read_b64 v[208:209], v27 offset:3072
    ds_read_b128 v[188:191], v29 offset:8192
    s_waitcnt lgkmcnt(5)
    v_mfma_f32_16x16x32_bf16 v[220:223], v[192:195], v[212:215], v[220:223]
    v_mfma_f32_16x16x32_bf16 v[224:227], v[196:199], v[212:215], v[224:227]
    v_mfma_f32_16x16x32_bf16 v[224:227], v[200:203], v[216:219], v[224:227]
    ds_read_b128 v[212:215], v26 offset:4608
    ds_read_b128 v[192:195], v29 offset:9216
    ds_read_b128 v[196:199], v29 offset:10240
    ds_read_b64 v[216:217], v27 offset:4608
    ds_read_b128 v[200:203], v29 offset:11264
    s_waitcnt lgkmcnt(5)
    v_mfma_f32_16x16x32_bf16 v[220:223], v[180:183], v[204:207], v[220:223]
    v_mfma_f32_16x16x32_bf16 v[224:227], v[184:187], v[204:207], v[224:227]
    v_mfma_f32_16x16x32_bf16 v[224:227], v[188:191], v[208:211], v[224:227]
    s_waitcnt lgkmcnt(0)
    v_mfma_f32_16x16x32_bf16 v[220:223], v[192:195], v[212:215], v[220:223]
    v_mfma_f32_16x16x32_bf16 v[224:227], v[196:199], v[212:215], v[224:227]
    v_mfma_f32_16x16x32_bf16 v[224:227], v[200:203], v[216:219], v[224:227]
    s_nop 0
    v_cvt_pk_bf16_f32 v220, v220, v221
    v_cvt_pk_bf16_f32 v221, v222, v223
    s_nop 4
    v_cvt_pk_bf16_f32 v222, v224, v225
    v_cvt_pk_bf16_f32 v223, v226, v227
    buffer_store_dwordx4 v[220:223], v30, s[4:7], s49 offen sc1
    s_waitcnt vmcnt(1)
    v_cmp_lt_i32 vcc, v36, v35
    s_cbranch_vccz L_fok_93
L_fw_92:
    buffer_load_dword v36, v33, s[4:7], s38 offen sc1
    s_sub_u32 s36, s36, 1
    s_cbranch_scc1 L_exit
    s_waitcnt vmcnt(0)
    v_cmp_lt_i32 vcc, v36, v35
    s_cbranch_vccnz L_fw_92
L_fok_93:
    buffer_load_dwordx4 v37, s[4:7], s48 offen offset:0 sc1 lds
    buffer_load_dwordx4 v37, s[4:7], s48 offen offset:1024 sc1 lds
    buffer_load_dwordx4 v37, s[4:7], s48 offen offset:2048 sc1 lds
    s_waitcnt vmcnt(0) lgkmcnt(0)
    s_barrier
    s_add_u32 s56, s37, -1
    s_and_b32 s55, s56, 3
    s_mul_i32 s55, s55, 24576
    v_add_u32 v26, s55, v22
    v_add_u32 v27, s55, v23
    s_and_b32 s55, s56, 1
    s_mul_i32 s55, s55, 12288
    v_add_u32 v29, s55, v28
    s_mov_b32 s49, 5832704
    ds_read_b128 v[204:207], v26 offset:0
    ds_read_b128 v[180:183], v29 offset:0
    ds_read_b128 v[184:187], v29 offset:1024
    ds_read_b64 v[208:209], v27 offset:0
    ds_read_b128 v[188:191], v29 offset:2048
    ds_read_b128 v[212:215], v26 offset:1536
    ds_read_b128 v[192:195], v29 offset:3072
    ds_read_b128 v[196:199], v29 offset:4096
    ds_read_b64 v[216:217], v27 offset:1536
    ds_read_b128 v[200:203], v29 offset:5120
    s_waitcnt lgkmcnt(5)
    v_mfma_f32_16x16x32_bf16 v[220:223], v[180:183], v[204:207], 0
    v_mfma_f32_16x16x32_bf16 v[224:227], v[184:187], v[204:207], 0
    v_mfma_f32_16x16x32_bf16 v[224:227], v[188:191], v[208:211], v[224:227]
    ds_read_b128 v[204:207], v26 offset:3072
    ds_read_b128 v[180:183], v29 offset:6144
    ds_read_b128 v[184:187], v29 offset:7168
    ds_read_b64 v[208:209], v27 offset:3072
    ds_read_b128 v[188:191], v29 offset:8192
    s_waitcnt lgkmcnt(5)
    v_mfma_f32_16x16x32_bf16 v[220:223], v[192:195], v[212:215], v[220:223]
    v_mfma_f32_16x16x32_bf16 v[224:227], v[196:199], v[212:215], v[224:227]
    v_mfma_f32_16x16x32_bf16 v[224:227], v[200:203], v[216:219], v[224:227]
    ds_read_b128 v[212:215], v26 offset:4608
    ds_read_b128 v[192:195], v29 offset:9216
    ds_read_b128 v[196:199], v29 offset:10240
    ds_read_b64 v[216:217], v27 offset:4608
    ds_read_b128 v[200:203], v29 offset:11264
    s_waitcnt lgkmcnt(5)
    v_mfma_f32_16x16x32_bf16 v[220:223], v[180:183], v[204:207], v[220:223]
    v_mfma_f32_16x16x32_bf16 v[224:227], v[184:187], v[204:207], v[224:227]
    v_mfma_f32_16x16x32_bf16 v[224:227], v[188:191], v[208:211], v[224:227]
    s_waitcnt lgkmcnt(0)
    v_mfma_f32_16x16x32_bf16 v[220:223], v[192:195], v[212:215], v[220:223]
    v_mfma_f32_16x16x32_bf16 v[224:227], v[196:199], v[212:215], v[224:227]
    v_mfma_f32_16x16x32_bf16 v[224:227], v[200:203], v[216:219], v[224:227]
    s_nop 0
    v_cvt_pk_bf16_f32 v220, v220, v221
    v_cvt_pk_bf16_f32 v221, v222, v223
    s_nop 4
    v_cvt_pk_bf16_f32 v222, v224, v225
    v_cvt_pk_bf16_f32 v223, v226, v227
    buffer_store_dwordx4 v[220:223], v30, s[4:7], s49 offen sc1
    s_mov_b32 s51, 5832704
L_fp_94:
    buffer_load_dwordx4 v[120:123], v31, s[4:7], s51 offen sc1
    s_sub_u32 s36, s36, 1
    s_cbranch_scc1 L_exit
    s_waitcnt vmcnt(0)
    v_max3_u32 v41, v120, v121, v122
    v_max_u32 v41, v41, v123
    v_cmp_eq_u32 vcc, -1, v41
    s_cbranch_vccnz L_fp_94
    s_mov_b32 s51, 4849664
    buffer_load_dwordx4 v[148:151], v31, s[4:7], s51 offen sc1
    s_mov_b32 s51, 5177344
    buffer_load_dwordx4 v[152:155], v31, s[4:7], s51 offen sc1
    s_mov_b32 s51, 4194304
    buffer_load_dwordx4 v[156:159], v31, s[4:7], s51 offen sc1
    s_mov_b32 s51, 5505024
    buffer_load_dwordx4 v[160:163], v31, s[4:7], s51 offen sc1
    s_mov_b32 s52, 5079040
    v_mfma_f32_16x16x32_bf16 v[232:235], a[144:147], v[120:123], 0
    s_nop 7
    v_cndmask_b32 v234, v232, v233, s[58:59]
    v_cndmask_b32 v235, v233, v232, s[58:59]
    s_nop 1
    v_add_f32_dpp v235, v234, v235 row_ror:8 row_mask:0xf bank_mask:0xf
    v_cvt_pk_bf16_f32 v235, v235, v235
    buffer_store_short v235, v32, s[28:31], s52 offen
    s_waitcnt vmcnt(1)
    s_mov_b32 s52, 4751360
    v_mfma_f32_16x16x32_bf16 v[232:235], a[144:147], v[148:151], 0
    s_nop 7
    v_cndmask_b32 v234, v232, v233, s[58:59]
    v_cndmask_b32 v235, v233, v232, s[58:59]
    s_nop 1
    v_add_f32_dpp v235, v234, v235 row_ror:8 row_mask:0xf bank_mask:0xf
    v_cvt_pk_bf16_f32 v235, v235, v235
    buffer_store_short v235, v32, s[28:31], s52 offen
    s_mov_b32 s52, 4833280
    v_mfma_f32_16x16x32_bf16 v[232:235], a[144:147], v[152:155], 0
    s_nop 7
    v_cndmask_b32 v234, v232, v233, s[58:59]
    v_cndmask_b32 v235, v233, v232, s[58:59]
    s_nop 1
    v_add_f32_dpp v235, v234, v235 row_ror:8 row_mask:0xf bank_mask:0xf
    v_cvt_pk_bf16_f32 v235, v235, v235
    buffer_store_short v235, v32, s[28:31], s52 offen
    s_mov_b32 s52, 4915200
    v_mfma_f32_16x16x32_bf16 v[232:235], a[144:147], v[156:159], 0
    s_nop 7
    v_cndmask_b32 v234, v232, v233, s[58:59]
    v_cndmask_b32 v235, v233, v232, s[58:59]
    s_nop 1
    v_add_f32_dpp v235, v234, v235 row_ror:8 row_mask:0xf bank_mask:0xf
    v_cvt_pk_bf16_f32 v235, v235, v235
    buffer_store_short v235, v32, s[28:31], s52 offen
    s_mov_b32 s52, 4997120
    v_mfma_f32_16x16x32_bf16 v[232:235], a[144:147], v[160:163], 0
    s_nop 7
    v_cndmask_b32 v234, v232, v233, s[58:59]
    v_cndmask_b32 v235, v233, v232, s[58:59]
    s_nop 1
    v_add_f32_dpp v235, v234, v235 row_ror:8 row_mask:0xf bank_mask:0xf
    v_cvt_pk_bf16_f32 v235, v235, v235
    buffer_store_short v235, v32, s[28:31], s52 offen
    s_add_u32 s56, s37, 0
    s_and_b32 s55, s56, 3
    s_mul_i32 s55, s55, 114688
    s_add_u32 s55, s55, 53248
    s_add_u32 s48, s38, s55
    s_and_b32 s55, s56, 1
    s_add_u32 s56, s56, 1
    v_mov_b32 v35, -16
    v_writelane_b32 v35, s56, 12
    s_mul_i32 s55, s55, 12288
    s_add_u32 m0, s54, s55
    buffer_load_dword v36, v33, s[4:7], s38 offen sc1
    s_waitcnt vmcnt(0)
    v_cmp_lt_i32 vcc, v36, v35
    s_cbranch_vccz L_fok_96
L_fw_95:
    buffer_load_dword v36, v33, s[4:7], s38 offen sc1
    s_sub_u32 s36, s36, 1
    s_cbranch_scc1 L_exit
    s_waitcnt vmcnt(0)
    v_cmp_lt_i32 vcc, v36, v35
    s_cbranch_vccnz L_fw_95
L_fok_96:
    buffer_load_dwordx4 v37, s[4:7], s48 offen offset:0 sc1 lds
    buffer_load_dwordx4 v37, s[4:7], s48 offen offset:1024 sc1 lds
    buffer_load_dwordx4 v37, s[4:7], s48 offen offset:2048 sc1 lds
    s_waitcnt vmcnt(0) lgkmcnt(0)
    s_barrier
    s_add_u32 s56, s37, 0
    s_and_b32 s55, s56, 3
    s_mul_i32 s55, s55, 24576
    v_add_u32 v26, s55, v22
    v_add_u32 v27, s55, v23
    s_and_b32 s55, s56, 1
    s_mul_i32 s55, s55, 12288
    v_add_u32 v29, s55, v28
    s_mov_b32 s49, 6160384
    ds_read_b128 v[204:207], v26 offset:0
    ds_read_b128 v[180:183], v29 offset:0
    ds_read_b128 v[184:187], v29 offset:1024
    ds_read_b64 v[208:209], v27 offset:0
    ds_read_b128 v[188:191], v29 offset:2048
    ds_read_b128 v[212:215], v26 offset:1536
    ds_read_b128 v[192:195], v29 offset:3072
    ds_read_b128 v[196:199], v29 offset:4096
    ds_read_b64 v[216:217], v27 offset:1536
    ds_read_b128 v[200:203], v29 offset:5120
    s_waitcnt lgkmcnt(5)
    v_mfma_f32_16x16x32_bf16 v[220:223], v[180:183], v[204:207], 0
    v_mfma_f32_16x16x32_bf16 v[224:227], v[184:187], v[204:207], 0
    v_mfma_f32_16x16x32_bf16 v[224:227], v[188:191], v[208:211], v[224:227]
    ds_read_b128 v[204:207], v26 offset:3072
    ds_read_b128 v[180:183], v29 offset:6144
    ds_read_b128 v[184:187], v29 offset:7168
    ds_read_b64 v[208:209], v27 offset:3072
    ds_read_b128 v[188:191], v29 offset:8192
    s_waitcnt lgkmcnt(5)
    v_mfma_f32_16x16x32_bf16 v[220:223], v[192:195], v[212:215], v[220:223]
    v_mfma_f32_16x16x32_bf16 v[224:227], v[196:199], v[212:215], v[224:227]
    v_mfma_f32_16x16x32_bf16 v[224:227], v[200:203], v[216:219], v[224:227]
    ds_read_b128 v[212:215], v26 offset:4608
    ds_read_b128 v[192:195], v29 offset:9216
    ds_read_b128 v[196:199], v29 offset:10240
    ds_read_b64 v[216:217], v27 offset:4608
    ds_read_b128 v[200:203], v29 offset:11264
    s_waitcnt lgkmcnt(5)
    v_mfma_f32_16x16x32_bf16 v[220:223], v[180:183], v[204:207], v[220:223]
    v_mfma_f32_16x16x32_bf16 v[224:227], v[184:187], v[204:207], v[224:227]
    v_mfma_f32_16x16x32_bf16 v[224:227], v[188:191], v[208:211], v[224:227]
    s_waitcnt lgkmcnt(0)
    v_mfma_f32_16x16x32_bf16 v[220:223], v[192:195], v[212:215], v[220:223]
    v_mfma_f32_16x16x32_bf16 v[224:227], v[196:199], v[212:215], v[224:227]
    v_mfma_f32_16x16x32_bf16 v[224:227], v[200:203], v[216:219], v[224:227]
    s_nop 0
    v_cvt_pk_bf16_f32 v220, v220, v221
    v_cvt_pk_bf16_f32 v221, v222, v223
    s_nop 4
    v_cvt_pk_bf16_f32 v222, v224, v225
    v_cvt_pk_bf16_f32 v223, v226, v227
    buffer_store_dwordx4 v[220:223], v30, s[4:7], s49 offen sc1
    s_mov_b32 s51, 6160384
L_fp_97:
    buffer_load_dwordx4 v[120:123], v31, s[4:7], s51 offen sc1
    s_sub_u32 s36, s36, 1
    s_cbranch_scc1 L_exit
    s_waitcnt vmcnt(0)
    v_max3_u32 v41, v120, v121, v122
    v_max_u32 v41, v41, v123
    v_cmp_eq_u32 vcc, -1, v41
    s_cbranch_vccnz L_fp_97
    s_mov_b32 s52, 5160960
    v_mfma_f32_16x16x32_bf16 v[232:235], a[144:147], v[120:123], 0
    s_nop 7
    v_cndmask_b32 v234, v232, v233, s[58:59]
    v_cndmask_b32 v235, v233, v232, s[58:59]
    s_nop 1
    v_add_f32_dpp v235, v234, v235 row_ror:8 row_mask:0xf bank_mask:0xf
    v_cvt_pk_bf16_f32 v235, v235, v235
    buffer_store_short v235, v32, s[28:31], s52 offen
    s_endpgm
L_vm_84:
    buffer_load_dwordx4 v[136:139], v44, s[4:7], s43 offen offset:0 sc1
    buffer_load_dwordx4 v[140:143], v44, s[4:7], s43 offen offset:1024 sc1
    buffer_load_dwordx4 v[144:147], v44, s[4:7], s43 offen offset:2048 sc1
    s_sub_u32 s36, s36, 1
    s_cbranch_scc1 L_exit
    s_waitcnt vmcnt(0)
    v_max_u32 v4, v136, v137
    v_max3_u32 v4, v4, v138, v139
    v_max3_u32 v4, v4, v140, v141
    v_max3_u32 v4, v4, v142, v143
    v_max3_u32 v4, v4, v144, v145
    v_max3_u32 v4, v4, v146, v147
    v_cmp_eq_u32 vcc, -1, v4
    s_cbranch_vccnz L_vm_84
    buffer_load_dwordx4 v[92:95], v38, s[4:7], s43 offen offset:0 sc1
    buffer_load_dword v104, v39, s[4:7], s43 offen offset:0 sc1
    buffer_load_dwordx4 v[96:99], v38, s[4:7], s43 offen offset:1280 sc1
    buffer_load_dword v105, v39, s[4:7], s43 offen offset:1280 sc1
    buffer_load_dwordx4 v[100:103], v38, s[4:7], s43 offen offset:2560 sc1
    buffer_load_dword v106, v39, s[4:7], s43 offen offset:2560 sc1
    v_mov_b32 v148, 0
    v_mov_b32 v149, 0
    v_mov_b32 v150, 0
    v_mov_b32 v151, 0
    v_mov_b32 v152, 0
    v_mov_b32 v153, 0
    v_mov_b32 v154, 0
    v_mov_b32 v155, 0
    v_mov_b32 v156, 0
    v_mov_b32 v157, 0
    v_mov_b32 v158, 0
    v_mov_b32 v159, 0
    v_mov_b32 v160, 0
    v_mov_b32 v161, 0
    v_mov_b32 v162, 0
    v_mov_b32 v163, 0
    v_smfmac_f32_16x16x64_bf16 v[148:151], v[136:139], a[0:7], v10
    v_smfmac_f32_16x16x64_bf16 v[152:155], v[136:139], a[24:31], v10
    v_smfmac_f32_16x16x64_bf16 v[156:159], v[136:139], a[48:55], v10
    v_smfmac_f32_16x16x64_bf16 v[160:163], v[136:139], a[72:79], v10
    v_smfmac_f32_16x16x64_bf16 v[148:151], v[140:143], a[8:15], v10
    v_smfmac_f32_16x16x64_bf16 v[152:155], v[140:143], a[32:39], v10
    v_smfmac_f32_16x16x64_bf16 v[156:159], v[140:143], a[56:63], v10
    v_smfmac_f32_16x16x64_bf16 v[160:163], v[140:143], a[80:87], v10
    v_smfmac_f32_16x16x64_bf16 v[148:151], v[144:147], a[16:23], v10
    v_smfmac_f32_16x16x64_bf16 v[152:155], v[144:147], a[40:47], v10
    v_smfmac_f32_16x16x64_bf16 v[156:159], v[144:147], a[64:71], v10
    v_smfmac_f32_16x16x64_bf16 v[160:163], v[144:147], a[88:95], v10
    v_pk_add_f32 v[148:149], v[148:149], v[150:151]
    v_cmp_u_f32 vcc, v148, v149
    v_cvt_pk_bf16_f32 v50, v148, v149
    v_cvt_pk_bf16_f32 v54, v148, v149
    v_pk_add_f32 v[152:153], v[152:153], v[154:155]
    v_cvt_pk_bf16_f32 v58, v152, v153
    v_cvt_pk_bf16_f32 v62, v152, v153
    v_pk_add_f32 v[156:157], v[156:157], v[158:159]
    v_cvt_pk_bf16_f32 v66, v156, v157
    v_cvt_pk_bf16_f32 v70, v156, v157
    v_pk_add_f32 v[160:161], v[160:161], v[162:163]
    v_cvt_pk_bf16_f32 v74, v160, v161
    v_cvt_pk_bf16_f32 v78, v160, v161
    s_branch L_u_85
L_sp_87:
    v_max3_u32 v4, v104, v105, v106
    v_max3_u32 v4, v4, v92, v93
    v_max3_u32 v4, v4, v94, v95
    v_max3_u32 v4, v4, v96, v97
    v_max3_u32 v4, v4, v98, v99
    v_max3_u32 v4, v4, v100, v101
    v_max3_u32 v4, v4, v102, v103
    v_cmp_eq_u32 vcc, -1, v4
    s_cbranch_vccz L_sg_88
    buffer_load_dwordx4 v[92:95], v38, s[4:7], s43 offen offset:0 sc1
    buffer_load_dword v104, v39, s[4:7], s43 offen offset:0 sc1
    buffer_load_dwordx4 v[96:99], v38, s[4:7], s43 offen offset:1280 sc1
    buffer_load_dword v105, v39, s[4:7], s43 offen offset:1280 sc1
    buffer_load_dwordx4 v[100:103], v38, s[4:7], s43 offen offset:2560 sc1
    buffer_load_dword v106, v39, s[4:7], s43 offen offset:2560 sc1
    s_sub_u32 s36, s36, 1
    s_cbranch_scc1 L_exit
    s_branch L_sc_86
L_px_s:
    v_and_b32 v1, 15, v0
    v_lshrrev_b32 v2, 4, v0
    s_mul_i32 s90, s32, 12288
    v_lshl_add_u32 v10, v0, 4, s90
    s_mul_i32 s90, s32, 3072
    v_lshl_add_u32 v12, v0, 4, s90
    v_lshrrev_b32 v3, 2, v1
    v_lshlrev_b32 v3, 1, v3
    v_and_b32 v4, 1, v1
    v_or_b32 v3, v3, v4
    v_lshl_add_u32 v3, v2, 3, v3
    v_lshl_add_u32 v11, v3, 4, s90
    s_lshl_b32 s90, s32, 7
    v_min_u32 v3, 11, v0
    v_lshl_add_u32 v3, v3, 2, s90
    v_add_u32 v13, 458752, v3
    v_min_u32 v3, 2, v0
    v_lshl_add_u32 v3, v3, 2, s90
    v_add_u32 v14, 459264, v3
    v_add_u32 v22, 462336, v3
    s_add_u32 s90, s90, 459776
    v_mov_b32 v15, s90
    v_cmp_eq_u32 vcc, 0, v0
    v_mov_b32 v9, 2146435072
    s_nop 0
    v_cndmask_b32 v15, v9, v15, vcc
    s_nop 0
    v_mov_b32 v21, 0xd04e79ff
    s_mov_b32 s44, 0x3dd53b95
    v_lshl_add_u32 v3, v2, 2, 0
    v_cmp_le_u32 s[48:49], v3, v1
    v_lshl_add_u32 v3, v2, 2, 1
    v_cmp_le_u32 s[50:51], v3, v1
    v_lshl_add_u32 v3, v2, 2, 2
    v_cmp_le_u32 s[52:53], v3, v1
    v_lshl_add_u32 v3, v2, 2, 3
    v_cmp_le_u32 s[54:55], v3, v1
    v_mov_b32 v167, 0
    v_mov_b32 v171, 0
    v_mov_b32 v174, 0
    v_mov_b32 v175, 0
    s_waitcnt vmcnt(0)
    s_barrier
    s_mov_b32 s37, 0
    s_or_b32 s90, s34, s32
    s_cbranch_scc1 L_xg_98c
    v_lshlrev_b32 v1, 2, v0
L_arp_100:
    buffer_load_dword v2, v1, s[8:11], 0 offen sc1
    s_sub_u32 s36, s36, 1
    s_cbranch_scc1 L_exit
    s_waitcnt vmcnt(0)
    v_readlane_b32 s92, v2, 17
    s_nop 0
    s_cmp_lg_u32 s92, 256
    s_cbranch_scc1 L_arp_100
    v_mov_b32 v1, 196
    v_mov_b32 v2, 1
    s_mov_b64 exec, 1
    buffer_store_dword v2, v1, s[8:11], 0 offen sc1
    s_mov_b64 exec, -1
L_arr_99:
L_xg_98c:
    s_barrier
    v_mov_b32 v1, 196
L_gw_101:
    buffer_load_dword v2, v1, s[8:11], 0 offen sc1
    s_sub_u32 s36, s36, 1
    s_cbranch_scc1 L_exit
    s_waitcnt vmcnt(0)
    v_readfirstlane_b32 s90, v2
    s_nop 0
    s_cmp_eq_u32 s90, 0
    s_cbranch_scc1 L_gw_101
    s_cmp_lg_u32 s32, 0
    s_cbranch_scc1 L_xg_98
    s_lshl_b32 s92, s34, 14
    s_add_u32 s92, s92, 1966080
    s_add_u32 s93, s92, 8192
    v_lshlrev_b32 v3, 4, v0
    buffer_store_dwordx4 v[24:27], v3, s[4:7], s92 offen offset:0 sc1
    buffer_store_dwordx4 v[24:27], v3, s[4:7], s93 offen offset:0 sc1
    buffer_store_dwordx4 v[24:27], v3, s[4:7], s92 offen offset:1024 sc1
    buffer_store_dwordx4 v[24:27], v3, s[4:7], s93 offen offset:1024 sc1
    buffer_store_dwordx4 v[24:27], v3, s[4:7], s92 offen offset:2048 sc1
    buffer_store_dwordx4 v[24:27], v3, s[4:7], s93 offen offset:2048 sc1
    buffer_store_dwordx4 v[24:27], v3, s[4:7], s92 offen offset:3072 sc1
    buffer_store_dwordx4 v[24:27], v3, s[4:7], s93 offen offset:3072 sc1
    v_mov_b32 v3, 0
    s_mov_b32 s56, -1
    s_mov_b32 s57, -1
    s_mov_b32 s62, 0
    s_mov_b32 s63, 0
    s_waitcnt vmcnt(0)
L_pr_102:
    s_memtime s[58:59]
    s_waitcnt lgkmcnt(0)
    buffer_load_dword v4, v3, s[4:7], s92 offen sc1
    s_waitcnt vmcnt(0)
    s_memtime s[60:61]
    s_waitcnt lgkmcnt(0)
    s_sub_u32 s60, s60, s58
    s_min_u32 s56, s56, s60
    s_memtime s[58:59]
    s_waitcnt lgkmcnt(0)
    buffer_load_dword v4, v3, s[4:7], s93 offen sc1
    s_waitcnt vmcnt(0)
    s_memtime s[60:61]
    s_waitcnt lgkmcnt(0)
    s_sub_u32 s60, s60, s58
    s_min_u32 s57, s57, s60
    buffer_load_dword v4, v13, s[4:7], s38 offen sc1
    v_add_u32 v3, 128, v3
    s_add_u32 s62, s62, 1
    s_waitcnt vmcnt(0)
    v_cmp_eq_u32 vcc, 0, v4
    s_nop 0
    s_cmp_eq_u64 vcc, 0
    s_addc_u32 s63, s63, 0
    s_cmp_ge_u32 s63, 2
    s_cselect_b32 s62, 32, s62
    s_cmp_lt_u32 s62, 32
    s_cbranch_scc1 L_pr_102
    s_cmp_lt_u32 s57, s56
    s_cselect_b32 s62, 2, 1
    s_nop 0
    v_mov_b32 v3, 460288
    v_mov_b32 v4, s62
    buffer_store_dword v4, v3, s[4:7], s38 offen sc1
    s_cmp_lg_u32 s34, 0
    s_cbranch_scc1 L_xg_98
    v_mov_b32 v3, 204
    buffer_store_dword v4, v3, s[8:11], 0 offen sc1
L_xg_98:
    s_barrier
    s_add_u32 s41, s38, 475136
L_pf_103:
    buffer_load_dword v16, v22, s[4:7], s38 offen sc1
    s_sub_u32 s36, s36, 1
    s_cbranch_scc1 L_exit
    s_waitcnt vmcnt(0)
    v_cmp_ge_u32 vcc, s37, v16
    s_cbranch_vccnz L_pf_103
    s_add_u32 s90, s41, 49152
    buffer_load_dwordx4 v[72:75], v10, s[4:7], s90 offen offset:0 sc1
    buffer_load_dwordx4 v[76:79], v10, s[4:7], s90 offen offset:1024 sc1
    buffer_load_dwordx4 v[80:83], v10, s[4:7], s90 offen offset:2048 sc1
    buffer_load_dwordx4 v[84:87], v10, s[4:7], s90 offen offset:3072 sc1
    s_add_u32 s90, s41, 53248
    buffer_load_dwordx4 v[88:91], v10, s[4:7], s90 offen offset:0 sc1
    buffer_load_dwordx4 v[92:95], v10, s[4:7], s90 offen offset:1024 sc1
    buffer_load_dwordx4 v[96:99], v10, s[4:7], s90 offen offset:2048 sc1
    buffer_load_dwordx4 v[100:103], v10, s[4:7], s90 offen offset:3072 sc1
    s_add_u32 s90, s41, 57344
    buffer_load_dwordx4 v[104:107], v10, s[4:7], s90 offen offset:0 sc1
    buffer_load_dwordx4 v[108:111], v10, s[4:7], s90 offen offset:1024 sc1
    buffer_load_dwordx4 v[112:115], v10, s[4:7], s90 offen offset:2048 sc1
    buffer_load_dwordx4 v[116:119], v10, s[4:7], s90 offen offset:3072 sc1
    s_add_u32 s90, s41, 0
    buffer_load_dwordx4 v[24:27], v10, s[4:7], s90 offen offset:0 sc1
    buffer_load_dwordx4 v[28:31], v10, s[4:7], s90 offen offset:1024 sc1
    buffer_load_dwordx4 v[32:35], v10, s[4:7], s90 offen offset:2048 sc1
    buffer_load_dwordx4 v[36:39], v10, s[4:7], s90 offen offset:3072 sc1
    s_add_u32 s90, s41, 4096
    buffer_load_dwordx4 v[40:43], v10, s[4:7], s90 offen offset:0 sc1
    buffer_load_dwordx4 v[44:47], v10, s[4:7], s90 offen offset:1024 sc1
    buffer_load_dwordx4 v[48:51], v10, s[4:7], s90 offen offset:2048 sc1
    buffer_load_dwordx4 v[52:55], v10, s[4:7], s90 offen offset:3072 sc1
    s_add_u32 s90, s41, 8192
    buffer_load_dwordx4 v[56:59], v10, s[4:7], s90 offen offset:0 sc1
    buffer_load_dwordx4 v[60:63], v10, s[4:7], s90 offen offset:1024 sc1
    buffer_load_dwordx4 v[64:67], v10, s[4:7], s90 offen offset:2048 sc1
    buffer_load_dwordx4 v[68:71], v10, s[4:7], s90 offen offset:3072 sc1
    s_waitcnt vmcnt(0)
L_px_loop_s:
    s_and_b32 s90, s37, 3
    s_mul_i32 s91, s90, 114688
    s_add_u32 s91, s91, s38
    s_add_u32 s42, s91, 40960
    s_add_u32 s43, s91, 53248
    s_add_u32 s90, s37, 1
    v_mov_b32 v17, s90
    s_and_b32 s90, s90, 3
    s_mul_i32 s91, s90, 98304
    s_add_u32 s91, s91, 475136
    s_add_u32 s41, s38, s91
    v_mfma_f32_16x16x32_bf16 v[144:147], v[72:75], v[24:27], 0
    v_mfma_f32_16x16x32_bf16 v[152:155], v[72:75], v[48:51], 0
    v_mfma_f32_16x16x32_bf16 v[156:159], v[96:99], v[48:51], 0
    v_mfma_f32_16x16x32_bf16 v[144:147], v[76:79], v[28:31], v[144:147]
    v_mfma_f32_16x16x32_bf16 v[152:155], v[76:79], v[52:55], v[152:155]
    v_mfma_f32_16x16x32_bf16 v[156:159], v[100:103], v[52:55], v[156:159]
    v_mfma_f32_16x16x32_bf16 v[144:147], v[80:83], v[32:35], v[144:147]
    v_mfma_f32_16x16x32_bf16 v[152:155], v[80:83], v[56:59], v[152:155]
    v_mfma_f32_16x16x32_bf16 v[156:159], v[104:107], v[56:59], v[156:159]
    v_mfma_f32_16x16x32_bf16 v[144:147], v[84:87], v[36:39], v[144:147]
    v_mfma_f32_16x16x32_bf16 v[152:155], v[84:87], v[60:63], v[152:155]
    v_mfma_f32_16x16x32_bf16 v[156:159], v[108:111], v[60:63], v[156:159]
    v_mfma_f32_16x16x32_bf16 v[144:147], v[88:91], v[40:43], v[144:147]
    v_mfma_f32_16x16x32_bf16 v[152:155], v[88:91], v[64:67], v[152:155]
    v_mfma_f32_16x16x32_bf16 v[156:159], v[112:115], v[64:67], v[156:159]
    v_mfma_f32_16x16x32_bf16 v[144:147], v[92:95], v[44:47], v[144:147]
    v_mfma_f32_16x16x32_bf16 v[152:155], v[92:95], v[68:71], v[152:155]
    v_mfma_f32_16x16x32_bf16 v[156:159], v[116:119], v[68:71], v[156:159]
    s_nop 0
    v_cndmask_b32 v144, v21, v144, s[48:49]
    v_cndmask_b32 v145, v21, v145, s[50:51]
    v_cndmask_b32 v146, v21, v146, s[52:53]
    v_cndmask_b32 v147, v21, v147, s[54:55]
    s_nop 2
    v_cndmask_b32 v156, v21, v156, s[48:49]
    v_cndmask_b32 v157, v21, v157, s[50:51]
    v_cndmask_b32 v158, v21, v158, s[52:53]
    v_cndmask_b32 v159, v21, v159, s[54:55]
L_pf_104:
    buffer_load_dword v16, v14, s[4:7], s38 offen sc1
    s_sub_u32 s36, s36, 1
    s_cbranch_scc1 L_exit
    s_waitcnt vmcnt(0)
    v_cmp_ge_u32 vcc, s37, v16
    s_cbranch_vccnz L_pf_104
    buffer_load_dwordx4 v[120:123], v11, s[4:7], s42 offen offset:0 sc1
    buffer_load_dwordx4 v[124:127], v11, s[4:7], s42 offen offset:512 sc1
    buffer_load_dwordx4 v[128:131], v11, s[4:7], s42 offen offset:1024 sc1
    buffer_load_dwordx4 v[132:135], v11, s[4:7], s42 offen offset:1536 sc1
    buffer_load_dwordx4 v[136:139], v11, s[4:7], s42 offen offset:2048 sc1
    buffer_load_dwordx4 v[140:143], v11, s[4:7], s42 offen offset:2560 sc1
    s_waitcnt vmcnt(5)
    v_mfma_f32_16x16x32_bf16 v[148:151], v[120:123], v[24:27], 0
    v_mfma_f32_16x16x32_bf16 v[160:163], v[120:123], v[48:51], 0
    s_waitcnt vmcnt(4)
    v_mfma_f32_16x16x32_bf16 v[148:151], v[124:127], v[28:31], v[148:151]
    v_mfma_f32_16x16x32_bf16 v[160:163], v[124:127], v[52:55], v[160:163]
    s_waitcnt vmcnt(3)
    v_mfma_f32_16x16x32_bf16 v[148:151], v[128:131], v[32:35], v[148:151]
    v_mfma_f32_16x16x32_bf16 v[160:163], v[128:131], v[56:59], v[160:163]
    s_waitcnt vmcnt(2)
    v_mfma_f32_16x16x32_bf16 v[148:151], v[132:135], v[36:39], v[148:151]
    v_mfma_f32_16x16x32_bf16 v[160:163], v[132:135], v[60:63], v[160:163]
    s_waitcnt vmcnt(1)
    v_mfma_f32_16x16x32_bf16 v[148:151], v[136:139], v[40:43], v[148:151]
    v_mfma_f32_16x16x32_bf16 v[160:163], v[136:139], v[64:67], v[160:163]
    s_waitcnt vmcnt(0)
    v_mfma_f32_16x16x32_bf16 v[148:151], v[140:143], v[44:47], v[148:151]
    v_mfma_f32_16x16x32_bf16 v[160:163], v[140:143], v[68:71], v[160:163]
    s_cmp_eq_u32 s37, 63
    s_nop 2
    s_cbranch_scc1 L_pxl_105
    s_add_u32 s90, s41, 49152
    v_max_f32 v18, v144, v145
    v_max3_f32 v18, v18, v146, v147
    v_max3_f32 v18, v18, v148, v149
    v_mov_b32 v19, v18
    buffer_load_dwordx4 v[72:75], v10, s[4:7], s90 offen offset:0 sc1
    s_nop 0
    v_permlane16_swap_b32 v18, v19
    v_max_f32 v18, v18, v19
    v_mov_b32 v19, v18
    s_nop 1
    v_permlane32_swap_b32 v18, v19
    buffer_load_dwordx4 v[76:79], v10, s[4:7], s90 offen offset:1024 sc1
    v_max_f32 v18, v18, v19
    v_mul_f32 v18, 0xbdd53b95, v18
    v_fma_f32 v144, v144, s44, v18
    v_fma_f32 v145, v145, s44, v18
    buffer_load_dwordx4 v[80:83], v10, s[4:7], s90 offen offset:2048 sc1
    v_fma_f32 v146, v146, s44, v18
    v_fma_f32 v147, v147, s44, v18
    v_fma_f32 v148, v148, s44, v18
    v_fma_f32 v149, v149, s44, v18
    buffer_load_dwordx4 v[84:87], v10, s[4:7], s90 offen offset:3072 sc1
    v_exp_f32 v144, v144
    v_exp_f32 v145, v145
    v_exp_f32 v146, v146
    v_exp_f32 v147, v147
    s_add_u32 s90, s41, 53248
    v_exp_f32 v148, v148
    v_exp_f32 v149, v149
    v_add_f32 v20, v144, v145
    v_add_f32 v20, v20, v146
    buffer_load_dwordx4 v[88:91], v10, s[4:7], s90 offen offset:0 sc1
    v_add_f32 v20, v20, v147
    v_add_f32 v20, v20, v148
    v_add_f32 v20, v20, v149
    v_mov_b32 v19, v20
    buffer_load_dwordx4 v[92:95], v10, s[4:7], s90 offen offset:1024 sc1
    s_nop 0
    v_permlane16_swap_b32 v20, v19
    v_add_f32 v20, v20, v19
    v_mov_b32 v19, v20
    s_nop 1
    v_permlane32_swap_b32 v20, v19
    buffer_load_dwordx4 v[96:99], v10, s[4:7], s90 offen offset:2048 sc1
    v_add_f32 v20, v20, v19
    v_rcp_f32 v20, v20
    s_nop 0
    v_mul_f32 v144, v144, v20
    v_mul_f32 v145, v145, v20
    buffer_load_dwordx4 v[100:103], v10, s[4:7], s90 offen offset:3072 sc1
    v_mul_f32 v146, v146, v20
    v_mul_f32 v147, v147, v20
    v_mul_f32 v148, v148, v20
    v_mul_f32 v149, v149, v20
    s_add_u32 s90, s41, 57344
    v_cvt_pk_bf16_f32 v164, v144, v145
    v_cvt_pk_bf16_f32 v165, v146, v147
    v_cvt_pk_bf16_f32 v166, v148, v149
    v_max_f32 v18, v152, v153
    buffer_load_dwordx4 v[104:107], v10, s[4:7], s90 offen offset:0 sc1
    v_max3_f32 v18, v18, v154, v155
    v_max3_f32 v18, v18, v160, v161
    v_max3_f32 v18, v18, v156, v157
    v_max3_f32 v18, v18, v158, v159
    buffer_load_dwordx4 v[108:111], v10, s[4:7], s90 offen offset:1024 sc1
    v_mov_b32 v19, v18
    s_nop 1
    v_permlane16_swap_b32 v18, v19
    v_max_f32 v18, v18, v19
    v_mov_b32 v19, v18
    buffer_load_dwordx4 v[112:115], v10, s[4:7], s90 offen offset:2048 sc1
    s_nop 0
    v_permlane32_swap_b32 v18, v19
    v_max_f32 v18, v18, v19
    v_mul_f32 v18, 0xbdd53b95, v18
    v_fma_f32 v152, v152, s44, v18
    buffer_load_dwordx4 v[116:119], v10, s[4:7], s90 offen offset:3072 sc1
    v_fma_f32 v153, v153, s44, v18
    v_fma_f32 v154, v154, s44, v18
    v_fma_f32 v155, v155, s44, v18
    v_fma_f32 v160, v160, s44, v18
    s_add_u32 s90, s41, 0
    v_fma_f32 v161, v161, s44, v18
    v_fma_f32 v156, v156, s44, v18
    v_fma_f32 v157, v157, s44, v18
    v_fma_f32 v158, v158, s44, v18
    buffer_load_dwordx4 v[24:27], v10, s[4:7], s90 offen offset:0 sc1
    v_fma_f32 v159, v159, s44, v18
    v_exp_f32 v152, v152
    v_exp_f32 v153, v153
    v_exp_f32 v154, v154
    buffer_load_dwordx4 v[28:31], v10, s[4:7], s90 offen offset:1024 sc1
    v_exp_f32 v155, v155
    v_exp_f32 v160, v160
    v_exp_f32 v161, v161
    v_exp_f32 v156, v156
    buffer_load_dwordx4 v[32:35], v10, s[4:7], s90 offen offset:2048 sc1
    v_exp_f32 v157, v157
    v_exp_f32 v158, v158
    v_exp_f32 v159, v159
    v_add_f32 v20, v152, v153
    buffer_load_dwordx4 v[36:39], v10, s[4:7], s90 offen offset:3072 sc1
    v_add_f32 v20, v20, v154
    v_add_f32 v20, v20, v155
    v_add_f32 v20, v20, v160
    v_add_f32 v20, v20, v161
    s_add_u32 s90, s41, 4096
    v_add_f32 v20, v20, v156
    v_add_f32 v20, v20, v157
    v_add_f32 v20, v20, v158
    v_add_f32 v20, v20, v159
    buffer_load_dwordx4 v[40:43], v10, s[4:7], s90 offen offset:0 sc1
    v_mov_b32 v19, v20
    s_nop 1
    v_permlane16_swap_b32 v20, v19
    v_add_f32 v20, v20, v19
    v_mov_b32 v19, v20
    buffer_load_dwordx4 v[44:47], v10, s[4:7], s90 offen offset:1024 sc1
    s_nop 0
    v_permlane32_swap_b32 v20, v19
    v_add_f32 v20, v20, v19
    v_rcp_f32 v20, v20
    s_nop 0
    v_mul_f32 v152, v152, v20
    buffer_load_dwordx4 v[48:51], v10, s[4:7], s90 offen offset:2048 sc1
    v_mul_f32 v153, v153, v20
    v_mul_f32 v154, v154, v20
    v_mul_f32 v155, v155, v20
    v_mul_f32 v160, v160, v20
    buffer_load_dwordx4 v[52:55], v10, s[4:7], s90 offen offset:3072 sc1
    v_mul_f32 v161, v161, v20
    v_mul_f32 v156, v156, v20
    v_mul_f32 v157, v157, v20
    v_mul_f32 v158, v158, v20
    s_add_u32 s90, s41, 8192
    v_mul_f32 v159, v159, v20
    v_cvt_pk_bf16_f32 v168, v152, v153
    v_cvt_pk_bf16_f32 v169, v154, v155
    v_cvt_pk_bf16_f32 v170, v160, v161
    buffer_load_dwordx4 v[56:59], v10, s[4:7], s90 offen offset:0 sc1
    v_cvt_pk_bf16_f32 v172, v156, v157
    v_cvt_pk_bf16_f32 v173, v158, v159
    buffer_load_dwordx4 v[60:63], v10, s[4:7], s90 offen offset:1024 sc1
    buffer_load_dwordx4 v[64:67], v10, s[4:7], s90 offen offset:2048 sc1
    buffer_load_dwordx4 v[68:71], v10, s[4:7], s90 offen offset:3072 sc1
    buffer_store_dwordx4 v[164:167], v12, s[4:7], s43 offen offset:0 sc1
    buffer_store_dwordx4 v[168:171], v12, s[4:7], s43 offen offset:1024 sc1
    buffer_store_dwordx4 v[172:175], v12, s[4:7], s43 offen offset:2048 sc1
    s_waitcnt vmcnt(0)
    buffer_store_dword v17, v15, s[4:7], s38 offen sc1
    s_add_u32 s37, s37, 1
    s_branch L_px_loop_s
L_pxl_105:
    v_max_f32 v18, v144, v145
    v_max3_f32 v18, v18, v146, v147
    v_max3_f32 v18, v18, v148, v149
    v_mov_b32 v19, v18
    s_nop 1
    v_permlane16_swap_b32 v18, v19
    v_max_f32 v18, v18, v19
    v_mov_b32 v19, v18
    s_nop 1
    v_permlane32_swap_b32 v18, v19
    v_max_f32 v18, v18, v19
    v_mul_f32 v18, 0xbdd53b95, v18
    v_fma_f32 v144, v144, s44, v18
    v_fma_f32 v145, v145, s44, v18
    v_fma_f32 v146, v146, s44, v18
    v_fma_f32 v147, v147, s44, v18
    v_fma_f32 v148, v148, s44, v18
    v_fma_f32 v149, v149, s44, v18
    v_exp_f32 v144, v144
    v_exp_f32 v145, v145
    v_exp_f32 v146, v146
    v_exp_f32 v147, v147
    v_exp_f32 v148, v148
    v_exp_f32 v149, v149
    v_add_f32 v20, v144, v145
    v_add_f32 v20, v20, v146
    v_add_f32 v20, v20, v147
    v_add_f32 v20, v20, v148
    v_add_f32 v20, v20, v149
    v_mov_b32 v19, v20
    s_nop 1
    v_permlane16_swap_b32 v20, v19
    v_add_f32 v20, v20, v19
    v_mov_b32 v19, v20
    s_nop 1
    v_permlane32_swap_b32 v20, v19
    v_add_f32 v20, v20, v19
    v_rcp_f32 v20, v20
    s_nop 0
    v_mul_f32 v144, v144, v20
    v_mul_f32 v145, v145, v20
    v_mul_f32 v146, v146, v20
    v_mul_f32 v147, v147, v20
    v_mul_f32 v148, v148, v20
    v_mul_f32 v149, v149, v20
    v_cvt_pk_bf16_f32 v164, v144, v145
    v_cvt_pk_bf16_f32 v165, v146, v147
    v_cvt_pk_bf16_f32 v166, v148, v149
    v_max_f32 v18, v152, v153
    v_max3_f32 v18, v18, v154, v155
    v_max3_f32 v18, v18, v160, v161
    v_max3_f32 v18, v18, v156, v157
    v_max3_f32 v18, v18, v158, v159
    v_mov_b32 v19, v18
    s_nop 1
    v_permlane16_swap_b32 v18, v19
    v_max_f32 v18, v18, v19
    v_mov_b32 v19, v18
    s_nop 1
    v_permlane32_swap_b32 v18, v19
    v_max_f32 v18, v18, v19
    v_mul_f32 v18, 0xbdd53b95, v18
    v_fma_f32 v152, v152, s44, v18
    v_fma_f32 v153, v153, s44, v18
    v_fma_f32 v154, v154, s44, v18
    v_fma_f32 v155, v155, s44, v18
    v_fma_f32 v160, v160, s44, v18
    v_fma_f32 v161, v161, s44, v18
    v_fma_f32 v156, v156, s44, v18
    v_fma_f32 v157, v157, s44, v18
    v_fma_f32 v158, v158, s44, v18
    v_fma_f32 v159, v159, s44, v18
    v_exp_f32 v152, v152
    v_exp_f32 v153, v153
    v_exp_f32 v154, v154
    v_exp_f32 v155, v155
    v_exp_f32 v160, v160
    v_exp_f32 v161, v161
    v_exp_f32 v156, v156
    v_exp_f32 v157, v157
    v_exp_f32 v158, v158
    v_exp_f32 v159, v159
    v_add_f32 v20, v152, v153
    v_add_f32 v20, v20, v154
    v_add_f32 v20, v20, v155
    v_add_f32 v20, v20, v160
    v_add_f32 v20, v20, v161
    v_add_f32 v20, v20, v156
    v_add_f32 v20, v20, v157
    v_add_f32 v20, v20, v158
    v_add_f32 v20, v20, v159
    v_mov_b32 v19, v20
    s_nop 1
    v_permlane16_swap_b32 v20, v19
    v_add_f32 v20, v20, v19
    v_mov_b32 v19, v20
    s_nop 1
    v_permlane32_swap_b32 v20, v19
    v_add_f32 v20, v20, v19
    v_rcp_f32 v20, v20
    s_nop 0
    v_mul_f32 v152, v152, v20
    v_mul_f32 v153, v153, v20
    v_mul_f32 v154, v154, v20
    v_mul_f32 v155, v155, v20
    v_mul_f32 v160, v160, v20
    v_mul_f32 v161, v161, v20
    v_mul_f32 v156, v156, v20
    v_mul_f32 v157, v157, v20
    v_mul_f32 v158, v158, v20
    v_mul_f32 v159, v159, v20
    v_cvt_pk_bf16_f32 v168, v152, v153
    v_cvt_pk_bf16_f32 v169, v154, v155
    v_cvt_pk_bf16_f32 v170, v160, v161
    v_cvt_pk_bf16_f32 v172, v156, v157
    v_cvt_pk_bf16_f32 v173, v158, v159
    buffer_store_dwordx4 v[164:167], v12, s[4:7], s43 offen offset:0 sc1
    buffer_store_dwordx4 v[168:171], v12, s[4:7], s43 offen offset:1024 sc1
    buffer_store_dwordx4 v[172:175], v12, s[4:7], s43 offen offset:2048 sc1
    s_waitcnt vmcnt(0)
    buffer_store_dword v17, v15, s[4:7], s38 offen sc1
    s_endpgm
L_pa_s:
    v_mov_b32 v1, 196
L_gw_106:
    buffer_load_dword v2, v1, s[8:11], 0 offen sc1
    s_sub_u32 s36, s36, 1
    s_cbranch_scc1 L_exit
    s_waitcnt vmcnt(0)
    v_readfirstlane_b32 s90, v2
    s_nop 0
    s_cmp_eq_u32 s90, 0
    s_cbranch_scc1 L_gw_106
    s_branch L_pa_body
.section .rodata,"a"
.p2align 6
.amdhsa_kernel concat_heads__sliding_local_dilated__memory_aug_recurrent_mem_tr__prompt_kernel
  .amdhsa_next_free_vgpr 512
  .amdhsa_next_free_sgpr 102
  .amdhsa_accum_offset 256
  .amdhsa_group_segment_fixed_size 0
  .amdhsa_kernarg_size 104
  .amdhsa_user_sgpr_count 2
  .amdhsa_user_sgpr_kernarg_segment_ptr 1
  .amdhsa_system_sgpr_workgroup_id_x 1
  .amdhsa_float_denorm_mode_32 3
.end_amdhsa_kernel
```

```asm
; @launch grid=(256,1,1) block=(256,1,1) lds=163840
.amdgcn_target "amdgcn-amd-amdhsa--gfx950"
.text
.globl concat_heads__sliding_local_dilated__memory_aug_recurrent_mem_tr__prompt_kernel
.p2align 8
.type concat_heads__sliding_local_dilated__memory_aug_recurrent_mem_tr__prompt_kernel,@function
concat_heads__sliding_local_dilated__memory_aug_recurrent_mem_tr__prompt_kernel:
    s_cmp_ge_u32 s2, 256
    s_cbranch_scc1 L_exit
    s_load_dwordx16 s[64:79], s[0:1], 0
    s_load_dwordx8 s[80:87], s[0:1], 64
    s_load_dwordx2 s[88:89], s[0:1], 96
    s_getreg_b32 s33, hwreg(HW_REG_XCC_ID, 0, 4)
    v_lshrrev_b32 v1, 6, v0
    v_and_b32 v0, 63, v0
    v_readfirstlane_b32 s32, v1
    s_mov_b32 s36, 0x40000
    s_mov_b32 s96, 0
    s_mov_b32 s97, 0
    s_and_b32 s90, s33, 4
    s_lshl_b32 s90, s90, 5
    s_and_b32 s91, s33, 3
    s_lshl_b32 s91, s91, 2
    s_add_u32 s90, s90, s91
    s_lshr_b32 s91, s33, 3
    s_lshl_b32 s91, s91, 4
    s_add_u32 s90, s90, s91
    v_mov_b32 v1, s90
    v_mov_b32 v2, 1
    v_mov_b32 v3, 0
    s_waitcnt lgkmcnt(0)
    s_mov_b32 s8, s86
    s_and_b32 s9, s87, 0xffff
    s_mov_b32 s10, 256
    s_mov_b32 s11, 0x20000
    s_mov_b32 s4, s88
    s_and_b32 s5, s89, 0xffff
    s_mov_b32 s6, 33554432
    s_mov_b32 s7, 0x20000
    s_mov_b32 s28, s84
    s_and_b32 s29, s85, 0xffff
    s_mov_b32 s30, 5242880
    s_mov_b32 s31, 0x20000
    s_cmp_lg_u32 s32, 0
    s_cbranch_scc1 L_norank
    s_mov_b64 exec, 1
    buffer_atomic_add v2, v1, s[8:11], 0 offen sc0 sc1
    s_mov_b64 exec, -1
    v_mov_b32 v240, -1
    v_mov_b32 v241, -1
    v_mov_b32 v242, -1
    v_mov_b32 v243, -1
    v_mov_b32 v244, 0
    v_lshlrev_b32 v4, 4, v0
    v_lshlrev_b32 v5, 2, v0
    s_mul_i32 s91, s2, 2560
    s_and_b32 s92, s2, 7
    s_lshl_b32 s92, s92, 21
    s_add_u32 s92, s92, 8388608
    s_lshr_b32 s93, s2, 3
    s_lshl_b32 s40, s93, 7
    s_add_u32 s40, s40, s92
    s_add_u32 s40, s40, 458752
    s_lshr_b32 s41, s93, 4
    s_mul_i32 s41, s41, 114688
    s_add_u32 s92, s92, s41
    s_and_b32 s93, s93, 15
    s_mul_i32 s93, s93, 2560
    s_add_u32 s92, s92, s93
    buffer_store_dwordx4 v[240:243], v4, s[4:7], s91 offen sc1
    buffer_store_dwordx4 v[240:243], v4, s[4:7], s91 offen offset:1024 sc1
    buffer_store_dword v240, v5, s[4:7], s91 offen offset:2048 sc1
    buffer_store_dword v240, v5, s[4:7], s91 offen offset:2304 sc1
    buffer_store_dwordx4 v[240:243], v4, s[4:7], s92 offen sc1
    buffer_store_dwordx4 v[240:243], v4, s[4:7], s92 offen offset:1024 sc1
    buffer_store_dword v240, v5, s[4:7], s92 offen offset:2048 sc1
    buffer_store_dword v240, v5, s[4:7], s92 offen offset:2304 sc1
    s_mov_b64 exec, 0xffffffff
    buffer_store_dword v244, v5, s[4:7], s40 offen sc1
    s_lshl_b32 s40, s2, 7
    s_add_u32 s40, s40, 1933312
    buffer_store_dword v244, v5, s[4:7], s40 offen sc1
    s_mov_b64 exec, -1
    s_waitcnt vmcnt(10)
    s_mov_b64 exec, 1
    ds_write_b32 v3, v2
    s_mov_b64 exec, -1
    s_waitcnt vmcnt(0) lgkmcnt(0)
    s_and_b32 s91, s33, 4
    s_lshl_b32 s91, s91, 5
    s_add_u32 s91, s91, 48
    v_mov_b32 v1, s91
    v_mov_b32 v4, 1
    s_mov_b64 exec, 1
    buffer_atomic_add v4, v1, s[8:11], 0 offen sc1
    s_mov_b64 exec, -1
    s_branch L_rank
L_norank:
    s_and_b32 s34, s33, 7
    s_lshr_b32 s93, s2, 3
    s_mul_i32 s93, s93, 3
    s_add_u32 s93, s93, s32
    s_sub_u32 s93, s93, 1
    v_add_u32 v4, 0, v0
    v_cmp_le_u32 vcc, 96, v4
    v_subrev_u32 v5, 96, v4
    s_nop 0
    v_cndmask_b32 v4, v4, v5, vcc
    v_lshlrev_b32 v4, 4, v4
    v_mov_b32 v5, 12288
    v_cndmask_b32 v5, 0, v5, vcc
    s_mul_i32 s90, s34, 1536
    v_add3_u32 v6, v4, v5, s90
    v_add_u32 v4, 64, v0
    v_cmp_le_u32 vcc, 96, v4
    v_subrev_u32 v5, 96, v4
    s_nop 0
    v_cndmask_b32 v4, v4, v5, vcc
    v_lshlrev_b32 v4, 4, v4
    v_mov_b32 v5, 12288
    v_cndmask_b32 v5, 0, v5, vcc
    s_mul_i32 s90, s34, 1536
    v_add3_u32 v7, v4, v5, s90
    v_add_u32 v4, 128, v0
    v_cmp_le_u32 vcc, 96, v4
    v_subrev_u32 v5, 96, v4
    s_nop 0
    v_cndmask_b32 v4, v4, v5, vcc
    v_lshlrev_b32 v4, 4, v4
    v_mov_b32 v5, 12288
    v_cndmask_b32 v5, 0, v5, vcc
    s_mul_i32 s90, s34, 1536
    v_add3_u32 v8, v4, v5, s90
    s_cmp_lt_u32 s93, 64
    s_cselect_b32 s12, s74, s76
    s_cselect_b32 s13, s75, s77
    s_cselect_b32 s91, 1, 0
    s_cmp_lt_u32 s93, 32
    s_cselect_b32 s12, s78, s12
    s_cselect_b32 s13, s79, s13
    s_cselect_b32 s91, 2, s91
    s_and_b32 s13, s13, 0xffff
    s_mov_b32 s14, 7864320
    s_mov_b32 s15, 0x20000
    s_mul_i32 s91, s91, 320
    s_mul_i32 s90, s93, 10
    s_add_u32 s90, s90, s91
    s_sub_u32 s90, s90, 640
    s_mul_i32 s90, s90, 12288
    buffer_load_dwordx4 v[248:251], v6, s[12:15], s90 offen
    buffer_load_dwordx4 v[248:251], v7, s[12:15], s90 offen
    buffer_load_dwordx4 v[248:251], v8, s[12:15], s90 offen
    s_add_u32 s90, s90, 24576
    buffer_load_dwordx4 v[248:251], v6, s[12:15], s90 offen
    buffer_load_dwordx4 v[248:251], v7, s[12:15], s90 offen
    buffer_load_dwordx4 v[248:251], v8, s[12:15], s90 offen
    s_add_u32 s90, s90, 24576
    buffer_load_dwordx4 v[248:251], v6, s[12:15], s90 offen
    buffer_load_dwordx4 v[248:251], v7, s[12:15], s90 offen
    buffer_load_dwordx4 v[248:251], v8, s[12:15], s90 offen
    s_add_u32 s90, s90, 24576
    buffer_load_dwordx4 v[248:251], v6, s[12:15], s90 offen
    buffer_load_dwordx4 v[248:251], v7, s[12:15], s90 offen
    buffer_load_dwordx4 v[248:251], v8, s[12:15], s90 offen
    s_add_u32 s90, s90, 24576
    buffer_load_dwordx4 v[248:251], v6, s[12:15], s90 offen
    buffer_load_dwordx4 v[248:251], v7, s[12:15], s90 offen
    buffer_load_dwordx4 v[248:251], v8, s[12:15], s90 offen
    s_add_u32 s90, s90, 24576
    v_add_u32 v4, 0, v0
    v_cmp_le_u32 vcc, 96, v4
    v_subrev_u32 v5, 96, v4
    s_nop 0
    v_cndmask_b32 v4, v4, v5, vcc
    v_lshlrev_b32 v4, 4, v4
    v_mov_b32 v5, 12288
    v_cndmask_b32 v5, 0, v5, vcc
    s_mul_i32 s90, s34, 1536
    v_add3_u32 v6, v4, v5, s90
    v_add_u32 v4, 64, v0
    v_cmp_le_u32 vcc, 96, v4
    v_subrev_u32 v5, 96, v4
    s_nop 0
    v_cndmask_b32 v4, v4, v5, vcc
    v_lshlrev_b32 v4, 4, v4
    v_mov_b32 v5, 12288
    v_cndmask_b32 v5, 0, v5, vcc
    s_mul_i32 s90, s34, 1536
    v_add3_u32 v7, v4, v5, s90
    v_add_u32 v4, 128, v0
    v_cmp_le_u32 vcc, 96, v4
    v_subrev_u32 v5, 96, v4
    s_nop 0
    v_cndmask_b32 v4, v4, v5, vcc
    v_lshlrev_b32 v4, 4, v4
    v_mov_b32 v5, 12288
    v_cndmask_b32 v5, 0, v5, vcc
    s_mul_i32 s90, s34, 1536
    v_add3_u32 v8, v4, v5, s90
    s_cmp_lt_u32 s93, 64
    s_cselect_b32 s12, s74, s76
    s_cselect_b32 s13, s75, s77
    s_cselect_b32 s91, 2, 1
    s_cmp_lt_u32 s93, 32
    s_cselect_b32 s12, s78, s12
    s_cselect_b32 s13, s79, s13
    s_cselect_b32 s91, 3, s91
    s_and_b32 s13, s13, 0xffff
    s_mov_b32 s14, 7864320
    s_mov_b32 s15, 0x20000
    s_mul_i32 s91, s91, 320
    s_mul_i32 s90, s93, 10
    s_add_u32 s90, s90, s91
    s_sub_u32 s90, s90, 640
    s_mul_i32 s90, s90, 12288
    buffer_load_dwordx4 v[248:251], v6, s[12:15], s90 offen
    buffer_load_dwordx4 v[248:251], v7, s[12:15], s90 offen
    buffer_load_dwordx4 v[248:251], v8, s[12:15], s90 offen
    s_add_u32 s90, s90, 24576
    buffer_load_dwordx4 v[248:251], v6, s[12:15], s90 offen
    buffer_load_dwordx4 v[248:251], v7, s[12:15], s90 offen
    buffer_load_dwordx4 v[248:251], v8, s[12:15], s90 offen
    s_add_u32 s90, s90, 24576
    buffer_load_dwordx4 v[248:251], v6, s[12:15], s90 offen
    buffer_load_dwordx4 v[248:251], v7, s[12:15], s90 offen
    buffer_load_dwordx4 v[248:251], v8, s[12:15], s90 offen
    s_add_u32 s90, s90, 24576
    buffer_load_dwordx4 v[248:251], v6, s[12:15], s90 offen
    buffer_load_dwordx4 v[248:251], v7, s[12:15], s90 offen
    buffer_load_dwordx4 v[248:251], v8, s[12:15], s90 offen
    s_add_u32 s90, s90, 24576
    buffer_load_dwordx4 v[248:251], v6, s[12:15], s90 offen
    buffer_load_dwordx4 v[248:251], v7, s[12:15], s90 offen
    buffer_load_dwordx4 v[248:251], v8, s[12:15], s90 offen
    s_add_u32 s90, s90, 24576
    s_waitcnt vmcnt(20)
L_rank:
    s_barrier
    ds_read_b32 v2, v3
    s_waitcnt lgkmcnt(0)
    v_readfirstlane_b32 s35, v2
    s_mov_b32 s34, s33
    s_barrier
    s_cmp_ge_u32 s33, 8
    s_cbranch_scc1 L_norole
    s_cmp_ge_u32 s35, 32
    s_cbranch_scc1 L_norole
    s_lshl_b32 s38, s34, 21
    s_add_u32 s38, s38, 8388608
    s_cmp_lt_u32 s35, 12
    s_cbranch_scc1 L_qkv_f
    s_cmp_lt_u32 s35, 18
    s_cbranch_scc1 L_v_f
    s_cmp_lt_u32 s35, 28
    s_cbranch_scc1 L_wo_f
    s_cmp_lt_u32 s35, 29
    s_cbranch_scc1 L_px_f
    s_branch L_pa_f
L_norole:
    v_mov_b32 v1, 192
    v_mov_b32 v2, 2
    s_mov_b64 exec, 1
    buffer_store_dword v2, v1, s[8:11], 0 offen sc1
    s_mov_b64 exec, -1
    s_branch L_slow
L_exit:
    s_endpgm
L_qkv_f:
    s_mov_b32 s12, s74
    s_and_b32 s13, s75, 0xffff
    s_mov_b32 s14, 7864320
    s_mov_b32 s15, 0x20000
    s_mov_b32 s16, s76
    s_and_b32 s17, s77, 0xffff
    s_mov_b32 s18, 7864320
    s_mov_b32 s19, 0x20000
    s_mov_b32 s40, s35
    s_mov_b32 s24, s70
    s_and_b32 s25, s71, 0xffff
    s_mov_b32 s26, 2621440
    s_mov_b32 s27, 0x20000
    v_and_b32 v1, 15, v0
    v_lshrrev_b32 v2, 4, v0
    v_lshrrev_b32 v3, 3, v0
    v_and_b32 v4, 7, v0
    s_lshl_b32 s90, s32, 3
    v_add_u32 v5, s90, v3
    s_and_b32 s91, s32, 1
    s_lshl_b32 s91, s91, 2
    v_and_b32 v6, 2, v3
    v_or_b32 v6, s91, v6
    v_xor_b32 v6, v6, v4
    v_lshlrev_b32 v6, 4, v6
    v_mul_u32_u24 v7, 12288, v5
    s_mul_i32 s92, s34, 1536
    s_lshl_b32 s93, s40, 7
    s_add_u32 s92, s92, s93
    v_add3_u32 v124, v6, v7, s92
    v_lshrrev_b32 v6, 1, v3
    v_or_b32 v6, s91, v6
    v_xor_b32 v6, v6, v4
    v_lshlrev_b32 v6, 4, v6
    v_mul_u32_u24 v7, 1280, v5
    v_add_u32 v10, v6, v7
    s_lshl_b32 s90, s32, 10
    s_add_u32 m0, s90, 81920
    s_mov_b32 s91, 0
    buffer_load_dwordx4 v124, s[12:15], s91 offen nt lds
    s_add_u32 m0, m0, 4096
    s_add_u32 s91, s91, 393216
    buffer_load_dwordx4 v124, s[12:15], s91 offen nt lds
    s_add_u32 m0, m0, 4096
    s_add_u32 s91, s91, 393216
    buffer_load_dwordx4 v124, s[12:15], s91 offen nt lds
    s_add_u32 m0, m0, 4096
    s_add_u32 s91, s91, 393216
    buffer_load_dwordx4 v124, s[12:15], s91 offen nt lds
    s_add_u32 m0, m0, 4096
    s_add_u32 s91, s91, 393216
    buffer_load_dwordx4 v124, s[12:15], s91 offen nt lds
    s_add_u32 m0, m0, 4096
    s_add_u32 s91, s91, 393216
    buffer_load_dwordx4 v124, s[12:15], s91 offen nt lds
    s_add_u32 m0, m0, 4096
    s_add_u32 s91, s91, 393216
    buffer_load_dwordx4 v124, s[12:15], s91 offen nt lds
    s_add_u32 m0, m0, 4096
    s_add_u32 s91, s91, 393216
    buffer_load_dwordx4 v124, s[12:15], s91 offen nt lds
    s_add_u32 m0, m0, 4096
    s_add_u32 s91, s91, 393216
    buffer_load_dwordx4 v124, s[12:15], s91 offen nt lds
    s_add_u32 m0, m0, 4096
    s_add_u32 s91, s91, 393216
    buffer_load_dwordx4 v124, s[12:15], s91 offen nt lds
    s_lshl_b32 s90, s32, 10
    s_add_u32 m0, s90, 40960
    s_mov_b32 s91, 0
    buffer_load_dwordx4 v124, s[16:19], s91 offen nt lds
    s_add_u32 m0, m0, 4096
    s_add_u32 s91, s91, 393216
    buffer_load_dwordx4 v124, s[16:19], s91 offen nt lds
    s_add_u32 m0, m0, 4096
    s_add_u32 s91, s91, 393216
    buffer_load_dwordx4 v124, s[16:19], s91 offen nt lds
    s_add_u32 m0, m0, 4096
    s_add_u32 s91, s91, 393216
    buffer_load_dwordx4 v124, s[16:19], s91 offen nt lds
    s_add_u32 m0, m0, 4096
    s_add_u32 s91, s91, 393216
    buffer_load_dwordx4 v124, s[16:19], s91 offen nt lds
    s_add_u32 m0, m0, 4096
    s_add_u32 s91, s91, 393216
    buffer_load_dwordx4 v124, s[16:19], s91 offen nt lds
    s_add_u32 m0, m0, 4096
    s_add_u32 s91, s91, 393216
    buffer_load_dwordx4 v124, s[16:19], s91 offen nt lds
    s_add_u32 m0, m0, 4096
    s_add_u32 s91, s91, 393216
    buffer_load_dwordx4 v124, s[16:19], s91 offen nt lds
    s_add_u32 m0, m0, 4096
    s_add_u32 s91, s91, 393216
    buffer_load_dwordx4 v124, s[16:19], s91 offen nt lds
    s_add_u32 m0, m0, 4096
    s_add_u32 s91, s91, 393216
    buffer_load_dwordx4 v124, s[16:19], s91 offen nt lds
    s_lshl_b32 s90, s32, 10
    s_add_u32 m0, s90, 122880
    s_mov_b32 s91, 3932160
    buffer_load_dwordx4 v124, s[12:15], s91 offen nt lds
    s_add_u32 m0, m0, 4096
    s_add_u32 s91, s91, 393216
    buffer_load_dwordx4 v124, s[12:15], s91 offen nt lds
    s_add_u32 m0, m0, 4096
    s_add_u32 s91, s91, 393216
    buffer_load_dwordx4 v124, s[12:15], s91 offen nt lds
    s_add_u32 m0, m0, 4096
    s_add_u32 s91, s91, 393216
    buffer_load_dwordx4 v124, s[12:15], s91 offen nt lds
    s_add_u32 m0, m0, 4096
    s_add_u32 s91, s91, 393216
    buffer_load_dwordx4 v124, s[12:15], s91 offen nt lds
    s_add_u32 m0, m0, 4096
    s_add_u32 s91, s91, 393216
    buffer_load_dwordx4 v124, s[12:15], s91 offen nt lds
    s_add_u32 m0, m0, 4096
    s_add_u32 s91, s91, 393216
    buffer_load_dwordx4 v124, s[12:15], s91 offen nt lds
    s_add_u32 m0, m0, 4096
    s_add_u32 s91, s91, 393216
    buffer_load_dwordx4 v124, s[12:15], s91 offen nt lds
    s_add_u32 m0, m0, 4096
    s_add_u32 s91, s91, 393216
    buffer_load_dwordx4 v124, s[12:15], s91 offen nt lds
    s_add_u32 m0, m0, 4096
    s_add_u32 s91, s91, 393216
    buffer_load_dwordx4 v124, s[12:15], s91 offen nt lds
    s_mov_b32 s46, 0
    s_lshl_b32 s90, s32, 10
    s_add_u32 m0, s90, 0
    s_nop 0
    buffer_load_dwordx4 v10, s[24:27], s46 offen offset:0 lds
    s_add_u32 m0, m0, 3968
    s_nop 0
    buffer_load_dwordx4 v10, s[24:27], s46 offen offset:128 lds
    s_add_u32 m0, m0, 3968
    s_nop 0
    buffer_load_dwordx4 v10, s[24:27], s46 offen offset:256 lds
    s_add_u32 m0, m0, 3968
    s_nop 0
    buffer_load_dwordx4 v10, s[24:27], s46 offen offset:384 lds
    s_add_u32 m0, m0, 3968
    s_nop 0
    buffer_load_dwordx4 v10, s[24:27], s46 offen offset:512 lds
    s_add_u32 m0, m0, 3968
    s_nop 0
    buffer_load_dwordx4 v10, s[24:27], s46 offen offset:640 lds
    s_add_u32 m0, m0, 3968
    s_nop 0
    buffer_load_dwordx4 v10, s[24:27], s46 offen offset:768 lds
    s_add_u32 m0, m0, 3968
    s_nop 0
    buffer_load_dwordx4 v10, s[24:27], s46 offen offset:896 lds
    s_add_u32 m0, m0, 3968
    s_nop 0
    buffer_load_dwordx4 v10, s[24:27], s46 offen offset:1024 lds
    s_add_u32 m0, m0, 3968
    s_nop 0
    buffer_load_dwordx4 v10, s[24:27], s46 offen offset:1152 lds
    s_mul_i32 s60, s40, 86
    s_lshr_b32 s60, s60, 8
    s_mul_i32 s59, s60, 3
    s_sub_u32 s59, s40, s59
    s_add_u32 s90, s40, 1
    s_mul_i32 s62, s90, 86
    s_lshr_b32 s62, s62, 8
    s_mul_i32 s63, s62, 3
    s_sub_u32 s63, s90, s63
    v_lshrrev_b32 v3, 1, v2
    v_and_b32 v5, 1, v2
    s_lshl_b32 s90, s32, 9
    v_lshlrev_b32 v6, 4, v1
    v_lshl_add_u32 v6, v3, 8, v6
    v_add_u32 v6, s90, v6
    s_mul_i32 s90, s60, 12288
    s_lshl_b32 s91, s59, 11
    s_add_u32 s90, s90, s91
    v_mul_u32_u24 v7, 6144, v5
    v_add3_u32 v19, v6, v7, s90
    v_mov_b32 v22, -1
    s_mov_b32 s56, 49152
    v_lshl_add_u32 v137, v5, 11, v6
    v_add_u32 v137, 135168, v137
    s_mul_i32 s90, s40, 1280
    s_add_u32 s90, s90, 10240
    v_lshlrev_b32 v6, 1, v5
    v_or_b32 v7, v6, v3
    v_lshl_add_u32 v7, v7, 4, v1
    v_lshlrev_b32 v7, 2, v7
    v_add_u32 v7, 1024, v7
    v_or_b32 v6, v6, v1
    v_lshl_add_u32 v6, v3, 4, v6
    v_lshlrev_b32 v6, 4, v6
    s_sub_u32 s91, s32, 1
    s_lshl_b32 s91, s91, 9
    v_add_u32 v6, s91, v6
    s_cmp_eq_u32 s32, 0
    s_cselect_b64 vcc, -1, 0
    v_cndmask_b32 v6, v6, v7, vcc
    v_add_u32 v135, s90, v6
    s_lshl_b32 s91, s32, 8
    s_add_u32 s91, s91, s90
    v_lshl_add_u32 v150, v0, 2, s91
    v_and_b32 v4, 2, v1
    v_cmp_eq_u32 vcc, 0, v4
    v_mov_b32 v9, 2146435072
    s_nop 0
    v_cndmask_b32 v135, v9, v135, vcc
    s_lshl_b32 s90, s40, 10
    v_lshrrev_b32 v3, 2, v1
    v_lshlrev_b32 v3, 1, v3
    v_and_b32 v6, 1, v1
    v_or_b32 v3, v3, v6
    v_lshl_add_u32 v3, v2, 3, v3
    v_lshl_add_u32 v136, v3, 4, s90
    v_cmp_ne_u32 vcc, 0, v4
    v_mov_b32 v9, 2146435072
    s_nop 0
    v_cndmask_b32 v136, v9, v136, vcc
    v_and_b32 v6, 9, v1
    v_lshl_or_b32 v6, v4, 1, v6
    v_and_b32 v7, 4, v1
    v_lshrrev_b32 v7, 1, v7
    v_or_b32 v6, v6, v7
    v_lshlrev_b32 v6, 4, v6
    v_lshl_add_u32 v6, v2, 8, v6
    s_cmp_eq_u32 s32, 2
    s_cselect_b32 s90, 2048, 0
    s_add_u32 s90, s90, 135168
    v_add_u32 v138, s90, v6
    s_lshl_b32 s90, s60, 7
    s_lshl_b32 s91, s59, 2
    s_add_u32 s91, s91, s90
    s_add_u32 s91, s91, 459264
    s_cmp_eq_u32 s32, 3
    s_cselect_b32 s91, s91, 2146435072
    s_cselect_b32 s55, -1, 0
    v_mov_b32 v139, s91
    v_cmp_eq_u32 vcc, 0, v0
    v_mov_b32 v9, 2146435072
    s_nop 0
    v_cndmask_b32 v139, v9, v139, vcc
    v_add_u32 v21, 3072, v139
    s_mul_i32 s90, s35, 32768
    s_lshl_b32 s91, s32, 11
    s_add_u32 s90, s90, s91
    s_lshl_b32 s92, s35, 10
    s_lshl_b32 s91, s32, 8
    s_add_u32 s92, s92, s91
    s_cmp_lt_u32 s35, 10
    s_cselect_b32 s90, s90, 2146435072
    s_cselect_b32 s92, s92, 2146435072
    s_lshl_b32 s91, s34, 8
    v_lshlrev_b32 v3, 4, v0
    v_xor_b32 v3, s91, v3
    v_add_u32 v142, s90, v3
    v_xor_b32 v3, 1024, v3
    v_add_u32 v143, s90, v3
    s_min_u32 s90, s35, 9
    s_lshl_b32 s90, s90, 7
    s_add_u32 s90, s90, 460800
    s_add_u32 s90, s90, s38
    v_and_b32 v3, 3, v0
    v_lshl_add_u32 v146, v3, 2, s90
    v_lshl_add_u32 v149, v0, 2, s92
    v_lshl_add_u32 v148, v1, 4, s92
    v_cmp_eq_u32 vcc, 0, v2
    v_mov_b32 v9, 2146435072
    s_nop 0
    v_cndmask_b32 v148, v9, v148, vcc
    v_and_b32 v7, 1, v1
    v_cmp_ne_u32 vcc, 0, v7
    v_mov_b32 v5, 0x3f80
    v_mov_b32 v6, 0x3f800000
    v_cndmask_b32 v5, v5, v6, vcc
    v_bfe_u32 v6, v1, 1, 1
    v_cmp_eq_u32 vcc, 0, v6
    s_nop 1
    v_cndmask_b32 v198, 0, v5, vcc
    v_mov_b32 v196, 0
    v_mov_b32 v200, 0
    v_cmp_eq_u32 vcc, 1, v6
    s_nop 1
    v_cndmask_b32 v199, 0, v5, vcc
    v_mov_b32 v197, 0
    v_mov_b32 v201, 0
    v_lshrrev_b32 v3, 2, v1
    v_and_b32 v4, 3, v1
    v_and_b32 v5, 1, v2
    v_lshl_add_u32 v6, v2, 3, v3
    v_lshlrev_b32 v6, 7, v6
    v_and_b32 v7, 2, v3
    v_lshl_or_b32 v7, v5, 2, v7
    v_lshrrev_b32 v8, 1, v4
    s_lshl_b32 s90, s32, 1
    v_or_b32 v8, s90, v8
    v_xor_b32 v7, v7, v8
    v_lshl_add_u32 v6, v7, 4, v6
    v_and_b32 v7, 1, v4
    v_lshl_add_u32 v6, v7, 3, v6
    v_add_u32 v125, 81920, v6
    v_add_u32 v126, 40960, v6
    v_add_u32 v127, 122880, v6
    s_lshl_b32 s90, s32, 9
    s_add_u32 s90, s90, 133120
    v_xor_b32 v6, 0, v5
    v_lshl_add_u32 v6, v6, 2, v3
    v_lshl_add_u32 v6, v2, 3, v6
    v_lshlrev_b32 v6, 5, v6
    v_lshl_or_b32 v7, v5, 1, 0
    v_xor_b32 v7, v7, v4
    v_lshl_add_u32 v6, v7, 3, v6
    v_add_u32 v24, 133120, v6
    v_xor_b32 v6, 1, v5
    v_lshl_add_u32 v6, v6, 2, v3
    v_lshl_add_u32 v6, v2, 3, v6
    v_lshlrev_b32 v6, 5, v6
    v_lshl_or_b32 v7, v5, 1, 1
    v_xor_b32 v7, v7, v4
    v_lshl_add_u32 v6, v7, 3, v6
    v_add_u32 v134, 133120, v6
    v_lshrrev_b32 v6, 3, v1
    v_lshlrev_b32 v6, 2, v6
    v_xor_b32 v6, v6, v1
    v_lshlrev_b32 v6, 5, v6
    v_xor_b32 v7, v2, v3
    v_lshl_add_u32 v6, v7, 3, v6
    v_add_u32 v23, s90, v6
    v_and_b32 v7, 2, v1
    v_cmp_ne_u32 vcc, 0, v7
    v_mov_b32 v6, 0x4444
    v_mov_b32 v8, 0xeeee
    v_cndmask_b32 v17, v6, v8, vcc
    v_lshlrev_b32 v6, 4, v0
    v_add_u32 v16, 122880, v6
    s_mul_i32 s90, s32, 2560
    v_lshl_add_u32 v13, v0, 4, s90
    v_lshl_add_u32 v14, v0, 2, s90
    s_add_u32 s48, s90, 122880
    v_mul_u32_u24 v6, 40, v0
    v_add_u32 v15, s48, v6
    v_mul_u32_u24 v6, 164, v0
    v_min_u32 v6, 10236, v6
    v_add_u32 v25, 122880, v6
    v_lshrrev_b32 v6, 3, v1
    v_lshlrev_b32 v6, 10, v6
    v_and_b32 v7, 7, v1
    v_lshl_add_u32 v6, v7, 7, v6
    v_lshrrev_b32 v7, 1, v1
    v_xor_b32 v7, v7, v2
    v_lshl_add_u32 v11, v7, 4, v6
    v_xor_b32 v12, 64, v11
    s_waitcnt vmcnt(30)
    s_barrier
    ds_read_b64_tr_b16 a[0:1], v125 offset:0
    ds_read_b64_tr_b16 a[2:3], v125 offset:512
    ds_read_b64_tr_b16 a[4:5], v125 offset:4096
    ds_read_b64_tr_b16 a[6:7], v125 offset:4608
    ds_read_b64_tr_b16 a[8:9], v125 offset:8192
    ds_read_b64_tr_b16 a[10:11], v125 offset:8704
    ds_read_b64_tr_b16 a[12:13], v125 offset:12288
    ds_read_b64_tr_b16 a[14:15], v125 offset:12800
    ds_read_b64_tr_b16 a[16:17], v125 offset:16384
    ds_read_b64_tr_b16 a[18:19], v125 offset:16896
    ds_read_b64_tr_b16 a[20:21], v125 offset:20480
    ds_read_b64_tr_b16 a[22:23], v125 offset:20992
    ds_read_b64_tr_b16 a[24:25], v125 offset:24576
    ds_read_b64_tr_b16 a[26:27], v125 offset:25088
    ds_read_b64_tr_b16 a[28:29], v125 offset:28672
    ds_read_b64_tr_b16 a[30:31], v125 offset:29184
    ds_read_b64_tr_b16 a[32:33], v125 offset:32768
    ds_read_b64_tr_b16 a[34:35], v125 offset:33280
    ds_read_b64_tr_b16 a[36:37], v125 offset:36864
    ds_read_b64_tr_b16 a[38:39], v125 offset:37376
    s_waitcnt lgkmcnt(0)
    s_barrier
    s_lshl_b32 s90, s32, 10
    s_add_u32 m0, s90, 81920
    s_mov_b32 s91, 3932160
    buffer_load_dwordx4 v124, s[16:19], s91 offen nt lds
    s_add_u32 m0, m0, 4096
    s_add_u32 s91, s91, 393216
    buffer_load_dwordx4 v124, s[16:19], s91 offen nt lds
    s_add_u32 m0, m0, 4096
    s_add_u32 s91, s91, 393216
    buffer_load_dwordx4 v124, s[16:19], s91 offen nt lds
    s_add_u32 m0, m0, 4096
    s_add_u32 s91, s91, 393216
    buffer_load_dwordx4 v124, s[16:19], s91 offen nt lds
    s_add_u32 m0, m0, 4096
    s_add_u32 s91, s91, 393216
    buffer_load_dwordx4 v124, s[16:19], s91 offen nt lds
    s_add_u32 m0, m0, 4096
    s_add_u32 s91, s91, 393216
    buffer_load_dwordx4 v124, s[16:19], s91 offen nt lds
    s_add_u32 m0, m0, 4096
    s_add_u32 s91, s91, 393216
    buffer_load_dwordx4 v124, s[16:19], s91 offen nt lds
    s_add_u32 m0, m0, 4096
    s_add_u32 s91, s91, 393216
    buffer_load_dwordx4 v124, s[16:19], s91 offen nt lds
    s_add_u32 m0, m0, 4096
    s_add_u32 s91, s91, 393216
    buffer_load_dwordx4 v124, s[16:19], s91 offen nt lds
    s_add_u32 m0, m0, 4096
    s_add_u32 s91, s91, 393216
    buffer_load_dwordx4 v124, s[16:19], s91 offen nt lds
    s_waitcnt vmcnt(30)
    s_barrier
    ds_read_b64_tr_b16 a[80:81], v126 offset:0
    ds_read_b64_tr_b16 a[82:83], v126 offset:512
    ds_read_b64_tr_b16 a[84:85], v126 offset:4096
    ds_read_b64_tr_b16 a[86:87], v126 offset:4608
    ds_read_b64_tr_b16 a[88:89], v126 offset:8192
    ds_read_b64_tr_b16 a[90:91], v126 offset:8704
    ds_read_b64_tr_b16 a[92:93], v126 offset:12288
    ds_read_b64_tr_b16 a[94:95], v126 offset:12800
    ds_read_b64_tr_b16 a[96:97], v126 offset:16384
    ds_read_b64_tr_b16 a[98:99], v126 offset:16896
    ds_read_b64_tr_b16 a[100:101], v126 offset:20480
    ds_read_b64_tr_b16 a[102:103], v126 offset:20992
    ds_read_b64_tr_b16 a[104:105], v126 offset:24576
    ds_read_b64_tr_b16 a[106:107], v126 offset:25088
    ds_read_b64_tr_b16 a[108:109], v126 offset:28672
    ds_read_b64_tr_b16 a[110:111], v126 offset:29184
    ds_read_b64_tr_b16 a[112:113], v126 offset:32768
    ds_read_b64_tr_b16 a[114:115], v126 offset:33280
    ds_read_b64_tr_b16 a[116:117], v126 offset:36864
    ds_read_b64_tr_b16 a[118:119], v126 offset:37376
    s_waitcnt lgkmcnt(0)
    s_barrier
    s_mov_b32 s46, 40960
    s_lshl_b32 s90, s32, 10
    s_add_u32 m0, s90, 40960
    s_nop 0
    buffer_load_dwordx4 v10, s[24:27], s46 offen offset:0 lds
    s_add_u32 m0, m0, 3968
    s_nop 0
    buffer_load_dwordx4 v10, s[24:27], s46 offen offset:128 lds
    s_add_u32 m0, m0, 3968
    s_nop 0
    buffer_load_dwordx4 v10, s[24:27], s46 offen offset:256 lds
    s_add_u32 m0, m0, 3968
    s_nop 0
    buffer_load_dwordx4 v10, s[24:27], s46 offen offset:384 lds
    s_add_u32 m0, m0, 3968
    s_nop 0
    buffer_load_dwordx4 v10, s[24:27], s46 offen offset:512 lds
    s_add_u32 m0, m0, 3968
    s_nop 0
    buffer_load_dwordx4 v10, s[24:27], s46 offen offset:640 lds
    s_add_u32 m0, m0, 3968
    s_nop 0
    buffer_load_dwordx4 v10, s[24:27], s46 offen offset:768 lds
    s_add_u32 m0, m0, 3968
    s_nop 0
    buffer_load_dwordx4 v10, s[24:27], s46 offen offset:896 lds
    s_add_u32 m0, m0, 3968
    s_nop 0
    buffer_load_dwordx4 v10, s[24:27], s46 offen offset:1024 lds
    s_add_u32 m0, m0, 3968
    s_nop 0
    buffer_load_dwordx4 v10, s[24:27], s46 offen offset:1152 lds
    s_waitcnt vmcnt(30)
    s_barrier
    ds_read_b64_tr_b16 a[40:41], v127 offset:0
    ds_read_b64_tr_b16 a[42:43], v127 offset:512
    ds_read_b64_tr_b16 a[44:45], v127 offset:4096
    ds_read_b64_tr_b16 a[46:47], v127 offset:4608
    ds_read_b64_tr_b16 a[48:49], v127 offset:8192
    ds_read_b64_tr_b16 a[50:51], v127 offset:8704
    ds_read_b64_tr_b16 a[52:53], v127 offset:12288
    ds_read_b64_tr_b16 a[54:55], v127 offset:12800
    ds_read_b64_tr_b16 a[56:57], v127 offset:16384
    ds_read_b64_tr_b16 a[58:59], v127 offset:16896
    ds_read_b64_tr_b16 a[60:61], v127 offset:20480
    ds_read_b64_tr_b16 a[62:63], v127 offset:20992
    ds_read_b64_tr_b16 a[64:65], v127 offset:24576
    ds_read_b64_tr_b16 a[66:67], v127 offset:25088
    ds_read_b64_tr_b16 a[68:69], v127 offset:28672
    ds_read_b64_tr_b16 a[70:71], v127 offset:29184
    ds_read_b64_tr_b16 a[72:73], v127 offset:32768
    ds_read_b64_tr_b16 a[74:75], v127 offset:33280
    ds_read_b64_tr_b16 a[76:77], v127 offset:36864
    ds_read_b64_tr_b16 a[78:79], v127 offset:37376
    s_waitcnt lgkmcnt(0)
    s_waitcnt vmcnt(10)
    s_barrier
    ds_read_b64_tr_b16 a[120:121], v125 offset:0
    ds_read_b64_tr_b16 a[122:123], v125 offset:512
    ds_read_b64_tr_b16 a[124:125], v125 offset:4096
    ds_read_b64_tr_b16 a[126:127], v125 offset:4608
    ds_read_b64_tr_b16 a[128:129], v125 offset:8192
    ds_read_b64_tr_b16 a[130:131], v125 offset:8704
    ds_read_b64_tr_b16 a[132:133], v125 offset:12288
    ds_read_b64_tr_b16 a[134:135], v125 offset:12800
    ds_read_b64_tr_b16 a[136:137], v125 offset:16384
    ds_read_b64_tr_b16 a[138:139], v125 offset:16896
    ds_read_b64_tr_b16 a[140:141], v125 offset:20480
    ds_read_b64_tr_b16 a[142:143], v125 offset:20992
    ds_read_b64_tr_b16 a[144:145], v125 offset:24576
    ds_read_b64_tr_b16 a[146:147], v125 offset:25088
    ds_read_b64_tr_b16 a[148:149], v125 offset:28672
    ds_read_b64_tr_b16 a[150:151], v125 offset:29184
    ds_read_b64_tr_b16 a[152:153], v125 offset:32768
    ds_read_b64_tr_b16 a[154:155], v125 offset:33280
    ds_read_b64_tr_b16 a[156:157], v125 offset:36864
    ds_read_b64_tr_b16 a[158:159], v125 offset:37376
    s_waitcnt lgkmcnt(0)
    s_mov_b32 s49, 40960
    s_mov_b32 s47, 40960
    s_mov_b32 s37, -1
    s_add_u32 s44, s38, 475136
    s_add_u32 s45, s44, s56
    s_mov_b32 s46, 40960
    v_add_u32 v140, 0, v137
    ds_read_b128 v[84:87], v11 offset:0
    ds_read_b128 v[88:91], v11 offset:2048
    ds_read_b128 v[92:95], v12 offset:0
    ds_read_b128 v[96:99], v12 offset:2048
    s_waitcnt lgkmcnt(2)
    v_mfma_f32_16x16x32_bf16 v[108:111], a[0:3], v[84:87], 0
    ds_read_b128 v[100:103], v11 offset:4096
    v_mfma_f32_16x16x32_bf16 v[112:115], a[0:3], v[88:91], 0
    ds_read_b128 v[104:107], v11 offset:6144
    v_mfma_f32_16x16x32_bf16 v[116:119], a[80:83], v[84:87], 0
    v_mfma_f32_16x16x32_bf16 v[120:123], a[80:83], v[88:91], 0
    s_waitcnt lgkmcnt(2)
    v_mfma_f32_16x16x32_bf16 v[108:111], a[4:7], v[92:95], v[108:111]
    ds_read_b128 v[84:87], v12 offset:4096
    v_mfma_f32_16x16x32_bf16 v[112:115], a[4:7], v[96:99], v[112:115]
    ds_read_b128 v[88:91], v12 offset:6144
    v_mfma_f32_16x16x32_bf16 v[116:119], a[84:87], v[92:95], v[116:119]
    v_mfma_f32_16x16x32_bf16 v[120:123], a[84:87], v[96:99], v[120:123]
    s_waitcnt lgkmcnt(2)
    v_mfma_f32_16x16x32_bf16 v[108:111], a[8:11], v[100:103], v[108:111]
    ds_read_b128 v[92:95], v11 offset:8192
    v_mfma_f32_16x16x32_bf16 v[112:115], a[8:11], v[104:107], v[112:115]
    ds_read_b128 v[96:99], v11 offset:10240
    v_mfma_f32_16x16x32_bf16 v[116:119], a[88:91], v[100:103], v[116:119]
    v_mfma_f32_16x16x32_bf16 v[120:123], a[88:91], v[104:107], v[120:123]
    s_waitcnt lgkmcnt(2)
    v_mfma_f32_16x16x32_bf16 v[108:111], a[12:15], v[84:87], v[108:111]
    ds_read_b128 v[100:103], v12 offset:8192
    v_mfma_f32_16x16x32_bf16 v[112:115], a[12:15], v[88:91], v[112:115]
    ds_read_b128 v[104:107], v12 offset:10240
    v_mfma_f32_16x16x32_bf16 v[116:119], a[92:95], v[84:87], v[116:119]
    v_mfma_f32_16x16x32_bf16 v[120:123], a[92:95], v[88:91], v[120:123]
    s_waitcnt lgkmcnt(2)
    v_mfma_f32_16x16x32_bf16 v[108:111], a[16:19], v[92:95], v[108:111]
    ds_read_b128 v[84:87], v11 offset:12288
    v_mfma_f32_16x16x32_bf16 v[112:115], a[16:19], v[96:99], v[112:115]
    ds_read_b128 v[88:91], v11 offset:14336
    v_mfma_f32_16x16x32_bf16 v[116:119], a[96:99], v[92:95], v[116:119]
    v_mfma_f32_16x16x32_bf16 v[120:123], a[96:99], v[96:99], v[120:123]
    s_waitcnt lgkmcnt(2)
    v_mfma_f32_16x16x32_bf16 v[108:111], a[20:23], v[100:103], v[108:111]
    ds_read_b128 v[92:95], v12 offset:12288
    v_mfma_f32_16x16x32_bf16 v[112:115], a[20:23], v[104:107], v[112:115]
    ds_read_b128 v[96:99], v12 offset:14336
    v_mfma_f32_16x16x32_bf16 v[116:119], a[100:103], v[100:103], v[116:119]
    v_mfma_f32_16x16x32_bf16 v[120:123], a[100:103], v[104:107], v[120:123]
    s_waitcnt lgkmcnt(2)
    v_mfma_f32_16x16x32_bf16 v[108:111], a[24:27], v[84:87], v[108:111]
    ds_read_b128 v[100:103], v11 offset:16384
    v_mfma_f32_16x16x32_bf16 v[112:115], a[24:27], v[88:91], v[112:115]
    ds_read_b128 v[104:107], v11 offset:18432
    v_mfma_f32_16x16x32_bf16 v[116:119], a[104:107], v[84:87], v[116:119]
    v_mfma_f32_16x16x32_bf16 v[120:123], a[104:107], v[88:91], v[120:123]
    s_waitcnt lgkmcnt(2)
    v_mfma_f32_16x16x32_bf16 v[108:111], a[28:31], v[92:95], v[108:111]
    ds_read_b128 v[84:87], v12 offset:16384
    v_mfma_f32_16x16x32_bf16 v[112:115], a[28:31], v[96:99], v[112:115]
    ds_read_b128 v[88:91], v12 offset:18432
    v_mfma_f32_16x16x32_bf16 v[116:119], a[108:111], v[92:95], v[116:119]
    v_mfma_f32_16x16x32_bf16 v[120:123], a[108:111], v[96:99], v[120:123]
    s_waitcnt lgkmcnt(2)
    v_mfma_f32_16x16x32_bf16 v[108:111], a[32:35], v[100:103], v[108:111]
    ds_read_b128 v[92:95], v11 offset:20480
    v_mfma_f32_16x16x32_bf16 v[112:115], a[32:35], v[104:107], v[112:115]
    ds_read_b128 v[96:99], v11 offset:22528
    v_mfma_f32_16x16x32_bf16 v[116:119], a[112:115], v[100:103], v[116:119]
    v_mfma_f32_16x16x32_bf16 v[120:123], a[112:115], v[104:107], v[120:123]
    s_waitcnt lgkmcnt(2)
    v_mfma_f32_16x16x32_bf16 v[108:111], a[36:39], v[84:87], v[108:111]
    ds_read_b128 v[100:103], v12 offset:20480
    v_mfma_f32_16x16x32_bf16 v[112:115], a[36:39], v[88:91], v[112:115]
    ds_read_b128 v[104:107], v12 offset:22528
    v_mfma_f32_16x16x32_bf16 v[116:119], a[116:119], v[84:87], v[116:119]
    v_mfma_f32_16x16x32_bf16 v[120:123], a[116:119], v[88:91], v[120:123]
    s_waitcnt lgkmcnt(2)
    v_mfma_f32_16x16x32_bf16 v[108:111], a[40:43], v[92:95], v[108:111]
    ds_read_b128 v[84:87], v11 offset:24576
    v_mfma_f32_16x16x32_bf16 v[112:115], a[40:43], v[96:99], v[112:115]
    ds_read_b128 v[88:91], v11 offset:26624
    v_mfma_f32_16x16x32_bf16 v[116:119], a[120:123], v[92:95], v[116:119]
    v_mfma_f32_16x16x32_bf16 v[120:123], a[120:123], v[96:99], v[120:123]
    s_waitcnt lgkmcnt(2)
    v_mfma_f32_16x16x32_bf16 v[108:111], a[44:47], v[100:103], v[108:111]
    ds_read_b128 v[92:95], v12 offset:24576
    v_mfma_f32_16x16x32_bf16 v[112:115], a[44:47], v[104:107], v[112:115]
    ds_read_b128 v[96:99], v12 offset:26624
    v_mfma_f32_16x16x32_bf16 v[116:119], a[124:127], v[100:103], v[116:119]
    v_mfma_f32_16x16x32_bf16 v[120:123], a[124:127], v[104:107], v[120:123]
    s_waitcnt lgkmcnt(2)
    v_mfma_f32_16x16x32_bf16 v[108:111], a[48:51], v[84:87], v[108:111]
    ds_read_b128 v[100:103], v11 offset:28672
    v_mfma_f32_16x16x32_bf16 v[112:115], a[48:51], v[88:91], v[112:115]
    ds_read_b128 v[104:107], v11 offset:30720
    v_mfma_f32_16x16x32_bf16 v[116:119], a[128:131], v[84:87], v[116:119]
    v_mfma_f32_16x16x32_bf16 v[120:123], a[128:131], v[88:91], v[120:123]
    s_waitcnt lgkmcnt(2)
    v_mfma_f32_16x16x32_bf16 v[108:111], a[52:55], v[92:95], v[108:111]
    ds_read_b128 v[84:87], v12 offset:28672
    v_mfma_f32_16x16x32_bf16 v[112:115], a[52:55], v[96:99], v[112:115]
    ds_read_b128 v[88:91], v12 offset:30720
    v_mfma_f32_16x16x32_bf16 v[116:119], a[132:135], v[92:95], v[116:119]
    v_mfma_f32_16x16x32_bf16 v[120:123], a[132:135], v[96:99], v[120:123]
    s_waitcnt lgkmcnt(2)
    v_mfma_f32_16x16x32_bf16 v[108:111], a[56:59], v[100:103], v[108:111]
    ds_read_b128 v[92:95], v11 offset:32768
    v_mfma_f32_16x16x32_bf16 v[112:115], a[56:59], v[104:107], v[112:115]
    ds_read_b128 v[96:99], v11 offset:34816
    v_mfma_f32_16x16x32_bf16 v[116:119], a[136:139], v[100:103], v[116:119]
    v_mfma_f32_16x16x32_bf16 v[120:123], a[136:139], v[104:107], v[120:123]
    s_waitcnt lgkmcnt(2)
    v_mfma_f32_16x16x32_bf16 v[108:111], a[60:63], v[84:87], v[108:111]
    ds_read_b128 v[100:103], v12 offset:32768
    v_mfma_f32_16x16x32_bf16 v[112:115], a[60:63], v[88:91], v[112:115]
    ds_read_b128 v[104:107], v12 offset:34816
    v_mfma_f32_16x16x32_bf16 v[116:119], a[140:143], v[84:87], v[116:119]
    v_mfma_f32_16x16x32_bf16 v[120:123], a[140:143], v[88:91], v[120:123]
    s_waitcnt lgkmcnt(2)
    v_mfma_f32_16x16x32_bf16 v[108:111], a[64:67], v[92:95], v[108:111]
    ds_read_b128 v[84:87], v11 offset:36864
    v_mfma_f32_16x16x32_bf16 v[112:115], a[64:67], v[96:99], v[112:115]
    ds_read_b128 v[88:91], v11 offset:38912
    v_mfma_f32_16x16x32_bf16 v[116:119], a[144:147], v[92:95], v[116:119]
    v_mfma_f32_16x16x32_bf16 v[120:123], a[144:147], v[96:99], v[120:123]
    s_waitcnt lgkmcnt(2)
    v_mfma_f32_16x16x32_bf16 v[108:111], a[68:71], v[100:103], v[108:111]
    ds_read_b128 v[92:95], v12 offset:36864
    v_mfma_f32_16x16x32_bf16 v[112:115], a[68:71], v[104:107], v[112:115]
    ds_read_b128 v[96:99], v12 offset:38912
    v_mfma_f32_16x16x32_bf16 v[116:119], a[148:151], v[100:103], v[116:119]
    v_mfma_f32_16x16x32_bf16 v[120:123], a[148:151], v[104:107], v[120:123]
    s_waitcnt lgkmcnt(0)
    v_mfma_f32_16x16x32_bf16 v[108:111], a[72:75], v[84:87], v[108:111]
    v_add_u32 v11, s49, v11
    v_mfma_f32_16x16x32_bf16 v[112:115], a[72:75], v[88:91], v[112:115]
    v_add_u32 v12, s49, v12
    v_mfma_f32_16x16x32_bf16 v[108:111], a[76:79], v[92:95], v[108:111]
    s_sub_u32 s47, s47, s49
    v_mfma_f32_16x16x32_bf16 v[112:115], a[76:79], v[96:99], v[112:115]
    s_sub_u32 s49, 0, s49
    v_mfma_f32_16x16x32_bf16 v[116:119], a[152:155], v[84:87], v[116:119]
    v_mfma_f32_16x16x32_bf16 v[120:123], a[152:155], v[88:91], v[120:123]
    v_mfma_f32_16x16x32_bf16 v[116:119], a[156:159], v[92:95], v[116:119]
    v_mfma_f32_16x16x32_bf16 v[120:123], a[156:159], v[96:99], v[120:123]
    v_cvt_pk_bf16_f32 v124, v108, v109
    v_cvt_pk_bf16_f32 v125, v110, v111
    v_cvt_pk_bf16_f32 v126, v112, v113
    v_cvt_pk_bf16_f32 v127, v114, v115
    s_nop 0
    v_permlane16_swap_b32 v124, v126
    v_permlane16_swap_b32 v125, v127
    v_cvt_pk_bf16_f32 v128, v116, v117
    v_cvt_pk_bf16_f32 v129, v118, v119
    v_cvt_pk_bf16_f32 v130, v120, v121
    v_cvt_pk_bf16_f32 v131, v122, v123
    s_nop 0
    v_permlane16_swap_b32 v128, v130
    v_permlane16_swap_b32 v129, v131
    ds_write_b128 v140, v[128:131]
    buffer_store_dwordx4 v[124:127], v19, s[4:7], s44 offen
    buffer_store_dwordx4 v[128:131], v19, s[4:7], s45 offen
    v_mov_b32 v1, 192
L_gw_1:
    buffer_load_dword v2, v1, s[8:11], 0 offen sc1
    s_sub_u32 s36, s36, 1
    s_cbranch_scc1 L_exit
    s_waitcnt vmcnt(0)
    v_readfirstlane_b32 s90, v2
    s_nop 0
    s_cmp_eq_u32 s90, 0
    s_cbranch_scc1 L_gw_1
    s_cmp_lg_u32 s90, 1
    s_cbranch_scc1 L_slow
    s_waitcnt vmcnt(0) lgkmcnt(0)
    s_barrier
    s_add_u32 s44, s38, 573440
    s_add_u32 s45, s44, s56
    s_mov_b32 s46, 81920
    v_add_u32 v140, 4096, v137
    ds_read_b128 v[84:87], v11 offset:0
    ds_read_b128 v[88:91], v11 offset:2048
    ds_read_b128 v[92:95], v12 offset:0
    ds_read_b128 v[96:99], v12 offset:2048
    s_lshl_b32 s90, s32, 10
    s_add_u32 m0, s90, s47
    s_waitcnt lgkmcnt(2)
    v_mfma_f32_16x16x32_bf16 v[108:111], a[0:3], v[84:87], 0
    ds_read_b128 v[100:103], v11 offset:4096
    s_and_b32 s50, s37, 3
    v_mfma_f32_16x16x32_bf16 v[112:115], a[0:3], v[88:91], 0
    ds_read_b128 v[104:107], v11 offset:6144
    s_mul_i32 s53, s50, 327680
    v_mfma_f32_16x16x32_bf16 v[116:119], a[80:83], v[84:87], 0
    buffer_load_dwordx4 v10, s[24:27], s46 offen offset:0 lds
    s_add_u32 m0, m0, 3968
    v_mfma_f32_16x16x32_bf16 v[120:123], a[80:83], v[88:91], 0
    s_waitcnt lgkmcnt(2)
    s_add_u32 s51, s37, 2
    v_mfma_f32_16x16x32_bf16 v[108:111], a[4:7], v[92:95], v[108:111]
    ds_read_b128 v[84:87], v12 offset:4096
    s_and_b32 s50, s51, 3
    v_mfma_f32_16x16x32_bf16 v[112:115], a[4:7], v[96:99], v[112:115]
    ds_read_b128 v[88:91], v12 offset:6144
    s_mul_i32 s50, s50, 98304
    v_mfma_f32_16x16x32_bf16 v[116:119], a[84:87], v[92:95], v[116:119]
    buffer_load_dwordx4 v10, s[24:27], s46 offen offset:128 lds
    s_add_u32 m0, m0, 3968
    v_mfma_f32_16x16x32_bf16 v[120:123], a[84:87], v[96:99], v[120:123]
    s_waitcnt lgkmcnt(2)
    s_add_u32 s50, s50, 475136
    v_mfma_f32_16x16x32_bf16 v[108:111], a[8:11], v[100:103], v[108:111]
    ds_read_b128 v[92:95], v11 offset:8192
    s_add_u32 s44, s38, s50
    v_mfma_f32_16x16x32_bf16 v[112:115], a[8:11], v[104:107], v[112:115]
    ds_read_b128 v[96:99], v11 offset:10240
    s_add_u32 s45, s44, s56
    v_mfma_f32_16x16x32_bf16 v[116:119], a[88:91], v[100:103], v[116:119]
    buffer_load_dwordx4 v10, s[24:27], s46 offen offset:256 lds
    s_add_u32 m0, m0, 3968
    v_mfma_f32_16x16x32_bf16 v[120:123], a[88:91], v[104:107], v[120:123]
    s_waitcnt lgkmcnt(2)
    s_and_b32 s50, s51, 3
    v_mfma_f32_16x16x32_bf16 v[108:111], a[12:15], v[84:87], v[108:111]
    ds_read_b128 v[100:103], v12 offset:8192
    s_lshl_b32 s50, s50, 12
    v_mfma_f32_16x16x32_bf16 v[112:115], a[12:15], v[88:91], v[112:115]
    ds_read_b128 v[104:107], v12 offset:10240
    v_add_u32 v140, s50, v137
    v_mfma_f32_16x16x32_bf16 v[116:119], a[92:95], v[84:87], v[116:119]
    buffer_load_dwordx4 v10, s[24:27], s46 offen offset:384 lds
    s_add_u32 m0, m0, 3968
    v_mfma_f32_16x16x32_bf16 v[120:123], a[92:95], v[88:91], v[120:123]
    s_waitcnt lgkmcnt(2)
    s_add_u32 s37, s37, 1
    v_mfma_f32_16x16x32_bf16 v[108:111], a[16:19], v[92:95], v[108:111]
    ds_read_b128 v[84:87], v11 offset:12288
    s_mov_b32 s52, 0
    v_mfma_f32_16x16x32_bf16 v[112:115], a[16:19], v[96:99], v[112:115]
    ds_read_b128 v[88:91], v11 offset:14336
    s_and_b32 s50, s37, 3
    v_mfma_f32_16x16x32_bf16 v[116:119], a[96:99], v[92:95], v[116:119]
    buffer_load_dwordx4 v10, s[24:27], s46 offen offset:512 lds
    s_add_u32 m0, m0, 3968
    v_mfma_f32_16x16x32_bf16 v[120:123], a[96:99], v[96:99], v[120:123]
    s_waitcnt lgkmcnt(2)
    s_mul_i32 s51, s50, 114688
    v_mfma_f32_16x16x32_bf16 v[108:111], a[20:23], v[100:103], v[108:111]
    ds_read_b128 v[92:95], v12 offset:12288
    s_add_u32 s41, s38, s51
    v_mfma_f32_16x16x32_bf16 v[112:115], a[20:23], v[104:107], v[112:115]
    ds_read_b128 v[96:99], v12 offset:14336
    s_and_b32 s54, s37, s55
    v_mfma_f32_16x16x32_bf16 v[116:119], a[100:103], v[100:103], v[116:119]
    buffer_load_dwordx4 v10, s[24:27], s46 offen offset:640 lds
    s_add_u32 m0, m0, 3968
    v_mfma_f32_16x16x32_bf16 v[120:123], a[100:103], v[104:107], v[120:123]
    s_waitcnt lgkmcnt(2)
    s_lshl_b32 s50, s50, 12
    v_mfma_f32_16x16x32_bf16 v[108:111], a[24:27], v[84:87], v[108:111]
    ds_read_b128 v[100:103], v11 offset:16384
    v_add_u32 v141, s50, v138
    v_mfma_f32_16x16x32_bf16 v[112:115], a[24:27], v[88:91], v[112:115]
    ds_read_b128 v[104:107], v11 offset:18432
    s_add_u32 s43, s41, 40960
    v_mfma_f32_16x16x32_bf16 v[116:119], a[104:107], v[84:87], v[116:119]
    buffer_load_dwordx4 v10, s[24:27], s46 offen offset:768 lds
    s_add_u32 m0, m0, 3968
    v_mfma_f32_16x16x32_bf16 v[120:123], a[104:107], v[88:91], v[120:123]
    s_waitcnt lgkmcnt(2)
    v_mfma_f32_16x16x32_bf16 v[108:111], a[28:31], v[92:95], v[108:111]
    ds_read_b128 v[84:87], v12 offset:16384
    v_mfma_f32_16x16x32_bf16 v[112:115], a[28:31], v[96:99], v[112:115]
    ds_read_b128 v[88:91], v12 offset:18432
    v_mfma_f32_16x16x32_bf16 v[116:119], a[108:111], v[92:95], v[116:119]
    buffer_load_dwordx4 v10, s[24:27], s46 offen offset:896 lds
    s_add_u32 m0, m0, 3968
    v_mfma_f32_16x16x32_bf16 v[120:123], a[108:111], v[96:99], v[120:123]
    s_waitcnt lgkmcnt(2)
    v_mfma_f32_16x16x32_bf16 v[108:111], a[32:35], v[100:103], v[108:111]
    ds_read_b128 v[92:95], v11 offset:20480
    v_mfma_f32_16x16x32_bf16 v[112:115], a[32:35], v[104:107], v[112:115]
    ds_read_b128 v[96:99], v11 offset:22528
    v_mfma_f32_16x16x32_bf16 v[116:119], a[112:115], v[100:103], v[116:119]
    buffer_load_dwordx4 v10, s[24:27], s46 offen offset:1024 lds
    s_add_u32 m0, m0, 3968
    v_mfma_f32_16x16x32_bf16 v[120:123], a[112:115], v[104:107], v[120:123]
    s_waitcnt lgkmcnt(2)
    v_mfma_f32_16x16x32_bf16 v[108:111], a[36:39], v[84:87], v[108:111]
    ds_read_b128 v[100:103], v12 offset:20480
    v_mfma_f32_16x16x32_bf16 v[112:115], a[36:39], v[88:91], v[112:115]
    ds_read_b128 v[104:107], v12 offset:22528
    v_mfma_f32_16x16x32_bf16 v[116:119], a[116:119], v[84:87], v[116:119]
    buffer_load_dwordx4 v10, s[24:27], s46 offen offset:1152 lds
    v_mfma_f32_16x16x32_bf16 v[120:123], a[116:119], v[88:91], v[120:123]
    s_waitcnt lgkmcnt(2)
    v_mfma_f32_16x16x32_bf16 v[108:111], a[40:43], v[92:95], v[108:111]
    ds_read_b128 v[84:87], v11 offset:24576
    v_mfma_f32_16x16x32_bf16 v[112:115], a[40:43], v[96:99], v[112:115]
    ds_read_b128 v[88:91], v11 offset:26624
    v_mfma_f32_16x16x32_bf16 v[116:119], a[120:123], v[92:95], v[116:119]
    v_mfma_f32_16x16x32_bf16 v[120:123], a[120:123], v[96:99], v[120:123]
    s_waitcnt lgkmcnt(2)
    v_mfma_f32_16x16x32_bf16 v[108:111], a[44:47], v[100:103], v[108:111]
    ds_read_b128 v[92:95], v12 offset:24576
    v_mfma_f32_16x16x32_bf16 v[112:115], a[44:47], v[104:107], v[112:115]
    ds_read_b128 v[96:99], v12 offset:26624
    v_mfma_f32_16x16x32_bf16 v[116:119], a[124:127], v[100:103], v[116:119]
    v_mfma_f32_16x16x32_bf16 v[120:123], a[124:127], v[104:107], v[120:123]
    s_waitcnt lgkmcnt(2)
    v_mfma_f32_16x16x32_bf16 v[108:111], a[48:51], v[84:87], v[108:111]
    ds_read_b128 v[100:103], v11 offset:28672
    v_mfma_f32_16x16x32_bf16 v[112:115], a[48:51], v[88:91], v[112:115]
    ds_read_b128 v[104:107], v11 offset:30720
    v_mfma_f32_16x16x32_bf16 v[116:119], a[128:131], v[84:87], v[116:119]
    v_mfma_f32_16x16x32_bf16 v[120:123], a[128:131], v[88:91], v[120:123]
    s_waitcnt lgkmcnt(2)
    v_mfma_f32_16x16x32_bf16 v[108:111], a[52:55], v[92:95], v[108:111]
    ds_read_b128 v[84:87], v12 offset:28672
    v_mfma_f32_16x16x32_bf16 v[112:115], a[52:55], v[96:99], v[112:115]
    ds_read_b128 v[88:91], v12 offset:30720
    v_mfma_f32_16x16x32_bf16 v[116:119], a[132:135], v[92:95], v[116:119]
    v_mfma_f32_16x16x32_bf16 v[120:123], a[132:135], v[96:99], v[120:123]
    s_waitcnt lgkmcnt(2)
    v_mfma_f32_16x16x32_bf16 v[108:111], a[56:59], v[100:103], v[108:111]
    ds_read_b128 v[92:95], v11 offset:32768
    v_mfma_f32_16x16x32_bf16 v[112:115], a[56:59], v[104:107], v[112:115]
    ds_read_b128 v[96:99], v11 offset:34816
    v_mfma_f32_16x16x32_bf16 v[116:119], a[136:139], v[100:103], v[116:119]
    v_mfma_f32_16x16x32_bf16 v[120:123], a[136:139], v[104:107], v[120:123]
    s_waitcnt lgkmcnt(2)
    v_mfma_f32_16x16x32_bf16 v[108:111], a[60:63], v[84:87], v[108:111]
    ds_read_b128 v[100:103], v12 offset:32768
    v_mfma_f32_16x16x32_bf16 v[112:115], a[60:63], v[88:91], v[112:115]
    ds_read_b128 v[104:107], v12 offset:34816
    v_mfma_f32_16x16x32_bf16 v[116:119], a[140:143], v[84:87], v[116:119]
    v_mfma_f32_16x16x32_bf16 v[120:123], a[140:143], v[88:91], v[120:123]
    s_waitcnt lgkmcnt(2)
    v_mfma_f32_16x16x32_bf16 v[108:111], a[64:67], v[92:95], v[108:111]
    ds_read_b128 v[84:87], v11 offset:36864
    v_mfma_f32_16x16x32_bf16 v[112:115], a[64:67], v[96:99], v[112:115]
    ds_read_b128 v[88:91], v11 offset:38912
    v_mfma_f32_16x16x32_bf16 v[116:119], a[144:147], v[92:95], v[116:119]
    v_mfma_f32_16x16x32_bf16 v[120:123], a[144:147], v[96:99], v[120:123]
    s_waitcnt lgkmcnt(2)
    v_mfma_f32_16x16x32_bf16 v[108:111], a[68:71], v[100:103], v[108:111]
    ds_read_b128 v[92:95], v12 offset:36864
    v_mfma_f32_16x16x32_bf16 v[112:115], a[68:71], v[104:107], v[112:115]
    ds_read_b128 v[96:99], v12 offset:38912
    v_mfma_f32_16x16x32_bf16 v[116:119], a[148:151], v[100:103], v[116:119]
    v_mfma_f32_16x16x32_bf16 v[120:123], a[148:151], v[104:107], v[120:123]
    s_waitcnt lgkmcnt(0)
    v_mfma_f32_16x16x32_bf16 v[108:111], a[72:75], v[84:87], v[108:111]
    v_add_u32 v11, s49, v11
    v_mfma_f32_16x16x32_bf16 v[112:115], a[72:75], v[88:91], v[112:115]
    v_add_u32 v12, s49, v12
    v_mfma_f32_16x16x32_bf16 v[108:111], a[76:79], v[92:95], v[108:111]
    s_sub_u32 s47, s47, s49
    v_mfma_f32_16x16x32_bf16 v[112:115], a[76:79], v[96:99], v[112:115]
    s_sub_u32 s49, 0, s49
    v_mfma_f32_16x16x32_bf16 v[116:119], a[152:155], v[84:87], v[116:119]
    v_mfma_f32_16x16x32_bf16 v[120:123], a[152:155], v[88:91], v[120:123]
    v_mfma_f32_16x16x32_bf16 v[116:119], a[156:159], v[92:95], v[116:119]
    v_mfma_f32_16x16x32_bf16 v[120:123], a[156:159], v[96:99], v[120:123]
    v_cvt_pk_bf16_f32 v124, v108, v109
    v_cvt_pk_bf16_f32 v125, v110, v111
    v_cvt_pk_bf16_f32 v126, v112, v113
    v_cvt_pk_bf16_f32 v127, v114, v115
    s_nop 0
    v_permlane16_swap_b32 v124, v126
    v_permlane16_swap_b32 v125, v127
    v_cvt_pk_bf16_f32 v128, v116, v117
    v_cvt_pk_bf16_f32 v129, v118, v119
    v_cvt_pk_bf16_f32 v130, v120, v121
    v_cvt_pk_bf16_f32 v131, v122, v123
    s_nop 0
    v_permlane16_swap_b32 v128, v130
    v_permlane16_swap_b32 v129, v131
    ds_write_b128 v140, v[128:131]
    buffer_store_dwordx4 v[124:127], v19, s[4:7], s44 offen
    buffer_store_dwordx4 v[128:131], v19, s[4:7], s45 offen
    v_mov_b32 v3, 460288
L_pf_2:
    buffer_load_dword v4, v3, s[4:7], s38 offen sc1
    s_sub_u32 s36, s36, 1
    s_cbranch_scc1 L_exit
    s_waitcnt vmcnt(0)
    v_readfirstlane_b32 s90, v4
    s_nop 0
    s_cmp_eq_u32 s90, 0
    s_cbranch_scc1 L_pf_2
    s_and_b32 s90, s90, 2
    s_lshl_b32 s90, s90, 12
    v_mov_b32 v3, s90
    v_mov_b32 v4, v3
    v_cmp_gt_u32 vcc, 16, v0
    s_nop 1
    v_cndmask_b32 v3, v3, v4, vcc
    v_add_u32 v142, v3, v142
    v_add_u32 v143, s90, v143
    v_add_u32 v144, 0, v142
    v_add_u32 v145, 0, v143
    s_mov_b32 m0, s48
    v_mov_b32 v3, 200
L_p0_3:
    buffer_load_dword v4, v3, s[8:11], 0 offen sc1
    s_sub_u32 s36, s36, 1
    s_cbranch_scc1 L_exit
    s_waitcnt vmcnt(0)
    v_readfirstlane_b32 s90, v4
    s_nop 0
    s_cmp_eq_u32 s90, 0
    s_cbranch_scc1 L_p0_3
    s_and_b32 s90, s90, 2
    s_lshl_b32 s90, s90, 12
    s_and_b32 s91, s34, 1
    s_lshl_b32 s91, s91, 12
    s_lshr_b32 s92, s34, 2
    s_lshl_b32 s92, s92, 13
    s_add_u32 s91, s91, s92
    s_and_b32 s92, s34, 2
    s_lshl_b32 s92, s92, 13
    s_add_u32 s91, s91, s92
    s_xor_b32 s91, s91, s90
    s_add_u32 s91, s91, 1933312
    v_lshrrev_b32 v4, 2, v0
    v_lshl_add_u32 v3, v4, 9, s91
    v_cmp_ne_u32 s[92:93], s34, v4
    v_cmp_gt_u32 vcc, 32, v0
    s_nop 0
    s_and_b64 vcc, vcc, s[92:93]
    s_and_b32 vcc_lo, vcc_lo, s55
    v_cndmask_b32 v146, v146, v3, vcc
L_qkv_loop_f:
    buffer_load_dwordx4 v13, s[4:7], s41 offen sc1 lds
    buffer_load_dwordx4 v13, s[4:7], s41 offen offset:1024 sc1 lds
    buffer_load_dword v14, s[4:7], s41 offen offset:2048 sc1 lds
    buffer_load_dword v14, s[4:7], s41 offen offset:2304 sc1 lds
    s_add_u32 s50, s37, 2
    s_and_b32 s50, s50, 3
    s_mul_i32 s50, s50, 114688
    s_add_u32 s42, s38, s50
    s_add_u32 s50, s37, 3
    s_min_u32 s50, s50, 63
    s_mul_i32 s46, s50, 40960
    s_add_u32 s51, s37, 1
    v_mov_b32 v20, s51
    s_mov_b32 m0, s48
    v_mov_b32 v68, 0
    v_mov_b32 v69, 0
    v_mov_b32 v70, 0
    v_mov_b32 v71, 0
    v_mov_b32 v72, 0
    v_mov_b32 v73, 0
    v_mov_b32 v74, 0
    v_mov_b32 v75, 0
    ds_read_b128 v[156:159], v141
    ds_read_b128 v[160:163], v141 offset:1024
L_poll_5:
    buffer_load_dwordx4 v13, s[4:7], s41 offen sc1 lds
    buffer_load_dwordx4 v13, s[4:7], s41 offen offset:1024 sc1 lds
    buffer_load_dword v14, s[4:7], s41 offen offset:2048 sc1 lds
    buffer_load_dword v14, s[4:7], s41 offen offset:2304 sc1 lds
    s_sub_u32 s36, s36, 1
    s_cbranch_scc1 L_exit
    s_waitcnt vmcnt(4)
    ds_read_b32 v18, v15
    s_waitcnt lgkmcnt(0)
    v_cmp_eq_u32 vcc, -1, v18
    s_cbranch_vccnz L_poll_5
    s_barrier
    ds_read_b128 v[28:31], v16 offset:0
    ds_read_b128 v[32:35], v16 offset:1024
    ds_read_b128 v[36:39], v16 offset:2048
    ds_read_b128 v[40:43], v16 offset:3072
    s_waitcnt lgkmcnt(3)
    v_smfmac_f32_16x16x64_bf16 v[68:71], v[28:31], a[0:7], v17
    ds_read_b128 v[44:47], v16 offset:4096
    v_smfmac_f32_16x16x64_bf16 v[72:75], v[28:31], a[80:87], v17
    ds_read_b128 v[48:51], v16 offset:5120
    s_waitcnt lgkmcnt(4)
    v_smfmac_f32_16x16x64_bf16 v[68:71], v[32:35], a[8:15], v17
    ds_read_b128 v[52:55], v16 offset:6144
    v_smfmac_f32_16x16x64_bf16 v[72:75], v[32:35], a[88:95], v17
    ds_read_b128 v[56:59], v16 offset:7168
    s_waitcnt lgkmcnt(5)
    v_smfmac_f32_16x16x64_bf16 v[68:71], v[36:39], a[16:23], v17
    ds_read_b128 v[60:63], v16 offset:8192
    s_waitcnt lgkmcnt(5)
    v_smfmac_f32_16x16x64_bf16 v[68:71], v[40:43], a[24:31], v17
    ds_read_b128 v[64:67], v16 offset:9216
    s_waitcnt lgkmcnt(5)
    v_smfmac_f32_16x16x64_bf16 v[68:71], v[44:47], a[32:39], v17
    s_waitcnt lgkmcnt(4)
    v_smfmac_f32_16x16x64_bf16 v[68:71], v[48:51], a[40:47], v17
    s_waitcnt lgkmcnt(3)
    v_smfmac_f32_16x16x64_bf16 v[68:71], v[52:55], a[48:55], v17
    s_waitcnt lgkmcnt(2)
    v_smfmac_f32_16x16x64_bf16 v[68:71], v[56:59], a[56:63], v17
    s_waitcnt lgkmcnt(1)
    v_smfmac_f32_16x16x64_bf16 v[68:71], v[60:63], a[64:71], v17
    buffer_store_dword v20, v21, s[4:7], s38 offen offset:0
    s_waitcnt lgkmcnt(0)
    v_smfmac_f32_16x16x64_bf16 v[68:71], v[64:67], a[72:79], v17
L_redo_4:
    v_smfmac_f32_16x16x64_bf16 v[72:75], v[36:39], a[96:103], v17
    v_smfmac_f32_16x16x64_bf16 v[72:75], v[40:43], a[104:111], v17
    v_smfmac_f32_16x16x64_bf16 v[72:75], v[44:47], a[112:119], v17
    v_add_f32 v68, v68, v70
    v_add_f32 v69, v69, v71
    v_smfmac_f32_16x16x64_bf16 v[72:75], v[48:51], a[120:127], v17
    v_cvt_pk_bf16_f32 v132, v68, v69
    ds_write_b32 v23, v132
    v_smfmac_f32_16x16x64_bf16 v[72:75], v[52:55], a[128:135], v17
    v_cmp_u_f32 vcc, v68, v69
    v_smfmac_f32_16x16x64_bf16 v[72:75], v[56:59], a[136:143], v17
    v_smfmac_f32_16x16x64_bf16 v[72:75], v[60:63], a[144:151], v17
    s_cbranch_vccnz L_nan_6
L_cont_7:
    v_smfmac_f32_16x16x64_bf16 v[72:75], v[64:67], a[152:159], v17
    s_waitcnt lgkmcnt(0)
    s_barrier
    ds_read_b64_tr_b16 v[76:77], v24 offset:0
    ds_read_b64_tr_b16 v[78:79], v134 offset:0
    ds_read_b64_tr_b16 v[80:81], v24 offset:1024
    ds_read_b64_tr_b16 v[82:83], v134 offset:1024
    s_cmp_eq_u32 s32, 0
    s_cbranch_scc1 L_w0_8
    s_cmp_eq_u32 s32, 3
    s_cbranch_scc1 L_w3_9
    v_pk_add_f32 v[72:73], v[72:73], v[74:75]
    v_cvt_pk_bf16_f32 v133, v72, v73
    ds_write_b32 v23, v133 offset:4
    s_waitcnt lgkmcnt(3)
    v_mfma_f32_16x16x32_bf16 v[164:167], v[156:159], v[76:79], 0
    s_waitcnt lgkmcnt(1)
    v_mfma_f32_16x16x32_bf16 v[164:167], v[160:163], v[80:83], v[164:167]
    s_waitcnt lgkmcnt(0)
    s_barrier
    s_nop 5
    buffer_store_dwordx4 v[164:167], v135, s[4:7], s41 offen
    ds_read_b128 v[84:87], v11 offset:0
    ds_read_b128 v[88:91], v11 offset:2048
    ds_read_b128 v[92:95], v12 offset:0
    ds_read_b128 v[96:99], v12 offset:2048
    s_branch L_join_10
L_w0_8:
    v_pk_add_f32 v[72:73], v[72:73], v[74:75]
    v_cvt_pk_bf16_f32 v133, v72, v73
    ds_write_b32 v23, v133 offset:4
    s_waitcnt lgkmcnt(0)
    s_barrier
    ds_read_b64_tr_b16 v[76:77], v24 offset:0
    ds_read_b64_tr_b16 v[78:79], v134 offset:0
    ds_read_b64_tr_b16 v[80:81], v24 offset:1024
    ds_read_b64_tr_b16 v[82:83], v134 offset:1024
    s_waitcnt lgkmcnt(2)
    v_mfma_f32_16x16x32_bf16 v[164:167], v[76:79], v[76:79], 0
    s_waitcnt lgkmcnt(0)
    v_mfma_f32_16x16x32_bf16 v[164:167], v[80:83], v[80:83], v[164:167]
    ds_read_b128 v[84:87], v11 offset:0
    ds_read_b128 v[88:91], v11 offset:2048
    ds_read_b128 v[92:95], v12 offset:0
    ds_read_b128 v[96:99], v12 offset:2048
    s_nop 3
    buffer_store_dword v166, v135, s[4:7], s41 offen
    buffer_store_dword v167, v135, s[4:7], s41 offen offset:8
    s_branch L_join_10
L_w3_9:
    v_pk_add_f32 v[72:73], v[72:73], v[74:75]
    v_cvt_pk_bf16_f32 v133, v72, v73
    ds_write_b32 v23, v133 offset:4
    s_waitcnt lgkmcnt(0)
    s_barrier
    ds_read_b64_tr_b16 v[76:77], v24 offset:0
    ds_read_b64_tr_b16 v[78:79], v134 offset:0
    ds_read_b64_tr_b16 v[80:81], v24 offset:1024
    ds_read_b64_tr_b16 v[82:83], v134 offset:1024
    buffer_store_dword v20, v21, s[4:7], s38 offen offset:32
    s_waitcnt lgkmcnt(0)
    ds_read_b128 v[84:87], v11 offset:0
    ds_read_b128 v[88:91], v11 offset:2048
    ds_read_b128 v[92:95], v12 offset:0
    ds_read_b128 v[96:99], v12 offset:2048
    s_waitcnt lgkmcnt(0)
    buffer_store_dwordx4 v[76:79], v136, s[4:7], s43 offen
    buffer_store_dwordx4 v[80:83], v136, s[4:7], s43 offen offset:512
L_join_10:
    s_cmp_eq_u32 s37, 63
    s_cbranch_scc1 L_end_11
    s_lshl_b32 s90, s32, 10
    s_add_u32 m0, s90, s47
    s_waitcnt lgkmcnt(2)
    v_mfma_f32_16x16x32_bf16 v[108:111], a[0:3], v[84:87], 0
    ds_read_b128 v[100:103], v11 offset:4096
    s_and_b32 s50, s37, 3
    v_mfma_f32_16x16x32_bf16 v[112:115], a[0:3], v[88:91], 0
    ds_read_b128 v[104:107], v11 offset:6144
    s_mul_i32 s53, s50, 327680
    v_mfma_f32_16x16x32_bf16 v[116:119], a[80:83], v[84:87], 0
    s_add_u32 s51, s37, 2
    s_and_b32 s50, s51, 3
    v_mfma_f32_16x16x32_bf16 v[120:123], a[80:83], v[88:91], 0
    s_waitcnt lgkmcnt(2)
    s_mul_i32 s50, s50, 98304
    v_mfma_f32_16x16x32_bf16 v[108:111], a[4:7], v[92:95], v[108:111]
    ds_read_b128 v[84:87], v12 offset:4096
    s_add_u32 s50, s50, 475136
    v_mfma_f32_16x16x32_bf16 v[112:115], a[4:7], v[96:99], v[112:115]
    ds_read_b128 v[88:91], v12 offset:6144
    s_add_u32 s44, s38, s50
    v_mfma_f32_16x16x32_bf16 v[116:119], a[84:87], v[92:95], v[116:119]
    s_add_u32 s45, s44, s56
    s_and_b32 s50, s51, 3
    v_mfma_f32_16x16x32_bf16 v[120:123], a[84:87], v[96:99], v[120:123]
    s_waitcnt lgkmcnt(2)
    s_lshl_b32 s50, s50, 12
    v_mfma_f32_16x16x32_bf16 v[108:111], a[8:11], v[100:103], v[108:111]
    ds_read_b128 v[92:95], v11 offset:8192
    v_add_u32 v140, s50, v137
    v_mfma_f32_16x16x32_bf16 v[112:115], a[8:11], v[104:107], v[112:115]
    ds_read_b128 v[96:99], v11 offset:10240
    s_add_u32 s37, s37, 1
    v_mfma_f32_16x16x32_bf16 v[116:119], a[88:91], v[100:103], v[116:119]
    s_mov_b32 s52, 0
    s_and_b32 s50, s37, 3
    v_mfma_f32_16x16x32_bf16 v[120:123], a[88:91], v[104:107], v[120:123]
    s_waitcnt lgkmcnt(2)
    s_mul_i32 s51, s50, 114688
    v_mfma_f32_16x16x32_bf16 v[108:111], a[12:15], v[84:87], v[108:111]
    ds_read_b128 v[100:103], v12 offset:8192
    s_add_u32 s41, s38, s51
    v_mfma_f32_16x16x32_bf16 v[112:115], a[12:15], v[88:91], v[112:115]
    ds_read_b128 v[104:107], v12 offset:10240
    s_and_b32 s54, s37, s55
    v_mfma_f32_16x16x32_bf16 v[116:119], a[92:95], v[84:87], v[116:119]
    buffer_store_dword v22, v150, s[4:7], s42 offen offset:0
    buffer_store_dword v22, v149, s[4:7], s42 offen offset:0
    v_mfma_f32_16x16x32_bf16 v[120:123], a[92:95], v[88:91], v[120:123]
    s_waitcnt lgkmcnt(2)
    s_lshl_b32 s50, s50, 12
    v_mfma_f32_16x16x32_bf16 v[108:111], a[16:19], v[92:95], v[108:111]
    ds_read_b128 v[84:87], v11 offset:12288
    v_add_u32 v141, s50, v138
    v_mfma_f32_16x16x32_bf16 v[112:115], a[16:19], v[96:99], v[112:115]
    ds_read_b128 v[88:91], v11 offset:14336
    s_add_u32 s43, s41, 40960
    v_mfma_f32_16x16x32_bf16 v[116:119], a[96:99], v[92:95], v[116:119]
    buffer_store_dword v22, v150, s[4:7], s42 offen offset:256
    v_mfma_f32_16x16x32_bf16 v[120:123], a[96:99], v[96:99], v[120:123]
    s_waitcnt lgkmcnt(2)
    v_mfma_f32_16x16x32_bf16 v[108:111], a[20:23], v[100:103], v[108:111]
    ds_read_b128 v[92:95], v12 offset:12288
    v_mfma_f32_16x16x32_bf16 v[112:115], a[20:23], v[104:107], v[112:115]
    ds_read_b128 v[96:99], v12 offset:14336
    v_mfma_f32_16x16x32_bf16 v[116:119], a[100:103], v[100:103], v[116:119]
    buffer_load_dwordx4 v10, s[24:27], s46 offen offset:0 lds
    s_add_u32 m0, m0, 3968
    v_mfma_f32_16x16x32_bf16 v[120:123], a[100:103], v[104:107], v[120:123]
    s_waitcnt lgkmcnt(2)
    v_mfma_f32_16x16x32_bf16 v[108:111], a[24:27], v[84:87], v[108:111]
    ds_read_b128 v[100:103], v11 offset:16384
    v_mfma_f32_16x16x32_bf16 v[112:115], a[24:27], v[88:91], v[112:115]
    ds_read_b128 v[104:107], v11 offset:18432
    v_mfma_f32_16x16x32_bf16 v[116:119], a[104:107], v[84:87], v[116:119]
    buffer_load_dwordx4 v10, s[24:27], s46 offen offset:128 lds
    s_add_u32 m0, m0, 3968
    v_mfma_f32_16x16x32_bf16 v[120:123], a[104:107], v[88:91], v[120:123]
    s_waitcnt lgkmcnt(2)
    v_mfma_f32_16x16x32_bf16 v[108:111], a[28:31], v[92:95], v[108:111]
    ds_read_b128 v[84:87], v12 offset:16384
    v_mfma_f32_16x16x32_bf16 v[112:115], a[28:31], v[96:99], v[112:115]
    ds_read_b128 v[88:91], v12 offset:18432
    v_mfma_f32_16x16x32_bf16 v[116:119], a[108:111], v[92:95], v[116:119]
    buffer_load_dwordx4 v10, s[24:27], s46 offen offset:256 lds
    s_add_u32 m0, m0, 3968
    v_mfma_f32_16x16x32_bf16 v[120:123], a[108:111], v[96:99], v[120:123]
    s_waitcnt lgkmcnt(2)
    v_mfma_f32_16x16x32_bf16 v[108:111], a[32:35], v[100:103], v[108:111]
    ds_read_b128 v[92:95], v11 offset:20480
    v_mfma_f32_16x16x32_bf16 v[112:115], a[32:35], v[104:107], v[112:115]
    ds_read_b128 v[96:99], v11 offset:22528
    v_mfma_f32_16x16x32_bf16 v[116:119], a[112:115], v[100:103], v[116:119]
    s_waitcnt vmcnt(6)
    buffer_store_dword v20, v139, s[4:7], s38 offen
    v_mfma_f32_16x16x32_bf16 v[120:123], a[112:115], v[104:107], v[120:123]
    s_waitcnt lgkmcnt(2)
    v_mfma_f32_16x16x32_bf16 v[108:111], a[36:39], v[84:87], v[108:111]
    ds_read_b128 v[100:103], v12 offset:20480
    v_mfma_f32_16x16x32_bf16 v[112:115], a[36:39], v[88:91], v[112:115]
    buffer_load_dword v147, v146, s[4:7], 0 offen sc1
    ds_read_b128 v[104:107], v12 offset:22528
    v_mfma_f32_16x16x32_bf16 v[116:119], a[116:119], v[84:87], v[116:119]
    buffer_load_dwordx4 v10, s[24:27], s46 offen offset:384 lds
    s_add_u32 m0, m0, 3968
    v_mfma_f32_16x16x32_bf16 v[120:123], a[116:119], v[88:91], v[120:123]
    s_waitcnt lgkmcnt(2)
    v_mfma_f32_16x16x32_bf16 v[108:111], a[40:43], v[92:95], v[108:111]
    ds_read_b128 v[84:87], v11 offset:24576
    v_mfma_f32_16x16x32_bf16 v[112:115], a[40:43], v[96:99], v[112:115]
    buffer_load_dword v147, v146, s[4:7], 0 offen sc1
    ds_read_b128 v[88:91], v11 offset:26624
    v_mfma_f32_16x16x32_bf16 v[116:119], a[120:123], v[92:95], v[116:119]
    buffer_load_dwordx4 v10, s[24:27], s46 offen offset:512 lds
    s_add_u32 m0, m0, 3968
    v_mfma_f32_16x16x32_bf16 v[120:123], a[120:123], v[96:99], v[120:123]
    s_waitcnt lgkmcnt(2)
    v_mfma_f32_16x16x32_bf16 v[108:111], a[44:47], v[100:103], v[108:111]
    ds_read_b128 v[92:95], v12 offset:24576
    v_mfma_f32_16x16x32_bf16 v[112:115], a[44:47], v[104:107], v[112:115]
    buffer_load_dword v147, v146, s[4:7], 0 offen sc1
    ds_read_b128 v[96:99], v12 offset:26624
    v_mfma_f32_16x16x32_bf16 v[116:119], a[124:127], v[100:103], v[116:119]
    buffer_load_dwordx4 v10, s[24:27], s46 offen offset:640 lds
    s_add_u32 m0, m0, 3968
    v_mfma_f32_16x16x32_bf16 v[120:123], a[124:127], v[104:107], v[120:123]
    s_waitcnt lgkmcnt(2)
    v_mfma_f32_16x16x32_bf16 v[108:111], a[48:51], v[84:87], v[108:111]
    ds_read_b128 v[100:103], v11 offset:28672
    v_mfma_f32_16x16x32_bf16 v[112:115], a[48:51], v[88:91], v[112:115]
    buffer_load_dword v147, v146, s[4:7], 0 offen sc1
    ds_read_b128 v[104:107], v11 offset:30720
    v_mfma_f32_16x16x32_bf16 v[116:119], a[128:131], v[84:87], v[116:119]
    buffer_load_dwordx4 v10, s[24:27], s46 offen offset:768 lds
    s_add_u32 m0, m0, 3968
    v_mfma_f32_16x16x32_bf16 v[120:123], a[128:131], v[88:91], v[120:123]
    s_waitcnt lgkmcnt(2)
    v_mfma_f32_16x16x32_bf16 v[108:111], a[52:55], v[92:95], v[108:111]
    ds_read_b128 v[84:87], v12 offset:28672
    v_mfma_f32_16x16x32_bf16 v[112:115], a[52:55], v[96:99], v[112:115]
    buffer_load_dword v147, v146, s[4:7], 0 offen sc1
    ds_read_b128 v[88:91], v12 offset:30720
    v_mfma_f32_16x16x32_bf16 v[116:119], a[132:135], v[92:95], v[116:119]
    buffer_load_dwordx4 v10, s[24:27], s46 offen offset:896 lds
    s_add_u32 m0, m0, 3968
    v_mfma_f32_16x16x32_bf16 v[120:123], a[132:135], v[96:99], v[120:123]
    s_waitcnt lgkmcnt(2)
    v_mfma_f32_16x16x32_bf16 v[108:111], a[56:59], v[100:103], v[108:111]
    ds_read_b128 v[92:95], v11 offset:32768
    v_mfma_f32_16x16x32_bf16 v[112:115], a[56:59], v[104:107], v[112:115]
    buffer_load_dword v147, v146, s[4:7], 0 offen sc1
    ds_read_b128 v[96:99], v11 offset:34816
    v_mfma_f32_16x16x32_bf16 v[116:119], a[136:139], v[100:103], v[116:119]
    buffer_load_dwordx4 v10, s[24:27], s46 offen offset:1024 lds
    s_add_u32 m0, m0, 3968
    v_mfma_f32_16x16x32_bf16 v[120:123], a[136:139], v[104:107], v[120:123]
    s_waitcnt lgkmcnt(2)
    v_mfma_f32_16x16x32_bf16 v[108:111], a[60:63], v[84:87], v[108:111]
    ds_read_b128 v[100:103], v12 offset:32768
    v_mfma_f32_16x16x32_bf16 v[112:115], a[60:63], v[88:91], v[112:115]
    buffer_load_dword v147, v146, s[4:7], 0 offen sc1
    ds_read_b128 v[104:107], v12 offset:34816
    v_mfma_f32_16x16x32_bf16 v[116:119], a[140:143], v[84:87], v[116:119]
    buffer_load_dwordx4 v10, s[24:27], s46 offen offset:1152 lds
    v_mfma_f32_16x16x32_bf16 v[120:123], a[140:143], v[88:91], v[120:123]
    s_waitcnt lgkmcnt(2)
    v_mfma_f32_16x16x32_bf16 v[108:111], a[64:67], v[92:95], v[108:111]
    ds_read_b128 v[84:87], v11 offset:36864
    v_mfma_f32_16x16x32_bf16 v[112:115], a[64:67], v[96:99], v[112:115]
L_sp_12:
    s_waitcnt vmcnt(6)
    v_cmp_gt_u32 vcc, s54, v147
    buffer_load_dword v147, v146, s[4:7], 0 offen sc1
    s_sub_u32 s36, s36, 1
    s_cbranch_scc1 L_exit
    s_cbranch_vccz L_sp_12x
    s_waitcnt vmcnt(6)
    v_cmp_gt_u32 vcc, s54, v147
    buffer_load_dword v147, v146, s[4:7], 0 offen sc1
    s_cbranch_vccz L_sp_12x
    s_waitcnt vmcnt(6)
    v_cmp_gt_u32 vcc, s54, v147
    buffer_load_dword v147, v146, s[4:7], 0 offen sc1
    s_cbranch_vccz L_sp_12x
    s_waitcnt vmcnt(6)
    v_cmp_gt_u32 vcc, s54, v147
    buffer_load_dword v147, v146, s[4:7], 0 offen sc1
    s_cbranch_vccnz L_sp_12
L_sp_12x:
    s_barrier
    buffer_load_dwordx4 v[168:171], v142, s[4:7], s53 offen sc1
    ds_read_b128 v[88:91], v11 offset:38912
    v_mfma_f32_16x16x32_bf16 v[116:119], a[144:147], v[92:95], v[116:119]
    v_mfma_f32_16x16x32_bf16 v[120:123], a[144:147], v[96:99], v[120:123]
    s_waitcnt lgkmcnt(2)
    v_mfma_f32_16x16x32_bf16 v[108:111], a[68:71], v[100:103], v[108:111]
    ds_read_b128 v[92:95], v12 offset:36864
    v_mfma_f32_16x16x32_bf16 v[112:115], a[68:71], v[104:107], v[112:115]
    ds_read_b128 v[96:99], v12 offset:38912
    v_mfma_f32_16x16x32_bf16 v[116:119], a[148:151], v[100:103], v[116:119]
    v_mfma_f32_16x16x32_bf16 v[120:123], a[148:151], v[104:107], v[120:123]
    buffer_load_dwordx4 v[172:175], v143, s[4:7], s53 offen sc1
    s_waitcnt lgkmcnt(0)
    v_mfma_f32_16x16x32_bf16 v[108:111], a[72:75], v[84:87], v[108:111]
    v_add_u32 v11, s49, v11
    v_mfma_f32_16x16x32_bf16 v[112:115], a[72:75], v[88:91], v[112:115]
    v_add_u32 v12, s49, v12
    v_mfma_f32_16x16x32_bf16 v[108:111], a[76:79], v[92:95], v[108:111]
    s_sub_u32 s47, s47, s49
    v_mfma_f32_16x16x32_bf16 v[112:115], a[76:79], v[96:99], v[112:115]
    s_sub_u32 s49, 0, s49
    v_mfma_f32_16x16x32_bf16 v[116:119], a[152:155], v[84:87], v[116:119]
    v_mfma_f32_16x16x32_bf16 v[120:123], a[152:155], v[88:91], v[120:123]
    v_mfma_f32_16x16x32_bf16 v[116:119], a[156:159], v[92:95], v[116:119]
    v_mfma_f32_16x16x32_bf16 v[120:123], a[156:159], v[96:99], v[120:123]
    v_cvt_pk_bf16_f32 v124, v108, v109
    v_cvt_pk_bf16_f32 v125, v110, v111
    v_cvt_pk_bf16_f32 v126, v112, v113
    v_cvt_pk_bf16_f32 v127, v114, v115
    s_nop 0
    v_permlane16_swap_b32 v124, v126
    v_permlane16_swap_b32 v125, v127
    v_cvt_pk_bf16_f32 v128, v116, v117
    v_cvt_pk_bf16_f32 v129, v118, v119
    v_cvt_pk_bf16_f32 v130, v120, v121
    v_cvt_pk_bf16_f32 v131, v122, v123
    s_nop 0
    v_permlane16_swap_b32 v128, v130
    v_permlane16_swap_b32 v129, v131
    ds_write_b128 v140, v[128:131]
    buffer_store_dwordx4 v[124:127], v19, s[4:7], s44 offen
    buffer_store_dwordx4 v[128:131], v19, s[4:7], s45 offen
    s_mov_b32 m0, s48
    s_waitcnt vmcnt(3)
    v_mfma_f32_16x16x32_bf16 v[184:187], v[198:201], v[168:171], 0
    v_mfma_f32_16x16x32_bf16 v[188:191], v[196:199], v[168:171], 0
    s_waitcnt vmcnt(2)
    v_mfma_f32_16x16x32_bf16 v[184:187], v[198:201], v[172:175], v[184:187]
    v_mfma_f32_16x16x32_bf16 v[188:191], v[196:199], v[172:175], v[188:191]
    s_nop 4
    v_cmp_u_f32 vcc, v184, v184
    v_cvt_pk_bf16_f32 v192, v184, v185
    v_cvt_pk_bf16_f32 v193, v186, v187
    v_cvt_pk_bf16_f32 v194, v188, v189
    v_cvt_pk_bf16_f32 v195, v190, v191
    s_cbranch_vccnz L_pp_13
L_pc_14:
    buffer_store_dwordx4 v[192:195], v148, s[4:7], s41 offen
    s_barrier
    s_branch L_qkv_loop_f
L_end_11:
    s_waitcnt vmcnt(0) lgkmcnt(0)
    buffer_store_dword v20, v139, s[4:7], s38 offen
    s_endpgm
L_nan_6:
    s_cmp_eq_u32 s52, 1
    s_cbranch_scc1 L_cont_7
    v_lshlrev_b32 v1, 4, v0
L_nan_6r:
    s_mov_b32 s90, s41
    v_mov_b32 v2, 0
    buffer_load_dwordx4 v[28:31], v1, s[4:7], s90 offen sc1
    s_add_u32 s90, s90, 1024
    buffer_load_dwordx4 v[32:35], v1, s[4:7], s90 offen sc1
    s_add_u32 s90, s90, 1024
    buffer_load_dwordx4 v[36:39], v1, s[4:7], s90 offen sc1
    s_add_u32 s90, s90, 1024
    buffer_load_dwordx4 v[40:43], v1, s[4:7], s90 offen sc1
    s_add_u32 s90, s90, 1024
    buffer_load_dwordx4 v[44:47], v1, s[4:7], s90 offen sc1
    s_add_u32 s90, s90, 1024
    buffer_load_dwordx4 v[48:51], v1, s[4:7], s90 offen sc1
    s_add_u32 s90, s90, 1024
    buffer_load_dwordx4 v[52:55], v1, s[4:7], s90 offen sc1
    s_add_u32 s90, s90, 1024
    buffer_load_dwordx4 v[56:59], v1, s[4:7], s90 offen sc1
    s_add_u32 s90, s90, 1024
    buffer_load_dwordx4 v[60:63], v1, s[4:7], s90 offen sc1
    s_add_u32 s90, s90, 1024
    buffer_load_dwordx4 v[64:67], v1, s[4:7], s90 offen sc1
    s_add_u32 s90, s90, 1024
    s_sub_u32 s36, s36, 1
    s_cbranch_scc1 L_exit
    s_waitcnt vmcnt(0) lgkmcnt(0)
    v_max3_u32 v2, v2, v28, v29
    v_max3_u32 v2, v2, v30, v31
    v_max3_u32 v2, v2, v32, v33
    v_max3_u32 v2, v2, v34, v35
    v_max3_u32 v2, v2, v36, v37
    v_max3_u32 v2, v2, v38, v39
    v_max3_u32 v2, v2, v40, v41
    v_max3_u32 v2, v2, v42, v43
    v_max3_u32 v2, v2, v44, v45
    v_max3_u32 v2, v2, v46, v47
    v_max3_u32 v2, v2, v48, v49
    v_max3_u32 v2, v2, v50, v51
    v_max3_u32 v2, v2, v52, v53
    v_max3_u32 v2, v2, v54, v55
    v_max3_u32 v2, v2, v56, v57
    v_max3_u32 v2, v2, v58, v59
    v_max3_u32 v2, v2, v60, v61
    v_max3_u32 v2, v2, v62, v63
    v_max3_u32 v2, v2, v64, v65
    v_max3_u32 v2, v2, v66, v67
    v_cmp_eq_u32 vcc, -1, v2
    s_cbranch_vccnz L_nan_6r
    s_mov_b32 s52, 1
    v_mov_b32 v68, 0
    v_mov_b32 v69, 0
    v_mov_b32 v70, 0
    v_mov_b32 v71, 0
    v_mov_b32 v72, 0
    v_mov_b32 v73, 0
    v_mov_b32 v74, 0
    v_mov_b32 v75, 0
    v_smfmac_f32_16x16x64_bf16 v[68:71], v[28:31], a[0:7], v17
    s_nop 0
    v_smfmac_f32_16x16x64_bf16 v[72:75], v[28:31], a[80:87], v17
    v_smfmac_f32_16x16x64_bf16 v[68:71], v[32:35], a[8:15], v17
    v_smfmac_f32_16x16x64_bf16 v[72:75], v[32:35], a[88:95], v17
    v_smfmac_f32_16x16x64_bf16 v[68:71], v[36:39], a[16:23], v17
    v_smfmac_f32_16x16x64_bf16 v[68:71], v[40:43], a[24:31], v17
    v_smfmac_f32_16x16x64_bf16 v[68:71], v[44:47], a[32:39], v17
    v_smfmac_f32_16x16x64_bf16 v[68:71], v[48:51], a[40:47], v17
    v_smfmac_f32_16x16x64_bf16 v[68:71], v[52:55], a[48:55], v17
    v_smfmac_f32_16x16x64_bf16 v[68:71], v[56:59], a[56:63], v17
    v_smfmac_f32_16x16x64_bf16 v[68:71], v[60:63], a[64:71], v17
    v_smfmac_f32_16x16x64_bf16 v[68:71], v[64:67], a[72:79], v17
    s_nop 3
    s_branch L_redo_4
L_pp_13:
    buffer_load_dwordx4 v[176:179], v144, s[4:7], s53 offen sc1
    buffer_load_dwordx4 v[180:183], v145, s[4:7], s53 offen sc1
    s_sub_u32 s36, s36, 1
    s_cbranch_scc1 L_exit
    v_max_u32 v151, v168, v169
    v_max3_u32 v151, v151, v170, v171
    v_max3_u32 v151, v151, v172, v173
    v_max3_u32 v151, v151, v174, v175
    v_cmp_eq_u32 vcc, -1, v151
    s_cbranch_vccz L_pc_14
    s_waitcnt vmcnt(1)
    v_mfma_f32_16x16x32_bf16 v[184:187], v[198:201], v[176:179], 0
    v_mfma_f32_16x16x32_bf16 v[188:191], v[196:199], v[176:179], 0
    s_waitcnt vmcnt(0)
    v_mfma_f32_16x16x32_bf16 v[184:187], v[198:201], v[180:183], v[184:187]
    v_mfma_f32_16x16x32_bf16 v[188:191], v[196:199], v[180:183], v[188:191]
    s_nop 4
    v_cmp_u_f32 vcc, v184, v184
    v_cvt_pk_bf16_f32 v192, v184, v185
    v_cvt_pk_bf16_f32 v193, v186, v187
    v_cvt_pk_bf16_f32 v194, v188, v189
    v_cvt_pk_bf16_f32 v195, v190, v191
    s_cbranch_vccnz L_pp_13_1
    s_branch L_pc_14
L_pp_13_1:
    buffer_load_dwordx4 v[168:171], v142, s[4:7], s53 offen sc1
    buffer_load_dwordx4 v[172:175], v143, s[4:7], s53 offen sc1
    s_sub_u32 s36, s36, 1
    s_cbranch_scc1 L_exit
    v_max_u32 v151, v176, v177
    v_max3_u32 v151, v151, v178, v179
    v_max3_u32 v151, v151, v180, v181
    v_max3_u32 v151, v151, v182, v183
    v_cmp_eq_u32 vcc, -1, v151
    s_cbranch_vccz L_pc_14
    s_waitcnt vmcnt(1)
    v_mfma_f32_16x16x32_bf16 v[184:187], v[198:201], v[168:171], 0
    v_mfma_f32_16x16x32_bf16 v[188:191], v[196:199], v[168:171], 0
    s_waitcnt vmcnt(0)
    v_mfma_f32_16x16x32_bf16 v[184:187], v[198:201], v[172:175], v[184:187]
    v_mfma_f32_16x16x32_bf16 v[188:191], v[196:199], v[172:175], v[188:191]
    s_nop 4
    v_cmp_u_f32 vcc, v184, v184
    v_cvt_pk_bf16_f32 v192, v184, v185
    v_cvt_pk_bf16_f32 v193, v186, v187
    v_cvt_pk_bf16_f32 v194, v188, v189
    v_cvt_pk_bf16_f32 v195, v190, v191
    s_cbranch_vccnz L_pp_13
    s_branch L_pc_14
L_v_f:
    s_mov_b32 s12, s78
    s_and_b32 s13, s79, 0xffff
    s_mov_b32 s14, 7864320
    s_mov_b32 s15, 0x20000
    s_sub_u32 s40, s35, 12
    s_lshl_b32 s40, s40, 1
    s_mov_b32 s24, s70
    s_and_b32 s25, s71, 0xffff
    s_mov_b32 s26, 2621440
    s_mov_b32 s27, 0x20000
    v_and_b32 v1, 15, v0
    v_lshrrev_b32 v2, 4, v0
    v_lshrrev_b32 v3, 3, v0
    v_and_b32 v4, 7, v0
    s_lshl_b32 s90, s32, 3
    v_add_u32 v5, s90, v3
    s_and_b32 s91, s32, 1
    s_lshl_b32 s91, s91, 2
    v_and_b32 v6, 2, v3
    v_or_b32 v6, s91, v6
    v_xor_b32 v6, v6, v4
    v_lshlrev_b32 v6, 4, v6
    v_mul_u32_u24 v7, 12288, v5
    s_mul_i32 s92, s34, 1536
    s_lshl_b32 s93, s40, 7
    s_add_u32 s92, s92, s93
    v_add3_u32 v124, v6, v7, s92
    v_lshrrev_b32 v6, 1, v3
    v_or_b32 v6, s91, v6
    v_xor_b32 v6, v6, v4
    v_lshlrev_b32 v6, 4, v6
    v_mul_u32_u24 v7, 1280, v5
    v_add_u32 v10, v6, v7
    s_lshl_b32 s90, s32, 10
    s_add_u32 m0, s90, 81920
    s_mov_b32 s91, 0
    buffer_load_dwordx4 v124, s[12:15], s91 offen nt lds
    s_add_u32 m0, m0, 4096
    s_add_u32 s91, s91, 393216
    buffer_load_dwordx4 v124, s[12:15], s91 offen nt lds
    s_add_u32 m0, m0, 4096
    s_add_u32 s91, s91, 393216
    buffer_load_dwordx4 v124, s[12:15], s91 offen nt lds
    s_add_u32 m0, m0, 4096
    s_add_u32 s91, s91, 393216
    buffer_load_dwordx4 v124, s[12:15], s91 offen nt lds
    s_add_u32 m0, m0, 4096
    s_add_u32 s91, s91, 393216
    buffer_load_dwordx4 v124, s[12:15], s91 offen nt lds
    s_add_u32 m0, m0, 4096
    s_add_u32 s91, s91, 393216
    buffer_load_dwordx4 v124, s[12:15], s91 offen nt lds
    s_add_u32 m0, m0, 4096
    s_add_u32 s91, s91, 393216
    buffer_load_dwordx4 v124, s[12:15], s91 offen nt lds
    s_add_u32 m0, m0, 4096
    s_add_u32 s91, s91, 393216
    buffer_load_dwordx4 v124, s[12:15], s91 offen nt lds
    s_add_u32 m0, m0, 4096
    s_add_u32 s91, s91, 393216
    buffer_load_dwordx4 v124, s[12:15], s91 offen nt lds
    s_add_u32 m0, m0, 4096
    s_add_u32 s91, s91, 393216
    buffer_load_dwordx4 v124, s[12:15], s91 offen nt lds
    s_lshl_b32 s90, s32, 10
    s_add_u32 m0, s90, 40960
    s_mov_b32 s91, 128
    buffer_load_dwordx4 v124, s[12:15], s91 offen nt lds
    s_add_u32 m0, m0, 4096
    s_add_u32 s91, s91, 393216
    buffer_load_dwordx4 v124, s[12:15], s91 offen nt lds
    s_add_u32 m0, m0, 4096
    s_add_u32 s91, s91, 393216
    buffer_load_dwordx4 v124, s[12:15], s91 offen nt lds
    s_add_u32 m0, m0, 4096
    s_add_u32 s91, s91, 393216
    buffer_load_dwordx4 v124, s[12:15], s91 offen nt lds
    s_add_u32 m0, m0, 4096
    s_add_u32 s91, s91, 393216
    buffer_load_dwordx4 v124, s[12:15], s91 offen nt lds
    s_add_u32 m0, m0, 4096
    s_add_u32 s91, s91, 393216
    buffer_load_dwordx4 v124, s[12:15], s91 offen nt lds
    s_add_u32 m0, m0, 4096
    s_add_u32 s91, s91, 393216
    buffer_load_dwordx4 v124, s[12:15], s91 offen nt lds
    s_add_u32 m0, m0, 4096
    s_add_u32 s91, s91, 393216
    buffer_load_dwordx4 v124, s[12:15], s91 offen nt lds
    s_add_u32 m0, m0, 4096
    s_add_u32 s91, s91, 393216
    buffer_load_dwordx4 v124, s[12:15], s91 offen nt lds
    s_add_u32 m0, m0, 4096
    s_add_u32 s91, s91, 393216
    buffer_load_dwordx4 v124, s[12:15], s91 offen nt lds
    s_lshl_b32 s90, s32, 10
    s_add_u32 m0, s90, 122880
    s_mov_b32 s91, 3932160
    buffer_load_dwordx4 v124, s[12:15], s91 offen nt lds
    s_add_u32 m0, m0, 4096
    s_add_u32 s91, s91, 393216
    buffer_load_dwordx4 v124, s[12:15], s91 offen nt lds
    s_add_u32 m0, m0, 4096
    s_add_u32 s91, s91, 393216
    buffer_load_dwordx4 v124, s[12:15], s91 offen nt lds
    s_add_u32 m0, m0, 4096
    s_add_u32 s91, s91, 393216
    buffer_load_dwordx4 v124, s[12:15], s91 offen nt lds
    s_add_u32 m0, m0, 4096
    s_add_u32 s91, s91, 393216
    buffer_load_dwordx4 v124, s[12:15], s91 offen nt lds
    s_add_u32 m0, m0, 4096
    s_add_u32 s91, s91, 393216
    buffer_load_dwordx4 v124, s[12:15], s91 offen nt lds
    s_add_u32 m0, m0, 4096
    s_add_u32 s91, s91, 393216
    buffer_load_dwordx4 v124, s[12:15], s91 offen nt lds
    s_add_u32 m0, m0, 4096
    s_add_u32 s91, s91, 393216
    buffer_load_dwordx4 v124, s[12:15], s91 offen nt lds
    s_add_u32 m0, m0, 4096
    s_add_u32 s91, s91, 393216
    buffer_load_dwordx4 v124, s[12:15], s91 offen nt lds
    s_add_u32 m0, m0, 4096
    s_add_u32 s91, s91, 393216
    buffer_load_dwordx4 v124, s[12:15], s91 offen nt lds
    s_mov_b32 s46, 0
    s_lshl_b32 s90, s32, 10
    s_add_u32 m0, s90, 0
    s_nop 0
    buffer_load_dwordx4 v10, s[24:27], s46 offen offset:0 lds
    s_add_u32 m0, m0, 3968
    s_nop 0
    buffer_load_dwordx4 v10, s[24:27], s46 offen offset:128 lds
    s_add_u32 m0, m0, 3968
    s_nop 0
    buffer_load_dwordx4 v10, s[24:27], s46 offen offset:256 lds
    s_add_u32 m0, m0, 3968
    s_nop 0
    buffer_load_dwordx4 v10, s[24:27], s46 offen offset:384 lds
    s_add_u32 m0, m0, 3968
    s_nop 0
    buffer_load_dwordx4 v10, s[24:27], s46 offen offset:512 lds
    s_add_u32 m0, m0, 3968
    s_nop 0
    buffer_load_dwordx4 v10, s[24:27], s46 offen offset:640 lds
    s_add_u32 m0, m0, 3968
    s_nop 0
    buffer_load_dwordx4 v10, s[24:27], s46 offen offset:768 lds
    s_add_u32 m0, m0, 3968
    s_nop 0
    buffer_load_dwordx4 v10, s[24:27], s46 offen offset:896 lds
    s_add_u32 m0, m0, 3968
    s_nop 0
    buffer_load_dwordx4 v10, s[24:27], s46 offen offset:1024 lds
    s_add_u32 m0, m0, 3968
    s_nop 0
    buffer_load_dwordx4 v10, s[24:27], s46 offen offset:1152 lds
    s_lshl_b32 s93, s40, 1
    s_add_u32 s93, s93, s32
    s_mul_i32 s93, s93, 7168
    s_add_u32 s93, s93, 884736
    s_add_u32 s61, s93, s38
    s_mul_i32 s60, s40, 86
    s_lshr_b32 s60, s60, 8
    s_mul_i32 s59, s60, 3
    s_sub_u32 s59, s40, s59
    s_add_u32 s90, s40, 1
    s_mul_i32 s62, s90, 86
    s_lshr_b32 s62, s62, 8
    s_mul_i32 s63, s62, 3
    s_sub_u32 s63, s90, s63
    v_lshrrev_b32 v3, 1, v2
    v_and_b32 v5, 1, v2
    s_lshl_b32 s90, s32, 9
    v_lshlrev_b32 v6, 4, v1
    v_lshl_add_u32 v6, v3, 8, v6
    v_add_u32 v6, s90, v6
    s_mul_i32 s90, s60, 12288
    s_lshl_b32 s91, s59, 11
    s_add_u32 s90, s90, s91
    v_mul_u32_u24 v7, 6144, v5
    v_add3_u32 v19, v6, v7, s90
    v_mov_b32 v22, -1
    s_mul_i32 s56, s62, 12288
    s_lshl_b32 s91, s63, 11
    s_add_u32 s56, s56, s91
    s_sub_u32 s56, s56, s90
    s_lshl_b32 s90, s40, 10
    s_lshl_b32 s91, s32, 8
    s_add_u32 s91, s91, s90
    s_add_u32 s91, s91, 25600
    v_lshl_add_u32 v135, v0, 2, s91
    v_and_b32 v6, 60, v0
    v_bfe_u32 v7, v0, 1, 1
    v_or_b32 v6, v6, v7
    v_and_b32 v7, 1, v0
    v_lshl_or_b32 v6, v7, 1, v6
    s_and_b32 s90, s32, 1
    s_lshl_b32 s90, s90, 3
    v_xor_b32 v6, s90, v6
    v_lshl_add_u32 v134, v6, 2, s91
    s_lshl_b32 s90, s60, 5
    s_lshl_b32 s91, s62, 5
    v_mov_b32 v3, s90
    v_mov_b32 v4, s91
    v_mov_b32 v6, s59
    v_mov_b32 v7, s63
    v_cmp_eq_u32 vcc, 0, v0
    s_nop 1
    v_cndmask_b32 v3, v4, v3, vcc
    v_cndmask_b32 v6, v7, v6, vcc
    v_add_u32 v4, v3, v6
    s_cmp_eq_u32 s32, 3
    s_cselect_b32 s91, 0, 2146435072
    s_add_u32 s91, s91, 462348
    v_lshl_add_u32 v21, v4, 2, s91
    v_lshl_add_u32 v4, v6, 2, v3
    s_lshl_b32 s91, s32, 2
    s_add_u32 s91, s91, 458752
    v_lshl_add_u32 v136, v4, 2, s91
    v_cmp_gt_u32 vcc, 2, v0
    v_mov_b32 v9, 2146435072
    s_nop 0
    v_cndmask_b32 v21, v9, v21, vcc
    v_cndmask_b32 v136, v9, v136, vcc
    s_lshl_b32 s90, s40, 1
    s_add_u32 s90, s90, s32
    s_sub_u32 s90, s90, 4
    s_lshl_b32 s90, s90, 11
    s_cmp_eq_u32 s40, 0
    s_cselect_b32 s90, 2146435072, s90
    v_lshl_add_u32 v137, v0, 4, s90
    v_mov_b32 v138, 460800
    v_lshrrev_b32 v3, 2, v1
    v_and_b32 v4, 3, v1
    v_and_b32 v5, 1, v2
    v_lshl_add_u32 v6, v2, 3, v3
    v_lshlrev_b32 v6, 7, v6
    v_and_b32 v7, 2, v3
    v_lshl_or_b32 v7, v5, 2, v7
    v_lshrrev_b32 v8, 1, v4
    s_lshl_b32 s90, s32, 1
    v_or_b32 v8, s90, v8
    v_xor_b32 v7, v7, v8
    v_lshl_add_u32 v6, v7, 4, v6
    v_and_b32 v7, 1, v4
    v_lshl_add_u32 v6, v7, 3, v6
    v_add_u32 v125, 81920, v6
    v_add_u32 v126, 40960, v6
    v_add_u32 v127, 122880, v6
    s_lshl_b32 s90, s32, 9
    s_add_u32 s90, s90, 133120
    v_and_b32 v7, 2, v1
    v_cmp_ne_u32 vcc, 0, v7
    v_mov_b32 v6, 0x4444
    v_mov_b32 v8, 0xeeee
    v_cndmask_b32 v17, v6, v8, vcc
    v_lshlrev_b32 v6, 4, v0
    v_add_u32 v16, 122880, v6
    s_mul_i32 s90, s32, 2560
    v_lshl_add_u32 v13, v0, 4, s90
    v_lshl_add_u32 v14, v0, 2, s90
    s_add_u32 s48, s90, 122880
    v_mul_u32_u24 v6, 40, v0
    v_add_u32 v15, s48, v6
    v_mul_u32_u24 v6, 164, v0
    v_min_u32 v6, 10236, v6
    v_add_u32 v25, 122880, v6
    v_lshrrev_b32 v6, 3, v1
    v_lshlrev_b32 v6, 10, v6
    v_and_b32 v7, 7, v1
    v_lshl_add_u32 v6, v7, 7, v6
    v_lshrrev_b32 v7, 1, v1
    v_xor_b32 v7, v7, v2
    v_lshl_add_u32 v11, v7, 4, v6
    v_xor_b32 v12, 64, v11
    s_waitcnt vmcnt(30)
    s_barrier
    ds_read_b64_tr_b16 a[0:1], v125 offset:0
    ds_read_b64_tr_b16 a[2:3], v125 offset:512
    ds_read_b64_tr_b16 a[4:5], v125 offset:4096
    ds_read_b64_tr_b16 a[6:7], v125 offset:4608
    ds_read_b64_tr_b16 a[8:9], v125 offset:8192
    ds_read_b64_tr_b16 a[10:11], v125 offset:8704
    ds_read_b64_tr_b16 a[12:13], v125 offset:12288
    ds_read_b64_tr_b16 a[14:15], v125 offset:12800
    ds_read_b64_tr_b16 a[16:17], v125 offset:16384
    ds_read_b64_tr_b16 a[18:19], v125 offset:16896
    ds_read_b64_tr_b16 a[20:21], v125 offset:20480
    ds_read_b64_tr_b16 a[22:23], v125 offset:20992
    ds_read_b64_tr_b16 a[24:25], v125 offset:24576
    ds_read_b64_tr_b16 a[26:27], v125 offset:25088
    ds_read_b64_tr_b16 a[28:29], v125 offset:28672
    ds_read_b64_tr_b16 a[30:31], v125 offset:29184
    ds_read_b64_tr_b16 a[32:33], v125 offset:32768
    ds_read_b64_tr_b16 a[34:35], v125 offset:33280
    ds_read_b64_tr_b16 a[36:37], v125 offset:36864
    ds_read_b64_tr_b16 a[38:39], v125 offset:37376
    s_waitcnt lgkmcnt(0)
    s_barrier
    s_lshl_b32 s90, s32, 10
    s_add_u32 m0, s90, 81920
    s_mov_b32 s91, 3932288
    buffer_load_dwordx4 v124, s[12:15], s91 offen nt lds
    s_add_u32 m0, m0, 4096
    s_add_u32 s91, s91, 393216
    buffer_load_dwordx4 v124, s[12:15], s91 offen nt lds
    s_add_u32 m0, m0, 4096
    s_add_u32 s91, s91, 393216
    buffer_load_dwordx4 v124, s[12:15], s91 offen nt lds
    s_add_u32 m0, m0, 4096
    s_add_u32 s91, s91, 393216
    buffer_load_dwordx4 v124, s[12:15], s91 offen nt lds
    s_add_u32 m0, m0, 4096
    s_add_u32 s91, s91, 393216
    buffer_load_dwordx4 v124, s[12:15], s91 offen nt lds
    s_add_u32 m0, m0, 4096
    s_add_u32 s91, s91, 393216
    buffer_load_dwordx4 v124, s[12:15], s91 offen nt lds
    s_add_u32 m0, m0, 4096
    s_add_u32 s91, s91, 393216
    buffer_load_dwordx4 v124, s[12:15], s91 offen nt lds
    s_add_u32 m0, m0, 4096
    s_add_u32 s91, s91, 393216
    buffer_load_dwordx4 v124, s[12:15], s91 offen nt lds
    s_add_u32 m0, m0, 4096
    s_add_u32 s91, s91, 393216
    buffer_load_dwordx4 v124, s[12:15], s91 offen nt lds
    s_add_u32 m0, m0, 4096
    s_add_u32 s91, s91, 393216
    buffer_load_dwordx4 v124, s[12:15], s91 offen nt lds
    s_waitcnt vmcnt(30)
    s_barrier
    ds_read_b64_tr_b16 a[80:81], v126 offset:0
    ds_read_b64_tr_b16 a[82:83], v126 offset:512
    ds_read_b64_tr_b16 a[84:85], v126 offset:4096
    ds_read_b64_tr_b16 a[86:87], v126 offset:4608
    ds_read_b64_tr_b16 a[88:89], v126 offset:8192
    ds_read_b64_tr_b16 a[90:91], v126 offset:8704
    ds_read_b64_tr_b16 a[92:93], v126 offset:12288
    ds_read_b64_tr_b16 a[94:95], v126 offset:12800
    ds_read_b64_tr_b16 a[96:97], v126 offset:16384
    ds_read_b64_tr_b16 a[98:99], v126 offset:16896
    ds_read_b64_tr_b16 a[100:101], v126 offset:20480
    ds_read_b64_tr_b16 a[102:103], v126 offset:20992
    ds_read_b64_tr_b16 a[104:105], v126 offset:24576
    ds_read_b64_tr_b16 a[106:107], v126 offset:25088
    ds_read_b64_tr_b16 a[108:109], v126 offset:28672
    ds_read_b64_tr_b16 a[110:111], v126 offset:29184
    ds_read_b64_tr_b16 a[112:113], v126 offset:32768
    ds_read_b64_tr_b16 a[114:115], v126 offset:33280
    ds_read_b64_tr_b16 a[116:117], v126 offset:36864
    ds_read_b64_tr_b16 a[118:119], v126 offset:37376
    s_waitcnt lgkmcnt(0)
    s_barrier
    s_mov_b32 s46, 40960
    s_lshl_b32 s90, s32, 10
    s_add_u32 m0, s90, 40960
    s_nop 0
    buffer_load_dwordx4 v10, s[24:27], s46 offen offset:0 lds
    s_add_u32 m0, m0, 3968
    s_nop 0
    buffer_load_dwordx4 v10, s[24:27], s46 offen offset:128 lds
    s_add_u32 m0, m0, 3968
    s_nop 0
    buffer_load_dwordx4 v10, s[24:27], s46 offen offset:256 lds
    s_add_u32 m0, m0, 3968
    s_nop 0
    buffer_load_dwordx4 v10, s[24:27], s46 offen offset:384 lds
    s_add_u32 m0, m0, 3968
    s_nop 0
    buffer_load_dwordx4 v10, s[24:27], s46 offen offset:512 lds
    s_add_u32 m0, m0, 3968
    s_nop 0
    buffer_load_dwordx4 v10, s[24:27], s46 offen offset:640 lds
    s_add_u32 m0, m0, 3968
    s_nop 0
    buffer_load_dwordx4 v10, s[24:27], s46 offen offset:768 lds
    s_add_u32 m0, m0, 3968
    s_nop 0
    buffer_load_dwordx4 v10, s[24:27], s46 offen offset:896 lds
    s_add_u32 m0, m0, 3968
    s_nop 0
    buffer_load_dwordx4 v10, s[24:27], s46 offen offset:1024 lds
    s_add_u32 m0, m0, 3968
    s_nop 0
    buffer_load_dwordx4 v10, s[24:27], s46 offen offset:1152 lds
    s_waitcnt vmcnt(30)
    s_barrier
    ds_read_b64_tr_b16 a[40:41], v127 offset:0
    ds_read_b64_tr_b16 a[42:43], v127 offset:512
    ds_read_b64_tr_b16 a[44:45], v127 offset:4096
    ds_read_b64_tr_b16 a[46:47], v127 offset:4608
    ds_read_b64_tr_b16 a[48:49], v127 offset:8192
    ds_read_b64_tr_b16 a[50:51], v127 offset:8704
    ds_read_b64_tr_b16 a[52:53], v127 offset:12288
    ds_read_b64_tr_b16 a[54:55], v127 offset:12800
    ds_read_b64_tr_b16 a[56:57], v127 offset:16384
    ds_read_b64_tr_b16 a[58:59], v127 offset:16896
    ds_read_b64_tr_b16 a[60:61], v127 offset:20480
    ds_read_b64_tr_b16 a[62:63], v127 offset:20992
    ds_read_b64_tr_b16 a[64:65], v127 offset:24576
    ds_read_b64_tr_b16 a[66:67], v127 offset:25088
    ds_read_b64_tr_b16 a[68:69], v127 offset:28672
    ds_read_b64_tr_b16 a[70:71], v127 offset:29184
    ds_read_b64_tr_b16 a[72:73], v127 offset:32768
    ds_read_b64_tr_b16 a[74:75], v127 offset:33280
    ds_read_b64_tr_b16 a[76:77], v127 offset:36864
    ds_read_b64_tr_b16 a[78:79], v127 offset:37376
    s_waitcnt lgkmcnt(0)
    s_waitcnt vmcnt(10)
    s_barrier
    ds_read_b64_tr_b16 a[120:121], v125 offset:0
    ds_read_b64_tr_b16 a[122:123], v125 offset:512
    ds_read_b64_tr_b16 a[124:125], v125 offset:4096
    ds_read_b64_tr_b16 a[126:127], v125 offset:4608
    ds_read_b64_tr_b16 a[128:129], v125 offset:8192
    ds_read_b64_tr_b16 a[130:131], v125 offset:8704
    ds_read_b64_tr_b16 a[132:133], v125 offset:12288
    ds_read_b64_tr_b16 a[134:135], v125 offset:12800
    ds_read_b64_tr_b16 a[136:137], v125 offset:16384
    ds_read_b64_tr_b16 a[138:139], v125 offset:16896
    ds_read_b64_tr_b16 a[140:141], v125 offset:20480
    ds_read_b64_tr_b16 a[142:143], v125 offset:20992
    ds_read_b64_tr_b16 a[144:145], v125 offset:24576
    ds_read_b64_tr_b16 a[146:147], v125 offset:25088
    ds_read_b64_tr_b16 a[148:149], v125 offset:28672
    ds_read_b64_tr_b16 a[150:151], v125 offset:29184
    ds_read_b64_tr_b16 a[152:153], v125 offset:32768
    ds_read_b64_tr_b16 a[154:155], v125 offset:33280
    ds_read_b64_tr_b16 a[156:157], v125 offset:36864
    ds_read_b64_tr_b16 a[158:159], v125 offset:37376
    s_waitcnt lgkmcnt(0)
    v_lshlrev_b32 v3, 4, v0
    buffer_load_dwordx4 v[248:251], v3, s[4:7], s61 offen sc1
    s_add_u32 s61, s61, 1024
    buffer_load_dwordx4 v[248:251], v3, s[4:7], s61 offen sc1
    s_add_u32 s61, s61, 1024
    buffer_load_dwordx4 v[248:251], v3, s[4:7], s61 offen sc1
    s_add_u32 s61, s61, 1024
    buffer_load_dwordx4 v[248:251], v3, s[4:7], s61 offen sc1
    s_add_u32 s61, s61, 1024
    buffer_load_dwordx4 v[248:251], v3, s[4:7], s61 offen sc1
    s_add_u32 s61, s61, 1024
    buffer_load_dwordx4 v[248:251], v3, s[4:7], s61 offen sc1
    s_add_u32 s61, s61, 1024
    buffer_load_dwordx4 v[248:251], v3, s[4:7], s61 offen sc1
    s_add_u32 s61, s61, 1024
    s_mov_b32 s49, 40960
    s_mov_b32 s47, 40960
    s_mov_b32 s37, -1
    s_add_u32 s44, s38, 65536
    s_add_u32 s45, s44, s56
    s_mov_b32 s46, 40960
    ds_read_b128 v[84:87], v11 offset:0
    ds_read_b128 v[88:91], v11 offset:2048
    ds_read_b128 v[92:95], v12 offset:0
    ds_read_b128 v[96:99], v12 offset:2048
    s_waitcnt lgkmcnt(2)
    v_mfma_f32_16x16x32_bf16 v[108:111], a[0:3], v[84:87], 0
    ds_read_b128 v[100:103], v11 offset:4096
    v_mfma_f32_16x16x32_bf16 v[112:115], a[0:3], v[88:91], 0
    ds_read_b128 v[104:107], v11 offset:6144
    v_mfma_f32_16x16x32_bf16 v[116:119], a[80:83], v[84:87], 0
    v_mfma_f32_16x16x32_bf16 v[120:123], a[80:83], v[88:91], 0
    s_waitcnt lgkmcnt(2)
    v_mfma_f32_16x16x32_bf16 v[108:111], a[4:7], v[92:95], v[108:111]
    ds_read_b128 v[84:87], v12 offset:4096
    v_mfma_f32_16x16x32_bf16 v[112:115], a[4:7], v[96:99], v[112:115]
    ds_read_b128 v[88:91], v12 offset:6144
    v_mfma_f32_16x16x32_bf16 v[116:119], a[84:87], v[92:95], v[116:119]
    v_mfma_f32_16x16x32_bf16 v[120:123], a[84:87], v[96:99], v[120:123]
    s_waitcnt lgkmcnt(2)
    v_mfma_f32_16x16x32_bf16 v[108:111], a[8:11], v[100:103], v[108:111]
    ds_read_b128 v[92:95], v11 offset:8192
    v_mfma_f32_16x16x32_bf16 v[112:115], a[8:11], v[104:107], v[112:115]
    ds_read_b128 v[96:99], v11 offset:10240
    v_mfma_f32_16x16x32_bf16 v[116:119], a[88:91], v[100:103], v[116:119]
    v_mfma_f32_16x16x32_bf16 v[120:123], a[88:91], v[104:107], v[120:123]
    s_waitcnt lgkmcnt(2)
    v_mfma_f32_16x16x32_bf16 v[108:111], a[12:15], v[84:87], v[108:111]
    ds_read_b128 v[100:103], v12 offset:8192
    v_mfma_f32_16x16x32_bf16 v[112:115], a[12:15], v[88:91], v[112:115]
    ds_read_b128 v[104:107], v12 offset:10240
    v_mfma_f32_16x16x32_bf16 v[116:119], a[92:95], v[84:87], v[116:119]
    v_mfma_f32_16x16x32_bf16 v[120:123], a[92:95], v[88:91], v[120:123]
    s_waitcnt lgkmcnt(2)
    v_mfma_f32_16x16x32_bf16 v[108:111], a[16:19], v[92:95], v[108:111]
    ds_read_b128 v[84:87], v11 offset:12288
    v_mfma_f32_16x16x32_bf16 v[112:115], a[16:19], v[96:99], v[112:115]
    ds_read_b128 v[88:91], v11 offset:14336
    v_mfma_f32_16x16x32_bf16 v[116:119], a[96:99], v[92:95], v[116:119]
    v_mfma_f32_16x16x32_bf16 v[120:123], a[96:99], v[96:99], v[120:123]
    s_waitcnt lgkmcnt(2)
    v_mfma_f32_16x16x32_bf16 v[108:111], a[20:23], v[100:103], v[108:111]
    ds_read_b128 v[92:95], v12 offset:12288
    v_mfma_f32_16x16x32_bf16 v[112:115], a[20:23], v[104:107], v[112:115]
    ds_read_b128 v[96:99], v12 offset:14336
    v_mfma_f32_16x16x32_bf16 v[116:119], a[100:103], v[100:103], v[116:119]
    v_mfma_f32_16x16x32_bf16 v[120:123], a[100:103], v[104:107], v[120:123]
    s_waitcnt lgkmcnt(2)
    v_mfma_f32_16x16x32_bf16 v[108:111], a[24:27], v[84:87], v[108:111]
    ds_read_b128 v[100:103], v11 offset:16384
    v_mfma_f32_16x16x32_bf16 v[112:115], a[24:27], v[88:91], v[112:115]
    ds_read_b128 v[104:107], v11 offset:18432
    v_mfma_f32_16x16x32_bf16 v[116:119], a[104:107], v[84:87], v[116:119]
    v_mfma_f32_16x16x32_bf16 v[120:123], a[104:107], v[88:91], v[120:123]
    s_waitcnt lgkmcnt(2)
    v_mfma_f32_16x16x32_bf16 v[108:111], a[28:31], v[92:95], v[108:111]
    ds_read_b128 v[84:87], v12 offset:16384
    v_mfma_f32_16x16x32_bf16 v[112:115], a[28:31], v[96:99], v[112:115]
    ds_read_b128 v[88:91], v12 offset:18432
    v_mfma_f32_16x16x32_bf16 v[116:119], a[108:111], v[92:95], v[116:119]
    v_mfma_f32_16x16x32_bf16 v[120:123], a[108:111], v[96:99], v[120:123]
    s_waitcnt lgkmcnt(2)
    v_mfma_f32_16x16x32_bf16 v[108:111], a[32:35], v[100:103], v[108:111]
    ds_read_b128 v[92:95], v11 offset:20480
    v_mfma_f32_16x16x32_bf16 v[112:115], a[32:35], v[104:107], v[112:115]
    ds_read_b128 v[96:99], v11 offset:22528
    v_mfma_f32_16x16x32_bf16 v[116:119], a[112:115], v[100:103], v[116:119]
    v_mfma_f32_16x16x32_bf16 v[120:123], a[112:115], v[104:107], v[120:123]
    s_waitcnt lgkmcnt(2)
    v_mfma_f32_16x16x32_bf16 v[108:111], a[36:39], v[84:87], v[108:111]
    ds_read_b128 v[100:103], v12 offset:20480
    v_mfma_f32_16x16x32_bf16 v[112:115], a[36:39], v[88:91], v[112:115]
    ds_read_b128 v[104:107], v12 offset:22528
    v_mfma_f32_16x16x32_bf16 v[116:119], a[116:119], v[84:87], v[116:119]
    v_mfma_f32_16x16x32_bf16 v[120:123], a[116:119], v[88:91], v[120:123]
    s_waitcnt lgkmcnt(2)
    v_mfma_f32_16x16x32_bf16 v[108:111], a[40:43], v[92:95], v[108:111]
    ds_read_b128 v[84:87], v11 offset:24576
    v_mfma_f32_16x16x32_bf16 v[112:115], a[40:43], v[96:99], v[112:115]
    ds_read_b128 v[88:91], v11 offset:26624
    v_mfma_f32_16x16x32_bf16 v[116:119], a[120:123], v[92:95], v[116:119]
    v_mfma_f32_16x16x32_bf16 v[120:123], a[120:123], v[96:99], v[120:123]
    s_waitcnt lgkmcnt(2)
    v_mfma_f32_16x16x32_bf16 v[108:111], a[44:47], v[100:103], v[108:111]
    ds_read_b128 v[92:95], v12 offset:24576
    v_mfma_f32_16x16x32_bf16 v[112:115], a[44:47], v[104:107], v[112:115]
    ds_read_b128 v[96:99], v12 offset:26624
    v_mfma_f32_16x16x32_bf16 v[116:119], a[124:127], v[100:103], v[116:119]
    v_mfma_f32_16x16x32_bf16 v[120:123], a[124:127], v[104:107], v[120:123]
    s_waitcnt lgkmcnt(2)
    v_mfma_f32_16x16x32_bf16 v[108:111], a[48:51], v[84:87], v[108:111]
    ds_read_b128 v[100:103], v11 offset:28672
    v_mfma_f32_16x16x32_bf16 v[112:115], a[48:51], v[88:91], v[112:115]
    ds_read_b128 v[104:107], v11 offset:30720
    v_mfma_f32_16x16x32_bf16 v[116:119], a[128:131], v[84:87], v[116:119]
    v_mfma_f32_16x16x32_bf16 v[120:123], a[128:131], v[88:91], v[120:123]
    s_waitcnt lgkmcnt(2)
    v_mfma_f32_16x16x32_bf16 v[108:111], a[52:55], v[92:95], v[108:111]
    ds_read_b128 v[84:87], v12 offset:28672
    v_mfma_f32_16x16x32_bf16 v[112:115], a[52:55], v[96:99], v[112:115]
    ds_read_b128 v[88:91], v12 offset:30720
    v_mfma_f32_16x16x32_bf16 v[116:119], a[132:135], v[92:95], v[116:119]
    v_mfma_f32_16x16x32_bf16 v[120:123], a[132:135], v[96:99], v[120:123]
    s_waitcnt lgkmcnt(2)
    v_mfma_f32_16x16x32_bf16 v[108:111], a[56:59], v[100:103], v[108:111]
    ds_read_b128 v[92:95], v11 offset:32768
    v_mfma_f32_16x16x32_bf16 v[112:115], a[56:59], v[104:107], v[112:115]
    ds_read_b128 v[96:99], v11 offset:34816
    v_mfma_f32_16x16x32_bf16 v[116:119], a[136:139], v[100:103], v[116:119]
    v_mfma_f32_16x16x32_bf16 v[120:123], a[136:139], v[104:107], v[120:123]
    s_waitcnt lgkmcnt(2)
    v_mfma_f32_16x16x32_bf16 v[108:111], a[60:63], v[84:87], v[108:111]
    ds_read_b128 v[100:103], v12 offset:32768
    v_mfma_f32_16x16x32_bf16 v[112:115], a[60:63], v[88:91], v[112:115]
    ds_read_b128 v[104:107], v12 offset:34816
    v_mfma_f32_16x16x32_bf16 v[116:119], a[140:143], v[84:87], v[116:119]
    v_mfma_f32_16x16x32_bf16 v[120:123], a[140:143], v[88:91], v[120:123]
    s_waitcnt lgkmcnt(2)
    v_mfma_f32_16x16x32_bf16 v[108:111], a[64:67], v[92:95], v[108:111]
    ds_read_b128 v[84:87], v11 offset:36864
    v_mfma_f32_16x16x32_bf16 v[112:115], a[64:67], v[96:99], v[112:115]
    ds_read_b128 v[88:91], v11 offset:38912
    v_mfma_f32_16x16x32_bf16 v[116:119], a[144:147], v[92:95], v[116:119]
    v_mfma_f32_16x16x32_bf16 v[120:123], a[144:147], v[96:99], v[120:123]
    s_waitcnt lgkmcnt(2)
    v_mfma_f32_16x16x32_bf16 v[108:111], a[68:71], v[100:103], v[108:111]
    ds_read_b128 v[92:95], v12 offset:36864
    v_mfma_f32_16x16x32_bf16 v[112:115], a[68:71], v[104:107], v[112:115]
    ds_read_b128 v[96:99], v12 offset:38912
    v_mfma_f32_16x16x32_bf16 v[116:119], a[148:151], v[100:103], v[116:119]
    v_mfma_f32_16x16x32_bf16 v[120:123], a[148:151], v[104:107], v[120:123]
    s_waitcnt lgkmcnt(0)
    v_mfma_f32_16x16x32_bf16 v[108:111], a[72:75], v[84:87], v[108:111]
    v_add_u32 v11, s49, v11
    v_mfma_f32_16x16x32_bf16 v[112:115], a[72:75], v[88:91], v[112:115]
    v_add_u32 v12, s49, v12
    v_mfma_f32_16x16x32_bf16 v[108:111], a[76:79], v[92:95], v[108:111]
    s_sub_u32 s47, s47, s49
    v_mfma_f32_16x16x32_bf16 v[112:115], a[76:79], v[96:99], v[112:115]
    s_sub_u32 s49, 0, s49
    v_mfma_f32_16x16x32_bf16 v[116:119], a[152:155], v[84:87], v[116:119]
    v_mfma_f32_16x16x32_bf16 v[120:123], a[152:155], v[88:91], v[120:123]
    v_mfma_f32_16x16x32_bf16 v[116:119], a[156:159], v[92:95], v[116:119]
    v_mfma_f32_16x16x32_bf16 v[120:123], a[156:159], v[96:99], v[120:123]
    v_cvt_pk_bf16_f32 v124, v108, v109
    v_cvt_pk_bf16_f32 v125, v110, v111
    v_cvt_pk_bf16_f32 v126, v112, v113
    v_cvt_pk_bf16_f32 v127, v114, v115
    s_nop 0
    v_permlane16_swap_b32 v124, v126
    v_permlane16_swap_b32 v125, v127
    v_cvt_pk_bf16_f32 v128, v116, v117
    v_cvt_pk_bf16_f32 v129, v118, v119
    v_cvt_pk_bf16_f32 v130, v120, v121
    v_cvt_pk_bf16_f32 v131, v122, v123
    s_nop 0
    v_permlane16_swap_b32 v128, v130
    v_permlane16_swap_b32 v129, v131
    buffer_store_dwordx4 v[124:127], v19, s[4:7], s44 offen
    buffer_store_dwordx4 v[128:131], v19, s[4:7], s45 offen
    v_mov_b32 v1, 192
L_gw_15:
    buffer_load_dword v2, v1, s[8:11], 0 offen sc1
    s_sub_u32 s36, s36, 1
    s_cbranch_scc1 L_exit
    s_waitcnt vmcnt(0)
    v_readfirstlane_b32 s90, v2
    s_nop 0
    s_cmp_eq_u32 s90, 0
    s_cbranch_scc1 L_gw_15
    s_cmp_lg_u32 s90, 1
    s_cbranch_scc1 L_slow
    s_waitcnt vmcnt(0) lgkmcnt(0)
    v_mov_b32 v20, 1
    buffer_store_dword v20, v136, s[4:7], s38 offen
    s_barrier
    s_add_u32 s44, s38, 180224
    s_add_u32 s45, s44, s56
    s_mov_b32 s46, 81920
    ds_read_b128 v[84:87], v11 offset:0
    ds_read_b128 v[88:91], v11 offset:2048
    ds_read_b128 v[92:95], v12 offset:0
    ds_read_b128 v[96:99], v12 offset:2048
    s_lshl_b32 s90, s32, 10
    s_add_u32 m0, s90, s47
    s_waitcnt lgkmcnt(2)
    v_mfma_f32_16x16x32_bf16 v[108:111], a[0:3], v[84:87], 0
    ds_read_b128 v[100:103], v11 offset:4096
    v_mfma_f32_16x16x32_bf16 v[112:115], a[0:3], v[88:91], 0
    ds_read_b128 v[104:107], v11 offset:6144
    v_mfma_f32_16x16x32_bf16 v[116:119], a[80:83], v[84:87], 0
    buffer_load_dwordx4 v10, s[24:27], s46 offen offset:0 lds
    s_add_u32 m0, m0, 3968
    v_mfma_f32_16x16x32_bf16 v[120:123], a[80:83], v[88:91], 0
    s_waitcnt lgkmcnt(2)
    v_mfma_f32_16x16x32_bf16 v[108:111], a[4:7], v[92:95], v[108:111]
    ds_read_b128 v[84:87], v12 offset:4096
    v_mfma_f32_16x16x32_bf16 v[112:115], a[4:7], v[96:99], v[112:115]
    ds_read_b128 v[88:91], v12 offset:6144
    v_mfma_f32_16x16x32_bf16 v[116:119], a[84:87], v[92:95], v[116:119]
    buffer_load_dwordx4 v10, s[24:27], s46 offen offset:128 lds
    s_add_u32 m0, m0, 3968
    v_mfma_f32_16x16x32_bf16 v[120:123], a[84:87], v[96:99], v[120:123]
    s_waitcnt lgkmcnt(2)
    v_mfma_f32_16x16x32_bf16 v[108:111], a[8:11], v[100:103], v[108:111]
    ds_read_b128 v[92:95], v11 offset:8192
    v_mfma_f32_16x16x32_bf16 v[112:115], a[8:11], v[104:107], v[112:115]
    ds_read_b128 v[96:99], v11 offset:10240
    v_mfma_f32_16x16x32_bf16 v[116:119], a[88:91], v[100:103], v[116:119]
    buffer_load_dwordx4 v10, s[24:27], s46 offen offset:256 lds
    s_add_u32 m0, m0, 3968
    v_mfma_f32_16x16x32_bf16 v[120:123], a[88:91], v[104:107], v[120:123]
    s_waitcnt lgkmcnt(2)
    v_mfma_f32_16x16x32_bf16 v[108:111], a[12:15], v[84:87], v[108:111]
    ds_read_b128 v[100:103], v12 offset:8192
    v_mfma_f32_16x16x32_bf16 v[112:115], a[12:15], v[88:91], v[112:115]
    ds_read_b128 v[104:107], v12 offset:10240
    v_mfma_f32_16x16x32_bf16 v[116:119], a[92:95], v[84:87], v[116:119]
    buffer_load_dwordx4 v10, s[24:27], s46 offen offset:384 lds
    s_add_u32 m0, m0, 3968
    v_mfma_f32_16x16x32_bf16 v[120:123], a[92:95], v[88:91], v[120:123]
    s_waitcnt lgkmcnt(2)
    v_mfma_f32_16x16x32_bf16 v[108:111], a[16:19], v[92:95], v[108:111]
    ds_read_b128 v[84:87], v11 offset:12288
    v_mfma_f32_16x16x32_bf16 v[112:115], a[16:19], v[96:99], v[112:115]
    ds_read_b128 v[88:91], v11 offset:14336
    v_mfma_f32_16x16x32_bf16 v[116:119], a[96:99], v[92:95], v[116:119]
    buffer_load_dwordx4 v10, s[24:27], s46 offen offset:512 lds
    s_add_u32 m0, m0, 3968
    v_mfma_f32_16x16x32_bf16 v[120:123], a[96:99], v[96:99], v[120:123]
    s_waitcnt lgkmcnt(2)
    v_mfma_f32_16x16x32_bf16 v[108:111], a[20:23], v[100:103], v[108:111]
    ds_read_b128 v[92:95], v12 offset:12288
    v_mfma_f32_16x16x32_bf16 v[112:115], a[20:23], v[104:107], v[112:115]
    ds_read_b128 v[96:99], v12 offset:14336
    v_mfma_f32_16x16x32_bf16 v[116:119], a[100:103], v[100:103], v[116:119]
    buffer_load_dwordx4 v10, s[24:27], s46 offen offset:640 lds
    s_add_u32 m0, m0, 3968
    v_mfma_f32_16x16x32_bf16 v[120:123], a[100:103], v[104:107], v[120:123]
    s_waitcnt lgkmcnt(2)
    v_mfma_f32_16x16x32_bf16 v[108:111], a[24:27], v[84:87], v[108:111]
    ds_read_b128 v[100:103], v11 offset:16384
    v_mfma_f32_16x16x32_bf16 v[112:115], a[24:27], v[88:91], v[112:115]
    ds_read_b128 v[104:107], v11 offset:18432
    v_mfma_f32_16x16x32_bf16 v[116:119], a[104:107], v[84:87], v[116:119]
    buffer_load_dwordx4 v10, s[24:27], s46 offen offset:768 lds
    s_add_u32 m0, m0, 3968
    v_mfma_f32_16x16x32_bf16 v[120:123], a[104:107], v[88:91], v[120:123]
    s_waitcnt lgkmcnt(2)
    v_mfma_f32_16x16x32_bf16 v[108:111], a[28:31], v[92:95], v[108:111]
    ds_read_b128 v[84:87], v12 offset:16384
    v_mfma_f32_16x16x32_bf16 v[112:115], a[28:31], v[96:99], v[112:115]
    ds_read_b128 v[88:91], v12 offset:18432
    v_mfma_f32_16x16x32_bf16 v[116:119], a[108:111], v[92:95], v[116:119]
    buffer_load_dwordx4 v10, s[24:27], s46 offen offset:896 lds
    s_add_u32 m0, m0, 3968
    v_mfma_f32_16x16x32_bf16 v[120:123], a[108:111], v[96:99], v[120:123]
    s_waitcnt lgkmcnt(2)
    v_mfma_f32_16x16x32_bf16 v[108:111], a[32:35], v[100:103], v[108:111]
    ds_read_b128 v[92:95], v11 offset:20480
    v_mfma_f32_16x16x32_bf16 v[112:115], a[32:35], v[104:107], v[112:115]
    ds_read_b128 v[96:99], v11 offset:22528
    v_mfma_f32_16x16x32_bf16 v[116:119], a[112:115], v[100:103], v[116:119]
    buffer_load_dwordx4 v10, s[24:27], s46 offen offset:1024 lds
    s_add_u32 m0, m0, 3968
    v_mfma_f32_16x16x32_bf16 v[120:123], a[112:115], v[104:107], v[120:123]
    s_waitcnt lgkmcnt(2)
    v_mfma_f32_16x16x32_bf16 v[108:111], a[36:39], v[84:87], v[108:111]
    ds_read_b128 v[100:103], v12 offset:20480
    v_mfma_f32_16x16x32_bf16 v[112:115], a[36:39], v[88:91], v[112:115]
    ds_read_b128 v[104:107], v12 offset:22528
    v_mfma_f32_16x16x32_bf16 v[116:119], a[116:119], v[84:87], v[116:119]
    buffer_load_dwordx4 v10, s[24:27], s46 offen offset:1152 lds
    v_mfma_f32_16x16x32_bf16 v[120:123], a[116:119], v[88:91], v[120:123]
    s_waitcnt lgkmcnt(2)
    v_mfma_f32_16x16x32_bf16 v[108:111], a[40:43], v[92:95], v[108:111]
    ds_read_b128 v[84:87], v11 offset:24576
    v_mfma_f32_16x16x32_bf16 v[112:115], a[40:43], v[96:99], v[112:115]
    ds_read_b128 v[88:91], v11 offset:26624
    v_mfma_f32_16x16x32_bf16 v[116:119], a[120:123], v[92:95], v[116:119]
    v_mfma_f32_16x16x32_bf16 v[120:123], a[120:123], v[96:99], v[120:123]
    s_waitcnt lgkmcnt(2)
    v_mfma_f32_16x16x32_bf16 v[108:111], a[44:47], v[100:103], v[108:111]
    ds_read_b128 v[92:95], v12 offset:24576
    v_mfma_f32_16x16x32_bf16 v[112:115], a[44:47], v[104:107], v[112:115]
    ds_read_b128 v[96:99], v12 offset:26624
    v_mfma_f32_16x16x32_bf16 v[116:119], a[124:127], v[100:103], v[116:119]
    v_mfma_f32_16x16x32_bf16 v[120:123], a[124:127], v[104:107], v[120:123]
    s_waitcnt lgkmcnt(2)
    v_mfma_f32_16x16x32_bf16 v[108:111], a[48:51], v[84:87], v[108:111]
    ds_read_b128 v[100:103], v11 offset:28672
    v_mfma_f32_16x16x32_bf16 v[112:115], a[48:51], v[88:91], v[112:115]
    ds_read_b128 v[104:107], v11 offset:30720
    v_mfma_f32_16x16x32_bf16 v[116:119], a[128:131], v[84:87], v[116:119]
    v_mfma_f32_16x16x32_bf16 v[120:123], a[128:131], v[88:91], v[120:123]
    s_waitcnt lgkmcnt(2)
    v_mfma_f32_16x16x32_bf16 v[108:111], a[52:55], v[92:95], v[108:111]
    ds_read_b128 v[84:87], v12 offset:28672
    v_mfma_f32_16x16x32_bf16 v[112:115], a[52:55], v[96:99], v[112:115]
    ds_read_b128 v[88:91], v12 offset:30720
    v_mfma_f32_16x16x32_bf16 v[116:119], a[132:135], v[92:95], v[116:119]
    v_mfma_f32_16x16x32_bf16 v[120:123], a[132:135], v[96:99], v[120:123]
    s_waitcnt lgkmcnt(2)
    v_mfma_f32_16x16x32_bf16 v[108:111], a[56:59], v[100:103], v[108:111]
    ds_read_b128 v[92:95], v11 offset:32768
    v_mfma_f32_16x16x32_bf16 v[112:115], a[56:59], v[104:107], v[112:115]
    ds_read_b128 v[96:99], v11 offset:34816
    v_mfma_f32_16x16x32_bf16 v[116:119], a[136:139], v[100:103], v[116:119]
    v_mfma_f32_16x16x32_bf16 v[120:123], a[136:139], v[104:107], v[120:123]
    s_waitcnt lgkmcnt(2)
    v_mfma_f32_16x16x32_bf16 v[108:111], a[60:63], v[84:87], v[108:111]
    ds_read_b128 v[100:103], v12 offset:32768
    v_mfma_f32_16x16x32_bf16 v[112:115], a[60:63], v[88:91], v[112:115]
    ds_read_b128 v[104:107], v12 offset:34816
    v_mfma_f32_16x16x32_bf16 v[116:119], a[140:143], v[84:87], v[116:119]
    v_mfma_f32_16x16x32_bf16 v[120:123], a[140:143], v[88:91], v[120:123]
    s_waitcnt lgkmcnt(2)
    v_mfma_f32_16x16x32_bf16 v[108:111], a[64:67], v[92:95], v[108:111]
    ds_read_b128 v[84:87], v11 offset:36864
    v_mfma_f32_16x16x32_bf16 v[112:115], a[64:67], v[96:99], v[112:115]
    ds_read_b128 v[88:91], v11 offset:38912
    v_mfma_f32_16x16x32_bf16 v[116:119], a[144:147], v[92:95], v[116:119]
    v_mfma_f32_16x16x32_bf16 v[120:123], a[144:147], v[96:99], v[120:123]
    s_waitcnt lgkmcnt(2)
    v_mfma_f32_16x16x32_bf16 v[108:111], a[68:71], v[100:103], v[108:111]
    ds_read_b128 v[92:95], v12 offset:36864
    v_mfma_f32_16x16x32_bf16 v[112:115], a[68:71], v[104:107], v[112:115]
    ds_read_b128 v[96:99], v12 offset:38912
    v_mfma_f32_16x16x32_bf16 v[116:119], a[148:151], v[100:103], v[116:119]
    v_mfma_f32_16x16x32_bf16 v[120:123], a[148:151], v[104:107], v[120:123]
    s_waitcnt lgkmcnt(0)
    v_mfma_f32_16x16x32_bf16 v[108:111], a[72:75], v[84:87], v[108:111]
    v_add_u32 v11, s49, v11
    v_mfma_f32_16x16x32_bf16 v[112:115], a[72:75], v[88:91], v[112:115]
    v_add_u32 v12, s49, v12
    v_mfma_f32_16x16x32_bf16 v[108:111], a[76:79], v[92:95], v[108:111]
    s_sub_u32 s47, s47, s49
    v_mfma_f32_16x16x32_bf16 v[112:115], a[76:79], v[96:99], v[112:115]
    s_sub_u32 s49, 0, s49
    v_mfma_f32_16x16x32_bf16 v[116:119], a[152:155], v[84:87], v[116:119]
    v_mfma_f32_16x16x32_bf16 v[120:123], a[152:155], v[88:91], v[120:123]
    v_mfma_f32_16x16x32_bf16 v[116:119], a[156:159], v[92:95], v[116:119]
    v_mfma_f32_16x16x32_bf16 v[120:123], a[156:159], v[96:99], v[120:123]
    v_cvt_pk_bf16_f32 v124, v108, v109
    v_cvt_pk_bf16_f32 v125, v110, v111
    v_cvt_pk_bf16_f32 v126, v112, v113
    v_cvt_pk_bf16_f32 v127, v114, v115
    s_nop 0
    v_permlane16_swap_b32 v124, v126
    v_permlane16_swap_b32 v125, v127
    v_cvt_pk_bf16_f32 v128, v116, v117
    v_cvt_pk_bf16_f32 v129, v118, v119
    v_cvt_pk_bf16_f32 v130, v120, v121
    v_cvt_pk_bf16_f32 v131, v122, v123
    s_nop 0
    v_permlane16_swap_b32 v128, v130
    v_permlane16_swap_b32 v129, v131
    buffer_store_dwordx4 v[124:127], v19, s[4:7], s44 offen
    buffer_store_dwordx4 v[128:131], v19, s[4:7], s45 offen
    s_waitcnt vmcnt(0) lgkmcnt(0)
    v_mov_b32 v20, 2
    buffer_store_dword v20, v136, s[4:7], s38 offen
    s_barrier
    s_add_u32 s44, s38, 294912
    s_add_u32 s45, s44, s56
    s_mov_b32 s46, 122880
    ds_read_b128 v[84:87], v11 offset:0
    ds_read_b128 v[88:91], v11 offset:2048
    ds_read_b128 v[92:95], v12 offset:0
    ds_read_b128 v[96:99], v12 offset:2048
    s_lshl_b32 s90, s32, 10
    s_add_u32 m0, s90, s47
    s_waitcnt lgkmcnt(2)
    v_mfma_f32_16x16x32_bf16 v[108:111], a[0:3], v[84:87], 0
    ds_read_b128 v[100:103], v11 offset:4096
    s_add_u32 s51, s37, 3
    v_mfma_f32_16x16x32_bf16 v[112:115], a[0:3], v[88:91], 0
    ds_read_b128 v[104:107], v11 offset:6144
    s_and_b32 s50, s51, 3
    v_mfma_f32_16x16x32_bf16 v[116:119], a[80:83], v[84:87], 0
    buffer_load_dwordx4 v10, s[24:27], s46 offen offset:0 lds
    s_add_u32 m0, m0, 3968
    v_mfma_f32_16x16x32_bf16 v[120:123], a[80:83], v[88:91], 0
    s_waitcnt lgkmcnt(2)
    s_mul_i32 s50, s50, 114688
    v_mfma_f32_16x16x32_bf16 v[108:111], a[4:7], v[92:95], v[108:111]
    ds_read_b128 v[84:87], v12 offset:4096
    s_add_u32 s50, s50, 65536
    v_mfma_f32_16x16x32_bf16 v[112:115], a[4:7], v[96:99], v[112:115]
    ds_read_b128 v[88:91], v12 offset:6144
    s_add_u32 s44, s38, s50
    v_mfma_f32_16x16x32_bf16 v[116:119], a[84:87], v[92:95], v[116:119]
    buffer_load_dwordx4 v10, s[24:27], s46 offen offset:128 lds
    s_add_u32 m0, m0, 3968
    v_mfma_f32_16x16x32_bf16 v[120:123], a[84:87], v[96:99], v[120:123]
    s_waitcnt lgkmcnt(2)
    s_add_u32 s45, s44, s56
    v_mfma_f32_16x16x32_bf16 v[108:111], a[8:11], v[100:103], v[108:111]
    ds_read_b128 v[92:95], v11 offset:8192
    s_add_u32 s37, s37, 1
    v_mfma_f32_16x16x32_bf16 v[112:115], a[8:11], v[104:107], v[112:115]
    ds_read_b128 v[96:99], v11 offset:10240
    s_mov_b32 s52, 0
    v_mfma_f32_16x16x32_bf16 v[116:119], a[88:91], v[100:103], v[116:119]
    buffer_load_dwordx4 v10, s[24:27], s46 offen offset:256 lds
    s_add_u32 m0, m0, 3968
    v_mfma_f32_16x16x32_bf16 v[120:123], a[88:91], v[104:107], v[120:123]
    s_waitcnt lgkmcnt(2)
    s_and_b32 s50, s37, 3
    v_mfma_f32_16x16x32_bf16 v[108:111], a[12:15], v[84:87], v[108:111]
    ds_read_b128 v[100:103], v12 offset:8192
    s_mul_i32 s51, s50, 114688
    v_mfma_f32_16x16x32_bf16 v[112:115], a[12:15], v[88:91], v[112:115]
    ds_read_b128 v[104:107], v12 offset:10240
    s_add_u32 s41, s38, s51
    v_mfma_f32_16x16x32_bf16 v[116:119], a[92:95], v[84:87], v[116:119]
    buffer_load_dwordx4 v10, s[24:27], s46 offen offset:384 lds
    s_add_u32 m0, m0, 3968
    v_mfma_f32_16x16x32_bf16 v[120:123], a[92:95], v[88:91], v[120:123]
    s_waitcnt lgkmcnt(2)
    v_mfma_f32_16x16x32_bf16 v[108:111], a[16:19], v[92:95], v[108:111]
    ds_read_b128 v[84:87], v11 offset:12288
    v_mfma_f32_16x16x32_bf16 v[112:115], a[16:19], v[96:99], v[112:115]
    ds_read_b128 v[88:91], v11 offset:14336
    v_mfma_f32_16x16x32_bf16 v[116:119], a[96:99], v[92:95], v[116:119]
    buffer_load_dwordx4 v10, s[24:27], s46 offen offset:512 lds
    s_add_u32 m0, m0, 3968
    v_mfma_f32_16x16x32_bf16 v[120:123], a[96:99], v[96:99], v[120:123]
    s_waitcnt lgkmcnt(2)
    v_mfma_f32_16x16x32_bf16 v[108:111], a[20:23], v[100:103], v[108:111]
    ds_read_b128 v[92:95], v12 offset:12288
    v_mfma_f32_16x16x32_bf16 v[112:115], a[20:23], v[104:107], v[112:115]
    ds_read_b128 v[96:99], v12 offset:14336
    v_mfma_f32_16x16x32_bf16 v[116:119], a[100:103], v[100:103], v[116:119]
    buffer_load_dwordx4 v10, s[24:27], s46 offen offset:640 lds
    s_add_u32 m0, m0, 3968
    v_mfma_f32_16x16x32_bf16 v[120:123], a[100:103], v[104:107], v[120:123]
    s_waitcnt lgkmcnt(2)
    v_mfma_f32_16x16x32_bf16 v[108:111], a[24:27], v[84:87], v[108:111]
    ds_read_b128 v[100:103], v11 offset:16384
    v_mfma_f32_16x16x32_bf16 v[112:115], a[24:27], v[88:91], v[112:115]
    ds_read_b128 v[104:107], v11 offset:18432
    v_mfma_f32_16x16x32_bf16 v[116:119], a[104:107], v[84:87], v[116:119]
    buffer_load_dwordx4 v10, s[24:27], s46 offen offset:768 lds
    s_add_u32 m0, m0, 3968
    v_mfma_f32_16x16x32_bf16 v[120:123], a[104:107], v[88:91], v[120:123]
    s_waitcnt lgkmcnt(2)
    v_mfma_f32_16x16x32_bf16 v[108:111], a[28:31], v[92:95], v[108:111]
    ds_read_b128 v[84:87], v12 offset:16384
    v_mfma_f32_16x16x32_bf16 v[112:115], a[28:31], v[96:99], v[112:115]
    ds_read_b128 v[88:91], v12 offset:18432
    v_mfma_f32_16x16x32_bf16 v[116:119], a[108:111], v[92:95], v[116:119]
    buffer_load_dwordx4 v10, s[24:27], s46 offen offset:896 lds
    s_add_u32 m0, m0, 3968
    v_mfma_f32_16x16x32_bf16 v[120:123], a[108:111], v[96:99], v[120:123]
    s_waitcnt lgkmcnt(2)
    v_mfma_f32_16x16x32_bf16 v[108:111], a[32:35], v[100:103], v[108:111]
    ds_read_b128 v[92:95], v11 offset:20480
    v_mfma_f32_16x16x32_bf16 v[112:115], a[32:35], v[104:107], v[112:115]
    ds_read_b128 v[96:99], v11 offset:22528
    v_mfma_f32_16x16x32_bf16 v[116:119], a[112:115], v[100:103], v[116:119]
    buffer_load_dwordx4 v10, s[24:27], s46 offen offset:1024 lds
    s_add_u32 m0, m0, 3968
    v_mfma_f32_16x16x32_bf16 v[120:123], a[112:115], v[104:107], v[120:123]
    s_waitcnt lgkmcnt(2)
    v_mfma_f32_16x16x32_bf16 v[108:111], a[36:39], v[84:87], v[108:111]
    ds_read_b128 v[100:103], v12 offset:20480
    v_mfma_f32_16x16x32_bf16 v[112:115], a[36:39], v[88:91], v[112:115]
    ds_read_b128 v[104:107], v12 offset:22528
    v_mfma_f32_16x16x32_bf16 v[116:119], a[116:119], v[84:87], v[116:119]
    buffer_load_dwordx4 v10, s[24:27], s46 offen offset:1152 lds
    v_mfma_f32_16x16x32_bf16 v[120:123], a[116:119], v[88:91], v[120:123]
    s_waitcnt lgkmcnt(2)
    v_mfma_f32_16x16x32_bf16 v[108:111], a[40:43], v[92:95], v[108:111]
    ds_read_b128 v[84:87], v11 offset:24576
    v_mfma_f32_16x16x32_bf16 v[112:115], a[40:43], v[96:99], v[112:115]
    ds_read_b128 v[88:91], v11 offset:26624
    v_mfma_f32_16x16x32_bf16 v[116:119], a[120:123], v[92:95], v[116:119]
    v_mfma_f32_16x16x32_bf16 v[120:123], a[120:123], v[96:99], v[120:123]
    s_waitcnt lgkmcnt(2)
    v_mfma_f32_16x16x32_bf16 v[108:111], a[44:47], v[100:103], v[108:111]
    ds_read_b128 v[92:95], v12 offset:24576
    v_mfma_f32_16x16x32_bf16 v[112:115], a[44:47], v[104:107], v[112:115]
    ds_read_b128 v[96:99], v12 offset:26624
    v_mfma_f32_16x16x32_bf16 v[116:119], a[124:127], v[100:103], v[116:119]
    v_mfma_f32_16x16x32_bf16 v[120:123], a[124:127], v[104:107], v[120:123]
    s_waitcnt lgkmcnt(2)
    v_mfma_f32_16x16x32_bf16 v[108:111], a[48:51], v[84:87], v[108:111]
    ds_read_b128 v[100:103], v11 offset:28672
    v_mfma_f32_16x16x32_bf16 v[112:115], a[48:51], v[88:91], v[112:115]
    ds_read_b128 v[104:107], v11 offset:30720
    v_mfma_f32_16x16x32_bf16 v[116:119], a[128:131], v[84:87], v[116:119]
    v_mfma_f32_16x16x32_bf16 v[120:123], a[128:131], v[88:91], v[120:123]
    s_waitcnt lgkmcnt(2)
    v_mfma_f32_16x16x32_bf16 v[108:111], a[52:55], v[92:95], v[108:111]
    ds_read_b128 v[84:87], v12 offset:28672
    v_mfma_f32_16x16x32_bf16 v[112:115], a[52:55], v[96:99], v[112:115]
    ds_read_b128 v[88:91], v12 offset:30720
    v_mfma_f32_16x16x32_bf16 v[116:119], a[132:135], v[92:95], v[116:119]
    v_mfma_f32_16x16x32_bf16 v[120:123], a[132:135], v[96:99], v[120:123]
    s_waitcnt lgkmcnt(2)
    v_mfma_f32_16x16x32_bf16 v[108:111], a[56:59], v[100:103], v[108:111]
    ds_read_b128 v[92:95], v11 offset:32768
    v_mfma_f32_16x16x32_bf16 v[112:115], a[56:59], v[104:107], v[112:115]
    ds_read_b128 v[96:99], v11 offset:34816
    v_mfma_f32_16x16x32_bf16 v[116:119], a[136:139], v[100:103], v[116:119]
    v_mfma_f32_16x16x32_bf16 v[120:123], a[136:139], v[104:107], v[120:123]
    s_waitcnt lgkmcnt(2)
    v_mfma_f32_16x16x32_bf16 v[108:111], a[60:63], v[84:87], v[108:111]
    ds_read_b128 v[100:103], v12 offset:32768
    v_mfma_f32_16x16x32_bf16 v[112:115], a[60:63], v[88:91], v[112:115]
    ds_read_b128 v[104:107], v12 offset:34816
    v_mfma_f32_16x16x32_bf16 v[116:119], a[140:143], v[84:87], v[116:119]
    v_mfma_f32_16x16x32_bf16 v[120:123], a[140:143], v[88:91], v[120:123]
    s_waitcnt lgkmcnt(2)
    v_mfma_f32_16x16x32_bf16 v[108:111], a[64:67], v[92:95], v[108:111]
    ds_read_b128 v[84:87], v11 offset:36864
    v_mfma_f32_16x16x32_bf16 v[112:115], a[64:67], v[96:99], v[112:115]
    ds_read_b128 v[88:91], v11 offset:38912
    v_mfma_f32_16x16x32_bf16 v[116:119], a[144:147], v[92:95], v[116:119]
    v_mfma_f32_16x16x32_bf16 v[120:123], a[144:147], v[96:99], v[120:123]
    s_waitcnt lgkmcnt(2)
    v_mfma_f32_16x16x32_bf16 v[108:111], a[68:71], v[100:103], v[108:111]
    ds_read_b128 v[92:95], v12 offset:36864
    v_mfma_f32_16x16x32_bf16 v[112:115], a[68:71], v[104:107], v[112:115]
    ds_read_b128 v[96:99], v12 offset:38912
    v_mfma_f32_16x16x32_bf16 v[116:119], a[148:151], v[100:103], v[116:119]
    v_mfma_f32_16x16x32_bf16 v[120:123], a[148:151], v[104:107], v[120:123]
    s_waitcnt lgkmcnt(0)
    v_mfma_f32_16x16x32_bf16 v[108:111], a[72:75], v[84:87], v[108:111]
    v_add_u32 v11, s49, v11
    v_mfma_f32_16x16x32_bf16 v[112:115], a[72:75], v[88:91], v[112:115]
    v_add_u32 v12, s49, v12
    v_mfma_f32_16x16x32_bf16 v[108:111], a[76:79], v[92:95], v[108:111]
    s_sub_u32 s47, s47, s49
    v_mfma_f32_16x16x32_bf16 v[112:115], a[76:79], v[96:99], v[112:115]
    s_sub_u32 s49, 0, s49
    v_mfma_f32_16x16x32_bf16 v[116:119], a[152:155], v[84:87], v[116:119]
    v_mfma_f32_16x16x32_bf16 v[120:123], a[152:155], v[88:91], v[120:123]
    v_mfma_f32_16x16x32_bf16 v[116:119], a[156:159], v[92:95], v[116:119]
    v_mfma_f32_16x16x32_bf16 v[120:123], a[156:159], v[96:99], v[120:123]
    v_cvt_pk_bf16_f32 v124, v108, v109
    v_cvt_pk_bf16_f32 v125, v110, v111
    v_cvt_pk_bf16_f32 v126, v112, v113
    v_cvt_pk_bf16_f32 v127, v114, v115
    s_nop 0
    v_permlane16_swap_b32 v124, v126
    v_permlane16_swap_b32 v125, v127
    v_cvt_pk_bf16_f32 v128, v116, v117
    v_cvt_pk_bf16_f32 v129, v118, v119
    v_cvt_pk_bf16_f32 v130, v120, v121
    v_cvt_pk_bf16_f32 v131, v122, v123
    s_nop 0
    v_permlane16_swap_b32 v128, v130
    v_permlane16_swap_b32 v129, v131
    buffer_store_dwordx4 v[124:127], v19, s[4:7], s44 offen
    buffer_store_dwordx4 v[128:131], v19, s[4:7], s45 offen
    v_mov_b32 v3, 200
L_p0_16:
    buffer_load_dword v4, v3, s[8:11], 0 offen sc1
    s_sub_u32 s36, s36, 1
    s_cbranch_scc1 L_exit
    s_waitcnt vmcnt(0)
    v_readfirstlane_b32 s90, v4
    s_nop 0
    s_cmp_eq_u32 s90, 0
    s_cbranch_scc1 L_p0_16
    s_and_b32 s90, s90, 2
    s_lshl_b32 s90, s90, 12
    v_and_b32 v3, 1, v0
    v_lshlrev_b32 v3, 12, v3
    v_bfe_u32 v5, v0, 2, 1
    v_lshl_add_u32 v3, v5, 13, v3
    v_bfe_u32 v4, v0, 1, 1
    v_lshl_add_u32 v3, v4, 14, v3
    v_xor_b32 v3, s90, v3
    s_lshl_b32 s91, s34, 9
    s_add_u32 s91, s91, 1933312
    s_xor_b32 s55, s32, 3
    s_or_b32 s55, s55, s40
    s_cselect_b32 s91, 2146435072, s91
    v_add_u32 v140, s91, v3
    v_cmp_gt_u32 vcc, 8, v0
    v_mov_b32 v9, 2146435072
    s_nop 0
    v_cndmask_b32 v140, v9, v140, vcc
    v_cmp_ne_u32 vcc, s34, v0
    v_mov_b32 v9, 2146435072
    s_nop 0
    v_cndmask_b32 v140, v9, v140, vcc
    s_lshr_b32 s91, s34, 2
    v_cmp_eq_u32 vcc, s91, v5
    s_nop 1
    v_cndmask_b32 v141, v9, v140, vcc
    v_cndmask_b32 v140, v140, v9, vcc
    v_and_b32 v3, 7, v0
    v_min_u32 v3, 5, v3
    v_bfe_u32 v4, v0, 3, 2
    v_lshlrev_b32 v4, 7, v4
    v_lshl_add_u32 v3, v3, 2, v4
    v_add_u32 v142, 462368, v3
    s_mov_b32 s61, s90
    s_lshl_b32 s93, s40, 1
    s_add_u32 s93, s93, s32
    s_lshl_b32 s93, s93, 1
    s_sub_u32 s93, s93, 8
    v_and_b32 v1, 15, v0
    v_lshrrev_b32 v2, 4, v0
    s_nop 0
    s_lshr_b32 s90, s93, 2
    s_lshl_b32 s90, s90, 15
    s_and_b32 s92, s93, 3
    s_lshl_b32 s92, s92, 10
    s_add_u32 s90, s90, s92
    v_mov_b32 v5, s34
    v_and_b32 v6, 7, v1
    v_lshlrev_b32 v6, 4, v6
    v_lshl_add_u32 v6, v5, 7, v6
    v_lshrrev_b32 v7, 3, v1
    v_lshl_add_u32 v6, v7, 12, v6
    v_lshrrev_b32 v5, 1, v2
    v_lshl_add_u32 v6, v5, 13, v6
    v_and_b32 v5, 1, v2
    v_lshl_add_u32 v6, v5, 14, v6
    v_add_u32 v143, s90, v6
    s_and_b32 s91, s34, 1
    s_lshl_b32 s91, s91, 12
    s_add_u32 s90, s90, s91
    s_lshr_b32 s91, s34, 2
    s_lshl_b32 s91, s91, 13
    s_add_u32 s90, s90, s91
    s_and_b32 s91, s34, 2
    s_lshl_b32 s91, s91, 13
    s_add_u32 s90, s90, s91
    v_lshl_add_u32 v144, v0, 4, s90
    s_lshl_b32 s91, s93, 10
    s_add_u32 s91, s91, 884736
    v_lshl_add_u32 v146, v0, 4, s91
    s_lshr_b32 s91, s34, 1
    s_mul_i32 s91, s91, 10240
    s_lshl_b32 s92, s93, 5
    s_add_u32 s91, s91, s92
    s_and_b32 s92, s34, 1
    s_mul_i32 s92, s92, 40960
    s_add_u32 s91, s91, s92
    s_add_u32 s91, s91, 1280
    v_mul_u32_u24 v6, 2560, v2
    v_lshl_add_u32 v6, v1, 1, v6
    v_add_u32 v145, s91, v6
    v_cmp_gt_u32 s[58:59], 8, v1
    v_and_b32 v5, 1, v1
    v_lshrrev_b32 v6, 3, v1
    v_lshl_add_u32 v5, v5, 1, v6
    v_bfe_u32 v6, v1, 2, 1
    v_cmp_ne_u32 vcc, 0, v6
    v_mov_b32 v6, 0x3f80
    v_mov_b32 v7, 0x3f800000
    v_cndmask_b32 v6, v6, v7, vcc
    v_cmp_eq_u32 vcc, 0, v5
    s_nop 1
    v_cndmask_b32 v7, 0, v6, vcc
    v_accvgpr_write_b32 a160, v7
    v_cmp_eq_u32 vcc, 1, v5
    s_nop 1
    v_cndmask_b32 v7, 0, v6, vcc
    v_accvgpr_write_b32 a161, v7
    v_cmp_eq_u32 vcc, 2, v5
    s_nop 1
    v_cndmask_b32 v7, 0, v6, vcc
    v_accvgpr_write_b32 a162, v7
    v_cmp_eq_u32 vcc, 3, v5
    s_nop 1
    v_cndmask_b32 v7, 0, v6, vcc
    v_accvgpr_write_b32 a163, v7
    v_xor_b32 v143, s61, v143
    v_xor_b32 v144, s61, v144
    s_cmp_lg_u32 s40, 0
    s_cselect_b64 vcc, -1, 0
    v_mov_b32 v9, 2146435072
    v_cndmask_b32 v143, v9, v143, vcc
    v_cndmask_b32 v144, v9, v144, vcc
    v_cndmask_b32 v145, v9, v145, vcc
    v_cndmask_b32 v146, v9, v146, vcc
L_v_loop_f:
    s_add_u32 s50, s37, 2
    s_and_b32 s50, s50, 3
    s_mul_i32 s50, s50, 114688
    s_add_u32 s42, s38, s50
    s_add_u32 s50, s37, 4
    s_min_u32 s50, s50, 63
    s_mul_i32 s46, s50, 40960
    s_add_u32 s51, s37, 1
    v_mov_b32 v20, s51
    s_mov_b32 m0, s48
    v_mov_b32 v68, 0
    v_mov_b32 v69, 0
    v_mov_b32 v70, 0
    v_mov_b32 v71, 0
    v_mov_b32 v72, 0
    v_mov_b32 v73, 0
    v_mov_b32 v74, 0
    v_mov_b32 v75, 0
    s_add_u32 s50, s37, 6
    s_min_u32 s50, s50, 63
    s_mul_i32 s57, s50, 40960
    s_and_b32 s50, s37, 3
    s_mul_i32 s51, s50, 40960
    s_add_u32 s43, s51, s38
    s_mul_i32 s51, s50, 327680
    s_add_u32 s53, s51, 4194304
    s_xor_b32 s50, s50, 2
    s_mul_i32 s51, s50, 327680
    s_add_u32 s54, s51, 4194304
    s_sub_u32 s51, s37, 6
    s_mul_i32 s60, s51, 81920
L_vg_17:
    buffer_load_dword v139, v138, s[4:7], s38 offen sc1
    s_sub_u32 s36, s36, 1
    s_cbranch_scc1 L_exit
    s_waitcnt vmcnt(0)
    v_cmp_gt_u32 vcc, s37, v139
    s_cbranch_vccnz L_vg_17
    buffer_load_dwordx4 v13, s[4:7], s41 offen sc1 lds
    buffer_load_dwordx4 v13, s[4:7], s41 offen offset:1024 sc1 lds
    buffer_load_dword v14, s[4:7], s41 offen offset:2048 sc1 lds
    buffer_load_dword v14, s[4:7], s41 offen offset:2304 sc1 lds
L_poll_19:
    buffer_load_dwordx4 v13, s[4:7], s41 offen sc1 lds
    buffer_load_dwordx4 v13, s[4:7], s41 offen offset:1024 sc1 lds
    buffer_load_dword v14, s[4:7], s41 offen offset:2048 sc1 lds
    buffer_load_dword v14, s[4:7], s41 offen offset:2304 sc1 lds
    s_sub_u32 s36, s36, 1
    s_cbranch_scc1 L_exit
    s_waitcnt vmcnt(4)
    ds_read_b32 v18, v15
    s_waitcnt lgkmcnt(0)
    v_cmp_eq_u32 vcc, -1, v18
    s_cbranch_vccnz L_poll_19
    s_barrier
    ds_read_b128 v[28:31], v16 offset:0
    ds_read_b128 v[32:35], v16 offset:1024
    ds_read_b128 v[36:39], v16 offset:2048
    ds_read_b128 v[40:43], v16 offset:3072
    s_waitcnt lgkmcnt(3)
    v_smfmac_f32_16x16x64_bf16 v[68:71], v[28:31], a[0:7], v17
    ds_read_b128 v[44:47], v16 offset:4096
    v_smfmac_f32_16x16x64_bf16 v[72:75], v[28:31], a[80:87], v17
    ds_read_b128 v[48:51], v16 offset:5120
    s_waitcnt lgkmcnt(4)
    v_smfmac_f32_16x16x64_bf16 v[68:71], v[32:35], a[8:15], v17
    ds_read_b128 v[52:55], v16 offset:6144
    v_smfmac_f32_16x16x64_bf16 v[72:75], v[32:35], a[88:95], v17
    ds_read_b128 v[56:59], v16 offset:7168
    s_waitcnt lgkmcnt(5)
    v_smfmac_f32_16x16x64_bf16 v[68:71], v[36:39], a[16:23], v17
    ds_read_b128 v[60:63], v16 offset:8192
    v_smfmac_f32_16x16x64_bf16 v[72:75], v[36:39], a[96:103], v17
    ds_read_b128 v[64:67], v16 offset:9216
    s_waitcnt lgkmcnt(6)
    v_smfmac_f32_16x16x64_bf16 v[68:71], v[40:43], a[24:31], v17
    v_smfmac_f32_16x16x64_bf16 v[72:75], v[40:43], a[104:111], v17
    s_waitcnt lgkmcnt(5)
    v_smfmac_f32_16x16x64_bf16 v[68:71], v[44:47], a[32:39], v17
    v_smfmac_f32_16x16x64_bf16 v[72:75], v[44:47], a[112:119], v17
    s_waitcnt lgkmcnt(4)
    v_smfmac_f32_16x16x64_bf16 v[68:71], v[48:51], a[40:47], v17
    s_waitcnt lgkmcnt(3)
    v_smfmac_f32_16x16x64_bf16 v[68:71], v[52:55], a[48:55], v17
    s_waitcnt lgkmcnt(2)
    v_smfmac_f32_16x16x64_bf16 v[68:71], v[56:59], a[56:63], v17
    s_waitcnt lgkmcnt(1)
    v_smfmac_f32_16x16x64_bf16 v[68:71], v[60:63], a[64:71], v17
    s_waitcnt lgkmcnt(0)
    v_smfmac_f32_16x16x64_bf16 v[68:71], v[64:67], a[72:79], v17
L_redo_18:
    v_smfmac_f32_16x16x64_bf16 v[72:75], v[48:51], a[120:127], v17
    v_smfmac_f32_16x16x64_bf16 v[72:75], v[52:55], a[128:135], v17
    buffer_store_dword v20, v21, s[4:7], s38 offen offset:0
    v_smfmac_f32_16x16x64_bf16 v[72:75], v[56:59], a[136:143], v17
    v_add_f32 v68, v68, v70
    v_add_f32 v69, v69, v71
    v_smfmac_f32_16x16x64_bf16 v[72:75], v[60:63], a[144:151], v17
    v_cmp_u_f32 vcc, v68, v69
    v_cvt_pk_bf16_f32 v132, v68, v69
    v_smfmac_f32_16x16x64_bf16 v[72:75], v[64:67], a[152:159], v17
    s_cbranch_vccnz L_nan_20
L_cont_21:
    buffer_store_dword v132, v134, s[4:7], s41 offen offset:0
    s_nop 5
    v_pk_add_f32 v[72:73], v[72:73], v[74:75]
    v_cvt_pk_bf16_f32 v133, v72, v73
    buffer_store_dword v133, v134, s[4:7], s41 offen offset:1024
    buffer_store_dword v20, v21, s[4:7], s38 offen offset:32
    ds_read_b128 v[84:87], v11 offset:0
    ds_read_b128 v[88:91], v11 offset:2048
    ds_read_b128 v[92:95], v12 offset:0
    ds_read_b128 v[96:99], v12 offset:2048
    s_cmp_eq_u32 s37, 63
    s_cbranch_scc1 L_end_22
    s_cmp_lg_u32 s55, 0
    s_cbranch_scc1 L_an_23x
    buffer_load_dword v139, v142, s[4:7], s38 offen sc1
    buffer_load_dword v139, v142, s[4:7], s38 offen sc1
    buffer_load_dword v139, v142, s[4:7], s38 offen sc1
    buffer_load_dword v139, v142, s[4:7], s38 offen sc1
    buffer_load_dword v139, v142, s[4:7], s38 offen sc1
    buffer_load_dword v139, v142, s[4:7], s38 offen sc1
L_sp_24:
    s_waitcnt vmcnt(5)
    v_cmp_ge_u32 vcc, s37, v139
    buffer_load_dword v139, v142, s[4:7], s38 offen sc1
    s_sub_u32 s36, s36, 1
    s_cbranch_scc1 L_exit
    s_cbranch_vccz L_sp_24x
    s_waitcnt vmcnt(5)
    v_cmp_ge_u32 vcc, s37, v139
    buffer_load_dword v139, v142, s[4:7], s38 offen sc1
    s_cbranch_vccz L_sp_24x
    s_waitcnt vmcnt(5)
    v_cmp_ge_u32 vcc, s37, v139
    buffer_load_dword v139, v142, s[4:7], s38 offen sc1
    s_cbranch_vccz L_sp_24x
    s_waitcnt vmcnt(5)
    v_cmp_ge_u32 vcc, s37, v139
    buffer_load_dword v139, v142, s[4:7], s38 offen sc1
    s_cbranch_vccnz L_sp_24
L_sp_24x:
L_an_23x:
    s_barrier
    s_lshl_b32 s90, s32, 10
    s_add_u32 m0, s90, s47
    s_waitcnt lgkmcnt(2)
    v_mfma_f32_16x16x32_bf16 v[108:111], a[0:3], v[84:87], 0
    ds_read_b128 v[100:103], v11 offset:4096
    s_add_u32 s51, s37, 3
    v_mfma_f32_16x16x32_bf16 v[112:115], a[0:3], v[88:91], 0
    ds_read_b128 v[104:107], v11 offset:6144
    s_and_b32 s50, s51, 3
    v_mfma_f32_16x16x32_bf16 v[116:119], a[80:83], v[84:87], 0
    buffer_load_dwordx4 v[148:151], v146, s[4:7], s43 offen offset:0 sc1
    buffer_load_dwordx4 v[152:155], v146, s[4:7], s43 offen offset:1024 sc1
    v_mfma_f32_16x16x32_bf16 v[120:123], a[80:83], v[88:91], 0
    s_waitcnt lgkmcnt(2)
    s_mul_i32 s50, s50, 114688
    v_mfma_f32_16x16x32_bf16 v[108:111], a[4:7], v[92:95], v[108:111]
    ds_read_b128 v[84:87], v12 offset:4096
    s_add_u32 s50, s50, 65536
    v_mfma_f32_16x16x32_bf16 v[112:115], a[4:7], v[96:99], v[112:115]
    ds_read_b128 v[88:91], v12 offset:6144
    s_add_u32 s44, s38, s50
    v_mfma_f32_16x16x32_bf16 v[116:119], a[84:87], v[92:95], v[116:119]
    s_cmp_lt_i32 s60, 0
    s_cselect_b32 s54, s38, s54
    buffer_load_dwordx4 v[156:159], v144, s[4:7], s54 offen offset:0 sc1
    buffer_load_dwordx4 v[160:163], v144, s[4:7], s54 offen offset:1024 sc1
    v_mfma_f32_16x16x32_bf16 v[120:123], a[84:87], v[96:99], v[120:123]
    s_waitcnt lgkmcnt(2)
    s_add_u32 s45, s44, s56
    v_mfma_f32_16x16x32_bf16 v[108:111], a[8:11], v[100:103], v[108:111]
    ds_read_b128 v[92:95], v11 offset:8192
    s_add_u32 s37, s37, 1
    v_mfma_f32_16x16x32_bf16 v[112:115], a[8:11], v[104:107], v[112:115]
    ds_read_b128 v[96:99], v11 offset:10240
    s_mov_b32 s52, 0
    v_mfma_f32_16x16x32_bf16 v[116:119], a[88:91], v[100:103], v[116:119]
    s_and_b32 s50, s37, 3
    s_mul_i32 s51, s50, 114688
    v_mfma_f32_16x16x32_bf16 v[120:123], a[88:91], v[104:107], v[120:123]
    s_waitcnt lgkmcnt(2)
    s_add_u32 s41, s38, s51
    v_mfma_f32_16x16x32_bf16 v[108:111], a[12:15], v[84:87], v[108:111]
    ds_read_b128 v[100:103], v12 offset:8192
    v_mfma_f32_16x16x32_bf16 v[112:115], a[12:15], v[88:91], v[112:115]
    ds_read_b128 v[104:107], v12 offset:10240
    v_mfma_f32_16x16x32_bf16 v[116:119], a[92:95], v[84:87], v[116:119]
    buffer_load_dwordx4 v[248:251], v137, s[24:27], s57 offen offset:0
    buffer_load_dwordx4 v[248:251], v137, s[24:27], s57 offen offset:1024
    v_mfma_f32_16x16x32_bf16 v[120:123], a[92:95], v[88:91], v[120:123]
    s_waitcnt lgkmcnt(2)
    v_mfma_f32_16x16x32_bf16 v[108:111], a[16:19], v[92:95], v[108:111]
    buffer_store_dword v20, v140, s[4:7], 0 offen sc1
    ds_read_b128 v[84:87], v11 offset:12288
    v_mfma_f32_16x16x32_bf16 v[112:115], a[16:19], v[96:99], v[112:115]
    ds_read_b128 v[88:91], v11 offset:14336
    v_mfma_f32_16x16x32_bf16 v[116:119], a[96:99], v[92:95], v[116:119]
    v_mfma_f32_16x16x32_bf16 v[120:123], a[96:99], v[96:99], v[120:123]
    s_waitcnt lgkmcnt(2)
    v_mfma_f32_16x16x32_bf16 v[108:111], a[20:23], v[100:103], v[108:111]
    ds_read_b128 v[92:95], v12 offset:12288
    v_mfma_f32_16x16x32_bf16 v[112:115], a[20:23], v[104:107], v[112:115]
    ds_read_b128 v[96:99], v12 offset:14336
    v_mfma_f32_16x16x32_bf16 v[116:119], a[100:103], v[100:103], v[116:119]
    buffer_store_dword v20, v141, s[4:7], 0 offen sc1
    s_waitcnt vmcnt(4)
    s_cmp_lt_i32 s60, -327680
    s_cbranch_scc1 L_fw_25c
L_fw_25:
    buffer_store_dwordx4 v[148:151], v143, s[4:7], s53 offen offset:0 sc1
    buffer_store_dwordx4 v[152:155], v143, s[4:7], s53 offen offset:1024 sc1
    v_mfma_f32_16x16x32_bf16 v[120:123], a[100:103], v[104:107], v[120:123]
    s_waitcnt lgkmcnt(2)
    v_mfma_f32_16x16x32_bf16 v[108:111], a[24:27], v[84:87], v[108:111]
    ds_read_b128 v[100:103], v11 offset:16384
    v_mfma_f32_16x16x32_bf16 v[112:115], a[24:27], v[88:91], v[112:115]
    ds_read_b128 v[104:107], v11 offset:18432
    v_mfma_f32_16x16x32_bf16 v[116:119], a[104:107], v[84:87], v[116:119]
    v_mfma_f32_16x16x32_bf16 v[120:123], a[104:107], v[88:91], v[120:123]
    s_waitcnt lgkmcnt(2)
    v_mfma_f32_16x16x32_bf16 v[108:111], a[28:31], v[92:95], v[108:111]
    ds_read_b128 v[84:87], v12 offset:16384
    v_mfma_f32_16x16x32_bf16 v[112:115], a[28:31], v[96:99], v[112:115]
    ds_read_b128 v[88:91], v12 offset:18432
    v_mfma_f32_16x16x32_bf16 v[116:119], a[108:111], v[92:95], v[116:119]
    buffer_store_dword v22, v135, s[4:7], s42 offen offset:0
    buffer_store_dword v22, v135, s[4:7], s42 offen offset:1024
    v_mfma_f32_16x16x32_bf16 v[120:123], a[108:111], v[96:99], v[120:123]
    s_waitcnt lgkmcnt(2)
    v_mfma_f32_16x16x32_bf16 v[108:111], a[32:35], v[100:103], v[108:111]
    ds_read_b128 v[92:95], v11 offset:20480
    v_mfma_f32_16x16x32_bf16 v[112:115], a[32:35], v[104:107], v[112:115]
    ds_read_b128 v[96:99], v11 offset:22528
    v_mfma_f32_16x16x32_bf16 v[116:119], a[112:115], v[100:103], v[116:119]
    buffer_load_dwordx4 v10, s[24:27], s46 offen offset:0 lds
    s_add_u32 m0, m0, 3968
    v_mfma_f32_16x16x32_bf16 v[120:123], a[112:115], v[104:107], v[120:123]
    s_waitcnt lgkmcnt(2)
    v_mfma_f32_16x16x32_bf16 v[108:111], a[36:39], v[84:87], v[108:111]
    ds_read_b128 v[100:103], v12 offset:20480
    v_mfma_f32_16x16x32_bf16 v[112:115], a[36:39], v[88:91], v[112:115]
    ds_read_b128 v[104:107], v12 offset:22528
    v_mfma_f32_16x16x32_bf16 v[116:119], a[116:119], v[84:87], v[116:119]
    buffer_load_dwordx4 v10, s[24:27], s46 offen offset:128 lds
    s_add_u32 m0, m0, 3968
    v_mfma_f32_16x16x32_bf16 v[120:123], a[116:119], v[88:91], v[120:123]
    s_waitcnt lgkmcnt(2)
    v_mfma_f32_16x16x32_bf16 v[108:111], a[40:43], v[92:95], v[108:111]
    ds_read_b128 v[84:87], v11 offset:24576
    v_mfma_f32_16x16x32_bf16 v[112:115], a[40:43], v[96:99], v[112:115]
    ds_read_b128 v[88:91], v11 offset:26624
    v_mfma_f32_16x16x32_bf16 v[116:119], a[120:123], v[92:95], v[116:119]
    buffer_load_dwordx4 v10, s[24:27], s46 offen offset:256 lds
    s_add_u32 m0, m0, 3968
    v_mfma_f32_16x16x32_bf16 v[120:123], a[120:123], v[96:99], v[120:123]
    s_waitcnt lgkmcnt(2)
    v_mfma_f32_16x16x32_bf16 v[108:111], a[44:47], v[100:103], v[108:111]
    ds_read_b128 v[92:95], v12 offset:24576
    v_mfma_f32_16x16x32_bf16 v[112:115], a[44:47], v[104:107], v[112:115]
    ds_read_b128 v[96:99], v12 offset:26624
    v_mfma_f32_16x16x32_bf16 v[116:119], a[124:127], v[100:103], v[116:119]
    buffer_load_dwordx4 v10, s[24:27], s46 offen offset:384 lds
    s_add_u32 m0, m0, 3968
    v_mfma_f32_16x16x32_bf16 v[120:123], a[124:127], v[104:107], v[120:123]
    s_waitcnt lgkmcnt(2)
    v_mfma_f32_16x16x32_bf16 v[108:111], a[48:51], v[84:87], v[108:111]
    ds_read_b128 v[100:103], v11 offset:28672
    v_mfma_f32_16x16x32_bf16 v[112:115], a[48:51], v[88:91], v[112:115]
    ds_read_b128 v[104:107], v11 offset:30720
    v_mfma_f32_16x16x32_bf16 v[116:119], a[128:131], v[84:87], v[116:119]
    buffer_load_dwordx4 v10, s[24:27], s46 offen offset:512 lds
    s_add_u32 m0, m0, 3968
    v_mfma_f32_16x16x32_bf16 v[120:123], a[128:131], v[88:91], v[120:123]
    s_waitcnt lgkmcnt(2)
    v_mfma_f32_16x16x32_bf16 v[108:111], a[52:55], v[92:95], v[108:111]
    ds_read_b128 v[84:87], v12 offset:28672
    v_mfma_f32_16x16x32_bf16 v[112:115], a[52:55], v[96:99], v[112:115]
    ds_read_b128 v[88:91], v12 offset:30720
    v_mfma_f32_16x16x32_bf16 v[116:119], a[132:135], v[92:95], v[116:119]
    buffer_load_dwordx4 v10, s[24:27], s46 offen offset:640 lds
    s_add_u32 m0, m0, 3968
    v_mfma_f32_16x16x32_bf16 v[120:123], a[132:135], v[96:99], v[120:123]
    s_waitcnt lgkmcnt(2)
    v_mfma_f32_16x16x32_bf16 v[108:111], a[56:59], v[100:103], v[108:111]
    ds_read_b128 v[92:95], v11 offset:32768
    v_mfma_f32_16x16x32_bf16 v[112:115], a[56:59], v[104:107], v[112:115]
    ds_read_b128 v[96:99], v11 offset:34816
    v_mfma_f32_16x16x32_bf16 v[116:119], a[136:139], v[100:103], v[116:119]
    buffer_load_dwordx4 v10, s[24:27], s46 offen offset:768 lds
    s_add_u32 m0, m0, 3968
    v_mfma_f32_16x16x32_bf16 v[120:123], a[136:139], v[104:107], v[120:123]
    s_waitcnt lgkmcnt(2)
    v_mfma_f32_16x16x32_bf16 v[108:111], a[60:63], v[84:87], v[108:111]
    ds_read_b128 v[100:103], v12 offset:32768
    v_mfma_f32_16x16x32_bf16 v[112:115], a[60:63], v[88:91], v[112:115]
    ds_read_b128 v[104:107], v12 offset:34816
    v_mfma_f32_16x16x32_bf16 v[116:119], a[140:143], v[84:87], v[116:119]
    buffer_load_dwordx4 v10, s[24:27], s46 offen offset:896 lds
    s_add_u32 m0, m0, 3968
    v_mfma_f32_16x16x32_bf16 v[120:123], a[140:143], v[88:91], v[120:123]
    s_waitcnt lgkmcnt(2)
    v_mfma_f32_16x16x32_bf16 v[108:111], a[64:67], v[92:95], v[108:111]
    ds_read_b128 v[84:87], v11 offset:36864
    v_mfma_f32_16x16x32_bf16 v[112:115], a[64:67], v[96:99], v[112:115]
    ds_read_b128 v[88:91], v11 offset:38912
    v_mfma_f32_16x16x32_bf16 v[116:119], a[144:147], v[92:95], v[116:119]
    buffer_load_dwordx4 v10, s[24:27], s46 offen offset:1024 lds
    s_add_u32 m0, m0, 3968
    v_mfma_f32_16x16x32_bf16 v[120:123], a[144:147], v[96:99], v[120:123]
    s_waitcnt lgkmcnt(2)
    v_mfma_f32_16x16x32_bf16 v[108:111], a[68:71], v[100:103], v[108:111]
    ds_read_b128 v[92:95], v12 offset:36864
    v_mfma_f32_16x16x32_bf16 v[112:115], a[68:71], v[104:107], v[112:115]
    ds_read_b128 v[96:99], v12 offset:38912
    v_mfma_f32_16x16x32_bf16 v[116:119], a[148:151], v[100:103], v[116:119]
    buffer_load_dwordx4 v10, s[24:27], s46 offen offset:1152 lds
    v_mfma_f32_16x16x32_bf16 v[120:123], a[148:151], v[104:107], v[120:123]
    s_waitcnt lgkmcnt(0)
    v_mfma_f32_16x16x32_bf16 v[108:111], a[72:75], v[84:87], v[108:111]
    v_add_u32 v11, s49, v11
    v_mfma_f32_16x16x32_bf16 v[112:115], a[72:75], v[88:91], v[112:115]
    v_add_u32 v12, s49, v12
    v_mfma_f32_16x16x32_bf16 v[108:111], a[76:79], v[92:95], v[108:111]
    s_sub_u32 s47, s47, s49
    v_mfma_f32_16x16x32_bf16 v[112:115], a[76:79], v[96:99], v[112:115]
    s_sub_u32 s49, 0, s49
    v_mfma_f32_16x16x32_bf16 v[116:119], a[152:155], v[84:87], v[116:119]
    v_mfma_f32_16x16x32_bf16 v[120:123], a[152:155], v[88:91], v[120:123]
    v_mfma_f32_16x16x32_bf16 v[116:119], a[156:159], v[92:95], v[116:119]
    v_mfma_f32_16x16x32_bf16 v[120:123], a[156:159], v[96:99], v[120:123]
    v_cvt_pk_bf16_f32 v124, v108, v109
    v_cvt_pk_bf16_f32 v125, v110, v111
    v_cvt_pk_bf16_f32 v126, v112, v113
    v_cvt_pk_bf16_f32 v127, v114, v115
    s_nop 0
    v_permlane16_swap_b32 v124, v126
    v_permlane16_swap_b32 v125, v127
    v_cvt_pk_bf16_f32 v128, v116, v117
    v_cvt_pk_bf16_f32 v129, v118, v119
    v_cvt_pk_bf16_f32 v130, v120, v121
    v_cvt_pk_bf16_f32 v131, v122, v123
    s_nop 0
    v_permlane16_swap_b32 v128, v130
    v_permlane16_swap_b32 v129, v131
    buffer_store_dwordx4 v[124:127], v19, s[4:7], s44 offen
    buffer_store_dwordx4 v[128:131], v19, s[4:7], s45 offen
    s_waitcnt vmcnt(18)
    s_cmp_lt_i32 s60, 0
    s_cbranch_scc1 L_fin_26
    v_mfma_f32_16x16x32_bf16 v[164:167], a[160:163], v[156:159], 0
    v_mfma_f32_16x16x32_bf16 v[168:171], a[160:163], v[160:163], 0
    s_nop 4
    v_cndmask_b32 v166, v164, v165, s[58:59]
    s_nop 1
    v_cndmask_b32 v170, v168, v169, s[58:59]
    v_cndmask_b32 v167, v165, v164, s[58:59]
    v_cndmask_b32 v171, v169, v168, s[58:59]
    s_nop 0
    v_add_f32_dpp v167, v166, v167 row_ror:8 row_mask:0xf bank_mask:0xf
    v_add_f32_dpp v171, v170, v171 row_ror:8 row_mask:0xf bank_mask:0xf
    v_cvt_pk_bf16_f32 v167, v167, v167
    v_cvt_pk_bf16_f32 v171, v171, v171
    buffer_store_short v167, v145, s[28:31], s60 offen offset:0
    buffer_store_short v171, v145, s[28:31], s60 offen offset:32
L_fin_26:
    s_branch L_v_loop_f
L_end_22:
    s_cmp_lt_i32 s60, 0
    s_cselect_b32 s54, s38, s54
    buffer_load_dwordx4 v[156:159], v144, s[4:7], s54 offen offset:0 sc1
    buffer_load_dwordx4 v[160:163], v144, s[4:7], s54 offen offset:1024 sc1
    s_waitcnt vmcnt(0) lgkmcnt(0)
    s_cmp_lt_i32 s60, 0
    s_cbranch_scc1 L_fin_27
    v_mfma_f32_16x16x32_bf16 v[164:167], a[160:163], v[156:159], 0
    v_mfma_f32_16x16x32_bf16 v[168:171], a[160:163], v[160:163], 0
    s_nop 4
    v_cndmask_b32 v166, v164, v165, s[58:59]
    s_nop 1
    v_cndmask_b32 v170, v168, v169, s[58:59]
    v_cndmask_b32 v167, v165, v164, s[58:59]
    v_cndmask_b32 v171, v169, v168, s[58:59]
    s_nop 0
    v_add_f32_dpp v167, v166, v167 row_ror:8 row_mask:0xf bank_mask:0xf
    v_add_f32_dpp v171, v170, v171 row_ror:8 row_mask:0xf bank_mask:0xf
    v_cvt_pk_bf16_f32 v167, v167, v167
    v_cvt_pk_bf16_f32 v171, v171, v171
    buffer_store_short v167, v145, s[28:31], s60 offen offset:0
    buffer_store_short v171, v145, s[28:31], s60 offen offset:32
L_fin_27:
    s_waitcnt vmcnt(0)
    s_cmp_lg_u32 s55, 0
    s_cbranch_scc1 L_wb_28
    buffer_wbl2 sc1
    s_waitcnt vmcnt(0)
L_wb_28:
    s_endpgm
L_nan_20:
    s_cmp_eq_u32 s52, 1
    s_cbranch_scc1 L_cont_21
    v_lshlrev_b32 v1, 4, v0
L_nan_20r:
    s_mov_b32 s90, s41
    v_mov_b32 v2, 0
    buffer_load_dwordx4 v[28:31], v1, s[4:7], s90 offen sc1
    s_add_u32 s90, s90, 1024
    buffer_load_dwordx4 v[32:35], v1, s[4:7], s90 offen sc1
    s_add_u32 s90, s90, 1024
    buffer_load_dwordx4 v[36:39], v1, s[4:7], s90 offen sc1
    s_add_u32 s90, s90, 1024
    buffer_load_dwordx4 v[40:43], v1, s[4:7], s90 offen sc1
    s_add_u32 s90, s90, 1024
    buffer_load_dwordx4 v[44:47], v1, s[4:7], s90 offen sc1
    s_add_u32 s90, s90, 1024
    buffer_load_dwordx4 v[48:51], v1, s[4:7], s90 offen sc1
    s_add_u32 s90, s90, 1024
    buffer_load_dwordx4 v[52:55], v1, s[4:7], s90 offen sc1
    s_add_u32 s90, s90, 1024
    buffer_load_dwordx4 v[56:59], v1, s[4:7], s90 offen sc1
    s_add_u32 s90, s90, 1024
    buffer_load_dwordx4 v[60:63], v1, s[4:7], s90 offen sc1
    s_add_u32 s90, s90, 1024
    buffer_load_dwordx4 v[64:67], v1, s[4:7], s90 offen sc1
    s_add_u32 s90, s90, 1024
    s_sub_u32 s36, s36, 1
    s_cbranch_scc1 L_exit
    s_waitcnt vmcnt(0) lgkmcnt(0)
    v_max3_u32 v2, v2, v28, v29
    v_max3_u32 v2, v2, v30, v31
    v_max3_u32 v2, v2, v32, v33
    v_max3_u32 v2, v2, v34, v35
    v_max3_u32 v2, v2, v36, v37
    v_max3_u32 v2, v2, v38, v39
    v_max3_u32 v2, v2, v40, v41
    v_max3_u32 v2, v2, v42, v43
    v_max3_u32 v2, v2, v44, v45
    v_max3_u32 v2, v2, v46, v47
    v_max3_u32 v2, v2, v48, v49
    v_max3_u32 v2, v2, v50, v51
    v_max3_u32 v2, v2, v52, v53
    v_max3_u32 v2, v2, v54, v55
    v_max3_u32 v2, v2, v56, v57
    v_max3_u32 v2, v2, v58, v59
    v_max3_u32 v2, v2, v60, v61
    v_max3_u32 v2, v2, v62, v63
    v_max3_u32 v2, v2, v64, v65
    v_max3_u32 v2, v2, v66, v67
    v_cmp_eq_u32 vcc, -1, v2
    s_cbranch_vccnz L_nan_20r
    s_mov_b32 s52, 1
    v_mov_b32 v68, 0
    v_mov_b32 v69, 0
    v_mov_b32 v70, 0
    v_mov_b32 v71, 0
    v_mov_b32 v72, 0
    v_mov_b32 v73, 0
    v_mov_b32 v74, 0
    v_mov_b32 v75, 0
    v_smfmac_f32_16x16x64_bf16 v[68:71], v[28:31], a[0:7], v17
    s_nop 0
    v_smfmac_f32_16x16x64_bf16 v[72:75], v[28:31], a[80:87], v17
    v_smfmac_f32_16x16x64_bf16 v[68:71], v[32:35], a[8:15], v17
    v_smfmac_f32_16x16x64_bf16 v[72:75], v[32:35], a[88:95], v17
    v_smfmac_f32_16x16x64_bf16 v[68:71], v[36:39], a[16:23], v17
    v_smfmac_f32_16x16x64_bf16 v[72:75], v[36:39], a[96:103], v17
    v_smfmac_f32_16x16x64_bf16 v[68:71], v[40:43], a[24:31], v17
    v_smfmac_f32_16x16x64_bf16 v[72:75], v[40:43], a[104:111], v17
    v_smfmac_f32_16x16x64_bf16 v[68:71], v[44:47], a[32:39], v17
    v_smfmac_f32_16x16x64_bf16 v[72:75], v[44:47], a[112:119], v17
    v_smfmac_f32_16x16x64_bf16 v[68:71], v[48:51], a[40:47], v17
    v_smfmac_f32_16x16x64_bf16 v[68:71], v[52:55], a[48:55], v17
    v_smfmac_f32_16x16x64_bf16 v[68:71], v[56:59], a[56:63], v17
    v_smfmac_f32_16x16x64_bf16 v[68:71], v[60:63], a[64:71], v17
    v_smfmac_f32_16x16x64_bf16 v[68:71], v[64:67], a[72:79], v17
    s_nop 2
    s_branch L_redo_18
L_fw_25c:
    v_mov_b32 v148, -1
    v_mov_b32 v149, -1
    v_mov_b32 v150, -1
    v_mov_b32 v151, -1
    v_mov_b32 v152, -1
    v_mov_b32 v153, -1
    v_mov_b32 v154, -1
    v_mov_b32 v155, -1
    s_add_u32 s53, s53, 1310720
    s_branch L_fw_25
L_wo_f:
    s_mov_b32 s12, s80
    s_and_b32 s13, s81, 0xffff
    s_mov_b32 s14, 7864320
    s_mov_b32 s15, 0x20000
    s_mov_b32 s16, s72
    s_and_b32 s17, s73, 0xffff
    s_mov_b32 s18, 10240
    s_mov_b32 s19, 0x20000
    s_sub_u32 s40, s35, 18
    v_and_b32 v1, 15, v0
    v_lshrrev_b32 v2, 4, v0
    v_lshrrev_b32 v3, 3, v0
    v_and_b32 v4, 7, v0
    v_and_b32 v6, 2, v3
    v_xor_b32 v6, v6, v4
    v_lshlrev_b32 v6, 4, v6
    v_mul_u32_u24 v7, 1280, v3
    s_lshl_b32 s90, s34, 2
    s_add_u32 s90, s90, s32
    s_mul_i32 s90, s90, 245760
    s_lshl_b32 s91, s40, 7
    s_add_u32 s90, s90, s91
    v_add3_u32 v180, v6, v7, s90
    v_xor_b32 v181, 64, v180
    s_mul_i32 s90, s40, 32768
    s_lshl_b32 s91, s32, 11
    s_add_u32 s90, s90, s91
    s_lshr_b32 s91, s32, 1
    s_mul_i32 s91, s91, 0
    s_xor_b32 s91, s91, s34
    v_mul_u32_u24 v7, 0, v2
    v_xor_b32 v7, s91, v7
    v_lshlrev_b32 v6, 4, v1
    v_lshl_add_u32 v7, v7, 8, v6
    v_lshl_add_u32 v7, v2, 13, v7
    v_add_u32 v14, s90, v7
    v_lshlrev_b32 v12, 4, v0
    v_lshlrev_b32 v13, 2, v0
    v_add_u32 v46, s90, v13
    s_xor_b32 s92, s91, 0
    s_lshl_b32 s92, s92, 8
    s_add_u32 s60, s92, 0
    s_xor_b32 s92, s91, 0
    s_lshl_b32 s92, s92, 8
    s_add_u32 s61, s92, 8192
    s_xor_b32 s92, s91, 0
    s_lshl_b32 s92, s92, 8
    s_add_u32 s62, s92, 16384
    s_xor_b32 s92, s91, 0
    s_lshl_b32 s92, s92, 8
    s_add_u32 s63, s92, 24576
    v_cmp_gt_u32 vcc, 2, v2
    v_mov_b32 v9, 2146435072
    s_nop 0
    v_cndmask_b32 v14, v9, v14, vcc
    s_lshl_b32 s92, s40, 7
    s_lshl_b32 s93, s32, 2
    s_add_u32 s92, s92, s93
    s_add_u32 s92, s92, 460800
    v_mov_b32 v244, s92
    v_cmp_eq_u32 vcc, 0, v0
    v_mov_b32 v9, 2146435072
    s_nop 0
    v_cndmask_b32 v244, v9, v244, vcc
    s_lshl_b32 s92, s32, 7
    s_add_u32 s92, s92, 462336
    v_min_u32 v3, 5, v0
    v_lshl_add_u32 v245, v3, 2, s92
    s_lshl_b32 s90, s40, 2
    s_add_u32 s90, s90, s32
    s_lshl_b32 s91, s90, 8
    v_add_u32 v17, s91, v6
    v_cmp_eq_u32 vcc, 0, v2
    v_mov_b32 v9, 2146435072
    s_nop 0
    v_cndmask_b32 v17, v9, v17, vcc
    v_lshrrev_b32 v3, 2, v1
    v_and_b32 v7, 1, v1
    v_lshl_or_b32 v4, v3, 1, v7
    v_mul_u32_u24 v4, 1280, v4
    v_and_b32 v5, 2, v1
    v_lshl_add_u32 v4, v5, 1, v4
    s_lshl_b32 s91, s90, 5
    v_add_u32 v4, s91, v4
    v_lshlrev_b32 v6, 6, v3
    v_lshl_add_u32 v6, v7, 5, v6
    v_lshl_add_u32 v6, v2, 3, v6
    v_lshl_add_u32 v6, v5, 1, v6
    s_mul_i32 s92, s32, 1152
    s_add_u32 s92, s92, 122880
    v_add_u32 v18, s92, v6
    buffer_load_dword v164, v4, s[16:19], 0 offen offset:0
    buffer_load_dword v165, v4, s[16:19], 0 offen offset:8
    buffer_load_dword v166, v4, s[16:19], 0 offen offset:16
    buffer_load_dword v167, v4, s[16:19], 0 offen offset:24
    v_mov_b32 v168, -1
    v_mov_b32 v169, -1
    v_mov_b32 v170, -1
    v_mov_b32 v171, -1
    s_mul_i32 s90, s32, 24576
    s_mov_b32 m0, s90
    s_mov_b32 s91, 0
    buffer_load_dwordx4 v180, s[12:15], s91 offen nt lds
    s_add_u32 m0, m0, 1024
    s_add_u32 s91, s91, 10240
    buffer_load_dwordx4 v181, s[12:15], s91 offen nt lds
    s_add_u32 m0, m0, 1024
    s_add_u32 s91, s91, 10240
    buffer_load_dwordx4 v180, s[12:15], s91 offen nt lds
    s_add_u32 m0, m0, 1024
    s_add_u32 s91, s91, 10240
    buffer_load_dwordx4 v181, s[12:15], s91 offen nt lds
    s_add_u32 m0, m0, 1024
    s_add_u32 s91, s91, 10240
    buffer_load_dwordx4 v180, s[12:15], s91 offen nt lds
    s_add_u32 m0, m0, 1024
    s_add_u32 s91, s91, 10240
    buffer_load_dwordx4 v181, s[12:15], s91 offen nt lds
    s_add_u32 m0, m0, 1024
    s_add_u32 s91, s91, 10240
    buffer_load_dwordx4 v180, s[12:15], s91 offen nt lds
    s_add_u32 m0, m0, 1024
    s_add_u32 s91, s91, 10240
    buffer_load_dwordx4 v181, s[12:15], s91 offen nt lds
    s_add_u32 m0, m0, 1024
    s_add_u32 s91, s91, 10240
    buffer_load_dwordx4 v180, s[12:15], s91 offen nt lds
    s_add_u32 m0, m0, 1024
    s_add_u32 s91, s91, 10240
    buffer_load_dwordx4 v181, s[12:15], s91 offen nt lds
    s_add_u32 m0, m0, 1024
    s_add_u32 s91, s91, 10240
    buffer_load_dwordx4 v180, s[12:15], s91 offen nt lds
    s_add_u32 m0, m0, 1024
    s_add_u32 s91, s91, 10240
    buffer_load_dwordx4 v181, s[12:15], s91 offen nt lds
    s_add_u32 m0, m0, 1024
    s_add_u32 s91, s91, 10240
    buffer_load_dwordx4 v180, s[12:15], s91 offen nt lds
    s_add_u32 m0, m0, 1024
    s_add_u32 s91, s91, 10240
    buffer_load_dwordx4 v181, s[12:15], s91 offen nt lds
    s_add_u32 m0, m0, 1024
    s_add_u32 s91, s91, 10240
    buffer_load_dwordx4 v180, s[12:15], s91 offen nt lds
    s_add_u32 m0, m0, 1024
    s_add_u32 s91, s91, 10240
    buffer_load_dwordx4 v181, s[12:15], s91 offen nt lds
    s_add_u32 m0, m0, 1024
    s_add_u32 s91, s91, 10240
    buffer_load_dwordx4 v180, s[12:15], s91 offen nt lds
    s_add_u32 m0, m0, 1024
    s_add_u32 s91, s91, 10240
    buffer_load_dwordx4 v181, s[12:15], s91 offen nt lds
    s_add_u32 m0, m0, 1024
    s_add_u32 s91, s91, 10240
    buffer_load_dwordx4 v180, s[12:15], s91 offen nt lds
    s_add_u32 m0, m0, 1024
    s_add_u32 s91, s91, 10240
    buffer_load_dwordx4 v181, s[12:15], s91 offen nt lds
    s_add_u32 m0, m0, 1024
    s_add_u32 s91, s91, 10240
    buffer_load_dwordx4 v180, s[12:15], s91 offen nt lds
    s_add_u32 m0, m0, 1024
    s_add_u32 s91, s91, 10240
    buffer_load_dwordx4 v181, s[12:15], s91 offen nt lds
    s_add_u32 m0, m0, 1024
    s_add_u32 s91, s91, 10240
    buffer_load_dwordx4 v180, s[12:15], s91 offen nt lds
    s_add_u32 m0, m0, 1024
    s_add_u32 s91, s91, 10240
    buffer_load_dwordx4 v181, s[12:15], s91 offen nt lds
    s_waitcnt vmcnt(24)
    v_min_u32 v164, -2, v164
    v_min_u32 v165, -2, v165
    v_min_u32 v166, -2, v166
    v_min_u32 v167, -2, v167
    v_and_b32 v7, 2, v1
    v_cmp_ne_u32 vcc, 0, v7
    v_mov_b32 v5, 0x4444
    v_mov_b32 v6, 0xeeee
    v_cndmask_b32 v10, v5, v6, vcc
    v_mov_b32 v5, 0xe484
    v_mov_b32 v6, 0xee9e
    v_cndmask_b32 v7, v5, v6, vcc
    v_mov_b32 v5, 0x84e4
    v_mov_b32 v6, 0x9eee
    v_cndmask_b32 v8, v5, v6, vcc
    v_cmp_gt_u32 vcc, 2, v2
    s_nop 1
    v_cndmask_b32 v11, v8, v7, vcc
    v_mov_b32 v84, 1065369472
    v_mov_b32 v85, 1065369472
    v_mov_b32 v86, 1065369472
    v_mov_b32 v87, 0
    v_mov_b32 v88, 1065369472
    v_mov_b32 v89, 1065369472
    v_mov_b32 v90, 1065369472
    v_mov_b32 v91, 0
    v_mov_b32 v51, 0
    v_mov_b32 v55, 0
    v_mov_b32 v59, 0
    v_mov_b32 v63, 0
    v_mov_b32 v67, 0
    v_mov_b32 v71, 0
    v_mov_b32 v75, 0
    v_mov_b32 v79, 0
    v_mov_b32 v210, 0
    v_mov_b32 v211, 0
    v_mov_b32 v218, 0
    v_mov_b32 v219, 0
    v_and_b32 v7, 1, v1
    v_cmp_ne_u32 vcc, 0, v7
    v_mov_b32 v5, 0x3f80
    v_mov_b32 v6, 0x3f800000
    v_cndmask_b32 v5, v5, v6, vcc
    v_bfe_u32 v6, v1, 1, 1
    v_cmp_eq_u32 vcc, 0, v6
    s_nop 1
    v_cndmask_b32 v110, 0, v5, vcc
    v_mov_b32 v108, 0
    v_mov_b32 v112, 0
    v_cmp_eq_u32 vcc, 1, v6
    s_nop 1
    v_cndmask_b32 v111, 0, v5, vcc
    v_mov_b32 v109, 0
    v_mov_b32 v113, 0
    v_mov_b32 v240, 0x3dd53b95
    v_mov_b32 v241, 0x3dd53b95
    s_lshl_b32 s90, s32, 8
    s_add_u32 s90, s90, 122880
    v_mul_u32_u24 v6, 1152, v2
    v_lshl_add_u32 v6, v1, 3, v6
    v_add_u32 v19, s90, v6
    s_mul_i32 s90, s32, 1536
    v_add_u32 v20, s90, v12
    s_add_u32 s90, s90, 1024
    v_lshl_add_u32 v21, v0, 3, s90
    s_mul_i32 s90, s32, 6144
    v_add_u32 v22, s90, v12
    s_add_u32 s90, s90, 1024
    v_lshl_add_u32 v23, v0, 3, s90
    v_add_u32 v28, 98304, v12
    s_mul_i32 s90, s32, 3072
    v_add_u32 v37, s90, v12
    v_add_u32 v44, 25600, v37
    s_add_u32 s54, s90, 98304
    s_mul_i32 s90, s32, 3840
    s_add_u32 s90, s90, 10240
    v_add_u32 v38, s90, v12
    s_add_u32 s90, s90, 1024
    v_add_u32 v39, s90, v13
    s_mul_i32 s90, s32, 12288
    v_add_u32 v40, s90, v12
    s_lshl_b32 s93, s40, 2
    s_add_u32 s93, s93, s32
    s_nop 0
    s_lshr_b32 s90, s93, 2
    s_lshl_b32 s90, s90, 15
    s_and_b32 s92, s93, 3
    s_lshl_b32 s92, s92, 10
    s_add_u32 s90, s90, s92
    v_mov_b32 v5, s34
    v_and_b32 v6, 7, v1
    v_lshlrev_b32 v6, 4, v6
    v_lshl_add_u32 v6, v5, 7, v6
    v_lshrrev_b32 v7, 3, v1
    v_lshl_add_u32 v6, v7, 12, v6
    v_lshrrev_b32 v5, 1, v2
    v_lshl_add_u32 v6, v5, 13, v6
    v_and_b32 v5, 1, v2
    v_lshl_add_u32 v6, v5, 14, v6
    v_add_u32 v30, s90, v6
    s_and_b32 s91, s34, 1
    s_lshl_b32 s91, s91, 12
    s_add_u32 s90, s90, s91
    s_lshr_b32 s91, s34, 2
    s_lshl_b32 s91, s91, 13
    s_add_u32 s90, s90, s91
    s_and_b32 s91, s34, 2
    s_lshl_b32 s91, s91, 13
    s_add_u32 s90, s90, s91
    v_lshl_add_u32 v31, v0, 4, s90
    s_lshl_b32 s91, s93, 10
    s_add_u32 s91, s91, 884736
    v_lshl_add_u32 v15, v0, 4, s91
    s_lshr_b32 s91, s34, 1
    s_mul_i32 s91, s91, 10240
    s_lshl_b32 s92, s93, 5
    s_add_u32 s91, s91, s92
    s_and_b32 s92, s34, 1
    s_mul_i32 s92, s92, 40960
    s_add_u32 s91, s91, s92
    s_add_u32 s91, s91, 1280
    v_mul_u32_u24 v6, 2560, v2
    v_lshl_add_u32 v6, v1, 1, v6
    v_add_u32 v32, s91, v6
    v_cmp_gt_u32 s[58:59], 8, v1
    v_and_b32 v5, 1, v1
    v_lshrrev_b32 v6, 3, v1
    v_lshl_add_u32 v5, v5, 1, v6
    v_bfe_u32 v6, v1, 2, 1
    v_cmp_ne_u32 vcc, 0, v6
    v_mov_b32 v6, 0x3f80
    v_mov_b32 v7, 0x3f800000
    v_cndmask_b32 v6, v6, v7, vcc
    v_cmp_eq_u32 vcc, 0, v5
    s_nop 1
    v_cndmask_b32 v7, 0, v6, vcc
    v_accvgpr_write_b32 a144, v7
    v_cmp_eq_u32 vcc, 1, v5
    s_nop 1
    v_cndmask_b32 v7, 0, v6, vcc
    v_accvgpr_write_b32 a145, v7
    v_cmp_eq_u32 vcc, 2, v5
    s_nop 1
    v_cndmask_b32 v7, 0, v6, vcc
    v_accvgpr_write_b32 a146, v7
    v_cmp_eq_u32 vcc, 3, v5
    s_nop 1
    v_cndmask_b32 v7, 0, v6, vcc
    v_accvgpr_write_b32 a147, v7
    s_lshl_b32 s90, s32, 7
    v_add_u32 v5, s90, v13
    v_add_u32 v6, 458752, v5
    v_add_u32 v7, 459728, v5
    v_cmp_gt_u32 vcc, 12, v0
    s_nop 1
    v_cndmask_b32 v33, v7, v6, vcc
    v_mov_b32 v5, -2
    v_cndmask_b32 v34, v5, 3, vcc
    v_cmp_gt_u32 vcc, 14, v0
    v_mov_b32 v9, 2146435072
    s_nop 0
    v_cndmask_b32 v33, v9, v33, vcc
    v_mov_b32 v5, -1000
    v_cndmask_b32 v34, v5, v34, vcc
    v_and_b32 v4, 3, v1
    v_lshlrev_b32 v6, 6, v4
    v_lshl_add_u32 v6, v3, 3, v6
    v_lshl_add_u32 v6, v2, 8, v6
    v_and_b32 v5, 1, v2
    v_lshl_add_u32 v6, v5, 5, v6
    s_mul_i32 s90, s32, 3072
    s_add_u32 s53, s90, 131072
    v_add_u32 v16, s53, v6
    v_xor_b32 v13, 32, v16
    v_and_b32 v4, 3, v1
    v_and_b32 v5, 1, v2
    v_lshl_add_u32 v6, v2, 3, v3
    v_lshlrev_b32 v6, 7, v6
    v_and_b32 v7, 2, v3
    v_lshl_or_b32 v7, v5, 2, v7
    v_lshrrev_b32 v8, 1, v4
    v_xor_b32 v7, v7, v8
    v_lshl_add_u32 v6, v7, 4, v6
    v_and_b32 v7, 1, v4
    v_lshl_add_u32 v6, v7, 3, v6
    s_mul_i32 s90, s32, 24576
    v_add_u32 v6, s90, v6
    v_xor_b32 v182, 0, v6
    v_xor_b32 v183, 32, v6
    v_xor_b32 v184, 64, v6
    v_xor_b32 v185, 96, v6
    s_waitcnt vmcnt(0)
    ds_read_b64_tr_b16 a[0:1], v182 offset:0
    ds_read_b64_tr_b16 a[2:3], v182 offset:512
    ds_read_b64_tr_b16 a[4:5], v182 offset:4096
    ds_read_b64_tr_b16 a[6:7], v182 offset:4608
    ds_read_b64_tr_b16 a[8:9], v182 offset:8192
    ds_read_b64_tr_b16 a[10:11], v182 offset:8704
    ds_read_b64_tr_b16 a[12:13], v182 offset:12288
    ds_read_b64_tr_b16 a[14:15], v182 offset:12800
    ds_read_b64_tr_b16 a[16:17], v182 offset:16384
    ds_read_b64_tr_b16 a[18:19], v182 offset:16896
    ds_read_b64_tr_b16 a[20:21], v182 offset:20480
    ds_read_b64_tr_b16 a[22:23], v182 offset:20992
    ds_read_b64_tr_b16 a[24:25], v183 offset:0
    ds_read_b64_tr_b16 a[26:27], v183 offset:512
    ds_read_b64_tr_b16 a[28:29], v183 offset:4096
    ds_read_b64_tr_b16 a[30:31], v183 offset:4608
    ds_read_b64_tr_b16 a[32:33], v183 offset:8192
    ds_read_b64_tr_b16 a[34:35], v183 offset:8704
    ds_read_b64_tr_b16 a[36:37], v183 offset:12288
    ds_read_b64_tr_b16 a[38:39], v183 offset:12800
    ds_read_b64_tr_b16 a[40:41], v183 offset:16384
    ds_read_b64_tr_b16 a[42:43], v183 offset:16896
    ds_read_b64_tr_b16 a[44:45], v183 offset:20480
    ds_read_b64_tr_b16 a[46:47], v183 offset:20992
    ds_read_b64_tr_b16 a[48:49], v184 offset:0
    ds_read_b64_tr_b16 a[50:51], v184 offset:512
    ds_read_b64_tr_b16 a[52:53], v184 offset:4096
    ds_read_b64_tr_b16 a[54:55], v184 offset:4608
    ds_read_b64_tr_b16 a[56:57], v184 offset:8192
    ds_read_b64_tr_b16 a[58:59], v184 offset:8704
    ds_read_b64_tr_b16 a[60:61], v184 offset:12288
    ds_read_b64_tr_b16 a[62:63], v184 offset:12800
    ds_read_b64_tr_b16 a[64:65], v184 offset:16384
    ds_read_b64_tr_b16 a[66:67], v184 offset:16896
    ds_read_b64_tr_b16 a[68:69], v184 offset:20480
    ds_read_b64_tr_b16 a[70:71], v184 offset:20992
    ds_read_b64_tr_b16 a[72:73], v185 offset:0
    ds_read_b64_tr_b16 a[74:75], v185 offset:512
    ds_read_b64_tr_b16 a[76:77], v185 offset:4096
    ds_read_b64_tr_b16 a[78:79], v185 offset:4608
    ds_read_b64_tr_b16 a[80:81], v185 offset:8192
    ds_read_b64_tr_b16 a[82:83], v185 offset:8704
    ds_read_b64_tr_b16 a[84:85], v185 offset:12288
    ds_read_b64_tr_b16 a[86:87], v185 offset:12800
    ds_read_b64_tr_b16 a[88:89], v185 offset:16384
    ds_read_b64_tr_b16 a[90:91], v185 offset:16896
    ds_read_b64_tr_b16 a[92:93], v185 offset:20480
    ds_read_b64_tr_b16 a[94:95], v185 offset:20992
    s_waitcnt lgkmcnt(0)
    s_barrier
    v_mov_b32 v1, 192
L_gw_29:
    buffer_load_dword v2, v1, s[8:11], 0 offen sc1
    s_sub_u32 s36, s36, 1
    s_cbranch_scc1 L_exit
    s_waitcnt vmcnt(0)
    v_readfirstlane_b32 s90, v2
    s_nop 0
    s_cmp_eq_u32 s90, 0
    s_cbranch_scc1 L_gw_29
    s_cmp_lg_u32 s90, 1
    s_cbranch_scc1 L_slow
    buffer_store_dwordx4 v[164:167], v17, s[4:7], s38 offen
    s_mov_b32 s24, s70
    s_and_b32 s25, s71, 0xffff
    s_mov_b32 s26, 2621440
    s_mov_b32 s27, 0x20000
    s_lshl_b32 s93, s40, 2
    s_add_u32 s93, s93, s32
    s_lshl_b32 s93, s93, 10
    s_add_u32 s92, s93, 81920
    s_add_u32 s93, s93, s38
    buffer_load_dwordx4 v[248:251], v12, s[24:27], s92 offen
    s_add_u32 s92, s92, 40960
    buffer_load_dwordx4 v[248:251], v12, s[24:27], s92 offen
    s_add_u32 s92, s92, 40960
    buffer_load_dwordx4 v[248:251], v12, s[24:27], s92 offen
    s_add_u32 s92, s92, 40960
    buffer_load_dwordx4 v[248:251], v12, s[24:27], s92 offen
    s_add_u32 s92, s92, 40960
    buffer_load_dwordx4 v[248:251], v12, s[4:7], s93 offen sc1
    s_add_u32 s93, s93, 40960
    buffer_load_dwordx4 v[248:251], v12, s[4:7], s93 offen sc1
    s_add_u32 s93, s93, 40960
    buffer_load_dwordx4 v[248:251], v12, s[4:7], s93 offen sc1
    s_add_u32 s93, s93, 40960
    buffer_load_dwordx4 v[248:251], v12, s[4:7], s93 offen sc1
    s_add_u32 s93, s93, 40960
    buffer_load_dwordx4 v[248:251], v12, s[4:7], s93 offen sc1
    s_add_u32 s93, s93, 40960
    buffer_load_dwordx4 v[248:251], v12, s[4:7], s93 offen sc1
    s_add_u32 s93, s93, 40960
    buffer_load_dwordx4 v[248:251], v12, s[4:7], s93 offen sc1
    s_add_u32 s93, s93, 40960
    buffer_load_dwordx4 v[248:251], v12, s[4:7], s93 offen sc1
    s_add_u32 s93, s93, 40960
    buffer_load_dwordx4 v[248:251], v12, s[4:7], s93 offen sc1
    s_add_u32 s93, s93, 40960
    buffer_load_dwordx4 v[248:251], v12, s[4:7], s93 offen sc1
    s_add_u32 s93, s93, 40960
    buffer_load_dwordx4 v[248:251], v12, s[4:7], s93 offen sc1
    s_add_u32 s93, s93, 40960
    buffer_load_dwordx4 v[248:251], v12, s[4:7], s93 offen sc1
    s_add_u32 s93, s93, 40960
    buffer_load_dwordx4 v[248:251], v12, s[4:7], s93 offen sc1
    s_add_u32 s93, s93, 40960
    buffer_load_dwordx4 v[248:251], v12, s[4:7], s93 offen sc1
    s_add_u32 s93, s93, 40960
    buffer_load_dwordx4 v[248:251], v12, s[4:7], s93 offen sc1
    s_add_u32 s93, s93, 40960
    buffer_load_dwordx4 v[248:251], v12, s[4:7], s93 offen sc1
    s_add_u32 s93, s93, 40960
    buffer_load_dwordx4 v[248:251], v12, s[4:7], s93 offen sc1
    s_add_u32 s93, s93, 40960
    buffer_load_dwordx4 v[248:251], v12, s[4:7], s93 offen sc1
    s_add_u32 s93, s93, 40960
    buffer_load_dwordx4 v[248:251], v12, s[4:7], s93 offen sc1
    s_add_u32 s93, s93, 40960
    buffer_load_dwordx4 v[248:251], v12, s[4:7], s93 offen sc1
    s_add_u32 s93, s93, 40960
    buffer_load_dwordx4 v[248:251], v12, s[4:7], s93 offen sc1
    s_add_u32 s93, s93, 40960
    buffer_load_dwordx4 v[248:251], v12, s[4:7], s93 offen sc1
    s_add_u32 s93, s93, 40960
    s_mov_b32 s37, -1
    v_add_u32 v35, -2, v34
    s_add_u32 s45, s38, 65536
    s_add_u32 s46, s45, 4096
    s_add_u32 s47, s45, 8192
    v_mov_b32 v24, v20
    v_mov_b32 v25, v21
    buffer_load_dword v36, v33, s[4:7], s38 offen sc1
    s_waitcnt vmcnt(0)
    v_cmp_lt_i32 vcc, v36, v35
    s_cbranch_vccz L_fok_31
L_fw_30:
    buffer_load_dword v36, v33, s[4:7], s38 offen sc1
    s_sub_u32 s36, s36, 1
    s_cbranch_scc1 L_exit
    s_waitcnt vmcnt(0)
    v_cmp_lt_i32 vcc, v36, v35
    s_cbranch_vccnz L_fw_30
L_fok_31:
    buffer_load_dwordx4 a[96:99], v40, s[4:7], s45 offen offset:0 sc1
    buffer_load_dwordx4 a[100:103], v40, s[4:7], s45 offen offset:1024 sc1
    buffer_load_dwordx4 a[104:107], v40, s[4:7], s45 offen offset:2048 sc1
    buffer_load_dwordx4 a[108:111], v40, s[4:7], s45 offen offset:3072 sc1
    buffer_load_dwordx4 a[112:115], v40, s[4:7], s46 offen offset:0 sc1
    buffer_load_dwordx4 a[116:119], v40, s[4:7], s46 offen offset:1024 sc1
    buffer_load_dwordx4 a[120:123], v40, s[4:7], s46 offen offset:2048 sc1
    buffer_load_dwordx4 a[124:127], v40, s[4:7], s46 offen offset:3072 sc1
    buffer_load_dwordx4 a[128:131], v40, s[4:7], s47 offen offset:0 sc1
    buffer_load_dwordx4 a[132:135], v40, s[4:7], s47 offen offset:1024 sc1
    buffer_load_dwordx4 a[136:139], v40, s[4:7], s47 offen offset:2048 sc1
    buffer_load_dwordx4 a[140:143], v40, s[4:7], s47 offen offset:3072 sc1
    s_waitcnt vmcnt(0)
    v_mfma_f32_16x16x32_bf16 v[148:151], a[96:99], a[0:3], 0
    v_mfma_f32_16x16x32_bf16 v[152:155], a[120:123], a[0:3], 0
    v_mfma_f32_16x16x32_bf16 v[156:159], a[96:99], a[24:27], 0
    v_mfma_f32_16x16x32_bf16 v[160:163], a[120:123], a[24:27], 0
    v_mfma_f32_16x16x32_bf16 v[180:183], a[96:99], a[48:51], 0
    v_mfma_f32_16x16x32_bf16 v[184:187], a[120:123], a[48:51], 0
    v_mfma_f32_16x16x32_bf16 v[188:191], a[96:99], a[72:75], 0
    v_mfma_f32_16x16x32_bf16 v[192:195], a[120:123], a[72:75], 0
    v_mfma_f32_16x16x32_bf16 v[148:151], a[100:103], a[4:7], v[148:151]
    v_mfma_f32_16x16x32_bf16 v[152:155], a[124:127], a[4:7], v[152:155]
    v_mfma_f32_16x16x32_bf16 v[156:159], a[100:103], a[28:31], v[156:159]
    v_mfma_f32_16x16x32_bf16 v[160:163], a[124:127], a[28:31], v[160:163]
    v_mfma_f32_16x16x32_bf16 v[180:183], a[100:103], a[52:55], v[180:183]
    v_mfma_f32_16x16x32_bf16 v[184:187], a[124:127], a[52:55], v[184:187]
    v_mfma_f32_16x16x32_bf16 v[188:191], a[100:103], a[76:79], v[188:191]
    v_mfma_f32_16x16x32_bf16 v[192:195], a[124:127], a[76:79], v[192:195]
    v_mfma_f32_16x16x32_bf16 v[148:151], a[104:107], a[8:11], v[148:151]
    v_mfma_f32_16x16x32_bf16 v[152:155], a[128:131], a[8:11], v[152:155]
    v_mfma_f32_16x16x32_bf16 v[156:159], a[104:107], a[32:35], v[156:159]
    v_mfma_f32_16x16x32_bf16 v[160:163], a[128:131], a[32:35], v[160:163]
    v_mfma_f32_16x16x32_bf16 v[180:183], a[104:107], a[56:59], v[180:183]
    v_mfma_f32_16x16x32_bf16 v[184:187], a[128:131], a[56:59], v[184:187]
    v_mfma_f32_16x16x32_bf16 v[188:191], a[104:107], a[80:83], v[188:191]
    v_mfma_f32_16x16x32_bf16 v[192:195], a[128:131], a[80:83], v[192:195]
    v_mfma_f32_16x16x32_bf16 v[148:151], a[108:111], a[12:15], v[148:151]
    v_mfma_f32_16x16x32_bf16 v[152:155], a[132:135], a[12:15], v[152:155]
    v_mfma_f32_16x16x32_bf16 v[156:159], a[108:111], a[36:39], v[156:159]
    v_mfma_f32_16x16x32_bf16 v[160:163], a[132:135], a[36:39], v[160:163]
    v_mfma_f32_16x16x32_bf16 v[180:183], a[108:111], a[60:63], v[180:183]
    v_mfma_f32_16x16x32_bf16 v[184:187], a[132:135], a[60:63], v[184:187]
    v_mfma_f32_16x16x32_bf16 v[188:191], a[108:111], a[84:87], v[188:191]
    v_mfma_f32_16x16x32_bf16 v[192:195], a[132:135], a[84:87], v[192:195]
    v_mfma_f32_16x16x32_bf16 v[148:151], a[112:115], a[16:19], v[148:151]
    v_mfma_f32_16x16x32_bf16 v[152:155], a[136:139], a[16:19], v[152:155]
    v_mfma_f32_16x16x32_bf16 v[156:159], a[112:115], a[40:43], v[156:159]
    v_mfma_f32_16x16x32_bf16 v[160:163], a[136:139], a[40:43], v[160:163]
    v_mfma_f32_16x16x32_bf16 v[180:183], a[112:115], a[64:67], v[180:183]
    v_mfma_f32_16x16x32_bf16 v[184:187], a[136:139], a[64:67], v[184:187]
    v_mfma_f32_16x16x32_bf16 v[188:191], a[112:115], a[88:91], v[188:191]
    v_mfma_f32_16x16x32_bf16 v[192:195], a[136:139], a[88:91], v[192:195]
    v_mfma_f32_16x16x32_bf16 v[148:151], a[116:119], a[20:23], v[148:151]
    v_mfma_f32_16x16x32_bf16 v[152:155], a[140:143], a[20:23], v[152:155]
    v_mfma_f32_16x16x32_bf16 v[156:159], a[116:119], a[44:47], v[156:159]
    v_mfma_f32_16x16x32_bf16 v[160:163], a[140:143], a[44:47], v[160:163]
    v_mfma_f32_16x16x32_bf16 v[180:183], a[116:119], a[68:71], v[180:183]
    v_mfma_f32_16x16x32_bf16 v[184:187], a[140:143], a[68:71], v[184:187]
    v_mfma_f32_16x16x32_bf16 v[188:191], a[116:119], a[92:95], v[188:191]
    v_mfma_f32_16x16x32_bf16 v[192:195], a[140:143], a[92:95], v[192:195]
    v_cvt_pk_bf16_f32 v64, v180, v181
    v_cvt_pk_bf16_f32 v65, v182, v183
    ds_write_b64 v24, v[64:65] offset:12288
    v_cvt_pk_bf16_f32 v68, v184, v185
    v_cvt_pk_bf16_f32 v69, v186, v187
    ds_write_b64 v25, v[68:69] offset:12288
    v_cvt_pk_bf16_f32 v72, v188, v189
    v_cvt_pk_bf16_f32 v73, v190, v191
    ds_write_b64 v24, v[72:73] offset:18432
    v_cvt_pk_bf16_f32 v76, v192, v193
    v_cvt_pk_bf16_f32 v77, v194, v195
    ds_write_b64 v25, v[76:77] offset:18432
    v_cvt_pk_bf16_f32 v48, v148, v149
    v_cvt_pk_bf16_f32 v49, v150, v151
    ds_write_b64 v24, v[48:49] offset:0
    v_cvt_pk_bf16_f32 v52, v152, v153
    v_cvt_pk_bf16_f32 v53, v154, v155
    ds_write_b64 v25, v[52:53] offset:0
    v_cvt_pk_bf16_f32 v56, v156, v157
    v_cvt_pk_bf16_f32 v57, v158, v159
    ds_write_b64 v24, v[56:57] offset:6144
    v_cvt_pk_bf16_f32 v60, v160, v161
    v_cvt_pk_bf16_f32 v61, v162, v163
    ds_write_b64 v25, v[60:61] offset:6144
    s_add_u32 s56, s37, 2
    s_and_b32 s55, s56, 3
    s_mul_i32 s55, s55, 114688
    s_add_u32 s55, s55, 65536
    s_add_u32 s45, s38, s55
    s_add_u32 s46, s45, 4096
    s_add_u32 s47, s45, 8192
    s_add_u32 s56, s37, -1
    s_and_b32 s55, s56, 3
    s_mul_i32 s55, s55, 114688
    s_add_u32 s55, s55, 53248
    s_add_u32 s48, s38, s55
    s_and_b32 s55, s56, 1
    s_add_u32 s56, s56, 1
    v_mov_b32 v35, -16
    v_writelane_b32 v35, s56, 12
    s_mul_i32 s55, s55, 12288
    s_add_u32 m0, s54, s55
    v_add_u32 v35, -1, v34
    buffer_load_dword v36, v33, s[4:7], s38 offen sc1
    s_waitcnt vmcnt(0)
    v_cmp_lt_i32 vcc, v36, v35
    s_cbranch_vccz L_fok_33
L_fw_32:
    buffer_load_dword v36, v33, s[4:7], s38 offen sc1
    s_sub_u32 s36, s36, 1
    s_cbranch_scc1 L_exit
    s_waitcnt vmcnt(0)
    v_cmp_lt_i32 vcc, v36, v35
    s_cbranch_vccnz L_fw_32
L_fok_33:
    buffer_load_dwordx4 a[96:99], v40, s[4:7], s45 offen offset:0 sc1
    buffer_load_dwordx4 a[100:103], v40, s[4:7], s45 offen offset:1024 sc1
    buffer_load_dwordx4 a[104:107], v40, s[4:7], s45 offen offset:2048 sc1
    buffer_load_dwordx4 a[108:111], v40, s[4:7], s45 offen offset:3072 sc1
    buffer_load_dwordx4 a[112:115], v40, s[4:7], s46 offen offset:0 sc1
    buffer_load_dwordx4 a[116:119], v40, s[4:7], s46 offen offset:1024 sc1
    buffer_load_dwordx4 a[120:123], v40, s[4:7], s46 offen offset:2048 sc1
    buffer_load_dwordx4 a[124:127], v40, s[4:7], s46 offen offset:3072 sc1
    buffer_load_dwordx4 a[128:131], v40, s[4:7], s47 offen offset:0 sc1
    buffer_load_dwordx4 a[132:135], v40, s[4:7], s47 offen offset:1024 sc1
    buffer_load_dwordx4 a[136:139], v40, s[4:7], s47 offen offset:2048 sc1
    buffer_load_dwordx4 a[140:143], v40, s[4:7], s47 offen offset:3072 sc1
    s_mov_b32 s50, s42
    s_add_u32 s56, s37, 1
    v_mov_b32 v47, v24
    s_and_b32 s55, s56, 3
    s_mul_i32 s41, s55, 327680
    s_mul_i32 s56, s55, 114688
    s_add_u32 s43, s38, s56
    s_xor_b32 s55, s55, 2
    s_mul_i32 s42, s55, 327680
    s_add_u32 s56, s37, 2
    v_mov_b32 v107, s56
    s_and_b32 s55, s56, 3
    s_mul_i32 s44, s55, 24576
    s_add_u32 s56, s37, -1
    s_and_b32 s55, s56, 3
    s_mul_i32 s55, s55, 40960
    s_add_u32 s49, s55, s38
    s_add_u32 s56, s37, -1
    s_and_b32 s55, s56, 3
    s_mul_i32 s55, s55, 24576
    v_add_u32 v26, s55, v22
    v_add_u32 v27, s55, v23
    s_and_b32 s55, s56, 1
    s_mul_i32 s55, s55, 12288
    v_add_u32 v29, s55, v28
    s_add_u32 s37, s37, 1
    s_mov_b32 m0, s53
    v_add_u32 v24, s44, v20
    v_add_u32 v25, s44, v21
    v_pk_mul_f32 v[148:149], v[210:211], v[210:211]
    v_pk_mul_f32 v[150:151], v[210:211], v[210:211]
    v_pk_mul_f32 v[152:153], v[210:211], v[210:211]
    v_pk_mul_f32 v[154:155], v[210:211], v[210:211]
    v_pk_mul_f32 v[156:157], v[210:211], v[210:211]
    v_pk_mul_f32 v[158:159], v[210:211], v[210:211]
    v_pk_mul_f32 v[160:161], v[210:211], v[210:211]
    v_pk_mul_f32 v[162:163], v[210:211], v[210:211]
    v_mov_b32 v120, 0
    v_mov_b32 v121, 0
    v_mov_b32 v122, 0
    v_mov_b32 v123, 0
    v_mov_b32 v124, 0
    v_mov_b32 v125, 0
    v_mov_b32 v126, 0
    v_mov_b32 v127, 0
    v_mov_b32 v128, 0
    v_mov_b32 v129, 0
    v_mov_b32 v130, 0
    v_mov_b32 v131, 0
    v_mov_b32 v132, 0
    v_mov_b32 v133, 0
    v_mov_b32 v134, 0
    v_mov_b32 v135, 0
    v_mov_b32 v116, 0
    v_mov_b32 v117, 0
    v_mov_b32 v118, 0
    v_mov_b32 v119, 0
L_wo_loop_f:
    buffer_load_dword v41, v245, s[4:7], s38 offen sc1
    buffer_load_dword v41, v245, s[4:7], s38 offen sc1
    buffer_load_dword v41, v245, s[4:7], s38 offen sc1
    buffer_load_dword v41, v245, s[4:7], s38 offen sc1
    buffer_load_dword v41, v245, s[4:7], s38 offen sc1
    buffer_load_dword v41, v245, s[4:7], s38 offen sc1
L_sp_37:
    s_waitcnt vmcnt(5)
    v_cmp_ge_u32 vcc, s37, v41
    buffer_load_dword v41, v245, s[4:7], s38 offen sc1
    s_sub_u32 s36, s36, 1
    s_cbranch_scc1 L_exit
    s_cbranch_vccz L_sp_37x
    s_waitcnt vmcnt(5)
    v_cmp_ge_u32 vcc, s37, v41
    buffer_load_dword v41, v245, s[4:7], s38 offen sc1
    s_cbranch_vccz L_sp_37x
    s_waitcnt vmcnt(5)
    v_cmp_ge_u32 vcc, s37, v41
    buffer_load_dword v41, v245, s[4:7], s38 offen sc1
    s_cbranch_vccz L_sp_37x
    s_waitcnt vmcnt(5)
    v_cmp_ge_u32 vcc, s37, v41
    buffer_load_dword v41, v245, s[4:7], s38 offen sc1
    s_cbranch_vccnz L_sp_37
L_sp_37x:
    buffer_load_dwordx4 v44, s[4:7], s43 offen offset:0 sc1 lds
    buffer_load_dwordx4 v44, s[4:7], s43 offen offset:1024 sc1 lds
    buffer_load_dwordx4 v44, s[4:7], s43 offen offset:2048 sc1 lds
    s_waitcnt vmcnt(2)
    ds_read_b64_tr_b16 v[136:137], v16 offset:0
    ds_read_b64_tr_b16 v[138:139], v13 offset:0
    s_waitcnt vmcnt(1)
    ds_read_b64_tr_b16 v[140:141], v16 offset:1024
    ds_read_b64_tr_b16 v[142:143], v13 offset:1024
    s_waitcnt vmcnt(0)
    ds_read_b64_tr_b16 v[144:145], v16 offset:2048
    ds_read_b64_tr_b16 v[146:147], v13 offset:2048
    buffer_load_dwordx4 v[92:95], v38, s[4:7], s43 offen offset:0 sc1
    buffer_load_dwordx4 v[96:99], v38, s[4:7], s43 offen offset:1280 sc1
    buffer_load_dwordx4 v[100:103], v38, s[4:7], s43 offen offset:2560 sc1
    s_cmp_eq_u32 s37, 63
    s_waitcnt lgkmcnt(4)
    v_smfmac_f32_16x16x64_bf16 v[148:151], v[136:139], a[0:7], v10
    v_smfmac_f32_16x16x64_bf16 v[152:155], v[136:139], a[24:31], v10
    v_smfmac_f32_16x16x64_bf16 v[156:159], v[136:139], a[48:55], v10
    buffer_load_dword v104, v39, s[4:7], s43 offen offset:0 sc1
    v_smfmac_f32_16x16x64_bf16 v[160:163], v[136:139], a[72:79], v10
    buffer_load_dword v105, v39, s[4:7], s43 offen offset:1280 sc1
    s_waitcnt lgkmcnt(2)
    v_smfmac_f32_16x16x64_bf16 v[148:151], v[140:143], a[8:15], v10
    buffer_load_dword v106, v39, s[4:7], s43 offen offset:2560 sc1
    v_smfmac_f32_16x16x64_bf16 v[152:155], v[140:143], a[32:39], v10
    v_smfmac_f32_16x16x64_bf16 v[156:159], v[140:143], a[56:63], v10
    v_smfmac_f32_16x16x64_bf16 v[160:163], v[140:143], a[80:87], v10
    s_waitcnt lgkmcnt(0)
    v_smfmac_f32_16x16x64_bf16 v[148:151], v[144:147], a[16:23], v10
    v_smfmac_f32_16x16x64_bf16 v[152:155], v[144:147], a[40:47], v10
    v_smfmac_f32_16x16x64_bf16 v[156:159], v[144:147], a[64:71], v10
    v_smfmac_f32_16x16x64_bf16 v[160:163], v[144:147], a[88:95], v10
    v_pk_add_f32 v[148:149], v[148:149], v[150:151]
    v_cmp_u_f32 vcc, v148, v149
    v_cvt_pk_bf16_f32 v50, v148, v149
    v_cvt_pk_bf16_f32 v54, v148, v149
    v_pk_add_f32 v[152:153], v[152:153], v[154:155]
    v_cvt_pk_bf16_f32 v58, v152, v153
    v_cvt_pk_bf16_f32 v62, v152, v153
    v_pk_add_f32 v[156:157], v[156:157], v[158:159]
    v_cvt_pk_bf16_f32 v66, v156, v157
    v_cvt_pk_bf16_f32 v70, v156, v157
    v_pk_add_f32 v[160:161], v[160:161], v[162:163]
    v_cvt_pk_bf16_f32 v74, v160, v161
    v_cvt_pk_bf16_f32 v78, v160, v161
    s_cbranch_vccnz L_vm_35
L_u_36:
    s_cbranch_scc1 L_wo_tail_f
L_sc_38:
    s_waitcnt vmcnt(4)
    v_pk_add_f32 v[236:237], v[92:93], v[96:97]
    v_pk_add_f32 v[238:239], v[94:95], v[98:99]
    s_waitcnt vmcnt(3)
    v_pk_add_f32 v[236:237], v[236:237], v[100:101]
    v_pk_add_f32 v[238:239], v[238:239], v[102:103]
    v_max3_f32 v41, v236, v237, v238
    v_pk_add_f32 v[242:243], v[236:237], v[238:239]
    s_waitcnt vmcnt(0)
    v_add_f32 v43, v104, v105
    v_add_f32 v43, v43, v106
    v_max3_f32 v41, v41, v239, v43
    v_add_f32 v242, v242, v43
    s_nop 0
    v_max_f32_dpp v42, v41, v41 quad_perm:[2,3,0,1] row_mask:0xf bank_mask:0xf
    v_max_f32_dpp v41, v41, v41 quad_perm:[2,3,0,1] row_mask:0xf bank_mask:0xf
    v_cmp_u_f32 vcc, v242, v243
    s_nop 0
    v_permlane16_swap_b32 v41, v42
    v_max_f32 v41, v41, v42
    v_mov_b32 v42, v41
    s_cbranch_vccnz L_sp_39
L_sg_40:
    s_nop 0
    v_permlane32_swap_b32 v41, v42
    v_max_f32 v41, v41, v42
    v_mul_f32 v242, 0xbdd53b95, v41
    v_pk_fma_f32 v[236:237], v[236:237], v[240:241], v[242:243] op_sel_hi:[1,1,0]
    v_pk_fma_f32 v[238:239], v[238:239], v[240:241], v[242:243] op_sel_hi:[1,1,0]
    v_fma_f32 v43, v43, v240, v242
    v_exp_f32 v236, v236
    v_exp_f32 v237, v237
    v_exp_f32 v238, v238
    v_exp_f32 v239, v239
    v_exp_f32 v43, v43
    v_cvt_pk_bf16_f32 v80, v236, v237
    v_cvt_pk_bf16_f32 v82, v238, v239
    v_cvt_pk_bf16_f32 v81, v43, 0
    v_cvt_pk_bf16_f32 v83, v43, 0
    s_nop 1
    v_smfmac_f32_16x16x64_bf16 v[116:119], v[80:83], v[84:91], v11
    v_smfmac_f32_16x16x64_bf16 v[120:123], v[80:83], v[48:55], v11
    v_smfmac_f32_16x16x64_bf16 v[124:127], v[80:83], v[56:63], v11
    v_smfmac_f32_16x16x64_bf16 v[128:131], v[80:83], v[64:71], v11
    v_add_f32 v116, v116, v118
    v_add_f32 v117, v117, v119
    v_smfmac_f32_16x16x64_bf16 v[132:135], v[80:83], v[72:79], v11
    v_rcp_f32 v116, v116
    v_rcp_f32 v117, v117
    v_pk_add_f32 v[120:121], v[120:121], v[122:123]
    v_pk_mul_f32 v[120:121], v[120:121], v[116:117]
    v_cvt_pk_bf16_f32 v236, v120, v121
    v_pk_add_f32 v[124:125], v[124:125], v[126:127]
    v_pk_mul_f32 v[124:125], v[124:125], v[116:117]
    v_cvt_pk_bf16_f32 v237, v124, v125
    ds_write2st64_b32 v18, v236, v237 offset0:0 offset1:1
    v_pk_add_f32 v[128:129], v[128:129], v[130:131]
    v_pk_mul_f32 v[128:129], v[128:129], v[116:117]
    v_cvt_pk_bf16_f32 v238, v128, v129
    v_pk_add_f32 v[132:133], v[132:133], v[134:135]
    v_pk_mul_f32 v[132:133], v[132:133], v[116:117]
    v_cvt_pk_bf16_f32 v239, v132, v133
    ds_write2st64_b32 v18, v238, v239 offset0:2 offset1:3
    buffer_store_dword v107, v244, s[4:7], s38 offen
    v_mov_b32 v120, 0
    v_mov_b32 v121, 0
    v_mov_b32 v122, 0
    v_mov_b32 v123, 0
    v_mov_b32 v124, 0
    v_mov_b32 v125, 0
    v_mov_b32 v126, 0
    v_mov_b32 v127, 0
    v_mov_b32 v128, 0
    v_mov_b32 v129, 0
    s_waitcnt lgkmcnt(0)
    s_barrier
    ds_read_b64_tr_b16 v[80:81], v19
    ds_read_b64_tr_b16 v[82:83], v19 offset:128
    v_mov_b32 v130, 0
    v_mov_b32 v131, 0
    v_mov_b32 v132, 0
    v_mov_b32 v133, 0
    v_mov_b32 v134, 0
    v_mov_b32 v135, 0
    v_mov_b32 v116, 0
    v_mov_b32 v117, 0
    v_mov_b32 v118, 0
    v_mov_b32 v119, 0
    s_waitcnt lgkmcnt(0)
    v_mfma_f32_16x16x32_bf16 v[172:175], v[110:113], v[80:83], 0
    v_mfma_f32_16x16x32_bf16 v[176:179], v[108:111], v[80:83], 0
    buffer_load_dword v36, v33, s[4:7], s38 offen sc1
    s_nop 3
    v_cvt_pk_bf16_f32 v236, v172, v173
    v_cvt_pk_bf16_f32 v237, v174, v175
    s_nop 0
    v_cvt_pk_bf16_f32 v238, v176, v177
    v_cvt_pk_bf16_f32 v239, v178, v179
    buffer_store_dwordx4 v[236:239], v14, s[4:7], s41 offen sc1
    ds_write_b32 v47, v50 offset:8
    ds_write_b32 v47, v58 offset:6152
    ds_write_b32 v47, v66 offset:12296
    ds_write_b32 v47, v74 offset:18440
    ds_read_b128 v[204:207], v26 offset:0
    ds_read_b128 v[180:183], v29 offset:0
    ds_read_b128 v[184:187], v29 offset:1024
    ds_read_b64 v[208:209], v27 offset:0
    ds_read_b128 v[188:191], v29 offset:2048
    ds_read_b128 v[212:215], v26 offset:1536
    ds_read_b128 v[192:195], v29 offset:3072
    ds_read_b128 v[196:199], v29 offset:4096
    ds_read_b64 v[216:217], v27 offset:1536
    ds_read_b128 v[200:203], v29 offset:5120
    s_add_u32 s55, s42, s60
    buffer_store_dword v168, v46, s[4:7], s55 offen sc1
    s_add_u32 s55, s42, s61
    buffer_store_dword v168, v46, s[4:7], s55 offen sc1
    s_waitcnt lgkmcnt(5)
    v_mfma_f32_16x16x32_bf16 v[220:223], v[180:183], v[204:207], 0
    v_mfma_f32_16x16x32_bf16 v[224:227], v[184:187], v[204:207], 0
    v_mfma_f32_16x16x32_bf16 v[224:227], v[188:191], v[208:211], v[224:227]
    ds_read_b128 v[204:207], v26 offset:3072
    ds_read_b128 v[180:183], v29 offset:6144
    ds_read_b128 v[184:187], v29 offset:7168
    ds_read_b64 v[208:209], v27 offset:3072
    ds_read_b128 v[188:191], v29 offset:8192
    s_add_u32 s56, s37, 2
    s_and_b32 s55, s56, 3
    s_mul_i32 s55, s55, 114688
    s_add_u32 s55, s55, 65536
    s_add_u32 s45, s38, s55
    s_add_u32 s46, s45, 4096
    s_add_u32 s47, s45, 8192
    s_add_u32 s56, s37, -1
    s_and_b32 s55, s56, 3
    s_mul_i32 s55, s55, 114688
    s_add_u32 s55, s55, 53248
    s_add_u32 s48, s38, s55
    s_and_b32 s55, s56, 1
    s_add_u32 s56, s56, 1
    v_mov_b32 v35, -16
    v_writelane_b32 v35, s56, 12
    s_mul_i32 s55, s55, 12288
    s_add_u32 m0, s54, s55
    s_waitcnt lgkmcnt(5)
    v_mfma_f32_16x16x32_bf16 v[220:223], v[192:195], v[212:215], v[220:223]
    v_mfma_f32_16x16x32_bf16 v[224:227], v[196:199], v[212:215], v[224:227]
    v_mfma_f32_16x16x32_bf16 v[224:227], v[200:203], v[216:219], v[224:227]
    ds_read_b128 v[212:215], v26 offset:4608
    ds_read_b128 v[192:195], v29 offset:9216
    ds_read_b128 v[196:199], v29 offset:10240
    ds_read_b64 v[216:217], v27 offset:4608
    ds_read_b128 v[200:203], v29 offset:11264
    s_waitcnt lgkmcnt(5)
    v_mfma_f32_16x16x32_bf16 v[220:223], v[180:183], v[204:207], v[220:223]
    v_mfma_f32_16x16x32_bf16 v[224:227], v[184:187], v[204:207], v[224:227]
    v_mfma_f32_16x16x32_bf16 v[224:227], v[188:191], v[208:211], v[224:227]
    s_waitcnt lgkmcnt(0)
    v_mfma_f32_16x16x32_bf16 v[220:223], v[192:195], v[212:215], v[220:223]
    v_mfma_f32_16x16x32_bf16 v[224:227], v[196:199], v[212:215], v[224:227]
    v_mfma_f32_16x16x32_bf16 v[224:227], v[200:203], v[216:219], v[224:227]
    s_waitcnt vmcnt(3)
    v_cmp_lt_i32 vcc, v36, v35
    s_cbranch_vccz L_fok_43
L_fw_42:
    buffer_load_dword v36, v33, s[4:7], s38 offen sc1
    s_sub_u32 s36, s36, 1
    s_cbranch_scc1 L_exit
    s_waitcnt vmcnt(0)
    v_cmp_lt_i32 vcc, v36, v35
    s_cbranch_vccnz L_fw_42
L_fok_43:
    buffer_load_dwordx4 v37, s[4:7], s48 offen offset:0 sc1 lds
    buffer_load_dwordx4 v37, s[4:7], s48 offen offset:1024 sc1 lds
    buffer_load_dwordx4 v37, s[4:7], s48 offen offset:2048 sc1 lds
    v_cvt_pk_bf16_f32 v220, v220, v221
    v_cvt_pk_bf16_f32 v221, v222, v223
    v_cvt_pk_bf16_f32 v222, v224, v225
    v_cvt_pk_bf16_f32 v223, v226, v227
    v_mov_b32 v224, v220
    v_mov_b32 v225, v221
    v_mov_b32_dpp v220, v222 row_ror:8 row_mask:0xf bank_mask:0xc
    v_mov_b32_dpp v221, v223 row_ror:8 row_mask:0xf bank_mask:0xc
    v_mov_b32_dpp v222, v224 row_ror:8 row_mask:0xf bank_mask:0x3
    v_mov_b32_dpp v223, v225 row_ror:8 row_mask:0xf bank_mask:0x3
    buffer_store_dwordx4 v[220:223], v15, s[4:7], s49 offen
    v_mfma_f32_16x16x32_bf16 v[148:151], a[96:99], a[0:3], 0
    s_mov_b32 s50, s42
    s_add_u32 s56, s37, 1
    v_mov_b32 v47, v24
    v_mfma_f32_16x16x32_bf16 v[152:155], a[120:123], a[0:3], 0
    s_and_b32 s55, s56, 3
    s_mul_i32 s41, s55, 327680
    s_mul_i32 s56, s55, 114688
    v_mfma_f32_16x16x32_bf16 v[156:159], a[96:99], a[24:27], 0
    s_add_u32 s43, s38, s56
    s_xor_b32 s55, s55, 2
    s_mul_i32 s42, s55, 327680
    v_mfma_f32_16x16x32_bf16 v[160:163], a[120:123], a[24:27], 0
    s_add_u32 s56, s37, 2
    v_mov_b32 v107, s56
    s_and_b32 s55, s56, 3
    v_mfma_f32_16x16x32_bf16 v[180:183], a[96:99], a[48:51], 0
    s_mul_i32 s44, s55, 24576
    s_add_u32 s56, s37, -1
    s_and_b32 s55, s56, 3
    v_mfma_f32_16x16x32_bf16 v[184:187], a[120:123], a[48:51], 0
    s_mul_i32 s55, s55, 40960
    s_add_u32 s49, s55, s38
    s_add_u32 s56, s37, -1
    v_mfma_f32_16x16x32_bf16 v[188:191], a[96:99], a[72:75], 0
    s_and_b32 s55, s56, 3
    s_mul_i32 s55, s55, 24576
    v_add_u32 v26, s55, v22
    v_mfma_f32_16x16x32_bf16 v[192:195], a[120:123], a[72:75], 0
    buffer_load_dwordx4 a[96:99], v40, s[4:7], s45 offen offset:0 sc1
    v_mfma_f32_16x16x32_bf16 v[148:151], a[100:103], a[4:7], v[148:151]
    v_add_u32 v27, s55, v23
    s_and_b32 s55, s56, 1
    s_mul_i32 s55, s55, 12288
    v_mfma_f32_16x16x32_bf16 v[152:155], a[124:127], a[4:7], v[152:155]
    buffer_load_dwordx4 a[120:123], v40, s[4:7], s46 offen offset:2048 sc1
    v_mfma_f32_16x16x32_bf16 v[156:159], a[100:103], a[28:31], v[156:159]
    v_add_u32 v29, s55, v28
    v_mfma_f32_16x16x32_bf16 v[160:163], a[124:127], a[28:31], v[160:163]
    v_mfma_f32_16x16x32_bf16 v[180:183], a[100:103], a[52:55], v[180:183]
    v_mfma_f32_16x16x32_bf16 v[184:187], a[124:127], a[52:55], v[184:187]
    v_mfma_f32_16x16x32_bf16 v[188:191], a[100:103], a[76:79], v[188:191]
    v_mfma_f32_16x16x32_bf16 v[192:195], a[124:127], a[76:79], v[192:195]
    buffer_load_dwordx4 a[100:103], v40, s[4:7], s45 offen offset:1024 sc1
    v_mfma_f32_16x16x32_bf16 v[148:151], a[104:107], a[8:11], v[148:151]
    v_mfma_f32_16x16x32_bf16 v[152:155], a[128:131], a[8:11], v[152:155]
    buffer_load_dwordx4 a[124:127], v40, s[4:7], s46 offen offset:3072 sc1
    v_mfma_f32_16x16x32_bf16 v[156:159], a[104:107], a[32:35], v[156:159]
    v_mfma_f32_16x16x32_bf16 v[160:163], a[128:131], a[32:35], v[160:163]
    v_mfma_f32_16x16x32_bf16 v[180:183], a[104:107], a[56:59], v[180:183]
    v_mfma_f32_16x16x32_bf16 v[184:187], a[128:131], a[56:59], v[184:187]
    v_mfma_f32_16x16x32_bf16 v[188:191], a[104:107], a[80:83], v[188:191]
    v_mfma_f32_16x16x32_bf16 v[192:195], a[128:131], a[80:83], v[192:195]
    buffer_load_dwordx4 a[104:107], v40, s[4:7], s45 offen offset:2048 sc1
    v_mfma_f32_16x16x32_bf16 v[148:151], a[108:111], a[12:15], v[148:151]
    v_mfma_f32_16x16x32_bf16 v[152:155], a[132:135], a[12:15], v[152:155]
    buffer_load_dwordx4 a[128:131], v40, s[4:7], s47 offen offset:0 sc1
    v_mfma_f32_16x16x32_bf16 v[156:159], a[108:111], a[36:39], v[156:159]
    v_mfma_f32_16x16x32_bf16 v[160:163], a[132:135], a[36:39], v[160:163]
    v_mfma_f32_16x16x32_bf16 v[180:183], a[108:111], a[60:63], v[180:183]
    v_mfma_f32_16x16x32_bf16 v[184:187], a[132:135], a[60:63], v[184:187]
    v_mfma_f32_16x16x32_bf16 v[188:191], a[108:111], a[84:87], v[188:191]
    v_mfma_f32_16x16x32_bf16 v[192:195], a[132:135], a[84:87], v[192:195]
    buffer_load_dwordx4 a[108:111], v40, s[4:7], s45 offen offset:3072 sc1
    v_mfma_f32_16x16x32_bf16 v[148:151], a[112:115], a[16:19], v[148:151]
    v_mfma_f32_16x16x32_bf16 v[152:155], a[136:139], a[16:19], v[152:155]
    buffer_load_dwordx4 a[132:135], v40, s[4:7], s47 offen offset:1024 sc1
    v_mfma_f32_16x16x32_bf16 v[156:159], a[112:115], a[40:43], v[156:159]
    v_mfma_f32_16x16x32_bf16 v[160:163], a[136:139], a[40:43], v[160:163]
    v_mfma_f32_16x16x32_bf16 v[180:183], a[112:115], a[64:67], v[180:183]
    v_mfma_f32_16x16x32_bf16 v[184:187], a[136:139], a[64:67], v[184:187]
    v_mfma_f32_16x16x32_bf16 v[188:191], a[112:115], a[88:91], v[188:191]
    v_mfma_f32_16x16x32_bf16 v[192:195], a[136:139], a[88:91], v[192:195]
    v_mfma_f32_16x16x32_bf16 v[148:151], a[116:119], a[20:23], v[148:151]
    v_mfma_f32_16x16x32_bf16 v[152:155], a[140:143], a[20:23], v[152:155]
    v_mfma_f32_16x16x32_bf16 v[156:159], a[116:119], a[44:47], v[156:159]
    v_mfma_f32_16x16x32_bf16 v[160:163], a[140:143], a[44:47], v[160:163]
    v_mfma_f32_16x16x32_bf16 v[180:183], a[116:119], a[68:71], v[180:183]
    v_mfma_f32_16x16x32_bf16 v[184:187], a[140:143], a[68:71], v[184:187]
    v_mfma_f32_16x16x32_bf16 v[188:191], a[116:119], a[92:95], v[188:191]
    v_mfma_f32_16x16x32_bf16 v[192:195], a[140:143], a[92:95], v[192:195]
    v_cvt_pk_bf16_f32 v64, v180, v181
    v_cvt_pk_bf16_f32 v65, v182, v183
    ds_write_b64 v24, v[64:65] offset:12288
    v_cvt_pk_bf16_f32 v68, v184, v185
    v_cvt_pk_bf16_f32 v69, v186, v187
    ds_write_b64 v25, v[68:69] offset:12288
    v_cvt_pk_bf16_f32 v72, v188, v189
    v_cvt_pk_bf16_f32 v73, v190, v191
    ds_write_b64 v24, v[72:73] offset:18432
    v_cvt_pk_bf16_f32 v76, v192, v193
    v_cvt_pk_bf16_f32 v77, v194, v195
    ds_write_b64 v25, v[76:77] offset:18432
    v_cvt_pk_bf16_f32 v48, v148, v149
    v_cvt_pk_bf16_f32 v49, v150, v151
    ds_write_b64 v24, v[48:49] offset:0
    v_cvt_pk_bf16_f32 v52, v152, v153
    v_cvt_pk_bf16_f32 v53, v154, v155
    ds_write_b64 v25, v[52:53] offset:0
    v_cvt_pk_bf16_f32 v56, v156, v157
    v_cvt_pk_bf16_f32 v57, v158, v159
    ds_write_b64 v24, v[56:57] offset:6144
    v_cvt_pk_bf16_f32 v60, v160, v161
    v_cvt_pk_bf16_f32 v61, v162, v163
    ds_write_b64 v25, v[60:61] offset:6144
    s_add_u32 s37, s37, 1
    s_mov_b32 m0, s53
    v_add_u32 v24, s44, v20
    v_add_u32 v25, s44, v21
    v_pk_mul_f32 v[148:149], v[210:211], v[210:211]
    v_pk_mul_f32 v[150:151], v[210:211], v[210:211]
    v_pk_mul_f32 v[152:153], v[210:211], v[210:211]
    v_pk_mul_f32 v[154:155], v[210:211], v[210:211]
    v_pk_mul_f32 v[156:157], v[210:211], v[210:211]
    v_pk_mul_f32 v[158:159], v[210:211], v[210:211]
    v_pk_mul_f32 v[160:161], v[210:211], v[210:211]
    v_pk_mul_f32 v[162:163], v[210:211], v[210:211]
    buffer_load_dwordx4 a[112:115], v40, s[4:7], s46 offen offset:0 sc1
    buffer_load_dwordx4 a[136:139], v40, s[4:7], s47 offen offset:2048 sc1
    buffer_load_dwordx4 a[116:119], v40, s[4:7], s46 offen offset:1024 sc1
    buffer_load_dwordx4 a[140:143], v40, s[4:7], s47 offen offset:3072 sc1
    s_branch L_wo_loop_f
L_wo_tail_f:
    ds_write_b32 v47, v50 offset:8
    ds_write_b32 v47, v58 offset:6152
    ds_write_b32 v47, v66 offset:12296
    ds_write_b32 v47, v74 offset:18440
    s_add_u32 s91, s38, 81920
    buffer_load_dwordx4 v[120:123], v15, s[4:7], s91 offen sc1
    s_add_u32 s91, s38, 122880
    buffer_load_dwordx4 v[124:127], v15, s[4:7], s91 offen sc1
    v_mov_b32 v3, 200
L_p0_44:
    buffer_load_dword v4, v3, s[8:11], 0 offen sc1
    s_sub_u32 s36, s36, 1
    s_cbranch_scc1 L_exit
    s_waitcnt vmcnt(0)
    v_readfirstlane_b32 s90, v4
    s_nop 0
    s_cmp_eq_u32 s90, 0
    s_cbranch_scc1 L_p0_44
    s_and_b32 s90, s90, 2
    s_lshl_b32 s90, s90, 12
    v_xor_b32 v30, s90, v30
    v_xor_b32 v31, s90, v31
    s_mov_b32 s49, 6160384
    buffer_store_dwordx4 v[120:123], v30, s[4:7], s49 offen sc1
    s_mov_b32 s49, 6488064
    buffer_store_dwordx4 v[124:127], v30, s[4:7], s49 offen sc1
    s_mov_b32 s49, 6815744
    buffer_store_dwordx4 v[220:223], v30, s[4:7], s49 offen sc1
    s_waitcnt lgkmcnt(0)
    s_barrier
    s_add_u32 s56, s37, -1
    s_and_b32 s55, s56, 3
    s_mul_i32 s55, s55, 114688
    s_add_u32 s55, s55, 53248
    s_add_u32 s48, s38, s55
    s_and_b32 s55, s56, 1
    s_add_u32 s56, s56, 1
    v_mov_b32 v35, -16
    v_writelane_b32 v35, s56, 12
    s_mul_i32 s55, s55, 12288
    s_add_u32 m0, s54, s55
    buffer_load_dword v36, v33, s[4:7], s38 offen sc1
    s_add_u32 s56, s37, -2
    s_and_b32 s55, s56, 3
    s_mul_i32 s55, s55, 24576
    v_add_u32 v26, s55, v22
    v_add_u32 v27, s55, v23
    s_and_b32 s55, s56, 1
    s_mul_i32 s55, s55, 12288
    v_add_u32 v29, s55, v28
    s_mov_b32 s49, 7143424
    ds_read_b128 v[204:207], v26 offset:0
    ds_read_b128 v[180:183], v29 offset:0
    ds_read_b128 v[184:187], v29 offset:1024
    ds_read_b64 v[208:209], v27 offset:0
    ds_read_b128 v[188:191], v29 offset:2048
    ds_read_b128 v[212:215], v26 offset:1536
    ds_read_b128 v[192:195], v29 offset:3072
    ds_read_b128 v[196:199], v29 offset:4096
    ds_read_b64 v[216:217], v27 offset:1536
    ds_read_b128 v[200:203], v29 offset:5120
    s_waitcnt lgkmcnt(5)
    v_mfma_f32_16x16x32_bf16 v[220:223], v[180:183], v[204:207], 0
    v_mfma_f32_16x16x32_bf16 v[224:227], v[184:187], v[204:207], 0
    v_mfma_f32_16x16x32_bf16 v[224:227], v[188:191], v[208:211], v[224:227]
    ds_read_b128 v[204:207], v26 offset:3072
    ds_read_b128 v[180:183], v29 offset:6144
    ds_read_b128 v[184:187], v29 offset:7168
    ds_read_b64 v[208:209], v27 offset:3072
    ds_read_b128 v[188:191], v29 offset:8192
    s_waitcnt lgkmcnt(5)
    v_mfma_f32_16x16x32_bf16 v[220:223], v[192:195], v[212:215], v[220:223]
    v_mfma_f32_16x16x32_bf16 v[224:227], v[196:199], v[212:215], v[224:227]
    v_mfma_f32_16x16x32_bf16 v[224:227], v[200:203], v[216:219], v[224:227]
    ds_read_b128 v[212:215], v26 offset:4608
    ds_read_b128 v[192:195], v29 offset:9216
    ds_read_b128 v[196:199], v29 offset:10240
    ds_read_b64 v[216:217], v27 offset:4608
    ds_read_b128 v[200:203], v29 offset:11264
    s_waitcnt lgkmcnt(5)
    v_mfma_f32_16x16x32_bf16 v[220:223], v[180:183], v[204:207], v[220:223]
    v_mfma_f32_16x16x32_bf16 v[224:227], v[184:187], v[204:207], v[224:227]
    v_mfma_f32_16x16x32_bf16 v[224:227], v[188:191], v[208:211], v[224:227]
    s_waitcnt lgkmcnt(0)
    v_mfma_f32_16x16x32_bf16 v[220:223], v[192:195], v[212:215], v[220:223]
    v_mfma_f32_16x16x32_bf16 v[224:227], v[196:199], v[212:215], v[224:227]
    v_mfma_f32_16x16x32_bf16 v[224:227], v[200:203], v[216:219], v[224:227]
    s_nop 0
    v_cvt_pk_bf16_f32 v220, v220, v221
    v_cvt_pk_bf16_f32 v221, v222, v223
    s_nop 4
    v_cvt_pk_bf16_f32 v222, v224, v225
    v_cvt_pk_bf16_f32 v223, v226, v227
    v_mov_b32 v224, v220
    v_mov_b32 v225, v221
    v_mov_b32_dpp v220, v222 row_ror:8 row_mask:0xf bank_mask:0xc
    v_mov_b32_dpp v221, v223 row_ror:8 row_mask:0xf bank_mask:0xc
    v_mov_b32_dpp v222, v224 row_ror:8 row_mask:0xf bank_mask:0x3
    v_mov_b32_dpp v223, v225 row_ror:8 row_mask:0xf bank_mask:0x3
    buffer_store_dwordx4 v[220:223], v30, s[4:7], s49 offen sc1
    s_waitcnt vmcnt(1)
    v_cmp_lt_i32 vcc, v36, v35
    s_cbranch_vccz L_fok_46
L_fw_45:
    buffer_load_dword v36, v33, s[4:7], s38 offen sc1
    s_sub_u32 s36, s36, 1
    s_cbranch_scc1 L_exit
    s_waitcnt vmcnt(0)
    v_cmp_lt_i32 vcc, v36, v35
    s_cbranch_vccnz L_fw_45
L_fok_46:
    buffer_load_dwordx4 v37, s[4:7], s48 offen offset:0 sc1 lds
    buffer_load_dwordx4 v37, s[4:7], s48 offen offset:1024 sc1 lds
    buffer_load_dwordx4 v37, s[4:7], s48 offen offset:2048 sc1 lds
    s_waitcnt vmcnt(0) lgkmcnt(0)
    s_barrier
    s_add_u32 s56, s37, -1
    s_and_b32 s55, s56, 3
    s_mul_i32 s55, s55, 24576
    v_add_u32 v26, s55, v22
    v_add_u32 v27, s55, v23
    s_and_b32 s55, s56, 1
    s_mul_i32 s55, s55, 12288
    v_add_u32 v29, s55, v28
    s_mov_b32 s49, 5832704
    ds_read_b128 v[204:207], v26 offset:0
    ds_read_b128 v[180:183], v29 offset:0
    ds_read_b128 v[184:187], v29 offset:1024
    ds_read_b64 v[208:209], v27 offset:0
    ds_read_b128 v[188:191], v29 offset:2048
    ds_read_b128 v[212:215], v26 offset:1536
    ds_read_b128 v[192:195], v29 offset:3072
    ds_read_b128 v[196:199], v29 offset:4096
    ds_read_b64 v[216:217], v27 offset:1536
    ds_read_b128 v[200:203], v29 offset:5120
    s_waitcnt lgkmcnt(5)
    v_mfma_f32_16x16x32_bf16 v[220:223], v[180:183], v[204:207], 0
    v_mfma_f32_16x16x32_bf16 v[224:227], v[184:187], v[204:207], 0
    v_mfma_f32_16x16x32_bf16 v[224:227], v[188:191], v[208:211], v[224:227]
    ds_read_b128 v[204:207], v26 offset:3072
    ds_read_b128 v[180:183], v29 offset:6144
    ds_read_b128 v[184:187], v29 offset:7168
    ds_read_b64 v[208:209], v27 offset:3072
    ds_read_b128 v[188:191], v29 offset:8192
    s_waitcnt lgkmcnt(5)
    v_mfma_f32_16x16x32_bf16 v[220:223], v[192:195], v[212:215], v[220:223]
    v_mfma_f32_16x16x32_bf16 v[224:227], v[196:199], v[212:215], v[224:227]
    v_mfma_f32_16x16x32_bf16 v[224:227], v[200:203], v[216:219], v[224:227]
    ds_read_b128 v[212:215], v26 offset:4608
    ds_read_b128 v[192:195], v29 offset:9216
    ds_read_b128 v[196:199], v29 offset:10240
    ds_read_b64 v[216:217], v27 offset:4608
    ds_read_b128 v[200:203], v29 offset:11264
    s_waitcnt lgkmcnt(5)
    v_mfma_f32_16x16x32_bf16 v[220:223], v[180:183], v[204:207], v[220:223]
    v_mfma_f32_16x16x32_bf16 v[224:227], v[184:187], v[204:207], v[224:227]
    v_mfma_f32_16x16x32_bf16 v[224:227], v[188:191], v[208:211], v[224:227]
    s_waitcnt lgkmcnt(0)
    v_mfma_f32_16x16x32_bf16 v[220:223], v[192:195], v[212:215], v[220:223]
    v_mfma_f32_16x16x32_bf16 v[224:227], v[196:199], v[212:215], v[224:227]
    v_mfma_f32_16x16x32_bf16 v[224:227], v[200:203], v[216:219], v[224:227]
    s_nop 0
    v_cvt_pk_bf16_f32 v220, v220, v221
    v_cvt_pk_bf16_f32 v221, v222, v223
    s_nop 4
    v_cvt_pk_bf16_f32 v222, v224, v225
    v_cvt_pk_bf16_f32 v223, v226, v227
    v_mov_b32 v224, v220
    v_mov_b32 v225, v221
    v_mov_b32_dpp v220, v222 row_ror:8 row_mask:0xf bank_mask:0xc
    v_mov_b32_dpp v221, v223 row_ror:8 row_mask:0xf bank_mask:0xc
    v_mov_b32_dpp v222, v224 row_ror:8 row_mask:0xf bank_mask:0x3
    v_mov_b32_dpp v223, v225 row_ror:8 row_mask:0xf bank_mask:0x3
    buffer_store_dwordx4 v[220:223], v30, s[4:7], s49 offen sc1
    s_mov_b32 s51, 5832704
L_fp_47:
    buffer_load_dwordx4 v[120:123], v31, s[4:7], s51 offen sc1
    s_sub_u32 s36, s36, 1
    s_cbranch_scc1 L_exit
    s_waitcnt vmcnt(0)
    v_max3_u32 v41, v120, v121, v122
    v_max_u32 v41, v41, v123
    v_cmp_eq_u32 vcc, -1, v41
    s_cbranch_vccnz L_fp_47
    s_mov_b32 s51, 6160384
    buffer_load_dwordx4 v[148:151], v31, s[4:7], s51 offen sc1
    s_mov_b32 s51, 6488064
    buffer_load_dwordx4 v[152:155], v31, s[4:7], s51 offen sc1
    s_mov_b32 s51, 6815744
    buffer_load_dwordx4 v[156:159], v31, s[4:7], s51 offen sc1
    s_mov_b32 s51, 7143424
    buffer_load_dwordx4 v[160:163], v31, s[4:7], s51 offen sc1
    s_mov_b32 s52, 5079040
    v_mfma_f32_16x16x32_bf16 v[232:235], a[144:147], v[120:123], 0
    s_nop 7
    v_cndmask_b32 v234, v232, v233, s[58:59]
    v_cndmask_b32 v235, v233, v232, s[58:59]
    s_nop 1
    v_add_f32_dpp v235, v234, v235 row_ror:8 row_mask:0xf bank_mask:0xf
    v_cvt_pk_bf16_f32 v235, v235, v235
    buffer_store_short v235, v32, s[28:31], s52 offen offset:0
    s_waitcnt vmcnt(1)
    s_mov_b32 s52, 4751360
    v_mfma_f32_16x16x32_bf16 v[232:235], a[144:147], v[148:151], 0
    s_nop 7
    v_cndmask_b32 v234, v232, v233, s[58:59]
    v_cndmask_b32 v235, v233, v232, s[58:59]
    s_nop 1
    v_add_f32_dpp v235, v234, v235 row_ror:8 row_mask:0xf bank_mask:0xf
    v_cvt_pk_bf16_f32 v235, v235, v235
    buffer_store_short v235, v32, s[28:31], s52 offen offset:0
    s_mov_b32 s52, 4833280
    v_mfma_f32_16x16x32_bf16 v[232:235], a[144:147], v[152:155], 0
    s_nop 7
    v_cndmask_b32 v234, v232, v233, s[58:59]
    v_cndmask_b32 v235, v233, v232, s[58:59]
    s_nop 1
    v_add_f32_dpp v235, v234, v235 row_ror:8 row_mask:0xf bank_mask:0xf
    v_cvt_pk_bf16_f32 v235, v235, v235
    buffer_store_short v235, v32, s[28:31], s52 offen offset:0
    s_mov_b32 s52, 4915200
    v_mfma_f32_16x16x32_bf16 v[232:235], a[144:147], v[156:159], 0
    s_nop 7
    v_cndmask_b32 v234, v232, v233, s[58:59]
    v_cndmask_b32 v235, v233, v232, s[58:59]
    s_nop 1
    v_add_f32_dpp v235, v234, v235 row_ror:8 row_mask:0xf bank_mask:0xf
    v_cvt_pk_bf16_f32 v235, v235, v235
    buffer_store_short v235, v32, s[28:31], s52 offen offset:0
    s_mov_b32 s52, 4997120
    v_mfma_f32_16x16x32_bf16 v[232:235], a[144:147], v[160:163], 0
    s_nop 7
    v_cndmask_b32 v234, v232, v233, s[58:59]
    v_cndmask_b32 v235, v233, v232, s[58:59]
    s_nop 1
    v_add_f32_dpp v235, v234, v235 row_ror:8 row_mask:0xf bank_mask:0xf
    v_cvt_pk_bf16_f32 v235, v235, v235
    buffer_store_short v235, v32, s[28:31], s52 offen offset:0
    s_add_u32 s56, s37, 0
    s_and_b32 s55, s56, 3
    s_mul_i32 s55, s55, 114688
    s_add_u32 s55, s55, 53248
    s_add_u32 s48, s38, s55
    s_and_b32 s55, s56, 1
    s_add_u32 s56, s56, 1
    v_mov_b32 v35, -16
    v_writelane_b32 v35, s56, 12
    s_mul_i32 s55, s55, 12288
    s_add_u32 m0, s54, s55
    buffer_load_dword v36, v33, s[4:7], s38 offen sc1
    s_waitcnt vmcnt(0)
    v_cmp_lt_i32 vcc, v36, v35
    s_cbranch_vccz L_fok_49
L_fw_48:
    buffer_load_dword v36, v33, s[4:7], s38 offen sc1
    s_sub_u32 s36, s36, 1
    s_cbranch_scc1 L_exit
    s_waitcnt vmcnt(0)
    v_cmp_lt_i32 vcc, v36, v35
    s_cbranch_vccnz L_fw_48
L_fok_49:
    buffer_load_dwordx4 v37, s[4:7], s48 offen offset:0 sc1 lds
    buffer_load_dwordx4 v37, s[4:7], s48 offen offset:1024 sc1 lds
    buffer_load_dwordx4 v37, s[4:7], s48 offen offset:2048 sc1 lds
    s_waitcnt vmcnt(0) lgkmcnt(0)
    s_barrier
    s_add_u32 s56, s37, 0
    s_and_b32 s55, s56, 3
    s_mul_i32 s55, s55, 24576
    v_add_u32 v26, s55, v22
    v_add_u32 v27, s55, v23
    s_and_b32 s55, s56, 1
    s_mul_i32 s55, s55, 12288
    v_add_u32 v29, s55, v28
    s_mov_b32 s49, 5505024
    ds_read_b128 v[204:207], v26 offset:0
    ds_read_b128 v[180:183], v29 offset:0
    ds_read_b128 v[184:187], v29 offset:1024
    ds_read_b64 v[208:209], v27 offset:0
    ds_read_b128 v[188:191], v29 offset:2048
    ds_read_b128 v[212:215], v26 offset:1536
    ds_read_b128 v[192:195], v29 offset:3072
    ds_read_b128 v[196:199], v29 offset:4096
    ds_read_b64 v[216:217], v27 offset:1536
    ds_read_b128 v[200:203], v29 offset:5120
    s_waitcnt lgkmcnt(5)
    v_mfma_f32_16x16x32_bf16 v[220:223], v[180:183], v[204:207], 0
    v_mfma_f32_16x16x32_bf16 v[224:227], v[184:187], v[204:207], 0
    v_mfma_f32_16x16x32_bf16 v[224:227], v[188:191], v[208:211], v[224:227]
    ds_read_b128 v[204:207], v26 offset:3072
    ds_read_b128 v[180:183], v29 offset:6144
    ds_read_b128 v[184:187], v29 offset:7168
    ds_read_b64 v[208:209], v27 offset:3072
    ds_read_b128 v[188:191], v29 offset:8192
    s_waitcnt lgkmcnt(5)
    v_mfma_f32_16x16x32_bf16 v[220:223], v[192:195], v[212:215], v[220:223]
    v_mfma_f32_16x16x32_bf16 v[224:227], v[196:199], v[212:215], v[224:227]
    v_mfma_f32_16x16x32_bf16 v[224:227], v[200:203], v[216:219], v[224:227]
    ds_read_b128 v[212:215], v26 offset:4608
    ds_read_b128 v[192:195], v29 offset:9216
    ds_read_b128 v[196:199], v29 offset:10240
    ds_read_b64 v[216:217], v27 offset:4608
    ds_read_b128 v[200:203], v29 offset:11264
    s_waitcnt lgkmcnt(5)
    v_mfma_f32_16x16x32_bf16 v[220:223], v[180:183], v[204:207], v[220:223]
    v_mfma_f32_16x16x32_bf16 v[224:227], v[184:187], v[204:207], v[224:227]
    v_mfma_f32_16x16x32_bf16 v[224:227], v[188:191], v[208:211], v[224:227]
    s_waitcnt lgkmcnt(0)
    v_mfma_f32_16x16x32_bf16 v[220:223], v[192:195], v[212:215], v[220:223]
    v_mfma_f32_16x16x32_bf16 v[224:227], v[196:199], v[212:215], v[224:227]
    v_mfma_f32_16x16x32_bf16 v[224:227], v[200:203], v[216:219], v[224:227]
    s_nop 0
    v_cvt_pk_bf16_f32 v220, v220, v221
    v_cvt_pk_bf16_f32 v221, v222, v223
    s_nop 4
    v_cvt_pk_bf16_f32 v222, v224, v225
    v_cvt_pk_bf16_f32 v223, v226, v227
    v_mov_b32 v224, v220
    v_mov_b32 v225, v221
    v_mov_b32_dpp v220, v222 row_ror:8 row_mask:0xf bank_mask:0xc
    v_mov_b32_dpp v221, v223 row_ror:8 row_mask:0xf bank_mask:0xc
    v_mov_b32_dpp v222, v224 row_ror:8 row_mask:0xf bank_mask:0x3
    v_mov_b32_dpp v223, v225 row_ror:8 row_mask:0xf bank_mask:0x3
    buffer_store_dwordx4 v[220:223], v30, s[4:7], s49 offen sc1
    s_mov_b32 s51, 5505024
L_fp_50:
    buffer_load_dwordx4 v[120:123], v31, s[4:7], s51 offen sc1
    s_sub_u32 s36, s36, 1
    s_cbranch_scc1 L_exit
    s_waitcnt vmcnt(0)
    v_max3_u32 v41, v120, v121, v122
    v_max_u32 v41, v41, v123
    v_cmp_eq_u32 vcc, -1, v41
    s_cbranch_vccnz L_fp_50
    s_mov_b32 s52, 5160960
    v_mfma_f32_16x16x32_bf16 v[232:235], a[144:147], v[120:123], 0
    s_nop 7
    v_cndmask_b32 v234, v232, v233, s[58:59]
    v_cndmask_b32 v235, v233, v232, s[58:59]
    s_nop 1
    v_add_f32_dpp v235, v234, v235 row_ror:8 row_mask:0xf bank_mask:0xf
    v_cvt_pk_bf16_f32 v235, v235, v235
    buffer_store_short v235, v32, s[28:31], s52 offen offset:0
    s_endpgm
L_vm_35:
    buffer_load_dwordx4 v44, s[4:7], s43 offen offset:0 sc1 lds
    buffer_load_dwordx4 v44, s[4:7], s43 offen offset:1024 sc1 lds
    buffer_load_dwordx4 v44, s[4:7], s43 offen offset:2048 sc1 lds
    s_sub_u32 s36, s36, 1
    s_cbranch_scc1 L_exit
    v_add_u32 v5, s53, v12
    s_waitcnt vmcnt(0)
    ds_read_b128 v[136:139], v5 offset:0
    ds_read_b128 v[140:143], v5 offset:1024
    ds_read_b128 v[144:147], v5 offset:2048
    s_waitcnt lgkmcnt(0)
    v_max_u32 v4, v136, v137
    v_max3_u32 v4, v4, v138, v139
    v_max3_u32 v4, v4, v140, v141
    v_max3_u32 v4, v4, v142, v143
    v_max3_u32 v4, v4, v144, v145
    v_max3_u32 v4, v4, v146, v147
    v_cmp_eq_u32 vcc, -1, v4
    s_cbranch_vccnz L_vm_35
    buffer_load_dwordx4 v[92:95], v38, s[4:7], s43 offen offset:0 sc1
    buffer_load_dwordx4 v[96:99], v38, s[4:7], s43 offen offset:1280 sc1
    buffer_load_dwordx4 v[100:103], v38, s[4:7], s43 offen offset:2560 sc1
    buffer_load_dword v104, v39, s[4:7], s43 offen offset:0 sc1
    buffer_load_dword v105, v39, s[4:7], s43 offen offset:1280 sc1
    buffer_load_dword v106, v39, s[4:7], s43 offen offset:2560 sc1
    ds_read_b64_tr_b16 v[136:137], v16 offset:0
    ds_read_b64_tr_b16 v[138:139], v13 offset:0
    ds_read_b64_tr_b16 v[140:141], v16 offset:1024
    ds_read_b64_tr_b16 v[142:143], v13 offset:1024
    ds_read_b64_tr_b16 v[144:145], v16 offset:2048
    ds_read_b64_tr_b16 v[146:147], v13 offset:2048
    v_mov_b32 v148, 0
    v_mov_b32 v149, 0
    v_mov_b32 v150, 0
    v_mov_b32 v151, 0
    v_mov_b32 v152, 0
    v_mov_b32 v153, 0
    v_mov_b32 v154, 0
    v_mov_b32 v155, 0
    v_mov_b32 v156, 0
    v_mov_b32 v157, 0
    v_mov_b32 v158, 0
    v_mov_b32 v159, 0
    v_mov_b32 v160, 0
    v_mov_b32 v161, 0
    v_mov_b32 v162, 0
    v_mov_b32 v163, 0
    s_waitcnt lgkmcnt(0)
    v_smfmac_f32_16x16x64_bf16 v[148:151], v[136:139], a[0:7], v10
    v_smfmac_f32_16x16x64_bf16 v[152:155], v[136:139], a[24:31], v10
    v_smfmac_f32_16x16x64_bf16 v[156:159], v[136:139], a[48:55], v10
    v_smfmac_f32_16x16x64_bf16 v[160:163], v[136:139], a[72:79], v10
    v_smfmac_f32_16x16x64_bf16 v[148:151], v[140:143], a[8:15], v10
    v_smfmac_f32_16x16x64_bf16 v[152:155], v[140:143], a[32:39], v10
    v_smfmac_f32_16x16x64_bf16 v[156:159], v[140:143], a[56:63], v10
    v_smfmac_f32_16x16x64_bf16 v[160:163], v[140:143], a[80:87], v10
    v_smfmac_f32_16x16x64_bf16 v[148:151], v[144:147], a[16:23], v10
    v_smfmac_f32_16x16x64_bf16 v[152:155], v[144:147], a[40:47], v10
    v_smfmac_f32_16x16x64_bf16 v[156:159], v[144:147], a[64:71], v10
    v_smfmac_f32_16x16x64_bf16 v[160:163], v[144:147], a[88:95], v10
    v_pk_add_f32 v[148:149], v[148:149], v[150:151]
    v_cmp_u_f32 vcc, v148, v149
    v_cvt_pk_bf16_f32 v50, v148, v149
    v_cvt_pk_bf16_f32 v54, v148, v149
    v_pk_add_f32 v[152:153], v[152:153], v[154:155]
    v_cvt_pk_bf16_f32 v58, v152, v153
    v_cvt_pk_bf16_f32 v62, v152, v153
    v_pk_add_f32 v[156:157], v[156:157], v[158:159]
    v_cvt_pk_bf16_f32 v66, v156, v157
    v_cvt_pk_bf16_f32 v70, v156, v157
    v_pk_add_f32 v[160:161], v[160:161], v[162:163]
    v_cvt_pk_bf16_f32 v74, v160, v161
    v_cvt_pk_bf16_f32 v78, v160, v161
    s_cmp_eq_u32 s37, 63
    s_branch L_u_36
L_sp_39:
    v_max3_u32 v4, v104, v105, v106
    v_max3_u32 v4, v4, v92, v93
    v_max3_u32 v4, v4, v94, v95
    v_max3_u32 v4, v4, v96, v97
    v_max3_u32 v4, v4, v98, v99
    v_max3_u32 v4, v4, v100, v101
    v_max3_u32 v4, v4, v102, v103
    v_cmp_eq_u32 vcc, -1, v4
    s_cbranch_vccz L_sg_40
    buffer_load_dwordx4 v[92:95], v38, s[4:7], s43 offen offset:0 sc1
    buffer_load_dwordx4 v[96:99], v38, s[4:7], s43 offen offset:1280 sc1
    buffer_load_dwordx4 v[100:103], v38, s[4:7], s43 offen offset:2560 sc1
    buffer_load_dword v104, v39, s[4:7], s43 offen offset:0 sc1
    buffer_load_dword v105, v39, s[4:7], s43 offen offset:1280 sc1
    buffer_load_dword v106, v39, s[4:7], s43 offen offset:2560 sc1
    s_sub_u32 s36, s36, 1
    s_cbranch_scc1 L_exit
    s_branch L_sc_38
L_px_f:
    v_and_b32 v1, 15, v0
    v_lshrrev_b32 v2, 4, v0
    s_mul_i32 s90, s32, 12288
    v_lshl_add_u32 v10, v0, 4, s90
    s_mul_i32 s90, s32, 3072
    v_lshl_add_u32 v12, v0, 4, s90
    v_lshrrev_b32 v3, 2, v1
    v_lshlrev_b32 v3, 1, v3
    v_and_b32 v4, 1, v1
    v_or_b32 v3, v3, v4
    v_lshl_add_u32 v3, v2, 3, v3
    v_lshl_add_u32 v11, v3, 4, s90
    s_lshl_b32 s90, s32, 7
    v_min_u32 v3, 11, v0
    v_lshl_add_u32 v3, v3, 2, s90
    v_add_u32 v13, 458752, v3
    v_min_u32 v3, 2, v0
    v_lshl_add_u32 v3, v3, 2, s90
    v_add_u32 v14, 459264, v3
    v_add_u32 v22, 462336, v3
    s_add_u32 s90, s90, 459776
    v_mov_b32 v15, s90
    v_cmp_eq_u32 vcc, 0, v0
    v_mov_b32 v9, 2146435072
    s_nop 0
    v_cndmask_b32 v15, v9, v15, vcc
    s_nop 0
    v_mov_b32 v21, 0xd04e79ff
    s_mov_b32 s44, 0x3dd53b95
    v_lshl_add_u32 v3, v2, 2, 0
    v_cmp_le_u32 s[48:49], v3, v1
    v_lshl_add_u32 v3, v2, 2, 1
    v_cmp_le_u32 s[50:51], v3, v1
    v_lshl_add_u32 v3, v2, 2, 2
    v_cmp_le_u32 s[52:53], v3, v1
    v_lshl_add_u32 v3, v2, 2, 3
    v_cmp_le_u32 s[54:55], v3, v1
    v_mov_b32 v167, 0
    v_mov_b32 v171, 0
    v_mov_b32 v174, 0
    v_mov_b32 v175, 0
    s_waitcnt vmcnt(0)
    s_barrier
    s_mov_b32 s37, 0
    s_or_b32 s90, s34, s32
    s_cbranch_scc1 L_xg_51c
    v_lshlrev_b32 v1, 2, v0
L_arp_53:
    buffer_load_dword v2, v1, s[8:11], 0 offen sc1
    s_sub_u32 s36, s36, 1
    s_cbranch_scc1 L_exit
    s_waitcnt vmcnt(0)
    v_readlane_b32 s92, v2, 12
    v_readlane_b32 s93, v2, 44
    v_cmp_eq_u32 s[90:91], 32, v2
    s_add_u32 s92, s92, s93
    s_cmp_lg_u32 s92, 256
    s_cbranch_scc1 L_arp_53
    s_and_b32 s90, s90, s91
    s_and_b32 s90, s90, 15
    s_cmp_lg_u32 s90, 15
    s_cbranch_scc1 L_arr_52
    v_mov_b32 v1, 192
    v_mov_b32 v2, 1
    s_mov_b64 exec, 1
    buffer_store_dword v2, v1, s[8:11], 0 offen sc1
    s_mov_b64 exec, -1
L_arr_52:
L_xg_51c:
    s_barrier
    v_mov_b32 v1, 192
L_gw_54:
    buffer_load_dword v2, v1, s[8:11], 0 offen sc1
    s_sub_u32 s36, s36, 1
    s_cbranch_scc1 L_exit
    s_waitcnt vmcnt(0)
    v_readfirstlane_b32 s90, v2
    s_nop 0
    s_cmp_eq_u32 s90, 0
    s_cbranch_scc1 L_gw_54
    s_cmp_lg_u32 s90, 1
    s_cbranch_scc1 L_slow
    s_cmp_lg_u32 s32, 0
    s_cbranch_scc1 L_xg_51
    s_lshl_b32 s92, s34, 14
    s_add_u32 s92, s92, 1966080
    s_add_u32 s93, s92, 8192
    v_lshlrev_b32 v3, 4, v0
    buffer_store_dwordx4 v[24:27], v3, s[4:7], s92 offen offset:0 sc1
    buffer_store_dwordx4 v[24:27], v3, s[4:7], s93 offen offset:0 sc1
    buffer_store_dwordx4 v[24:27], v3, s[4:7], s92 offen offset:1024 sc1
    buffer_store_dwordx4 v[24:27], v3, s[4:7], s93 offen offset:1024 sc1
    buffer_store_dwordx4 v[24:27], v3, s[4:7], s92 offen offset:2048 sc1
    buffer_store_dwordx4 v[24:27], v3, s[4:7], s93 offen offset:2048 sc1
    buffer_store_dwordx4 v[24:27], v3, s[4:7], s92 offen offset:3072 sc1
    buffer_store_dwordx4 v[24:27], v3, s[4:7], s93 offen offset:3072 sc1
    v_mov_b32 v3, 0
    s_mov_b32 s56, -1
    s_mov_b32 s57, -1
    s_mov_b32 s62, 0
    s_mov_b32 s63, 0
    s_waitcnt vmcnt(0)
L_pr_55:
    s_memtime s[58:59]
    s_waitcnt lgkmcnt(0)
    buffer_load_dword v4, v3, s[4:7], s92 offen sc1
    s_waitcnt vmcnt(0)
    s_memtime s[60:61]
    s_waitcnt lgkmcnt(0)
    s_sub_u32 s60, s60, s58
    s_min_u32 s56, s56, s60
    s_memtime s[58:59]
    s_waitcnt lgkmcnt(0)
    buffer_load_dword v4, v3, s[4:7], s93 offen sc1
    s_waitcnt vmcnt(0)
    s_memtime s[60:61]
    s_waitcnt lgkmcnt(0)
    s_sub_u32 s60, s60, s58
    s_min_u32 s57, s57, s60
    buffer_load_dword v4, v13, s[4:7], s38 offen sc1
    v_add_u32 v3, 128, v3
    s_add_u32 s62, s62, 1
    s_waitcnt vmcnt(0)
    v_cmp_eq_u32 vcc, 0, v4
    s_nop 0
    s_cmp_eq_u64 vcc, 0
    s_addc_u32 s63, s63, 0
    s_cmp_ge_u32 s63, 2
    s_cselect_b32 s62, 32, s62
    s_min_u32 s58, s56, s57
    s_max_u32 s59, s56, s57
    s_sub_u32 s59, s59, s58
    s_cmp_ge_u32 s59, 150
    s_cselect_b32 s58, s58, -1
    s_cmp_le_u32 s58, 540
    s_cselect_b32 s62, 32, s62
    s_cmp_lt_u32 s62, 32
    s_cbranch_scc1 L_pr_55
    s_cmp_lt_u32 s57, s56
    s_cselect_b32 s62, 2, 1
    s_nop 0
    v_mov_b32 v3, 460288
    v_mov_b32 v4, s62
    buffer_store_dword v4, v3, s[4:7], s38 offen
    s_cmp_lg_u32 s34, 0
    s_cbranch_scc1 L_xg_51
    v_mov_b32 v3, 200
    buffer_store_dword v4, v3, s[8:11], 0 offen sc1
L_xg_51:
    s_barrier
    s_add_u32 s41, s38, 475136
L_pf_56:
    buffer_load_dword v16, v22, s[4:7], s38 offen sc1
    s_sub_u32 s36, s36, 1
    s_cbranch_scc1 L_exit
    s_waitcnt vmcnt(0)
    v_cmp_ge_u32 vcc, s37, v16
    s_cbranch_vccnz L_pf_56
    s_add_u32 s90, s41, 49152
    buffer_load_dwordx4 v[72:75], v10, s[4:7], s90 offen offset:0 sc1
    buffer_load_dwordx4 v[76:79], v10, s[4:7], s90 offen offset:1024 sc1
    buffer_load_dwordx4 v[80:83], v10, s[4:7], s90 offen offset:2048 sc1
    buffer_load_dwordx4 v[84:87], v10, s[4:7], s90 offen offset:3072 sc1
    s_add_u32 s90, s41, 53248
    buffer_load_dwordx4 v[88:91], v10, s[4:7], s90 offen offset:0 sc1
    buffer_load_dwordx4 v[92:95], v10, s[4:7], s90 offen offset:1024 sc1
    buffer_load_dwordx4 v[96:99], v10, s[4:7], s90 offen offset:2048 sc1
    buffer_load_dwordx4 v[100:103], v10, s[4:7], s90 offen offset:3072 sc1
    s_add_u32 s90, s41, 57344
    buffer_load_dwordx4 v[104:107], v10, s[4:7], s90 offen offset:0 sc1
    buffer_load_dwordx4 v[108:111], v10, s[4:7], s90 offen offset:1024 sc1
    buffer_load_dwordx4 v[112:115], v10, s[4:7], s90 offen offset:2048 sc1
    buffer_load_dwordx4 v[116:119], v10, s[4:7], s90 offen offset:3072 sc1
    s_add_u32 s90, s41, 0
    buffer_load_dwordx4 v[24:27], v10, s[4:7], s90 offen offset:0 sc1
    buffer_load_dwordx4 v[28:31], v10, s[4:7], s90 offen offset:1024 sc1
    buffer_load_dwordx4 v[32:35], v10, s[4:7], s90 offen offset:2048 sc1
    buffer_load_dwordx4 v[36:39], v10, s[4:7], s90 offen offset:3072 sc1
    s_add_u32 s90, s41, 4096
    buffer_load_dwordx4 v[40:43], v10, s[4:7], s90 offen offset:0 sc1
    buffer_load_dwordx4 v[44:47], v10, s[4:7], s90 offen offset:1024 sc1
    buffer_load_dwordx4 v[48:51], v10, s[4:7], s90 offen offset:2048 sc1
    buffer_load_dwordx4 v[52:55], v10, s[4:7], s90 offen offset:3072 sc1
    s_add_u32 s90, s41, 8192
    buffer_load_dwordx4 v[56:59], v10, s[4:7], s90 offen offset:0 sc1
    buffer_load_dwordx4 v[60:63], v10, s[4:7], s90 offen offset:1024 sc1
    buffer_load_dwordx4 v[64:67], v10, s[4:7], s90 offen offset:2048 sc1
    buffer_load_dwordx4 v[68:71], v10, s[4:7], s90 offen offset:3072 sc1
    s_waitcnt vmcnt(0)
L_px_loop_f:
    s_and_b32 s90, s37, 3
    s_mul_i32 s91, s90, 114688
    s_add_u32 s91, s91, s38
    s_add_u32 s42, s91, 40960
    s_add_u32 s43, s91, 53248
    s_add_u32 s90, s37, 1
    v_mov_b32 v17, s90
    s_and_b32 s90, s90, 3
    s_mul_i32 s91, s90, 98304
    s_add_u32 s91, s91, 475136
    s_add_u32 s41, s38, s91
    v_mfma_f32_16x16x32_bf16 v[144:147], v[72:75], v[24:27], 0
    v_mfma_f32_16x16x32_bf16 v[152:155], v[72:75], v[48:51], 0
    v_mfma_f32_16x16x32_bf16 v[156:159], v[96:99], v[48:51], 0
    v_mfma_f32_16x16x32_bf16 v[144:147], v[76:79], v[28:31], v[144:147]
    v_mfma_f32_16x16x32_bf16 v[152:155], v[76:79], v[52:55], v[152:155]
    v_mfma_f32_16x16x32_bf16 v[156:159], v[100:103], v[52:55], v[156:159]
    v_mfma_f32_16x16x32_bf16 v[144:147], v[80:83], v[32:35], v[144:147]
    v_mfma_f32_16x16x32_bf16 v[152:155], v[80:83], v[56:59], v[152:155]
    v_mfma_f32_16x16x32_bf16 v[156:159], v[104:107], v[56:59], v[156:159]
    v_mfma_f32_16x16x32_bf16 v[144:147], v[84:87], v[36:39], v[144:147]
    v_mfma_f32_16x16x32_bf16 v[152:155], v[84:87], v[60:63], v[152:155]
    v_mfma_f32_16x16x32_bf16 v[156:159], v[108:111], v[60:63], v[156:159]
    v_mfma_f32_16x16x32_bf16 v[144:147], v[88:91], v[40:43], v[144:147]
    v_mfma_f32_16x16x32_bf16 v[152:155], v[88:91], v[64:67], v[152:155]
    v_mfma_f32_16x16x32_bf16 v[156:159], v[112:115], v[64:67], v[156:159]
    v_mfma_f32_16x16x32_bf16 v[144:147], v[92:95], v[44:47], v[144:147]
    v_mfma_f32_16x16x32_bf16 v[152:155], v[92:95], v[68:71], v[152:155]
    v_mfma_f32_16x16x32_bf16 v[156:159], v[116:119], v[68:71], v[156:159]
    s_nop 0
    v_cndmask_b32 v144, v21, v144, s[48:49]
    v_cndmask_b32 v145, v21, v145, s[50:51]
    v_cndmask_b32 v146, v21, v146, s[52:53]
    v_cndmask_b32 v147, v21, v147, s[54:55]
    s_nop 2
    v_cndmask_b32 v156, v21, v156, s[48:49]
    v_cndmask_b32 v157, v21, v157, s[50:51]
    v_cndmask_b32 v158, v21, v158, s[52:53]
    v_cndmask_b32 v159, v21, v159, s[54:55]
L_pf_57:
    buffer_load_dword v16, v14, s[4:7], s38 offen sc1
    s_sub_u32 s36, s36, 1
    s_cbranch_scc1 L_exit
    s_waitcnt vmcnt(0)
    v_cmp_ge_u32 vcc, s37, v16
    s_cbranch_vccnz L_pf_57
    buffer_load_dwordx4 v[120:123], v11, s[4:7], s42 offen offset:0 sc1
    buffer_load_dwordx4 v[124:127], v11, s[4:7], s42 offen offset:512 sc1
    buffer_load_dwordx4 v[128:131], v11, s[4:7], s42 offen offset:1024 sc1
    buffer_load_dwordx4 v[132:135], v11, s[4:7], s42 offen offset:1536 sc1
    buffer_load_dwordx4 v[136:139], v11, s[4:7], s42 offen offset:2048 sc1
    buffer_load_dwordx4 v[140:143], v11, s[4:7], s42 offen offset:2560 sc1
    s_waitcnt vmcnt(5)
    v_mfma_f32_16x16x32_bf16 v[148:151], v[120:123], v[24:27], 0
    v_mfma_f32_16x16x32_bf16 v[160:163], v[120:123], v[48:51], 0
    s_waitcnt vmcnt(4)
    v_mfma_f32_16x16x32_bf16 v[148:151], v[124:127], v[28:31], v[148:151]
    v_mfma_f32_16x16x32_bf16 v[160:163], v[124:127], v[52:55], v[160:163]
    s_waitcnt vmcnt(3)
    v_mfma_f32_16x16x32_bf16 v[148:151], v[128:131], v[32:35], v[148:151]
    v_mfma_f32_16x16x32_bf16 v[160:163], v[128:131], v[56:59], v[160:163]
    s_waitcnt vmcnt(2)
    v_mfma_f32_16x16x32_bf16 v[148:151], v[132:135], v[36:39], v[148:151]
    v_mfma_f32_16x16x32_bf16 v[160:163], v[132:135], v[60:63], v[160:163]
    s_waitcnt vmcnt(1)
    v_mfma_f32_16x16x32_bf16 v[148:151], v[136:139], v[40:43], v[148:151]
    v_mfma_f32_16x16x32_bf16 v[160:163], v[136:139], v[64:67], v[160:163]
    s_waitcnt vmcnt(0)
    v_mfma_f32_16x16x32_bf16 v[148:151], v[140:143], v[44:47], v[148:151]
    v_mfma_f32_16x16x32_bf16 v[160:163], v[140:143], v[68:71], v[160:163]
    s_cmp_eq_u32 s37, 63
    s_nop 2
    s_cbranch_scc1 L_pxl_58
    s_add_u32 s90, s41, 49152
    v_max_f32 v18, v144, v145
    v_max3_f32 v18, v18, v146, v147
    v_max3_f32 v18, v18, v148, v149
    v_mov_b32 v19, v18
    buffer_load_dwordx4 v[72:75], v10, s[4:7], s90 offen offset:0 sc1
    s_nop 0
    v_permlane16_swap_b32 v18, v19
    v_max_f32 v18, v18, v19
    v_mov_b32 v19, v18
    s_nop 1
    v_permlane32_swap_b32 v18, v19
    buffer_load_dwordx4 v[76:79], v10, s[4:7], s90 offen offset:1024 sc1
    v_max_f32 v18, v18, v19
    v_mul_f32 v18, 0xbdd53b95, v18
    v_fma_f32 v144, v144, s44, v18
    v_fma_f32 v145, v145, s44, v18
    buffer_load_dwordx4 v[80:83], v10, s[4:7], s90 offen offset:2048 sc1
    v_fma_f32 v146, v146, s44, v18
    v_fma_f32 v147, v147, s44, v18
    v_fma_f32 v148, v148, s44, v18
    v_fma_f32 v149, v149, s44, v18
    buffer_load_dwordx4 v[84:87], v10, s[4:7], s90 offen offset:3072 sc1
    v_exp_f32 v144, v144
    v_exp_f32 v145, v145
    v_exp_f32 v146, v146
    v_exp_f32 v147, v147
    s_add_u32 s90, s41, 53248
    v_exp_f32 v148, v148
    v_exp_f32 v149, v149
    v_add_f32 v20, v144, v145
    v_add_f32 v20, v20, v146
    buffer_load_dwordx4 v[88:91], v10, s[4:7], s90 offen offset:0 sc1
    v_add_f32 v20, v20, v147
    v_add_f32 v20, v20, v148
    v_add_f32 v20, v20, v149
    v_mov_b32 v19, v20
    buffer_load_dwordx4 v[92:95], v10, s[4:7], s90 offen offset:1024 sc1
    s_nop 0
    v_permlane16_swap_b32 v20, v19
    v_add_f32 v20, v20, v19
    v_mov_b32 v19, v20
    s_nop 1
    v_permlane32_swap_b32 v20, v19
    buffer_load_dwordx4 v[96:99], v10, s[4:7], s90 offen offset:2048 sc1
    v_add_f32 v20, v20, v19
    v_rcp_f32 v20, v20
    s_nop 0
    v_mul_f32 v144, v144, v20
    v_mul_f32 v145, v145, v20
    buffer_load_dwordx4 v[100:103], v10, s[4:7], s90 offen offset:3072 sc1
    v_mul_f32 v146, v146, v20
    v_mul_f32 v147, v147, v20
    v_mul_f32 v148, v148, v20
    v_mul_f32 v149, v149, v20
    s_add_u32 s90, s41, 57344
    v_cvt_pk_bf16_f32 v164, v144, v145
    v_cvt_pk_bf16_f32 v165, v146, v147
    v_cvt_pk_bf16_f32 v166, v148, v149
    v_max_f32 v18, v152, v153
    buffer_load_dwordx4 v[104:107], v10, s[4:7], s90 offen offset:0 sc1
    v_max3_f32 v18, v18, v154, v155
    v_max3_f32 v18, v18, v160, v161
    v_max3_f32 v18, v18, v156, v157
    v_max3_f32 v18, v18, v158, v159
    buffer_load_dwordx4 v[108:111], v10, s[4:7], s90 offen offset:1024 sc1
    v_mov_b32 v19, v18
    s_nop 1
    v_permlane16_swap_b32 v18, v19
    v_max_f32 v18, v18, v19
    v_mov_b32 v19, v18
    buffer_load_dwordx4 v[112:115], v10, s[4:7], s90 offen offset:2048 sc1
    s_nop 0
    v_permlane32_swap_b32 v18, v19
    v_max_f32 v18, v18, v19
    v_mul_f32 v18, 0xbdd53b95, v18
    v_fma_f32 v152, v152, s44, v18
    buffer_load_dwordx4 v[116:119], v10, s[4:7], s90 offen offset:3072 sc1
    v_fma_f32 v153, v153, s44, v18
    v_fma_f32 v154, v154, s44, v18
    v_fma_f32 v155, v155, s44, v18
    v_fma_f32 v160, v160, s44, v18
    s_add_u32 s90, s41, 0
    v_fma_f32 v161, v161, s44, v18
    v_fma_f32 v156, v156, s44, v18
    v_fma_f32 v157, v157, s44, v18
    v_fma_f32 v158, v158, s44, v18
    buffer_load_dwordx4 v[24:27], v10, s[4:7], s90 offen offset:0 sc1
    v_fma_f32 v159, v159, s44, v18
    v_exp_f32 v152, v152
    v_exp_f32 v153, v153
    v_exp_f32 v154, v154
    buffer_load_dwordx4 v[28:31], v10, s[4:7], s90 offen offset:1024 sc1
    v_exp_f32 v155, v155
    v_exp_f32 v160, v160
    v_exp_f32 v161, v161
    v_exp_f32 v156, v156
    buffer_load_dwordx4 v[32:35], v10, s[4:7], s90 offen offset:2048 sc1
    v_exp_f32 v157, v157
    v_exp_f32 v158, v158
    v_exp_f32 v159, v159
    v_add_f32 v20, v152, v153
    buffer_load_dwordx4 v[36:39], v10, s[4:7], s90 offen offset:3072 sc1
    v_add_f32 v20, v20, v154
    v_add_f32 v20, v20, v155
    v_add_f32 v20, v20, v160
    v_add_f32 v20, v20, v161
    s_add_u32 s90, s41, 4096
    v_add_f32 v20, v20, v156
    v_add_f32 v20, v20, v157
    v_add_f32 v20, v20, v158
    v_add_f32 v20, v20, v159
    buffer_load_dwordx4 v[40:43], v10, s[4:7], s90 offen offset:0 sc1
    v_mov_b32 v19, v20
    s_nop 1
    v_permlane16_swap_b32 v20, v19
    v_add_f32 v20, v20, v19
    v_mov_b32 v19, v20
    buffer_load_dwordx4 v[44:47], v10, s[4:7], s90 offen offset:1024 sc1
    s_nop 0
    v_permlane32_swap_b32 v20, v19
    v_add_f32 v20, v20, v19
    v_rcp_f32 v20, v20
    s_nop 0
    v_mul_f32 v152, v152, v20
    buffer_load_dwordx4 v[48:51], v10, s[4:7], s90 offen offset:2048 sc1
    v_mul_f32 v153, v153, v20
    v_mul_f32 v154, v154, v20
    v_mul_f32 v155, v155, v20
    v_mul_f32 v160, v160, v20
    buffer_load_dwordx4 v[52:55], v10, s[4:7], s90 offen offset:3072 sc1
    v_mul_f32 v161, v161, v20
    v_mul_f32 v156, v156, v20
    v_mul_f32 v157, v157, v20
    v_mul_f32 v158, v158, v20
    s_add_u32 s90, s41, 8192
    v_mul_f32 v159, v159, v20
    v_cvt_pk_bf16_f32 v168, v152, v153
    v_cvt_pk_bf16_f32 v169, v154, v155
    v_cvt_pk_bf16_f32 v170, v160, v161
    buffer_load_dwordx4 v[56:59], v10, s[4:7], s90 offen offset:0 sc1
    v_cvt_pk_bf16_f32 v172, v156, v157
    v_cvt_pk_bf16_f32 v173, v158, v159
    buffer_load_dwordx4 v[60:63], v10, s[4:7], s90 offen offset:1024 sc1
    buffer_load_dwordx4 v[64:67], v10, s[4:7], s90 offen offset:2048 sc1
    buffer_load_dwordx4 v[68:71], v10, s[4:7], s90 offen offset:3072 sc1
    buffer_store_dwordx4 v[164:167], v12, s[4:7], s43 offen offset:0
    buffer_store_dwordx4 v[168:171], v12, s[4:7], s43 offen offset:1024
    buffer_store_dwordx4 v[172:175], v12, s[4:7], s43 offen offset:2048
    s_waitcnt vmcnt(0)
    buffer_store_dword v17, v15, s[4:7], s38 offen
    s_add_u32 s37, s37, 1
    s_branch L_px_loop_f
L_pxl_58:
    v_max_f32 v18, v144, v145
    v_max3_f32 v18, v18, v146, v147
    v_max3_f32 v18, v18, v148, v149
    v_mov_b32 v19, v18
    s_nop 1
    v_permlane16_swap_b32 v18, v19
    v_max_f32 v18, v18, v19
    v_mov_b32 v19, v18
    s_nop 1
    v_permlane32_swap_b32 v18, v19
    v_max_f32 v18, v18, v19
    v_mul_f32 v18, 0xbdd53b95, v18
    v_fma_f32 v144, v144, s44, v18
    v_fma_f32 v145, v145, s44, v18
    v_fma_f32 v146, v146, s44, v18
    v_fma_f32 v147, v147, s44, v18
    v_fma_f32 v148, v148, s44, v18
    v_fma_f32 v149, v149, s44, v18
    v_exp_f32 v144, v144
    v_exp_f32 v145, v145
    v_exp_f32 v146, v146
    v_exp_f32 v147, v147
    v_exp_f32 v148, v148
    v_exp_f32 v149, v149
    v_add_f32 v20, v144, v145
    v_add_f32 v20, v20, v146
    v_add_f32 v20, v20, v147
    v_add_f32 v20, v20, v148
    v_add_f32 v20, v20, v149
    v_mov_b32 v19, v20
    s_nop 1
    v_permlane16_swap_b32 v20, v19
    v_add_f32 v20, v20, v19
    v_mov_b32 v19, v20
    s_nop 1
    v_permlane32_swap_b32 v20, v19
    v_add_f32 v20, v20, v19
    v_rcp_f32 v20, v20
    s_nop 0
    v_mul_f32 v144, v144, v20
    v_mul_f32 v145, v145, v20
    v_mul_f32 v146, v146, v20
    v_mul_f32 v147, v147, v20
    v_mul_f32 v148, v148, v20
    v_mul_f32 v149, v149, v20
    v_cvt_pk_bf16_f32 v164, v144, v145
    v_cvt_pk_bf16_f32 v165, v146, v147
    v_cvt_pk_bf16_f32 v166, v148, v149
    v_max_f32 v18, v152, v153
    v_max3_f32 v18, v18, v154, v155
    v_max3_f32 v18, v18, v160, v161
    v_max3_f32 v18, v18, v156, v157
    v_max3_f32 v18, v18, v158, v159
    v_mov_b32 v19, v18
    s_nop 1
    v_permlane16_swap_b32 v18, v19
    v_max_f32 v18, v18, v19
    v_mov_b32 v19, v18
    s_nop 1
    v_permlane32_swap_b32 v18, v19
    v_max_f32 v18, v18, v19
    v_mul_f32 v18, 0xbdd53b95, v18
    v_fma_f32 v152, v152, s44, v18
    v_fma_f32 v153, v153, s44, v18
    v_fma_f32 v154, v154, s44, v18
    v_fma_f32 v155, v155, s44, v18
    v_fma_f32 v160, v160, s44, v18
    v_fma_f32 v161, v161, s44, v18
    v_fma_f32 v156, v156, s44, v18
    v_fma_f32 v157, v157, s44, v18
    v_fma_f32 v158, v158, s44, v18
    v_fma_f32 v159, v159, s44, v18
    v_exp_f32 v152, v152
    v_exp_f32 v153, v153
    v_exp_f32 v154, v154
    v_exp_f32 v155, v155
    v_exp_f32 v160, v160
    v_exp_f32 v161, v161
    v_exp_f32 v156, v156
    v_exp_f32 v157, v157
    v_exp_f32 v158, v158
    v_exp_f32 v159, v159
    v_add_f32 v20, v152, v153
    v_add_f32 v20, v20, v154
    v_add_f32 v20, v20, v155
    v_add_f32 v20, v20, v160
    v_add_f32 v20, v20, v161
    v_add_f32 v20, v20, v156
    v_add_f32 v20, v20, v157
    v_add_f32 v20, v20, v158
    v_add_f32 v20, v20, v159
    v_mov_b32 v19, v20
    s_nop 1
    v_permlane16_swap_b32 v20, v19
    v_add_f32 v20, v20, v19
    v_mov_b32 v19, v20
    s_nop 1
    v_permlane32_swap_b32 v20, v19
    v_add_f32 v20, v20, v19
    v_rcp_f32 v20, v20
    s_nop 0
    v_mul_f32 v152, v152, v20
    v_mul_f32 v153, v153, v20
    v_mul_f32 v154, v154, v20
    v_mul_f32 v155, v155, v20
    v_mul_f32 v160, v160, v20
    v_mul_f32 v161, v161, v20
    v_mul_f32 v156, v156, v20
    v_mul_f32 v157, v157, v20
    v_mul_f32 v158, v158, v20
    v_mul_f32 v159, v159, v20
    v_cvt_pk_bf16_f32 v168, v152, v153
    v_cvt_pk_bf16_f32 v169, v154, v155
    v_cvt_pk_bf16_f32 v170, v160, v161
    v_cvt_pk_bf16_f32 v172, v156, v157
    v_cvt_pk_bf16_f32 v173, v158, v159
    buffer_store_dwordx4 v[164:167], v12, s[4:7], s43 offen offset:0
    buffer_store_dwordx4 v[168:171], v12, s[4:7], s43 offen offset:1024
    buffer_store_dwordx4 v[172:175], v12, s[4:7], s43 offen offset:2048
    s_waitcnt vmcnt(0)
    buffer_store_dword v17, v15, s[4:7], s38 offen
    s_endpgm
L_pa_f:
    v_mov_b32 v1, 192
L_gw_59:
    buffer_load_dword v2, v1, s[8:11], 0 offen sc1
    s_sub_u32 s36, s36, 1
    s_cbranch_scc1 L_exit
    s_waitcnt vmcnt(0)
    v_readfirstlane_b32 s90, v2
    s_nop 0
    s_cmp_eq_u32 s90, 0
    s_cbranch_scc1 L_gw_59
    s_cmp_lg_u32 s90, 1
    s_cbranch_scc1 L_slow
    s_branch L_pa_body
L_pa_body:
    s_sub_u32 s90, s35, 29
    s_cmp_ge_u32 s90, 3
    s_cbranch_scc1 L_pa_end
    s_mul_i32 s52, s90, 3
    s_add_u32 s52, s52, s34
    s_and_b32 s52, s52, 7
    s_cmp_eq_u32 s90, 0
    s_cselect_b32 s91, 0x76543210, 0
    s_cmp_eq_u32 s90, 1
    s_cselect_b32 s91, 0x54c321b0, s91
    s_cmp_eq_u32 s90, 2
    s_cselect_b32 s91, 0xf9ea87d6, s91
    s_lshl_b32 s92, s34, 2
    s_lshr_b32 s91, s91, s92
    s_and_b32 s91, s91, 15
    s_min_u32 s90, s90, 1
    s_lshl_b32 s90, s90, 3
    s_add_u32 s54, s90, s91
    s_mul_i32 s40, s54, 112
    s_lshl_b32 s90, s32, 5
    s_add_u32 s40, s40, s90
    s_sub_u32 s40, s40, 16
    s_mov_b32 s12, s64
    s_and_b32 s13, s65, 0xffff
    s_mov_b32 s14, 2621440
    s_mov_b32 s15, 0x20000
    s_mov_b32 s16, s66
    s_and_b32 s17, s67, 0xffff
    s_mov_b32 s18, 2457600
    s_mov_b32 s19, 0x20000
    s_mov_b32 s20, s68
    s_and_b32 s21, s69, 0xffff
    s_mov_b32 s22, 819200
    s_mov_b32 s23, 0x20000
    v_and_b32 v1, 15, v0
    v_lshrrev_b32 v2, 4, v0
    s_add_u32 s90, s40, 0
    v_add_u32 v3, s90, v1
    v_cmp_gt_u32 vcc, 2048, v3
    v_mul_u32_u24 v3, 1280, v3
    v_lshl_add_u32 v3, v2, 4, v3
    v_mov_b32 v4, 2146435072
    v_cndmask_b32 v3, v4, v3, vcc
    buffer_load_dwordx4 a[0:3], v3, s[12:15], 0 offen offset:0
    buffer_load_dwordx4 a[4:7], v3, s[12:15], 0 offen offset:64
    buffer_load_dwordx4 a[8:11], v3, s[12:15], 0 offen offset:128
    buffer_load_dwordx4 a[12:15], v3, s[12:15], 0 offen offset:192
    buffer_load_dwordx4 a[16:19], v3, s[12:15], 0 offen offset:256
    buffer_load_dwordx4 a[20:23], v3, s[12:15], 0 offen offset:320
    buffer_load_dwordx4 a[24:27], v3, s[12:15], 0 offen offset:384
    buffer_load_dwordx4 a[28:31], v3, s[12:15], 0 offen offset:448
    buffer_load_dwordx4 a[32:35], v3, s[12:15], 0 offen offset:512
    buffer_load_dwordx4 a[36:39], v3, s[12:15], 0 offen offset:576
    buffer_load_dwordx4 a[40:43], v3, s[12:15], 0 offen offset:640
    buffer_load_dwordx4 a[44:47], v3, s[12:15], 0 offen offset:704
    buffer_load_dwordx4 a[48:51], v3, s[12:15], 0 offen offset:768
    buffer_load_dwordx4 a[52:55], v3, s[12:15], 0 offen offset:832
    buffer_load_dwordx4 a[56:59], v3, s[12:15], 0 offen offset:896
    buffer_load_dwordx4 a[60:63], v3, s[12:15], 0 offen offset:960
    buffer_load_dwordx4 a[64:67], v3, s[12:15], 0 offen offset:1024
    buffer_load_dwordx4 a[68:71], v3, s[12:15], 0 offen offset:1088
    buffer_load_dwordx4 a[72:75], v3, s[12:15], 0 offen offset:1152
    buffer_load_dwordx4 a[76:79], v3, s[12:15], 0 offen offset:1216
    s_add_u32 s90, s40, 16
    v_add_u32 v3, s90, v1
    v_cmp_gt_u32 vcc, 2048, v3
    v_mul_u32_u24 v3, 1280, v3
    v_lshl_add_u32 v3, v2, 4, v3
    v_mov_b32 v4, 2146435072
    v_cndmask_b32 v3, v4, v3, vcc
    buffer_load_dwordx4 a[80:83], v3, s[12:15], 0 offen offset:0
    buffer_load_dwordx4 a[84:87], v3, s[12:15], 0 offen offset:64
    buffer_load_dwordx4 a[88:91], v3, s[12:15], 0 offen offset:128
    buffer_load_dwordx4 a[92:95], v3, s[12:15], 0 offen offset:192
    buffer_load_dwordx4 a[96:99], v3, s[12:15], 0 offen offset:256
    buffer_load_dwordx4 a[100:103], v3, s[12:15], 0 offen offset:320
    buffer_load_dwordx4 a[104:107], v3, s[12:15], 0 offen offset:384
    buffer_load_dwordx4 a[108:111], v3, s[12:15], 0 offen offset:448
    buffer_load_dwordx4 a[112:115], v3, s[12:15], 0 offen offset:512
    buffer_load_dwordx4 a[116:119], v3, s[12:15], 0 offen offset:576
    buffer_load_dwordx4 a[120:123], v3, s[12:15], 0 offen offset:640
    buffer_load_dwordx4 a[124:127], v3, s[12:15], 0 offen offset:704
    buffer_load_dwordx4 a[128:131], v3, s[12:15], 0 offen offset:768
    buffer_load_dwordx4 a[132:135], v3, s[12:15], 0 offen offset:832
    buffer_load_dwordx4 a[136:139], v3, s[12:15], 0 offen offset:896
    buffer_load_dwordx4 a[140:143], v3, s[12:15], 0 offen offset:960
    buffer_load_dwordx4 a[144:147], v3, s[12:15], 0 offen offset:1024
    buffer_load_dwordx4 a[148:151], v3, s[12:15], 0 offen offset:1088
    buffer_load_dwordx4 a[152:155], v3, s[12:15], 0 offen offset:1152
    buffer_load_dwordx4 a[156:159], v3, s[12:15], 0 offen offset:1216
    v_add_u32 v3, 0, v0
    v_mul_u32_u24 v4, 6554, v3
    v_lshrrev_b32 v4, 16, v4
    v_mul_u32_u24 v5, 10, v4
    v_sub_u32 v5, v3, v5
    v_and_b32 v6, 19, v4
    v_and_b32 v7, 4, v4
    v_lshl_or_b32 v6, v7, 1, v6
    v_and_b32 v7, 8, v4
    v_lshrrev_b32 v7, 1, v7
    v_or_b32 v6, v6, v7
    s_lshl_b32 s90, s32, 5
    v_add_u32 v6, s90, v6
    v_mul_u32_u24 v6, 3840, v6
    v_lshl_add_u32 v10, v5, 4, v6
    v_add_u32 v3, 64, v0
    v_mul_u32_u24 v4, 6554, v3
    v_lshrrev_b32 v4, 16, v4
    v_mul_u32_u24 v5, 10, v4
    v_sub_u32 v5, v3, v5
    v_and_b32 v6, 19, v4
    v_and_b32 v7, 4, v4
    v_lshl_or_b32 v6, v7, 1, v6
    v_and_b32 v7, 8, v4
    v_lshrrev_b32 v7, 1, v7
    v_or_b32 v6, v6, v7
    s_lshl_b32 s90, s32, 5
    v_add_u32 v6, s90, v6
    v_mul_u32_u24 v6, 3840, v6
    v_lshl_add_u32 v11, v5, 4, v6
    v_add_u32 v3, 128, v0
    v_mul_u32_u24 v4, 6554, v3
    v_lshrrev_b32 v4, 16, v4
    v_mul_u32_u24 v5, 10, v4
    v_sub_u32 v5, v3, v5
    v_and_b32 v6, 19, v4
    v_and_b32 v7, 4, v4
    v_lshl_or_b32 v6, v7, 1, v6
    v_and_b32 v7, 8, v4
    v_lshrrev_b32 v7, 1, v7
    v_or_b32 v6, v6, v7
    s_lshl_b32 s90, s32, 5
    v_add_u32 v6, s90, v6
    v_mul_u32_u24 v6, 3840, v6
    v_lshl_add_u32 v12, v5, 4, v6
    v_add_u32 v3, 192, v0
    v_mul_u32_u24 v4, 6554, v3
    v_lshrrev_b32 v4, 16, v4
    v_mul_u32_u24 v5, 10, v4
    v_sub_u32 v5, v3, v5
    v_and_b32 v6, 19, v4
    v_and_b32 v7, 4, v4
    v_lshl_or_b32 v6, v7, 1, v6
    v_and_b32 v7, 8, v4
    v_lshrrev_b32 v7, 1, v7
    v_or_b32 v6, v6, v7
    s_lshl_b32 s90, s32, 5
    v_add_u32 v6, s90, v6
    v_mul_u32_u24 v6, 3840, v6
    v_lshl_add_u32 v13, v5, 4, v6
    v_add_u32 v3, 256, v0
    v_mul_u32_u24 v4, 6554, v3
    v_lshrrev_b32 v4, 16, v4
    v_mul_u32_u24 v5, 10, v4
    v_sub_u32 v5, v3, v5
    v_and_b32 v6, 19, v4
    v_and_b32 v7, 4, v4
    v_lshl_or_b32 v6, v7, 1, v6
    v_and_b32 v7, 8, v4
    v_lshrrev_b32 v7, 1, v7
    v_or_b32 v6, v6, v7
    s_lshl_b32 s90, s32, 5
    v_add_u32 v6, s90, v6
    v_mul_u32_u24 v6, 3840, v6
    v_lshl_add_u32 v14, v5, 4, v6
    v_lshrrev_b32 v3, 2, v1
    v_and_b32 v4, 3, v1
    v_and_b32 v5, 1, v2
    v_lshl_add_u32 v3, v5, 2, v3
    v_lshrrev_b32 v6, 1, v2
    v_lshl_add_u32 v3, v6, 4, v3
    v_mul_u32_u24 v3, 160, v3
    v_lshl_add_u32 v15, v4, 3, v3
    s_lshl_b32 s90, s32, 5
    v_add_u32 v3, s90, v1
    v_mul_u32_u24 v3, 168, v3
    v_add_u32 v3, 81920, v3
    v_lshl_add_u32 v17, v2, 3, v3
    v_lshl_add_u32 v28, v2, 4, v3
    v_add_u32 v28, -32, v28
    v_lshl_add_u32 v3, v5, 4, v1
    v_add_u32 v4, s90, v3
    v_add_u32 v3, s40, v3
    v_cmp_le_u32 s[92:93], 16, v4
    v_cmp_gt_u32 vcc, 2048, v3
    s_nop 0
    s_and_b64 vcc, vcc, s[92:93]
    v_mul_u32_u24 v3, 2560, v3
    v_lshl_add_u32 v3, v6, 4, v3
    v_mov_b32 v4, 2146435072
    v_cndmask_b32 v19, v4, v3, vcc
    v_and_b32 v3, 31, v0
    v_add_u32 v24, s40, v3
    v_add_u32 v3, s90, v3
    v_mul_u32_u24 v3, 168, v3
    v_lshrrev_b32 v4, 5, v0
    v_mul_u32_u24 v4, 40, v4
    v_add_u32 v3, v3, v4
    v_add_u32 v20, 81920, v3
    v_add_u32 v21, 101072, v3
    v_mov_b32 v27, 0xcf8547b1
    s_mov_b32 s49, 0x3ea52b5c
    s_cmp_lt_u32 s54, 19
    s_cbranch_scc1 L_pa_rows
    s_mov_b32 s24, s70
    s_and_b32 s25, s71, 0xffff
    s_mov_b32 s26, 2621440
    s_mov_b32 s27, 0x20000
    s_sub_u32 s90, s54, 19
    s_lshl_b32 s90, s90, 2
    s_add_u32 s90, s90, s32
    s_lshl_b32 s90, s90, 11
    v_lshl_add_u32 v3, v0, 4, s90
    s_mov_b32 s91, 245760
L_pa_xw:
    buffer_load_dwordx4 v[248:251], v3, s[24:27], s91 offen
    buffer_load_dwordx4 v[248:251], v3, s[24:27], s91 offen offset:1024
    s_add_u32 s91, s91, 40960
    s_waitcnt vmcnt(20)
    s_cmp_lt_u32 s91, 2621440
    s_cbranch_scc1 L_pa_xw
    s_mov_b32 s46, 0
    s_mov_b32 s47, 0
    s_mul_i32 s43, s52, 160
    s_mov_b32 s44, 0
    s_mov_b32 s45, 0
    s_mov_b32 s51, 45
    s_mov_b32 s48, s52
    s_mov_b32 s53, 0
L_pa_pf_60:
    s_mul_i32 s90, s32, 5120
    s_add_u32 m0, s90, s47
    s_mul_i32 s91, s44, 491520
    s_add_u32 s91, s91, s43
    buffer_load_dwordx4 v[248:251], v10, s[16:19], s91 offen
    s_add_u32 s47, s47, 20480
    s_cmp_eq_u32 s47, 81920
    s_cselect_b32 s47, 0, s47
    s_cmp_lg_u32 s51, 0
    s_cselect_b32 s90, 1, 0
    s_sub_u32 s51, s51, s90
    s_add_u32 s44, s44, s90
    s_cmp_eq_u32 s44, 5
    s_cselect_b32 s44, 0, s44
    s_cselect_b32 s90, 1280, 0
    s_addc_u32 s45, s45, 0
    s_add_u32 s43, s43, s90
    s_cmp_eq_u32 s45, 3
    s_cselect_b32 s45, 0, s45
    s_cselect_b32 s90, 3680, 0
    s_cmp_eq_u32 s43, 4960
    s_cselect_b32 s90, s43, s90
    s_sub_u32 s43, s43, s90
    s_add_u32 m0, m0, 1024
    buffer_load_dwordx4 v[248:251], v11, s[16:19], s91 offen
    s_add_u32 m0, m0, 1024
    buffer_load_dwordx4 v[248:251], v12, s[16:19], s91 offen
    s_add_u32 m0, m0, 1024
    buffer_load_dwordx4 v[248:251], v13, s[16:19], s91 offen
    s_add_u32 m0, m0, 1024
    buffer_load_dwordx4 v[248:251], v14, s[16:19], s91 offen
    s_waitcnt vmcnt(20)
    s_cmp_lg_u32 s51, 0
    s_cbranch_scc1 L_pa_pf_60
    v_add_u32 v3, 0, v0
    v_mul_u32_u24 v4, 6554, v3
    v_lshrrev_b32 v4, 16, v4
    v_mul_u32_u24 v5, 10, v4
    v_sub_u32 v5, v3, v5
    v_and_b32 v6, 19, v4
    v_and_b32 v7, 4, v4
    v_lshl_or_b32 v6, v7, 1, v6
    v_and_b32 v7, 8, v4
    v_lshrrev_b32 v7, 1, v7
    v_or_b32 v6, v6, v7
    s_lshl_b32 s90, s32, 5
    v_add_u32 v6, s90, v6
    v_mul_u32_u24 v6, 1280, v6
    v_lshl_add_u32 v10, v5, 4, v6
    v_add_u32 v3, 64, v0
    v_mul_u32_u24 v4, 6554, v3
    v_lshrrev_b32 v4, 16, v4
    v_mul_u32_u24 v5, 10, v4
    v_sub_u32 v5, v3, v5
    v_and_b32 v6, 19, v4
    v_and_b32 v7, 4, v4
    v_lshl_or_b32 v6, v7, 1, v6
    v_and_b32 v7, 8, v4
    v_lshrrev_b32 v7, 1, v7
    v_or_b32 v6, v6, v7
    s_lshl_b32 s90, s32, 5
    v_add_u32 v6, s90, v6
    v_mul_u32_u24 v6, 1280, v6
    v_lshl_add_u32 v11, v5, 4, v6
    v_add_u32 v3, 128, v0
    v_mul_u32_u24 v4, 6554, v3
    v_lshrrev_b32 v4, 16, v4
    v_mul_u32_u24 v5, 10, v4
    v_sub_u32 v5, v3, v5
    v_and_b32 v6, 19, v4
    v_and_b32 v7, 4, v4
    v_lshl_or_b32 v6, v7, 1, v6
    v_and_b32 v7, 8, v4
    v_lshrrev_b32 v7, 1, v7
    v_or_b32 v6, v6, v7
    s_lshl_b32 s90, s32, 5
    v_add_u32 v6, s90, v6
    v_mul_u32_u24 v6, 1280, v6
    v_lshl_add_u32 v12, v5, 4, v6
    v_add_u32 v3, 192, v0
    v_mul_u32_u24 v4, 6554, v3
    v_lshrrev_b32 v4, 16, v4
    v_mul_u32_u24 v5, 10, v4
    v_sub_u32 v5, v3, v5
    v_and_b32 v6, 19, v4
    v_and_b32 v7, 4, v4
    v_lshl_or_b32 v6, v7, 1, v6
    v_and_b32 v7, 8, v4
    v_lshrrev_b32 v7, 1, v7
    v_or_b32 v6, v6, v7
    s_lshl_b32 s90, s32, 5
    v_add_u32 v6, s90, v6
    v_mul_u32_u24 v6, 1280, v6
    v_lshl_add_u32 v13, v5, 4, v6
    v_add_u32 v3, 256, v0
    v_mul_u32_u24 v4, 6554, v3
    v_lshrrev_b32 v4, 16, v4
    v_mul_u32_u24 v5, 10, v4
    v_sub_u32 v5, v3, v5
    v_and_b32 v6, 19, v4
    v_and_b32 v7, 4, v4
    v_lshl_or_b32 v6, v7, 1, v6
    v_and_b32 v7, 8, v4
    v_lshrrev_b32 v7, 1, v7
    v_or_b32 v6, v6, v7
    s_lshl_b32 s90, s32, 5
    v_add_u32 v6, s90, v6
    v_mul_u32_u24 v6, 1280, v6
    v_lshl_add_u32 v14, v5, 4, v6
    s_mov_b32 s46, 0
    s_mov_b32 s47, 0
    s_mul_i32 s43, s52, 160
    s_mov_b32 s44, 0
    s_mov_b32 s45, 0
    s_mov_b32 s51, 40
    s_mov_b32 s48, s52
    s_mov_b32 s53, 0
L_pa_pf_61:
    s_mul_i32 s90, s32, 5120
    s_add_u32 m0, s90, s47
    s_mul_i32 s91, s44, 163840
    s_add_u32 s91, s91, s43
    buffer_load_dwordx4 v[248:251], v10, s[20:23], s91 offen
    s_add_u32 s47, s47, 20480
    s_cmp_eq_u32 s47, 81920
    s_cselect_b32 s47, 0, s47
    s_cmp_lg_u32 s51, 0
    s_cselect_b32 s90, 1, 0
    s_sub_u32 s51, s51, s90
    s_add_u32 s44, s44, s90
    s_cmp_eq_u32 s44, 5
    s_cselect_b32 s44, 0, s44
    s_cselect_b32 s90, 160, 0
    s_add_u32 s43, s43, s90
    s_cmp_eq_u32 s43, 1280
    s_cselect_b32 s43, 0, s43
    s_add_u32 m0, m0, 1024
    buffer_load_dwordx4 v[248:251], v11, s[20:23], s91 offen
    s_add_u32 m0, m0, 1024
    buffer_load_dwordx4 v[248:251], v12, s[20:23], s91 offen
    s_add_u32 m0, m0, 1024
    buffer_load_dwordx4 v[248:251], v13, s[20:23], s91 offen
    s_add_u32 m0, m0, 1024
    buffer_load_dwordx4 v[248:251], v14, s[20:23], s91 offen
    s_waitcnt vmcnt(20)
    s_cmp_lg_u32 s51, 0
    s_cbranch_scc1 L_pa_pf_61
    s_branch L_pa_end
L_pa_rows:
    s_mov_b32 s46, 0
    s_mov_b32 s47, 0
    s_mul_i32 s43, s52, 160
    s_mov_b32 s44, 0
    s_mov_b32 s45, 0
    s_mov_b32 s51, 119
    s_mov_b32 s48, s52
    s_mov_b32 s53, 0
    s_mul_i32 s90, s32, 5120
    s_add_u32 m0, s90, s47
    s_mul_i32 s91, s44, 491520
    s_add_u32 s91, s91, s43
    buffer_load_dwordx4 v10, s[16:19], s91 offen lds
    s_add_u32 s47, s47, 20480
    s_cmp_eq_u32 s47, 81920
    s_cselect_b32 s47, 0, s47
    s_cmp_lg_u32 s51, 0
    s_cselect_b32 s90, 1, 0
    s_sub_u32 s51, s51, s90
    s_add_u32 s44, s44, s90
    s_cmp_eq_u32 s44, 5
    s_cselect_b32 s44, 0, s44
    s_cselect_b32 s90, 1280, 0
    s_addc_u32 s45, s45, 0
    s_add_u32 s43, s43, s90
    s_cmp_eq_u32 s45, 3
    s_cselect_b32 s45, 0, s45
    s_cselect_b32 s90, 3680, 0
    s_cmp_eq_u32 s43, 4960
    s_cselect_b32 s90, s43, s90
    s_sub_u32 s43, s43, s90
    s_add_u32 m0, m0, 1024
    s_nop 0
    buffer_load_dwordx4 v11, s[16:19], s91 offen lds
    s_add_u32 m0, m0, 1024
    s_nop 0
    buffer_load_dwordx4 v12, s[16:19], s91 offen lds
    s_add_u32 m0, m0, 1024
    s_nop 0
    buffer_load_dwordx4 v13, s[16:19], s91 offen lds
    s_add_u32 m0, m0, 1024
    s_nop 0
    buffer_load_dwordx4 v14, s[16:19], s91 offen lds
    s_mul_i32 s90, s32, 5120
    s_add_u32 m0, s90, s47
    s_mul_i32 s91, s44, 491520
    s_add_u32 s91, s91, s43
    buffer_load_dwordx4 v10, s[16:19], s91 offen lds
    s_add_u32 s47, s47, 20480
    s_cmp_eq_u32 s47, 81920
    s_cselect_b32 s47, 0, s47
    s_cmp_lg_u32 s51, 0
    s_cselect_b32 s90, 1, 0
    s_sub_u32 s51, s51, s90
    s_add_u32 s44, s44, s90
    s_cmp_eq_u32 s44, 5
    s_cselect_b32 s44, 0, s44
    s_cselect_b32 s90, 1280, 0
    s_addc_u32 s45, s45, 0
    s_add_u32 s43, s43, s90
    s_cmp_eq_u32 s45, 3
    s_cselect_b32 s45, 0, s45
    s_cselect_b32 s90, 3680, 0
    s_cmp_eq_u32 s43, 4960
    s_cselect_b32 s90, s43, s90
    s_sub_u32 s43, s43, s90
    s_add_u32 m0, m0, 1024
    s_nop 0
    buffer_load_dwordx4 v11, s[16:19], s91 offen lds
    s_add_u32 m0, m0, 1024
    s_nop 0
    buffer_load_dwordx4 v12, s[16:19], s91 offen lds
    s_add_u32 m0, m0, 1024
    s_nop 0
    buffer_load_dwordx4 v13, s[16:19], s91 offen lds
    s_add_u32 m0, m0, 1024
    s_nop 0
    buffer_load_dwordx4 v14, s[16:19], s91 offen lds
    s_mul_i32 s90, s32, 5120
    s_add_u32 m0, s90, s47
    s_mul_i32 s91, s44, 491520
    s_add_u32 s91, s91, s43
    buffer_load_dwordx4 v10, s[16:19], s91 offen lds
    s_add_u32 s47, s47, 20480
    s_cmp_eq_u32 s47, 81920
    s_cselect_b32 s47, 0, s47
    s_cmp_lg_u32 s51, 0
    s_cselect_b32 s90, 1, 0
    s_sub_u32 s51, s51, s90
    s_add_u32 s44, s44, s90
    s_cmp_eq_u32 s44, 5
    s_cselect_b32 s44, 0, s44
    s_cselect_b32 s90, 1280, 0
    s_addc_u32 s45, s45, 0
    s_add_u32 s43, s43, s90
    s_cmp_eq_u32 s45, 3
    s_cselect_b32 s45, 0, s45
    s_cselect_b32 s90, 3680, 0
    s_cmp_eq_u32 s43, 4960
    s_cselect_b32 s90, s43, s90
    s_sub_u32 s43, s43, s90
    s_add_u32 m0, m0, 1024
    s_nop 0
    buffer_load_dwordx4 v11, s[16:19], s91 offen lds
    s_add_u32 m0, m0, 1024
    s_nop 0
    buffer_load_dwordx4 v12, s[16:19], s91 offen lds
    s_add_u32 m0, m0, 1024
    s_nop 0
    buffer_load_dwordx4 v13, s[16:19], s91 offen lds
    s_add_u32 m0, m0, 1024
    s_nop 0
    buffer_load_dwordx4 v14, s[16:19], s91 offen lds
    v_add_u32 v16, s46, v15
    s_waitcnt vmcnt(10) lgkmcnt(0)
    s_barrier
    ds_read_b64_tr_b16 v[96:97], v16 offset:0
    ds_read_b64_tr_b16 v[98:99], v16 offset:1280
    ds_read_b64_tr_b16 v[100:101], v16 offset:32
    ds_read_b64_tr_b16 v[102:103], v16 offset:1312
    ds_read_b64_tr_b16 v[104:105], v16 offset:64
    ds_read_b64_tr_b16 v[106:107], v16 offset:1344
    ds_read_b64_tr_b16 v[108:109], v16 offset:96
    ds_read_b64_tr_b16 v[110:111], v16 offset:1376
    ds_read_b64_tr_b16 v[112:113], v16 offset:128
    ds_read_b64_tr_b16 v[114:115], v16 offset:1408
L_pa_grp:
    s_mov_b32 s41, 0
L_pa_blk:
    s_waitcnt lgkmcnt(8)
    v_mfma_f32_16x16x32_bf16 v[136:139], v[96:99], a[0:3], 0
    ds_read_b64_tr_b16 v[116:117], v16 offset:5120
    s_add_u32 s46, s46, 20480
    s_cmp_eq_u32 s46, 81920
    v_mfma_f32_16x16x32_bf16 v[140:143], v[96:99], a[80:83], 0
    ds_read_b64_tr_b16 v[118:119], v16 offset:6400
    s_cselect_b32 s46, 0, s46
    s_mul_i32 s90, s32, 5120
    s_waitcnt lgkmcnt(8)
    v_mfma_f32_16x16x32_bf16 v[144:147], v[100:103], a[0:3], 0
    ds_read_b64_tr_b16 v[120:121], v16 offset:5152
    s_add_u32 m0, s90, s47
    s_mul_i32 s91, s44, 491520
    v_mfma_f32_16x16x32_bf16 v[148:151], v[100:103], a[80:83], 0
    ds_read_b64_tr_b16 v[122:123], v16 offset:6432
    s_add_u32 s91, s91, s43
    buffer_load_dwordx4 v10, s[16:19], s91 offen lds
    s_waitcnt lgkmcnt(8)
    v_mfma_f32_16x16x32_bf16 v[152:155], v[104:107], a[0:3], 0
    ds_read_b64_tr_b16 v[124:125], v16 offset:5184
    s_add_u32 s47, s47, 20480
    s_cmp_eq_u32 s47, 81920
    v_mfma_f32_16x16x32_bf16 v[156:159], v[104:107], a[80:83], 0
    ds_read_b64_tr_b16 v[126:127], v16 offset:6464
    s_cselect_b32 s47, 0, s47
    s_cmp_lg_u32 s51, 0
    s_waitcnt lgkmcnt(8)
    v_mfma_f32_16x16x32_bf16 v[160:163], v[108:111], a[0:3], 0
    ds_read_b64_tr_b16 v[128:129], v16 offset:5216
    s_cselect_b32 s90, 1, 0
    s_sub_u32 s51, s51, s90
    v_mfma_f32_16x16x32_bf16 v[164:167], v[108:111], a[80:83], 0
    ds_read_b64_tr_b16 v[130:131], v16 offset:6496
    s_add_u32 s44, s44, s90
    s_cmp_eq_u32 s44, 5
    s_waitcnt lgkmcnt(8)
    v_mfma_f32_16x16x32_bf16 v[168:171], v[112:115], a[0:3], 0
    ds_read_b64_tr_b16 v[132:133], v16 offset:5248
    s_cselect_b32 s44, 0, s44
    s_cselect_b32 s90, 1280, 0
    v_mfma_f32_16x16x32_bf16 v[172:175], v[112:115], a[80:83], 0
    ds_read_b64_tr_b16 v[134:135], v16 offset:6528
    s_addc_u32 s45, s45, 0
    s_add_u32 s43, s43, s90
    s_waitcnt lgkmcnt(8)
    v_mfma_f32_16x16x32_bf16 v[136:139], v[116:119], a[4:7], v[136:139]
    ds_read_b64_tr_b16 v[96:97], v16 offset:10240
    s_cmp_eq_u32 s45, 3
    s_cselect_b32 s45, 0, s45
    v_mfma_f32_16x16x32_bf16 v[140:143], v[116:119], a[84:87], v[140:143]
    ds_read_b64_tr_b16 v[98:99], v16 offset:11520
    s_cselect_b32 s90, 3680, 0
    s_cmp_eq_u32 s43, 4960
    s_waitcnt lgkmcnt(8)
    v_mfma_f32_16x16x32_bf16 v[144:147], v[120:123], a[4:7], v[144:147]
    ds_read_b64_tr_b16 v[100:101], v16 offset:10272
    s_cselect_b32 s90, s43, s90
    s_sub_u32 s43, s43, s90
    v_mfma_f32_16x16x32_bf16 v[148:151], v[120:123], a[84:87], v[148:151]
    ds_read_b64_tr_b16 v[102:103], v16 offset:11552
    s_add_u32 m0, m0, 1024
    s_nop 0
    buffer_load_dwordx4 v11, s[16:19], s91 offen lds
    s_waitcnt lgkmcnt(8)
    v_mfma_f32_16x16x32_bf16 v[152:155], v[124:127], a[4:7], v[152:155]
    ds_read_b64_tr_b16 v[104:105], v16 offset:10304
    s_add_u32 m0, m0, 1024
    v_mfma_f32_16x16x32_bf16 v[156:159], v[124:127], a[84:87], v[156:159]
    ds_read_b64_tr_b16 v[106:107], v16 offset:11584
    s_waitcnt lgkmcnt(8)
    v_mfma_f32_16x16x32_bf16 v[160:163], v[128:131], a[4:7], v[160:163]
    ds_read_b64_tr_b16 v[108:109], v16 offset:10336
    v_mfma_f32_16x16x32_bf16 v[164:167], v[128:131], a[84:87], v[164:167]
    ds_read_b64_tr_b16 v[110:111], v16 offset:11616
    s_waitcnt lgkmcnt(8)
    v_mfma_f32_16x16x32_bf16 v[168:171], v[132:135], a[4:7], v[168:171]
    ds_read_b64_tr_b16 v[112:113], v16 offset:10368
    buffer_load_dwordx4 v12, s[16:19], s91 offen lds
    s_add_u32 m0, m0, 1024
    v_mfma_f32_16x16x32_bf16 v[172:175], v[132:135], a[84:87], v[172:175]
    ds_read_b64_tr_b16 v[114:115], v16 offset:11648
    s_waitcnt lgkmcnt(8)
    v_mfma_f32_16x16x32_bf16 v[136:139], v[96:99], a[8:11], v[136:139]
    ds_read_b64_tr_b16 v[116:117], v16 offset:15360
    v_mfma_f32_16x16x32_bf16 v[140:143], v[96:99], a[88:91], v[140:143]
    ds_read_b64_tr_b16 v[118:119], v16 offset:16640
    s_waitcnt lgkmcnt(8)
    v_mfma_f32_16x16x32_bf16 v[144:147], v[100:103], a[8:11], v[144:147]
    ds_read_b64_tr_b16 v[120:121], v16 offset:15392
    v_mfma_f32_16x16x32_bf16 v[148:151], v[100:103], a[88:91], v[148:151]
    ds_read_b64_tr_b16 v[122:123], v16 offset:16672
    buffer_load_dwordx4 v13, s[16:19], s91 offen lds
    s_add_u32 m0, m0, 1024
    s_waitcnt lgkmcnt(8)
    v_mfma_f32_16x16x32_bf16 v[152:155], v[104:107], a[8:11], v[152:155]
    ds_read_b64_tr_b16 v[124:125], v16 offset:15424
    v_mfma_f32_16x16x32_bf16 v[156:159], v[104:107], a[88:91], v[156:159]
    ds_read_b64_tr_b16 v[126:127], v16 offset:16704
    s_waitcnt lgkmcnt(8)
    v_mfma_f32_16x16x32_bf16 v[160:163], v[108:111], a[8:11], v[160:163]
    ds_read_b64_tr_b16 v[128:129], v16 offset:15456
    v_mfma_f32_16x16x32_bf16 v[164:167], v[108:111], a[88:91], v[164:167]
    ds_read_b64_tr_b16 v[130:131], v16 offset:16736
    s_waitcnt lgkmcnt(8)
    v_mfma_f32_16x16x32_bf16 v[168:171], v[112:115], a[8:11], v[168:171]
    ds_read_b64_tr_b16 v[132:133], v16 offset:15488
    buffer_load_dwordx4 v14, s[16:19], s91 offen lds
    v_mfma_f32_16x16x32_bf16 v[172:175], v[112:115], a[88:91], v[172:175]
    ds_read_b64_tr_b16 v[134:135], v16 offset:16768
    s_waitcnt lgkmcnt(8)
    v_mfma_f32_16x16x32_bf16 v[136:139], v[116:119], a[12:15], v[136:139]
    v_mfma_f32_16x16x32_bf16 v[140:143], v[116:119], a[92:95], v[140:143]
    s_waitcnt lgkmcnt(6)
    v_mfma_f32_16x16x32_bf16 v[144:147], v[120:123], a[12:15], v[144:147]
    v_mfma_f32_16x16x32_bf16 v[148:151], v[120:123], a[92:95], v[148:151]
    v_add_u32 v16, s46, v15
    s_waitcnt vmcnt(10) lgkmcnt(0)
    s_barrier
    v_mfma_f32_16x16x32_bf16 v[152:155], v[124:127], a[12:15], v[152:155]
    ds_read_b64_tr_b16 v[96:97], v16 offset:0
    ds_read_b64_tr_b16 v[98:99], v16 offset:1280
    v_mfma_f32_16x16x32_bf16 v[156:159], v[124:127], a[92:95], v[156:159]
    ds_read_b64_tr_b16 v[100:101], v16 offset:32
    ds_read_b64_tr_b16 v[102:103], v16 offset:1312
    v_mfma_f32_16x16x32_bf16 v[160:163], v[128:131], a[12:15], v[160:163]
    ds_read_b64_tr_b16 v[104:105], v16 offset:64
    ds_read_b64_tr_b16 v[106:107], v16 offset:1344
    v_mfma_f32_16x16x32_bf16 v[164:167], v[128:131], a[92:95], v[164:167]
    ds_read_b64_tr_b16 v[108:109], v16 offset:96
    ds_read_b64_tr_b16 v[110:111], v16 offset:1376
    v_mfma_f32_16x16x32_bf16 v[168:171], v[132:135], a[12:15], v[168:171]
    ds_read_b64_tr_b16 v[112:113], v16 offset:128
    ds_read_b64_tr_b16 v[114:115], v16 offset:1408
    v_mfma_f32_16x16x32_bf16 v[172:175], v[132:135], a[92:95], v[172:175]
    s_waitcnt lgkmcnt(8)
    v_mfma_f32_16x16x32_bf16 v[136:139], v[96:99], a[16:19], v[136:139]
    ds_read_b64_tr_b16 v[116:117], v16 offset:5120
    s_add_u32 s46, s46, 20480
    s_cmp_eq_u32 s46, 81920
    v_mfma_f32_16x16x32_bf16 v[140:143], v[96:99], a[96:99], v[140:143]
    ds_read_b64_tr_b16 v[118:119], v16 offset:6400
    s_cselect_b32 s46, 0, s46
    s_mul_i32 s90, s32, 5120
    s_waitcnt lgkmcnt(8)
    v_mfma_f32_16x16x32_bf16 v[144:147], v[100:103], a[16:19], v[144:147]
    ds_read_b64_tr_b16 v[120:121], v16 offset:5152
    s_add_u32 m0, s90, s47
    s_mul_i32 s91, s44, 491520
    v_mfma_f32_16x16x32_bf16 v[148:151], v[100:103], a[96:99], v[148:151]
    ds_read_b64_tr_b16 v[122:123], v16 offset:6432
    s_add_u32 s91, s91, s43
    buffer_load_dwordx4 v10, s[16:19], s91 offen lds
    s_waitcnt lgkmcnt(8)
    v_mfma_f32_16x16x32_bf16 v[152:155], v[104:107], a[16:19], v[152:155]
    ds_read_b64_tr_b16 v[124:125], v16 offset:5184
    s_add_u32 s47, s47, 20480
    s_cmp_eq_u32 s47, 81920
    v_mfma_f32_16x16x32_bf16 v[156:159], v[104:107], a[96:99], v[156:159]
    ds_read_b64_tr_b16 v[126:127], v16 offset:6464
    s_cselect_b32 s47, 0, s47
    s_cmp_lg_u32 s51, 0
    s_waitcnt lgkmcnt(8)
    v_mfma_f32_16x16x32_bf16 v[160:163], v[108:111], a[16:19], v[160:163]
    ds_read_b64_tr_b16 v[128:129], v16 offset:5216
    s_cselect_b32 s90, 1, 0
    s_sub_u32 s51, s51, s90
    v_mfma_f32_16x16x32_bf16 v[164:167], v[108:111], a[96:99], v[164:167]
    ds_read_b64_tr_b16 v[130:131], v16 offset:6496
    s_add_u32 s44, s44, s90
    s_cmp_eq_u32 s44, 5
    s_waitcnt lgkmcnt(8)
    v_mfma_f32_16x16x32_bf16 v[168:171], v[112:115], a[16:19], v[168:171]
    ds_read_b64_tr_b16 v[132:133], v16 offset:5248
    s_cselect_b32 s44, 0, s44
    s_cselect_b32 s90, 1280, 0
    v_mfma_f32_16x16x32_bf16 v[172:175], v[112:115], a[96:99], v[172:175]
    ds_read_b64_tr_b16 v[134:135], v16 offset:6528
    s_addc_u32 s45, s45, 0
    s_add_u32 s43, s43, s90
    s_waitcnt lgkmcnt(8)
    v_mfma_f32_16x16x32_bf16 v[136:139], v[116:119], a[20:23], v[136:139]
    ds_read_b64_tr_b16 v[96:97], v16 offset:10240
    s_cmp_eq_u32 s45, 3
    s_cselect_b32 s45, 0, s45
    v_mfma_f32_16x16x32_bf16 v[140:143], v[116:119], a[100:103], v[140:143]
    ds_read_b64_tr_b16 v[98:99], v16 offset:11520
    s_cselect_b32 s90, 3680, 0
    s_cmp_eq_u32 s43, 4960
    s_waitcnt lgkmcnt(8)
    v_mfma_f32_16x16x32_bf16 v[144:147], v[120:123], a[20:23], v[144:147]
    ds_read_b64_tr_b16 v[100:101], v16 offset:10272
    s_cselect_b32 s90, s43, s90
    s_sub_u32 s43, s43, s90
    v_mfma_f32_16x16x32_bf16 v[148:151], v[120:123], a[100:103], v[148:151]
    ds_read_b64_tr_b16 v[102:103], v16 offset:11552
    s_add_u32 m0, m0, 1024
    s_nop 0
    buffer_load_dwordx4 v11, s[16:19], s91 offen lds
    s_waitcnt lgkmcnt(8)
    v_mfma_f32_16x16x32_bf16 v[152:155], v[124:127], a[20:23], v[152:155]
    ds_read_b64_tr_b16 v[104:105], v16 offset:10304
    s_add_u32 m0, m0, 1024
    v_mfma_f32_16x16x32_bf16 v[156:159], v[124:127], a[100:103], v[156:159]
    ds_read_b64_tr_b16 v[106:107], v16 offset:11584
    s_waitcnt lgkmcnt(8)
    v_mfma_f32_16x16x32_bf16 v[160:163], v[128:131], a[20:23], v[160:163]
    ds_read_b64_tr_b16 v[108:109], v16 offset:10336
    v_mfma_f32_16x16x32_bf16 v[164:167], v[128:131], a[100:103], v[164:167]
    ds_read_b64_tr_b16 v[110:111], v16 offset:11616
    s_waitcnt lgkmcnt(8)
    v_mfma_f32_16x16x32_bf16 v[168:171], v[132:135], a[20:23], v[168:171]
    ds_read_b64_tr_b16 v[112:113], v16 offset:10368
    buffer_load_dwordx4 v12, s[16:19], s91 offen lds
    s_add_u32 m0, m0, 1024
    v_mfma_f32_16x16x32_bf16 v[172:175], v[132:135], a[100:103], v[172:175]
    ds_read_b64_tr_b16 v[114:115], v16 offset:11648
    s_waitcnt lgkmcnt(8)
    v_mfma_f32_16x16x32_bf16 v[136:139], v[96:99], a[24:27], v[136:139]
    ds_read_b64_tr_b16 v[116:117], v16 offset:15360
    v_mfma_f32_16x16x32_bf16 v[140:143], v[96:99], a[104:107], v[140:143]
    ds_read_b64_tr_b16 v[118:119], v16 offset:16640
    s_waitcnt lgkmcnt(8)
    v_mfma_f32_16x16x32_bf16 v[144:147], v[100:103], a[24:27], v[144:147]
    ds_read_b64_tr_b16 v[120:121], v16 offset:15392
    v_mfma_f32_16x16x32_bf16 v[148:151], v[100:103], a[104:107], v[148:151]
    ds_read_b64_tr_b16 v[122:123], v16 offset:16672
    buffer_load_dwordx4 v13, s[16:19], s91 offen lds
    s_add_u32 m0, m0, 1024
    s_waitcnt lgkmcnt(8)
    v_mfma_f32_16x16x32_bf16 v[152:155], v[104:107], a[24:27], v[152:155]
    ds_read_b64_tr_b16 v[124:125], v16 offset:15424
    v_mfma_f32_16x16x32_bf16 v[156:159], v[104:107], a[104:107], v[156:159]
    ds_read_b64_tr_b16 v[126:127], v16 offset:16704
    s_waitcnt lgkmcnt(8)
    v_mfma_f32_16x16x32_bf16 v[160:163], v[108:111], a[24:27], v[160:163]
    ds_read_b64_tr_b16 v[128:129], v16 offset:15456
    v_mfma_f32_16x16x32_bf16 v[164:167], v[108:111], a[104:107], v[164:167]
    ds_read_b64_tr_b16 v[130:131], v16 offset:16736
    s_waitcnt lgkmcnt(8)
    v_mfma_f32_16x16x32_bf16 v[168:171], v[112:115], a[24:27], v[168:171]
    ds_read_b64_tr_b16 v[132:133], v16 offset:15488
    buffer_load_dwordx4 v14, s[16:19], s91 offen lds
    v_mfma_f32_16x16x32_bf16 v[172:175], v[112:115], a[104:107], v[172:175]
    ds_read_b64_tr_b16 v[134:135], v16 offset:16768
    s_waitcnt lgkmcnt(8)
    v_mfma_f32_16x16x32_bf16 v[136:139], v[116:119], a[28:31], v[136:139]
    v_mfma_f32_16x16x32_bf16 v[140:143], v[116:119], a[108:111], v[140:143]
    s_waitcnt lgkmcnt(6)
    v_mfma_f32_16x16x32_bf16 v[144:147], v[120:123], a[28:31], v[144:147]
    v_mfma_f32_16x16x32_bf16 v[148:151], v[120:123], a[108:111], v[148:151]
    v_add_u32 v16, s46, v15
    s_waitcnt vmcnt(10) lgkmcnt(0)
    s_barrier
    v_mfma_f32_16x16x32_bf16 v[152:155], v[124:127], a[28:31], v[152:155]
    ds_read_b64_tr_b16 v[96:97], v16 offset:0
    ds_read_b64_tr_b16 v[98:99], v16 offset:1280
    v_mfma_f32_16x16x32_bf16 v[156:159], v[124:127], a[108:111], v[156:159]
    ds_read_b64_tr_b16 v[100:101], v16 offset:32
    ds_read_b64_tr_b16 v[102:103], v16 offset:1312
    v_mfma_f32_16x16x32_bf16 v[160:163], v[128:131], a[28:31], v[160:163]
    ds_read_b64_tr_b16 v[104:105], v16 offset:64
    ds_read_b64_tr_b16 v[106:107], v16 offset:1344
    v_mfma_f32_16x16x32_bf16 v[164:167], v[128:131], a[108:111], v[164:167]
    ds_read_b64_tr_b16 v[108:109], v16 offset:96
    ds_read_b64_tr_b16 v[110:111], v16 offset:1376
    v_mfma_f32_16x16x32_bf16 v[168:171], v[132:135], a[28:31], v[168:171]
    ds_read_b64_tr_b16 v[112:113], v16 offset:128
    ds_read_b64_tr_b16 v[114:115], v16 offset:1408
    v_mfma_f32_16x16x32_bf16 v[172:175], v[132:135], a[108:111], v[172:175]
    s_waitcnt lgkmcnt(8)
    v_mfma_f32_16x16x32_bf16 v[136:139], v[96:99], a[32:35], v[136:139]
    ds_read_b64_tr_b16 v[116:117], v16 offset:5120
    s_add_u32 s46, s46, 20480
    s_cmp_eq_u32 s46, 81920
    v_mfma_f32_16x16x32_bf16 v[140:143], v[96:99], a[112:115], v[140:143]
    ds_read_b64_tr_b16 v[118:119], v16 offset:6400
    s_cselect_b32 s46, 0, s46
    s_mul_i32 s90, s32, 5120
    s_waitcnt lgkmcnt(8)
    v_mfma_f32_16x16x32_bf16 v[144:147], v[100:103], a[32:35], v[144:147]
    ds_read_b64_tr_b16 v[120:121], v16 offset:5152
    s_add_u32 m0, s90, s47
    s_mul_i32 s91, s44, 491520
    v_mfma_f32_16x16x32_bf16 v[148:151], v[100:103], a[112:115], v[148:151]
    ds_read_b64_tr_b16 v[122:123], v16 offset:6432
    s_add_u32 s91, s91, s43
    buffer_load_dwordx4 v10, s[16:19], s91 offen lds
    s_waitcnt lgkmcnt(8)
    v_mfma_f32_16x16x32_bf16 v[152:155], v[104:107], a[32:35], v[152:155]
    ds_read_b64_tr_b16 v[124:125], v16 offset:5184
    s_add_u32 s47, s47, 20480
    s_cmp_eq_u32 s47, 81920
    v_mfma_f32_16x16x32_bf16 v[156:159], v[104:107], a[112:115], v[156:159]
    ds_read_b64_tr_b16 v[126:127], v16 offset:6464
    s_cselect_b32 s47, 0, s47
    s_cmp_lg_u32 s51, 0
    s_waitcnt lgkmcnt(8)
    v_mfma_f32_16x16x32_bf16 v[160:163], v[108:111], a[32:35], v[160:163]
    ds_read_b64_tr_b16 v[128:129], v16 offset:5216
    s_cselect_b32 s90, 1, 0
    s_sub_u32 s51, s51, s90
    v_mfma_f32_16x16x32_bf16 v[164:167], v[108:111], a[112:115], v[164:167]
    ds_read_b64_tr_b16 v[130:131], v16 offset:6496
    s_add_u32 s44, s44, s90
    s_cmp_eq_u32 s44, 5
    s_waitcnt lgkmcnt(8)
    v_mfma_f32_16x16x32_bf16 v[168:171], v[112:115], a[32:35], v[168:171]
    ds_read_b64_tr_b16 v[132:133], v16 offset:5248
    s_cselect_b32 s44, 0, s44
    s_cselect_b32 s90, 1280, 0
    v_mfma_f32_16x16x32_bf16 v[172:175], v[112:115], a[112:115], v[172:175]
    ds_read_b64_tr_b16 v[134:135], v16 offset:6528
    s_addc_u32 s45, s45, 0
    s_add_u32 s43, s43, s90
    s_waitcnt lgkmcnt(8)
    v_mfma_f32_16x16x32_bf16 v[136:139], v[116:119], a[36:39], v[136:139]
    ds_read_b64_tr_b16 v[96:97], v16 offset:10240
    s_cmp_eq_u32 s45, 3
    s_cselect_b32 s45, 0, s45
    v_mfma_f32_16x16x32_bf16 v[140:143], v[116:119], a[116:119], v[140:143]
    ds_read_b64_tr_b16 v[98:99], v16 offset:11520
    s_cselect_b32 s90, 3680, 0
    s_cmp_eq_u32 s43, 4960
    s_waitcnt lgkmcnt(8)
    v_mfma_f32_16x16x32_bf16 v[144:147], v[120:123], a[36:39], v[144:147]
    ds_read_b64_tr_b16 v[100:101], v16 offset:10272
    s_cselect_b32 s90, s43, s90
    s_sub_u32 s43, s43, s90
    v_mfma_f32_16x16x32_bf16 v[148:151], v[120:123], a[116:119], v[148:151]
    ds_read_b64_tr_b16 v[102:103], v16 offset:11552
    s_add_u32 m0, m0, 1024
    s_nop 0
    buffer_load_dwordx4 v11, s[16:19], s91 offen lds
    s_waitcnt lgkmcnt(8)
    v_mfma_f32_16x16x32_bf16 v[152:155], v[124:127], a[36:39], v[152:155]
    ds_read_b64_tr_b16 v[104:105], v16 offset:10304
    s_add_u32 m0, m0, 1024
    v_mfma_f32_16x16x32_bf16 v[156:159], v[124:127], a[116:119], v[156:159]
    ds_read_b64_tr_b16 v[106:107], v16 offset:11584
    s_waitcnt lgkmcnt(8)
    v_mfma_f32_16x16x32_bf16 v[160:163], v[128:131], a[36:39], v[160:163]
    ds_read_b64_tr_b16 v[108:109], v16 offset:10336
    v_mfma_f32_16x16x32_bf16 v[164:167], v[128:131], a[116:119], v[164:167]
    ds_read_b64_tr_b16 v[110:111], v16 offset:11616
    s_waitcnt lgkmcnt(8)
    v_mfma_f32_16x16x32_bf16 v[168:171], v[132:135], a[36:39], v[168:171]
    ds_read_b64_tr_b16 v[112:113], v16 offset:10368
    buffer_load_dwordx4 v12, s[16:19], s91 offen lds
    s_add_u32 m0, m0, 1024
    v_mfma_f32_16x16x32_bf16 v[172:175], v[132:135], a[116:119], v[172:175]
    ds_read_b64_tr_b16 v[114:115], v16 offset:11648
    s_waitcnt lgkmcnt(8)
    v_mfma_f32_16x16x32_bf16 v[136:139], v[96:99], a[40:43], v[136:139]
    ds_read_b64_tr_b16 v[116:117], v16 offset:15360
    v_mfma_f32_16x16x32_bf16 v[140:143], v[96:99], a[120:123], v[140:143]
    ds_read_b64_tr_b16 v[118:119], v16 offset:16640
    s_waitcnt lgkmcnt(8)
    v_mfma_f32_16x16x32_bf16 v[144:147], v[100:103], a[40:43], v[144:147]
    ds_read_b64_tr_b16 v[120:121], v16 offset:15392
    v_mfma_f32_16x16x32_bf16 v[148:151], v[100:103], a[120:123], v[148:151]
    ds_read_b64_tr_b16 v[122:123], v16 offset:16672
    buffer_load_dwordx4 v13, s[16:19], s91 offen lds
    s_add_u32 m0, m0, 1024
    s_waitcnt lgkmcnt(8)
    v_mfma_f32_16x16x32_bf16 v[152:155], v[104:107], a[40:43], v[152:155]
    ds_read_b64_tr_b16 v[124:125], v16 offset:15424
    v_mfma_f32_16x16x32_bf16 v[156:159], v[104:107], a[120:123], v[156:159]
    ds_read_b64_tr_b16 v[126:127], v16 offset:16704
    s_waitcnt lgkmcnt(8)
    v_mfma_f32_16x16x32_bf16 v[160:163], v[108:111], a[40:43], v[160:163]
    ds_read_b64_tr_b16 v[128:129], v16 offset:15456
    v_mfma_f32_16x16x32_bf16 v[164:167], v[108:111], a[120:123], v[164:167]
    ds_read_b64_tr_b16 v[130:131], v16 offset:16736
    s_waitcnt lgkmcnt(8)
    v_mfma_f32_16x16x32_bf16 v[168:171], v[112:115], a[40:43], v[168:171]
    ds_read_b64_tr_b16 v[132:133], v16 offset:15488
    buffer_load_dwordx4 v14, s[16:19], s91 offen lds
    v_mfma_f32_16x16x32_bf16 v[172:175], v[112:115], a[120:123], v[172:175]
    ds_read_b64_tr_b16 v[134:135], v16 offset:16768
    s_waitcnt lgkmcnt(8)
    v_mfma_f32_16x16x32_bf16 v[136:139], v[116:119], a[44:47], v[136:139]
    v_mfma_f32_16x16x32_bf16 v[140:143], v[116:119], a[124:127], v[140:143]
    s_waitcnt lgkmcnt(6)
    v_mfma_f32_16x16x32_bf16 v[144:147], v[120:123], a[44:47], v[144:147]
    v_mfma_f32_16x16x32_bf16 v[148:151], v[120:123], a[124:127], v[148:151]
    v_add_u32 v16, s46, v15
    s_waitcnt vmcnt(10) lgkmcnt(0)
    s_barrier
    v_mfma_f32_16x16x32_bf16 v[152:155], v[124:127], a[44:47], v[152:155]
    ds_read_b64_tr_b16 v[96:97], v16 offset:0
    ds_read_b64_tr_b16 v[98:99], v16 offset:1280
    v_mfma_f32_16x16x32_bf16 v[156:159], v[124:127], a[124:127], v[156:159]
    ds_read_b64_tr_b16 v[100:101], v16 offset:32
    ds_read_b64_tr_b16 v[102:103], v16 offset:1312
    v_mfma_f32_16x16x32_bf16 v[160:163], v[128:131], a[44:47], v[160:163]
    ds_read_b64_tr_b16 v[104:105], v16 offset:64
    ds_read_b64_tr_b16 v[106:107], v16 offset:1344
    v_mfma_f32_16x16x32_bf16 v[164:167], v[128:131], a[124:127], v[164:167]
    ds_read_b64_tr_b16 v[108:109], v16 offset:96
    ds_read_b64_tr_b16 v[110:111], v16 offset:1376
    v_mfma_f32_16x16x32_bf16 v[168:171], v[132:135], a[44:47], v[168:171]
    ds_read_b64_tr_b16 v[112:113], v16 offset:128
    ds_read_b64_tr_b16 v[114:115], v16 offset:1408
    v_mfma_f32_16x16x32_bf16 v[172:175], v[132:135], a[124:127], v[172:175]
    s_waitcnt lgkmcnt(8)
    v_mfma_f32_16x16x32_bf16 v[136:139], v[96:99], a[48:51], v[136:139]
    ds_read_b64_tr_b16 v[116:117], v16 offset:5120
    s_add_u32 s46, s46, 20480
    s_cmp_eq_u32 s46, 81920
    v_mfma_f32_16x16x32_bf16 v[140:143], v[96:99], a[128:131], v[140:143]
    ds_read_b64_tr_b16 v[118:119], v16 offset:6400
    s_cselect_b32 s46, 0, s46
    s_mul_i32 s90, s32, 5120
    s_waitcnt lgkmcnt(8)
    v_mfma_f32_16x16x32_bf16 v[144:147], v[100:103], a[48:51], v[144:147]
    ds_read_b64_tr_b16 v[120:121], v16 offset:5152
    s_add_u32 m0, s90, s47
    s_mul_i32 s91, s44, 491520
    v_mfma_f32_16x16x32_bf16 v[148:151], v[100:103], a[128:131], v[148:151]
    ds_read_b64_tr_b16 v[122:123], v16 offset:6432
    s_add_u32 s91, s91, s43
    buffer_load_dwordx4 v10, s[16:19], s91 offen lds
    s_waitcnt lgkmcnt(8)
    v_mfma_f32_16x16x32_bf16 v[152:155], v[104:107], a[48:51], v[152:155]
    ds_read_b64_tr_b16 v[124:125], v16 offset:5184
    s_add_u32 s47, s47, 20480
    s_cmp_eq_u32 s47, 81920
    v_mfma_f32_16x16x32_bf16 v[156:159], v[104:107], a[128:131], v[156:159]
    ds_read_b64_tr_b16 v[126:127], v16 offset:6464
    s_cselect_b32 s47, 0, s47
    s_cmp_lg_u32 s51, 0
    s_waitcnt lgkmcnt(8)
    v_mfma_f32_16x16x32_bf16 v[160:163], v[108:111], a[48:51], v[160:163]
    ds_read_b64_tr_b16 v[128:129], v16 offset:5216
    s_cselect_b32 s90, 1, 0
    s_sub_u32 s51, s51, s90
    v_mfma_f32_16x16x32_bf16 v[164:167], v[108:111], a[128:131], v[164:167]
    ds_read_b64_tr_b16 v[130:131], v16 offset:6496
    s_add_u32 s44, s44, s90
    s_cmp_eq_u32 s44, 5
    s_waitcnt lgkmcnt(8)
    v_mfma_f32_16x16x32_bf16 v[168:171], v[112:115], a[48:51], v[168:171]
    ds_read_b64_tr_b16 v[132:133], v16 offset:5248
    s_cselect_b32 s44, 0, s44
    s_cselect_b32 s90, 1280, 0
    v_mfma_f32_16x16x32_bf16 v[172:175], v[112:115], a[128:131], v[172:175]
    ds_read_b64_tr_b16 v[134:135], v16 offset:6528
    s_addc_u32 s45, s45, 0
    s_add_u32 s43, s43, s90
    s_waitcnt lgkmcnt(8)
    v_mfma_f32_16x16x32_bf16 v[136:139], v[116:119], a[52:55], v[136:139]
    ds_read_b64_tr_b16 v[96:97], v16 offset:10240
    s_cmp_eq_u32 s45, 3
    s_cselect_b32 s45, 0, s45
    v_mfma_f32_16x16x32_bf16 v[140:143], v[116:119], a[132:135], v[140:143]
    ds_read_b64_tr_b16 v[98:99], v16 offset:11520
    s_cselect_b32 s90, 3680, 0
    s_cmp_eq_u32 s43, 4960
    s_waitcnt lgkmcnt(8)
    v_mfma_f32_16x16x32_bf16 v[144:147], v[120:123], a[52:55], v[144:147]
    ds_read_b64_tr_b16 v[100:101], v16 offset:10272
    s_cselect_b32 s90, s43, s90
    s_sub_u32 s43, s43, s90
    v_mfma_f32_16x16x32_bf16 v[148:151], v[120:123], a[132:135], v[148:151]
    ds_read_b64_tr_b16 v[102:103], v16 offset:11552
    s_add_u32 m0, m0, 1024
    s_nop 0
    buffer_load_dwordx4 v11, s[16:19], s91 offen lds
    s_waitcnt lgkmcnt(8)
    v_mfma_f32_16x16x32_bf16 v[152:155], v[124:127], a[52:55], v[152:155]
    ds_read_b64_tr_b16 v[104:105], v16 offset:10304
    s_add_u32 m0, m0, 1024
    v_mfma_f32_16x16x32_bf16 v[156:159], v[124:127], a[132:135], v[156:159]
    ds_read_b64_tr_b16 v[106:107], v16 offset:11584
    s_waitcnt lgkmcnt(8)
    v_mfma_f32_16x16x32_bf16 v[160:163], v[128:131], a[52:55], v[160:163]
    ds_read_b64_tr_b16 v[108:109], v16 offset:10336
    v_mfma_f32_16x16x32_bf16 v[164:167], v[128:131], a[132:135], v[164:167]
    ds_read_b64_tr_b16 v[110:111], v16 offset:11616
    s_waitcnt lgkmcnt(8)
    v_mfma_f32_16x16x32_bf16 v[168:171], v[132:135], a[52:55], v[168:171]
    ds_read_b64_tr_b16 v[112:113], v16 offset:10368
    buffer_load_dwordx4 v12, s[16:19], s91 offen lds
    s_add_u32 m0, m0, 1024
    v_mfma_f32_16x16x32_bf16 v[172:175], v[132:135], a[132:135], v[172:175]
    ds_read_b64_tr_b16 v[114:115], v16 offset:11648
    s_waitcnt lgkmcnt(8)
    v_mfma_f32_16x16x32_bf16 v[136:139], v[96:99], a[56:59], v[136:139]
    ds_read_b64_tr_b16 v[116:117], v16 offset:15360
    v_mfma_f32_16x16x32_bf16 v[140:143], v[96:99], a[136:139], v[140:143]
    ds_read_b64_tr_b16 v[118:119], v16 offset:16640
    s_waitcnt lgkmcnt(8)
    v_mfma_f32_16x16x32_bf16 v[144:147], v[100:103], a[56:59], v[144:147]
    ds_read_b64_tr_b16 v[120:121], v16 offset:15392
    v_mfma_f32_16x16x32_bf16 v[148:151], v[100:103], a[136:139], v[148:151]
    ds_read_b64_tr_b16 v[122:123], v16 offset:16672
    buffer_load_dwordx4 v13, s[16:19], s91 offen lds
    s_add_u32 m0, m0, 1024
    s_waitcnt lgkmcnt(8)
    v_mfma_f32_16x16x32_bf16 v[152:155], v[104:107], a[56:59], v[152:155]
    ds_read_b64_tr_b16 v[124:125], v16 offset:15424
    v_mfma_f32_16x16x32_bf16 v[156:159], v[104:107], a[136:139], v[156:159]
    ds_read_b64_tr_b16 v[126:127], v16 offset:16704
    s_waitcnt lgkmcnt(8)
    v_mfma_f32_16x16x32_bf16 v[160:163], v[108:111], a[56:59], v[160:163]
    ds_read_b64_tr_b16 v[128:129], v16 offset:15456
    v_mfma_f32_16x16x32_bf16 v[164:167], v[108:111], a[136:139], v[164:167]
    ds_read_b64_tr_b16 v[130:131], v16 offset:16736
    s_waitcnt lgkmcnt(8)
    v_mfma_f32_16x16x32_bf16 v[168:171], v[112:115], a[56:59], v[168:171]
    ds_read_b64_tr_b16 v[132:133], v16 offset:15488
    buffer_load_dwordx4 v14, s[16:19], s91 offen lds
    v_mfma_f32_16x16x32_bf16 v[172:175], v[112:115], a[136:139], v[172:175]
    ds_read_b64_tr_b16 v[134:135], v16 offset:16768
    s_waitcnt lgkmcnt(8)
    v_mfma_f32_16x16x32_bf16 v[136:139], v[116:119], a[60:63], v[136:139]
    v_mfma_f32_16x16x32_bf16 v[140:143], v[116:119], a[140:143], v[140:143]
    s_waitcnt lgkmcnt(6)
    v_mfma_f32_16x16x32_bf16 v[144:147], v[120:123], a[60:63], v[144:147]
    v_mfma_f32_16x16x32_bf16 v[148:151], v[120:123], a[140:143], v[148:151]
    v_add_u32 v16, s46, v15
    s_waitcnt vmcnt(10) lgkmcnt(0)
    s_barrier
    v_mfma_f32_16x16x32_bf16 v[152:155], v[124:127], a[60:63], v[152:155]
    ds_read_b64_tr_b16 v[96:97], v16 offset:0
    ds_read_b64_tr_b16 v[98:99], v16 offset:1280
    v_mfma_f32_16x16x32_bf16 v[156:159], v[124:127], a[140:143], v[156:159]
    ds_read_b64_tr_b16 v[100:101], v16 offset:32
    ds_read_b64_tr_b16 v[102:103], v16 offset:1312
    v_mfma_f32_16x16x32_bf16 v[160:163], v[128:131], a[60:63], v[160:163]
    ds_read_b64_tr_b16 v[104:105], v16 offset:64
    ds_read_b64_tr_b16 v[106:107], v16 offset:1344
    v_mfma_f32_16x16x32_bf16 v[164:167], v[128:131], a[140:143], v[164:167]
    ds_read_b64_tr_b16 v[108:109], v16 offset:96
    ds_read_b64_tr_b16 v[110:111], v16 offset:1376
    v_mfma_f32_16x16x32_bf16 v[168:171], v[132:135], a[60:63], v[168:171]
    ds_read_b64_tr_b16 v[112:113], v16 offset:128
    ds_read_b64_tr_b16 v[114:115], v16 offset:1408
    v_mfma_f32_16x16x32_bf16 v[172:175], v[132:135], a[140:143], v[172:175]
    s_waitcnt lgkmcnt(8)
    v_mfma_f32_16x16x32_bf16 v[136:139], v[96:99], a[64:67], v[136:139]
    ds_read_b64_tr_b16 v[116:117], v16 offset:5120
    s_add_u32 s46, s46, 20480
    s_cmp_eq_u32 s46, 81920
    v_mfma_f32_16x16x32_bf16 v[140:143], v[96:99], a[144:147], v[140:143]
    ds_read_b64_tr_b16 v[118:119], v16 offset:6400
    s_cselect_b32 s46, 0, s46
    s_mul_i32 s90, s32, 5120
    s_waitcnt lgkmcnt(8)
    v_mfma_f32_16x16x32_bf16 v[144:147], v[100:103], a[64:67], v[144:147]
    ds_read_b64_tr_b16 v[120:121], v16 offset:5152
    s_add_u32 m0, s90, s47
    s_mul_i32 s91, s44, 491520
    v_mfma_f32_16x16x32_bf16 v[148:151], v[100:103], a[144:147], v[148:151]
    ds_read_b64_tr_b16 v[122:123], v16 offset:6432
    s_add_u32 s91, s91, s43
    buffer_load_dwordx4 v10, s[16:19], s91 offen lds
    s_waitcnt lgkmcnt(8)
    v_mfma_f32_16x16x32_bf16 v[152:155], v[104:107], a[64:67], v[152:155]
    ds_read_b64_tr_b16 v[124:125], v16 offset:5184
    s_add_u32 s47, s47, 20480
    s_cmp_eq_u32 s47, 81920
    v_mfma_f32_16x16x32_bf16 v[156:159], v[104:107], a[144:147], v[156:159]
    ds_read_b64_tr_b16 v[126:127], v16 offset:6464
    s_cselect_b32 s47, 0, s47
    s_cmp_lg_u32 s51, 0
    s_waitcnt lgkmcnt(8)
    v_mfma_f32_16x16x32_bf16 v[160:163], v[108:111], a[64:67], v[160:163]
    ds_read_b64_tr_b16 v[128:129], v16 offset:5216
    s_cselect_b32 s90, 1, 0
    s_sub_u32 s51, s51, s90
    v_mfma_f32_16x16x32_bf16 v[164:167], v[108:111], a[144:147], v[164:167]
    ds_read_b64_tr_b16 v[130:131], v16 offset:6496
    s_add_u32 s44, s44, s90
    s_cmp_eq_u32 s44, 5
    s_waitcnt lgkmcnt(8)
    v_mfma_f32_16x16x32_bf16 v[168:171], v[112:115], a[64:67], v[168:171]
    ds_read_b64_tr_b16 v[132:133], v16 offset:5248
    s_cselect_b32 s44, 0, s44
    s_cselect_b32 s90, 1280, 0
    v_mfma_f32_16x16x32_bf16 v[172:175], v[112:115], a[144:147], v[172:175]
    ds_read_b64_tr_b16 v[134:135], v16 offset:6528
    s_addc_u32 s45, s45, 0
    s_add_u32 s43, s43, s90
    s_waitcnt lgkmcnt(8)
    v_mfma_f32_16x16x32_bf16 v[136:139], v[116:119], a[68:71], v[136:139]
    ds_read_b64_tr_b16 v[96:97], v16 offset:10240
    s_cmp_eq_u32 s45, 3
    s_cselect_b32 s45, 0, s45
    v_mfma_f32_16x16x32_bf16 v[140:143], v[116:119], a[148:151], v[140:143]
    ds_read_b64_tr_b16 v[98:99], v16 offset:11520
    s_cselect_b32 s90, 3680, 0
    s_cmp_eq_u32 s43, 4960
    s_waitcnt lgkmcnt(8)
    v_mfma_f32_16x16x32_bf16 v[144:147], v[120:123], a[68:71], v[144:147]
    ds_read_b64_tr_b16 v[100:101], v16 offset:10272
    s_cselect_b32 s90, s43, s90
    s_sub_u32 s43, s43, s90
    v_mfma_f32_16x16x32_bf16 v[148:151], v[120:123], a[148:151], v[148:151]
    ds_read_b64_tr_b16 v[102:103], v16 offset:11552
    s_add_u32 m0, m0, 1024
    s_nop 0
    buffer_load_dwordx4 v11, s[16:19], s91 offen lds
    s_waitcnt lgkmcnt(8)
    v_mfma_f32_16x16x32_bf16 v[152:155], v[124:127], a[68:71], v[152:155]
    ds_read_b64_tr_b16 v[104:105], v16 offset:10304
    s_add_u32 m0, m0, 1024
    v_mfma_f32_16x16x32_bf16 v[156:159], v[124:127], a[148:151], v[156:159]
    ds_read_b64_tr_b16 v[106:107], v16 offset:11584
    s_waitcnt lgkmcnt(8)
    v_mfma_f32_16x16x32_bf16 v[160:163], v[128:131], a[68:71], v[160:163]
    ds_read_b64_tr_b16 v[108:109], v16 offset:10336
    v_mfma_f32_16x16x32_bf16 v[164:167], v[128:131], a[148:151], v[164:167]
    ds_read_b64_tr_b16 v[110:111], v16 offset:11616
    s_waitcnt lgkmcnt(8)
    v_mfma_f32_16x16x32_bf16 v[168:171], v[132:135], a[68:71], v[168:171]
    ds_read_b64_tr_b16 v[112:113], v16 offset:10368
    buffer_load_dwordx4 v12, s[16:19], s91 offen lds
    s_add_u32 m0, m0, 1024
    v_mfma_f32_16x16x32_bf16 v[172:175], v[132:135], a[148:151], v[172:175]
    ds_read_b64_tr_b16 v[114:115], v16 offset:11648
    s_waitcnt lgkmcnt(8)
    v_mfma_f32_16x16x32_bf16 v[136:139], v[96:99], a[72:75], v[136:139]
    ds_read_b64_tr_b16 v[116:117], v16 offset:15360
    v_mfma_f32_16x16x32_bf16 v[140:143], v[96:99], a[152:155], v[140:143]
    ds_read_b64_tr_b16 v[118:119], v16 offset:16640
    s_waitcnt lgkmcnt(8)
    v_mfma_f32_16x16x32_bf16 v[144:147], v[100:103], a[72:75], v[144:147]
    ds_read_b64_tr_b16 v[120:121], v16 offset:15392
    v_mfma_f32_16x16x32_bf16 v[148:151], v[100:103], a[152:155], v[148:151]
    ds_read_b64_tr_b16 v[122:123], v16 offset:16672
    buffer_load_dwordx4 v13, s[16:19], s91 offen lds
    s_add_u32 m0, m0, 1024
    s_waitcnt lgkmcnt(8)
    v_mfma_f32_16x16x32_bf16 v[152:155], v[104:107], a[72:75], v[152:155]
    ds_read_b64_tr_b16 v[124:125], v16 offset:15424
    v_mfma_f32_16x16x32_bf16 v[156:159], v[104:107], a[152:155], v[156:159]
    ds_read_b64_tr_b16 v[126:127], v16 offset:16704
    s_waitcnt lgkmcnt(8)
    v_mfma_f32_16x16x32_bf16 v[160:163], v[108:111], a[72:75], v[160:163]
    ds_read_b64_tr_b16 v[128:129], v16 offset:15456
    v_mfma_f32_16x16x32_bf16 v[164:167], v[108:111], a[152:155], v[164:167]
    ds_read_b64_tr_b16 v[130:131], v16 offset:16736
    s_waitcnt lgkmcnt(8)
    v_mfma_f32_16x16x32_bf16 v[168:171], v[112:115], a[72:75], v[168:171]
    ds_read_b64_tr_b16 v[132:133], v16 offset:15488
    buffer_load_dwordx4 v14, s[16:19], s91 offen lds
    v_mfma_f32_16x16x32_bf16 v[172:175], v[112:115], a[152:155], v[172:175]
    ds_read_b64_tr_b16 v[134:135], v16 offset:16768
    s_waitcnt lgkmcnt(8)
    v_mfma_f32_16x16x32_bf16 v[136:139], v[116:119], a[76:79], v[136:139]
    v_mfma_f32_16x16x32_bf16 v[140:143], v[116:119], a[156:159], v[140:143]
    s_waitcnt lgkmcnt(6)
    v_mfma_f32_16x16x32_bf16 v[144:147], v[120:123], a[76:79], v[144:147]
    v_mfma_f32_16x16x32_bf16 v[148:151], v[120:123], a[156:159], v[148:151]
    v_add_u32 v16, s46, v15
    s_waitcnt vmcnt(10) lgkmcnt(0)
    s_barrier
    v_mfma_f32_16x16x32_bf16 v[152:155], v[124:127], a[76:79], v[152:155]
    ds_read_b64_tr_b16 v[96:97], v16 offset:0
    ds_read_b64_tr_b16 v[98:99], v16 offset:1280
    v_mfma_f32_16x16x32_bf16 v[156:159], v[124:127], a[156:159], v[156:159]
    ds_read_b64_tr_b16 v[100:101], v16 offset:32
    ds_read_b64_tr_b16 v[102:103], v16 offset:1312
    v_mfma_f32_16x16x32_bf16 v[160:163], v[128:131], a[76:79], v[160:163]
    ds_read_b64_tr_b16 v[104:105], v16 offset:64
    ds_read_b64_tr_b16 v[106:107], v16 offset:1344
    v_mfma_f32_16x16x32_bf16 v[164:167], v[128:131], a[156:159], v[164:167]
    ds_read_b64_tr_b16 v[108:109], v16 offset:96
    ds_read_b64_tr_b16 v[110:111], v16 offset:1376
    v_mfma_f32_16x16x32_bf16 v[168:171], v[132:135], a[76:79], v[168:171]
    ds_read_b64_tr_b16 v[112:113], v16 offset:128
    ds_read_b64_tr_b16 v[114:115], v16 offset:1408
    v_mfma_f32_16x16x32_bf16 v[172:175], v[132:135], a[156:159], v[172:175]
    v_add_u32 v18, s41, v17
    v_cvt_pk_bf16_f32 v176, v136, v137
    v_cvt_pk_bf16_f32 v177, v138, v139
    v_cvt_pk_bf16_f32 v178, v140, v141
    v_cvt_pk_bf16_f32 v179, v142, v143
    ds_write_b64 v18, v[176:177] offset:0
    ds_write_b64 v18, v[178:179] offset:2688
    v_cvt_pk_bf16_f32 v176, v144, v145
    v_cvt_pk_bf16_f32 v177, v146, v147
    v_cvt_pk_bf16_f32 v178, v148, v149
    v_cvt_pk_bf16_f32 v179, v150, v151
    ds_write_b64 v18, v[176:177] offset:32
    ds_write_b64 v18, v[178:179] offset:2720
    v_cvt_pk_bf16_f32 v176, v152, v153
    v_cvt_pk_bf16_f32 v177, v154, v155
    v_cvt_pk_bf16_f32 v178, v156, v157
    v_cvt_pk_bf16_f32 v179, v158, v159
    ds_write_b64 v18, v[176:177] offset:64
    ds_write_b64 v18, v[178:179] offset:2752
    v_cvt_pk_bf16_f32 v176, v160, v161
    v_cvt_pk_bf16_f32 v177, v162, v163
    v_cvt_pk_bf16_f32 v178, v164, v165
    v_cvt_pk_bf16_f32 v179, v166, v167
    ds_write_b64 v18, v[176:177] offset:96
    ds_write_b64 v18, v[178:179] offset:2784
    v_cvt_pk_bf16_f32 v176, v168, v169
    v_cvt_pk_bf16_f32 v177, v170, v171
    v_cvt_pk_bf16_f32 v178, v172, v173
    v_cvt_pk_bf16_f32 v179, v174, v175
    ds_write_b64 v18, v[176:177] offset:128
    ds_write_b64 v18, v[178:179] offset:2816
    s_waitcnt lgkmcnt(0)
    s_add_u32 s41, s41, 21504
    s_cmp_lt_u32 s41, 64512
    s_cbranch_scc1 L_pa_blk
    s_barrier
    s_mov_b32 s50, 0
L_pa_att:
    v_add_u32 v23, s50, v21
    v_add_u32 v22, s50, v20
    ds_read_b64 v[116:117], v22 offset:0
    ds_read_b64 v[118:119], v22 offset:8
    ds_read_b64 v[120:121], v22 offset:16
    ds_read_b64 v[122:123], v22 offset:24
    ds_read_b64 v[124:125], v22 offset:32
    ds_read_b64 v[126:127], v23 offset:2352
    ds_read_b64 v[128:129], v23 offset:2360
    ds_read_b64 v[130:131], v23 offset:2368
    ds_read_b64 v[132:133], v23 offset:2376
    ds_read_b64 v[134:135], v23 offset:2384
    ds_read_b64 v[136:137], v23 offset:2016
    ds_read_b64 v[138:139], v23 offset:2024
    ds_read_b64 v[140:141], v23 offset:2032
    ds_read_b64 v[142:143], v23 offset:2040
    ds_read_b64 v[144:145], v23 offset:2048
    s_waitcnt lgkmcnt(5)
    v_dot2_f32_bf16 v146, v116, v126, 0
    v_dot2_f32_bf16 v146, v117, v127, v146
    v_dot2_f32_bf16 v146, v118, v128, v146
    v_dot2_f32_bf16 v146, v119, v129, v146
    v_dot2_f32_bf16 v146, v120, v130, v146
    v_dot2_f32_bf16 v146, v121, v131, v146
    v_dot2_f32_bf16 v146, v122, v132, v146
    v_dot2_f32_bf16 v146, v123, v133, v146
    v_dot2_f32_bf16 v146, v124, v134, v146
    v_dot2_f32_bf16 v146, v125, v135, v146
    ds_read_b64 v[126:127], v23 offset:1680
    ds_read_b64 v[128:129], v23 offset:1688
    ds_read_b64 v[130:131], v23 offset:1696
    ds_read_b64 v[132:133], v23 offset:1704
    ds_read_b64 v[134:135], v23 offset:1712
    s_waitcnt lgkmcnt(5)
    v_dot2_f32_bf16 v147, v116, v136, 0
    v_dot2_f32_bf16 v147, v117, v137, v147
    v_dot2_f32_bf16 v147, v118, v138, v147
    v_dot2_f32_bf16 v147, v119, v139, v147
    v_dot2_f32_bf16 v147, v120, v140, v147
    v_dot2_f32_bf16 v147, v121, v141, v147
    v_dot2_f32_bf16 v147, v122, v142, v147
    v_dot2_f32_bf16 v147, v123, v143, v147
    v_dot2_f32_bf16 v147, v124, v144, v147
    v_dot2_f32_bf16 v147, v125, v145, v147
    ds_read_b64 v[136:137], v23 offset:1344
    ds_read_b64 v[138:139], v23 offset:1352
    ds_read_b64 v[140:141], v23 offset:1360
    ds_read_b64 v[142:143], v23 offset:1368
    ds_read_b64 v[144:145], v23 offset:1376
    s_waitcnt lgkmcnt(5)
    v_dot2_f32_bf16 v148, v116, v126, 0
    v_dot2_f32_bf16 v148, v117, v127, v148
    v_dot2_f32_bf16 v148, v118, v128, v148
    v_dot2_f32_bf16 v148, v119, v129, v148
    v_dot2_f32_bf16 v148, v120, v130, v148
    v_dot2_f32_bf16 v148, v121, v131, v148
    v_dot2_f32_bf16 v148, v122, v132, v148
    v_dot2_f32_bf16 v148, v123, v133, v148
    v_dot2_f32_bf16 v148, v124, v134, v148
    v_dot2_f32_bf16 v148, v125, v135, v148
    ds_read_b64 v[126:127], v23 offset:1008
    ds_read_b64 v[128:129], v23 offset:1016
    ds_read_b64 v[130:131], v23 offset:1024
    ds_read_b64 v[132:133], v23 offset:1032
    ds_read_b64 v[134:135], v23 offset:1040
    s_waitcnt lgkmcnt(5)
    v_dot2_f32_bf16 v149, v116, v136, 0
    v_dot2_f32_bf16 v149, v117, v137, v149
    v_dot2_f32_bf16 v149, v118, v138, v149
    v_dot2_f32_bf16 v149, v119, v139, v149
    v_dot2_f32_bf16 v149, v120, v140, v149
    v_dot2_f32_bf16 v149, v121, v141, v149
    v_dot2_f32_bf16 v149, v122, v142, v149
    v_dot2_f32_bf16 v149, v123, v143, v149
    v_dot2_f32_bf16 v149, v124, v144, v149
    v_dot2_f32_bf16 v149, v125, v145, v149
    ds_read_b64 v[136:137], v23 offset:672
    ds_read_b64 v[138:139], v23 offset:680
    ds_read_b64 v[140:141], v23 offset:688
    ds_read_b64 v[142:143], v23 offset:696
    ds_read_b64 v[144:145], v23 offset:704
    s_waitcnt lgkmcnt(5)
    v_dot2_f32_bf16 v150, v116, v126, 0
    v_dot2_f32_bf16 v150, v117, v127, v150
    v_dot2_f32_bf16 v150, v118, v128, v150
    v_dot2_f32_bf16 v150, v119, v129, v150
    v_dot2_f32_bf16 v150, v120, v130, v150
    v_dot2_f32_bf16 v150, v121, v131, v150
    v_dot2_f32_bf16 v150, v122, v132, v150
    v_dot2_f32_bf16 v150, v123, v133, v150
    v_dot2_f32_bf16 v150, v124, v134, v150
    v_dot2_f32_bf16 v150, v125, v135, v150
    ds_read_b64 v[126:127], v23 offset:336
    ds_read_b64 v[128:129], v23 offset:344
    ds_read_b64 v[130:131], v23 offset:352
    ds_read_b64 v[132:133], v23 offset:360
    ds_read_b64 v[134:135], v23 offset:368
    s_waitcnt lgkmcnt(5)
    v_dot2_f32_bf16 v151, v116, v136, 0
    v_dot2_f32_bf16 v151, v117, v137, v151
    v_dot2_f32_bf16 v151, v118, v138, v151
    v_dot2_f32_bf16 v151, v119, v139, v151
    v_dot2_f32_bf16 v151, v120, v140, v151
    v_dot2_f32_bf16 v151, v121, v141, v151
    v_dot2_f32_bf16 v151, v122, v142, v151
    v_dot2_f32_bf16 v151, v123, v143, v151
    v_dot2_f32_bf16 v151, v124, v144, v151
    v_dot2_f32_bf16 v151, v125, v145, v151
    ds_read_b64 v[136:137], v23 offset:0
    ds_read_b64 v[138:139], v23 offset:8
    ds_read_b64 v[140:141], v23 offset:16
    ds_read_b64 v[142:143], v23 offset:24
    ds_read_b64 v[144:145], v23 offset:32
    s_waitcnt lgkmcnt(5)
    v_dot2_f32_bf16 v152, v116, v126, 0
    v_dot2_f32_bf16 v152, v117, v127, v152
    v_dot2_f32_bf16 v152, v118, v128, v152
    v_dot2_f32_bf16 v152, v119, v129, v152
    v_dot2_f32_bf16 v152, v120, v130, v152
    v_dot2_f32_bf16 v152, v121, v131, v152
    v_dot2_f32_bf16 v152, v122, v132, v152
    v_dot2_f32_bf16 v152, v123, v133, v152
    v_dot2_f32_bf16 v152, v124, v134, v152
    v_dot2_f32_bf16 v152, v125, v135, v152
    ds_read_b64 v[126:127], v23 offset:23856
    ds_read_b64 v[128:129], v23 offset:23864
    ds_read_b64 v[130:131], v23 offset:23872
    ds_read_b64 v[132:133], v23 offset:23880
    ds_read_b64 v[134:135], v23 offset:23888
    s_waitcnt lgkmcnt(5)
    v_dot2_f32_bf16 v153, v116, v136, 0
    v_dot2_f32_bf16 v153, v117, v137, v153
    v_dot2_f32_bf16 v153, v118, v138, v153
    v_dot2_f32_bf16 v153, v119, v139, v153
    v_dot2_f32_bf16 v153, v120, v140, v153
    v_dot2_f32_bf16 v153, v121, v141, v153
    v_dot2_f32_bf16 v153, v122, v142, v153
    v_dot2_f32_bf16 v153, v123, v143, v153
    v_dot2_f32_bf16 v153, v124, v144, v153
    v_dot2_f32_bf16 v153, v125, v145, v153
    v_cmp_le_i32 vcc, 2, v24
    s_nop 1
    v_cndmask_b32 v147, v27, v147, vcc
    v_cmp_le_i32 vcc, 4, v24
    s_nop 1
    v_cndmask_b32 v148, v27, v148, vcc
    v_cmp_le_i32 vcc, 6, v24
    s_nop 1
    v_cndmask_b32 v149, v27, v149, vcc
    v_cmp_le_i32 vcc, 8, v24
    s_nop 1
    v_cndmask_b32 v150, v27, v150, vcc
    v_cmp_le_i32 vcc, 10, v24
    s_nop 1
    v_cndmask_b32 v151, v27, v151, vcc
    v_cmp_le_i32 vcc, 12, v24
    s_nop 1
    v_cndmask_b32 v152, v27, v152, vcc
    v_cmp_le_i32 vcc, 14, v24
    s_nop 1
    v_cndmask_b32 v153, v27, v153, vcc
    v_max_f32 v25, v146, v147
    v_max3_f32 v25, v25, v148, v149
    v_max3_f32 v25, v25, v150, v151
    v_max3_f32 v25, v25, v152, v153
    v_mul_f32 v25, 0xbea52b5c, v25
    v_fma_f32 v146, v146, s49, v25
    v_fma_f32 v147, v147, s49, v25
    v_fma_f32 v148, v148, s49, v25
    v_fma_f32 v149, v149, s49, v25
    v_fma_f32 v150, v150, s49, v25
    v_fma_f32 v151, v151, s49, v25
    v_fma_f32 v152, v152, s49, v25
    v_fma_f32 v153, v153, s49, v25
    v_exp_f32 v146, v146
    v_exp_f32 v147, v147
    v_exp_f32 v148, v148
    v_exp_f32 v149, v149
    v_exp_f32 v150, v150
    v_exp_f32 v151, v151
    v_exp_f32 v152, v152
    v_exp_f32 v153, v153
    v_add_f32 v26, v146, v147
    v_add_f32 v26, v26, v148
    v_add_f32 v26, v26, v149
    v_add_f32 v26, v26, v150
    v_add_f32 v26, v26, v151
    v_add_f32 v26, v26, v152
    v_add_f32 v26, v26, v153
    v_rcp_f32 v26, v26
    s_nop 0
    v_mul_f32 v146, v146, v26
    v_cvt_pk_bf16_f32 v154, v146, 0
    v_cvt_pk_bf16_f32 v155, 0, v146
    v_mul_f32 v147, v147, v26
    v_cvt_pk_bf16_f32 v156, v147, 0
    v_cvt_pk_bf16_f32 v157, 0, v147
    v_mul_f32 v148, v148, v26
    v_cvt_pk_bf16_f32 v158, v148, 0
    v_cvt_pk_bf16_f32 v159, 0, v148
    v_mul_f32 v149, v149, v26
    v_cvt_pk_bf16_f32 v160, v149, 0
    v_cvt_pk_bf16_f32 v161, 0, v149
    v_mul_f32 v150, v150, v26
    v_cvt_pk_bf16_f32 v162, v150, 0
    v_cvt_pk_bf16_f32 v163, 0, v150
    v_mul_f32 v151, v151, v26
    v_cvt_pk_bf16_f32 v164, v151, 0
    v_cvt_pk_bf16_f32 v165, 0, v151
    v_mul_f32 v152, v152, v26
    v_cvt_pk_bf16_f32 v166, v152, 0
    v_cvt_pk_bf16_f32 v167, 0, v152
    v_mul_f32 v153, v153, v26
    v_cvt_pk_bf16_f32 v168, v153, 0
    v_cvt_pk_bf16_f32 v169, 0, v153
    ds_read_b64 v[136:137], v23 offset:23520
    ds_read_b64 v[138:139], v23 offset:23528
    ds_read_b64 v[140:141], v23 offset:23536
    ds_read_b64 v[142:143], v23 offset:23544
    ds_read_b64 v[144:145], v23 offset:23552
    s_waitcnt lgkmcnt(5)
    v_dot2_f32_bf16 v170, v126, v154, 0
    v_dot2_f32_bf16 v171, v126, v155, 0
    v_dot2_f32_bf16 v172, v127, v154, 0
    v_dot2_f32_bf16 v173, v127, v155, 0
    v_dot2_f32_bf16 v174, v128, v154, 0
    v_dot2_f32_bf16 v175, v128, v155, 0
    v_dot2_f32_bf16 v176, v129, v154, 0
    v_dot2_f32_bf16 v177, v129, v155, 0
    v_dot2_f32_bf16 v178, v130, v154, 0
    v_dot2_f32_bf16 v179, v130, v155, 0
    v_dot2_f32_bf16 v180, v131, v154, 0
    v_dot2_f32_bf16 v181, v131, v155, 0
    v_dot2_f32_bf16 v182, v132, v154, 0
    v_dot2_f32_bf16 v183, v132, v155, 0
    v_dot2_f32_bf16 v184, v133, v154, 0
    v_dot2_f32_bf16 v185, v133, v155, 0
    v_dot2_f32_bf16 v186, v134, v154, 0
    v_dot2_f32_bf16 v187, v134, v155, 0
    v_dot2_f32_bf16 v188, v135, v154, 0
    v_dot2_f32_bf16 v189, v135, v155, 0
    ds_read_b64 v[126:127], v23 offset:23184
    ds_read_b64 v[128:129], v23 offset:23192
    ds_read_b64 v[130:131], v23 offset:23200
    ds_read_b64 v[132:133], v23 offset:23208
    ds_read_b64 v[134:135], v23 offset:23216
    s_waitcnt lgkmcnt(5)
    v_dot2_f32_bf16 v170, v136, v156, v170
    v_dot2_f32_bf16 v171, v136, v157, v171
    v_dot2_f32_bf16 v172, v137, v156, v172
    v_dot2_f32_bf16 v173, v137, v157, v173
    v_dot2_f32_bf16 v174, v138, v156, v174
    v_dot2_f32_bf16 v175, v138, v157, v175
    v_dot2_f32_bf16 v176, v139, v156, v176
    v_dot2_f32_bf16 v177, v139, v157, v177
    v_dot2_f32_bf16 v178, v140, v156, v178
    v_dot2_f32_bf16 v179, v140, v157, v179
    v_dot2_f32_bf16 v180, v141, v156, v180
    v_dot2_f32_bf16 v181, v141, v157, v181
    v_dot2_f32_bf16 v182, v142, v156, v182
    v_dot2_f32_bf16 v183, v142, v157, v183
    v_dot2_f32_bf16 v184, v143, v156, v184
    v_dot2_f32_bf16 v185, v143, v157, v185
    v_dot2_f32_bf16 v186, v144, v156, v186
    v_dot2_f32_bf16 v187, v144, v157, v187
    v_dot2_f32_bf16 v188, v145, v156, v188
    v_dot2_f32_bf16 v189, v145, v157, v189
    ds_read_b64 v[136:137], v23 offset:22848
    ds_read_b64 v[138:139], v23 offset:22856
    ds_read_b64 v[140:141], v23 offset:22864
    ds_read_b64 v[142:143], v23 offset:22872
    ds_read_b64 v[144:145], v23 offset:22880
    s_waitcnt lgkmcnt(5)
    v_dot2_f32_bf16 v170, v126, v158, v170
    v_dot2_f32_bf16 v171, v126, v159, v171
    v_dot2_f32_bf16 v172, v127, v158, v172
    v_dot2_f32_bf16 v173, v127, v159, v173
    v_dot2_f32_bf16 v174, v128, v158, v174
    v_dot2_f32_bf16 v175, v128, v159, v175
    v_dot2_f32_bf16 v176, v129, v158, v176
    v_dot2_f32_bf16 v177, v129, v159, v177
    v_dot2_f32_bf16 v178, v130, v158, v178
    v_dot2_f32_bf16 v179, v130, v159, v179
    v_dot2_f32_bf16 v180, v131, v158, v180
    v_dot2_f32_bf16 v181, v131, v159, v181
    v_dot2_f32_bf16 v182, v132, v158, v182
    v_dot2_f32_bf16 v183, v132, v159, v183
    v_dot2_f32_bf16 v184, v133, v158, v184
    v_dot2_f32_bf16 v185, v133, v159, v185
    v_dot2_f32_bf16 v186, v134, v158, v186
    v_dot2_f32_bf16 v187, v134, v159, v187
    v_dot2_f32_bf16 v188, v135, v158, v188
    v_dot2_f32_bf16 v189, v135, v159, v189
    ds_read_b64 v[126:127], v23 offset:22512
    ds_read_b64 v[128:129], v23 offset:22520
    ds_read_b64 v[130:131], v23 offset:22528
    ds_read_b64 v[132:133], v23 offset:22536
    ds_read_b64 v[134:135], v23 offset:22544
    s_waitcnt lgkmcnt(5)
    v_dot2_f32_bf16 v170, v136, v160, v170
    v_dot2_f32_bf16 v171, v136, v161, v171
    v_dot2_f32_bf16 v172, v137, v160, v172
    v_dot2_f32_bf16 v173, v137, v161, v173
    v_dot2_f32_bf16 v174, v138, v160, v174
    v_dot2_f32_bf16 v175, v138, v161, v175
    v_dot2_f32_bf16 v176, v139, v160, v176
    v_dot2_f32_bf16 v177, v139, v161, v177
    v_dot2_f32_bf16 v178, v140, v160, v178
    v_dot2_f32_bf16 v179, v140, v161, v179
    v_dot2_f32_bf16 v180, v141, v160, v180
    v_dot2_f32_bf16 v181, v141, v161, v181
    v_dot2_f32_bf16 v182, v142, v160, v182
    v_dot2_f32_bf16 v183, v142, v161, v183
    v_dot2_f32_bf16 v184, v143, v160, v184
    v_dot2_f32_bf16 v185, v143, v161, v185
    v_dot2_f32_bf16 v186, v144, v160, v186
    v_dot2_f32_bf16 v187, v144, v161, v187
    v_dot2_f32_bf16 v188, v145, v160, v188
    v_dot2_f32_bf16 v189, v145, v161, v189
    ds_read_b64 v[136:137], v23 offset:22176
    ds_read_b64 v[138:139], v23 offset:22184
    ds_read_b64 v[140:141], v23 offset:22192
    ds_read_b64 v[142:143], v23 offset:22200
    ds_read_b64 v[144:145], v23 offset:22208
    s_waitcnt lgkmcnt(5)
    v_dot2_f32_bf16 v170, v126, v162, v170
    v_dot2_f32_bf16 v171, v126, v163, v171
    v_dot2_f32_bf16 v172, v127, v162, v172
    v_dot2_f32_bf16 v173, v127, v163, v173
    v_dot2_f32_bf16 v174, v128, v162, v174
    v_dot2_f32_bf16 v175, v128, v163, v175
    v_dot2_f32_bf16 v176, v129, v162, v176
    v_dot2_f32_bf16 v177, v129, v163, v177
    v_dot2_f32_bf16 v178, v130, v162, v178
    v_dot2_f32_bf16 v179, v130, v163, v179
    v_dot2_f32_bf16 v180, v131, v162, v180
    v_dot2_f32_bf16 v181, v131, v163, v181
    v_dot2_f32_bf16 v182, v132, v162, v182
    v_dot2_f32_bf16 v183, v132, v163, v183
    v_dot2_f32_bf16 v184, v133, v162, v184
    v_dot2_f32_bf16 v185, v133, v163, v185
    v_dot2_f32_bf16 v186, v134, v162, v186
    v_dot2_f32_bf16 v187, v134, v163, v187
    v_dot2_f32_bf16 v188, v135, v162, v188
    v_dot2_f32_bf16 v189, v135, v163, v189
    ds_read_b64 v[126:127], v23 offset:21840
    ds_read_b64 v[128:129], v23 offset:21848
    ds_read_b64 v[130:131], v23 offset:21856
    ds_read_b64 v[132:133], v23 offset:21864
    ds_read_b64 v[134:135], v23 offset:21872
    s_waitcnt lgkmcnt(5)
    v_dot2_f32_bf16 v170, v136, v164, v170
    v_dot2_f32_bf16 v171, v136, v165, v171
    v_dot2_f32_bf16 v172, v137, v164, v172
    v_dot2_f32_bf16 v173, v137, v165, v173
    v_dot2_f32_bf16 v174, v138, v164, v174
    v_dot2_f32_bf16 v175, v138, v165, v175
    v_dot2_f32_bf16 v176, v139, v164, v176
    v_dot2_f32_bf16 v177, v139, v165, v177
    v_dot2_f32_bf16 v178, v140, v164, v178
    v_dot2_f32_bf16 v179, v140, v165, v179
    v_dot2_f32_bf16 v180, v141, v164, v180
    v_dot2_f32_bf16 v181, v141, v165, v181
    v_dot2_f32_bf16 v182, v142, v164, v182
    v_dot2_f32_bf16 v183, v142, v165, v183
    v_dot2_f32_bf16 v184, v143, v164, v184
    v_dot2_f32_bf16 v185, v143, v165, v185
    v_dot2_f32_bf16 v186, v144, v164, v186
    v_dot2_f32_bf16 v187, v144, v165, v187
    v_dot2_f32_bf16 v188, v145, v164, v188
    v_dot2_f32_bf16 v189, v145, v165, v189
    ds_read_b64 v[136:137], v23 offset:21504
    ds_read_b64 v[138:139], v23 offset:21512
    ds_read_b64 v[140:141], v23 offset:21520
    ds_read_b64 v[142:143], v23 offset:21528
    ds_read_b64 v[144:145], v23 offset:21536
    s_waitcnt lgkmcnt(5)
    v_dot2_f32_bf16 v170, v126, v166, v170
    v_dot2_f32_bf16 v171, v126, v167, v171
    v_dot2_f32_bf16 v172, v127, v166, v172
    v_dot2_f32_bf16 v173, v127, v167, v173
    v_dot2_f32_bf16 v174, v128, v166, v174
    v_dot2_f32_bf16 v175, v128, v167, v175
    v_dot2_f32_bf16 v176, v129, v166, v176
    v_dot2_f32_bf16 v177, v129, v167, v177
    v_dot2_f32_bf16 v178, v130, v166, v178
    v_dot2_f32_bf16 v179, v130, v167, v179
    v_dot2_f32_bf16 v180, v131, v166, v180
    v_dot2_f32_bf16 v181, v131, v167, v181
    v_dot2_f32_bf16 v182, v132, v166, v182
    v_dot2_f32_bf16 v183, v132, v167, v183
    v_dot2_f32_bf16 v184, v133, v166, v184
    v_dot2_f32_bf16 v185, v133, v167, v185
    v_dot2_f32_bf16 v186, v134, v166, v186
    v_dot2_f32_bf16 v187, v134, v167, v187
    v_dot2_f32_bf16 v188, v135, v166, v188
    v_dot2_f32_bf16 v189, v135, v167, v189
    s_waitcnt lgkmcnt(0)
    v_dot2_f32_bf16 v170, v136, v168, v170
    v_dot2_f32_bf16 v171, v136, v169, v171
    v_dot2_f32_bf16 v172, v137, v168, v172
    v_dot2_f32_bf16 v173, v137, v169, v173
    v_dot2_f32_bf16 v174, v138, v168, v174
    v_dot2_f32_bf16 v175, v138, v169, v175
    v_dot2_f32_bf16 v176, v139, v168, v176
    v_dot2_f32_bf16 v177, v139, v169, v177
    v_dot2_f32_bf16 v178, v140, v168, v178
    v_dot2_f32_bf16 v179, v140, v169, v179
    v_dot2_f32_bf16 v180, v141, v168, v180
    v_dot2_f32_bf16 v181, v141, v169, v181
    v_dot2_f32_bf16 v182, v142, v168, v182
    v_dot2_f32_bf16 v183, v142, v169, v183
    v_dot2_f32_bf16 v184, v143, v168, v184
    v_dot2_f32_bf16 v185, v143, v169, v185
    v_dot2_f32_bf16 v186, v144, v168, v186
    v_dot2_f32_bf16 v187, v144, v169, v187
    v_dot2_f32_bf16 v188, v145, v168, v188
    v_dot2_f32_bf16 v189, v145, v169, v189
    v_cvt_pk_bf16_f32 v116, v170, v171
    v_cvt_pk_bf16_f32 v117, v172, v173
    v_cvt_pk_bf16_f32 v118, v174, v175
    v_cvt_pk_bf16_f32 v119, v176, v177
    v_cvt_pk_bf16_f32 v120, v178, v179
    v_cvt_pk_bf16_f32 v121, v180, v181
    v_cvt_pk_bf16_f32 v122, v182, v183
    v_cvt_pk_bf16_f32 v123, v184, v185
    v_cvt_pk_bf16_f32 v124, v186, v187
    v_cvt_pk_bf16_f32 v125, v188, v189
    ds_write_b64 v22, v[116:117] offset:0
    ds_write_b64 v22, v[118:119] offset:8
    ds_write_b64 v22, v[120:121] offset:16
    ds_write_b64 v22, v[122:123] offset:24
    ds_write_b64 v22, v[124:125] offset:32
    s_waitcnt lgkmcnt(0)
    s_add_u32 s50, s50, 80
    s_cmp_lt_u32 s50, 160
    s_cbranch_scc1 L_pa_att
    s_cmp_lg_u32 s48, 0
    s_cbranch_scc1 L_pa_o1
    ds_read_b64 a[160:161], v28 offset:32
    ds_read_b64 a[162:163], v28 offset:40
    ds_read_b64 a[240:241], v28 offset:2720
    ds_read_b64 a[242:243], v28 offset:2728
    ds_read_b64 a[164:165], v28 offset:96
    ds_read_b64 a[166:167], v28 offset:104
    ds_read_b64 a[244:245], v28 offset:2784
    ds_read_b64 a[246:247], v28 offset:2792
    s_mov_b32 exec_hi, 0
    ds_read_b64 a[168:169], v28 offset:160
    ds_read_b64 a[170:171], v28 offset:168
    ds_read_b64 a[248:249], v28 offset:2848
    ds_read_b64 a[250:251], v28 offset:2856
    s_mov_b64 exec, -1
    s_branch L_pa_oe
L_pa_o1:
    s_cmp_lg_u32 s48, 1
    s_cbranch_scc1 L_pa_o2
    s_mov_b32 exec_lo, 0
    ds_read_b64 a[168:169], v28 offset:0
    ds_read_b64 a[170:171], v28 offset:8
    ds_read_b64 a[248:249], v28 offset:2688
    ds_read_b64 a[250:251], v28 offset:2696
    s_mov_b64 exec, -1
    ds_read_b64 a[172:173], v28 offset:64
    ds_read_b64 a[174:175], v28 offset:72
    ds_read_b64 a[252:253], v28 offset:2752
    ds_read_b64 a[254:255], v28 offset:2760
    ds_read_b64 a[176:177], v28 offset:128
    ds_read_b64 a[178:179], v28 offset:136
    ds_read_b64 v[32:33], v28 offset:2816
    ds_read_b64 v[34:35], v28 offset:2824
    s_branch L_pa_oe
L_pa_o2:
    s_cmp_lg_u32 s48, 2
    s_cbranch_scc1 L_pa_o3
    ds_read_b64 a[180:181], v28 offset:32
    ds_read_b64 a[182:183], v28 offset:40
    ds_read_b64 v[36:37], v28 offset:2720
    ds_read_b64 v[38:39], v28 offset:2728
    ds_read_b64 a[184:185], v28 offset:96
    ds_read_b64 a[186:187], v28 offset:104
    ds_read_b64 v[40:41], v28 offset:2784
    ds_read_b64 v[42:43], v28 offset:2792
    s_mov_b32 exec_hi, 0
    ds_read_b64 a[188:189], v28 offset:160
    ds_read_b64 a[190:191], v28 offset:168
    ds_read_b64 v[44:45], v28 offset:2848
    ds_read_b64 v[46:47], v28 offset:2856
    s_mov_b64 exec, -1
    s_branch L_pa_oe
L_pa_o3:
    s_cmp_lg_u32 s48, 3
    s_cbranch_scc1 L_pa_o4
    s_mov_b32 exec_lo, 0
    ds_read_b64 a[188:189], v28 offset:0
    ds_read_b64 a[190:191], v28 offset:8
    ds_read_b64 v[44:45], v28 offset:2688
    ds_read_b64 v[46:47], v28 offset:2696
    s_mov_b64 exec, -1
    ds_read_b64 a[192:193], v28 offset:64
    ds_read_b64 a[194:195], v28 offset:72
    ds_read_b64 v[48:49], v28 offset:2752
    ds_read_b64 v[50:51], v28 offset:2760
    ds_read_b64 a[196:197], v28 offset:128
    ds_read_b64 a[198:199], v28 offset:136
    ds_read_b64 v[52:53], v28 offset:2816
    ds_read_b64 v[54:55], v28 offset:2824
    s_branch L_pa_oe
L_pa_o4:
    s_cmp_lg_u32 s48, 4
    s_cbranch_scc1 L_pa_o5
    ds_read_b64 a[200:201], v28 offset:32
    ds_read_b64 a[202:203], v28 offset:40
    ds_read_b64 v[56:57], v28 offset:2720
    ds_read_b64 v[58:59], v28 offset:2728
    ds_read_b64 a[204:205], v28 offset:96
    ds_read_b64 a[206:207], v28 offset:104
    ds_read_b64 v[60:61], v28 offset:2784
    ds_read_b64 v[62:63], v28 offset:2792
    s_mov_b32 exec_hi, 0
    ds_read_b64 a[208:209], v28 offset:160
    ds_read_b64 a[210:211], v28 offset:168
    ds_read_b64 v[64:65], v28 offset:2848
    ds_read_b64 v[66:67], v28 offset:2856
    s_mov_b64 exec, -1
    s_branch L_pa_oe
L_pa_o5:
    s_cmp_lg_u32 s48, 5
    s_cbranch_scc1 L_pa_o6
    s_mov_b32 exec_lo, 0
    ds_read_b64 a[208:209], v28 offset:0
    ds_read_b64 a[210:211], v28 offset:8
    ds_read_b64 v[64:65], v28 offset:2688
    ds_read_b64 v[66:67], v28 offset:2696
    s_mov_b64 exec, -1
    ds_read_b64 a[212:213], v28 offset:64
    ds_read_b64 a[214:215], v28 offset:72
    ds_read_b64 v[68:69], v28 offset:2752
    ds_read_b64 v[70:71], v28 offset:2760
    ds_read_b64 a[216:217], v28 offset:128
    ds_read_b64 a[218:219], v28 offset:136
    ds_read_b64 v[72:73], v28 offset:2816
    ds_read_b64 v[74:75], v28 offset:2824
    s_branch L_pa_oe
L_pa_o6:
    s_cmp_lg_u32 s48, 6
    s_cbranch_scc1 L_pa_o7
    ds_read_b64 a[220:221], v28 offset:32
    ds_read_b64 a[222:223], v28 offset:40
    ds_read_b64 v[76:77], v28 offset:2720
    ds_read_b64 v[78:79], v28 offset:2728
    ds_read_b64 a[224:225], v28 offset:96
    ds_read_b64 a[226:227], v28 offset:104
    ds_read_b64 v[80:81], v28 offset:2784
    ds_read_b64 v[82:83], v28 offset:2792
    s_mov_b32 exec_hi, 0
    ds_read_b64 a[228:229], v28 offset:160
    ds_read_b64 a[230:231], v28 offset:168
    ds_read_b64 v[84:85], v28 offset:2848
    ds_read_b64 v[86:87], v28 offset:2856
    s_mov_b64 exec, -1
    s_branch L_pa_oe
L_pa_o7:
    s_mov_b32 exec_lo, 0
    ds_read_b64 a[228:229], v28 offset:0
    ds_read_b64 a[230:231], v28 offset:8
    ds_read_b64 v[84:85], v28 offset:2688
    ds_read_b64 v[86:87], v28 offset:2696
    s_mov_b64 exec, -1
    ds_read_b64 a[232:233], v28 offset:64
    ds_read_b64 a[234:235], v28 offset:72
    ds_read_b64 v[88:89], v28 offset:2752
    ds_read_b64 v[90:91], v28 offset:2760
    ds_read_b64 a[236:237], v28 offset:128
    ds_read_b64 a[238:239], v28 offset:136
    ds_read_b64 v[92:93], v28 offset:2816
    ds_read_b64 v[94:95], v28 offset:2824
L_pa_oe:
    s_waitcnt lgkmcnt(0)
    s_add_u32 s48, s48, 1
    s_and_b32 s48, s48, 7
    s_cmp_lg_u32 s48, s52
    s_cbranch_scc1 L_pa_grp
    v_add_u32 v3, 0, v0
    v_mul_u32_u24 v4, 6554, v3
    v_lshrrev_b32 v4, 16, v4
    v_mul_u32_u24 v5, 10, v4
    v_sub_u32 v5, v3, v5
    v_and_b32 v6, 19, v4
    v_and_b32 v7, 4, v4
    v_lshl_or_b32 v6, v7, 1, v6
    v_and_b32 v7, 8, v4
    v_lshrrev_b32 v7, 1, v7
    v_or_b32 v6, v6, v7
    s_lshl_b32 s90, s32, 5
    v_add_u32 v6, s90, v6
    v_mul_u32_u24 v6, 1280, v6
    v_lshl_add_u32 v10, v5, 4, v6
    v_add_u32 v3, 64, v0
    v_mul_u32_u24 v4, 6554, v3
    v_lshrrev_b32 v4, 16, v4
    v_mul_u32_u24 v5, 10, v4
    v_sub_u32 v5, v3, v5
    v_and_b32 v6, 19, v4
    v_and_b32 v7, 4, v4
    v_lshl_or_b32 v6, v7, 1, v6
    v_and_b32 v7, 8, v4
    v_lshrrev_b32 v7, 1, v7
    v_or_b32 v6, v6, v7
    s_lshl_b32 s90, s32, 5
    v_add_u32 v6, s90, v6
    v_mul_u32_u24 v6, 1280, v6
    v_lshl_add_u32 v11, v5, 4, v6
    v_add_u32 v3, 128, v0
    v_mul_u32_u24 v4, 6554, v3
    v_lshrrev_b32 v4, 16, v4
    v_mul_u32_u24 v5, 10, v4
    v_sub_u32 v5, v3, v5
    v_and_b32 v6, 19, v4
    v_and_b32 v7, 4, v4
    v_lshl_or_b32 v6, v7, 1, v6
    v_and_b32 v7, 8, v4
    v_lshrrev_b32 v7, 1, v7
    v_or_b32 v6, v6, v7
    s_lshl_b32 s90, s32, 5
    v_add_u32 v6, s90, v6
    v_mul_u32_u24 v6, 1280, v6
    v_lshl_add_u32 v12, v5, 4, v6
    v_add_u32 v3, 192, v0
    v_mul_u32_u24 v4, 6554, v3
    v_lshrrev_b32 v4, 16, v4
    v_mul_u32_u24 v5, 10, v4
    v_sub_u32 v5, v3, v5
    v_and_b32 v6, 19, v4
    v_and_b32 v7, 4, v4
    v_lshl_or_b32 v6, v7, 1, v6
    v_and_b32 v7, 8, v4
    v_lshrrev_b32 v7, 1, v7
    v_or_b32 v6, v6, v7
    s_lshl_b32 s90, s32, 5
    v_add_u32 v6, s90, v6
    v_mul_u32_u24 v6, 1280, v6
    v_lshl_add_u32 v13, v5, 4, v6
    v_add_u32 v3, 256, v0
    v_mul_u32_u24 v4, 6554, v3
    v_lshrrev_b32 v4, 16, v4
    v_mul_u32_u24 v5, 10, v4
    v_sub_u32 v5, v3, v5
    v_and_b32 v6, 19, v4
    v_and_b32 v7, 4, v4
    v_lshl_or_b32 v6, v7, 1, v6
    v_and_b32 v7, 8, v4
    v_lshrrev_b32 v7, 1, v7
    v_or_b32 v6, v6, v7
    s_lshl_b32 s90, s32, 5
    v_add_u32 v6, s90, v6
    v_mul_u32_u24 v6, 1280, v6
    v_lshl_add_u32 v14, v5, 4, v6
    s_waitcnt vmcnt(0) lgkmcnt(0)
    s_barrier
    s_mov_b32 s46, 0
    s_mov_b32 s47, 0
    s_mul_i32 s43, s52, 160
    s_mov_b32 s44, 0
    s_mov_b32 s45, 0
    s_mov_b32 s51, 39
    s_mov_b32 s48, s52
    s_mov_b32 s53, 0
    s_mul_i32 s90, s32, 5120
    s_add_u32 m0, s90, s47
    s_mul_i32 s91, s44, 163840
    s_add_u32 s91, s91, s43
    buffer_load_dwordx4 v10, s[20:23], s91 offen lds
    s_add_u32 s47, s47, 20480
    s_cmp_eq_u32 s47, 81920
    s_cselect_b32 s47, 0, s47
    s_cmp_lg_u32 s51, 0
    s_cselect_b32 s90, 1, 0
    s_sub_u32 s51, s51, s90
    s_add_u32 s44, s44, s90
    s_cmp_eq_u32 s44, 5
    s_cselect_b32 s44, 0, s44
    s_cselect_b32 s90, 160, 0
    s_add_u32 s43, s43, s90
    s_cmp_eq_u32 s43, 1280
    s_cselect_b32 s43, 0, s43
    s_add_u32 m0, m0, 1024
    s_nop 0
    buffer_load_dwordx4 v11, s[20:23], s91 offen lds
    s_add_u32 m0, m0, 1024
    s_nop 0
    buffer_load_dwordx4 v12, s[20:23], s91 offen lds
    s_add_u32 m0, m0, 1024
    s_nop 0
    buffer_load_dwordx4 v13, s[20:23], s91 offen lds
    s_add_u32 m0, m0, 1024
    s_nop 0
    buffer_load_dwordx4 v14, s[20:23], s91 offen lds
    s_mul_i32 s90, s32, 5120
    s_add_u32 m0, s90, s47
    s_mul_i32 s91, s44, 163840
    s_add_u32 s91, s91, s43
    buffer_load_dwordx4 v10, s[20:23], s91 offen lds
    s_add_u32 s47, s47, 20480
    s_cmp_eq_u32 s47, 81920
    s_cselect_b32 s47, 0, s47
    s_cmp_lg_u32 s51, 0
    s_cselect_b32 s90, 1, 0
    s_sub_u32 s51, s51, s90
    s_add_u32 s44, s44, s90
    s_cmp_eq_u32 s44, 5
    s_cselect_b32 s44, 0, s44
    s_cselect_b32 s90, 160, 0
    s_add_u32 s43, s43, s90
    s_cmp_eq_u32 s43, 1280
    s_cselect_b32 s43, 0, s43
    s_add_u32 m0, m0, 1024
    s_nop 0
    buffer_load_dwordx4 v11, s[20:23], s91 offen lds
    s_add_u32 m0, m0, 1024
    s_nop 0
    buffer_load_dwordx4 v12, s[20:23], s91 offen lds
    s_add_u32 m0, m0, 1024
    s_nop 0
    buffer_load_dwordx4 v13, s[20:23], s91 offen lds
    s_add_u32 m0, m0, 1024
    s_nop 0
    buffer_load_dwordx4 v14, s[20:23], s91 offen lds
    s_mul_i32 s90, s32, 5120
    s_add_u32 m0, s90, s47
    s_mul_i32 s91, s44, 163840
    s_add_u32 s91, s91, s43
    buffer_load_dwordx4 v10, s[20:23], s91 offen lds
    s_add_u32 s47, s47, 20480
    s_cmp_eq_u32 s47, 81920
    s_cselect_b32 s47, 0, s47
    s_cmp_lg_u32 s51, 0
    s_cselect_b32 s90, 1, 0
    s_sub_u32 s51, s51, s90
    s_add_u32 s44, s44, s90
    s_cmp_eq_u32 s44, 5
    s_cselect_b32 s44, 0, s44
    s_cselect_b32 s90, 160, 0
    s_add_u32 s43, s43, s90
    s_cmp_eq_u32 s43, 1280
    s_cselect_b32 s43, 0, s43
    s_add_u32 m0, m0, 1024
    s_nop 0
    buffer_load_dwordx4 v11, s[20:23], s91 offen lds
    s_add_u32 m0, m0, 1024
    s_nop 0
    buffer_load_dwordx4 v12, s[20:23], s91 offen lds
    s_add_u32 m0, m0, 1024
    s_nop 0
    buffer_load_dwordx4 v13, s[20:23], s91 offen lds
    s_add_u32 m0, m0, 1024
    s_nop 0
    buffer_load_dwordx4 v14, s[20:23], s91 offen lds
    v_add_u32 v16, s46, v15
    s_waitcnt vmcnt(10) lgkmcnt(0)
    s_barrier
    ds_read_b64_tr_b16 v[96:97], v16 offset:0
    ds_read_b64_tr_b16 v[98:99], v16 offset:1280
    ds_read_b64_tr_b16 v[100:101], v16 offset:32
    ds_read_b64_tr_b16 v[102:103], v16 offset:1312
    ds_read_b64_tr_b16 v[104:105], v16 offset:64
    ds_read_b64_tr_b16 v[106:107], v16 offset:1344
    ds_read_b64_tr_b16 v[108:109], v16 offset:96
    ds_read_b64_tr_b16 v[110:111], v16 offset:1376
    ds_read_b64_tr_b16 v[112:113], v16 offset:128
    ds_read_b64_tr_b16 v[114:115], v16 offset:1408
    s_mul_i32 s42, s52, 160
L_pa_oblk:
    s_waitcnt lgkmcnt(8)
    v_mfma_f32_16x16x32_bf16 v[136:139], v[96:99], a[160:163], 0
    ds_read_b64_tr_b16 v[116:117], v16 offset:5120
    s_add_u32 s46, s46, 20480
    s_cmp_eq_u32 s46, 81920
    v_mfma_f32_16x16x32_bf16 v[140:143], v[96:99], a[240:243], 0
    ds_read_b64_tr_b16 v[118:119], v16 offset:6400
    s_cselect_b32 s46, 0, s46
    s_mul_i32 s90, s32, 5120
    s_waitcnt lgkmcnt(8)
    v_mfma_f32_16x16x32_bf16 v[144:147], v[100:103], a[160:163], 0
    ds_read_b64_tr_b16 v[120:121], v16 offset:5152
    s_add_u32 m0, s90, s47
    s_mul_i32 s91, s44, 163840
    v_mfma_f32_16x16x32_bf16 v[148:151], v[100:103], a[240:243], 0
    ds_read_b64_tr_b16 v[122:123], v16 offset:6432
    s_add_u32 s91, s91, s43
    buffer_load_dwordx4 v10, s[20:23], s91 offen lds
    s_waitcnt lgkmcnt(8)
    v_mfma_f32_16x16x32_bf16 v[152:155], v[104:107], a[160:163], 0
    ds_read_b64_tr_b16 v[124:125], v16 offset:5184
    s_add_u32 s47, s47, 20480
    s_cmp_eq_u32 s47, 81920
    v_mfma_f32_16x16x32_bf16 v[156:159], v[104:107], a[240:243], 0
    ds_read_b64_tr_b16 v[126:127], v16 offset:6464
    s_cselect_b32 s47, 0, s47
    s_cmp_lg_u32 s51, 0
    s_waitcnt lgkmcnt(8)
    v_mfma_f32_16x16x32_bf16 v[160:163], v[108:111], a[160:163], 0
    ds_read_b64_tr_b16 v[128:129], v16 offset:5216
    s_cselect_b32 s90, 1, 0
    s_sub_u32 s51, s51, s90
    v_mfma_f32_16x16x32_bf16 v[164:167], v[108:111], a[240:243], 0
    ds_read_b64_tr_b16 v[130:131], v16 offset:6496
    s_add_u32 s44, s44, s90
    s_cmp_eq_u32 s44, 5
    s_waitcnt lgkmcnt(8)
    v_mfma_f32_16x16x32_bf16 v[168:171], v[112:115], a[160:163], 0
    ds_read_b64_tr_b16 v[132:133], v16 offset:5248
    s_cselect_b32 s44, 0, s44
    s_cselect_b32 s90, 160, 0
    v_mfma_f32_16x16x32_bf16 v[172:175], v[112:115], a[240:243], 0
    ds_read_b64_tr_b16 v[134:135], v16 offset:6528
    s_add_u32 s43, s43, s90
    s_cmp_eq_u32 s43, 1280
    s_waitcnt lgkmcnt(8)
    v_mfma_f32_16x16x32_bf16 v[136:139], v[116:119], a[164:167], v[136:139]
    ds_read_b64_tr_b16 v[96:97], v16 offset:10240
    s_cselect_b32 s43, 0, s43
    s_add_u32 m0, m0, 1024
    v_mfma_f32_16x16x32_bf16 v[140:143], v[116:119], a[244:247], v[140:143]
    ds_read_b64_tr_b16 v[98:99], v16 offset:11520
    buffer_load_dwordx4 v11, s[20:23], s91 offen lds
    s_add_u32 m0, m0, 1024
    s_waitcnt lgkmcnt(8)
    v_mfma_f32_16x16x32_bf16 v[144:147], v[120:123], a[164:167], v[144:147]
    ds_read_b64_tr_b16 v[100:101], v16 offset:10272
    v_mfma_f32_16x16x32_bf16 v[148:151], v[120:123], a[244:247], v[148:151]
    ds_read_b64_tr_b16 v[102:103], v16 offset:11552
    s_waitcnt lgkmcnt(8)
    v_mfma_f32_16x16x32_bf16 v[152:155], v[124:127], a[164:167], v[152:155]
    ds_read_b64_tr_b16 v[104:105], v16 offset:10304
    v_mfma_f32_16x16x32_bf16 v[156:159], v[124:127], a[244:247], v[156:159]
    ds_read_b64_tr_b16 v[106:107], v16 offset:11584
    s_waitcnt lgkmcnt(8)
    v_mfma_f32_16x16x32_bf16 v[160:163], v[128:131], a[164:167], v[160:163]
    ds_read_b64_tr_b16 v[108:109], v16 offset:10336
    buffer_load_dwordx4 v12, s[20:23], s91 offen lds
    s_add_u32 m0, m0, 1024
    v_mfma_f32_16x16x32_bf16 v[164:167], v[128:131], a[244:247], v[164:167]
    ds_read_b64_tr_b16 v[110:111], v16 offset:11616
    s_waitcnt lgkmcnt(8)
    v_mfma_f32_16x16x32_bf16 v[168:171], v[132:135], a[164:167], v[168:171]
    ds_read_b64_tr_b16 v[112:113], v16 offset:10368
    v_mfma_f32_16x16x32_bf16 v[172:175], v[132:135], a[244:247], v[172:175]
    ds_read_b64_tr_b16 v[114:115], v16 offset:11648
    s_waitcnt lgkmcnt(8)
    v_mfma_f32_16x16x32_bf16 v[136:139], v[96:99], a[168:171], v[136:139]
    ds_read_b64_tr_b16 v[116:117], v16 offset:15360
    v_mfma_f32_16x16x32_bf16 v[140:143], v[96:99], a[248:251], v[140:143]
    ds_read_b64_tr_b16 v[118:119], v16 offset:16640
    buffer_load_dwordx4 v13, s[20:23], s91 offen lds
    s_add_u32 m0, m0, 1024
    s_waitcnt lgkmcnt(8)
    v_mfma_f32_16x16x32_bf16 v[144:147], v[100:103], a[168:171], v[144:147]
    ds_read_b64_tr_b16 v[120:121], v16 offset:15392
    v_mfma_f32_16x16x32_bf16 v[148:151], v[100:103], a[248:251], v[148:151]
    ds_read_b64_tr_b16 v[122:123], v16 offset:16672
    s_waitcnt lgkmcnt(8)
    v_mfma_f32_16x16x32_bf16 v[152:155], v[104:107], a[168:171], v[152:155]
    ds_read_b64_tr_b16 v[124:125], v16 offset:15424
    v_mfma_f32_16x16x32_bf16 v[156:159], v[104:107], a[248:251], v[156:159]
    ds_read_b64_tr_b16 v[126:127], v16 offset:16704
    s_waitcnt lgkmcnt(8)
    v_mfma_f32_16x16x32_bf16 v[160:163], v[108:111], a[168:171], v[160:163]
    ds_read_b64_tr_b16 v[128:129], v16 offset:15456
    buffer_load_dwordx4 v14, s[20:23], s91 offen lds
    v_mfma_f32_16x16x32_bf16 v[164:167], v[108:111], a[248:251], v[164:167]
    ds_read_b64_tr_b16 v[130:131], v16 offset:16736
    s_waitcnt lgkmcnt(8)
    v_mfma_f32_16x16x32_bf16 v[168:171], v[112:115], a[168:171], v[168:171]
    ds_read_b64_tr_b16 v[132:133], v16 offset:15488
    v_mfma_f32_16x16x32_bf16 v[172:175], v[112:115], a[248:251], v[172:175]
    ds_read_b64_tr_b16 v[134:135], v16 offset:16768
    s_waitcnt lgkmcnt(8)
    v_mfma_f32_16x16x32_bf16 v[136:139], v[116:119], a[172:175], v[136:139]
    v_mfma_f32_16x16x32_bf16 v[140:143], v[116:119], a[252:255], v[140:143]
    s_waitcnt lgkmcnt(6)
    v_mfma_f32_16x16x32_bf16 v[144:147], v[120:123], a[172:175], v[144:147]
    v_mfma_f32_16x16x32_bf16 v[148:151], v[120:123], a[252:255], v[148:151]
    v_add_u32 v16, s46, v15
    s_waitcnt vmcnt(10) lgkmcnt(0)
    s_barrier
    v_mfma_f32_16x16x32_bf16 v[152:155], v[124:127], a[172:175], v[152:155]
    ds_read_b64_tr_b16 v[96:97], v16 offset:0
    ds_read_b64_tr_b16 v[98:99], v16 offset:1280
    v_mfma_f32_16x16x32_bf16 v[156:159], v[124:127], a[252:255], v[156:159]
    ds_read_b64_tr_b16 v[100:101], v16 offset:32
    ds_read_b64_tr_b16 v[102:103], v16 offset:1312
    v_mfma_f32_16x16x32_bf16 v[160:163], v[128:131], a[172:175], v[160:163]
    ds_read_b64_tr_b16 v[104:105], v16 offset:64
    ds_read_b64_tr_b16 v[106:107], v16 offset:1344
    v_mfma_f32_16x16x32_bf16 v[164:167], v[128:131], a[252:255], v[164:167]
    ds_read_b64_tr_b16 v[108:109], v16 offset:96
    ds_read_b64_tr_b16 v[110:111], v16 offset:1376
    v_mfma_f32_16x16x32_bf16 v[168:171], v[132:135], a[172:175], v[168:171]
    ds_read_b64_tr_b16 v[112:113], v16 offset:128
    ds_read_b64_tr_b16 v[114:115], v16 offset:1408
    v_mfma_f32_16x16x32_bf16 v[172:175], v[132:135], a[252:255], v[172:175]
    s_waitcnt lgkmcnt(8)
    v_mfma_f32_16x16x32_bf16 v[136:139], v[96:99], a[176:179], v[136:139]
    ds_read_b64_tr_b16 v[116:117], v16 offset:5120
    s_add_u32 s46, s46, 20480
    s_cmp_eq_u32 s46, 81920
    v_mfma_f32_16x16x32_bf16 v[140:143], v[96:99], v[32:35], v[140:143]
    ds_read_b64_tr_b16 v[118:119], v16 offset:6400
    s_cselect_b32 s46, 0, s46
    s_mul_i32 s90, s32, 5120
    s_waitcnt lgkmcnt(8)
    v_mfma_f32_16x16x32_bf16 v[144:147], v[100:103], a[176:179], v[144:147]
    ds_read_b64_tr_b16 v[120:121], v16 offset:5152
    s_add_u32 m0, s90, s47
    s_mul_i32 s91, s44, 163840
    v_mfma_f32_16x16x32_bf16 v[148:151], v[100:103], v[32:35], v[148:151]
    ds_read_b64_tr_b16 v[122:123], v16 offset:6432
    s_add_u32 s91, s91, s43
    buffer_load_dwordx4 v10, s[20:23], s91 offen lds
    s_waitcnt lgkmcnt(8)
    v_mfma_f32_16x16x32_bf16 v[152:155], v[104:107], a[176:179], v[152:155]
    ds_read_b64_tr_b16 v[124:125], v16 offset:5184
    s_add_u32 s47, s47, 20480
    s_cmp_eq_u32 s47, 81920
    v_mfma_f32_16x16x32_bf16 v[156:159], v[104:107], v[32:35], v[156:159]
    ds_read_b64_tr_b16 v[126:127], v16 offset:6464
    s_cselect_b32 s47, 0, s47
    s_cmp_lg_u32 s51, 0
    s_waitcnt lgkmcnt(8)
    v_mfma_f32_16x16x32_bf16 v[160:163], v[108:111], a[176:179], v[160:163]
    ds_read_b64_tr_b16 v[128:129], v16 offset:5216
    s_cselect_b32 s90, 1, 0
    s_sub_u32 s51, s51, s90
    v_mfma_f32_16x16x32_bf16 v[164:167], v[108:111], v[32:35], v[164:167]
    ds_read_b64_tr_b16 v[130:131], v16 offset:6496
    s_add_u32 s44, s44, s90
    s_cmp_eq_u32 s44, 5
    s_waitcnt lgkmcnt(8)
    v_mfma_f32_16x16x32_bf16 v[168:171], v[112:115], a[176:179], v[168:171]
    ds_read_b64_tr_b16 v[132:133], v16 offset:5248
    s_cselect_b32 s44, 0, s44
    s_cselect_b32 s90, 160, 0
    v_mfma_f32_16x16x32_bf16 v[172:175], v[112:115], v[32:35], v[172:175]
    ds_read_b64_tr_b16 v[134:135], v16 offset:6528
    s_add_u32 s43, s43, s90
    s_cmp_eq_u32 s43, 1280
    s_waitcnt lgkmcnt(8)
    v_mfma_f32_16x16x32_bf16 v[136:139], v[116:119], a[180:183], v[136:139]
    ds_read_b64_tr_b16 v[96:97], v16 offset:10240
    s_cselect_b32 s43, 0, s43
    s_add_u32 m0, m0, 1024
    v_mfma_f32_16x16x32_bf16 v[140:143], v[116:119], v[36:39], v[140:143]
    ds_read_b64_tr_b16 v[98:99], v16 offset:11520
    buffer_load_dwordx4 v11, s[20:23], s91 offen lds
    s_add_u32 m0, m0, 1024
    s_waitcnt lgkmcnt(8)
    v_mfma_f32_16x16x32_bf16 v[144:147], v[120:123], a[180:183], v[144:147]
    ds_read_b64_tr_b16 v[100:101], v16 offset:10272
    v_mfma_f32_16x16x32_bf16 v[148:151], v[120:123], v[36:39], v[148:151]
    ds_read_b64_tr_b16 v[102:103], v16 offset:11552
    s_waitcnt lgkmcnt(8)
    v_mfma_f32_16x16x32_bf16 v[152:155], v[124:127], a[180:183], v[152:155]
    ds_read_b64_tr_b16 v[104:105], v16 offset:10304
    v_mfma_f32_16x16x32_bf16 v[156:159], v[124:127], v[36:39], v[156:159]
    ds_read_b64_tr_b16 v[106:107], v16 offset:11584
    s_waitcnt lgkmcnt(8)
    v_mfma_f32_16x16x32_bf16 v[160:163], v[128:131], a[180:183], v[160:163]
    ds_read_b64_tr_b16 v[108:109], v16 offset:10336
    buffer_load_dwordx4 v12, s[20:23], s91 offen lds
    s_add_u32 m0, m0, 1024
    v_mfma_f32_16x16x32_bf16 v[164:167], v[128:131], v[36:39], v[164:167]
    ds_read_b64_tr_b16 v[110:111], v16 offset:11616
    s_waitcnt lgkmcnt(8)
    v_mfma_f32_16x16x32_bf16 v[168:171], v[132:135], a[180:183], v[168:171]
    ds_read_b64_tr_b16 v[112:113], v16 offset:10368
    v_mfma_f32_16x16x32_bf16 v[172:175], v[132:135], v[36:39], v[172:175]
    ds_read_b64_tr_b16 v[114:115], v16 offset:11648
    s_waitcnt lgkmcnt(8)
    v_mfma_f32_16x16x32_bf16 v[136:139], v[96:99], a[184:187], v[136:139]
    ds_read_b64_tr_b16 v[116:117], v16 offset:15360
    v_mfma_f32_16x16x32_bf16 v[140:143], v[96:99], v[40:43], v[140:143]
    ds_read_b64_tr_b16 v[118:119], v16 offset:16640
    buffer_load_dwordx4 v13, s[20:23], s91 offen lds
    s_add_u32 m0, m0, 1024
    s_waitcnt lgkmcnt(8)
    v_mfma_f32_16x16x32_bf16 v[144:147], v[100:103], a[184:187], v[144:147]
    ds_read_b64_tr_b16 v[120:121], v16 offset:15392
    v_mfma_f32_16x16x32_bf16 v[148:151], v[100:103], v[40:43], v[148:151]
    ds_read_b64_tr_b16 v[122:123], v16 offset:16672
    s_waitcnt lgkmcnt(8)
    v_mfma_f32_16x16x32_bf16 v[152:155], v[104:107], a[184:187], v[152:155]
    ds_read_b64_tr_b16 v[124:125], v16 offset:15424
    v_mfma_f32_16x16x32_bf16 v[156:159], v[104:107], v[40:43], v[156:159]
    ds_read_b64_tr_b16 v[126:127], v16 offset:16704
    s_waitcnt lgkmcnt(8)
    v_mfma_f32_16x16x32_bf16 v[160:163], v[108:111], a[184:187], v[160:163]
    ds_read_b64_tr_b16 v[128:129], v16 offset:15456
    buffer_load_dwordx4 v14, s[20:23], s91 offen lds
    v_mfma_f32_16x16x32_bf16 v[164:167], v[108:111], v[40:43], v[164:167]
    ds_read_b64_tr_b16 v[130:131], v16 offset:16736
    s_waitcnt lgkmcnt(8)
    v_mfma_f32_16x16x32_bf16 v[168:171], v[112:115], a[184:187], v[168:171]
    ds_read_b64_tr_b16 v[132:133], v16 offset:15488
    v_mfma_f32_16x16x32_bf16 v[172:175], v[112:115], v[40:43], v[172:175]
    ds_read_b64_tr_b16 v[134:135], v16 offset:16768
    s_waitcnt lgkmcnt(8)
    v_mfma_f32_16x16x32_bf16 v[136:139], v[116:119], a[188:191], v[136:139]
    v_mfma_f32_16x16x32_bf16 v[140:143], v[116:119], v[44:47], v[140:143]
    s_waitcnt lgkmcnt(6)
    v_mfma_f32_16x16x32_bf16 v[144:147], v[120:123], a[188:191], v[144:147]
    v_mfma_f32_16x16x32_bf16 v[148:151], v[120:123], v[44:47], v[148:151]
    v_add_u32 v16, s46, v15
    s_waitcnt vmcnt(10) lgkmcnt(0)
    s_barrier
    v_mfma_f32_16x16x32_bf16 v[152:155], v[124:127], a[188:191], v[152:155]
    ds_read_b64_tr_b16 v[96:97], v16 offset:0
    ds_read_b64_tr_b16 v[98:99], v16 offset:1280
    v_mfma_f32_16x16x32_bf16 v[156:159], v[124:127], v[44:47], v[156:159]
    ds_read_b64_tr_b16 v[100:101], v16 offset:32
    ds_read_b64_tr_b16 v[102:103], v16 offset:1312
    v_mfma_f32_16x16x32_bf16 v[160:163], v[128:131], a[188:191], v[160:163]
    ds_read_b64_tr_b16 v[104:105], v16 offset:64
    ds_read_b64_tr_b16 v[106:107], v16 offset:1344
    v_mfma_f32_16x16x32_bf16 v[164:167], v[128:131], v[44:47], v[164:167]
    ds_read_b64_tr_b16 v[108:109], v16 offset:96
    ds_read_b64_tr_b16 v[110:111], v16 offset:1376
    v_mfma_f32_16x16x32_bf16 v[168:171], v[132:135], a[188:191], v[168:171]
    ds_read_b64_tr_b16 v[112:113], v16 offset:128
    ds_read_b64_tr_b16 v[114:115], v16 offset:1408
    v_mfma_f32_16x16x32_bf16 v[172:175], v[132:135], v[44:47], v[172:175]
    s_waitcnt lgkmcnt(8)
    v_mfma_f32_16x16x32_bf16 v[136:139], v[96:99], a[192:195], v[136:139]
    ds_read_b64_tr_b16 v[116:117], v16 offset:5120
    s_add_u32 s46, s46, 20480
    s_cmp_eq_u32 s46, 81920
    v_mfma_f32_16x16x32_bf16 v[140:143], v[96:99], v[48:51], v[140:143]
    ds_read_b64_tr_b16 v[118:119], v16 offset:6400
    s_cselect_b32 s46, 0, s46
    s_mul_i32 s90, s32, 5120
    s_waitcnt lgkmcnt(8)
    v_mfma_f32_16x16x32_bf16 v[144:147], v[100:103], a[192:195], v[144:147]
    ds_read_b64_tr_b16 v[120:121], v16 offset:5152
    s_add_u32 m0, s90, s47
    s_mul_i32 s91, s44, 163840
    v_mfma_f32_16x16x32_bf16 v[148:151], v[100:103], v[48:51], v[148:151]
    ds_read_b64_tr_b16 v[122:123], v16 offset:6432
    s_add_u32 s91, s91, s43
    buffer_load_dwordx4 v10, s[20:23], s91 offen lds
    s_waitcnt lgkmcnt(8)
    v_mfma_f32_16x16x32_bf16 v[152:155], v[104:107], a[192:195], v[152:155]
    ds_read_b64_tr_b16 v[124:125], v16 offset:5184
    s_add_u32 s47, s47, 20480
    s_cmp_eq_u32 s47, 81920
    v_mfma_f32_16x16x32_bf16 v[156:159], v[104:107], v[48:51], v[156:159]
    ds_read_b64_tr_b16 v[126:127], v16 offset:6464
    s_cselect_b32 s47, 0, s47
    s_cmp_lg_u32 s51, 0
    s_waitcnt lgkmcnt(8)
    v_mfma_f32_16x16x32_bf16 v[160:163], v[108:111], a[192:195], v[160:163]
    ds_read_b64_tr_b16 v[128:129], v16 offset:5216
    s_cselect_b32 s90, 1, 0
    s_sub_u32 s51, s51, s90
    v_mfma_f32_16x16x32_bf16 v[164:167], v[108:111], v[48:51], v[164:167]
    ds_read_b64_tr_b16 v[130:131], v16 offset:6496
    s_add_u32 s44, s44, s90
    s_cmp_eq_u32 s44, 5
    s_waitcnt lgkmcnt(8)
    v_mfma_f32_16x16x32_bf16 v[168:171], v[112:115], a[192:195], v[168:171]
    ds_read_b64_tr_b16 v[132:133], v16 offset:5248
    s_cselect_b32 s44, 0, s44
    s_cselect_b32 s90, 160, 0
    v_mfma_f32_16x16x32_bf16 v[172:175], v[112:115], v[48:51], v[172:175]
    ds_read_b64_tr_b16 v[134:135], v16 offset:6528
    s_add_u32 s43, s43, s90
    s_cmp_eq_u32 s43, 1280
    s_waitcnt lgkmcnt(8)
    v_mfma_f32_16x16x32_bf16 v[136:139], v[116:119], a[196:199], v[136:139]
    ds_read_b64_tr_b16 v[96:97], v16 offset:10240
    s_cselect_b32 s43, 0, s43
    s_add_u32 m0, m0, 1024
    v_mfma_f32_16x16x32_bf16 v[140:143], v[116:119], v[52:55], v[140:143]
    ds_read_b64_tr_b16 v[98:99], v16 offset:11520
    buffer_load_dwordx4 v11, s[20:23], s91 offen lds
    s_add_u32 m0, m0, 1024
    s_waitcnt lgkmcnt(8)
    v_mfma_f32_16x16x32_bf16 v[144:147], v[120:123], a[196:199], v[144:147]
    ds_read_b64_tr_b16 v[100:101], v16 offset:10272
    v_mfma_f32_16x16x32_bf16 v[148:151], v[120:123], v[52:55], v[148:151]
    ds_read_b64_tr_b16 v[102:103], v16 offset:11552
    s_waitcnt lgkmcnt(8)
    v_mfma_f32_16x16x32_bf16 v[152:155], v[124:127], a[196:199], v[152:155]
    ds_read_b64_tr_b16 v[104:105], v16 offset:10304
    v_mfma_f32_16x16x32_bf16 v[156:159], v[124:127], v[52:55], v[156:159]
    ds_read_b64_tr_b16 v[106:107], v16 offset:11584
    s_waitcnt lgkmcnt(8)
    v_mfma_f32_16x16x32_bf16 v[160:163], v[128:131], a[196:199], v[160:163]
    ds_read_b64_tr_b16 v[108:109], v16 offset:10336
    buffer_load_dwordx4 v12, s[20:23], s91 offen lds
    s_add_u32 m0, m0, 1024
    v_mfma_f32_16x16x32_bf16 v[164:167], v[128:131], v[52:55], v[164:167]
    ds_read_b64_tr_b16 v[110:111], v16 offset:11616
    s_waitcnt lgkmcnt(8)
    v_mfma_f32_16x16x32_bf16 v[168:171], v[132:135], a[196:199], v[168:171]
    ds_read_b64_tr_b16 v[112:113], v16 offset:10368
    v_mfma_f32_16x16x32_bf16 v[172:175], v[132:135], v[52:55], v[172:175]
    ds_read_b64_tr_b16 v[114:115], v16 offset:11648
    s_waitcnt lgkmcnt(8)
    v_mfma_f32_16x16x32_bf16 v[136:139], v[96:99], a[200:203], v[136:139]
    ds_read_b64_tr_b16 v[116:117], v16 offset:15360
    v_mfma_f32_16x16x32_bf16 v[140:143], v[96:99], v[56:59], v[140:143]
    ds_read_b64_tr_b16 v[118:119], v16 offset:16640
    buffer_load_dwordx4 v13, s[20:23], s91 offen lds
    s_add_u32 m0, m0, 1024
    s_waitcnt lgkmcnt(8)
    v_mfma_f32_16x16x32_bf16 v[144:147], v[100:103], a[200:203], v[144:147]
    ds_read_b64_tr_b16 v[120:121], v16 offset:15392
    v_mfma_f32_16x16x32_bf16 v[148:151], v[100:103], v[56:59], v[148:151]
    ds_read_b64_tr_b16 v[122:123], v16 offset:16672
    s_waitcnt lgkmcnt(8)
    v_mfma_f32_16x16x32_bf16 v[152:155], v[104:107], a[200:203], v[152:155]
    ds_read_b64_tr_b16 v[124:125], v16 offset:15424
    v_mfma_f32_16x16x32_bf16 v[156:159], v[104:107], v[56:59], v[156:159]
    ds_read_b64_tr_b16 v[126:127], v16 offset:16704
    s_waitcnt lgkmcnt(8)
    v_mfma_f32_16x16x32_bf16 v[160:163], v[108:111], a[200:203], v[160:163]
    ds_read_b64_tr_b16 v[128:129], v16 offset:15456
    buffer_load_dwordx4 v14, s[20:23], s91 offen lds
    v_mfma_f32_16x16x32_bf16 v[164:167], v[108:111], v[56:59], v[164:167]
    ds_read_b64_tr_b16 v[130:131], v16 offset:16736
    s_waitcnt lgkmcnt(8)
    v_mfma_f32_16x16x32_bf16 v[168:171], v[112:115], a[200:203], v[168:171]
    ds_read_b64_tr_b16 v[132:133], v16 offset:15488
    v_mfma_f32_16x16x32_bf16 v[172:175], v[112:115], v[56:59], v[172:175]
    ds_read_b64_tr_b16 v[134:135], v16 offset:16768
    s_waitcnt lgkmcnt(8)
    v_mfma_f32_16x16x32_bf16 v[136:139], v[116:119], a[204:207], v[136:139]
    v_mfma_f32_16x16x32_bf16 v[140:143], v[116:119], v[60:63], v[140:143]
    s_waitcnt lgkmcnt(6)
    v_mfma_f32_16x16x32_bf16 v[144:147], v[120:123], a[204:207], v[144:147]
    v_mfma_f32_16x16x32_bf16 v[148:151], v[120:123], v[60:63], v[148:151]
    v_add_u32 v16, s46, v15
    s_waitcnt vmcnt(10) lgkmcnt(0)
    s_barrier
    v_mfma_f32_16x16x32_bf16 v[152:155], v[124:127], a[204:207], v[152:155]
    ds_read_b64_tr_b16 v[96:97], v16 offset:0
    ds_read_b64_tr_b16 v[98:99], v16 offset:1280
    v_mfma_f32_16x16x32_bf16 v[156:159], v[124:127], v[60:63], v[156:159]
    ds_read_b64_tr_b16 v[100:101], v16 offset:32
    ds_read_b64_tr_b16 v[102:103], v16 offset:1312
    v_mfma_f32_16x16x32_bf16 v[160:163], v[128:131], a[204:207], v[160:163]
    ds_read_b64_tr_b16 v[104:105], v16 offset:64
    ds_read_b64_tr_b16 v[106:107], v16 offset:1344
    v_mfma_f32_16x16x32_bf16 v[164:167], v[128:131], v[60:63], v[164:167]
    ds_read_b64_tr_b16 v[108:109], v16 offset:96
    ds_read_b64_tr_b16 v[110:111], v16 offset:1376
    v_mfma_f32_16x16x32_bf16 v[168:171], v[132:135], a[204:207], v[168:171]
    ds_read_b64_tr_b16 v[112:113], v16 offset:128
    ds_read_b64_tr_b16 v[114:115], v16 offset:1408
    v_mfma_f32_16x16x32_bf16 v[172:175], v[132:135], v[60:63], v[172:175]
    s_waitcnt lgkmcnt(8)
    v_mfma_f32_16x16x32_bf16 v[136:139], v[96:99], a[208:211], v[136:139]
    ds_read_b64_tr_b16 v[116:117], v16 offset:5120
    s_add_u32 s46, s46, 20480
    s_cmp_eq_u32 s46, 81920
    v_mfma_f32_16x16x32_bf16 v[140:143], v[96:99], v[64:67], v[140:143]
    ds_read_b64_tr_b16 v[118:119], v16 offset:6400
    s_cselect_b32 s46, 0, s46
    s_mul_i32 s90, s32, 5120
    s_waitcnt lgkmcnt(8)
    v_mfma_f32_16x16x32_bf16 v[144:147], v[100:103], a[208:211], v[144:147]
    ds_read_b64_tr_b16 v[120:121], v16 offset:5152
    s_add_u32 m0, s90, s47
    s_mul_i32 s91, s44, 163840
    v_mfma_f32_16x16x32_bf16 v[148:151], v[100:103], v[64:67], v[148:151]
    ds_read_b64_tr_b16 v[122:123], v16 offset:6432
    s_add_u32 s91, s91, s43
    buffer_load_dwordx4 v10, s[20:23], s91 offen lds
    s_waitcnt lgkmcnt(8)
    v_mfma_f32_16x16x32_bf16 v[152:155], v[104:107], a[208:211], v[152:155]
    ds_read_b64_tr_b16 v[124:125], v16 offset:5184
    s_add_u32 s47, s47, 20480
    s_cmp_eq_u32 s47, 81920
    v_mfma_f32_16x16x32_bf16 v[156:159], v[104:107], v[64:67], v[156:159]
    ds_read_b64_tr_b16 v[126:127], v16 offset:6464
    s_cselect_b32 s47, 0, s47
    s_cmp_lg_u32 s51, 0
    s_waitcnt lgkmcnt(8)
    v_mfma_f32_16x16x32_bf16 v[160:163], v[108:111], a[208:211], v[160:163]
    ds_read_b64_tr_b16 v[128:129], v16 offset:5216
    s_cselect_b32 s90, 1, 0
    s_sub_u32 s51, s51, s90
    v_mfma_f32_16x16x32_bf16 v[164:167], v[108:111], v[64:67], v[164:167]
    ds_read_b64_tr_b16 v[130:131], v16 offset:6496
    s_add_u32 s44, s44, s90
    s_cmp_eq_u32 s44, 5
    s_waitcnt lgkmcnt(8)
    v_mfma_f32_16x16x32_bf16 v[168:171], v[112:115], a[208:211], v[168:171]
    ds_read_b64_tr_b16 v[132:133], v16 offset:5248
    s_cselect_b32 s44, 0, s44
    s_cselect_b32 s90, 160, 0
    v_mfma_f32_16x16x32_bf16 v[172:175], v[112:115], v[64:67], v[172:175]
    ds_read_b64_tr_b16 v[134:135], v16 offset:6528
    s_add_u32 s43, s43, s90
    s_cmp_eq_u32 s43, 1280
    s_waitcnt lgkmcnt(8)
    v_mfma_f32_16x16x32_bf16 v[136:139], v[116:119], a[212:215], v[136:139]
    ds_read_b64_tr_b16 v[96:97], v16 offset:10240
    s_cselect_b32 s43, 0, s43
    s_add_u32 m0, m0, 1024
    v_mfma_f32_16x16x32_bf16 v[140:143], v[116:119], v[68:71], v[140:143]
    ds_read_b64_tr_b16 v[98:99], v16 offset:11520
    buffer_load_dwordx4 v11, s[20:23], s91 offen lds
    s_add_u32 m0, m0, 1024
    s_waitcnt lgkmcnt(8)
    v_mfma_f32_16x16x32_bf16 v[144:147], v[120:123], a[212:215], v[144:147]
    ds_read_b64_tr_b16 v[100:101], v16 offset:10272
    v_mfma_f32_16x16x32_bf16 v[148:151], v[120:123], v[68:71], v[148:151]
    ds_read_b64_tr_b16 v[102:103], v16 offset:11552
    s_waitcnt lgkmcnt(8)
    v_mfma_f32_16x16x32_bf16 v[152:155], v[124:127], a[212:215], v[152:155]
    ds_read_b64_tr_b16 v[104:105], v16 offset:10304
    v_mfma_f32_16x16x32_bf16 v[156:159], v[124:127], v[68:71], v[156:159]
    ds_read_b64_tr_b16 v[106:107], v16 offset:11584
    s_waitcnt lgkmcnt(8)
    v_mfma_f32_16x16x32_bf16 v[160:163], v[128:131], a[212:215], v[160:163]
    ds_read_b64_tr_b16 v[108:109], v16 offset:10336
    buffer_load_dwordx4 v12, s[20:23], s91 offen lds
    s_add_u32 m0, m0, 1024
    v_mfma_f32_16x16x32_bf16 v[164:167], v[128:131], v[68:71], v[164:167]
    ds_read_b64_tr_b16 v[110:111], v16 offset:11616
    s_waitcnt lgkmcnt(8)
    v_mfma_f32_16x16x32_bf16 v[168:171], v[132:135], a[212:215], v[168:171]
    ds_read_b64_tr_b16 v[112:113], v16 offset:10368
    v_mfma_f32_16x16x32_bf16 v[172:175], v[132:135], v[68:71], v[172:175]
    ds_read_b64_tr_b16 v[114:115], v16 offset:11648
    s_waitcnt lgkmcnt(8)
    v_mfma_f32_16x16x32_bf16 v[136:139], v[96:99], a[216:219], v[136:139]
    ds_read_b64_tr_b16 v[116:117], v16 offset:15360
    v_mfma_f32_16x16x32_bf16 v[140:143], v[96:99], v[72:75], v[140:143]
    ds_read_b64_tr_b16 v[118:119], v16 offset:16640
    buffer_load_dwordx4 v13, s[20:23], s91 offen lds
    s_add_u32 m0, m0, 1024
    s_waitcnt lgkmcnt(8)
    v_mfma_f32_16x16x32_bf16 v[144:147], v[100:103], a[216:219], v[144:147]
    ds_read_b64_tr_b16 v[120:121], v16 offset:15392
    v_mfma_f32_16x16x32_bf16 v[148:151], v[100:103], v[72:75], v[148:151]
    ds_read_b64_tr_b16 v[122:123], v16 offset:16672
    s_waitcnt lgkmcnt(8)
    v_mfma_f32_16x16x32_bf16 v[152:155], v[104:107], a[216:219], v[152:155]
    ds_read_b64_tr_b16 v[124:125], v16 offset:15424
    v_mfma_f32_16x16x32_bf16 v[156:159], v[104:107], v[72:75], v[156:159]
    ds_read_b64_tr_b16 v[126:127], v16 offset:16704
    s_waitcnt lgkmcnt(8)
    v_mfma_f32_16x16x32_bf16 v[160:163], v[108:111], a[216:219], v[160:163]
    ds_read_b64_tr_b16 v[128:129], v16 offset:15456
    buffer_load_dwordx4 v14, s[20:23], s91 offen lds
    v_mfma_f32_16x16x32_bf16 v[164:167], v[108:111], v[72:75], v[164:167]
    ds_read_b64_tr_b16 v[130:131], v16 offset:16736
    s_waitcnt lgkmcnt(8)
    v_mfma_f32_16x16x32_bf16 v[168:171], v[112:115], a[216:219], v[168:171]
    ds_read_b64_tr_b16 v[132:133], v16 offset:15488
    v_mfma_f32_16x16x32_bf16 v[172:175], v[112:115], v[72:75], v[172:175]
    ds_read_b64_tr_b16 v[134:135], v16 offset:16768
    s_waitcnt lgkmcnt(8)
    v_mfma_f32_16x16x32_bf16 v[136:139], v[116:119], a[220:223], v[136:139]
    v_mfma_f32_16x16x32_bf16 v[140:143], v[116:119], v[76:79], v[140:143]
    s_waitcnt lgkmcnt(6)
    v_mfma_f32_16x16x32_bf16 v[144:147], v[120:123], a[220:223], v[144:147]
    v_mfma_f32_16x16x32_bf16 v[148:151], v[120:123], v[76:79], v[148:151]
    v_add_u32 v16, s46, v15
    s_waitcnt vmcnt(10) lgkmcnt(0)
    s_barrier
    v_mfma_f32_16x16x32_bf16 v[152:155], v[124:127], a[220:223], v[152:155]
    ds_read_b64_tr_b16 v[96:97], v16 offset:0
    ds_read_b64_tr_b16 v[98:99], v16 offset:1280
    v_mfma_f32_16x16x32_bf16 v[156:159], v[124:127], v[76:79], v[156:159]
    ds_read_b64_tr_b16 v[100:101], v16 offset:32
    ds_read_b64_tr_b16 v[102:103], v16 offset:1312
    v_mfma_f32_16x16x32_bf16 v[160:163], v[128:131], a[220:223], v[160:163]
    ds_read_b64_tr_b16 v[104:105], v16 offset:64
    ds_read_b64_tr_b16 v[106:107], v16 offset:1344
    v_mfma_f32_16x16x32_bf16 v[164:167], v[128:131], v[76:79], v[164:167]
    ds_read_b64_tr_b16 v[108:109], v16 offset:96
    ds_read_b64_tr_b16 v[110:111], v16 offset:1376
    v_mfma_f32_16x16x32_bf16 v[168:171], v[132:135], a[220:223], v[168:171]
    ds_read_b64_tr_b16 v[112:113], v16 offset:128
    ds_read_b64_tr_b16 v[114:115], v16 offset:1408
    v_mfma_f32_16x16x32_bf16 v[172:175], v[132:135], v[76:79], v[172:175]
    s_waitcnt lgkmcnt(8)
    v_mfma_f32_16x16x32_bf16 v[136:139], v[96:99], a[224:227], v[136:139]
    ds_read_b64_tr_b16 v[116:117], v16 offset:5120
    s_add_u32 s46, s46, 20480
    s_cmp_eq_u32 s46, 81920
    v_mfma_f32_16x16x32_bf16 v[140:143], v[96:99], v[80:83], v[140:143]
    ds_read_b64_tr_b16 v[118:119], v16 offset:6400
    s_cselect_b32 s46, 0, s46
    s_mul_i32 s90, s32, 5120
    s_waitcnt lgkmcnt(8)
    v_mfma_f32_16x16x32_bf16 v[144:147], v[100:103], a[224:227], v[144:147]
    ds_read_b64_tr_b16 v[120:121], v16 offset:5152
    s_add_u32 m0, s90, s47
    s_mul_i32 s91, s44, 163840
    v_mfma_f32_16x16x32_bf16 v[148:151], v[100:103], v[80:83], v[148:151]
    ds_read_b64_tr_b16 v[122:123], v16 offset:6432
    s_add_u32 s91, s91, s43
    buffer_load_dwordx4 v10, s[20:23], s91 offen lds
    s_waitcnt lgkmcnt(8)
    v_mfma_f32_16x16x32_bf16 v[152:155], v[104:107], a[224:227], v[152:155]
    ds_read_b64_tr_b16 v[124:125], v16 offset:5184
    s_add_u32 s47, s47, 20480
    s_cmp_eq_u32 s47, 81920
    v_mfma_f32_16x16x32_bf16 v[156:159], v[104:107], v[80:83], v[156:159]
    ds_read_b64_tr_b16 v[126:127], v16 offset:6464
    s_cselect_b32 s47, 0, s47
    s_cmp_lg_u32 s51, 0
    s_waitcnt lgkmcnt(8)
    v_mfma_f32_16x16x32_bf16 v[160:163], v[108:111], a[224:227], v[160:163]
    ds_read_b64_tr_b16 v[128:129], v16 offset:5216
    s_cselect_b32 s90, 1, 0
    s_sub_u32 s51, s51, s90
    v_mfma_f32_16x16x32_bf16 v[164:167], v[108:111], v[80:83], v[164:167]
    ds_read_b64_tr_b16 v[130:131], v16 offset:6496
    s_add_u32 s44, s44, s90
    s_cmp_eq_u32 s44, 5
    s_waitcnt lgkmcnt(8)
    v_mfma_f32_16x16x32_bf16 v[168:171], v[112:115], a[224:227], v[168:171]
    ds_read_b64_tr_b16 v[132:133], v16 offset:5248
    s_cselect_b32 s44, 0, s44
    s_cselect_b32 s90, 160, 0
    v_mfma_f32_16x16x32_bf16 v[172:175], v[112:115], v[80:83], v[172:175]
    ds_read_b64_tr_b16 v[134:135], v16 offset:6528
    s_add_u32 s43, s43, s90
    s_cmp_eq_u32 s43, 1280
    s_waitcnt lgkmcnt(8)
    v_mfma_f32_16x16x32_bf16 v[136:139], v[116:119], a[228:231], v[136:139]
    ds_read_b64_tr_b16 v[96:97], v16 offset:10240
    s_cselect_b32 s43, 0, s43
    s_add_u32 m0, m0, 1024
    v_mfma_f32_16x16x32_bf16 v[140:143], v[116:119], v[84:87], v[140:143]
    ds_read_b64_tr_b16 v[98:99], v16 offset:11520
    buffer_load_dwordx4 v11, s[20:23], s91 offen lds
    s_add_u32 m0, m0, 1024
    s_waitcnt lgkmcnt(8)
    v_mfma_f32_16x16x32_bf16 v[144:147], v[120:123], a[228:231], v[144:147]
    ds_read_b64_tr_b16 v[100:101], v16 offset:10272
    v_mfma_f32_16x16x32_bf16 v[148:151], v[120:123], v[84:87], v[148:151]
    ds_read_b64_tr_b16 v[102:103], v16 offset:11552
    s_waitcnt lgkmcnt(8)
    v_mfma_f32_16x16x32_bf16 v[152:155], v[124:127], a[228:231], v[152:155]
    ds_read_b64_tr_b16 v[104:105], v16 offset:10304
    v_mfma_f32_16x16x32_bf16 v[156:159], v[124:127], v[84:87], v[156:159]
    ds_read_b64_tr_b16 v[106:107], v16 offset:11584
    s_waitcnt lgkmcnt(8)
    v_mfma_f32_16x16x32_bf16 v[160:163], v[128:131], a[228:231], v[160:163]
    ds_read_b64_tr_b16 v[108:109], v16 offset:10336
    buffer_load_dwordx4 v12, s[20:23], s91 offen lds
    s_add_u32 m0, m0, 1024
    v_mfma_f32_16x16x32_bf16 v[164:167], v[128:131], v[84:87], v[164:167]
    ds_read_b64_tr_b16 v[110:111], v16 offset:11616
    s_waitcnt lgkmcnt(8)
    v_mfma_f32_16x16x32_bf16 v[168:171], v[132:135], a[228:231], v[168:171]
    ds_read_b64_tr_b16 v[112:113], v16 offset:10368
    v_mfma_f32_16x16x32_bf16 v[172:175], v[132:135], v[84:87], v[172:175]
    ds_read_b64_tr_b16 v[114:115], v16 offset:11648
    s_waitcnt lgkmcnt(8)
    v_mfma_f32_16x16x32_bf16 v[136:139], v[96:99], a[232:235], v[136:139]
    ds_read_b64_tr_b16 v[116:117], v16 offset:15360
    v_mfma_f32_16x16x32_bf16 v[140:143], v[96:99], v[88:91], v[140:143]
    ds_read_b64_tr_b16 v[118:119], v16 offset:16640
    buffer_load_dwordx4 v13, s[20:23], s91 offen lds
    s_add_u32 m0, m0, 1024
    s_waitcnt lgkmcnt(8)
    v_mfma_f32_16x16x32_bf16 v[144:147], v[100:103], a[232:235], v[144:147]
    ds_read_b64_tr_b16 v[120:121], v16 offset:15392
    v_mfma_f32_16x16x32_bf16 v[148:151], v[100:103], v[88:91], v[148:151]
    ds_read_b64_tr_b16 v[122:123], v16 offset:16672
    s_waitcnt lgkmcnt(8)
    v_mfma_f32_16x16x32_bf16 v[152:155], v[104:107], a[232:235], v[152:155]
    ds_read_b64_tr_b16 v[124:125], v16 offset:15424
    v_mfma_f32_16x16x32_bf16 v[156:159], v[104:107], v[88:91], v[156:159]
    ds_read_b64_tr_b16 v[126:127], v16 offset:16704
    s_waitcnt lgkmcnt(8)
    v_mfma_f32_16x16x32_bf16 v[160:163], v[108:111], a[232:235], v[160:163]
    ds_read_b64_tr_b16 v[128:129], v16 offset:15456
    buffer_load_dwordx4 v14, s[20:23], s91 offen lds
    v_mfma_f32_16x16x32_bf16 v[164:167], v[108:111], v[88:91], v[164:167]
    ds_read_b64_tr_b16 v[130:131], v16 offset:16736
    s_waitcnt lgkmcnt(8)
    v_mfma_f32_16x16x32_bf16 v[168:171], v[112:115], a[232:235], v[168:171]
    ds_read_b64_tr_b16 v[132:133], v16 offset:15488
    v_mfma_f32_16x16x32_bf16 v[172:175], v[112:115], v[88:91], v[172:175]
    ds_read_b64_tr_b16 v[134:135], v16 offset:16768
    s_waitcnt lgkmcnt(8)
    v_mfma_f32_16x16x32_bf16 v[136:139], v[116:119], a[236:239], v[136:139]
    v_mfma_f32_16x16x32_bf16 v[140:143], v[116:119], v[92:95], v[140:143]
    s_waitcnt lgkmcnt(6)
    v_mfma_f32_16x16x32_bf16 v[144:147], v[120:123], a[236:239], v[144:147]
    v_mfma_f32_16x16x32_bf16 v[148:151], v[120:123], v[92:95], v[148:151]
    v_add_u32 v16, s46, v15
    s_waitcnt vmcnt(10) lgkmcnt(0)
    s_barrier
    v_mfma_f32_16x16x32_bf16 v[152:155], v[124:127], a[236:239], v[152:155]
    ds_read_b64_tr_b16 v[96:97], v16 offset:0
    ds_read_b64_tr_b16 v[98:99], v16 offset:1280
    v_mfma_f32_16x16x32_bf16 v[156:159], v[124:127], v[92:95], v[156:159]
    ds_read_b64_tr_b16 v[100:101], v16 offset:32
    ds_read_b64_tr_b16 v[102:103], v16 offset:1312
    v_mfma_f32_16x16x32_bf16 v[160:163], v[128:131], a[236:239], v[160:163]
    ds_read_b64_tr_b16 v[104:105], v16 offset:64
    ds_read_b64_tr_b16 v[106:107], v16 offset:1344
    v_mfma_f32_16x16x32_bf16 v[164:167], v[128:131], v[92:95], v[164:167]
    ds_read_b64_tr_b16 v[108:109], v16 offset:96
    ds_read_b64_tr_b16 v[110:111], v16 offset:1376
    v_mfma_f32_16x16x32_bf16 v[168:171], v[132:135], a[236:239], v[168:171]
    ds_read_b64_tr_b16 v[112:113], v16 offset:128
    ds_read_b64_tr_b16 v[114:115], v16 offset:1408
    v_mfma_f32_16x16x32_bf16 v[172:175], v[132:135], v[92:95], v[172:175]
    v_cvt_pk_bf16_f32 v176, v136, v137
    v_cvt_pk_bf16_f32 v177, v138, v139
    v_cvt_pk_bf16_f32 v178, v140, v141
    v_cvt_pk_bf16_f32 v179, v142, v143
    s_nop 0
    v_permlane16_swap_b32 v176, v178
    v_permlane16_swap_b32 v177, v179
    buffer_store_dwordx4 v[176:179], v19, s[28:31], s42 offen offset:0
    s_nop 1
    v_cvt_pk_bf16_f32 v176, v144, v145
    v_cvt_pk_bf16_f32 v177, v146, v147
    v_cvt_pk_bf16_f32 v178, v148, v149
    v_cvt_pk_bf16_f32 v179, v150, v151
    s_nop 0
    v_permlane16_swap_b32 v176, v178
    v_permlane16_swap_b32 v177, v179
    buffer_store_dwordx4 v[176:179], v19, s[28:31], s42 offen offset:32
    s_nop 1
    v_cvt_pk_bf16_f32 v176, v152, v153
    v_cvt_pk_bf16_f32 v177, v154, v155
    v_cvt_pk_bf16_f32 v178, v156, v157
    v_cvt_pk_bf16_f32 v179, v158, v159
    s_nop 0
    v_permlane16_swap_b32 v176, v178
    v_permlane16_swap_b32 v177, v179
    buffer_store_dwordx4 v[176:179], v19, s[28:31], s42 offen offset:64
    s_nop 1
    v_cvt_pk_bf16_f32 v176, v160, v161
    v_cvt_pk_bf16_f32 v177, v162, v163
    v_cvt_pk_bf16_f32 v178, v164, v165
    v_cvt_pk_bf16_f32 v179, v166, v167
    s_nop 0
    v_permlane16_swap_b32 v176, v178
    v_permlane16_swap_b32 v177, v179
    buffer_store_dwordx4 v[176:179], v19, s[28:31], s42 offen offset:96
    s_nop 1
    v_cvt_pk_bf16_f32 v176, v168, v169
    v_cvt_pk_bf16_f32 v177, v170, v171
    v_cvt_pk_bf16_f32 v178, v172, v173
    v_cvt_pk_bf16_f32 v179, v174, v175
    s_nop 0
    v_permlane16_swap_b32 v176, v178
    v_permlane16_swap_b32 v177, v179
    buffer_store_dwordx4 v[176:179], v19, s[28:31], s42 offen offset:128
    s_add_u32 s42, s42, 160
    s_cmp_eq_u32 s42, 1280
    s_cselect_b32 s42, 0, s42
    s_add_u32 s53, s53, 1
    s_cmp_lt_u32 s53, 8
    s_cbranch_scc1 L_pa_oblk
L_pa_end:
    s_waitcnt vmcnt(0)
    s_endpgm
L_slow:
    s_waitcnt vmcnt(0) lgkmcnt(0)
    s_barrier
    s_and_b32 s34, s2, 7
    s_lshr_b32 s35, s2, 3
    s_add_u32 s4, s88, 33554432
    s_addc_u32 s5, s89, 0
    s_and_b32 s5, s5, 0xffff
    s_cmp_lg_u32 s32, 0
    s_cbranch_scc1 L_slow_go
    v_mov_b32 v240, -1
    v_mov_b32 v241, -1
    v_mov_b32 v242, -1
    v_mov_b32 v243, -1
    v_mov_b32 v244, 0
    v_lshlrev_b32 v4, 4, v0
    v_lshlrev_b32 v5, 2, v0
    s_mul_i32 s91, s2, 2560
    s_and_b32 s92, s2, 7
    s_lshl_b32 s92, s92, 21
    s_add_u32 s92, s92, 8388608
    s_lshr_b32 s93, s2, 3
    s_lshl_b32 s40, s93, 7
    s_add_u32 s40, s40, s92
    s_add_u32 s40, s40, 458752
    s_lshr_b32 s41, s93, 4
    s_mul_i32 s41, s41, 114688
    s_add_u32 s92, s92, s41
    s_and_b32 s93, s93, 15
    s_mul_i32 s93, s93, 2560
    s_add_u32 s92, s92, s93
    buffer_store_dwordx4 v[240:243], v4, s[4:7], s91 offen sc1
    buffer_store_dwordx4 v[240:243], v4, s[4:7], s91 offen offset:1024 sc1
    buffer_store_dword v240, v5, s[4:7], s91 offen offset:2048 sc1
    buffer_store_dword v240, v5, s[4:7], s91 offen offset:2304 sc1
    buffer_store_dwordx4 v[240:243], v4, s[4:7], s92 offen sc1
    buffer_store_dwordx4 v[240:243], v4, s[4:7], s92 offen offset:1024 sc1
    buffer_store_dword v240, v5, s[4:7], s92 offen offset:2048 sc1
    buffer_store_dword v240, v5, s[4:7], s92 offen offset:2304 sc1
    s_mov_b64 exec, 0xffffffff
    buffer_store_dword v244, v5, s[4:7], s40 offen sc1
    s_lshl_b32 s40, s2, 7
    s_add_u32 s40, s40, 1933312
    buffer_store_dword v244, v5, s[4:7], s40 offen sc1
    s_mov_b64 exec, -1
    s_waitcnt vmcnt(0)
    v_mov_b32 v1, 68
    v_mov_b32 v4, 1
    s_mov_b64 exec, 1
    buffer_atomic_add v4, v1, s[8:11], 0 offen sc1
    s_mov_b64 exec, -1
L_slow_go:
    s_lshl_b32 s38, s34, 21
    s_add_u32 s38, s38, 8388608
    s_cmp_lt_u32 s35, 12
    s_cbranch_scc1 L_qkv_s
    s_cmp_lt_u32 s35, 18
    s_cbranch_scc1 L_v_s
    s_cmp_lt_u32 s35, 28
    s_cbranch_scc1 L_wo_s
    s_cmp_lt_u32 s35, 29
    s_cbranch_scc1 L_px_s
    s_branch L_pa_s
L_qkv_s:
    s_mov_b32 s12, s74
    s_and_b32 s13, s75, 0xffff
    s_mov_b32 s14, 7864320
    s_mov_b32 s15, 0x20000
    s_mov_b32 s16, s76
    s_and_b32 s17, s77, 0xffff
    s_mov_b32 s18, 7864320
    s_mov_b32 s19, 0x20000
    s_mov_b32 s40, s35
    s_mov_b32 s24, s70
    s_and_b32 s25, s71, 0xffff
    s_mov_b32 s26, 2621440
    s_mov_b32 s27, 0x20000
    v_and_b32 v1, 15, v0
    v_lshrrev_b32 v2, 4, v0
    v_lshrrev_b32 v3, 3, v0
    v_and_b32 v4, 7, v0
    s_lshl_b32 s90, s32, 3
    v_add_u32 v5, s90, v3
    s_and_b32 s91, s32, 1
    s_lshl_b32 s91, s91, 2
    v_and_b32 v6, 2, v3
    v_or_b32 v6, s91, v6
    v_xor_b32 v6, v6, v4
    v_lshlrev_b32 v6, 4, v6
    v_mul_u32_u24 v7, 12288, v5
    s_mul_i32 s92, s34, 1536
    s_lshl_b32 s93, s40, 7
    s_add_u32 s92, s92, s93
    v_add3_u32 v124, v6, v7, s92
    v_lshrrev_b32 v6, 1, v3
    v_or_b32 v6, s91, v6
    v_xor_b32 v6, v6, v4
    v_lshlrev_b32 v6, 4, v6
    v_mul_u32_u24 v7, 1280, v5
    v_add_u32 v10, v6, v7
    s_lshl_b32 s90, s32, 10
    s_add_u32 m0, s90, 81920
    s_mov_b32 s91, 0
    buffer_load_dwordx4 v124, s[12:15], s91 offen nt lds
    s_add_u32 m0, m0, 4096
    s_add_u32 s91, s91, 393216
    buffer_load_dwordx4 v124, s[12:15], s91 offen nt lds
    s_add_u32 m0, m0, 4096
    s_add_u32 s91, s91, 393216
    buffer_load_dwordx4 v124, s[12:15], s91 offen nt lds
    s_add_u32 m0, m0, 4096
    s_add_u32 s91, s91, 393216
    buffer_load_dwordx4 v124, s[12:15], s91 offen nt lds
    s_add_u32 m0, m0, 4096
    s_add_u32 s91, s91, 393216
    buffer_load_dwordx4 v124, s[12:15], s91 offen nt lds
    s_add_u32 m0, m0, 4096
    s_add_u32 s91, s91, 393216
    buffer_load_dwordx4 v124, s[12:15], s91 offen nt lds
    s_add_u32 m0, m0, 4096
    s_add_u32 s91, s91, 393216
    buffer_load_dwordx4 v124, s[12:15], s91 offen nt lds
    s_add_u32 m0, m0, 4096
    s_add_u32 s91, s91, 393216
    buffer_load_dwordx4 v124, s[12:15], s91 offen nt lds
    s_add_u32 m0, m0, 4096
    s_add_u32 s91, s91, 393216
    buffer_load_dwordx4 v124, s[12:15], s91 offen nt lds
    s_add_u32 m0, m0, 4096
    s_add_u32 s91, s91, 393216
    buffer_load_dwordx4 v124, s[12:15], s91 offen nt lds
    s_lshl_b32 s90, s32, 10
    s_add_u32 m0, s90, 40960
    s_mov_b32 s91, 0
    buffer_load_dwordx4 v124, s[16:19], s91 offen nt lds
    s_add_u32 m0, m0, 4096
    s_add_u32 s91, s91, 393216
    buffer_load_dwordx4 v124, s[16:19], s91 offen nt lds
    s_add_u32 m0, m0, 4096
    s_add_u32 s91, s91, 393216
    buffer_load_dwordx4 v124, s[16:19], s91 offen nt lds
    s_add_u32 m0, m0, 4096
    s_add_u32 s91, s91, 393216
    buffer_load_dwordx4 v124, s[16:19], s91 offen nt lds
    s_add_u32 m0, m0, 4096
    s_add_u32 s91, s91, 393216
    buffer_load_dwordx4 v124, s[16:19], s91 offen nt lds
    s_add_u32 m0, m0, 4096
    s_add_u32 s91, s91, 393216
    buffer_load_dwordx4 v124, s[16:19], s91 offen nt lds
    s_add_u32 m0, m0, 4096
    s_add_u32 s91, s91, 393216
    buffer_load_dwordx4 v124, s[16:19], s91 offen nt lds
    s_add_u32 m0, m0, 4096
    s_add_u32 s91, s91, 393216
    buffer_load_dwordx4 v124, s[16:19], s91 offen nt lds
    s_add_u32 m0, m0, 4096
    s_add_u32 s91, s91, 393216
    buffer_load_dwordx4 v124, s[16:19], s91 offen nt lds
    s_add_u32 m0, m0, 4096
    s_add_u32 s91, s91, 393216
    buffer_load_dwordx4 v124, s[16:19], s91 offen nt lds
    s_lshl_b32 s90, s32, 10
    s_add_u32 m0, s90, 122880
    s_mov_b32 s91, 3932160
    buffer_load_dwordx4 v124, s[12:15], s91 offen nt lds
    s_add_u32 m0, m0, 4096
    s_add_u32 s91, s91, 393216
    buffer_load_dwordx4 v124, s[12:15], s91 offen nt lds
    s_add_u32 m0, m0, 4096
    s_add_u32 s91, s91, 393216
    buffer_load_dwordx4 v124, s[12:15], s91 offen nt lds
    s_add_u32 m0, m0, 4096
    s_add_u32 s91, s91, 393216
    buffer_load_dwordx4 v124, s[12:15], s91 offen nt lds
    s_add_u32 m0, m0, 4096
    s_add_u32 s91, s91, 393216
    buffer_load_dwordx4 v124, s[12:15], s91 offen nt lds
    s_add_u32 m0, m0, 4096
    s_add_u32 s91, s91, 393216
    buffer_load_dwordx4 v124, s[12:15], s91 offen nt lds
    s_add_u32 m0, m0, 4096
    s_add_u32 s91, s91, 393216
    buffer_load_dwordx4 v124, s[12:15], s91 offen nt lds
    s_add_u32 m0, m0, 4096
    s_add_u32 s91, s91, 393216
    buffer_load_dwordx4 v124, s[12:15], s91 offen nt lds
    s_add_u32 m0, m0, 4096
    s_add_u32 s91, s91, 393216
    buffer_load_dwordx4 v124, s[12:15], s91 offen nt lds
    s_add_u32 m0, m0, 4096
    s_add_u32 s91, s91, 393216
    buffer_load_dwordx4 v124, s[12:15], s91 offen nt lds
    s_mov_b32 s46, 0
    s_lshl_b32 s90, s32, 10
    s_add_u32 m0, s90, 0
    s_nop 0
    buffer_load_dwordx4 v10, s[24:27], s46 offen offset:0 lds
    s_add_u32 m0, m0, 3968
    s_nop 0
    buffer_load_dwordx4 v10, s[24:27], s46 offen offset:128 lds
    s_add_u32 m0, m0, 3968
    s_nop 0
    buffer_load_dwordx4 v10, s[24:27], s46 offen offset:256 lds
    s_add_u32 m0, m0, 3968
    s_nop 0
    buffer_load_dwordx4 v10, s[24:27], s46 offen offset:384 lds
    s_add_u32 m0, m0, 3968
    s_nop 0
    buffer_load_dwordx4 v10, s[24:27], s46 offen offset:512 lds
    s_add_u32 m0, m0, 3968
    s_nop 0
    buffer_load_dwordx4 v10, s[24:27], s46 offen offset:640 lds
    s_add_u32 m0, m0, 3968
    s_nop 0
    buffer_load_dwordx4 v10, s[24:27], s46 offen offset:768 lds
    s_add_u32 m0, m0, 3968
    s_nop 0
    buffer_load_dwordx4 v10, s[24:27], s46 offen offset:896 lds
    s_add_u32 m0, m0, 3968
    s_nop 0
    buffer_load_dwordx4 v10, s[24:27], s46 offen offset:1024 lds
    s_add_u32 m0, m0, 3968
    s_nop 0
    buffer_load_dwordx4 v10, s[24:27], s46 offen offset:1152 lds
    s_mul_i32 s60, s40, 86
    s_lshr_b32 s60, s60, 8
    s_mul_i32 s59, s60, 3
    s_sub_u32 s59, s40, s59
    s_add_u32 s90, s40, 1
    s_mul_i32 s62, s90, 86
    s_lshr_b32 s62, s62, 8
    s_mul_i32 s63, s62, 3
    s_sub_u32 s63, s90, s63
    v_lshrrev_b32 v3, 1, v2
    v_and_b32 v5, 1, v2
    s_lshl_b32 s90, s32, 9
    v_lshlrev_b32 v6, 4, v1
    v_lshl_add_u32 v6, v3, 8, v6
    v_add_u32 v6, s90, v6
    s_mul_i32 s90, s60, 12288
    s_lshl_b32 s91, s59, 11
    s_add_u32 s90, s90, s91
    v_mul_u32_u24 v7, 6144, v5
    v_add3_u32 v19, v6, v7, s90
    v_mov_b32 v22, -1
    s_mov_b32 s56, 49152
    v_lshl_add_u32 v137, v5, 11, v6
    v_add_u32 v137, 135168, v137
    s_mul_i32 s90, s40, 1280
    s_add_u32 s90, s90, 10240
    v_lshlrev_b32 v6, 1, v5
    v_or_b32 v7, v6, v3
    v_lshl_add_u32 v7, v7, 4, v1
    v_lshlrev_b32 v7, 2, v7
    v_add_u32 v7, 1024, v7
    v_or_b32 v6, v6, v1
    v_lshl_add_u32 v6, v3, 4, v6
    v_lshlrev_b32 v6, 4, v6
    s_sub_u32 s91, s32, 1
    s_lshl_b32 s91, s91, 9
    v_add_u32 v6, s91, v6
    s_cmp_eq_u32 s32, 0
    s_cselect_b64 vcc, -1, 0
    v_cndmask_b32 v6, v6, v7, vcc
    v_add_u32 v135, s90, v6
    s_lshl_b32 s91, s32, 8
    s_add_u32 s91, s91, s90
    v_lshl_add_u32 v150, v0, 2, s91
    v_and_b32 v4, 2, v1
    v_cmp_eq_u32 vcc, 0, v4
    v_mov_b32 v9, 2146435072
    s_nop 0
    v_cndmask_b32 v135, v9, v135, vcc
    s_lshl_b32 s90, s40, 10
    v_lshrrev_b32 v3, 2, v1
    v_lshlrev_b32 v3, 1, v3
    v_and_b32 v6, 1, v1
    v_or_b32 v3, v3, v6
    v_lshl_add_u32 v3, v2, 3, v3
    v_lshl_add_u32 v136, v3, 4, s90
    v_cmp_ne_u32 vcc, 0, v4
    v_mov_b32 v9, 2146435072
    s_nop 0
    v_cndmask_b32 v136, v9, v136, vcc
    v_and_b32 v6, 9, v1
    v_lshl_or_b32 v6, v4, 1, v6
    v_and_b32 v7, 4, v1
    v_lshrrev_b32 v7, 1, v7
    v_or_b32 v6, v6, v7
    v_lshlrev_b32 v6, 4, v6
    v_lshl_add_u32 v6, v2, 8, v6
    s_cmp_eq_u32 s32, 2
    s_cselect_b32 s90, 2048, 0
    s_add_u32 s90, s90, 135168
    v_add_u32 v138, s90, v6
    s_lshl_b32 s90, s60, 7
    s_lshl_b32 s91, s59, 2
    s_add_u32 s91, s91, s90
    s_add_u32 s91, s91, 459264
    s_cmp_eq_u32 s32, 3
    s_cselect_b32 s91, s91, 2146435072
    s_cselect_b32 s55, -1, 0
    v_mov_b32 v139, s91
    v_cmp_eq_u32 vcc, 0, v0
    v_mov_b32 v9, 2146435072
    s_nop 0
    v_cndmask_b32 v139, v9, v139, vcc
    v_add_u32 v21, 3072, v139
    s_mul_i32 s90, s35, 32768
    s_lshl_b32 s91, s32, 11
    s_add_u32 s90, s90, s91
    s_lshl_b32 s92, s35, 10
    s_lshl_b32 s91, s32, 8
    s_add_u32 s92, s92, s91
    s_cmp_lt_u32 s35, 10
    s_cselect_b32 s90, s90, 2146435072
    s_cselect_b32 s92, s92, 2146435072
    s_lshl_b32 s91, s34, 8
    v_lshlrev_b32 v3, 4, v0
    v_xor_b32 v3, s91, v3
    v_add_u32 v142, s90, v3
    v_xor_b32 v3, 1024, v3
    v_add_u32 v143, s90, v3
    s_min_u32 s90, s35, 9
    s_lshl_b32 s90, s90, 7
    s_add_u32 s90, s90, 460800
    s_add_u32 s90, s90, s38
    v_and_b32 v3, 3, v0
    v_lshl_add_u32 v146, v3, 2, s90
    v_lshl_add_u32 v149, v0, 2, s92
    v_lshl_add_u32 v148, v1, 4, s92
    v_cmp_eq_u32 vcc, 0, v2
    v_mov_b32 v9, 2146435072
    s_nop 0
    v_cndmask_b32 v148, v9, v148, vcc
    v_and_b32 v7, 1, v1
    v_cmp_ne_u32 vcc, 0, v7
    v_mov_b32 v5, 0x3f80
    v_mov_b32 v6, 0x3f800000
    v_cndmask_b32 v5, v5, v6, vcc
    v_bfe_u32 v6, v1, 1, 1
    v_cmp_eq_u32 vcc, 0, v6
    s_nop 1
    v_cndmask_b32 v198, 0, v5, vcc
    v_mov_b32 v196, 0
    v_mov_b32 v200, 0
    v_cmp_eq_u32 vcc, 1, v6
    s_nop 1
    v_cndmask_b32 v199, 0, v5, vcc
    v_mov_b32 v197, 0
    v_mov_b32 v201, 0
    v_lshrrev_b32 v3, 2, v1
    v_and_b32 v4, 3, v1
    v_and_b32 v5, 1, v2
    v_lshl_add_u32 v6, v2, 3, v3
    v_lshlrev_b32 v6, 7, v6
    v_and_b32 v7, 2, v3
    v_lshl_or_b32 v7, v5, 2, v7
    v_lshrrev_b32 v8, 1, v4
    s_lshl_b32 s90, s32, 1
    v_or_b32 v8, s90, v8
    v_xor_b32 v7, v7, v8
    v_lshl_add_u32 v6, v7, 4, v6
    v_and_b32 v7, 1, v4
    v_lshl_add_u32 v6, v7, 3, v6
    v_add_u32 v125, 81920, v6
    v_add_u32 v126, 40960, v6
    v_add_u32 v127, 122880, v6
    s_lshl_b32 s90, s32, 9
    s_add_u32 s90, s90, 133120
    v_xor_b32 v6, 0, v5
    v_lshl_add_u32 v6, v6, 2, v3
    v_lshl_add_u32 v6, v2, 3, v6
    v_lshlrev_b32 v6, 5, v6
    v_lshl_or_b32 v7, v5, 1, 0
    v_xor_b32 v7, v7, v4
    v_lshl_add_u32 v6, v7, 3, v6
    v_add_u32 v24, 133120, v6
    v_xor_b32 v6, 1, v5
    v_lshl_add_u32 v6, v6, 2, v3
    v_lshl_add_u32 v6, v2, 3, v6
    v_lshlrev_b32 v6, 5, v6
    v_lshl_or_b32 v7, v5, 1, 1
    v_xor_b32 v7, v7, v4
    v_lshl_add_u32 v6, v7, 3, v6
    v_add_u32 v134, 133120, v6
    v_lshrrev_b32 v6, 3, v1
    v_lshlrev_b32 v6, 2, v6
    v_xor_b32 v6, v6, v1
    v_lshlrev_b32 v6, 5, v6
    v_xor_b32 v7, v2, v3
    v_lshl_add_u32 v6, v7, 3, v6
    v_add_u32 v23, s90, v6
    v_and_b32 v7, 2, v1
    v_cmp_ne_u32 vcc, 0, v7
    v_mov_b32 v6, 0x4444
    v_mov_b32 v8, 0xeeee
    v_cndmask_b32 v17, v6, v8, vcc
    v_lshlrev_b32 v6, 4, v0
    v_add_u32 v16, 122880, v6
    s_mul_i32 s90, s32, 2560
    v_lshl_add_u32 v13, v0, 4, s90
    v_lshl_add_u32 v14, v0, 2, s90
    s_add_u32 s48, s90, 122880
    v_mul_u32_u24 v6, 40, v0
    v_add_u32 v15, s48, v6
    v_mul_u32_u24 v6, 164, v0
    v_min_u32 v6, 10236, v6
    v_add_u32 v25, 122880, v6
    v_lshrrev_b32 v6, 3, v1
    v_lshlrev_b32 v6, 10, v6
    v_and_b32 v7, 7, v1
    v_lshl_add_u32 v6, v7, 7, v6
    v_lshrrev_b32 v7, 1, v1
    v_xor_b32 v7, v7, v2
    v_lshl_add_u32 v11, v7, 4, v6
    v_xor_b32 v12, 64, v11
    s_waitcnt vmcnt(30)
    s_barrier
    ds_read_b64_tr_b16 a[0:1], v125 offset:0
    ds_read_b64_tr_b16 a[2:3], v125 offset:512
    ds_read_b64_tr_b16 a[4:5], v125 offset:4096
    ds_read_b64_tr_b16 a[6:7], v125 offset:4608
    ds_read_b64_tr_b16 a[8:9], v125 offset:8192
    ds_read_b64_tr_b16 a[10:11], v125 offset:8704
    ds_read_b64_tr_b16 a[12:13], v125 offset:12288
    ds_read_b64_tr_b16 a[14:15], v125 offset:12800
    ds_read_b64_tr_b16 a[16:17], v125 offset:16384
    ds_read_b64_tr_b16 a[18:19], v125 offset:16896
    ds_read_b64_tr_b16 a[20:21], v125 offset:20480
    ds_read_b64_tr_b16 a[22:23], v125 offset:20992
    ds_read_b64_tr_b16 a[24:25], v125 offset:24576
    ds_read_b64_tr_b16 a[26:27], v125 offset:25088
    ds_read_b64_tr_b16 a[28:29], v125 offset:28672
    ds_read_b64_tr_b16 a[30:31], v125 offset:29184
    ds_read_b64_tr_b16 a[32:33], v125 offset:32768
    ds_read_b64_tr_b16 a[34:35], v125 offset:33280
    ds_read_b64_tr_b16 a[36:37], v125 offset:36864
    ds_read_b64_tr_b16 a[38:39], v125 offset:37376
    s_waitcnt lgkmcnt(0)
    s_barrier
    s_lshl_b32 s90, s32, 10
    s_add_u32 m0, s90, 81920
    s_mov_b32 s91, 3932160
    buffer_load_dwordx4 v124, s[16:19], s91 offen nt lds
    s_add_u32 m0, m0, 4096
    s_add_u32 s91, s91, 393216
    buffer_load_dwordx4 v124, s[16:19], s91 offen nt lds
    s_add_u32 m0, m0, 4096
    s_add_u32 s91, s91, 393216
    buffer_load_dwordx4 v124, s[16:19], s91 offen nt lds
    s_add_u32 m0, m0, 4096
    s_add_u32 s91, s91, 393216
    buffer_load_dwordx4 v124, s[16:19], s91 offen nt lds
    s_add_u32 m0, m0, 4096
    s_add_u32 s91, s91, 393216
    buffer_load_dwordx4 v124, s[16:19], s91 offen nt lds
    s_add_u32 m0, m0, 4096
    s_add_u32 s91, s91, 393216
    buffer_load_dwordx4 v124, s[16:19], s91 offen nt lds
    s_add_u32 m0, m0, 4096
    s_add_u32 s91, s91, 393216
    buffer_load_dwordx4 v124, s[16:19], s91 offen nt lds
    s_add_u32 m0, m0, 4096
    s_add_u32 s91, s91, 393216
    buffer_load_dwordx4 v124, s[16:19], s91 offen nt lds
    s_add_u32 m0, m0, 4096
    s_add_u32 s91, s91, 393216
    buffer_load_dwordx4 v124, s[16:19], s91 offen nt lds
    s_add_u32 m0, m0, 4096
    s_add_u32 s91, s91, 393216
    buffer_load_dwordx4 v124, s[16:19], s91 offen nt lds
    s_waitcnt vmcnt(30)
    s_barrier
    ds_read_b64_tr_b16 a[80:81], v126 offset:0
    ds_read_b64_tr_b16 a[82:83], v126 offset:512
    ds_read_b64_tr_b16 a[84:85], v126 offset:4096
    ds_read_b64_tr_b16 a[86:87], v126 offset:4608
    ds_read_b64_tr_b16 a[88:89], v126 offset:8192
    ds_read_b64_tr_b16 a[90:91], v126 offset:8704
    ds_read_b64_tr_b16 a[92:93], v126 offset:12288
    ds_read_b64_tr_b16 a[94:95], v126 offset:12800
    ds_read_b64_tr_b16 a[96:97], v126 offset:16384
    ds_read_b64_tr_b16 a[98:99], v126 offset:16896
    ds_read_b64_tr_b16 a[100:101], v126 offset:20480
    ds_read_b64_tr_b16 a[102:103], v126 offset:20992
    ds_read_b64_tr_b16 a[104:105], v126 offset:24576
    ds_read_b64_tr_b16 a[106:107], v126 offset:25088
    ds_read_b64_tr_b16 a[108:109], v126 offset:28672
    ds_read_b64_tr_b16 a[110:111], v126 offset:29184
    ds_read_b64_tr_b16 a[112:113], v126 offset:32768
    ds_read_b64_tr_b16 a[114:115], v126 offset:33280
    ds_read_b64_tr_b16 a[116:117], v126 offset:36864
    ds_read_b64_tr_b16 a[118:119], v126 offset:37376
    s_waitcnt lgkmcnt(0)
    s_barrier
    s_mov_b32 s46, 40960
    s_lshl_b32 s90, s32, 10
    s_add_u32 m0, s90, 40960
    s_nop 0
    buffer_load_dwordx4 v10, s[24:27], s46 offen offset:0 lds
    s_add_u32 m0, m0, 3968
    s_nop 0
    buffer_load_dwordx4 v10, s[24:27], s46 offen offset:128 lds
    s_add_u32 m0, m0, 3968
    s_nop 0
    buffer_load_dwordx4 v10, s[24:27], s46 offen offset:256 lds
    s_add_u32 m0, m0, 3968
    s_nop 0
    buffer_load_dwordx4 v10, s[24:27], s46 offen offset:384 lds
    s_add_u32 m0, m0, 3968
    s_nop 0
    buffer_load_dwordx4 v10, s[24:27], s46 offen offset:512 lds
    s_add_u32 m0, m0, 3968
    s_nop 0
    buffer_load_dwordx4 v10, s[24:27], s46 offen offset:640 lds
    s_add_u32 m0, m0, 3968
    s_nop 0
    buffer_load_dwordx4 v10, s[24:27], s46 offen offset:768 lds
    s_add_u32 m0, m0, 3968
    s_nop 0
    buffer_load_dwordx4 v10, s[24:27], s46 offen offset:896 lds
    s_add_u32 m0, m0, 3968
    s_nop 0
    buffer_load_dwordx4 v10, s[24:27], s46 offen offset:1024 lds
    s_add_u32 m0, m0, 3968
    s_nop 0
    buffer_load_dwordx4 v10, s[24:27], s46 offen offset:1152 lds
    s_waitcnt vmcnt(30)
    s_barrier
    ds_read_b64_tr_b16 a[40:41], v127 offset:0
    ds_read_b64_tr_b16 a[42:43], v127 offset:512
    ds_read_b64_tr_b16 a[44:45], v127 offset:4096
    ds_read_b64_tr_b16 a[46:47], v127 offset:4608
    ds_read_b64_tr_b16 a[48:49], v127 offset:8192
    ds_read_b64_tr_b16 a[50:51], v127 offset:8704
    ds_read_b64_tr_b16 a[52:53], v127 offset:12288
    ds_read_b64_tr_b16 a[54:55], v127 offset:12800
    ds_read_b64_tr_b16 a[56:57], v127 offset:16384
    ds_read_b64_tr_b16 a[58:59], v127 offset:16896
    ds_read_b64_tr_b16 a[60:61], v127 offset:20480
    ds_read_b64_tr_b16 a[62:63], v127 offset:20992
    ds_read_b64_tr_b16 a[64:65], v127 offset:24576
    ds_read_b64_tr_b16 a[66:67], v127 offset:25088
    ds_read_b64_tr_b16 a[68:69], v127 offset:28672
    ds_read_b64_tr_b16 a[70:71], v127 offset:29184
    ds_read_b64_tr_b16 a[72:73], v127 offset:32768
    ds_read_b64_tr_b16 a[74:75], v127 offset:33280
    ds_read_b64_tr_b16 a[76:77], v127 offset:36864
    ds_read_b64_tr_b16 a[78:79], v127 offset:37376
    s_waitcnt lgkmcnt(0)
    s_waitcnt vmcnt(10)
    s_barrier
    ds_read_b64_tr_b16 a[120:121], v125 offset:0
    ds_read_b64_tr_b16 a[122:123], v125 offset:512
    ds_read_b64_tr_b16 a[124:125], v125 offset:4096
    ds_read_b64_tr_b16 a[126:127], v125 offset:4608
    ds_read_b64_tr_b16 a[128:129], v125 offset:8192
    ds_read_b64_tr_b16 a[130:131], v125 offset:8704
    ds_read_b64_tr_b16 a[132:133], v125 offset:12288
    ds_read_b64_tr_b16 a[134:135], v125 offset:12800
    ds_read_b64_tr_b16 a[136:137], v125 offset:16384
    ds_read_b64_tr_b16 a[138:139], v125 offset:16896
    ds_read_b64_tr_b16 a[140:141], v125 offset:20480
    ds_read_b64_tr_b16 a[142:143], v125 offset:20992
    ds_read_b64_tr_b16 a[144:145], v125 offset:24576
    ds_read_b64_tr_b16 a[146:147], v125 offset:25088
    ds_read_b64_tr_b16 a[148:149], v125 offset:28672
    ds_read_b64_tr_b16 a[150:151], v125 offset:29184
    ds_read_b64_tr_b16 a[152:153], v125 offset:32768
    ds_read_b64_tr_b16 a[154:155], v125 offset:33280
    ds_read_b64_tr_b16 a[156:157], v125 offset:36864
    ds_read_b64_tr_b16 a[158:159], v125 offset:37376
    s_waitcnt lgkmcnt(0)
    s_mov_b32 s49, 40960
    s_mov_b32 s47, 40960
    s_mov_b32 s37, -1
    s_add_u32 s44, s38, 475136
    s_add_u32 s45, s44, s56
    s_mov_b32 s46, 40960
    v_add_u32 v140, 0, v137
    ds_read_b128 v[84:87], v11 offset:0
    ds_read_b128 v[88:91], v11 offset:2048
    ds_read_b128 v[92:95], v12 offset:0
    ds_read_b128 v[96:99], v12 offset:2048
    s_waitcnt lgkmcnt(2)
    v_mfma_f32_16x16x32_bf16 v[108:111], a[0:3], v[84:87], 0
    ds_read_b128 v[100:103], v11 offset:4096
    v_mfma_f32_16x16x32_bf16 v[112:115], a[0:3], v[88:91], 0
    ds_read_b128 v[104:107], v11 offset:6144
    v_mfma_f32_16x16x32_bf16 v[116:119], a[80:83], v[84:87], 0
    v_mfma_f32_16x16x32_bf16 v[120:123], a[80:83], v[88:91], 0
    s_waitcnt lgkmcnt(2)
    v_mfma_f32_16x16x32_bf16 v[108:111], a[4:7], v[92:95], v[108:111]
    ds_read_b128 v[84:87], v12 offset:4096
    v_mfma_f32_16x16x32_bf16 v[112:115], a[4:7], v[96:99], v[112:115]
    ds_read_b128 v[88:91], v12 offset:6144
    v_mfma_f32_16x16x32_bf16 v[116:119], a[84:87], v[92:95], v[116:119]
    v_mfma_f32_16x16x32_bf16 v[120:123], a[84:87], v[96:99], v[120:123]
    s_waitcnt lgkmcnt(2)
    v_mfma_f32_16x16x32_bf16 v[108:111], a[8:11], v[100:103], v[108:111]
    ds_read_b128 v[92:95], v11 offset:8192
    v_mfma_f32_16x16x32_bf16 v[112:115], a[8:11], v[104:107], v[112:115]
    ds_read_b128 v[96:99], v11 offset:10240
    v_mfma_f32_16x16x32_bf16 v[116:119], a[88:91], v[100:103], v[116:119]
    v_mfma_f32_16x16x32_bf16 v[120:123], a[88:91], v[104:107], v[120:123]
    s_waitcnt lgkmcnt(2)
    v_mfma_f32_16x16x32_bf16 v[108:111], a[12:15], v[84:87], v[108:111]
    ds_read_b128 v[100:103], v12 offset:8192
    v_mfma_f32_16x16x32_bf16 v[112:115], a[12:15], v[88:91], v[112:115]
    ds_read_b128 v[104:107], v12 offset:10240
    v_mfma_f32_16x16x32_bf16 v[116:119], a[92:95], v[84:87], v[116:119]
    v_mfma_f32_16x16x32_bf16 v[120:123], a[92:95], v[88:91], v[120:123]
    s_waitcnt lgkmcnt(2)
    v_mfma_f32_16x16x32_bf16 v[108:111], a[16:19], v[92:95], v[108:111]
    ds_read_b128 v[84:87], v11 offset:12288
    v_mfma_f32_16x16x32_bf16 v[112:115], a[16:19], v[96:99], v[112:115]
    ds_read_b128 v[88:91], v11 offset:14336
    v_mfma_f32_16x16x32_bf16 v[116:119], a[96:99], v[92:95], v[116:119]
    v_mfma_f32_16x16x32_bf16 v[120:123], a[96:99], v[96:99], v[120:123]
    s_waitcnt lgkmcnt(2)
    v_mfma_f32_16x16x32_bf16 v[108:111], a[20:23], v[100:103], v[108:111]
    ds_read_b128 v[92:95], v12 offset:12288
    v_mfma_f32_16x16x32_bf16 v[112:115], a[20:23], v[104:107], v[112:115]
    ds_read_b128 v[96:99], v12 offset:14336
    v_mfma_f32_16x16x32_bf16 v[116:119], a[100:103], v[100:103], v[116:119]
    v_mfma_f32_16x16x32_bf16 v[120:123], a[100:103], v[104:107], v[120:123]
    s_waitcnt lgkmcnt(2)
    v_mfma_f32_16x16x32_bf16 v[108:111], a[24:27], v[84:87], v[108:111]
    ds_read_b128 v[100:103], v11 offset:16384
    v_mfma_f32_16x16x32_bf16 v[112:115], a[24:27], v[88:91], v[112:115]
    ds_read_b128 v[104:107], v11 offset:18432
    v_mfma_f32_16x16x32_bf16 v[116:119], a[104:107], v[84:87], v[116:119]
    v_mfma_f32_16x16x32_bf16 v[120:123], a[104:107], v[88:91], v[120:123]
    s_waitcnt lgkmcnt(2)
    v_mfma_f32_16x16x32_bf16 v[108:111], a[28:31], v[92:95], v[108:111]
    ds_read_b128 v[84:87], v12 offset:16384
    v_mfma_f32_16x16x32_bf16 v[112:115], a[28:31], v[96:99], v[112:115]
    ds_read_b128 v[88:91], v12 offset:18432
    v_mfma_f32_16x16x32_bf16 v[116:119], a[108:111], v[92:95], v[116:119]
    v_mfma_f32_16x16x32_bf16 v[120:123], a[108:111], v[96:99], v[120:123]
    s_waitcnt lgkmcnt(2)
    v_mfma_f32_16x16x32_bf16 v[108:111], a[32:35], v[100:103], v[108:111]
    ds_read_b128 v[92:95], v11 offset:20480
    v_mfma_f32_16x16x32_bf16 v[112:115], a[32:35], v[104:107], v[112:115]
    ds_read_b128 v[96:99], v11 offset:22528
    v_mfma_f32_16x16x32_bf16 v[116:119], a[112:115], v[100:103], v[116:119]
    v_mfma_f32_16x16x32_bf16 v[120:123], a[112:115], v[104:107], v[120:123]
    s_waitcnt lgkmcnt(2)
    v_mfma_f32_16x16x32_bf16 v[108:111], a[36:39], v[84:87], v[108:111]
    ds_read_b128 v[100:103], v12 offset:20480
    v_mfma_f32_16x16x32_bf16 v[112:115], a[36:39], v[88:91], v[112:115]
    ds_read_b128 v[104:107], v12 offset:22528
    v_mfma_f32_16x16x32_bf16 v[116:119], a[116:119], v[84:87], v[116:119]
    v_mfma_f32_16x16x32_bf16 v[120:123], a[116:119], v[88:91], v[120:123]
    s_waitcnt lgkmcnt(2)
    v_mfma_f32_16x16x32_bf16 v[108:111], a[40:43], v[92:95], v[108:111]
    ds_read_b128 v[84:87], v11 offset:24576
    v_mfma_f32_16x16x32_bf16 v[112:115], a[40:43], v[96:99], v[112:115]
    ds_read_b128 v[88:91], v11 offset:26624
    v_mfma_f32_16x16x32_bf16 v[116:119], a[120:123], v[92:95], v[116:119]
    v_mfma_f32_16x16x32_bf16 v[120:123], a[120:123], v[96:99], v[120:123]
    s_waitcnt lgkmcnt(2)
    v_mfma_f32_16x16x32_bf16 v[108:111], a[44:47], v[100:103], v[108:111]
    ds_read_b128 v[92:95], v12 offset:24576
    v_mfma_f32_16x16x32_bf16 v[112:115], a[44:47], v[104:107], v[112:115]
    ds_read_b128 v[96:99], v12 offset:26624
    v_mfma_f32_16x16x32_bf16 v[116:119], a[124:127], v[100:103], v[116:119]
    v_mfma_f32_16x16x32_bf16 v[120:123], a[124:127], v[104:107], v[120:123]
    s_waitcnt lgkmcnt(2)
    v_mfma_f32_16x16x32_bf16 v[108:111], a[48:51], v[84:87], v[108:111]
    ds_read_b128 v[100:103], v11 offset:28672
    v_mfma_f32_16x16x32_bf16 v[112:115], a[48:51], v[88:91], v[112:115]
    ds_read_b128 v[104:107], v11 offset:30720
    v_mfma_f32_16x16x32_bf16 v[116:119], a[128:131], v[84:87], v[116:119]
    v_mfma_f32_16x16x32_bf16 v[120:123], a[128:131], v[88:91], v[120:123]
    s_waitcnt lgkmcnt(2)
    v_mfma_f32_16x16x32_bf16 v[108:111], a[52:55], v[92:95], v[108:111]
    ds_read_b128 v[84:87], v12 offset:28672
    v_mfma_f32_16x16x32_bf16 v[112:115], a[52:55], v[96:99], v[112:115]
    ds_read_b128 v[88:91], v12 offset:30720
    v_mfma_f32_16x16x32_bf16 v[116:119], a[132:135], v[92:95], v[116:119]
    v_mfma_f32_16x16x32_bf16 v[120:123], a[132:135], v[96:99], v[120:123]
    s_waitcnt lgkmcnt(2)
    v_mfma_f32_16x16x32_bf16 v[108:111], a[56:59], v[100:103], v[108:111]
    ds_read_b128 v[92:95], v11 offset:32768
    v_mfma_f32_16x16x32_bf16 v[112:115], a[56:59], v[104:107], v[112:115]
    ds_read_b128 v[96:99], v11 offset:34816
    v_mfma_f32_16x16x32_bf16 v[116:119], a[136:139], v[100:103], v[116:119]
    v_mfma_f32_16x16x32_bf16 v[120:123], a[136:139], v[104:107], v[120:123]
    s_waitcnt lgkmcnt(2)
    v_mfma_f32_16x16x32_bf16 v[108:111], a[60:63], v[84:87], v[108:111]
    ds_read_b128 v[100:103], v12 offset:32768
    v_mfma_f32_16x16x32_bf16 v[112:115], a[60:63], v[88:91], v[112:115]
    ds_read_b128 v[104:107], v12 offset:34816
    v_mfma_f32_16x16x32_bf16 v[116:119], a[140:143], v[84:87], v[116:119]
    v_mfma_f32_16x16x32_bf16 v[120:123], a[140:143], v[88:91], v[120:123]
    s_waitcnt lgkmcnt(2)
    v_mfma_f32_16x16x32_bf16 v[108:111], a[64:67], v[92:95], v[108:111]
    ds_read_b128 v[84:87], v11 offset:36864
    v_mfma_f32_16x16x32_bf16 v[112:115], a[64:67], v[96:99], v[112:115]
    ds_read_b128 v[88:91], v11 offset:38912
    v_mfma_f32_16x16x32_bf16 v[116:119], a[144:147], v[92:95], v[116:119]
    v_mfma_f32_16x16x32_bf16 v[120:123], a[144:147], v[96:99], v[120:123]
    s_waitcnt lgkmcnt(2)
    v_mfma_f32_16x16x32_bf16 v[108:111], a[68:71], v[100:103], v[108:111]
    ds_read_b128 v[92:95], v12 offset:36864
    v_mfma_f32_16x16x32_bf16 v[112:115], a[68:71], v[104:107], v[112:115]
    ds_read_b128 v[96:99], v12 offset:38912
    v_mfma_f32_16x16x32_bf16 v[116:119], a[148:151], v[100:103], v[116:119]
    v_mfma_f32_16x16x32_bf16 v[120:123], a[148:151], v[104:107], v[120:123]
    s_waitcnt lgkmcnt(0)
    v_mfma_f32_16x16x32_bf16 v[108:111], a[72:75], v[84:87], v[108:111]
    v_add_u32 v11, s49, v11
    v_mfma_f32_16x16x32_bf16 v[112:115], a[72:75], v[88:91], v[112:115]
    v_add_u32 v12, s49, v12
    v_mfma_f32_16x16x32_bf16 v[108:111], a[76:79], v[92:95], v[108:111]
    s_sub_u32 s47, s47, s49
    v_mfma_f32_16x16x32_bf16 v[112:115], a[76:79], v[96:99], v[112:115]
    s_sub_u32 s49, 0, s49
    v_mfma_f32_16x16x32_bf16 v[116:119], a[152:155], v[84:87], v[116:119]
    v_mfma_f32_16x16x32_bf16 v[120:123], a[152:155], v[88:91], v[120:123]
    v_mfma_f32_16x16x32_bf16 v[116:119], a[156:159], v[92:95], v[116:119]
    v_mfma_f32_16x16x32_bf16 v[120:123], a[156:159], v[96:99], v[120:123]
    v_cvt_pk_bf16_f32 v124, v108, v109
    v_cvt_pk_bf16_f32 v125, v110, v111
    v_cvt_pk_bf16_f32 v126, v112, v113
    v_cvt_pk_bf16_f32 v127, v114, v115
    s_nop 0
    v_permlane16_swap_b32 v124, v126
    v_permlane16_swap_b32 v125, v127
    v_cvt_pk_bf16_f32 v128, v116, v117
    v_cvt_pk_bf16_f32 v129, v118, v119
    v_cvt_pk_bf16_f32 v130, v120, v121
    v_cvt_pk_bf16_f32 v131, v122, v123
    s_nop 0
    v_permlane16_swap_b32 v128, v130
    v_permlane16_swap_b32 v129, v131
    ds_write_b128 v140, v[128:131]
    buffer_store_dwordx4 v[124:127], v19, s[4:7], s44 offen sc1
    buffer_store_dwordx4 v[128:131], v19, s[4:7], s45 offen sc1
    v_mov_b32 v1, 196
L_gw_62:
    buffer_load_dword v2, v1, s[8:11], 0 offen sc1
    s_sub_u32 s36, s36, 1
    s_cbranch_scc1 L_exit
    s_waitcnt vmcnt(0)
    v_readfirstlane_b32 s90, v2
    s_nop 0
    s_cmp_eq_u32 s90, 0
    s_cbranch_scc1 L_gw_62
    s_waitcnt vmcnt(0) lgkmcnt(0)
    s_barrier
    s_add_u32 s44, s38, 573440
    s_add_u32 s45, s44, s56
    s_mov_b32 s46, 81920
    v_add_u32 v140, 4096, v137
    ds_read_b128 v[84:87], v11 offset:0
    ds_read_b128 v[88:91], v11 offset:2048
    ds_read_b128 v[92:95], v12 offset:0
    ds_read_b128 v[96:99], v12 offset:2048
    s_lshl_b32 s90, s32, 10
    s_add_u32 m0, s90, s47
    s_waitcnt lgkmcnt(2)
    v_mfma_f32_16x16x32_bf16 v[108:111], a[0:3], v[84:87], 0
    ds_read_b128 v[100:103], v11 offset:4096
    s_and_b32 s50, s37, 3
    v_mfma_f32_16x16x32_bf16 v[112:115], a[0:3], v[88:91], 0
    ds_read_b128 v[104:107], v11 offset:6144
    s_mul_i32 s53, s50, 327680
    v_mfma_f32_16x16x32_bf16 v[116:119], a[80:83], v[84:87], 0
    buffer_load_dwordx4 v10, s[24:27], s46 offen offset:0 lds
    s_add_u32 m0, m0, 3968
    v_mfma_f32_16x16x32_bf16 v[120:123], a[80:83], v[88:91], 0
    s_waitcnt lgkmcnt(2)
    s_add_u32 s51, s37, 2
    v_mfma_f32_16x16x32_bf16 v[108:111], a[4:7], v[92:95], v[108:111]
    ds_read_b128 v[84:87], v12 offset:4096
    s_and_b32 s50, s51, 3
    v_mfma_f32_16x16x32_bf16 v[112:115], a[4:7], v[96:99], v[112:115]
    ds_read_b128 v[88:91], v12 offset:6144
    s_mul_i32 s50, s50, 98304
    v_mfma_f32_16x16x32_bf16 v[116:119], a[84:87], v[92:95], v[116:119]
    buffer_load_dwordx4 v10, s[24:27], s46 offen offset:128 lds
    s_add_u32 m0, m0, 3968
    v_mfma_f32_16x16x32_bf16 v[120:123], a[84:87], v[96:99], v[120:123]
    s_waitcnt lgkmcnt(2)
    s_add_u32 s50, s50, 475136
    v_mfma_f32_16x16x32_bf16 v[108:111], a[8:11], v[100:103], v[108:111]
    ds_read_b128 v[92:95], v11 offset:8192
    s_add_u32 s44, s38, s50
    v_mfma_f32_16x16x32_bf16 v[112:115], a[8:11], v[104:107], v[112:115]
    ds_read_b128 v[96:99], v11 offset:10240
    s_add_u32 s45, s44, s56
    v_mfma_f32_16x16x32_bf16 v[116:119], a[88:91], v[100:103], v[116:119]
    buffer_load_dwordx4 v10, s[24:27], s46 offen offset:256 lds
    s_add_u32 m0, m0, 3968
    v_mfma_f32_16x16x32_bf16 v[120:123], a[88:91], v[104:107], v[120:123]
    s_waitcnt lgkmcnt(2)
    s_and_b32 s50, s51, 3
    v_mfma_f32_16x16x32_bf16 v[108:111], a[12:15], v[84:87], v[108:111]
    ds_read_b128 v[100:103], v12 offset:8192
    s_lshl_b32 s50, s50, 12
    v_mfma_f32_16x16x32_bf16 v[112:115], a[12:15], v[88:91], v[112:115]
    ds_read_b128 v[104:107], v12 offset:10240
    v_add_u32 v140, s50, v137
    v_mfma_f32_16x16x32_bf16 v[116:119], a[92:95], v[84:87], v[116:119]
    buffer_load_dwordx4 v10, s[24:27], s46 offen offset:384 lds
    s_add_u32 m0, m0, 3968
    v_mfma_f32_16x16x32_bf16 v[120:123], a[92:95], v[88:91], v[120:123]
    s_waitcnt lgkmcnt(2)
    s_add_u32 s37, s37, 1
    v_mfma_f32_16x16x32_bf16 v[108:111], a[16:19], v[92:95], v[108:111]
    ds_read_b128 v[84:87], v11 offset:12288
    s_mov_b32 s52, 0
    v_mfma_f32_16x16x32_bf16 v[112:115], a[16:19], v[96:99], v[112:115]
    ds_read_b128 v[88:91], v11 offset:14336
    s_and_b32 s50, s37, 3
    v_mfma_f32_16x16x32_bf16 v[116:119], a[96:99], v[92:95], v[116:119]
    buffer_load_dwordx4 v10, s[24:27], s46 offen offset:512 lds
    s_add_u32 m0, m0, 3968
    v_mfma_f32_16x16x32_bf16 v[120:123], a[96:99], v[96:99], v[120:123]
    s_waitcnt lgkmcnt(2)
    s_mul_i32 s51, s50, 114688
    v_mfma_f32_16x16x32_bf16 v[108:111], a[20:23], v[100:103], v[108:111]
    ds_read_b128 v[92:95], v12 offset:12288
    s_add_u32 s41, s38, s51
    v_mfma_f32_16x16x32_bf16 v[112:115], a[20:23], v[104:107], v[112:115]
    ds_read_b128 v[96:99], v12 offset:14336
    s_and_b32 s54, s37, s55
    v_mfma_f32_16x16x32_bf16 v[116:119], a[100:103], v[100:103], v[116:119]
    buffer_load_dwordx4 v10, s[24:27], s46 offen offset:640 lds
    s_add_u32 m0, m0, 3968
    v_mfma_f32_16x16x32_bf16 v[120:123], a[100:103], v[104:107], v[120:123]
    s_waitcnt lgkmcnt(2)
    s_lshl_b32 s50, s50, 12
    v_mfma_f32_16x16x32_bf16 v[108:111], a[24:27], v[84:87], v[108:111]
    ds_read_b128 v[100:103], v11 offset:16384
    v_add_u32 v141, s50, v138
    v_mfma_f32_16x16x32_bf16 v[112:115], a[24:27], v[88:91], v[112:115]
    ds_read_b128 v[104:107], v11 offset:18432
    s_add_u32 s43, s41, 40960
    v_mfma_f32_16x16x32_bf16 v[116:119], a[104:107], v[84:87], v[116:119]
    buffer_load_dwordx4 v10, s[24:27], s46 offen offset:768 lds
    s_add_u32 m0, m0, 3968
    v_mfma_f32_16x16x32_bf16 v[120:123], a[104:107], v[88:91], v[120:123]
    s_waitcnt lgkmcnt(2)
    v_mfma_f32_16x16x32_bf16 v[108:111], a[28:31], v[92:95], v[108:111]
    ds_read_b128 v[84:87], v12 offset:16384
    v_mfma_f32_16x16x32_bf16 v[112:115], a[28:31], v[96:99], v[112:115]
    ds_read_b128 v[88:91], v12 offset:18432
    v_mfma_f32_16x16x32_bf16 v[116:119], a[108:111], v[92:95], v[116:119]
    buffer_load_dwordx4 v10, s[24:27], s46 offen offset:896 lds
    s_add_u32 m0, m0, 3968
    v_mfma_f32_16x16x32_bf16 v[120:123], a[108:111], v[96:99], v[120:123]
    s_waitcnt lgkmcnt(2)
    v_mfma_f32_16x16x32_bf16 v[108:111], a[32:35], v[100:103], v[108:111]
    ds_read_b128 v[92:95], v11 offset:20480
    v_mfma_f32_16x16x32_bf16 v[112:115], a[32:35], v[104:107], v[112:115]
    ds_read_b128 v[96:99], v11 offset:22528
    v_mfma_f32_16x16x32_bf16 v[116:119], a[112:115], v[100:103], v[116:119]
    buffer_load_dwordx4 v10, s[24:27], s46 offen offset:1024 lds
    s_add_u32 m0, m0, 3968
    v_mfma_f32_16x16x32_bf16 v[120:123], a[112:115], v[104:107], v[120:123]
    s_waitcnt lgkmcnt(2)
    v_mfma_f32_16x16x32_bf16 v[108:111], a[36:39], v[84:87], v[108:111]
    ds_read_b128 v[100:103], v12 offset:20480
    v_mfma_f32_16x16x32_bf16 v[112:115], a[36:39], v[88:91], v[112:115]
    ds_read_b128 v[104:107], v12 offset:22528
    v_mfma_f32_16x16x32_bf16 v[116:119], a[116:119], v[84:87], v[116:119]
    buffer_load_dwordx4 v10, s[24:27], s46 offen offset:1152 lds
    v_mfma_f32_16x16x32_bf16 v[120:123], a[116:119], v[88:91], v[120:123]
    s_waitcnt lgkmcnt(2)
    v_mfma_f32_16x16x32_bf16 v[108:111], a[40:43], v[92:95], v[108:111]
    ds_read_b128 v[84:87], v11 offset:24576
    v_mfma_f32_16x16x32_bf16 v[112:115], a[40:43], v[96:99], v[112:115]
    ds_read_b128 v[88:91], v11 offset:26624
    v_mfma_f32_16x16x32_bf16 v[116:119], a[120:123], v[92:95], v[116:119]
    v_mfma_f32_16x16x32_bf16 v[120:123], a[120:123], v[96:99], v[120:123]
    s_waitcnt lgkmcnt(2)
    v_mfma_f32_16x16x32_bf16 v[108:111], a[44:47], v[100:103], v[108:111]
    ds_read_b128 v[92:95], v12 offset:24576
    v_mfma_f32_16x16x32_bf16 v[112:115], a[44:47], v[104:107], v[112:115]
    ds_read_b128 v[96:99], v12 offset:26624
    v_mfma_f32_16x16x32_bf16 v[116:119], a[124:127], v[100:103], v[116:119]
    v_mfma_f32_16x16x32_bf16 v[120:123], a[124:127], v[104:107], v[120:123]
    s_waitcnt lgkmcnt(2)
    v_mfma_f32_16x16x32_bf16 v[108:111], a[48:51], v[84:87], v[108:111]
    ds_read_b128 v[100:103], v11 offset:28672
    v_mfma_f32_16x16x32_bf16 v[112:115], a[48:51], v[88:91], v[112:115]
    ds_read_b128 v[104:107], v11 offset:30720
    v_mfma_f32_16x16x32_bf16 v[116:119], a[128:131], v[84:87], v[116:119]
    v_mfma_f32_16x16x32_bf16 v[120:123], a[128:131], v[88:91], v[120:123]
    s_waitcnt lgkmcnt(2)
    v_mfma_f32_16x16x32_bf16 v[108:111], a[52:55], v[92:95], v[108:111]
    ds_read_b128 v[84:87], v12 offset:28672
    v_mfma_f32_16x16x32_bf16 v[112:115], a[52:55], v[96:99], v[112:115]
    ds_read_b128 v[88:91], v12 offset:30720
    v_mfma_f32_16x16x32_bf16 v[116:119], a[132:135], v[92:95], v[116:119]
    v_mfma_f32_16x16x32_bf16 v[120:123], a[132:135], v[96:99], v[120:123]
    s_waitcnt lgkmcnt(2)
    v_mfma_f32_16x16x32_bf16 v[108:111], a[56:59], v[100:103], v[108:111]
    ds_read_b128 v[92:95], v11 offset:32768
    v_mfma_f32_16x16x32_bf16 v[112:115], a[56:59], v[104:107], v[112:115]
    ds_read_b128 v[96:99], v11 offset:34816
    v_mfma_f32_16x16x32_bf16 v[116:119], a[136:139], v[100:103], v[116:119]
    v_mfma_f32_16x16x32_bf16 v[120:123], a[136:139], v[104:107], v[120:123]
    s_waitcnt lgkmcnt(2)
    v_mfma_f32_16x16x32_bf16 v[108:111], a[60:63], v[84:87], v[108:111]
    ds_read_b128 v[100:103], v12 offset:32768
    v_mfma_f32_16x16x32_bf16 v[112:115], a[60:63], v[88:91], v[112:115]
    ds_read_b128 v[104:107], v12 offset:34816
    v_mfma_f32_16x16x32_bf16 v[116:119], a[140:143], v[84:87], v[116:119]
    v_mfma_f32_16x16x32_bf16 v[120:123], a[140:143], v[88:91], v[120:123]
    s_waitcnt lgkmcnt(2)
    v_mfma_f32_16x16x32_bf16 v[108:111], a[64:67], v[92:95], v[108:111]
    ds_read_b128 v[84:87], v11 offset:36864
    v_mfma_f32_16x16x32_bf16 v[112:115], a[64:67], v[96:99], v[112:115]
    ds_read_b128 v[88:91], v11 offset:38912
    v_mfma_f32_16x16x32_bf16 v[116:119], a[144:147], v[92:95], v[116:119]
    v_mfma_f32_16x16x32_bf16 v[120:123], a[144:147], v[96:99], v[120:123]
    s_waitcnt lgkmcnt(2)
    v_mfma_f32_16x16x32_bf16 v[108:111], a[68:71], v[100:103], v[108:111]
    ds_read_b128 v[92:95], v12 offset:36864
    v_mfma_f32_16x16x32_bf16 v[112:115], a[68:71], v[104:107], v[112:115]
    ds_read_b128 v[96:99], v12 offset:38912
    v_mfma_f32_16x16x32_bf16 v[116:119], a[148:151], v[100:103], v[116:119]
    v_mfma_f32_16x16x32_bf16 v[120:123], a[148:151], v[104:107], v[120:123]
    s_waitcnt lgkmcnt(0)
    v_mfma_f32_16x16x32_bf16 v[108:111], a[72:75], v[84:87], v[108:111]
    v_add_u32 v11, s49, v11
    v_mfma_f32_16x16x32_bf16 v[112:115], a[72:75], v[88:91], v[112:115]
    v_add_u32 v12, s49, v12
    v_mfma_f32_16x16x32_bf16 v[108:111], a[76:79], v[92:95], v[108:111]
    s_sub_u32 s47, s47, s49
    v_mfma_f32_16x16x32_bf16 v[112:115], a[76:79], v[96:99], v[112:115]
    s_sub_u32 s49, 0, s49
    v_mfma_f32_16x16x32_bf16 v[116:119], a[152:155], v[84:87], v[116:119]
    v_mfma_f32_16x16x32_bf16 v[120:123], a[152:155], v[88:91], v[120:123]
    v_mfma_f32_16x16x32_bf16 v[116:119], a[156:159], v[92:95], v[116:119]
    v_mfma_f32_16x16x32_bf16 v[120:123], a[156:159], v[96:99], v[120:123]
    v_cvt_pk_bf16_f32 v124, v108, v109
    v_cvt_pk_bf16_f32 v125, v110, v111
    v_cvt_pk_bf16_f32 v126, v112, v113
    v_cvt_pk_bf16_f32 v127, v114, v115
    s_nop 0
    v_permlane16_swap_b32 v124, v126
    v_permlane16_swap_b32 v125, v127
    v_cvt_pk_bf16_f32 v128, v116, v117
    v_cvt_pk_bf16_f32 v129, v118, v119
    v_cvt_pk_bf16_f32 v130, v120, v121
    v_cvt_pk_bf16_f32 v131, v122, v123
    s_nop 0
    v_permlane16_swap_b32 v128, v130
    v_permlane16_swap_b32 v129, v131
    ds_write_b128 v140, v[128:131]
    buffer_store_dwordx4 v[124:127], v19, s[4:7], s44 offen sc1
    buffer_store_dwordx4 v[128:131], v19, s[4:7], s45 offen sc1
    v_mov_b32 v3, 460288
L_pf_63:
    buffer_load_dword v4, v3, s[4:7], s38 offen sc1
    s_sub_u32 s36, s36, 1
    s_cbranch_scc1 L_exit
    s_waitcnt vmcnt(0)
    v_readfirstlane_b32 s90, v4
    s_nop 0
    s_cmp_eq_u32 s90, 0
    s_cbranch_scc1 L_pf_63
    s_and_b32 s90, s90, 2
    s_lshl_b32 s90, s90, 12
    v_mov_b32 v3, s90
    v_mov_b32 v4, v3
    v_cmp_gt_u32 vcc, 16, v0
    s_nop 1
    v_cndmask_b32 v3, v3, v4, vcc
    v_add_u32 v142, v3, v142
    v_add_u32 v143, s90, v143
    v_add_u32 v144, 0, v142
    v_add_u32 v145, 0, v143
    s_mov_b32 m0, s48
    v_mov_b32 v3, 204
L_p0_64:
    buffer_load_dword v4, v3, s[8:11], 0 offen sc1
    s_sub_u32 s36, s36, 1
    s_cbranch_scc1 L_exit
    s_waitcnt vmcnt(0)
    v_readfirstlane_b32 s90, v4
    s_nop 0
    s_cmp_eq_u32 s90, 0
    s_cbranch_scc1 L_p0_64
    s_and_b32 s90, s90, 2
    s_lshl_b32 s90, s90, 12
    s_and_b32 s91, s34, 1
    s_lshl_b32 s91, s91, 12
    s_lshr_b32 s92, s34, 2
    s_lshl_b32 s92, s92, 13
    s_add_u32 s91, s91, s92
    s_and_b32 s92, s34, 2
    s_lshl_b32 s92, s92, 13
    s_add_u32 s91, s91, s92
    s_xor_b32 s91, s91, s90
    s_add_u32 s91, s91, 1933312
    v_lshrrev_b32 v4, 2, v0
    v_lshl_add_u32 v3, v4, 9, s91
    v_cmp_ne_u32 s[92:93], s34, v4
    v_cmp_gt_u32 vcc, 32, v0
    s_nop 0
    s_and_b64 vcc, vcc, s[92:93]
    s_and_b32 vcc_lo, vcc_lo, s55
    v_cndmask_b32 v146, v146, v3, vcc
L_qkv_loop_s:
    buffer_load_dwordx4 v13, s[4:7], s41 offen sc1 lds
    buffer_load_dwordx4 v13, s[4:7], s41 offen offset:1024 sc1 lds
    buffer_load_dword v14, s[4:7], s41 offen offset:2048 sc1 lds
    buffer_load_dword v14, s[4:7], s41 offen offset:2304 sc1 lds
    s_add_u32 s50, s37, 2
    s_and_b32 s50, s50, 3
    s_mul_i32 s50, s50, 114688
    s_add_u32 s42, s38, s50
    s_add_u32 s50, s37, 3
    s_min_u32 s50, s50, 63
    s_mul_i32 s46, s50, 40960
    s_add_u32 s51, s37, 1
    v_mov_b32 v20, s51
    s_mov_b32 m0, s48
    v_mov_b32 v68, 0
    v_mov_b32 v69, 0
    v_mov_b32 v70, 0
    v_mov_b32 v71, 0
    v_mov_b32 v72, 0
    v_mov_b32 v73, 0
    v_mov_b32 v74, 0
    v_mov_b32 v75, 0
    ds_read_b128 v[156:159], v141
    ds_read_b128 v[160:163], v141 offset:1024
L_poll_66:
    buffer_load_dwordx4 v13, s[4:7], s41 offen sc1 lds
    buffer_load_dwordx4 v13, s[4:7], s41 offen offset:1024 sc1 lds
    buffer_load_dword v14, s[4:7], s41 offen offset:2048 sc1 lds
    buffer_load_dword v14, s[4:7], s41 offen offset:2304 sc1 lds
    s_sub_u32 s36, s36, 1
    s_cbranch_scc1 L_exit
    s_waitcnt vmcnt(4)
    ds_read_b32 v18, v15
    s_waitcnt lgkmcnt(0)
    v_cmp_eq_u32 vcc, -1, v18
    s_cbranch_vccnz L_poll_66
    s_barrier
    ds_read_b128 v[28:31], v16 offset:0
    ds_read_b128 v[32:35], v16 offset:1024
    ds_read_b128 v[36:39], v16 offset:2048
    ds_read_b128 v[40:43], v16 offset:3072
    s_waitcnt lgkmcnt(3)
    v_smfmac_f32_16x16x64_bf16 v[68:71], v[28:31], a[0:7], v17
    ds_read_b128 v[44:47], v16 offset:4096
    v_smfmac_f32_16x16x64_bf16 v[72:75], v[28:31], a[80:87], v17
    ds_read_b128 v[48:51], v16 offset:5120
    s_waitcnt lgkmcnt(4)
    v_smfmac_f32_16x16x64_bf16 v[68:71], v[32:35], a[8:15], v17
    ds_read_b128 v[52:55], v16 offset:6144
    v_smfmac_f32_16x16x64_bf16 v[72:75], v[32:35], a[88:95], v17
    ds_read_b128 v[56:59], v16 offset:7168
    s_waitcnt lgkmcnt(5)
    v_smfmac_f32_16x16x64_bf16 v[68:71], v[36:39], a[16:23], v17
    ds_read_b128 v[60:63], v16 offset:8192
    s_waitcnt lgkmcnt(5)
    v_smfmac_f32_16x16x64_bf16 v[68:71], v[40:43], a[24:31], v17
    ds_read_b128 v[64:67], v16 offset:9216
    s_waitcnt lgkmcnt(5)
    v_smfmac_f32_16x16x64_bf16 v[68:71], v[44:47], a[32:39], v17
    s_waitcnt lgkmcnt(4)
    v_smfmac_f32_16x16x64_bf16 v[68:71], v[48:51], a[40:47], v17
    s_waitcnt lgkmcnt(3)
    v_smfmac_f32_16x16x64_bf16 v[68:71], v[52:55], a[48:55], v17
    s_waitcnt lgkmcnt(2)
    v_smfmac_f32_16x16x64_bf16 v[68:71], v[56:59], a[56:63], v17
    s_waitcnt lgkmcnt(1)
    v_smfmac_f32_16x16x64_bf16 v[68:71], v[60:63], a[64:71], v17
    buffer_store_dword v20, v21, s[4:7], s38 offen offset:0 sc1
    s_waitcnt lgkmcnt(0)
    v_smfmac_f32_16x16x64_bf16 v[68:71], v[64:67], a[72:79], v17
L_redo_65:
    v_smfmac_f32_16x16x64_bf16 v[72:75], v[36:39], a[96:103], v17
    v_smfmac_f32_16x16x64_bf16 v[72:75], v[40:43], a[104:111], v17
    v_smfmac_f32_16x16x64_bf16 v[72:75], v[44:47], a[112:119], v17
    v_add_f32 v68, v68, v70
    v_add_f32 v69, v69, v71
    v_smfmac_f32_16x16x64_bf16 v[72:75], v[48:51], a[120:127], v17
    v_cvt_pk_bf16_f32 v132, v68, v69
    ds_write_b32 v23, v132
    v_smfmac_f32_16x16x64_bf16 v[72:75], v[52:55], a[128:135], v17
    v_cmp_u_f32 vcc, v68, v69
    v_smfmac_f32_16x16x64_bf16 v[72:75], v[56:59], a[136:143], v17
    v_smfmac_f32_16x16x64_bf16 v[72:75], v[60:63], a[144:151], v17
    s_cbranch_vccnz L_nan_67
L_cont_68:
    v_smfmac_f32_16x16x64_bf16 v[72:75], v[64:67], a[152:159], v17
    s_waitcnt lgkmcnt(0)
    s_barrier
    ds_read_b64_tr_b16 v[76:77], v24 offset:0
    ds_read_b64_tr_b16 v[78:79], v134 offset:0
    ds_read_b64_tr_b16 v[80:81], v24 offset:1024
    ds_read_b64_tr_b16 v[82:83], v134 offset:1024
    s_cmp_eq_u32 s32, 0
    s_cbranch_scc1 L_w0_69
    s_cmp_eq_u32 s32, 3
    s_cbranch_scc1 L_w3_70
    v_pk_add_f32 v[72:73], v[72:73], v[74:75]
    v_cvt_pk_bf16_f32 v133, v72, v73
    ds_write_b32 v23, v133 offset:4
    s_waitcnt lgkmcnt(3)
    v_mfma_f32_16x16x32_bf16 v[164:167], v[156:159], v[76:79], 0
    s_waitcnt lgkmcnt(1)
    v_mfma_f32_16x16x32_bf16 v[164:167], v[160:163], v[80:83], v[164:167]
    s_waitcnt lgkmcnt(0)
    s_barrier
    s_nop 5
    buffer_store_dwordx4 v[164:167], v135, s[4:7], s41 offen sc1
    ds_read_b128 v[84:87], v11 offset:0
    ds_read_b128 v[88:91], v11 offset:2048
    ds_read_b128 v[92:95], v12 offset:0
    ds_read_b128 v[96:99], v12 offset:2048
    s_branch L_join_71
L_w0_69:
    v_pk_add_f32 v[72:73], v[72:73], v[74:75]
    v_cvt_pk_bf16_f32 v133, v72, v73
    ds_write_b32 v23, v133 offset:4
    s_waitcnt lgkmcnt(0)
    s_barrier
    ds_read_b64_tr_b16 v[76:77], v24 offset:0
    ds_read_b64_tr_b16 v[78:79], v134 offset:0
    ds_read_b64_tr_b16 v[80:81], v24 offset:1024
    ds_read_b64_tr_b16 v[82:83], v134 offset:1024
    s_waitcnt lgkmcnt(2)
    v_mfma_f32_16x16x32_bf16 v[164:167], v[76:79], v[76:79], 0
    s_waitcnt lgkmcnt(0)
    v_mfma_f32_16x16x32_bf16 v[164:167], v[80:83], v[80:83], v[164:167]
    ds_read_b128 v[84:87], v11 offset:0
    ds_read_b128 v[88:91], v11 offset:2048
    ds_read_b128 v[92:95], v12 offset:0
    ds_read_b128 v[96:99], v12 offset:2048
    s_nop 3
    buffer_store_dword v166, v135, s[4:7], s41 offen sc1
    buffer_store_dword v167, v135, s[4:7], s41 offen offset:8 sc1
    s_branch L_join_71
L_w3_70:
    v_pk_add_f32 v[72:73], v[72:73], v[74:75]
    v_cvt_pk_bf16_f32 v133, v72, v73
    ds_write_b32 v23, v133 offset:4
    s_waitcnt lgkmcnt(0)
    s_barrier
    ds_read_b64_tr_b16 v[76:77], v24 offset:0
    ds_read_b64_tr_b16 v[78:79], v134 offset:0
    ds_read_b64_tr_b16 v[80:81], v24 offset:1024
    ds_read_b64_tr_b16 v[82:83], v134 offset:1024
    buffer_store_dword v20, v21, s[4:7], s38 offen offset:32 sc1
    s_waitcnt lgkmcnt(0)
    ds_read_b128 v[84:87], v11 offset:0
    ds_read_b128 v[88:91], v11 offset:2048
    ds_read_b128 v[92:95], v12 offset:0
    ds_read_b128 v[96:99], v12 offset:2048
    s_waitcnt lgkmcnt(0)
    buffer_store_dwordx4 v[76:79], v136, s[4:7], s43 offen sc1
    buffer_store_dwordx4 v[80:83], v136, s[4:7], s43 offen offset:512 sc1
L_join_71:
    s_cmp_eq_u32 s37, 63
    s_cbranch_scc1 L_end_72
    s_lshl_b32 s90, s32, 10
    s_add_u32 m0, s90, s47
    s_waitcnt lgkmcnt(2)
    v_mfma_f32_16x16x32_bf16 v[108:111], a[0:3], v[84:87], 0
    ds_read_b128 v[100:103], v11 offset:4096
    s_and_b32 s50, s37, 3
    v_mfma_f32_16x16x32_bf16 v[112:115], a[0:3], v[88:91], 0
    ds_read_b128 v[104:107], v11 offset:6144
    s_mul_i32 s53, s50, 327680
    v_mfma_f32_16x16x32_bf16 v[116:119], a[80:83], v[84:87], 0
    s_add_u32 s51, s37, 2
    s_and_b32 s50, s51, 3
    v_mfma_f32_16x16x32_bf16 v[120:123], a[80:83], v[88:91], 0
    s_waitcnt lgkmcnt(2)
    s_mul_i32 s50, s50, 98304
    v_mfma_f32_16x16x32_bf16 v[108:111], a[4:7], v[92:95], v[108:111]
    ds_read_b128 v[84:87], v12 offset:4096
    s_add_u32 s50, s50, 475136
    v_mfma_f32_16x16x32_bf16 v[112:115], a[4:7], v[96:99], v[112:115]
    ds_read_b128 v[88:91], v12 offset:6144
    s_add_u32 s44, s38, s50
    v_mfma_f32_16x16x32_bf16 v[116:119], a[84:87], v[92:95], v[116:119]
    s_add_u32 s45, s44, s56
    s_and_b32 s50, s51, 3
    v_mfma_f32_16x16x32_bf16 v[120:123], a[84:87], v[96:99], v[120:123]
    s_waitcnt lgkmcnt(2)
    s_lshl_b32 s50, s50, 12
    v_mfma_f32_16x16x32_bf16 v[108:111], a[8:11], v[100:103], v[108:111]
    ds_read_b128 v[92:95], v11 offset:8192
    v_add_u32 v140, s50, v137
    v_mfma_f32_16x16x32_bf16 v[112:115], a[8:11], v[104:107], v[112:115]
    ds_read_b128 v[96:99], v11 offset:10240
    s_add_u32 s37, s37, 1
    v_mfma_f32_16x16x32_bf16 v[116:119], a[88:91], v[100:103], v[116:119]
    s_mov_b32 s52, 0
    s_and_b32 s50, s37, 3
    v_mfma_f32_16x16x32_bf16 v[120:123], a[88:91], v[104:107], v[120:123]
    s_waitcnt lgkmcnt(2)
    s_mul_i32 s51, s50, 114688
    v_mfma_f32_16x16x32_bf16 v[108:111], a[12:15], v[84:87], v[108:111]
    ds_read_b128 v[100:103], v12 offset:8192
    s_add_u32 s41, s38, s51
    v_mfma_f32_16x16x32_bf16 v[112:115], a[12:15], v[88:91], v[112:115]
    ds_read_b128 v[104:107], v12 offset:10240
    s_and_b32 s54, s37, s55
    v_mfma_f32_16x16x32_bf16 v[116:119], a[92:95], v[84:87], v[116:119]
    buffer_store_dword v22, v150, s[4:7], s42 offen offset:0 sc1
    buffer_store_dword v22, v149, s[4:7], s42 offen offset:0 sc1
    v_mfma_f32_16x16x32_bf16 v[120:123], a[92:95], v[88:91], v[120:123]
    s_waitcnt lgkmcnt(2)
    s_lshl_b32 s50, s50, 12
    v_mfma_f32_16x16x32_bf16 v[108:111], a[16:19], v[92:95], v[108:111]
    ds_read_b128 v[84:87], v11 offset:12288
    v_add_u32 v141, s50, v138
    v_mfma_f32_16x16x32_bf16 v[112:115], a[16:19], v[96:99], v[112:115]
    ds_read_b128 v[88:91], v11 offset:14336
    s_add_u32 s43, s41, 40960
    v_mfma_f32_16x16x32_bf16 v[116:119], a[96:99], v[92:95], v[116:119]
    buffer_store_dword v22, v150, s[4:7], s42 offen offset:256 sc1
    v_mfma_f32_16x16x32_bf16 v[120:123], a[96:99], v[96:99], v[120:123]
    s_waitcnt lgkmcnt(2)
    v_mfma_f32_16x16x32_bf16 v[108:111], a[20:23], v[100:103], v[108:111]
    ds_read_b128 v[92:95], v12 offset:12288
    v_mfma_f32_16x16x32_bf16 v[112:115], a[20:23], v[104:107], v[112:115]
    ds_read_b128 v[96:99], v12 offset:14336
    v_mfma_f32_16x16x32_bf16 v[116:119], a[100:103], v[100:103], v[116:119]
    buffer_load_dwordx4 v10, s[24:27], s46 offen offset:0 lds
    s_add_u32 m0, m0, 3968
    v_mfma_f32_16x16x32_bf16 v[120:123], a[100:103], v[104:107], v[120:123]
    s_waitcnt lgkmcnt(2)
    v_mfma_f32_16x16x32_bf16 v[108:111], a[24:27], v[84:87], v[108:111]
    ds_read_b128 v[100:103], v11 offset:16384
    v_mfma_f32_16x16x32_bf16 v[112:115], a[24:27], v[88:91], v[112:115]
    ds_read_b128 v[104:107], v11 offset:18432
    v_mfma_f32_16x16x32_bf16 v[116:119], a[104:107], v[84:87], v[116:119]
    buffer_load_dwordx4 v10, s[24:27], s46 offen offset:128 lds
    s_add_u32 m0, m0, 3968
    v_mfma_f32_16x16x32_bf16 v[120:123], a[104:107], v[88:91], v[120:123]
    s_waitcnt lgkmcnt(2)
    v_mfma_f32_16x16x32_bf16 v[108:111], a[28:31], v[92:95], v[108:111]
    ds_read_b128 v[84:87], v12 offset:16384
    v_mfma_f32_16x16x32_bf16 v[112:115], a[28:31], v[96:99], v[112:115]
    ds_read_b128 v[88:91], v12 offset:18432
    v_mfma_f32_16x16x32_bf16 v[116:119], a[108:111], v[92:95], v[116:119]
    buffer_load_dwordx4 v10, s[24:27], s46 offen offset:256 lds
    s_add_u32 m0, m0, 3968
    v_mfma_f32_16x16x32_bf16 v[120:123], a[108:111], v[96:99], v[120:123]
    s_waitcnt lgkmcnt(2)
    v_mfma_f32_16x16x32_bf16 v[108:111], a[32:35], v[100:103], v[108:111]
    ds_read_b128 v[92:95], v11 offset:20480
    v_mfma_f32_16x16x32_bf16 v[112:115], a[32:35], v[104:107], v[112:115]
    ds_read_b128 v[96:99], v11 offset:22528
    v_mfma_f32_16x16x32_bf16 v[116:119], a[112:115], v[100:103], v[116:119]
    s_waitcnt vmcnt(6)
    buffer_store_dword v20, v139, s[4:7], s38 offen sc1
    v_mfma_f32_16x16x32_bf16 v[120:123], a[112:115], v[104:107], v[120:123]
    s_waitcnt lgkmcnt(2)
    v_mfma_f32_16x16x32_bf16 v[108:111], a[36:39], v[84:87], v[108:111]
    ds_read_b128 v[100:103], v12 offset:20480
    v_mfma_f32_16x16x32_bf16 v[112:115], a[36:39], v[88:91], v[112:115]
    buffer_load_dword v147, v146, s[4:7], 0 offen sc1
    ds_read_b128 v[104:107], v12 offset:22528
    v_mfma_f32_16x16x32_bf16 v[116:119], a[116:119], v[84:87], v[116:119]
    buffer_load_dwordx4 v10, s[24:27], s46 offen offset:384 lds
    s_add_u32 m0, m0, 3968
    v_mfma_f32_16x16x32_bf16 v[120:123], a[116:119], v[88:91], v[120:123]
    s_waitcnt lgkmcnt(2)
    v_mfma_f32_16x16x32_bf16 v[108:111], a[40:43], v[92:95], v[108:111]
    ds_read_b128 v[84:87], v11 offset:24576
    v_mfma_f32_16x16x32_bf16 v[112:115], a[40:43], v[96:99], v[112:115]
    buffer_load_dword v147, v146, s[4:7], 0 offen sc1
    ds_read_b128 v[88:91], v11 offset:26624
    v_mfma_f32_16x16x32_bf16 v[116:119], a[120:123], v[92:95], v[116:119]
    buffer_load_dwordx4 v10, s[24:27], s46 offen offset:512 lds
    s_add_u32 m0, m0, 3968
    v_mfma_f32_16x16x32_bf16 v[120:123], a[120:123], v[96:99], v[120:123]
    s_waitcnt lgkmcnt(2)
    v_mfma_f32_16x16x32_bf16 v[108:111], a[44:47], v[100:103], v[108:111]
    ds_read_b128 v[92:95], v12 offset:24576
    v_mfma_f32_16x16x32_bf16 v[112:115], a[44:47], v[104:107], v[112:115]
    buffer_load_dword v147, v146, s[4:7], 0 offen sc1
    ds_read_b128 v[96:99], v12 offset:26624
    v_mfma_f32_16x16x32_bf16 v[116:119], a[124:127], v[100:103], v[116:119]
    buffer_load_dwordx4 v10, s[24:27], s46 offen offset:640 lds
    s_add_u32 m0, m0, 3968
    v_mfma_f32_16x16x32_bf16 v[120:123], a[124:127], v[104:107], v[120:123]
    s_waitcnt lgkmcnt(2)
    v_mfma_f32_16x16x32_bf16 v[108:111], a[48:51], v[84:87], v[108:111]
    ds_read_b128 v[100:103], v11 offset:28672
    v_mfma_f32_16x16x32_bf16 v[112:115], a[48:51], v[88:91], v[112:115]
    buffer_load_dword v147, v146, s[4:7], 0 offen sc1
    ds_read_b128 v[104:107], v11 offset:30720
    v_mfma_f32_16x16x32_bf16 v[116:119], a[128:131], v[84:87], v[116:119]
    buffer_load_dwordx4 v10, s[24:27], s46 offen offset:768 lds
    s_add_u32 m0, m0, 3968
    v_mfma_f32_16x16x32_bf16 v[120:123], a[128:131], v[88:91], v[120:123]
    s_waitcnt lgkmcnt(2)
    v_mfma_f32_16x16x32_bf16 v[108:111], a[52:55], v[92:95], v[108:111]
    ds_read_b128 v[84:87], v12 offset:28672
    v_mfma_f32_16x16x32_bf16 v[112:115], a[52:55], v[96:99], v[112:115]
    buffer_load_dword v147, v146, s[4:7], 0 offen sc1
    ds_read_b128 v[88:91], v12 offset:30720
    v_mfma_f32_16x16x32_bf16 v[116:119], a[132:135], v[92:95], v[116:119]
    buffer_load_dwordx4 v10, s[24:27], s46 offen offset:896 lds
    s_add_u32 m0, m0, 3968
    v_mfma_f32_16x16x32_bf16 v[120:123], a[132:135], v[96:99], v[120:123]
    s_waitcnt lgkmcnt(2)
    v_mfma_f32_16x16x32_bf16 v[108:111], a[56:59], v[100:103], v[108:111]
    ds_read_b128 v[92:95], v11 offset:32768
    v_mfma_f32_16x16x32_bf16 v[112:115], a[56:59], v[104:107], v[112:115]
    buffer_load_dword v147, v146, s[4:7], 0 offen sc1
    ds_read_b128 v[96:99], v11 offset:34816
    v_mfma_f32_16x16x32_bf16 v[116:119], a[136:139], v[100:103], v[116:119]
    buffer_load_dwordx4 v10, s[24:27], s46 offen offset:1024 lds
    s_add_u32 m0, m0, 3968
    v_mfma_f32_16x16x32_bf16 v[120:123], a[136:139], v[104:107], v[120:123]
    s_waitcnt lgkmcnt(2)
    v_mfma_f32_16x16x32_bf16 v[108:111], a[60:63], v[84:87], v[108:111]
    ds_read_b128 v[100:103], v12 offset:32768
    v_mfma_f32_16x16x32_bf16 v[112:115], a[60:63], v[88:91], v[112:115]
    buffer_load_dword v147, v146, s[4:7], 0 offen sc1
    ds_read_b128 v[104:107], v12 offset:34816
    v_mfma_f32_16x16x32_bf16 v[116:119], a[140:143], v[84:87], v[116:119]
    buffer_load_dwordx4 v10, s[24:27], s46 offen offset:1152 lds
    v_mfma_f32_16x16x32_bf16 v[120:123], a[140:143], v[88:91], v[120:123]
    s_waitcnt lgkmcnt(2)
    v_mfma_f32_16x16x32_bf16 v[108:111], a[64:67], v[92:95], v[108:111]
    ds_read_b128 v[84:87], v11 offset:36864
    v_mfma_f32_16x16x32_bf16 v[112:115], a[64:67], v[96:99], v[112:115]
L_sp_73:
    s_waitcnt vmcnt(6)
    v_cmp_gt_u32 vcc, s54, v147
    buffer_load_dword v147, v146, s[4:7], 0 offen sc1
    s_sub_u32 s36, s36, 1
    s_cbranch_scc1 L_exit
    s_cbranch_vccz L_sp_73x
    s_waitcnt vmcnt(6)
    v_cmp_gt_u32 vcc, s54, v147
    buffer_load_dword v147, v146, s[4:7], 0 offen sc1
    s_cbranch_vccz L_sp_73x
    s_waitcnt vmcnt(6)
    v_cmp_gt_u32 vcc, s54, v147
    buffer_load_dword v147, v146, s[4:7], 0 offen sc1
    s_cbranch_vccz L_sp_73x
    s_waitcnt vmcnt(6)
    v_cmp_gt_u32 vcc, s54, v147
    buffer_load_dword v147, v146, s[4:7], 0 offen sc1
    s_cbranch_vccnz L_sp_73
L_sp_73x:
    s_barrier
    buffer_load_dwordx4 v[168:171], v142, s[4:7], s53 offen sc1
    ds_read_b128 v[88:91], v11 offset:38912
    v_mfma_f32_16x16x32_bf16 v[116:119], a[144:147], v[92:95], v[116:119]
    v_mfma_f32_16x16x32_bf16 v[120:123], a[144:147], v[96:99], v[120:123]
    s_waitcnt lgkmcnt(2)
    v_mfma_f32_16x16x32_bf16 v[108:111], a[68:71], v[100:103], v[108:111]
    ds_read_b128 v[92:95], v12 offset:36864
    v_mfma_f32_16x16x32_bf16 v[112:115], a[68:71], v[104:107], v[112:115]
    ds_read_b128 v[96:99], v12 offset:38912
    v_mfma_f32_16x16x32_bf16 v[116:119], a[148:151], v[100:103], v[116:119]
    v_mfma_f32_16x16x32_bf16 v[120:123], a[148:151], v[104:107], v[120:123]
    buffer_load_dwordx4 v[172:175], v143, s[4:7], s53 offen sc1
    s_waitcnt lgkmcnt(0)
    v_mfma_f32_16x16x32_bf16 v[108:111], a[72:75], v[84:87], v[108:111]
    v_add_u32 v11, s49, v11
    v_mfma_f32_16x16x32_bf16 v[112:115], a[72:75], v[88:91], v[112:115]
    v_add_u32 v12, s49, v12
    v_mfma_f32_16x16x32_bf16 v[108:111], a[76:79], v[92:95], v[108:111]
    s_sub_u32 s47, s47, s49
    v_mfma_f32_16x16x32_bf16 v[112:115], a[76:79], v[96:99], v[112:115]
    s_sub_u32 s49, 0, s49
    v_mfma_f32_16x16x32_bf16 v[116:119], a[152:155], v[84:87], v[116:119]
    v_mfma_f32_16x16x32_bf16 v[120:123], a[152:155], v[88:91], v[120:123]
    v_mfma_f32_16x16x32_bf16 v[116:119], a[156:159], v[92:95], v[116:119]
    v_mfma_f32_16x16x32_bf16 v[120:123], a[156:159], v[96:99], v[120:123]
    v_cvt_pk_bf16_f32 v124, v108, v109
    v_cvt_pk_bf16_f32 v125, v110, v111
    v_cvt_pk_bf16_f32 v126, v112, v113
    v_cvt_pk_bf16_f32 v127, v114, v115
    s_nop 0
    v_permlane16_swap_b32 v124, v126
    v_permlane16_swap_b32 v125, v127
    v_cvt_pk_bf16_f32 v128, v116, v117
    v_cvt_pk_bf16_f32 v129, v118, v119
    v_cvt_pk_bf16_f32 v130, v120, v121
    v_cvt_pk_bf16_f32 v131, v122, v123
    s_nop 0
    v_permlane16_swap_b32 v128, v130
    v_permlane16_swap_b32 v129, v131
    ds_write_b128 v140, v[128:131]
    buffer_store_dwordx4 v[124:127], v19, s[4:7], s44 offen sc1
    buffer_store_dwordx4 v[128:131], v19, s[4:7], s45 offen sc1
    s_mov_b32 m0, s48
    s_waitcnt vmcnt(3)
    v_mfma_f32_16x16x32_bf16 v[184:187], v[198:201], v[168:171], 0
    v_mfma_f32_16x16x32_bf16 v[188:191], v[196:199], v[168:171], 0
    s_waitcnt vmcnt(2)
    v_mfma_f32_16x16x32_bf16 v[184:187], v[198:201], v[172:175], v[184:187]
    v_mfma_f32_16x16x32_bf16 v[188:191], v[196:199], v[172:175], v[188:191]
    s_nop 4
    v_cmp_u_f32 vcc, v184, v184
    v_cvt_pk_bf16_f32 v192, v184, v185
    v_cvt_pk_bf16_f32 v193, v186, v187
    v_cvt_pk_bf16_f32 v194, v188, v189
    v_cvt_pk_bf16_f32 v195, v190, v191
    s_cbranch_vccnz L_pp_74
L_pc_75:
    buffer_store_dwordx4 v[192:195], v148, s[4:7], s41 offen sc1
    s_barrier
    s_branch L_qkv_loop_s
L_end_72:
    s_waitcnt vmcnt(0) lgkmcnt(0)
    buffer_store_dword v20, v139, s[4:7], s38 offen sc1
    s_endpgm
L_nan_67:
    s_cmp_eq_u32 s52, 1
    s_cbranch_scc1 L_cont_68
    v_lshlrev_b32 v1, 4, v0
L_nan_67r:
    s_mov_b32 s90, s41
    v_mov_b32 v2, 0
    buffer_load_dwordx4 v[28:31], v1, s[4:7], s90 offen sc1
    s_add_u32 s90, s90, 1024
    buffer_load_dwordx4 v[32:35], v1, s[4:7], s90 offen sc1
    s_add_u32 s90, s90, 1024
    buffer_load_dwordx4 v[36:39], v1, s[4:7], s90 offen sc1
    s_add_u32 s90, s90, 1024
    buffer_load_dwordx4 v[40:43], v1, s[4:7], s90 offen sc1
    s_add_u32 s90, s90, 1024
    buffer_load_dwordx4 v[44:47], v1, s[4:7], s90 offen sc1
    s_add_u32 s90, s90, 1024
    buffer_load_dwordx4 v[48:51], v1, s[4:7], s90 offen sc1
    s_add_u32 s90, s90, 1024
    buffer_load_dwordx4 v[52:55], v1, s[4:7], s90 offen sc1
    s_add_u32 s90, s90, 1024
    buffer_load_dwordx4 v[56:59], v1, s[4:7], s90 offen sc1
    s_add_u32 s90, s90, 1024
    buffer_load_dwordx4 v[60:63], v1, s[4:7], s90 offen sc1
    s_add_u32 s90, s90, 1024
    buffer_load_dwordx4 v[64:67], v1, s[4:7], s90 offen sc1
    s_add_u32 s90, s90, 1024
    s_sub_u32 s36, s36, 1
    s_cbranch_scc1 L_exit
    s_waitcnt vmcnt(0) lgkmcnt(0)
    v_max3_u32 v2, v2, v28, v29
    v_max3_u32 v2, v2, v30, v31
    v_max3_u32 v2, v2, v32, v33
    v_max3_u32 v2, v2, v34, v35
    v_max3_u32 v2, v2, v36, v37
    v_max3_u32 v2, v2, v38, v39
    v_max3_u32 v2, v2, v40, v41
    v_max3_u32 v2, v2, v42, v43
    v_max3_u32 v2, v2, v44, v45
    v_max3_u32 v2, v2, v46, v47
    v_max3_u32 v2, v2, v48, v49
    v_max3_u32 v2, v2, v50, v51
    v_max3_u32 v2, v2, v52, v53
    v_max3_u32 v2, v2, v54, v55
    v_max3_u32 v2, v2, v56, v57
    v_max3_u32 v2, v2, v58, v59
    v_max3_u32 v2, v2, v60, v61
    v_max3_u32 v2, v2, v62, v63
    v_max3_u32 v2, v2, v64, v65
    v_max3_u32 v2, v2, v66, v67
    v_cmp_eq_u32 vcc, -1, v2
    s_cbranch_vccnz L_nan_67r
    s_mov_b32 s52, 1
    v_mov_b32 v68, 0
    v_mov_b32 v69, 0
    v_mov_b32 v70, 0
    v_mov_b32 v71, 0
    v_mov_b32 v72, 0
    v_mov_b32 v73, 0
    v_mov_b32 v74, 0
    v_mov_b32 v75, 0
    v_smfmac_f32_16x16x64_bf16 v[68:71], v[28:31], a[0:7], v17
    s_nop 0
    v_smfmac_f32_16x16x64_bf16 v[72:75], v[28:31], a[80:87], v17
    v_smfmac_f32_16x16x64_bf16 v[68:71], v[32:35], a[8:15], v17
    v_smfmac_f32_16x16x64_bf16 v[72:75], v[32:35], a[88:95], v17
    v_smfmac_f32_16x16x64_bf16 v[68:71], v[36:39], a[16:23], v17
    v_smfmac_f32_16x16x64_bf16 v[68:71], v[40:43], a[24:31], v17
    v_smfmac_f32_16x16x64_bf16 v[68:71], v[44:47], a[32:39], v17
    v_smfmac_f32_16x16x64_bf16 v[68:71], v[48:51], a[40:47], v17
    v_smfmac_f32_16x16x64_bf16 v[68:71], v[52:55], a[48:55], v17
    v_smfmac_f32_16x16x64_bf16 v[68:71], v[56:59], a[56:63], v17
    v_smfmac_f32_16x16x64_bf16 v[68:71], v[60:63], a[64:71], v17
    v_smfmac_f32_16x16x64_bf16 v[68:71], v[64:67], a[72:79], v17
    s_nop 3
    s_branch L_redo_65
L_pp_74:
    buffer_load_dwordx4 v[176:179], v144, s[4:7], s53 offen sc1
    buffer_load_dwordx4 v[180:183], v145, s[4:7], s53 offen sc1
    s_sub_u32 s36, s36, 1
    s_cbranch_scc1 L_exit
    v_max_u32 v151, v168, v169
    v_max3_u32 v151, v151, v170, v171
    v_max3_u32 v151, v151, v172, v173
    v_max3_u32 v151, v151, v174, v175
    v_cmp_eq_u32 vcc, -1, v151
    s_cbranch_vccz L_pc_75
    s_waitcnt vmcnt(1)
    v_mfma_f32_16x16x32_bf16 v[184:187], v[198:201], v[176:179], 0
    v_mfma_f32_16x16x32_bf16 v[188:191], v[196:199], v[176:179], 0
    s_waitcnt vmcnt(0)
    v_mfma_f32_16x16x32_bf16 v[184:187], v[198:201], v[180:183], v[184:187]
    v_mfma_f32_16x16x32_bf16 v[188:191], v[196:199], v[180:183], v[188:191]
    s_nop 4
    v_cmp_u_f32 vcc, v184, v184
    v_cvt_pk_bf16_f32 v192, v184, v185
    v_cvt_pk_bf16_f32 v193, v186, v187
    v_cvt_pk_bf16_f32 v194, v188, v189
    v_cvt_pk_bf16_f32 v195, v190, v191
    s_cbranch_vccnz L_pp_74_1
    s_branch L_pc_75
L_pp_74_1:
    buffer_load_dwordx4 v[168:171], v142, s[4:7], s53 offen sc1
    buffer_load_dwordx4 v[172:175], v143, s[4:7], s53 offen sc1
    s_sub_u32 s36, s36, 1
    s_cbranch_scc1 L_exit
    v_max_u32 v151, v176, v177
    v_max3_u32 v151, v151, v178, v179
    v_max3_u32 v151, v151, v180, v181
    v_max3_u32 v151, v151, v182, v183
    v_cmp_eq_u32 vcc, -1, v151
    s_cbranch_vccz L_pc_75
    s_waitcnt vmcnt(1)
    v_mfma_f32_16x16x32_bf16 v[184:187], v[198:201], v[168:171], 0
    v_mfma_f32_16x16x32_bf16 v[188:191], v[196:199], v[168:171], 0
    s_waitcnt vmcnt(0)
    v_mfma_f32_16x16x32_bf16 v[184:187], v[198:201], v[172:175], v[184:187]
    v_mfma_f32_16x16x32_bf16 v[188:191], v[196:199], v[172:175], v[188:191]
    s_nop 4
    v_cmp_u_f32 vcc, v184, v184
    v_cvt_pk_bf16_f32 v192, v184, v185
    v_cvt_pk_bf16_f32 v193, v186, v187
    v_cvt_pk_bf16_f32 v194, v188, v189
    v_cvt_pk_bf16_f32 v195, v190, v191
    s_cbranch_vccnz L_pp_74
    s_branch L_pc_75
L_v_s:
    s_mov_b32 s12, s78
    s_and_b32 s13, s79, 0xffff
    s_mov_b32 s14, 7864320
    s_mov_b32 s15, 0x20000
    s_sub_u32 s40, s35, 12
    s_lshl_b32 s40, s40, 1
    s_mov_b32 s24, s70
    s_and_b32 s25, s71, 0xffff
    s_mov_b32 s26, 2621440
    s_mov_b32 s27, 0x20000
    v_and_b32 v1, 15, v0
    v_lshrrev_b32 v2, 4, v0
    v_lshrrev_b32 v3, 3, v0
    v_and_b32 v4, 7, v0
    s_lshl_b32 s90, s32, 3
    v_add_u32 v5, s90, v3
    s_and_b32 s91, s32, 1
    s_lshl_b32 s91, s91, 2
    v_and_b32 v6, 2, v3
    v_or_b32 v6, s91, v6
    v_xor_b32 v6, v6, v4
    v_lshlrev_b32 v6, 4, v6
    v_mul_u32_u24 v7, 12288, v5
    s_mul_i32 s92, s34, 1536
    s_lshl_b32 s93, s40, 7
    s_add_u32 s92, s92, s93
    v_add3_u32 v124, v6, v7, s92
    v_lshrrev_b32 v6, 1, v3
    v_or_b32 v6, s91, v6
    v_xor_b32 v6, v6, v4
    v_lshlrev_b32 v6, 4, v6
    v_mul_u32_u24 v7, 1280, v5
    v_add_u32 v10, v6, v7
    s_lshl_b32 s90, s32, 10
    s_add_u32 m0, s90, 81920
    s_mov_b32 s91, 0
    buffer_load_dwordx4 v124, s[12:15], s91 offen nt lds
    s_add_u32 m0, m0, 4096
    s_add_u32 s91, s91, 393216
    buffer_load_dwordx4 v124, s[12:15], s91 offen nt lds
    s_add_u32 m0, m0, 4096
    s_add_u32 s91, s91, 393216
    buffer_load_dwordx4 v124, s[12:15], s91 offen nt lds
    s_add_u32 m0, m0, 4096
    s_add_u32 s91, s91, 393216
    buffer_load_dwordx4 v124, s[12:15], s91 offen nt lds
    s_add_u32 m0, m0, 4096
    s_add_u32 s91, s91, 393216
    buffer_load_dwordx4 v124, s[12:15], s91 offen nt lds
    s_add_u32 m0, m0, 4096
    s_add_u32 s91, s91, 393216
    buffer_load_dwordx4 v124, s[12:15], s91 offen nt lds
    s_add_u32 m0, m0, 4096
    s_add_u32 s91, s91, 393216
    buffer_load_dwordx4 v124, s[12:15], s91 offen nt lds
    s_add_u32 m0, m0, 4096
    s_add_u32 s91, s91, 393216
    buffer_load_dwordx4 v124, s[12:15], s91 offen nt lds
    s_add_u32 m0, m0, 4096
    s_add_u32 s91, s91, 393216
    buffer_load_dwordx4 v124, s[12:15], s91 offen nt lds
    s_add_u32 m0, m0, 4096
    s_add_u32 s91, s91, 393216
    buffer_load_dwordx4 v124, s[12:15], s91 offen nt lds
    s_lshl_b32 s90, s32, 10
    s_add_u32 m0, s90, 40960
    s_mov_b32 s91, 128
    buffer_load_dwordx4 v124, s[12:15], s91 offen nt lds
    s_add_u32 m0, m0, 4096
    s_add_u32 s91, s91, 393216
    buffer_load_dwordx4 v124, s[12:15], s91 offen nt lds
    s_add_u32 m0, m0, 4096
    s_add_u32 s91, s91, 393216
    buffer_load_dwordx4 v124, s[12:15], s91 offen nt lds
    s_add_u32 m0, m0, 4096
    s_add_u32 s91, s91, 393216
    buffer_load_dwordx4 v124, s[12:15], s91 offen nt lds
    s_add_u32 m0, m0, 4096
    s_add_u32 s91, s91, 393216
    buffer_load_dwordx4 v124, s[12:15], s91 offen nt lds
    s_add_u32 m0, m0, 4096
    s_add_u32 s91, s91, 393216
    buffer_load_dwordx4 v124, s[12:15], s91 offen nt lds
    s_add_u32 m0, m0, 4096
    s_add_u32 s91, s91, 393216
    buffer_load_dwordx4 v124, s[12:15], s91 offen nt lds
    s_add_u32 m0, m0, 4096
    s_add_u32 s91, s91, 393216
    buffer_load_dwordx4 v124, s[12:15], s91 offen nt lds
    s_add_u32 m0, m0, 4096
    s_add_u32 s91, s91, 393216
    buffer_load_dwordx4 v124, s[12:15], s91 offen nt lds
    s_add_u32 m0, m0, 4096
    s_add_u32 s91, s91, 393216
    buffer_load_dwordx4 v124, s[12:15], s91 offen nt lds
    s_lshl_b32 s90, s32, 10
    s_add_u32 m0, s90, 122880
    s_mov_b32 s91, 3932160
    buffer_load_dwordx4 v124, s[12:15], s91 offen nt lds
    s_add_u32 m0, m0, 4096
    s_add_u32 s91, s91, 393216
    buffer_load_dwordx4 v124, s[12:15], s91 offen nt lds
    s_add_u32 m0, m0, 4096
    s_add_u32 s91, s91, 393216
    buffer_load_dwordx4 v124, s[12:15], s91 offen nt lds
    s_add_u32 m0, m0, 4096
    s_add_u32 s91, s91, 393216
    buffer_load_dwordx4 v124, s[12:15], s91 offen nt lds
    s_add_u32 m0, m0, 4096
    s_add_u32 s91, s91, 393216
    buffer_load_dwordx4 v124, s[12:15], s91 offen nt lds
    s_add_u32 m0, m0, 4096
    s_add_u32 s91, s91, 393216
    buffer_load_dwordx4 v124, s[12:15], s91 offen nt lds
    s_add_u32 m0, m0, 4096
    s_add_u32 s91, s91, 393216
    buffer_load_dwordx4 v124, s[12:15], s91 offen nt lds
    s_add_u32 m0, m0, 4096
    s_add_u32 s91, s91, 393216
    buffer_load_dwordx4 v124, s[12:15], s91 offen nt lds
    s_add_u32 m0, m0, 4096
    s_add_u32 s91, s91, 393216
    buffer_load_dwordx4 v124, s[12:15], s91 offen nt lds
    s_add_u32 m0, m0, 4096
    s_add_u32 s91, s91, 393216
    buffer_load_dwordx4 v124, s[12:15], s91 offen nt lds
    s_mov_b32 s46, 0
    s_lshl_b32 s90, s32, 10
    s_add_u32 m0, s90, 0
    s_nop 0
    buffer_load_dwordx4 v10, s[24:27], s46 offen offset:0 lds
    s_add_u32 m0, m0, 3968
    s_nop 0
    buffer_load_dwordx4 v10, s[24:27], s46 offen offset:128 lds
    s_add_u32 m0, m0, 3968
    s_nop 0
    buffer_load_dwordx4 v10, s[24:27], s46 offen offset:256 lds
    s_add_u32 m0, m0, 3968
    s_nop 0
    buffer_load_dwordx4 v10, s[24:27], s46 offen offset:384 lds
    s_add_u32 m0, m0, 3968
    s_nop 0
    buffer_load_dwordx4 v10, s[24:27], s46 offen offset:512 lds
    s_add_u32 m0, m0, 3968
    s_nop 0
    buffer_load_dwordx4 v10, s[24:27], s46 offen offset:640 lds
    s_add_u32 m0, m0, 3968
    s_nop 0
    buffer_load_dwordx4 v10, s[24:27], s46 offen offset:768 lds
    s_add_u32 m0, m0, 3968
    s_nop 0
    buffer_load_dwordx4 v10, s[24:27], s46 offen offset:896 lds
    s_add_u32 m0, m0, 3968
    s_nop 0
    buffer_load_dwordx4 v10, s[24:27], s46 offen offset:1024 lds
    s_add_u32 m0, m0, 3968
    s_nop 0
    buffer_load_dwordx4 v10, s[24:27], s46 offen offset:1152 lds
    s_lshl_b32 s93, s40, 1
    s_add_u32 s93, s93, s32
    s_mul_i32 s93, s93, 7168
    s_add_u32 s93, s93, 884736
    s_add_u32 s61, s93, s38
    s_mul_i32 s60, s40, 86
    s_lshr_b32 s60, s60, 8
    s_mul_i32 s59, s60, 3
    s_sub_u32 s59, s40, s59
    s_add_u32 s90, s40, 1
    s_mul_i32 s62, s90, 86
    s_lshr_b32 s62, s62, 8
    s_mul_i32 s63, s62, 3
    s_sub_u32 s63, s90, s63
    v_lshrrev_b32 v3, 1, v2
    v_and_b32 v5, 1, v2
    s_lshl_b32 s90, s32, 9
    v_lshlrev_b32 v6, 4, v1
    v_lshl_add_u32 v6, v3, 8, v6
    v_add_u32 v6, s90, v6
    s_mul_i32 s90, s60, 12288
    s_lshl_b32 s91, s59, 11
    s_add_u32 s90, s90, s91
    v_mul_u32_u24 v7, 6144, v5
    v_add3_u32 v19, v6, v7, s90
    v_mov_b32 v22, -1
    s_mul_i32 s56, s62, 12288
    s_lshl_b32 s91, s63, 11
    s_add_u32 s56, s56, s91
    s_sub_u32 s56, s56, s90
    s_lshl_b32 s90, s40, 10
    s_lshl_b32 s91, s32, 8
    s_add_u32 s91, s91, s90
    s_add_u32 s91, s91, 25600
    v_lshl_add_u32 v135, v0, 2, s91
    v_and_b32 v6, 60, v0
    v_bfe_u32 v7, v0, 1, 1
    v_or_b32 v6, v6, v7
    v_and_b32 v7, 1, v0
    v_lshl_or_b32 v6, v7, 1, v6
    s_and_b32 s90, s32, 1
    s_lshl_b32 s90, s90, 3
    v_xor_b32 v6, s90, v6
    v_lshl_add_u32 v134, v6, 2, s91
    s_lshl_b32 s90, s60, 5
    s_lshl_b32 s91, s62, 5
    v_mov_b32 v3, s90
    v_mov_b32 v4, s91
    v_mov_b32 v6, s59
    v_mov_b32 v7, s63
    v_cmp_eq_u32 vcc, 0, v0
    s_nop 1
    v_cndmask_b32 v3, v4, v3, vcc
    v_cndmask_b32 v6, v7, v6, vcc
    v_add_u32 v4, v3, v6
    s_cmp_eq_u32 s32, 3
    s_cselect_b32 s91, 0, 2146435072
    s_add_u32 s91, s91, 462348
    v_lshl_add_u32 v21, v4, 2, s91
    v_lshl_add_u32 v4, v6, 2, v3
    s_lshl_b32 s91, s32, 2
    s_add_u32 s91, s91, 458752
    v_lshl_add_u32 v136, v4, 2, s91
    v_cmp_gt_u32 vcc, 2, v0
    v_mov_b32 v9, 2146435072
    s_nop 0
    v_cndmask_b32 v21, v9, v21, vcc
    v_cndmask_b32 v136, v9, v136, vcc
    s_lshl_b32 s90, s40, 1
    s_add_u32 s90, s90, s32
    s_sub_u32 s90, s90, 4
    s_lshl_b32 s90, s90, 11
    s_cmp_eq_u32 s40, 0
    s_cselect_b32 s90, 2146435072, s90
    v_lshl_add_u32 v137, v0, 4, s90
    v_mov_b32 v138, 460800
    v_lshrrev_b32 v3, 2, v1
    v_and_b32 v4, 3, v1
    v_and_b32 v5, 1, v2
    v_lshl_add_u32 v6, v2, 3, v3
    v_lshlrev_b32 v6, 7, v6
    v_and_b32 v7, 2, v3
    v_lshl_or_b32 v7, v5, 2, v7
    v_lshrrev_b32 v8, 1, v4
    s_lshl_b32 s90, s32, 1
    v_or_b32 v8, s90, v8
    v_xor_b32 v7, v7, v8
    v_lshl_add_u32 v6, v7, 4, v6
    v_and_b32 v7, 1, v4
    v_lshl_add_u32 v6, v7, 3, v6
    v_add_u32 v125, 81920, v6
    v_add_u32 v126, 40960, v6
    v_add_u32 v127, 122880, v6
    s_lshl_b32 s90, s32, 9
    s_add_u32 s90, s90, 133120
    v_and_b32 v7, 2, v1
    v_cmp_ne_u32 vcc, 0, v7
    v_mov_b32 v6, 0x4444
    v_mov_b32 v8, 0xeeee
    v_cndmask_b32 v17, v6, v8, vcc
    v_lshlrev_b32 v6, 4, v0
    v_add_u32 v16, 122880, v6
    s_mul_i32 s90, s32, 2560
    v_lshl_add_u32 v13, v0, 4, s90
    v_lshl_add_u32 v14, v0, 2, s90
    s_add_u32 s48, s90, 122880
    v_mul_u32_u24 v6, 40, v0
    v_add_u32 v15, s48, v6
    v_mul_u32_u24 v6, 164, v0
    v_min_u32 v6, 10236, v6
    v_add_u32 v25, 122880, v6
    v_lshrrev_b32 v6, 3, v1
    v_lshlrev_b32 v6, 10, v6
    v_and_b32 v7, 7, v1
    v_lshl_add_u32 v6, v7, 7, v6
    v_lshrrev_b32 v7, 1, v1
    v_xor_b32 v7, v7, v2
    v_lshl_add_u32 v11, v7, 4, v6
    v_xor_b32 v12, 64, v11
    s_waitcnt vmcnt(30)
    s_barrier
    ds_read_b64_tr_b16 a[0:1], v125 offset:0
    ds_read_b64_tr_b16 a[2:3], v125 offset:512
    ds_read_b64_tr_b16 a[4:5], v125 offset:4096
    ds_read_b64_tr_b16 a[6:7], v125 offset:4608
    ds_read_b64_tr_b16 a[8:9], v125 offset:8192
    ds_read_b64_tr_b16 a[10:11], v125 offset:8704
    ds_read_b64_tr_b16 a[12:13], v125 offset:12288
    ds_read_b64_tr_b16 a[14:15], v125 offset:12800
    ds_read_b64_tr_b16 a[16:17], v125 offset:16384
    ds_read_b64_tr_b16 a[18:19], v125 offset:16896
    ds_read_b64_tr_b16 a[20:21], v125 offset:20480
    ds_read_b64_tr_b16 a[22:23], v125 offset:20992
    ds_read_b64_tr_b16 a[24:25], v125 offset:24576
    ds_read_b64_tr_b16 a[26:27], v125 offset:25088
    ds_read_b64_tr_b16 a[28:29], v125 offset:28672
    ds_read_b64_tr_b16 a[30:31], v125 offset:29184
    ds_read_b64_tr_b16 a[32:33], v125 offset:32768
    ds_read_b64_tr_b16 a[34:35], v125 offset:33280
    ds_read_b64_tr_b16 a[36:37], v125 offset:36864
    ds_read_b64_tr_b16 a[38:39], v125 offset:37376
    s_waitcnt lgkmcnt(0)
    s_barrier
    s_lshl_b32 s90, s32, 10
    s_add_u32 m0, s90, 81920
    s_mov_b32 s91, 3932288
    buffer_load_dwordx4 v124, s[12:15], s91 offen nt lds
    s_add_u32 m0, m0, 4096
    s_add_u32 s91, s91, 393216
    buffer_load_dwordx4 v124, s[12:15], s91 offen nt lds
    s_add_u32 m0, m0, 4096
    s_add_u32 s91, s91, 393216
    buffer_load_dwordx4 v124, s[12:15], s91 offen nt lds
    s_add_u32 m0, m0, 4096
    s_add_u32 s91, s91, 393216
    buffer_load_dwordx4 v124, s[12:15], s91 offen nt lds
    s_add_u32 m0, m0, 4096
    s_add_u32 s91, s91, 393216
    buffer_load_dwordx4 v124, s[12:15], s91 offen nt lds
    s_add_u32 m0, m0, 4096
    s_add_u32 s91, s91, 393216
    buffer_load_dwordx4 v124, s[12:15], s91 offen nt lds
    s_add_u32 m0, m0, 4096
    s_add_u32 s91, s91, 393216
    buffer_load_dwordx4 v124, s[12:15], s91 offen nt lds
    s_add_u32 m0, m0, 4096
    s_add_u32 s91, s91, 393216
    buffer_load_dwordx4 v124, s[12:15], s91 offen nt lds
    s_add_u32 m0, m0, 4096
    s_add_u32 s91, s91, 393216
    buffer_load_dwordx4 v124, s[12:15], s91 offen nt lds
    s_add_u32 m0, m0, 4096
    s_add_u32 s91, s91, 393216
    buffer_load_dwordx4 v124, s[12:15], s91 offen nt lds
    s_waitcnt vmcnt(30)
    s_barrier
    ds_read_b64_tr_b16 a[80:81], v126 offset:0
    ds_read_b64_tr_b16 a[82:83], v126 offset:512
    ds_read_b64_tr_b16 a[84:85], v126 offset:4096
    ds_read_b64_tr_b16 a[86:87], v126 offset:4608
    ds_read_b64_tr_b16 a[88:89], v126 offset:8192
    ds_read_b64_tr_b16 a[90:91], v126 offset:8704
    ds_read_b64_tr_b16 a[92:93], v126 offset:12288
    ds_read_b64_tr_b16 a[94:95], v126 offset:12800
    ds_read_b64_tr_b16 a[96:97], v126 offset:16384
    ds_read_b64_tr_b16 a[98:99], v126 offset:16896
    ds_read_b64_tr_b16 a[100:101], v126 offset:20480
    ds_read_b64_tr_b16 a[102:103], v126 offset:20992
    ds_read_b64_tr_b16 a[104:105], v126 offset:24576
    ds_read_b64_tr_b16 a[106:107], v126 offset:25088
    ds_read_b64_tr_b16 a[108:109], v126 offset:28672
    ds_read_b64_tr_b16 a[110:111], v126 offset:29184
    ds_read_b64_tr_b16 a[112:113], v126 offset:32768
    ds_read_b64_tr_b16 a[114:115], v126 offset:33280
    ds_read_b64_tr_b16 a[116:117], v126 offset:36864
    ds_read_b64_tr_b16 a[118:119], v126 offset:37376
    s_waitcnt lgkmcnt(0)
    s_barrier
    s_mov_b32 s46, 40960
    s_lshl_b32 s90, s32, 10
    s_add_u32 m0, s90, 40960
    s_nop 0
    buffer_load_dwordx4 v10, s[24:27], s46 offen offset:0 lds
    s_add_u32 m0, m0, 3968
    s_nop 0
    buffer_load_dwordx4 v10, s[24:27], s46 offen offset:128 lds
    s_add_u32 m0, m0, 3968
    s_nop 0
    buffer_load_dwordx4 v10, s[24:27], s46 offen offset:256 lds
    s_add_u32 m0, m0, 3968
    s_nop 0
    buffer_load_dwordx4 v10, s[24:27], s46 offen offset:384 lds
    s_add_u32 m0, m0, 3968
    s_nop 0
    buffer_load_dwordx4 v10, s[24:27], s46 offen offset:512 lds
    s_add_u32 m0, m0, 3968
    s_nop 0
    buffer_load_dwordx4 v10, s[24:27], s46 offen offset:640 lds
    s_add_u32 m0, m0, 3968
    s_nop 0
    buffer_load_dwordx4 v10, s[24:27], s46 offen offset:768 lds
    s_add_u32 m0, m0, 3968
    s_nop 0
    buffer_load_dwordx4 v10, s[24:27], s46 offen offset:896 lds
    s_add_u32 m0, m0, 3968
    s_nop 0
    buffer_load_dwordx4 v10, s[24:27], s46 offen offset:1024 lds
    s_add_u32 m0, m0, 3968
    s_nop 0
    buffer_load_dwordx4 v10, s[24:27], s46 offen offset:1152 lds
    s_waitcnt vmcnt(30)
    s_barrier
    ds_read_b64_tr_b16 a[40:41], v127 offset:0
    ds_read_b64_tr_b16 a[42:43], v127 offset:512
    ds_read_b64_tr_b16 a[44:45], v127 offset:4096
    ds_read_b64_tr_b16 a[46:47], v127 offset:4608
    ds_read_b64_tr_b16 a[48:49], v127 offset:8192
    ds_read_b64_tr_b16 a[50:51], v127 offset:8704
    ds_read_b64_tr_b16 a[52:53], v127 offset:12288
    ds_read_b64_tr_b16 a[54:55], v127 offset:12800
    ds_read_b64_tr_b16 a[56:57], v127 offset:16384
    ds_read_b64_tr_b16 a[58:59], v127 offset:16896
    ds_read_b64_tr_b16 a[60:61], v127 offset:20480
    ds_read_b64_tr_b16 a[62:63], v127 offset:20992
    ds_read_b64_tr_b16 a[64:65], v127 offset:24576
    ds_read_b64_tr_b16 a[66:67], v127 offset:25088
    ds_read_b64_tr_b16 a[68:69], v127 offset:28672
    ds_read_b64_tr_b16 a[70:71], v127 offset:29184
    ds_read_b64_tr_b16 a[72:73], v127 offset:32768
    ds_read_b64_tr_b16 a[74:75], v127 offset:33280
    ds_read_b64_tr_b16 a[76:77], v127 offset:36864
    ds_read_b64_tr_b16 a[78:79], v127 offset:37376
    s_waitcnt lgkmcnt(0)
    s_waitcnt vmcnt(10)
    s_barrier
    ds_read_b64_tr_b16 a[120:121], v125 offset:0
    ds_read_b64_tr_b16 a[122:123], v125 offset:512
    ds_read_b64_tr_b16 a[124:125], v125 offset:4096
    ds_read_b64_tr_b16 a[126:127], v125 offset:4608
    ds_read_b64_tr_b16 a[128:129], v125 offset:8192
    ds_read_b64_tr_b16 a[130:131], v125 offset:8704
    ds_read_b64_tr_b16 a[132:133], v125 offset:12288
    ds_read_b64_tr_b16 a[134:135], v125 offset:12800
    ds_read_b64_tr_b16 a[136:137], v125 offset:16384
    ds_read_b64_tr_b16 a[138:139], v125 offset:16896
    ds_read_b64_tr_b16 a[140:141], v125 offset:20480
    ds_read_b64_tr_b16 a[142:143], v125 offset:20992
    ds_read_b64_tr_b16 a[144:145], v125 offset:24576
    ds_read_b64_tr_b16 a[146:147], v125 offset:25088
    ds_read_b64_tr_b16 a[148:149], v125 offset:28672
    ds_read_b64_tr_b16 a[150:151], v125 offset:29184
    ds_read_b64_tr_b16 a[152:153], v125 offset:32768
    ds_read_b64_tr_b16 a[154:155], v125 offset:33280
    ds_read_b64_tr_b16 a[156:157], v125 offset:36864
    ds_read_b64_tr_b16 a[158:159], v125 offset:37376
    s_waitcnt lgkmcnt(0)
    v_lshlrev_b32 v3, 4, v0
    buffer_load_dwordx4 v[248:251], v3, s[4:7], s61 offen sc1
    s_add_u32 s61, s61, 1024
    buffer_load_dwordx4 v[248:251], v3, s[4:7], s61 offen sc1
    s_add_u32 s61, s61, 1024
    buffer_load_dwordx4 v[248:251], v3, s[4:7], s61 offen sc1
    s_add_u32 s61, s61, 1024
    buffer_load_dwordx4 v[248:251], v3, s[4:7], s61 offen sc1
    s_add_u32 s61, s61, 1024
    buffer_load_dwordx4 v[248:251], v3, s[4:7], s61 offen sc1
    s_add_u32 s61, s61, 1024
    buffer_load_dwordx4 v[248:251], v3, s[4:7], s61 offen sc1
    s_add_u32 s61, s61, 1024
    buffer_load_dwordx4 v[248:251], v3, s[4:7], s61 offen sc1
    s_add_u32 s61, s61, 1024
    s_mov_b32 s49, 40960
    s_mov_b32 s47, 40960
    s_mov_b32 s37, -1
    s_add_u32 s44, s38, 65536
    s_add_u32 s45, s44, s56
    s_mov_b32 s46, 40960
    ds_read_b128 v[84:87], v11 offset:0
    ds_read_b128 v[88:91], v11 offset:2048
    ds_read_b128 v[92:95], v12 offset:0
    ds_read_b128 v[96:99], v12 offset:2048
    s_waitcnt lgkmcnt(2)
    v_mfma_f32_16x16x32_bf16 v[108:111], a[0:3], v[84:87], 0
    ds_read_b128 v[100:103], v11 offset:4096
    v_mfma_f32_16x16x32_bf16 v[112:115], a[0:3], v[88:91], 0
    ds_read_b128 v[104:107], v11 offset:6144
    v_mfma_f32_16x16x32_bf16 v[116:119], a[80:83], v[84:87], 0
    v_mfma_f32_16x16x32_bf16 v[120:123], a[80:83], v[88:91], 0
    s_waitcnt lgkmcnt(2)
    v_mfma_f32_16x16x32_bf16 v[108:111], a[4:7], v[92:95], v[108:111]
    ds_read_b128 v[84:87], v12 offset:4096
    v_mfma_f32_16x16x32_bf16 v[112:115], a[4:7], v[96:99], v[112:115]
    ds_read_b128 v[88:91], v12 offset:6144
    v_mfma_f32_16x16x32_bf16 v[116:119], a[84:87], v[92:95], v[116:119]
    v_mfma_f32_16x16x32_bf16 v[120:123], a[84:87], v[96:99], v[120:123]
    s_waitcnt lgkmcnt(2)
    v_mfma_f32_16x16x32_bf16 v[108:111], a[8:11], v[100:103], v[108:111]
    ds_read_b128 v[92:95], v11 offset:8192
    v_mfma_f32_16x16x32_bf16 v[112:115], a[8:11], v[104:107], v[112:115]
    ds_read_b128 v[96:99], v11 offset:10240
    v_mfma_f32_16x16x32_bf16 v[116:119], a[88:91], v[100:103], v[116:119]
    v_mfma_f32_16x16x32_bf16 v[120:123], a[88:91], v[104:107], v[120:123]
    s_waitcnt lgkmcnt(2)
    v_mfma_f32_16x16x32_bf16 v[108:111], a[12:15], v[84:87], v[108:111]
    ds_read_b128 v[100:103], v12 offset:8192
    v_mfma_f32_16x16x32_bf16 v[112:115], a[12:15], v[88:91], v[112:115]
    ds_read_b128 v[104:107], v12 offset:10240
    v_mfma_f32_16x16x32_bf16 v[116:119], a[92:95], v[84:87], v[116:119]
    v_mfma_f32_16x16x32_bf16 v[120:123], a[92:95], v[88:91], v[120:123]
    s_waitcnt lgkmcnt(2)
    v_mfma_f32_16x16x32_bf16 v[108:111], a[16:19], v[92:95], v[108:111]
    ds_read_b128 v[84:87], v11 offset:12288
    v_mfma_f32_16x16x32_bf16 v[112:115], a[16:19], v[96:99], v[112:115]
    ds_read_b128 v[88:91], v11 offset:14336
    v_mfma_f32_16x16x32_bf16 v[116:119], a[96:99], v[92:95], v[116:119]
    v_mfma_f32_16x16x32_bf16 v[120:123], a[96:99], v[96:99], v[120:123]
    s_waitcnt lgkmcnt(2)
    v_mfma_f32_16x16x32_bf16 v[108:111], a[20:23], v[100:103], v[108:111]
    ds_read_b128 v[92:95], v12 offset:12288
    v_mfma_f32_16x16x32_bf16 v[112:115], a[20:23], v[104:107], v[112:115]
    ds_read_b128 v[96:99], v12 offset:14336
    v_mfma_f32_16x16x32_bf16 v[116:119], a[100:103], v[100:103], v[116:119]
    v_mfma_f32_16x16x32_bf16 v[120:123], a[100:103], v[104:107], v[120:123]
    s_waitcnt lgkmcnt(2)
    v_mfma_f32_16x16x32_bf16 v[108:111], a[24:27], v[84:87], v[108:111]
    ds_read_b128 v[100:103], v11 offset:16384
    v_mfma_f32_16x16x32_bf16 v[112:115], a[24:27], v[88:91], v[112:115]
    ds_read_b128 v[104:107], v11 offset:18432
    v_mfma_f32_16x16x32_bf16 v[116:119], a[104:107], v[84:87], v[116:119]
    v_mfma_f32_16x16x32_bf16 v[120:123], a[104:107], v[88:91], v[120:123]
    s_waitcnt lgkmcnt(2)
    v_mfma_f32_16x16x32_bf16 v[108:111], a[28:31], v[92:95], v[108:111]
    ds_read_b128 v[84:87], v12 offset:16384
    v_mfma_f32_16x16x32_bf16 v[112:115], a[28:31], v[96:99], v[112:115]
    ds_read_b128 v[88:91], v12 offset:18432
    v_mfma_f32_16x16x32_bf16 v[116:119], a[108:111], v[92:95], v[116:119]
    v_mfma_f32_16x16x32_bf16 v[120:123], a[108:111], v[96:99], v[120:123]
    s_waitcnt lgkmcnt(2)
    v_mfma_f32_16x16x32_bf16 v[108:111], a[32:35], v[100:103], v[108:111]
    ds_read_b128 v[92:95], v11 offset:20480
    v_mfma_f32_16x16x32_bf16 v[112:115], a[32:35], v[104:107], v[112:115]
    ds_read_b128 v[96:99], v11 offset:22528
    v_mfma_f32_16x16x32_bf16 v[116:119], a[112:115], v[100:103], v[116:119]
    v_mfma_f32_16x16x32_bf16 v[120:123], a[112:115], v[104:107], v[120:123]
    s_waitcnt lgkmcnt(2)
    v_mfma_f32_16x16x32_bf16 v[108:111], a[36:39], v[84:87], v[108:111]
    ds_read_b128 v[100:103], v12 offset:20480
    v_mfma_f32_16x16x32_bf16 v[112:115], a[36:39], v[88:91], v[112:115]
    ds_read_b128 v[104:107], v12 offset:22528
    v_mfma_f32_16x16x32_bf16 v[116:119], a[116:119], v[84:87], v[116:119]
    v_mfma_f32_16x16x32_bf16 v[120:123], a[116:119], v[88:91], v[120:123]
    s_waitcnt lgkmcnt(2)
    v_mfma_f32_16x16x32_bf16 v[108:111], a[40:43], v[92:95], v[108:111]
    ds_read_b128 v[84:87], v11 offset:24576
    v_mfma_f32_16x16x32_bf16 v[112:115], a[40:43], v[96:99], v[112:115]
    ds_read_b128 v[88:91], v11 offset:26624
    v_mfma_f32_16x16x32_bf16 v[116:119], a[120:123], v[92:95], v[116:119]
    v_mfma_f32_16x16x32_bf16 v[120:123], a[120:123], v[96:99], v[120:123]
    s_waitcnt lgkmcnt(2)
    v_mfma_f32_16x16x32_bf16 v[108:111], a[44:47], v[100:103], v[108:111]
    ds_read_b128 v[92:95], v12 offset:24576
    v_mfma_f32_16x16x32_bf16 v[112:115], a[44:47], v[104:107], v[112:115]
    ds_read_b128 v[96:99], v12 offset:26624
    v_mfma_f32_16x16x32_bf16 v[116:119], a[124:127], v[100:103], v[116:119]
    v_mfma_f32_16x16x32_bf16 v[120:123], a[124:127], v[104:107], v[120:123]
    s_waitcnt lgkmcnt(2)
    v_mfma_f32_16x16x32_bf16 v[108:111], a[48:51], v[84:87], v[108:111]
    ds_read_b128 v[100:103], v11 offset:28672
    v_mfma_f32_16x16x32_bf16 v[112:115], a[48:51], v[88:91], v[112:115]
    ds_read_b128 v[104:107], v11 offset:30720
    v_mfma_f32_16x16x32_bf16 v[116:119], a[128:131], v[84:87], v[116:119]
    v_mfma_f32_16x16x32_bf16 v[120:123], a[128:131], v[88:91], v[120:123]
    s_waitcnt lgkmcnt(2)
    v_mfma_f32_16x16x32_bf16 v[108:111], a[52:55], v[92:95], v[108:111]
    ds_read_b128 v[84:87], v12 offset:28672
    v_mfma_f32_16x16x32_bf16 v[112:115], a[52:55], v[96:99], v[112:115]
    ds_read_b128 v[88:91], v12 offset:30720
    v_mfma_f32_16x16x32_bf16 v[116:119], a[132:135], v[92:95], v[116:119]
    v_mfma_f32_16x16x32_bf16 v[120:123], a[132:135], v[96:99], v[120:123]
    s_waitcnt lgkmcnt(2)
    v_mfma_f32_16x16x32_bf16 v[108:111], a[56:59], v[100:103], v[108:111]
    ds_read_b128 v[92:95], v11 offset:32768
    v_mfma_f32_16x16x32_bf16 v[112:115], a[56:59], v[104:107], v[112:115]
    ds_read_b128 v[96:99], v11 offset:34816
    v_mfma_f32_16x16x32_bf16 v[116:119], a[136:139], v[100:103], v[116:119]
    v_mfma_f32_16x16x32_bf16 v[120:123], a[136:139], v[104:107], v[120:123]
    s_waitcnt lgkmcnt(2)
    v_mfma_f32_16x16x32_bf16 v[108:111], a[60:63], v[84:87], v[108:111]
    ds_read_b128 v[100:103], v12 offset:32768
    v_mfma_f32_16x16x32_bf16 v[112:115], a[60:63], v[88:91], v[112:115]
    ds_read_b128 v[104:107], v12 offset:34816
    v_mfma_f32_16x16x32_bf16 v[116:119], a[140:143], v[84:87], v[116:119]
    v_mfma_f32_16x16x32_bf16 v[120:123], a[140:143], v[88:91], v[120:123]
    s_waitcnt lgkmcnt(2)
    v_mfma_f32_16x16x32_bf16 v[108:111], a[64:67], v[92:95], v[108:111]
    ds_read_b128 v[84:87], v11 offset:36864
    v_mfma_f32_16x16x32_bf16 v[112:115], a[64:67], v[96:99], v[112:115]
    ds_read_b128 v[88:91], v11 offset:38912
    v_mfma_f32_16x16x32_bf16 v[116:119], a[144:147], v[92:95], v[116:119]
    v_mfma_f32_16x16x32_bf16 v[120:123], a[144:147], v[96:99], v[120:123]
    s_waitcnt lgkmcnt(2)
    v_mfma_f32_16x16x32_bf16 v[108:111], a[68:71], v[100:103], v[108:111]
    ds_read_b128 v[92:95], v12 offset:36864
    v_mfma_f32_16x16x32_bf16 v[112:115], a[68:71], v[104:107], v[112:115]
    ds_read_b128 v[96:99], v12 offset:38912
    v_mfma_f32_16x16x32_bf16 v[116:119], a[148:151], v[100:103], v[116:119]
    v_mfma_f32_16x16x32_bf16 v[120:123], a[148:151], v[104:107], v[120:123]
    s_waitcnt lgkmcnt(0)
    v_mfma_f32_16x16x32_bf16 v[108:111], a[72:75], v[84:87], v[108:111]
    v_add_u32 v11, s49, v11
    v_mfma_f32_16x16x32_bf16 v[112:115], a[72:75], v[88:91], v[112:115]
    v_add_u32 v12, s49, v12
    v_mfma_f32_16x16x32_bf16 v[108:111], a[76:79], v[92:95], v[108:111]
    s_sub_u32 s47, s47, s49
    v_mfma_f32_16x16x32_bf16 v[112:115], a[76:79], v[96:99], v[112:115]
    s_sub_u32 s49, 0, s49
    v_mfma_f32_16x16x32_bf16 v[116:119], a[152:155], v[84:87], v[116:119]
    v_mfma_f32_16x16x32_bf16 v[120:123], a[152:155], v[88:91], v[120:123]
    v_mfma_f32_16x16x32_bf16 v[116:119], a[156:159], v[92:95], v[116:119]
    v_mfma_f32_16x16x32_bf16 v[120:123], a[156:159], v[96:99], v[120:123]
    v_cvt_pk_bf16_f32 v124, v108, v109
    v_cvt_pk_bf16_f32 v125, v110, v111
    v_cvt_pk_bf16_f32 v126, v112, v113
    v_cvt_pk_bf16_f32 v127, v114, v115
    s_nop 0
    v_permlane16_swap_b32 v124, v126
    v_permlane16_swap_b32 v125, v127
    v_cvt_pk_bf16_f32 v128, v116, v117
    v_cvt_pk_bf16_f32 v129, v118, v119
    v_cvt_pk_bf16_f32 v130, v120, v121
    v_cvt_pk_bf16_f32 v131, v122, v123
    s_nop 0
    v_permlane16_swap_b32 v128, v130
    v_permlane16_swap_b32 v129, v131
    buffer_store_dwordx4 v[124:127], v19, s[4:7], s44 offen sc1
    buffer_store_dwordx4 v[128:131], v19, s[4:7], s45 offen sc1
    v_mov_b32 v1, 196
L_gw_76:
    buffer_load_dword v2, v1, s[8:11], 0 offen sc1
    s_sub_u32 s36, s36, 1
    s_cbranch_scc1 L_exit
    s_waitcnt vmcnt(0)
    v_readfirstlane_b32 s90, v2
    s_nop 0
    s_cmp_eq_u32 s90, 0
    s_cbranch_scc1 L_gw_76
    s_waitcnt vmcnt(0) lgkmcnt(0)
    v_mov_b32 v20, 1
    buffer_store_dword v20, v136, s[4:7], s38 offen sc1
    s_barrier
    s_add_u32 s44, s38, 180224
    s_add_u32 s45, s44, s56
    s_mov_b32 s46, 81920
    ds_read_b128 v[84:87], v11 offset:0
    ds_read_b128 v[88:91], v11 offset:2048
    ds_read_b128 v[92:95], v12 offset:0
    ds_read_b128 v[96:99], v12 offset:2048
    s_lshl_b32 s90, s32, 10
    s_add_u32 m0, s90, s47
    s_waitcnt lgkmcnt(2)
    v_mfma_f32_16x16x32_bf16 v[108:111], a[0:3], v[84:87], 0
    ds_read_b128 v[100:103], v11 offset:4096
    v_mfma_f32_16x16x32_bf16 v[112:115], a[0:3], v[88:91], 0
    ds_read_b128 v[104:107], v11 offset:6144
    v_mfma_f32_16x16x32_bf16 v[116:119], a[80:83], v[84:87], 0
    buffer_load_dwordx4 v10, s[24:27], s46 offen offset:0 lds
    s_add_u32 m0, m0, 3968
    v_mfma_f32_16x16x32_bf16 v[120:123], a[80:83], v[88:91], 0
    s_waitcnt lgkmcnt(2)
    v_mfma_f32_16x16x32_bf16 v[108:111], a[4:7], v[92:95], v[108:111]
    ds_read_b128 v[84:87], v12 offset:4096
    v_mfma_f32_16x16x32_bf16 v[112:115], a[4:7], v[96:99], v[112:115]
    ds_read_b128 v[88:91], v12 offset:6144
    v_mfma_f32_16x16x32_bf16 v[116:119], a[84:87], v[92:95], v[116:119]
    buffer_load_dwordx4 v10, s[24:27], s46 offen offset:128 lds
    s_add_u32 m0, m0, 3968
    v_mfma_f32_16x16x32_bf16 v[120:123], a[84:87], v[96:99], v[120:123]
    s_waitcnt lgkmcnt(2)
    v_mfma_f32_16x16x32_bf16 v[108:111], a[8:11], v[100:103], v[108:111]
    ds_read_b128 v[92:95], v11 offset:8192
    v_mfma_f32_16x16x32_bf16 v[112:115], a[8:11], v[104:107], v[112:115]
    ds_read_b128 v[96:99], v11 offset:10240
    v_mfma_f32_16x16x32_bf16 v[116:119], a[88:91], v[100:103], v[116:119]
    buffer_load_dwordx4 v10, s[24:27], s46 offen offset:256 lds
    s_add_u32 m0, m0, 3968
    v_mfma_f32_16x16x32_bf16 v[120:123], a[88:91], v[104:107], v[120:123]
    s_waitcnt lgkmcnt(2)
    v_mfma_f32_16x16x32_bf16 v[108:111], a[12:15], v[84:87], v[108:111]
    ds_read_b128 v[100:103], v12 offset:8192
    v_mfma_f32_16x16x32_bf16 v[112:115], a[12:15], v[88:91], v[112:115]
    ds_read_b128 v[104:107], v12 offset:10240
    v_mfma_f32_16x16x32_bf16 v[116:119], a[92:95], v[84:87], v[116:119]
    buffer_load_dwordx4 v10, s[24:27], s46 offen offset:384 lds
    s_add_u32 m0, m0, 3968
    v_mfma_f32_16x16x32_bf16 v[120:123], a[92:95], v[88:91], v[120:123]
    s_waitcnt lgkmcnt(2)
    v_mfma_f32_16x16x32_bf16 v[108:111], a[16:19], v[92:95], v[108:111]
    ds_read_b128 v[84:87], v11 offset:12288
    v_mfma_f32_16x16x32_bf16 v[112:115], a[16:19], v[96:99], v[112:115]
    ds_read_b128 v[88:91], v11 offset:14336
    v_mfma_f32_16x16x32_bf16 v[116:119], a[96:99], v[92:95], v[116:119]
    buffer_load_dwordx4 v10, s[24:27], s46 offen offset:512 lds
    s_add_u32 m0, m0, 3968
    v_mfma_f32_16x16x32_bf16 v[120:123], a[96:99], v[96:99], v[120:123]
    s_waitcnt lgkmcnt(2)
    v_mfma_f32_16x16x32_bf16 v[108:111], a[20:23], v[100:103], v[108:111]
    ds_read_b128 v[92:95], v12 offset:12288
    v_mfma_f32_16x16x32_bf16 v[112:115], a[20:23], v[104:107], v[112:115]
    ds_read_b128 v[96:99], v12 offset:14336
    v_mfma_f32_16x16x32_bf16 v[116:119], a[100:103], v[100:103], v[116:119]
    buffer_load_dwordx4 v10, s[24:27], s46 offen offset:640 lds
    s_add_u32 m0, m0, 3968
    v_mfma_f32_16x16x32_bf16 v[120:123], a[100:103], v[104:107], v[120:123]
    s_waitcnt lgkmcnt(2)
    v_mfma_f32_16x16x32_bf16 v[108:111], a[24:27], v[84:87], v[108:111]
    ds_read_b128 v[100:103], v11 offset:16384
    v_mfma_f32_16x16x32_bf16 v[112:115], a[24:27], v[88:91], v[112:115]
    ds_read_b128 v[104:107], v11 offset:18432
    v_mfma_f32_16x16x32_bf16 v[116:119], a[104:107], v[84:87], v[116:119]
    buffer_load_dwordx4 v10, s[24:27], s46 offen offset:768 lds
    s_add_u32 m0, m0, 3968
    v_mfma_f32_16x16x32_bf16 v[120:123], a[104:107], v[88:91], v[120:123]
    s_waitcnt lgkmcnt(2)
    v_mfma_f32_16x16x32_bf16 v[108:111], a[28:31], v[92:95], v[108:111]
    ds_read_b128 v[84:87], v12 offset:16384
    v_mfma_f32_16x16x32_bf16 v[112:115], a[28:31], v[96:99], v[112:115]
    ds_read_b128 v[88:91], v12 offset:18432
    v_mfma_f32_16x16x32_bf16 v[116:119], a[108:111], v[92:95], v[116:119]
    buffer_load_dwordx4 v10, s[24:27], s46 offen offset:896 lds
    s_add_u32 m0, m0, 3968
    v_mfma_f32_16x16x32_bf16 v[120:123], a[108:111], v[96:99], v[120:123]
    s_waitcnt lgkmcnt(2)
    v_mfma_f32_16x16x32_bf16 v[108:111], a[32:35], v[100:103], v[108:111]
    ds_read_b128 v[92:95], v11 offset:20480
    v_mfma_f32_16x16x32_bf16 v[112:115], a[32:35], v[104:107], v[112:115]
    ds_read_b128 v[96:99], v11 offset:22528
    v_mfma_f32_16x16x32_bf16 v[116:119], a[112:115], v[100:103], v[116:119]
    buffer_load_dwordx4 v10, s[24:27], s46 offen offset:1024 lds
    s_add_u32 m0, m0, 3968
    v_mfma_f32_16x16x32_bf16 v[120:123], a[112:115], v[104:107], v[120:123]
    s_waitcnt lgkmcnt(2)
    v_mfma_f32_16x16x32_bf16 v[108:111], a[36:39], v[84:87], v[108:111]
    ds_read_b128 v[100:103], v12 offset:20480
    v_mfma_f32_16x16x32_bf16 v[112:115], a[36:39], v[88:91], v[112:115]
    ds_read_b128 v[104:107], v12 offset:22528
    v_mfma_f32_16x16x32_bf16 v[116:119], a[116:119], v[84:87], v[116:119]
    buffer_load_dwordx4 v10, s[24:27], s46 offen offset:1152 lds
    v_mfma_f32_16x16x32_bf16 v[120:123], a[116:119], v[88:91], v[120:123]
    s_waitcnt lgkmcnt(2)
    v_mfma_f32_16x16x32_bf16 v[108:111], a[40:43], v[92:95], v[108:111]
    ds_read_b128 v[84:87], v11 offset:24576
    v_mfma_f32_16x16x32_bf16 v[112:115], a[40:43], v[96:99], v[112:115]
    ds_read_b128 v[88:91], v11 offset:26624
    v_mfma_f32_16x16x32_bf16 v[116:119], a[120:123], v[92:95], v[116:119]
    v_mfma_f32_16x16x32_bf16 v[120:123], a[120:123], v[96:99], v[120:123]
    s_waitcnt lgkmcnt(2)
    v_mfma_f32_16x16x32_bf16 v[108:111], a[44:47], v[100:103], v[108:111]
    ds_read_b128 v[92:95], v12 offset:24576
    v_mfma_f32_16x16x32_bf16 v[112:115], a[44:47], v[104:107], v[112:115]
    ds_read_b128 v[96:99], v12 offset:26624
    v_mfma_f32_16x16x32_bf16 v[116:119], a[124:127], v[100:103], v[116:119]
    v_mfma_f32_16x16x32_bf16 v[120:123], a[124:127], v[104:107], v[120:123]
    s_waitcnt lgkmcnt(2)
    v_mfma_f32_16x16x32_bf16 v[108:111], a[48:51], v[84:87], v[108:111]
    ds_read_b128 v[100:103], v11 offset:28672
    v_mfma_f32_16x16x32_bf16 v[112:115], a[48:51], v[88:91], v[112:115]
    ds_read_b128 v[104:107], v11 offset:30720
    v_mfma_f32_16x16x32_bf16 v[116:119], a[128:131], v[84:87], v[116:119]
    v_mfma_f32_16x16x32_bf16 v[120:123], a[128:131], v[88:91], v[120:123]
    s_waitcnt lgkmcnt(2)
    v_mfma_f32_16x16x32_bf16 v[108:111], a[52:55], v[92:95], v[108:111]
    ds_read_b128 v[84:87], v12 offset:28672
    v_mfma_f32_16x16x32_bf16 v[112:115], a[52:55], v[96:99], v[112:115]
    ds_read_b128 v[88:91], v12 offset:30720
    v_mfma_f32_16x16x32_bf16 v[116:119], a[132:135], v[92:95], v[116:119]
    v_mfma_f32_16x16x32_bf16 v[120:123], a[132:135], v[96:99], v[120:123]
    s_waitcnt lgkmcnt(2)
    v_mfma_f32_16x16x32_bf16 v[108:111], a[56:59], v[100:103], v[108:111]
    ds_read_b128 v[92:95], v11 offset:32768
    v_mfma_f32_16x16x32_bf16 v[112:115], a[56:59], v[104:107], v[112:115]
    ds_read_b128 v[96:99], v11 offset:34816
    v_mfma_f32_16x16x32_bf16 v[116:119], a[136:139], v[100:103], v[116:119]
    v_mfma_f32_16x16x32_bf16 v[120:123], a[136:139], v[104:107], v[120:123]
    s_waitcnt lgkmcnt(2)
    v_mfma_f32_16x16x32_bf16 v[108:111], a[60:63], v[84:87], v[108:111]
    ds_read_b128 v[100:103], v12 offset:32768
    v_mfma_f32_16x16x32_bf16 v[112:115], a[60:63], v[88:91], v[112:115]
    ds_read_b128 v[104:107], v12 offset:34816
    v_mfma_f32_16x16x32_bf16 v[116:119], a[140:143], v[84:87], v[116:119]
    v_mfma_f32_16x16x32_bf16 v[120:123], a[140:143], v[88:91], v[120:123]
    s_waitcnt lgkmcnt(2)
    v_mfma_f32_16x16x32_bf16 v[108:111], a[64:67], v[92:95], v[108:111]
    ds_read_b128 v[84:87], v11 offset:36864
    v_mfma_f32_16x16x32_bf16 v[112:115], a[64:67], v[96:99], v[112:115]
    ds_read_b128 v[88:91], v11 offset:38912
    v_mfma_f32_16x16x32_bf16 v[116:119], a[144:147], v[92:95], v[116:119]
    v_mfma_f32_16x16x32_bf16 v[120:123], a[144:147], v[96:99], v[120:123]
    s_waitcnt lgkmcnt(2)
    v_mfma_f32_16x16x32_bf16 v[108:111], a[68:71], v[100:103], v[108:111]
    ds_read_b128 v[92:95], v12 offset:36864
    v_mfma_f32_16x16x32_bf16 v[112:115], a[68:71], v[104:107], v[112:115]
    ds_read_b128 v[96:99], v12 offset:38912
    v_mfma_f32_16x16x32_bf16 v[116:119], a[148:151], v[100:103], v[116:119]
    v_mfma_f32_16x16x32_bf16 v[120:123], a[148:151], v[104:107], v[120:123]
    s_waitcnt lgkmcnt(0)
    v_mfma_f32_16x16x32_bf16 v[108:111], a[72:75], v[84:87], v[108:111]
    v_add_u32 v11, s49, v11
    v_mfma_f32_16x16x32_bf16 v[112:115], a[72:75], v[88:91], v[112:115]
    v_add_u32 v12, s49, v12
    v_mfma_f32_16x16x32_bf16 v[108:111], a[76:79], v[92:95], v[108:111]
    s_sub_u32 s47, s47, s49
    v_mfma_f32_16x16x32_bf16 v[112:115], a[76:79], v[96:99], v[112:115]
    s_sub_u32 s49, 0, s49
    v_mfma_f32_16x16x32_bf16 v[116:119], a[152:155], v[84:87], v[116:119]
    v_mfma_f32_16x16x32_bf16 v[120:123], a[152:155], v[88:91], v[120:123]
    v_mfma_f32_16x16x32_bf16 v[116:119], a[156:159], v[92:95], v[116:119]
    v_mfma_f32_16x16x32_bf16 v[120:123], a[156:159], v[96:99], v[120:123]
    v_cvt_pk_bf16_f32 v124, v108, v109
    v_cvt_pk_bf16_f32 v125, v110, v111
    v_cvt_pk_bf16_f32 v126, v112, v113
    v_cvt_pk_bf16_f32 v127, v114, v115
    s_nop 0
    v_permlane16_swap_b32 v124, v126
    v_permlane16_swap_b32 v125, v127
    v_cvt_pk_bf16_f32 v128, v116, v117
    v_cvt_pk_bf16_f32 v129, v118, v119
    v_cvt_pk_bf16_f32 v130, v120, v121
    v_cvt_pk_bf16_f32 v131, v122, v123
    s_nop 0
    v_permlane16_swap_b32 v128, v130
    v_permlane16_swap_b32 v129, v131
    buffer_store_dwordx4 v[124:127], v19, s[4:7], s44 offen sc1
    buffer_store_dwordx4 v[128:131], v19, s[4:7], s45 offen sc1
    s_waitcnt vmcnt(0) lgkmcnt(0)
    v_mov_b32 v20, 2
    buffer_store_dword v20, v136, s[4:7], s38 offen sc1
    s_barrier
    s_add_u32 s44, s38, 294912
    s_add_u32 s45, s44, s56
    s_mov_b32 s46, 122880
    ds_read_b128 v[84:87], v11 offset:0
    ds_read_b128 v[88:91], v11 offset:2048
    ds_read_b128 v[92:95], v12 offset:0
    ds_read_b128 v[96:99], v12 offset:2048
    s_lshl_b32 s90, s32, 10
    s_add_u32 m0, s90, s47
    s_waitcnt lgkmcnt(2)
    v_mfma_f32_16x16x32_bf16 v[108:111], a[0:3], v[84:87], 0
    ds_read_b128 v[100:103], v11 offset:4096
    s_add_u32 s51, s37, 3
    v_mfma_f32_16x16x32_bf16 v[112:115], a[0:3], v[88:91], 0
    ds_read_b128 v[104:107], v11 offset:6144
    s_and_b32 s50, s51, 3
    v_mfma_f32_16x16x32_bf16 v[116:119], a[80:83], v[84:87], 0
    buffer_load_dwordx4 v10, s[24:27], s46 offen offset:0 lds
    s_add_u32 m0, m0, 3968
    v_mfma_f32_16x16x32_bf16 v[120:123], a[80:83], v[88:91], 0
    s_waitcnt lgkmcnt(2)
    s_mul_i32 s50, s50, 114688
    v_mfma_f32_16x16x32_bf16 v[108:111], a[4:7], v[92:95], v[108:111]
    ds_read_b128 v[84:87], v12 offset:4096
    s_add_u32 s50, s50, 65536
    v_mfma_f32_16x16x32_bf16 v[112:115], a[4:7], v[96:99], v[112:115]
    ds_read_b128 v[88:91], v12 offset:6144
    s_add_u32 s44, s38, s50
    v_mfma_f32_16x16x32_bf16 v[116:119], a[84:87], v[92:95], v[116:119]
    buffer_load_dwordx4 v10, s[24:27], s46 offen offset:128 lds
    s_add_u32 m0, m0, 3968
    v_mfma_f32_16x16x32_bf16 v[120:123], a[84:87], v[96:99], v[120:123]
    s_waitcnt lgkmcnt(2)
    s_add_u32 s45, s44, s56
    v_mfma_f32_16x16x32_bf16 v[108:111], a[8:11], v[100:103], v[108:111]
    ds_read_b128 v[92:95], v11 offset:8192
    s_add_u32 s37, s37, 1
    v_mfma_f32_16x16x32_bf16 v[112:115], a[8:11], v[104:107], v[112:115]
    ds_read_b128 v[96:99], v11 offset:10240
    s_mov_b32 s52, 0
    v_mfma_f32_16x16x32_bf16 v[116:119], a[88:91], v[100:103], v[116:119]
    buffer_load_dwordx4 v10, s[24:27], s46 offen offset:256 lds
    s_add_u32 m0, m0, 3968
    v_mfma_f32_16x16x32_bf16 v[120:123], a[88:91], v[104:107], v[120:123]
    s_waitcnt lgkmcnt(2)
    s_and_b32 s50, s37, 3
    v_mfma_f32_16x16x32_bf16 v[108:111], a[12:15], v[84:87], v[108:111]
    ds_read_b128 v[100:103], v12 offset:8192
    s_mul_i32 s51, s50, 114688
    v_mfma_f32_16x16x32_bf16 v[112:115], a[12:15], v[88:91], v[112:115]
    ds_read_b128 v[104:107], v12 offset:10240
    s_add_u32 s41, s38, s51
    v_mfma_f32_16x16x32_bf16 v[116:119], a[92:95], v[84:87], v[116:119]
    buffer_load_dwordx4 v10, s[24:27], s46 offen offset:384 lds
    s_add_u32 m0, m0, 3968
    v_mfma_f32_16x16x32_bf16 v[120:123], a[92:95], v[88:91], v[120:123]
    s_waitcnt lgkmcnt(2)
    v_mfma_f32_16x16x32_bf16 v[108:111], a[16:19], v[92:95], v[108:111]
    ds_read_b128 v[84:87], v11 offset:12288
    v_mfma_f32_16x16x32_bf16 v[112:115], a[16:19], v[96:99], v[112:115]
    ds_read_b128 v[88:91], v11 offset:14336
    v_mfma_f32_16x16x32_bf16 v[116:119], a[96:99], v[92:95], v[116:119]
    buffer_load_dwordx4 v10, s[24:27], s46 offen offset:512 lds
    s_add_u32 m0, m0, 3968
    v_mfma_f32_16x16x32_bf16 v[120:123], a[96:99], v[96:99], v[120:123]
    s_waitcnt lgkmcnt(2)
    v_mfma_f32_16x16x32_bf16 v[108:111], a[20:23], v[100:103], v[108:111]
    ds_read_b128 v[92:95], v12 offset:12288
    v_mfma_f32_16x16x32_bf16 v[112:115], a[20:23], v[104:107], v[112:115]
    ds_read_b128 v[96:99], v12 offset:14336
    v_mfma_f32_16x16x32_bf16 v[116:119], a[100:103], v[100:103], v[116:119]
    buffer_load_dwordx4 v10, s[24:27], s46 offen offset:640 lds
    s_add_u32 m0, m0, 3968
    v_mfma_f32_16x16x32_bf16 v[120:123], a[100:103], v[104:107], v[120:123]
    s_waitcnt lgkmcnt(2)
    v_mfma_f32_16x16x32_bf16 v[108:111], a[24:27], v[84:87], v[108:111]
    ds_read_b128 v[100:103], v11 offset:16384
    v_mfma_f32_16x16x32_bf16 v[112:115], a[24:27], v[88:91], v[112:115]
    ds_read_b128 v[104:107], v11 offset:18432
    v_mfma_f32_16x16x32_bf16 v[116:119], a[104:107], v[84:87], v[116:119]
    buffer_load_dwordx4 v10, s[24:27], s46 offen offset:768 lds
    s_add_u32 m0, m0, 3968
    v_mfma_f32_16x16x32_bf16 v[120:123], a[104:107], v[88:91], v[120:123]
    s_waitcnt lgkmcnt(2)
    v_mfma_f32_16x16x32_bf16 v[108:111], a[28:31], v[92:95], v[108:111]
    ds_read_b128 v[84:87], v12 offset:16384
    v_mfma_f32_16x16x32_bf16 v[112:115], a[28:31], v[96:99], v[112:115]
    ds_read_b128 v[88:91], v12 offset:18432
    v_mfma_f32_16x16x32_bf16 v[116:119], a[108:111], v[92:95], v[116:119]
    buffer_load_dwordx4 v10, s[24:27], s46 offen offset:896 lds
    s_add_u32 m0, m0, 3968
    v_mfma_f32_16x16x32_bf16 v[120:123], a[108:111], v[96:99], v[120:123]
    s_waitcnt lgkmcnt(2)
    v_mfma_f32_16x16x32_bf16 v[108:111], a[32:35], v[100:103], v[108:111]
    ds_read_b128 v[92:95], v11 offset:20480
    v_mfma_f32_16x16x32_bf16 v[112:115], a[32:35], v[104:107], v[112:115]
    ds_read_b128 v[96:99], v11 offset:22528
    v_mfma_f32_16x16x32_bf16 v[116:119], a[112:115], v[100:103], v[116:119]
    buffer_load_dwordx4 v10, s[24:27], s46 offen offset:1024 lds
    s_add_u32 m0, m0, 3968
    v_mfma_f32_16x16x32_bf16 v[120:123], a[112:115], v[104:107], v[120:123]
    s_waitcnt lgkmcnt(2)
    v_mfma_f32_16x16x32_bf16 v[108:111], a[36:39], v[84:87], v[108:111]
    ds_read_b128 v[100:103], v12 offset:20480
    v_mfma_f32_16x16x32_bf16 v[112:115], a[36:39], v[88:91], v[112:115]
    ds_read_b128 v[104:107], v12 offset:22528
    v_mfma_f32_16x16x32_bf16 v[116:119], a[116:119], v[84:87], v[116:119]
    buffer_load_dwordx4 v10, s[24:27], s46 offen offset:1152 lds
    v_mfma_f32_16x16x32_bf16 v[120:123], a[116:119], v[88:91], v[120:123]
    s_waitcnt lgkmcnt(2)
    v_mfma_f32_16x16x32_bf16 v[108:111], a[40:43], v[92:95], v[108:111]
    ds_read_b128 v[84:87], v11 offset:24576
    v_mfma_f32_16x16x32_bf16 v[112:115], a[40:43], v[96:99], v[112:115]
    ds_read_b128 v[88:91], v11 offset:26624
    v_mfma_f32_16x16x32_bf16 v[116:119], a[120:123], v[92:95], v[116:119]
    v_mfma_f32_16x16x32_bf16 v[120:123], a[120:123], v[96:99], v[120:123]
    s_waitcnt lgkmcnt(2)
    v_mfma_f32_16x16x32_bf16 v[108:111], a[44:47], v[100:103], v[108:111]
    ds_read_b128 v[92:95], v12 offset:24576
    v_mfma_f32_16x16x32_bf16 v[112:115], a[44:47], v[104:107], v[112:115]
    ds_read_b128 v[96:99], v12 offset:26624
    v_mfma_f32_16x16x32_bf16 v[116:119], a[124:127], v[100:103], v[116:119]
    v_mfma_f32_16x16x32_bf16 v[120:123], a[124:127], v[104:107], v[120:123]
    s_waitcnt lgkmcnt(2)
    v_mfma_f32_16x16x32_bf16 v[108:111], a[48:51], v[84:87], v[108:111]
    ds_read_b128 v[100:103], v11 offset:28672
    v_mfma_f32_16x16x32_bf16 v[112:115], a[48:51], v[88:91], v[112:115]
    ds_read_b128 v[104:107], v11 offset:30720
    v_mfma_f32_16x16x32_bf16 v[116:119], a[128:131], v[84:87], v[116:119]
    v_mfma_f32_16x16x32_bf16 v[120:123], a[128:131], v[88:91], v[120:123]
    s_waitcnt lgkmcnt(2)
    v_mfma_f32_16x16x32_bf16 v[108:111], a[52:55], v[92:95], v[108:111]
    ds_read_b128 v[84:87], v12 offset:28672
    v_mfma_f32_16x16x32_bf16 v[112:115], a[52:55], v[96:99], v[112:115]
    ds_read_b128 v[88:91], v12 offset:30720
    v_mfma_f32_16x16x32_bf16 v[116:119], a[132:135], v[92:95], v[116:119]
    v_mfma_f32_16x16x32_bf16 v[120:123], a[132:135], v[96:99], v[120:123]
    s_waitcnt lgkmcnt(2)
    v_mfma_f32_16x16x32_bf16 v[108:111], a[56:59], v[100:103], v[108:111]
    ds_read_b128 v[92:95], v11 offset:32768
    v_mfma_f32_16x16x32_bf16 v[112:115], a[56:59], v[104:107], v[112:115]
    ds_read_b128 v[96:99], v11 offset:34816
    v_mfma_f32_16x16x32_bf16 v[116:119], a[136:139], v[100:103], v[116:119]
    v_mfma_f32_16x16x32_bf16 v[120:123], a[136:139], v[104:107], v[120:123]
    s_waitcnt lgkmcnt(2)
    v_mfma_f32_16x16x32_bf16 v[108:111], a[60:63], v[84:87], v[108:111]
    ds_read_b128 v[100:103], v12 offset:32768
    v_mfma_f32_16x16x32_bf16 v[112:115], a[60:63], v[88:91], v[112:115]
    ds_read_b128 v[104:107], v12 offset:34816
    v_mfma_f32_16x16x32_bf16 v[116:119], a[140:143], v[84:87], v[116:119]
    v_mfma_f32_16x16x32_bf16 v[120:123], a[140:143], v[88:91], v[120:123]
    s_waitcnt lgkmcnt(2)
    v_mfma_f32_16x16x32_bf16 v[108:111], a[64:67], v[92:95], v[108:111]
    ds_read_b128 v[84:87], v11 offset:36864
    v_mfma_f32_16x16x32_bf16 v[112:115], a[64:67], v[96:99], v[112:115]
    ds_read_b128 v[88:91], v11 offset:38912
    v_mfma_f32_16x16x32_bf16 v[116:119], a[144:147], v[92:95], v[116:119]
    v_mfma_f32_16x16x32_bf16 v[120:123], a[144:147], v[96:99], v[120:123]
    s_waitcnt lgkmcnt(2)
    v_mfma_f32_16x16x32_bf16 v[108:111], a[68:71], v[100:103], v[108:111]
    ds_read_b128 v[92:95], v12 offset:36864
    v_mfma_f32_16x16x32_bf16 v[112:115], a[68:71], v[104:107], v[112:115]
    ds_read_b128 v[96:99], v12 offset:38912
    v_mfma_f32_16x16x32_bf16 v[116:119], a[148:151], v[100:103], v[116:119]
    v_mfma_f32_16x16x32_bf16 v[120:123], a[148:151], v[104:107], v[120:123]
    s_waitcnt lgkmcnt(0)
    v_mfma_f32_16x16x32_bf16 v[108:111], a[72:75], v[84:87], v[108:111]
    v_add_u32 v11, s49, v11
    v_mfma_f32_16x16x32_bf16 v[112:115], a[72:75], v[88:91], v[112:115]
    v_add_u32 v12, s49, v12
    v_mfma_f32_16x16x32_bf16 v[108:111], a[76:79], v[92:95], v[108:111]
    s_sub_u32 s47, s47, s49
    v_mfma_f32_16x16x32_bf16 v[112:115], a[76:79], v[96:99], v[112:115]
    s_sub_u32 s49, 0, s49
    v_mfma_f32_16x16x32_bf16 v[116:119], a[152:155], v[84:87], v[116:119]
    v_mfma_f32_16x16x32_bf16 v[120:123], a[152:155], v[88:91], v[120:123]
    v_mfma_f32_16x16x32_bf16 v[116:119], a[156:159], v[92:95], v[116:119]
    v_mfma_f32_16x16x32_bf16 v[120:123], a[156:159], v[96:99], v[120:123]
    v_cvt_pk_bf16_f32 v124, v108, v109
    v_cvt_pk_bf16_f32 v125, v110, v111
    v_cvt_pk_bf16_f32 v126, v112, v113
    v_cvt_pk_bf16_f32 v127, v114, v115
    s_nop 0
    v_permlane16_swap_b32 v124, v126
    v_permlane16_swap_b32 v125, v127
    v_cvt_pk_bf16_f32 v128, v116, v117
    v_cvt_pk_bf16_f32 v129, v118, v119
    v_cvt_pk_bf16_f32 v130, v120, v121
    v_cvt_pk_bf16_f32 v131, v122, v123
    s_nop 0
    v_permlane16_swap_b32 v128, v130
    v_permlane16_swap_b32 v129, v131
    buffer_store_dwordx4 v[124:127], v19, s[4:7], s44 offen sc1
    buffer_store_dwordx4 v[128:131], v19, s[4:7], s45 offen sc1
    v_mov_b32 v3, 204
L_p0_77:
    buffer_load_dword v4, v3, s[8:11], 0 offen sc1
    s_sub_u32 s36, s36, 1
    s_cbranch_scc1 L_exit
    s_waitcnt vmcnt(0)
    v_readfirstlane_b32 s90, v4
    s_nop 0
    s_cmp_eq_u32 s90, 0
    s_cbranch_scc1 L_p0_77
    s_and_b32 s90, s90, 2
    s_lshl_b32 s90, s90, 12
    v_and_b32 v3, 1, v0
    v_lshlrev_b32 v3, 12, v3
    v_bfe_u32 v5, v0, 2, 1
    v_lshl_add_u32 v3, v5, 13, v3
    v_bfe_u32 v4, v0, 1, 1
    v_lshl_add_u32 v3, v4, 14, v3
    v_xor_b32 v3, s90, v3
    s_lshl_b32 s91, s34, 9
    s_add_u32 s91, s91, 1933312
    s_xor_b32 s55, s32, 3
    s_or_b32 s55, s55, s40
    s_cselect_b32 s91, 2146435072, s91
    v_add_u32 v140, s91, v3
    v_cmp_gt_u32 vcc, 8, v0
    v_mov_b32 v9, 2146435072
    s_nop 0
    v_cndmask_b32 v140, v9, v140, vcc
    v_cmp_ne_u32 vcc, s34, v0
    v_mov_b32 v9, 2146435072
    s_nop 0
    v_cndmask_b32 v140, v9, v140, vcc
    s_lshr_b32 s91, s34, 2
    v_cmp_eq_u32 vcc, s91, v5
    s_nop 1
    v_cndmask_b32 v141, v9, v140, vcc
    v_cndmask_b32 v140, v140, v9, vcc
    v_and_b32 v3, 7, v0
    v_min_u32 v3, 5, v3
    v_bfe_u32 v4, v0, 3, 2
    v_lshlrev_b32 v4, 7, v4
    v_lshl_add_u32 v3, v3, 2, v4
    v_add_u32 v142, 462368, v3
    s_mov_b32 s61, s90
    s_lshl_b32 s93, s40, 1
    s_add_u32 s93, s93, s32
    s_lshl_b32 s93, s93, 1
    s_sub_u32 s93, s93, 8
    v_and_b32 v1, 15, v0
    v_lshrrev_b32 v2, 4, v0
    s_nop 0
    s_lshr_b32 s90, s93, 2
    s_lshl_b32 s90, s90, 15
    s_and_b32 s92, s93, 3
    s_lshl_b32 s92, s92, 10
    s_add_u32 s90, s90, s92
    v_mov_b32 v5, s34
    v_and_b32 v6, 7, v1
    v_lshlrev_b32 v6, 4, v6
    v_lshl_add_u32 v6, v5, 7, v6
    v_lshrrev_b32 v7, 3, v1
    v_lshl_add_u32 v6, v7, 12, v6
    v_lshrrev_b32 v5, 1, v2
    v_lshl_add_u32 v6, v5, 13, v6
    v_and_b32 v5, 1, v2
    v_lshl_add_u32 v6, v5, 14, v6
    v_add_u32 v143, s90, v6
    s_and_b32 s91, s34, 1
    s_lshl_b32 s91, s91, 12
    s_add_u32 s90, s90, s91
    s_lshr_b32 s91, s34, 2
    s_lshl_b32 s91, s91, 13
    s_add_u32 s90, s90, s91
    s_and_b32 s91, s34, 2
    s_lshl_b32 s91, s91, 13
    s_add_u32 s90, s90, s91
    v_lshl_add_u32 v144, v0, 4, s90
    s_lshl_b32 s91, s93, 10
    s_add_u32 s91, s91, 884736
    v_lshl_add_u32 v146, v0, 4, s91
    s_lshr_b32 s91, s34, 1
    s_mul_i32 s91, s91, 10240
    s_lshl_b32 s92, s93, 5
    s_add_u32 s91, s91, s92
    s_and_b32 s92, s34, 1
    s_mul_i32 s92, s92, 40960
    s_add_u32 s91, s91, s92
    s_add_u32 s91, s91, 1280
    v_mul_u32_u24 v6, 2560, v2
    v_lshl_add_u32 v6, v1, 1, v6
    v_add_u32 v145, s91, v6
    v_cmp_gt_u32 s[58:59], 8, v1
    v_and_b32 v5, 1, v1
    v_lshrrev_b32 v6, 3, v1
    v_lshl_add_u32 v5, v5, 1, v6
    v_bfe_u32 v6, v1, 2, 1
    v_cmp_ne_u32 vcc, 0, v6
    v_mov_b32 v6, 0x3f80
    v_mov_b32 v7, 0x3f800000
    v_cndmask_b32 v6, v6, v7, vcc
    v_cmp_eq_u32 vcc, 0, v5
    s_nop 1
    v_cndmask_b32 v7, 0, v6, vcc
    v_accvgpr_write_b32 a160, v7
    v_cmp_eq_u32 vcc, 1, v5
    s_nop 1
    v_cndmask_b32 v7, 0, v6, vcc
    v_accvgpr_write_b32 a161, v7
    v_cmp_eq_u32 vcc, 2, v5
    s_nop 1
    v_cndmask_b32 v7, 0, v6, vcc
    v_accvgpr_write_b32 a162, v7
    v_cmp_eq_u32 vcc, 3, v5
    s_nop 1
    v_cndmask_b32 v7, 0, v6, vcc
    v_accvgpr_write_b32 a163, v7
    v_xor_b32 v143, s61, v143
    v_xor_b32 v144, s61, v144
    s_cmp_lg_u32 s40, 0
    s_cselect_b64 vcc, -1, 0
    v_mov_b32 v9, 2146435072
    v_cndmask_b32 v143, v9, v143, vcc
    v_cndmask_b32 v144, v9, v144, vcc
    v_cndmask_b32 v145, v9, v145, vcc
    v_cndmask_b32 v146, v9, v146, vcc
L_v_loop_s:
    s_add_u32 s50, s37, 2
    s_and_b32 s50, s50, 3
    s_mul_i32 s50, s50, 114688
    s_add_u32 s42, s38, s50
    s_add_u32 s50, s37, 4
    s_min_u32 s50, s50, 63
    s_mul_i32 s46, s50, 40960
    s_add_u32 s51, s37, 1
    v_mov_b32 v20, s51
    s_mov_b32 m0, s48
    v_mov_b32 v68, 0
    v_mov_b32 v69, 0
    v_mov_b32 v70, 0
    v_mov_b32 v71, 0
    v_mov_b32 v72, 0
    v_mov_b32 v73, 0
    v_mov_b32 v74, 0
    v_mov_b32 v75, 0
    s_add_u32 s50, s37, 6
    s_min_u32 s50, s50, 63
    s_mul_i32 s57, s50, 40960
    s_and_b32 s50, s37, 3
    s_mul_i32 s51, s50, 40960
    s_add_u32 s43, s51, s38
    s_mul_i32 s51, s50, 327680
    s_add_u32 s53, s51, 4194304
    s_xor_b32 s50, s50, 2
    s_mul_i32 s51, s50, 327680
    s_add_u32 s54, s51, 4194304
    s_sub_u32 s51, s37, 6
    s_mul_i32 s60, s51, 81920
L_vg_78:
    buffer_load_dword v139, v138, s[4:7], s38 offen sc1
    s_sub_u32 s36, s36, 1
    s_cbranch_scc1 L_exit
    s_waitcnt vmcnt(0)
    v_cmp_gt_u32 vcc, s37, v139
    s_cbranch_vccnz L_vg_78
    buffer_load_dwordx4 v13, s[4:7], s41 offen sc1 lds
    buffer_load_dwordx4 v13, s[4:7], s41 offen offset:1024 sc1 lds
    buffer_load_dword v14, s[4:7], s41 offen offset:2048 sc1 lds
    buffer_load_dword v14, s[4:7], s41 offen offset:2304 sc1 lds
L_poll_80:
    buffer_load_dwordx4 v13, s[4:7], s41 offen sc1 lds
    buffer_load_dwordx4 v13, s[4:7], s41 offen offset:1024 sc1 lds
    buffer_load_dword v14, s[4:7], s41 offen offset:2048 sc1 lds
    buffer_load_dword v14, s[4:7], s41 offen offset:2304 sc1 lds
    s_sub_u32 s36, s36, 1
    s_cbranch_scc1 L_exit
    s_waitcnt vmcnt(4)
    ds_read_b32 v18, v15
    s_waitcnt lgkmcnt(0)
    v_cmp_eq_u32 vcc, -1, v18
    s_cbranch_vccnz L_poll_80
    s_barrier
    ds_read_b128 v[28:31], v16 offset:0
    ds_read_b128 v[32:35], v16 offset:1024
    ds_read_b128 v[36:39], v16 offset:2048
    ds_read_b128 v[40:43], v16 offset:3072
    s_waitcnt lgkmcnt(3)
    v_smfmac_f32_16x16x64_bf16 v[68:71], v[28:31], a[0:7], v17
    ds_read_b128 v[44:47], v16 offset:4096
    v_smfmac_f32_16x16x64_bf16 v[72:75], v[28:31], a[80:87], v17
    ds_read_b128 v[48:51], v16 offset:5120
    s_waitcnt lgkmcnt(4)
    v_smfmac_f32_16x16x64_bf16 v[68:71], v[32:35], a[8:15], v17
    ds_read_b128 v[52:55], v16 offset:6144
    v_smfmac_f32_16x16x64_bf16 v[72:75], v[32:35], a[88:95], v17
    ds_read_b128 v[56:59], v16 offset:7168
    s_waitcnt lgkmcnt(5)
    v_smfmac_f32_16x16x64_bf16 v[68:71], v[36:39], a[16:23], v17
    ds_read_b128 v[60:63], v16 offset:8192
    v_smfmac_f32_16x16x64_bf16 v[72:75], v[36:39], a[96:103], v17
    ds_read_b128 v[64:67], v16 offset:9216
    s_waitcnt lgkmcnt(6)
    v_smfmac_f32_16x16x64_bf16 v[68:71], v[40:43], a[24:31], v17
    v_smfmac_f32_16x16x64_bf16 v[72:75], v[40:43], a[104:111], v17
    s_waitcnt lgkmcnt(5)
    v_smfmac_f32_16x16x64_bf16 v[68:71], v[44:47], a[32:39], v17
    v_smfmac_f32_16x16x64_bf16 v[72:75], v[44:47], a[112:119], v17
    s_waitcnt lgkmcnt(4)
    v_smfmac_f32_16x16x64_bf16 v[68:71], v[48:51], a[40:47], v17
    s_waitcnt lgkmcnt(3)
    v_smfmac_f32_16x16x64_bf16 v[68:71], v[52:55], a[48:55], v17
    s_waitcnt lgkmcnt(2)
    v_smfmac_f32_16x16x64_bf16 v[68:71], v[56:59], a[56:63], v17
    s_waitcnt lgkmcnt(1)
    v_smfmac_f32_16x16x64_bf16 v[68:71], v[60:63], a[64:71], v17
    s_waitcnt lgkmcnt(0)
    v_smfmac_f32_16x16x64_bf16 v[68:71], v[64:67], a[72:79], v17
L_redo_79:
    v_smfmac_f32_16x16x64_bf16 v[72:75], v[48:51], a[120:127], v17
    v_smfmac_f32_16x16x64_bf16 v[72:75], v[52:55], a[128:135], v17
    buffer_store_dword v20, v21, s[4:7], s38 offen offset:0 sc1
    v_smfmac_f32_16x16x64_bf16 v[72:75], v[56:59], a[136:143], v17
    v_add_f32 v68, v68, v70
    v_add_f32 v69, v69, v71
    v_smfmac_f32_16x16x64_bf16 v[72:75], v[60:63], a[144:151], v17
    v_cmp_u_f32 vcc, v68, v69
    v_cvt_pk_bf16_f32 v132, v68, v69
    v_smfmac_f32_16x16x64_bf16 v[72:75], v[64:67], a[152:159], v17
    s_cbranch_vccnz L_nan_81
L_cont_82:
    buffer_store_dword v132, v134, s[4:7], s41 offen offset:0 sc1
    s_nop 5
    v_pk_add_f32 v[72:73], v[72:73], v[74:75]
    v_cvt_pk_bf16_f32 v133, v72, v73
    buffer_store_dword v133, v134, s[4:7], s41 offen offset:1024 sc1
    buffer_store_dword v20, v21, s[4:7], s38 offen offset:32 sc1
    ds_read_b128 v[84:87], v11 offset:0
    ds_read_b128 v[88:91], v11 offset:2048
    ds_read_b128 v[92:95], v12 offset:0
    ds_read_b128 v[96:99], v12 offset:2048
    s_cmp_eq_u32 s37, 63
    s_cbranch_scc1 L_end_83
    s_cmp_lg_u32 s55, 0
    s_cbranch_scc1 L_an_84x
    buffer_load_dword v139, v142, s[4:7], s38 offen sc1
    buffer_load_dword v139, v142, s[4:7], s38 offen sc1
    buffer_load_dword v139, v142, s[4:7], s38 offen sc1
    buffer_load_dword v139, v142, s[4:7], s38 offen sc1
    buffer_load_dword v139, v142, s[4:7], s38 offen sc1
    buffer_load_dword v139, v142, s[4:7], s38 offen sc1
L_sp_85:
    s_waitcnt vmcnt(5)
    v_cmp_ge_u32 vcc, s37, v139
    buffer_load_dword v139, v142, s[4:7], s38 offen sc1
    s_sub_u32 s36, s36, 1
    s_cbranch_scc1 L_exit
    s_cbranch_vccz L_sp_85x
    s_waitcnt vmcnt(5)
    v_cmp_ge_u32 vcc, s37, v139
    buffer_load_dword v139, v142, s[4:7], s38 offen sc1
    s_cbranch_vccz L_sp_85x
    s_waitcnt vmcnt(5)
    v_cmp_ge_u32 vcc, s37, v139
    buffer_load_dword v139, v142, s[4:7], s38 offen sc1
    s_cbranch_vccz L_sp_85x
    s_waitcnt vmcnt(5)
    v_cmp_ge_u32 vcc, s37, v139
    buffer_load_dword v139, v142, s[4:7], s38 offen sc1
    s_cbranch_vccnz L_sp_85
L_sp_85x:
L_an_84x:
    s_barrier
    s_lshl_b32 s90, s32, 10
    s_add_u32 m0, s90, s47
    s_waitcnt lgkmcnt(2)
    v_mfma_f32_16x16x32_bf16 v[108:111], a[0:3], v[84:87], 0
    ds_read_b128 v[100:103], v11 offset:4096
    s_add_u32 s51, s37, 3
    v_mfma_f32_16x16x32_bf16 v[112:115], a[0:3], v[88:91], 0
    ds_read_b128 v[104:107], v11 offset:6144
    s_and_b32 s50, s51, 3
    v_mfma_f32_16x16x32_bf16 v[116:119], a[80:83], v[84:87], 0
    buffer_load_dwordx4 v[148:151], v146, s[4:7], s43 offen offset:0 sc1
    buffer_load_dwordx4 v[152:155], v146, s[4:7], s43 offen offset:1024 sc1
    v_mfma_f32_16x16x32_bf16 v[120:123], a[80:83], v[88:91], 0
    s_waitcnt lgkmcnt(2)
    s_mul_i32 s50, s50, 114688
    v_mfma_f32_16x16x32_bf16 v[108:111], a[4:7], v[92:95], v[108:111]
    ds_read_b128 v[84:87], v12 offset:4096
    s_add_u32 s50, s50, 65536
    v_mfma_f32_16x16x32_bf16 v[112:115], a[4:7], v[96:99], v[112:115]
    ds_read_b128 v[88:91], v12 offset:6144
    s_add_u32 s44, s38, s50
    v_mfma_f32_16x16x32_bf16 v[116:119], a[84:87], v[92:95], v[116:119]
    s_cmp_lt_i32 s60, 0
    s_cselect_b32 s54, s38, s54
    buffer_load_dwordx4 v[156:159], v144, s[4:7], s54 offen offset:0 sc1
    buffer_load_dwordx4 v[160:163], v144, s[4:7], s54 offen offset:1024 sc1
    v_mfma_f32_16x16x32_bf16 v[120:123], a[84:87], v[96:99], v[120:123]
    s_waitcnt lgkmcnt(2)
    s_add_u32 s45, s44, s56
    v_mfma_f32_16x16x32_bf16 v[108:111], a[8:11], v[100:103], v[108:111]
    ds_read_b128 v[92:95], v11 offset:8192
    s_add_u32 s37, s37, 1
    v_mfma_f32_16x16x32_bf16 v[112:115], a[8:11], v[104:107], v[112:115]
    ds_read_b128 v[96:99], v11 offset:10240
    s_mov_b32 s52, 0
    v_mfma_f32_16x16x32_bf16 v[116:119], a[88:91], v[100:103], v[116:119]
    s_and_b32 s50, s37, 3
    s_mul_i32 s51, s50, 114688
    v_mfma_f32_16x16x32_bf16 v[120:123], a[88:91], v[104:107], v[120:123]
    s_waitcnt lgkmcnt(2)
    s_add_u32 s41, s38, s51
    v_mfma_f32_16x16x32_bf16 v[108:111], a[12:15], v[84:87], v[108:111]
    ds_read_b128 v[100:103], v12 offset:8192
    v_mfma_f32_16x16x32_bf16 v[112:115], a[12:15], v[88:91], v[112:115]
    ds_read_b128 v[104:107], v12 offset:10240
    v_mfma_f32_16x16x32_bf16 v[116:119], a[92:95], v[84:87], v[116:119]
    buffer_load_dwordx4 v[248:251], v137, s[24:27], s57 offen offset:0
    buffer_load_dwordx4 v[248:251], v137, s[24:27], s57 offen offset:1024
    v_mfma_f32_16x16x32_bf16 v[120:123], a[92:95], v[88:91], v[120:123]
    s_waitcnt lgkmcnt(2)
    v_mfma_f32_16x16x32_bf16 v[108:111], a[16:19], v[92:95], v[108:111]
    buffer_store_dword v20, v140, s[4:7], 0 offen sc1
    ds_read_b128 v[84:87], v11 offset:12288
    v_mfma_f32_16x16x32_bf16 v[112:115], a[16:19], v[96:99], v[112:115]
    ds_read_b128 v[88:91], v11 offset:14336
    v_mfma_f32_16x16x32_bf16 v[116:119], a[96:99], v[92:95], v[116:119]
    v_mfma_f32_16x16x32_bf16 v[120:123], a[96:99], v[96:99], v[120:123]
    s_waitcnt lgkmcnt(2)
    v_mfma_f32_16x16x32_bf16 v[108:111], a[20:23], v[100:103], v[108:111]
    ds_read_b128 v[92:95], v12 offset:12288
    v_mfma_f32_16x16x32_bf16 v[112:115], a[20:23], v[104:107], v[112:115]
    ds_read_b128 v[96:99], v12 offset:14336
    v_mfma_f32_16x16x32_bf16 v[116:119], a[100:103], v[100:103], v[116:119]
    buffer_store_dword v20, v141, s[4:7], 0 offen sc1
    s_waitcnt vmcnt(4)
    s_cmp_lt_i32 s60, -327680
    s_cbranch_scc1 L_fw_86c
L_fw_86:
    buffer_store_dwordx4 v[148:151], v143, s[4:7], s53 offen offset:0 sc1
    buffer_store_dwordx4 v[152:155], v143, s[4:7], s53 offen offset:1024 sc1
    v_mfma_f32_16x16x32_bf16 v[120:123], a[100:103], v[104:107], v[120:123]
    s_waitcnt lgkmcnt(2)
    v_mfma_f32_16x16x32_bf16 v[108:111], a[24:27], v[84:87], v[108:111]
    ds_read_b128 v[100:103], v11 offset:16384
    v_mfma_f32_16x16x32_bf16 v[112:115], a[24:27], v[88:91], v[112:115]
    ds_read_b128 v[104:107], v11 offset:18432
    v_mfma_f32_16x16x32_bf16 v[116:119], a[104:107], v[84:87], v[116:119]
    v_mfma_f32_16x16x32_bf16 v[120:123], a[104:107], v[88:91], v[120:123]
    s_waitcnt lgkmcnt(2)
    v_mfma_f32_16x16x32_bf16 v[108:111], a[28:31], v[92:95], v[108:111]
    ds_read_b128 v[84:87], v12 offset:16384
    v_mfma_f32_16x16x32_bf16 v[112:115], a[28:31], v[96:99], v[112:115]
    ds_read_b128 v[88:91], v12 offset:18432
    v_mfma_f32_16x16x32_bf16 v[116:119], a[108:111], v[92:95], v[116:119]
    buffer_store_dword v22, v135, s[4:7], s42 offen offset:0 sc1
    buffer_store_dword v22, v135, s[4:7], s42 offen offset:1024 sc1
    v_mfma_f32_16x16x32_bf16 v[120:123], a[108:111], v[96:99], v[120:123]
    s_waitcnt lgkmcnt(2)
    v_mfma_f32_16x16x32_bf16 v[108:111], a[32:35], v[100:103], v[108:111]
    ds_read_b128 v[92:95], v11 offset:20480
    v_mfma_f32_16x16x32_bf16 v[112:115], a[32:35], v[104:107], v[112:115]
    ds_read_b128 v[96:99], v11 offset:22528
    v_mfma_f32_16x16x32_bf16 v[116:119], a[112:115], v[100:103], v[116:119]
    buffer_load_dwordx4 v10, s[24:27], s46 offen offset:0 lds
    s_add_u32 m0, m0, 3968
    v_mfma_f32_16x16x32_bf16 v[120:123], a[112:115], v[104:107], v[120:123]
    s_waitcnt lgkmcnt(2)
    v_mfma_f32_16x16x32_bf16 v[108:111], a[36:39], v[84:87], v[108:111]
    ds_read_b128 v[100:103], v12 offset:20480
    v_mfma_f32_16x16x32_bf16 v[112:115], a[36:39], v[88:91], v[112:115]
    ds_read_b128 v[104:107], v12 offset:22528
    v_mfma_f32_16x16x32_bf16 v[116:119], a[116:119], v[84:87], v[116:119]
    buffer_load_dwordx4 v10, s[24:27], s46 offen offset:128 lds
    s_add_u32 m0, m0, 3968
    v_mfma_f32_16x16x32_bf16 v[120:123], a[116:119], v[88:91], v[120:123]
    s_waitcnt lgkmcnt(2)
    v_mfma_f32_16x16x32_bf16 v[108:111], a[40:43], v[92:95], v[108:111]
    ds_read_b128 v[84:87], v11 offset:24576
    v_mfma_f32_16x16x32_bf16 v[112:115], a[40:43], v[96:99], v[112:115]
    ds_read_b128 v[88:91], v11 offset:26624
    v_mfma_f32_16x16x32_bf16 v[116:119], a[120:123], v[92:95], v[116:119]
    buffer_load_dwordx4 v10, s[24:27], s46 offen offset:256 lds
    s_add_u32 m0, m0, 3968
    v_mfma_f32_16x16x32_bf16 v[120:123], a[120:123], v[96:99], v[120:123]
    s_waitcnt lgkmcnt(2)
    v_mfma_f32_16x16x32_bf16 v[108:111], a[44:47], v[100:103], v[108:111]
    ds_read_b128 v[92:95], v12 offset:24576
    v_mfma_f32_16x16x32_bf16 v[112:115], a[44:47], v[104:107], v[112:115]
    ds_read_b128 v[96:99], v12 offset:26624
    v_mfma_f32_16x16x32_bf16 v[116:119], a[124:127], v[100:103], v[116:119]
    buffer_load_dwordx4 v10, s[24:27], s46 offen offset:384 lds
    s_add_u32 m0, m0, 3968
    v_mfma_f32_16x16x32_bf16 v[120:123], a[124:127], v[104:107], v[120:123]
    s_waitcnt lgkmcnt(2)
    v_mfma_f32_16x16x32_bf16 v[108:111], a[48:51], v[84:87], v[108:111]
    ds_read_b128 v[100:103], v11 offset:28672
    v_mfma_f32_16x16x32_bf16 v[112:115], a[48:51], v[88:91], v[112:115]
    ds_read_b128 v[104:107], v11 offset:30720
    v_mfma_f32_16x16x32_bf16 v[116:119], a[128:131], v[84:87], v[116:119]
    buffer_load_dwordx4 v10, s[24:27], s46 offen offset:512 lds
    s_add_u32 m0, m0, 3968
    v_mfma_f32_16x16x32_bf16 v[120:123], a[128:131], v[88:91], v[120:123]
    s_waitcnt lgkmcnt(2)
    v_mfma_f32_16x16x32_bf16 v[108:111], a[52:55], v[92:95], v[108:111]
    ds_read_b128 v[84:87], v12 offset:28672
    v_mfma_f32_16x16x32_bf16 v[112:115], a[52:55], v[96:99], v[112:115]
    ds_read_b128 v[88:91], v12 offset:30720
    v_mfma_f32_16x16x32_bf16 v[116:119], a[132:135], v[92:95], v[116:119]
    buffer_load_dwordx4 v10, s[24:27], s46 offen offset:640 lds
    s_add_u32 m0, m0, 3968
    v_mfma_f32_16x16x32_bf16 v[120:123], a[132:135], v[96:99], v[120:123]
    s_waitcnt lgkmcnt(2)
    v_mfma_f32_16x16x32_bf16 v[108:111], a[56:59], v[100:103], v[108:111]
    ds_read_b128 v[92:95], v11 offset:32768
    v_mfma_f32_16x16x32_bf16 v[112:115], a[56:59], v[104:107], v[112:115]
    ds_read_b128 v[96:99], v11 offset:34816
    v_mfma_f32_16x16x32_bf16 v[116:119], a[136:139], v[100:103], v[116:119]
    buffer_load_dwordx4 v10, s[24:27], s46 offen offset:768 lds
    s_add_u32 m0, m0, 3968
    v_mfma_f32_16x16x32_bf16 v[120:123], a[136:139], v[104:107], v[120:123]
    s_waitcnt lgkmcnt(2)
    v_mfma_f32_16x16x32_bf16 v[108:111], a[60:63], v[84:87], v[108:111]
    ds_read_b128 v[100:103], v12 offset:32768
    v_mfma_f32_16x16x32_bf16 v[112:115], a[60:63], v[88:91], v[112:115]
    ds_read_b128 v[104:107], v12 offset:34816
    v_mfma_f32_16x16x32_bf16 v[116:119], a[140:143], v[84:87], v[116:119]
    buffer_load_dwordx4 v10, s[24:27], s46 offen offset:896 lds
    s_add_u32 m0, m0, 3968
    v_mfma_f32_16x16x32_bf16 v[120:123], a[140:143], v[88:91], v[120:123]
    s_waitcnt lgkmcnt(2)
    v_mfma_f32_16x16x32_bf16 v[108:111], a[64:67], v[92:95], v[108:111]
    ds_read_b128 v[84:87], v11 offset:36864
    v_mfma_f32_16x16x32_bf16 v[112:115], a[64:67], v[96:99], v[112:115]
    ds_read_b128 v[88:91], v11 offset:38912
    v_mfma_f32_16x16x32_bf16 v[116:119], a[144:147], v[92:95], v[116:119]
    buffer_load_dwordx4 v10, s[24:27], s46 offen offset:1024 lds
    s_add_u32 m0, m0, 3968
    v_mfma_f32_16x16x32_bf16 v[120:123], a[144:147], v[96:99], v[120:123]
    s_waitcnt lgkmcnt(2)
    v_mfma_f32_16x16x32_bf16 v[108:111], a[68:71], v[100:103], v[108:111]
    ds_read_b128 v[92:95], v12 offset:36864
    v_mfma_f32_16x16x32_bf16 v[112:115], a[68:71], v[104:107], v[112:115]
    ds_read_b128 v[96:99], v12 offset:38912
    v_mfma_f32_16x16x32_bf16 v[116:119], a[148:151], v[100:103], v[116:119]
    buffer_load_dwordx4 v10, s[24:27], s46 offen offset:1152 lds
    v_mfma_f32_16x16x32_bf16 v[120:123], a[148:151], v[104:107], v[120:123]
    s_waitcnt lgkmcnt(0)
    v_mfma_f32_16x16x32_bf16 v[108:111], a[72:75], v[84:87], v[108:111]
    v_add_u32 v11, s49, v11
    v_mfma_f32_16x16x32_bf16 v[112:115], a[72:75], v[88:91], v[112:115]
    v_add_u32 v12, s49, v12
    v_mfma_f32_16x16x32_bf16 v[108:111], a[76:79], v[92:95], v[108:111]
    s_sub_u32 s47, s47, s49
    v_mfma_f32_16x16x32_bf16 v[112:115], a[76:79], v[96:99], v[112:115]
    s_sub_u32 s49, 0, s49
    v_mfma_f32_16x16x32_bf16 v[116:119], a[152:155], v[84:87], v[116:119]
    v_mfma_f32_16x16x32_bf16 v[120:123], a[152:155], v[88:91], v[120:123]
    v_mfma_f32_16x16x32_bf16 v[116:119], a[156:159], v[92:95], v[116:119]
    v_mfma_f32_16x16x32_bf16 v[120:123], a[156:159], v[96:99], v[120:123]
    v_cvt_pk_bf16_f32 v124, v108, v109
    v_cvt_pk_bf16_f32 v125, v110, v111
    v_cvt_pk_bf16_f32 v126, v112, v113
    v_cvt_pk_bf16_f32 v127, v114, v115
    s_nop 0
    v_permlane16_swap_b32 v124, v126
    v_permlane16_swap_b32 v125, v127
    v_cvt_pk_bf16_f32 v128, v116, v117
    v_cvt_pk_bf16_f32 v129, v118, v119
    v_cvt_pk_bf16_f32 v130, v120, v121
    v_cvt_pk_bf16_f32 v131, v122, v123
    s_nop 0
    v_permlane16_swap_b32 v128, v130
    v_permlane16_swap_b32 v129, v131
    buffer_store_dwordx4 v[124:127], v19, s[4:7], s44 offen sc1
    buffer_store_dwordx4 v[128:131], v19, s[4:7], s45 offen sc1
    s_waitcnt vmcnt(18)
    s_cmp_lt_i32 s60, 0
    s_cbranch_scc1 L_fin_87
    v_mfma_f32_16x16x32_bf16 v[164:167], a[160:163], v[156:159], 0
    v_mfma_f32_16x16x32_bf16 v[168:171], a[160:163], v[160:163], 0
    s_nop 4
    v_cndmask_b32 v166, v164, v165, s[58:59]
    s_nop 1
    v_cndmask_b32 v170, v168, v169, s[58:59]
    v_cndmask_b32 v167, v165, v164, s[58:59]
    v_cndmask_b32 v171, v169, v168, s[58:59]
    s_nop 0
    v_add_f32_dpp v167, v166, v167 row_ror:8 row_mask:0xf bank_mask:0xf
    v_add_f32_dpp v171, v170, v171 row_ror:8 row_mask:0xf bank_mask:0xf
    v_cvt_pk_bf16_f32 v167, v167, v167
    v_cvt_pk_bf16_f32 v171, v171, v171
    buffer_store_short v167, v145, s[28:31], s60 offen offset:0
    buffer_store_short v171, v145, s[28:31], s60 offen offset:32
L_fin_87:
    s_branch L_v_loop_s
L_end_83:
    s_cmp_lt_i32 s60, 0
    s_cselect_b32 s54, s38, s54
    buffer_load_dwordx4 v[156:159], v144, s[4:7], s54 offen offset:0 sc1
    buffer_load_dwordx4 v[160:163], v144, s[4:7], s54 offen offset:1024 sc1
    s_waitcnt vmcnt(0) lgkmcnt(0)
    s_cmp_lt_i32 s60, 0
    s_cbranch_scc1 L_fin_88
    v_mfma_f32_16x16x32_bf16 v[164:167], a[160:163], v[156:159], 0
    v_mfma_f32_16x16x32_bf16 v[168:171], a[160:163], v[160:163], 0
    s_nop 4
    v_cndmask_b32 v166, v164, v165, s[58:59]
    s_nop 1
    v_cndmask_b32 v170, v168, v169, s[58:59]
    v_cndmask_b32 v167, v165, v164, s[58:59]
    v_cndmask_b32 v171, v169, v168, s[58:59]
    s_nop 0
    v_add_f32_dpp v167, v166, v167 row_ror:8 row_mask:0xf bank_mask:0xf
    v_add_f32_dpp v171, v170, v171 row_ror:8 row_mask:0xf bank_mask:0xf
    v_cvt_pk_bf16_f32 v167, v167, v167
    v_cvt_pk_bf16_f32 v171, v171, v171
    buffer_store_short v167, v145, s[28:31], s60 offen offset:0
    buffer_store_short v171, v145, s[28:31], s60 offen offset:32
L_fin_88:
    s_waitcnt vmcnt(0)
    s_cmp_lg_u32 s55, 0
    s_cbranch_scc1 L_wb_89
    buffer_wbl2 sc1
    s_waitcnt vmcnt(0)
L_wb_89:
    s_endpgm
L_nan_81:
    s_cmp_eq_u32 s52, 1
    s_cbranch_scc1 L_cont_82
    v_lshlrev_b32 v1, 4, v0
L_nan_81r:
    s_mov_b32 s90, s41
    v_mov_b32 v2, 0
    buffer_load_dwordx4 v[28:31], v1, s[4:7], s90 offen sc1
    s_add_u32 s90, s90, 1024
    buffer_load_dwordx4 v[32:35], v1, s[4:7], s90 offen sc1
    s_add_u32 s90, s90, 1024
    buffer_load_dwordx4 v[36:39], v1, s[4:7], s90 offen sc1
    s_add_u32 s90, s90, 1024
    buffer_load_dwordx4 v[40:43], v1, s[4:7], s90 offen sc1
    s_add_u32 s90, s90, 1024
    buffer_load_dwordx4 v[44:47], v1, s[4:7], s90 offen sc1
    s_add_u32 s90, s90, 1024
    buffer_load_dwordx4 v[48:51], v1, s[4:7], s90 offen sc1
    s_add_u32 s90, s90, 1024
    buffer_load_dwordx4 v[52:55], v1, s[4:7], s90 offen sc1
    s_add_u32 s90, s90, 1024
    buffer_load_dwordx4 v[56:59], v1, s[4:7], s90 offen sc1
    s_add_u32 s90, s90, 1024
    buffer_load_dwordx4 v[60:63], v1, s[4:7], s90 offen sc1
    s_add_u32 s90, s90, 1024
    buffer_load_dwordx4 v[64:67], v1, s[4:7], s90 offen sc1
    s_add_u32 s90, s90, 1024
    s_sub_u32 s36, s36, 1
    s_cbranch_scc1 L_exit
    s_waitcnt vmcnt(0) lgkmcnt(0)
    v_max3_u32 v2, v2, v28, v29
    v_max3_u32 v2, v2, v30, v31
    v_max3_u32 v2, v2, v32, v33
    v_max3_u32 v2, v2, v34, v35
    v_max3_u32 v2, v2, v36, v37
    v_max3_u32 v2, v2, v38, v39
    v_max3_u32 v2, v2, v40, v41
    v_max3_u32 v2, v2, v42, v43
    v_max3_u32 v2, v2, v44, v45
    v_max3_u32 v2, v2, v46, v47
    v_max3_u32 v2, v2, v48, v49
    v_max3_u32 v2, v2, v50, v51
    v_max3_u32 v2, v2, v52, v53
    v_max3_u32 v2, v2, v54, v55
    v_max3_u32 v2, v2, v56, v57
    v_max3_u32 v2, v2, v58, v59
    v_max3_u32 v2, v2, v60, v61
    v_max3_u32 v2, v2, v62, v63
    v_max3_u32 v2, v2, v64, v65
    v_max3_u32 v2, v2, v66, v67
    v_cmp_eq_u32 vcc, -1, v2
    s_cbranch_vccnz L_nan_81r
    s_mov_b32 s52, 1
    v_mov_b32 v68, 0
    v_mov_b32 v69, 0
    v_mov_b32 v70, 0
    v_mov_b32 v71, 0
    v_mov_b32 v72, 0
    v_mov_b32 v73, 0
    v_mov_b32 v74, 0
    v_mov_b32 v75, 0
    v_smfmac_f32_16x16x64_bf16 v[68:71], v[28:31], a[0:7], v17
    s_nop 0
    v_smfmac_f32_16x16x64_bf16 v[72:75], v[28:31], a[80:87], v17
    v_smfmac_f32_16x16x64_bf16 v[68:71], v[32:35], a[8:15], v17
    v_smfmac_f32_16x16x64_bf16 v[72:75], v[32:35], a[88:95], v17
    v_smfmac_f32_16x16x64_bf16 v[68:71], v[36:39], a[16:23], v17
    v_smfmac_f32_16x16x64_bf16 v[72:75], v[36:39], a[96:103], v17
    v_smfmac_f32_16x16x64_bf16 v[68:71], v[40:43], a[24:31], v17
    v_smfmac_f32_16x16x64_bf16 v[72:75], v[40:43], a[104:111], v17
    v_smfmac_f32_16x16x64_bf16 v[68:71], v[44:47], a[32:39], v17
    v_smfmac_f32_16x16x64_bf16 v[72:75], v[44:47], a[112:119], v17
    v_smfmac_f32_16x16x64_bf16 v[68:71], v[48:51], a[40:47], v17
    v_smfmac_f32_16x16x64_bf16 v[68:71], v[52:55], a[48:55], v17
    v_smfmac_f32_16x16x64_bf16 v[68:71], v[56:59], a[56:63], v17
    v_smfmac_f32_16x16x64_bf16 v[68:71], v[60:63], a[64:71], v17
    v_smfmac_f32_16x16x64_bf16 v[68:71], v[64:67], a[72:79], v17
    s_nop 2
    s_branch L_redo_79
L_wo_s:
    s_mov_b32 s12, s80
    s_and_b32 s13, s81, 0xffff
    s_mov_b32 s14, 7864320
    s_mov_b32 s15, 0x20000
    s_mov_b32 s16, s72
    s_and_b32 s17, s73, 0xffff
    s_mov_b32 s18, 10240
    s_mov_b32 s19, 0x20000
    s_sub_u32 s40, s35, 18
    v_and_b32 v1, 15, v0
    v_lshrrev_b32 v2, 4, v0
    v_lshrrev_b32 v3, 3, v0
    v_and_b32 v4, 7, v0
    v_and_b32 v6, 2, v3
    v_xor_b32 v6, v6, v4
    v_lshlrev_b32 v6, 4, v6
    v_mul_u32_u24 v7, 1280, v3
    s_lshl_b32 s90, s34, 2
    s_add_u32 s90, s90, s32
    s_mul_i32 s90, s90, 245760
    s_lshl_b32 s91, s40, 7
    s_add_u32 s90, s90, s91
    v_add3_u32 v180, v6, v7, s90
    v_xor_b32 v181, 64, v180
    s_mul_i32 s90, s40, 32768
    s_lshl_b32 s91, s32, 11
    s_add_u32 s90, s90, s91
    s_lshr_b32 s91, s32, 1
    s_mul_i32 s91, s91, 0
    s_xor_b32 s91, s91, s34
    v_mul_u32_u24 v7, 0, v2
    v_xor_b32 v7, s91, v7
    v_lshlrev_b32 v6, 4, v1
    v_lshl_add_u32 v7, v7, 8, v6
    v_lshl_add_u32 v7, v2, 13, v7
    v_add_u32 v14, s90, v7
    v_lshlrev_b32 v12, 4, v0
    v_lshlrev_b32 v13, 2, v0
    v_add_u32 v46, s90, v13
    s_xor_b32 s92, s91, 0
    s_lshl_b32 s92, s92, 8
    s_add_u32 s60, s92, 0
    s_xor_b32 s92, s91, 0
    s_lshl_b32 s92, s92, 8
    s_add_u32 s61, s92, 8192
    s_xor_b32 s92, s91, 0
    s_lshl_b32 s92, s92, 8
    s_add_u32 s62, s92, 16384
    s_xor_b32 s92, s91, 0
    s_lshl_b32 s92, s92, 8
    s_add_u32 s63, s92, 24576
    v_cmp_gt_u32 vcc, 2, v2
    v_mov_b32 v9, 2146435072
    s_nop 0
    v_cndmask_b32 v14, v9, v14, vcc
    s_lshl_b32 s92, s40, 7
    s_lshl_b32 s93, s32, 2
    s_add_u32 s92, s92, s93
    s_add_u32 s92, s92, 460800
    v_mov_b32 v244, s92
    v_cmp_eq_u32 vcc, 0, v0
    v_mov_b32 v9, 2146435072
    s_nop 0
    v_cndmask_b32 v244, v9, v244, vcc
    s_lshl_b32 s92, s32, 7
    s_add_u32 s92, s92, 462336
    v_min_u32 v3, 5, v0
    v_lshl_add_u32 v245, v3, 2, s92
    s_lshl_b32 s90, s40, 2
    s_add_u32 s90, s90, s32
    s_lshl_b32 s91, s90, 8
    v_add_u32 v17, s91, v6
    v_cmp_eq_u32 vcc, 0, v2
    v_mov_b32 v9, 2146435072
    s_nop 0
    v_cndmask_b32 v17, v9, v17, vcc
    v_lshrrev_b32 v3, 2, v1
    v_and_b32 v7, 1, v1
    v_lshl_or_b32 v4, v3, 1, v7
    v_mul_u32_u24 v4, 1280, v4
    v_and_b32 v5, 2, v1
    v_lshl_add_u32 v4, v5, 1, v4
    s_lshl_b32 s91, s90, 5
    v_add_u32 v4, s91, v4
    v_lshlrev_b32 v6, 6, v3
    v_lshl_add_u32 v6, v7, 5, v6
    v_lshl_add_u32 v6, v2, 3, v6
    v_lshl_add_u32 v6, v5, 1, v6
    s_mul_i32 s92, s32, 1152
    s_add_u32 s92, s92, 122880
    v_add_u32 v18, s92, v6
    buffer_load_dword v164, v4, s[16:19], 0 offen offset:0
    buffer_load_dword v165, v4, s[16:19], 0 offen offset:8
    buffer_load_dword v166, v4, s[16:19], 0 offen offset:16
    buffer_load_dword v167, v4, s[16:19], 0 offen offset:24
    v_mov_b32 v168, -1
    v_mov_b32 v169, -1
    v_mov_b32 v170, -1
    v_mov_b32 v171, -1
    s_mul_i32 s90, s32, 24576
    s_mov_b32 m0, s90
    s_mov_b32 s91, 0
    buffer_load_dwordx4 v180, s[12:15], s91 offen nt lds
    s_add_u32 m0, m0, 1024
    s_add_u32 s91, s91, 10240
    buffer_load_dwordx4 v181, s[12:15], s91 offen nt lds
    s_add_u32 m0, m0, 1024
    s_add_u32 s91, s91, 10240
    buffer_load_dwordx4 v180, s[12:15], s91 offen nt lds
    s_add_u32 m0, m0, 1024
    s_add_u32 s91, s91, 10240
    buffer_load_dwordx4 v181, s[12:15], s91 offen nt lds
    s_add_u32 m0, m0, 1024
    s_add_u32 s91, s91, 10240
    buffer_load_dwordx4 v180, s[12:15], s91 offen nt lds
    s_add_u32 m0, m0, 1024
    s_add_u32 s91, s91, 10240
    buffer_load_dwordx4 v181, s[12:15], s91 offen nt lds
    s_add_u32 m0, m0, 1024
    s_add_u32 s91, s91, 10240
    buffer_load_dwordx4 v180, s[12:15], s91 offen nt lds
    s_add_u32 m0, m0, 1024
    s_add_u32 s91, s91, 10240
    buffer_load_dwordx4 v181, s[12:15], s91 offen nt lds
    s_add_u32 m0, m0, 1024
    s_add_u32 s91, s91, 10240
    buffer_load_dwordx4 v180, s[12:15], s91 offen nt lds
    s_add_u32 m0, m0, 1024
    s_add_u32 s91, s91, 10240
    buffer_load_dwordx4 v181, s[12:15], s91 offen nt lds
    s_add_u32 m0, m0, 1024
    s_add_u32 s91, s91, 10240
    buffer_load_dwordx4 v180, s[12:15], s91 offen nt lds
    s_add_u32 m0, m0, 1024
    s_add_u32 s91, s91, 10240
    buffer_load_dwordx4 v181, s[12:15], s91 offen nt lds
    s_add_u32 m0, m0, 1024
    s_add_u32 s91, s91, 10240
    buffer_load_dwordx4 v180, s[12:15], s91 offen nt lds
    s_add_u32 m0, m0, 1024
    s_add_u32 s91, s91, 10240
    buffer_load_dwordx4 v181, s[12:15], s91 offen nt lds
    s_add_u32 m0, m0, 1024
    s_add_u32 s91, s91, 10240
    buffer_load_dwordx4 v180, s[12:15], s91 offen nt lds
    s_add_u32 m0, m0, 1024
    s_add_u32 s91, s91, 10240
    buffer_load_dwordx4 v181, s[12:15], s91 offen nt lds
    s_add_u32 m0, m0, 1024
    s_add_u32 s91, s91, 10240
    buffer_load_dwordx4 v180, s[12:15], s91 offen nt lds
    s_add_u32 m0, m0, 1024
    s_add_u32 s91, s91, 10240
    buffer_load_dwordx4 v181, s[12:15], s91 offen nt lds
    s_add_u32 m0, m0, 1024
    s_add_u32 s91, s91, 10240
    buffer_load_dwordx4 v180, s[12:15], s91 offen nt lds
    s_add_u32 m0, m0, 1024
    s_add_u32 s91, s91, 10240
    buffer_load_dwordx4 v181, s[12:15], s91 offen nt lds
    s_add_u32 m0, m0, 1024
    s_add_u32 s91, s91, 10240
    buffer_load_dwordx4 v180, s[12:15], s91 offen nt lds
    s_add_u32 m0, m0, 1024
    s_add_u32 s91, s91, 10240
    buffer_load_dwordx4 v181, s[12:15], s91 offen nt lds
    s_add_u32 m0, m0, 1024
    s_add_u32 s91, s91, 10240
    buffer_load_dwordx4 v180, s[12:15], s91 offen nt lds
    s_add_u32 m0, m0, 1024
    s_add_u32 s91, s91, 10240
    buffer_load_dwordx4 v181, s[12:15], s91 offen nt lds
    s_waitcnt vmcnt(24)
    v_min_u32 v164, -2, v164
    v_min_u32 v165, -2, v165
    v_min_u32 v166, -2, v166
    v_min_u32 v167, -2, v167
    v_and_b32 v7, 2, v1
    v_cmp_ne_u32 vcc, 0, v7
    v_mov_b32 v5, 0x4444
    v_mov_b32 v6, 0xeeee
    v_cndmask_b32 v10, v5, v6, vcc
    v_mov_b32 v5, 0xe484
    v_mov_b32 v6, 0xee9e
    v_cndmask_b32 v7, v5, v6, vcc
    v_mov_b32 v5, 0x84e4
    v_mov_b32 v6, 0x9eee
    v_cndmask_b32 v8, v5, v6, vcc
    v_cmp_gt_u32 vcc, 2, v2
    s_nop 1
    v_cndmask_b32 v11, v8, v7, vcc
    v_mov_b32 v84, 1065369472
    v_mov_b32 v85, 1065369472
    v_mov_b32 v86, 1065369472
    v_mov_b32 v87, 0
    v_mov_b32 v88, 1065369472
    v_mov_b32 v89, 1065369472
    v_mov_b32 v90, 1065369472
    v_mov_b32 v91, 0
    v_mov_b32 v51, 0
    v_mov_b32 v55, 0
    v_mov_b32 v59, 0
    v_mov_b32 v63, 0
    v_mov_b32 v67, 0
    v_mov_b32 v71, 0
    v_mov_b32 v75, 0
    v_mov_b32 v79, 0
    v_mov_b32 v210, 0
    v_mov_b32 v211, 0
    v_mov_b32 v218, 0
    v_mov_b32 v219, 0
    v_and_b32 v7, 1, v1
    v_cmp_ne_u32 vcc, 0, v7
    v_mov_b32 v5, 0x3f80
    v_mov_b32 v6, 0x3f800000
    v_cndmask_b32 v5, v5, v6, vcc
    v_bfe_u32 v6, v1, 1, 1
    v_cmp_eq_u32 vcc, 0, v6
    s_nop 1
    v_cndmask_b32 v110, 0, v5, vcc
    v_mov_b32 v108, 0
    v_mov_b32 v112, 0
    v_cmp_eq_u32 vcc, 1, v6
    s_nop 1
    v_cndmask_b32 v111, 0, v5, vcc
    v_mov_b32 v109, 0
    v_mov_b32 v113, 0
    v_mov_b32 v240, 0x3dd53b95
    v_mov_b32 v241, 0x3dd53b95
    s_lshl_b32 s90, s32, 8
    s_add_u32 s90, s90, 122880
    v_mul_u32_u24 v6, 1152, v2
    v_lshl_add_u32 v6, v1, 3, v6
    v_add_u32 v19, s90, v6
    s_mul_i32 s90, s32, 1536
    v_add_u32 v20, s90, v12
    s_add_u32 s90, s90, 1024
    v_lshl_add_u32 v21, v0, 3, s90
    s_mul_i32 s90, s32, 6144
    v_add_u32 v22, s90, v12
    s_add_u32 s90, s90, 1024
    v_lshl_add_u32 v23, v0, 3, s90
    v_add_u32 v28, 98304, v12
    s_mul_i32 s90, s32, 3072
    v_add_u32 v37, s90, v12
    v_add_u32 v44, 25600, v37
    s_add_u32 s54, s90, 98304
    s_mul_i32 s90, s32, 3840
    s_add_u32 s90, s90, 10240
    v_add_u32 v38, s90, v12
    s_add_u32 s90, s90, 1024
    v_add_u32 v39, s90, v13
    s_mul_i32 s90, s32, 12288
    v_add_u32 v40, s90, v12
    s_lshl_b32 s93, s40, 2
    s_add_u32 s93, s93, s32
    s_nop 0
    s_lshr_b32 s90, s93, 2
    s_lshl_b32 s90, s90, 15
    s_and_b32 s92, s93, 3
    s_lshl_b32 s92, s92, 10
    s_add_u32 s90, s90, s92
    v_mov_b32 v5, s34
    v_and_b32 v6, 7, v1
    v_lshlrev_b32 v6, 4, v6
    v_lshl_add_u32 v6, v5, 7, v6
    v_lshrrev_b32 v7, 3, v1
    v_lshl_add_u32 v6, v7, 12, v6
    v_lshrrev_b32 v5, 1, v2
    v_lshl_add_u32 v6, v5, 13, v6
    v_and_b32 v5, 1, v2
    v_lshl_add_u32 v6, v5, 14, v6
    v_add_u32 v30, s90, v6
    s_and_b32 s91, s34, 1
    s_lshl_b32 s91, s91, 12
    s_add_u32 s90, s90, s91
    s_lshr_b32 s91, s34, 2
    s_lshl_b32 s91, s91, 13
    s_add_u32 s90, s90, s91
    s_and_b32 s91, s34, 2
    s_lshl_b32 s91, s91, 13
    s_add_u32 s90, s90, s91
    v_lshl_add_u32 v31, v0, 4, s90
    s_lshl_b32 s91, s93, 10
    s_add_u32 s91, s91, 884736
    v_lshl_add_u32 v15, v0, 4, s91
    s_lshr_b32 s91, s34, 1
    s_mul_i32 s91, s91, 10240
    s_lshl_b32 s92, s93, 5
    s_add_u32 s91, s91, s92
    s_and_b32 s92, s34, 1
    s_mul_i32 s92, s92, 40960
    s_add_u32 s91, s91, s92
    s_add_u32 s91, s91, 1280
    v_mul_u32_u24 v6, 2560, v2
    v_lshl_add_u32 v6, v1, 1, v6
    v_add_u32 v32, s91, v6
    v_cmp_gt_u32 s[58:59], 8, v1
    v_and_b32 v5, 1, v1
    v_lshrrev_b32 v6, 3, v1
    v_lshl_add_u32 v5, v5, 1, v6
    v_bfe_u32 v6, v1, 2, 1
    v_cmp_ne_u32 vcc, 0, v6
    v_mov_b32 v6, 0x3f80
    v_mov_b32 v7, 0x3f800000
    v_cndmask_b32 v6, v6, v7, vcc
    v_cmp_eq_u32 vcc, 0, v5
    s_nop 1
    v_cndmask_b32 v7, 0, v6, vcc
    v_accvgpr_write_b32 a144, v7
    v_cmp_eq_u32 vcc, 1, v5
    s_nop 1
    v_cndmask_b32 v7, 0, v6, vcc
    v_accvgpr_write_b32 a145, v7
    v_cmp_eq_u32 vcc, 2, v5
    s_nop 1
    v_cndmask_b32 v7, 0, v6, vcc
    v_accvgpr_write_b32 a146, v7
    v_cmp_eq_u32 vcc, 3, v5
    s_nop 1
    v_cndmask_b32 v7, 0, v6, vcc
    v_accvgpr_write_b32 a147, v7
    s_lshl_b32 s90, s32, 7
    v_add_u32 v5, s90, v13
    v_add_u32 v6, 458752, v5
    v_add_u32 v7, 459728, v5
    v_cmp_gt_u32 vcc, 12, v0
    s_nop 1
    v_cndmask_b32 v33, v7, v6, vcc
    v_mov_b32 v5, -2
    v_cndmask_b32 v34, v5, 3, vcc
    v_cmp_gt_u32 vcc, 14, v0
    v_mov_b32 v9, 2146435072
    s_nop 0
    v_cndmask_b32 v33, v9, v33, vcc
    v_mov_b32 v5, -1000
    v_cndmask_b32 v34, v5, v34, vcc
    v_and_b32 v4, 3, v1
    v_lshlrev_b32 v6, 6, v4
    v_lshl_add_u32 v6, v3, 3, v6
    v_lshl_add_u32 v6, v2, 8, v6
    v_and_b32 v5, 1, v2
    v_lshl_add_u32 v6, v5, 5, v6
    s_mul_i32 s90, s32, 3072
    s_add_u32 s53, s90, 131072
    v_add_u32 v16, s53, v6
    v_xor_b32 v13, 32, v16
    v_and_b32 v4, 3, v1
    v_and_b32 v5, 1, v2
    v_lshl_add_u32 v6, v2, 3, v3
    v_lshlrev_b32 v6, 7, v6
    v_and_b32 v7, 2, v3
    v_lshl_or_b32 v7, v5, 2, v7
    v_lshrrev_b32 v8, 1, v4
    v_xor_b32 v7, v7, v8
    v_lshl_add_u32 v6, v7, 4, v6
    v_and_b32 v7, 1, v4
    v_lshl_add_u32 v6, v7, 3, v6
    s_mul_i32 s90, s32, 24576
    v_add_u32 v6, s90, v6
    v_xor_b32 v182, 0, v6
    v_xor_b32 v183, 32, v6
    v_xor_b32 v184, 64, v6
    v_xor_b32 v185, 96, v6
    s_waitcnt vmcnt(0)
    ds_read_b64_tr_b16 a[0:1], v182 offset:0
    ds_read_b64_tr_b16 a[2:3], v182 offset:512
    ds_read_b64_tr_b16 a[4:5], v182 offset:4096
    ds_read_b64_tr_b16 a[6:7], v182 offset:4608
    ds_read_b64_tr_b16 a[8:9], v182 offset:8192
    ds_read_b64_tr_b16 a[10:11], v182 offset:8704
    ds_read_b64_tr_b16 a[12:13], v182 offset:12288
    ds_read_b64_tr_b16 a[14:15], v182 offset:12800
    ds_read_b64_tr_b16 a[16:17], v182 offset:16384
    ds_read_b64_tr_b16 a[18:19], v182 offset:16896
    ds_read_b64_tr_b16 a[20:21], v182 offset:20480
    ds_read_b64_tr_b16 a[22:23], v182 offset:20992
    ds_read_b64_tr_b16 a[24:25], v183 offset:0
    ds_read_b64_tr_b16 a[26:27], v183 offset:512
    ds_read_b64_tr_b16 a[28:29], v183 offset:4096
    ds_read_b64_tr_b16 a[30:31], v183 offset:4608
    ds_read_b64_tr_b16 a[32:33], v183 offset:8192
    ds_read_b64_tr_b16 a[34:35], v183 offset:8704
    ds_read_b64_tr_b16 a[36:37], v183 offset:12288
    ds_read_b64_tr_b16 a[38:39], v183 offset:12800
    ds_read_b64_tr_b16 a[40:41], v183 offset:16384
    ds_read_b64_tr_b16 a[42:43], v183 offset:16896
    ds_read_b64_tr_b16 a[44:45], v183 offset:20480
    ds_read_b64_tr_b16 a[46:47], v183 offset:20992
    ds_read_b64_tr_b16 a[48:49], v184 offset:0
    ds_read_b64_tr_b16 a[50:51], v184 offset:512
    ds_read_b64_tr_b16 a[52:53], v184 offset:4096
    ds_read_b64_tr_b16 a[54:55], v184 offset:4608
    ds_read_b64_tr_b16 a[56:57], v184 offset:8192
    ds_read_b64_tr_b16 a[58:59], v184 offset:8704
    ds_read_b64_tr_b16 a[60:61], v184 offset:12288
    ds_read_b64_tr_b16 a[62:63], v184 offset:12800
    ds_read_b64_tr_b16 a[64:65], v184 offset:16384
    ds_read_b64_tr_b16 a[66:67], v184 offset:16896
    ds_read_b64_tr_b16 a[68:69], v184 offset:20480
    ds_read_b64_tr_b16 a[70:71], v184 offset:20992
    ds_read_b64_tr_b16 a[72:73], v185 offset:0
    ds_read_b64_tr_b16 a[74:75], v185 offset:512
    ds_read_b64_tr_b16 a[76:77], v185 offset:4096
    ds_read_b64_tr_b16 a[78:79], v185 offset:4608
    ds_read_b64_tr_b16 a[80:81], v185 offset:8192
    ds_read_b64_tr_b16 a[82:83], v185 offset:8704
    ds_read_b64_tr_b16 a[84:85], v185 offset:12288
    ds_read_b64_tr_b16 a[86:87], v185 offset:12800
    ds_read_b64_tr_b16 a[88:89], v185 offset:16384
    ds_read_b64_tr_b16 a[90:91], v185 offset:16896
    ds_read_b64_tr_b16 a[92:93], v185 offset:20480
    ds_read_b64_tr_b16 a[94:95], v185 offset:20992
    s_waitcnt lgkmcnt(0)
    s_barrier
    v_mov_b32 v1, 196
L_gw_90:
    buffer_load_dword v2, v1, s[8:11], 0 offen sc1
    s_sub_u32 s36, s36, 1
    s_cbranch_scc1 L_exit
    s_waitcnt vmcnt(0)
    v_readfirstlane_b32 s90, v2
    s_nop 0
    s_cmp_eq_u32 s90, 0
    s_cbranch_scc1 L_gw_90
    buffer_store_dwordx4 v[164:167], v17, s[4:7], s38 offen sc1
    s_mov_b32 s37, -1
    v_add_u32 v35, -2, v34
    s_add_u32 s45, s38, 65536
    s_add_u32 s46, s45, 4096
    s_add_u32 s47, s45, 8192
    v_mov_b32 v24, v20
    v_mov_b32 v25, v21
    buffer_load_dword v36, v33, s[4:7], s38 offen sc1
    s_waitcnt vmcnt(0)
    v_cmp_lt_i32 vcc, v36, v35
    s_cbranch_vccz L_fok_92
L_fw_91:
    buffer_load_dword v36, v33, s[4:7], s38 offen sc1
    s_sub_u32 s36, s36, 1
    s_cbranch_scc1 L_exit
    s_waitcnt vmcnt(0)
    v_cmp_lt_i32 vcc, v36, v35
    s_cbranch_vccnz L_fw_91
L_fok_92:
    buffer_load_dwordx4 a[96:99], v40, s[4:7], s45 offen offset:0 sc1
    buffer_load_dwordx4 a[100:103], v40, s[4:7], s45 offen offset:1024 sc1
    buffer_load_dwordx4 a[104:107], v40, s[4:7], s45 offen offset:2048 sc1
    buffer_load_dwordx4 a[108:111], v40, s[4:7], s45 offen offset:3072 sc1
    buffer_load_dwordx4 a[112:115], v40, s[4:7], s46 offen offset:0 sc1
    buffer_load_dwordx4 a[116:119], v40, s[4:7], s46 offen offset:1024 sc1
    buffer_load_dwordx4 a[120:123], v40, s[4:7], s46 offen offset:2048 sc1
    buffer_load_dwordx4 a[124:127], v40, s[4:7], s46 offen offset:3072 sc1
    buffer_load_dwordx4 a[128:131], v40, s[4:7], s47 offen offset:0 sc1
    buffer_load_dwordx4 a[132:135], v40, s[4:7], s47 offen offset:1024 sc1
    buffer_load_dwordx4 a[136:139], v40, s[4:7], s47 offen offset:2048 sc1
    buffer_load_dwordx4 a[140:143], v40, s[4:7], s47 offen offset:3072 sc1
    s_waitcnt vmcnt(0)
    v_mfma_f32_16x16x32_bf16 v[148:151], a[96:99], a[0:3], 0
    v_mfma_f32_16x16x32_bf16 v[152:155], a[120:123], a[0:3], 0
    v_mfma_f32_16x16x32_bf16 v[156:159], a[96:99], a[24:27], 0
    v_mfma_f32_16x16x32_bf16 v[160:163], a[120:123], a[24:27], 0
    v_mfma_f32_16x16x32_bf16 v[180:183], a[96:99], a[48:51], 0
    v_mfma_f32_16x16x32_bf16 v[184:187], a[120:123], a[48:51], 0
    v_mfma_f32_16x16x32_bf16 v[188:191], a[96:99], a[72:75], 0
    v_mfma_f32_16x16x32_bf16 v[192:195], a[120:123], a[72:75], 0
    v_mfma_f32_16x16x32_bf16 v[148:151], a[100:103], a[4:7], v[148:151]
    v_mfma_f32_16x16x32_bf16 v[152:155], a[124:127], a[4:7], v[152:155]
    v_mfma_f32_16x16x32_bf16 v[156:159], a[100:103], a[28:31], v[156:159]
    v_mfma_f32_16x16x32_bf16 v[160:163], a[124:127], a[28:31], v[160:163]
    v_mfma_f32_16x16x32_bf16 v[180:183], a[100:103], a[52:55], v[180:183]
    v_mfma_f32_16x16x32_bf16 v[184:187], a[124:127], a[52:55], v[184:187]
    v_mfma_f32_16x16x32_bf16 v[188:191], a[100:103], a[76:79], v[188:191]
    v_mfma_f32_16x16x32_bf16 v[192:195], a[124:127], a[76:79], v[192:195]
    v_mfma_f32_16x16x32_bf16 v[148:151], a[104:107], a[8:11], v[148:151]
    v_mfma_f32_16x16x32_bf16 v[152:155], a[128:131], a[8:11], v[152:155]
    v_mfma_f32_16x16x32_bf16 v[156:159], a[104:107], a[32:35], v[156:159]
    v_mfma_f32_16x16x32_bf16 v[160:163], a[128:131], a[32:35], v[160:163]
    v_mfma_f32_16x16x32_bf16 v[180:183], a[104:107], a[56:59], v[180:183]
    v_mfma_f32_16x16x32_bf16 v[184:187], a[128:131], a[56:59], v[184:187]
    v_mfma_f32_16x16x32_bf16 v[188:191], a[104:107], a[80:83], v[188:191]
    v_mfma_f32_16x16x32_bf16 v[192:195], a[128:131], a[80:83], v[192:195]
    v_mfma_f32_16x16x32_bf16 v[148:151], a[108:111], a[12:15], v[148:151]
    v_mfma_f32_16x16x32_bf16 v[152:155], a[132:135], a[12:15], v[152:155]
    v_mfma_f32_16x16x32_bf16 v[156:159], a[108:111], a[36:39], v[156:159]
    v_mfma_f32_16x16x32_bf16 v[160:163], a[132:135], a[36:39], v[160:163]
    v_mfma_f32_16x16x32_bf16 v[180:183], a[108:111], a[60:63], v[180:183]
    v_mfma_f32_16x16x32_bf16 v[184:187], a[132:135], a[60:63], v[184:187]
    v_mfma_f32_16x16x32_bf16 v[188:191], a[108:111], a[84:87], v[188:191]
    v_mfma_f32_16x16x32_bf16 v[192:195], a[132:135], a[84:87], v[192:195]
    v_mfma_f32_16x16x32_bf16 v[148:151], a[112:115], a[16:19], v[148:151]
    v_mfma_f32_16x16x32_bf16 v[152:155], a[136:139], a[16:19], v[152:155]
    v_mfma_f32_16x16x32_bf16 v[156:159], a[112:115], a[40:43], v[156:159]
    v_mfma_f32_16x16x32_bf16 v[160:163], a[136:139], a[40:43], v[160:163]
    v_mfma_f32_16x16x32_bf16 v[180:183], a[112:115], a[64:67], v[180:183]
    v_mfma_f32_16x16x32_bf16 v[184:187], a[136:139], a[64:67], v[184:187]
    v_mfma_f32_16x16x32_bf16 v[188:191], a[112:115], a[88:91], v[188:191]
    v_mfma_f32_16x16x32_bf16 v[192:195], a[136:139], a[88:91], v[192:195]
    v_mfma_f32_16x16x32_bf16 v[148:151], a[116:119], a[20:23], v[148:151]
    v_mfma_f32_16x16x32_bf16 v[152:155], a[140:143], a[20:23], v[152:155]
    v_mfma_f32_16x16x32_bf16 v[156:159], a[116:119], a[44:47], v[156:159]
    v_mfma_f32_16x16x32_bf16 v[160:163], a[140:143], a[44:47], v[160:163]
    v_mfma_f32_16x16x32_bf16 v[180:183], a[116:119], a[68:71], v[180:183]
    v_mfma_f32_16x16x32_bf16 v[184:187], a[140:143], a[68:71], v[184:187]
    v_mfma_f32_16x16x32_bf16 v[188:191], a[116:119], a[92:95], v[188:191]
    v_mfma_f32_16x16x32_bf16 v[192:195], a[140:143], a[92:95], v[192:195]
    v_cvt_pk_bf16_f32 v64, v180, v181
    v_cvt_pk_bf16_f32 v65, v182, v183
    ds_write_b64 v24, v[64:65] offset:12288
    v_cvt_pk_bf16_f32 v68, v184, v185
    v_cvt_pk_bf16_f32 v69, v186, v187
    ds_write_b64 v25, v[68:69] offset:12288
    v_cvt_pk_bf16_f32 v72, v188, v189
    v_cvt_pk_bf16_f32 v73, v190, v191
    ds_write_b64 v24, v[72:73] offset:18432
    v_cvt_pk_bf16_f32 v76, v192, v193
    v_cvt_pk_bf16_f32 v77, v194, v195
    ds_write_b64 v25, v[76:77] offset:18432
    v_cvt_pk_bf16_f32 v48, v148, v149
    v_cvt_pk_bf16_f32 v49, v150, v151
    ds_write_b64 v24, v[48:49] offset:0
    v_cvt_pk_bf16_f32 v52, v152, v153
    v_cvt_pk_bf16_f32 v53, v154, v155
    ds_write_b64 v25, v[52:53] offset:0
    v_cvt_pk_bf16_f32 v56, v156, v157
    v_cvt_pk_bf16_f32 v57, v158, v159
    ds_write_b64 v24, v[56:57] offset:6144
    v_cvt_pk_bf16_f32 v60, v160, v161
    v_cvt_pk_bf16_f32 v61, v162, v163
    ds_write_b64 v25, v[60:61] offset:6144
    s_add_u32 s56, s37, 2
    s_and_b32 s55, s56, 3
    s_mul_i32 s55, s55, 114688
    s_add_u32 s55, s55, 65536
    s_add_u32 s45, s38, s55
    s_add_u32 s46, s45, 4096
    s_add_u32 s47, s45, 8192
    s_add_u32 s56, s37, -1
    s_and_b32 s55, s56, 3
    s_mul_i32 s55, s55, 114688
    s_add_u32 s55, s55, 53248
    s_add_u32 s48, s38, s55
    s_and_b32 s55, s56, 1
    s_add_u32 s56, s56, 1
    v_mov_b32 v35, -16
    v_writelane_b32 v35, s56, 12
    s_mul_i32 s55, s55, 12288
    s_add_u32 m0, s54, s55
    v_add_u32 v35, -1, v34
    buffer_load_dword v36, v33, s[4:7], s38 offen sc1
    s_waitcnt vmcnt(0)
    v_cmp_lt_i32 vcc, v36, v35
    s_cbranch_vccz L_fok_94
L_fw_93:
    buffer_load_dword v36, v33, s[4:7], s38 offen sc1
    s_sub_u32 s36, s36, 1
    s_cbranch_scc1 L_exit
    s_waitcnt vmcnt(0)
    v_cmp_lt_i32 vcc, v36, v35
    s_cbranch_vccnz L_fw_93
L_fok_94:
    buffer_load_dwordx4 a[96:99], v40, s[4:7], s45 offen offset:0 sc1
    buffer_load_dwordx4 a[100:103], v40, s[4:7], s45 offen offset:1024 sc1
    buffer_load_dwordx4 a[104:107], v40, s[4:7], s45 offen offset:2048 sc1
    buffer_load_dwordx4 a[108:111], v40, s[4:7], s45 offen offset:3072 sc1
    buffer_load_dwordx4 a[112:115], v40, s[4:7], s46 offen offset:0 sc1
    buffer_load_dwordx4 a[116:119], v40, s[4:7], s46 offen offset:1024 sc1
    buffer_load_dwordx4 a[120:123], v40, s[4:7], s46 offen offset:2048 sc1
    buffer_load_dwordx4 a[124:127], v40, s[4:7], s46 offen offset:3072 sc1
    buffer_load_dwordx4 a[128:131], v40, s[4:7], s47 offen offset:0 sc1
    buffer_load_dwordx4 a[132:135], v40, s[4:7], s47 offen offset:1024 sc1
    buffer_load_dwordx4 a[136:139], v40, s[4:7], s47 offen offset:2048 sc1
    buffer_load_dwordx4 a[140:143], v40, s[4:7], s47 offen offset:3072 sc1
    s_mov_b32 s50, s42
    s_add_u32 s56, s37, 1
    v_mov_b32 v47, v24
    s_and_b32 s55, s56, 3
    s_mul_i32 s41, s55, 327680
    s_mul_i32 s56, s55, 114688
    s_add_u32 s43, s38, s56
    s_xor_b32 s55, s55, 2
    s_mul_i32 s42, s55, 327680
    s_add_u32 s56, s37, 2
    v_mov_b32 v107, s56
    s_and_b32 s55, s56, 3
    s_mul_i32 s44, s55, 24576
    s_add_u32 s56, s37, -1
    s_and_b32 s55, s56, 3
    s_mul_i32 s55, s55, 40960
    s_add_u32 s49, s55, s38
    s_add_u32 s56, s37, -1
    s_and_b32 s55, s56, 3
    s_mul_i32 s55, s55, 24576
    v_add_u32 v26, s55, v22
    v_add_u32 v27, s55, v23
    s_and_b32 s55, s56, 1
    s_mul_i32 s55, s55, 12288
    v_add_u32 v29, s55, v28
    s_add_u32 s37, s37, 1
    s_mov_b32 m0, s53
    v_add_u32 v24, s44, v20
    v_add_u32 v25, s44, v21
    v_pk_mul_f32 v[148:149], v[210:211], v[210:211]
    v_pk_mul_f32 v[150:151], v[210:211], v[210:211]
    v_pk_mul_f32 v[152:153], v[210:211], v[210:211]
    v_pk_mul_f32 v[154:155], v[210:211], v[210:211]
    v_pk_mul_f32 v[156:157], v[210:211], v[210:211]
    v_pk_mul_f32 v[158:159], v[210:211], v[210:211]
    v_pk_mul_f32 v[160:161], v[210:211], v[210:211]
    v_pk_mul_f32 v[162:163], v[210:211], v[210:211]
    v_mov_b32 v120, 0
    v_mov_b32 v121, 0
    v_mov_b32 v122, 0
    v_mov_b32 v123, 0
    v_mov_b32 v124, 0
    v_mov_b32 v125, 0
    v_mov_b32 v126, 0
    v_mov_b32 v127, 0
    v_mov_b32 v128, 0
    v_mov_b32 v129, 0
    v_mov_b32 v130, 0
    v_mov_b32 v131, 0
    v_mov_b32 v132, 0
    v_mov_b32 v133, 0
    v_mov_b32 v134, 0
    v_mov_b32 v135, 0
    v_mov_b32 v116, 0
    v_mov_b32 v117, 0
    v_mov_b32 v118, 0
    v_mov_b32 v119, 0
L_wo_loop_s:
    buffer_load_dword v41, v245, s[4:7], s38 offen sc1
    buffer_load_dword v41, v245, s[4:7], s38 offen sc1
    buffer_load_dword v41, v245, s[4:7], s38 offen sc1
    buffer_load_dword v41, v245, s[4:7], s38 offen sc1
    buffer_load_dword v41, v245, s[4:7], s38 offen sc1
    buffer_load_dword v41, v245, s[4:7], s38 offen sc1
L_sp_98:
    s_waitcnt vmcnt(5)
    v_cmp_ge_u32 vcc, s37, v41
    buffer_load_dword v41, v245, s[4:7], s38 offen sc1
    s_sub_u32 s36, s36, 1
    s_cbranch_scc1 L_exit
    s_cbranch_vccz L_sp_98x
    s_waitcnt vmcnt(5)
    v_cmp_ge_u32 vcc, s37, v41
    buffer_load_dword v41, v245, s[4:7], s38 offen sc1
    s_cbranch_vccz L_sp_98x
    s_waitcnt vmcnt(5)
    v_cmp_ge_u32 vcc, s37, v41
    buffer_load_dword v41, v245, s[4:7], s38 offen sc1
    s_cbranch_vccz L_sp_98x
    s_waitcnt vmcnt(5)
    v_cmp_ge_u32 vcc, s37, v41
    buffer_load_dword v41, v245, s[4:7], s38 offen sc1
    s_cbranch_vccnz L_sp_98
L_sp_98x:
    buffer_load_dwordx4 v44, s[4:7], s43 offen offset:0 sc1 lds
    buffer_load_dwordx4 v44, s[4:7], s43 offen offset:1024 sc1 lds
    buffer_load_dwordx4 v44, s[4:7], s43 offen offset:2048 sc1 lds
    s_waitcnt vmcnt(2)
    ds_read_b64_tr_b16 v[136:137], v16 offset:0
    ds_read_b64_tr_b16 v[138:139], v13 offset:0
    s_waitcnt vmcnt(1)
    ds_read_b64_tr_b16 v[140:141], v16 offset:1024
    ds_read_b64_tr_b16 v[142:143], v13 offset:1024
    s_waitcnt vmcnt(0)
    ds_read_b64_tr_b16 v[144:145], v16 offset:2048
    ds_read_b64_tr_b16 v[146:147], v13 offset:2048
    buffer_load_dwordx4 v[92:95], v38, s[4:7], s43 offen offset:0 sc1
    buffer_load_dwordx4 v[96:99], v38, s[4:7], s43 offen offset:1280 sc1
    buffer_load_dwordx4 v[100:103], v38, s[4:7], s43 offen offset:2560 sc1
    s_cmp_eq_u32 s37, 63
    s_waitcnt lgkmcnt(4)
    v_smfmac_f32_16x16x64_bf16 v[148:151], v[136:139], a[0:7], v10
    v_smfmac_f32_16x16x64_bf16 v[152:155], v[136:139], a[24:31], v10
    v_smfmac_f32_16x16x64_bf16 v[156:159], v[136:139], a[48:55], v10
    buffer_load_dword v104, v39, s[4:7], s43 offen offset:0 sc1
    v_smfmac_f32_16x16x64_bf16 v[160:163], v[136:139], a[72:79], v10
    buffer_load_dword v105, v39, s[4:7], s43 offen offset:1280 sc1
    s_waitcnt lgkmcnt(2)
    v_smfmac_f32_16x16x64_bf16 v[148:151], v[140:143], a[8:15], v10
    buffer_load_dword v106, v39, s[4:7], s43 offen offset:2560 sc1
    v_smfmac_f32_16x16x64_bf16 v[152:155], v[140:143], a[32:39], v10
    v_smfmac_f32_16x16x64_bf16 v[156:159], v[140:143], a[56:63], v10
    v_smfmac_f32_16x16x64_bf16 v[160:163], v[140:143], a[80:87], v10
    s_waitcnt lgkmcnt(0)
    v_smfmac_f32_16x16x64_bf16 v[148:151], v[144:147], a[16:23], v10
    v_smfmac_f32_16x16x64_bf16 v[152:155], v[144:147], a[40:47], v10
    v_smfmac_f32_16x16x64_bf16 v[156:159], v[144:147], a[64:71], v10
    v_smfmac_f32_16x16x64_bf16 v[160:163], v[144:147], a[88:95], v10
    v_pk_add_f32 v[148:149], v[148:149], v[150:151]
    v_cmp_u_f32 vcc, v148, v149
    v_cvt_pk_bf16_f32 v50, v148, v149
    v_cvt_pk_bf16_f32 v54, v148, v149
    v_pk_add_f32 v[152:153], v[152:153], v[154:155]
    v_cvt_pk_bf16_f32 v58, v152, v153
    v_cvt_pk_bf16_f32 v62, v152, v153
    v_pk_add_f32 v[156:157], v[156:157], v[158:159]
    v_cvt_pk_bf16_f32 v66, v156, v157
    v_cvt_pk_bf16_f32 v70, v156, v157
    v_pk_add_f32 v[160:161], v[160:161], v[162:163]
    v_cvt_pk_bf16_f32 v74, v160, v161
    v_cvt_pk_bf16_f32 v78, v160, v161
    s_cbranch_vccnz L_vm_96
L_u_97:
    s_cbranch_scc1 L_wo_tail_s
L_sc_99:
    s_waitcnt vmcnt(4)
    v_pk_add_f32 v[236:237], v[92:93], v[96:97]
    v_pk_add_f32 v[238:239], v[94:95], v[98:99]
    s_waitcnt vmcnt(3)
    v_pk_add_f32 v[236:237], v[236:237], v[100:101]
    v_pk_add_f32 v[238:239], v[238:239], v[102:103]
    v_max3_f32 v41, v236, v237, v238
    v_pk_add_f32 v[242:243], v[236:237], v[238:239]
    s_waitcnt vmcnt(0)
    v_add_f32 v43, v104, v105
    v_add_f32 v43, v43, v106
    v_max3_f32 v41, v41, v239, v43
    v_add_f32 v242, v242, v43
    s_nop 0
    v_max_f32_dpp v42, v41, v41 quad_perm:[2,3,0,1] row_mask:0xf bank_mask:0xf
    v_max_f32_dpp v41, v41, v41 quad_perm:[2,3,0,1] row_mask:0xf bank_mask:0xf
    v_cmp_u_f32 vcc, v242, v243
    s_nop 0
    v_permlane16_swap_b32 v41, v42
    v_max_f32 v41, v41, v42
    v_mov_b32 v42, v41
    s_cbranch_vccnz L_sp_100
L_sg_101:
    s_nop 0
    v_permlane32_swap_b32 v41, v42
    v_max_f32 v41, v41, v42
    v_mul_f32 v242, 0xbdd53b95, v41
    v_pk_fma_f32 v[236:237], v[236:237], v[240:241], v[242:243] op_sel_hi:[1,1,0]
    v_pk_fma_f32 v[238:239], v[238:239], v[240:241], v[242:243] op_sel_hi:[1,1,0]
    v_fma_f32 v43, v43, v240, v242
    v_exp_f32 v236, v236
    v_exp_f32 v237, v237
    v_exp_f32 v238, v238
    v_exp_f32 v239, v239
    v_exp_f32 v43, v43
    v_cvt_pk_bf16_f32 v80, v236, v237
    v_cvt_pk_bf16_f32 v82, v238, v239
    v_cvt_pk_bf16_f32 v81, v43, 0
    v_cvt_pk_bf16_f32 v83, v43, 0
    s_nop 1
    v_smfmac_f32_16x16x64_bf16 v[116:119], v[80:83], v[84:91], v11
    v_smfmac_f32_16x16x64_bf16 v[120:123], v[80:83], v[48:55], v11
    v_smfmac_f32_16x16x64_bf16 v[124:127], v[80:83], v[56:63], v11
    v_smfmac_f32_16x16x64_bf16 v[128:131], v[80:83], v[64:71], v11
    v_add_f32 v116, v116, v118
    v_add_f32 v117, v117, v119
    v_smfmac_f32_16x16x64_bf16 v[132:135], v[80:83], v[72:79], v11
    v_rcp_f32 v116, v116
    v_rcp_f32 v117, v117
    v_pk_add_f32 v[120:121], v[120:121], v[122:123]
    v_pk_mul_f32 v[120:121], v[120:121], v[116:117]
    v_cvt_pk_bf16_f32 v236, v120, v121
    v_pk_add_f32 v[124:125], v[124:125], v[126:127]
    v_pk_mul_f32 v[124:125], v[124:125], v[116:117]
    v_cvt_pk_bf16_f32 v237, v124, v125
    ds_write2st64_b32 v18, v236, v237 offset0:0 offset1:1
    v_pk_add_f32 v[128:129], v[128:129], v[130:131]
    v_pk_mul_f32 v[128:129], v[128:129], v[116:117]
    v_cvt_pk_bf16_f32 v238, v128, v129
    v_pk_add_f32 v[132:133], v[132:133], v[134:135]
    v_pk_mul_f32 v[132:133], v[132:133], v[116:117]
    v_cvt_pk_bf16_f32 v239, v132, v133
    ds_write2st64_b32 v18, v238, v239 offset0:2 offset1:3
    buffer_store_dword v107, v244, s[4:7], s38 offen sc1
    v_mov_b32 v120, 0
    v_mov_b32 v121, 0
    v_mov_b32 v122, 0
    v_mov_b32 v123, 0
    v_mov_b32 v124, 0
    v_mov_b32 v125, 0
    v_mov_b32 v126, 0
    v_mov_b32 v127, 0
    v_mov_b32 v128, 0
    v_mov_b32 v129, 0
    s_waitcnt lgkmcnt(0)
    s_barrier
    ds_read_b64_tr_b16 v[80:81], v19
    ds_read_b64_tr_b16 v[82:83], v19 offset:128
    v_mov_b32 v130, 0
    v_mov_b32 v131, 0
    v_mov_b32 v132, 0
    v_mov_b32 v133, 0
    v_mov_b32 v134, 0
    v_mov_b32 v135, 0
    v_mov_b32 v116, 0
    v_mov_b32 v117, 0
    v_mov_b32 v118, 0
    v_mov_b32 v119, 0
    s_waitcnt lgkmcnt(0)
    v_mfma_f32_16x16x32_bf16 v[172:175], v[110:113], v[80:83], 0
    v_mfma_f32_16x16x32_bf16 v[176:179], v[108:111], v[80:83], 0
    buffer_load_dword v36, v33, s[4:7], s38 offen sc1
    s_nop 3
    v_cvt_pk_bf16_f32 v236, v172, v173
    v_cvt_pk_bf16_f32 v237, v174, v175
    s_nop 0
    v_cvt_pk_bf16_f32 v238, v176, v177
    v_cvt_pk_bf16_f32 v239, v178, v179
    buffer_store_dwordx4 v[236:239], v14, s[4:7], s41 offen sc1
    ds_write_b32 v47, v50 offset:8
    ds_write_b32 v47, v58 offset:6152
    ds_write_b32 v47, v66 offset:12296
    ds_write_b32 v47, v74 offset:18440
    ds_read_b128 v[204:207], v26 offset:0
    ds_read_b128 v[180:183], v29 offset:0
    ds_read_b128 v[184:187], v29 offset:1024
    ds_read_b64 v[208:209], v27 offset:0
    ds_read_b128 v[188:191], v29 offset:2048
    ds_read_b128 v[212:215], v26 offset:1536
    ds_read_b128 v[192:195], v29 offset:3072
    ds_read_b128 v[196:199], v29 offset:4096
    ds_read_b64 v[216:217], v27 offset:1536
    ds_read_b128 v[200:203], v29 offset:5120
    s_add_u32 s55, s42, s60
    buffer_store_dword v168, v46, s[4:7], s55 offen sc1
    s_add_u32 s55, s42, s61
    buffer_store_dword v168, v46, s[4:7], s55 offen sc1
    s_waitcnt lgkmcnt(5)
    v_mfma_f32_16x16x32_bf16 v[220:223], v[180:183], v[204:207], 0
    v_mfma_f32_16x16x32_bf16 v[224:227], v[184:187], v[204:207], 0
    v_mfma_f32_16x16x32_bf16 v[224:227], v[188:191], v[208:211], v[224:227]
    ds_read_b128 v[204:207], v26 offset:3072
    ds_read_b128 v[180:183], v29 offset:6144
    ds_read_b128 v[184:187], v29 offset:7168
    ds_read_b64 v[208:209], v27 offset:3072
    ds_read_b128 v[188:191], v29 offset:8192
    s_add_u32 s56, s37, 2
    s_and_b32 s55, s56, 3
    s_mul_i32 s55, s55, 114688
    s_add_u32 s55, s55, 65536
    s_add_u32 s45, s38, s55
    s_add_u32 s46, s45, 4096
    s_add_u32 s47, s45, 8192
    s_add_u32 s56, s37, -1
    s_and_b32 s55, s56, 3
    s_mul_i32 s55, s55, 114688
    s_add_u32 s55, s55, 53248
    s_add_u32 s48, s38, s55
    s_and_b32 s55, s56, 1
    s_add_u32 s56, s56, 1
    v_mov_b32 v35, -16
    v_writelane_b32 v35, s56, 12
    s_mul_i32 s55, s55, 12288
    s_add_u32 m0, s54, s55
    s_waitcnt lgkmcnt(5)
    v_mfma_f32_16x16x32_bf16 v[220:223], v[192:195], v[212:215], v[220:223]
    v_mfma_f32_16x16x32_bf16 v[224:227], v[196:199], v[212:215], v[224:227]
    v_mfma_f32_16x16x32_bf16 v[224:227], v[200:203], v[216:219], v[224:227]
    ds_read_b128 v[212:215], v26 offset:4608
    ds_read_b128 v[192:195], v29 offset:9216
    ds_read_b128 v[196:199], v29 offset:10240
    ds_read_b64 v[216:217], v27 offset:4608
    ds_read_b128 v[200:203], v29 offset:11264
    s_waitcnt lgkmcnt(5)
    v_mfma_f32_16x16x32_bf16 v[220:223], v[180:183], v[204:207], v[220:223]
    v_mfma_f32_16x16x32_bf16 v[224:227], v[184:187], v[204:207], v[224:227]
    v_mfma_f32_16x16x32_bf16 v[224:227], v[188:191], v[208:211], v[224:227]
    s_waitcnt lgkmcnt(0)
    v_mfma_f32_16x16x32_bf16 v[220:223], v[192:195], v[212:215], v[220:223]
    v_mfma_f32_16x16x32_bf16 v[224:227], v[196:199], v[212:215], v[224:227]
    v_mfma_f32_16x16x32_bf16 v[224:227], v[200:203], v[216:219], v[224:227]
    s_waitcnt vmcnt(3)
    v_cmp_lt_i32 vcc, v36, v35
    s_cbranch_vccz L_fok_104
L_fw_103:
    buffer_load_dword v36, v33, s[4:7], s38 offen sc1
    s_sub_u32 s36, s36, 1
    s_cbranch_scc1 L_exit
    s_waitcnt vmcnt(0)
    v_cmp_lt_i32 vcc, v36, v35
    s_cbranch_vccnz L_fw_103
L_fok_104:
    buffer_load_dwordx4 v37, s[4:7], s48 offen offset:0 sc1 lds
    buffer_load_dwordx4 v37, s[4:7], s48 offen offset:1024 sc1 lds
    buffer_load_dwordx4 v37, s[4:7], s48 offen offset:2048 sc1 lds
    v_cvt_pk_bf16_f32 v220, v220, v221
    v_cvt_pk_bf16_f32 v221, v222, v223
    v_cvt_pk_bf16_f32 v222, v224, v225
    v_cvt_pk_bf16_f32 v223, v226, v227
    v_mov_b32 v224, v220
    v_mov_b32 v225, v221
    v_mov_b32_dpp v220, v222 row_ror:8 row_mask:0xf bank_mask:0xc
    v_mov_b32_dpp v221, v223 row_ror:8 row_mask:0xf bank_mask:0xc
    v_mov_b32_dpp v222, v224 row_ror:8 row_mask:0xf bank_mask:0x3
    v_mov_b32_dpp v223, v225 row_ror:8 row_mask:0xf bank_mask:0x3
    buffer_store_dwordx4 v[220:223], v15, s[4:7], s49 offen sc1
    v_mfma_f32_16x16x32_bf16 v[148:151], a[96:99], a[0:3], 0
    s_mov_b32 s50, s42
    s_add_u32 s56, s37, 1
    v_mov_b32 v47, v24
    v_mfma_f32_16x16x32_bf16 v[152:155], a[120:123], a[0:3], 0
    s_and_b32 s55, s56, 3
    s_mul_i32 s41, s55, 327680
    s_mul_i32 s56, s55, 114688
    v_mfma_f32_16x16x32_bf16 v[156:159], a[96:99], a[24:27], 0
    s_add_u32 s43, s38, s56
    s_xor_b32 s55, s55, 2
    s_mul_i32 s42, s55, 327680
    v_mfma_f32_16x16x32_bf16 v[160:163], a[120:123], a[24:27], 0
    s_add_u32 s56, s37, 2
    v_mov_b32 v107, s56
    s_and_b32 s55, s56, 3
    v_mfma_f32_16x16x32_bf16 v[180:183], a[96:99], a[48:51], 0
    s_mul_i32 s44, s55, 24576
    s_add_u32 s56, s37, -1
    s_and_b32 s55, s56, 3
    v_mfma_f32_16x16x32_bf16 v[184:187], a[120:123], a[48:51], 0
    s_mul_i32 s55, s55, 40960
    s_add_u32 s49, s55, s38
    s_add_u32 s56, s37, -1
    v_mfma_f32_16x16x32_bf16 v[188:191], a[96:99], a[72:75], 0
    s_and_b32 s55, s56, 3
    s_mul_i32 s55, s55, 24576
    v_add_u32 v26, s55, v22
    v_mfma_f32_16x16x32_bf16 v[192:195], a[120:123], a[72:75], 0
    buffer_load_dwordx4 a[96:99], v40, s[4:7], s45 offen offset:0 sc1
    v_mfma_f32_16x16x32_bf16 v[148:151], a[100:103], a[4:7], v[148:151]
    v_add_u32 v27, s55, v23
    s_and_b32 s55, s56, 1
    s_mul_i32 s55, s55, 12288
    v_mfma_f32_16x16x32_bf16 v[152:155], a[124:127], a[4:7], v[152:155]
    buffer_load_dwordx4 a[120:123], v40, s[4:7], s46 offen offset:2048 sc1
    v_mfma_f32_16x16x32_bf16 v[156:159], a[100:103], a[28:31], v[156:159]
    v_add_u32 v29, s55, v28
    v_mfma_f32_16x16x32_bf16 v[160:163], a[124:127], a[28:31], v[160:163]
    v_mfma_f32_16x16x32_bf16 v[180:183], a[100:103], a[52:55], v[180:183]
    v_mfma_f32_16x16x32_bf16 v[184:187], a[124:127], a[52:55], v[184:187]
    v_mfma_f32_16x16x32_bf16 v[188:191], a[100:103], a[76:79], v[188:191]
    v_mfma_f32_16x16x32_bf16 v[192:195], a[124:127], a[76:79], v[192:195]
    buffer_load_dwordx4 a[100:103], v40, s[4:7], s45 offen offset:1024 sc1
    v_mfma_f32_16x16x32_bf16 v[148:151], a[104:107], a[8:11], v[148:151]
    v_mfma_f32_16x16x32_bf16 v[152:155], a[128:131], a[8:11], v[152:155]
    buffer_load_dwordx4 a[124:127], v40, s[4:7], s46 offen offset:3072 sc1
    v_mfma_f32_16x16x32_bf16 v[156:159], a[104:107], a[32:35], v[156:159]
    v_mfma_f32_16x16x32_bf16 v[160:163], a[128:131], a[32:35], v[160:163]
    v_mfma_f32_16x16x32_bf16 v[180:183], a[104:107], a[56:59], v[180:183]
    v_mfma_f32_16x16x32_bf16 v[184:187], a[128:131], a[56:59], v[184:187]
    v_mfma_f32_16x16x32_bf16 v[188:191], a[104:107], a[80:83], v[188:191]
    v_mfma_f32_16x16x32_bf16 v[192:195], a[128:131], a[80:83], v[192:195]
    buffer_load_dwordx4 a[104:107], v40, s[4:7], s45 offen offset:2048 sc1
    v_mfma_f32_16x16x32_bf16 v[148:151], a[108:111], a[12:15], v[148:151]
    v_mfma_f32_16x16x32_bf16 v[152:155], a[132:135], a[12:15], v[152:155]
    buffer_load_dwordx4 a[128:131], v40, s[4:7], s47 offen offset:0 sc1
    v_mfma_f32_16x16x32_bf16 v[156:159], a[108:111], a[36:39], v[156:159]
    v_mfma_f32_16x16x32_bf16 v[160:163], a[132:135], a[36:39], v[160:163]
    v_mfma_f32_16x16x32_bf16 v[180:183], a[108:111], a[60:63], v[180:183]
    v_mfma_f32_16x16x32_bf16 v[184:187], a[132:135], a[60:63], v[184:187]
    v_mfma_f32_16x16x32_bf16 v[188:191], a[108:111], a[84:87], v[188:191]
    v_mfma_f32_16x16x32_bf16 v[192:195], a[132:135], a[84:87], v[192:195]
    buffer_load_dwordx4 a[108:111], v40, s[4:7], s45 offen offset:3072 sc1
    v_mfma_f32_16x16x32_bf16 v[148:151], a[112:115], a[16:19], v[148:151]
    v_mfma_f32_16x16x32_bf16 v[152:155], a[136:139], a[16:19], v[152:155]
    buffer_load_dwordx4 a[132:135], v40, s[4:7], s47 offen offset:1024 sc1
    v_mfma_f32_16x16x32_bf16 v[156:159], a[112:115], a[40:43], v[156:159]
    v_mfma_f32_16x16x32_bf16 v[160:163], a[136:139], a[40:43], v[160:163]
    v_mfma_f32_16x16x32_bf16 v[180:183], a[112:115], a[64:67], v[180:183]
    v_mfma_f32_16x16x32_bf16 v[184:187], a[136:139], a[64:67], v[184:187]
    v_mfma_f32_16x16x32_bf16 v[188:191], a[112:115], a[88:91], v[188:191]
    v_mfma_f32_16x16x32_bf16 v[192:195], a[136:139], a[88:91], v[192:195]
    v_mfma_f32_16x16x32_bf16 v[148:151], a[116:119], a[20:23], v[148:151]
    v_mfma_f32_16x16x32_bf16 v[152:155], a[140:143], a[20:23], v[152:155]
    v_mfma_f32_16x16x32_bf16 v[156:159], a[116:119], a[44:47], v[156:159]
    v_mfma_f32_16x16x32_bf16 v[160:163], a[140:143], a[44:47], v[160:163]
    v_mfma_f32_16x16x32_bf16 v[180:183], a[116:119], a[68:71], v[180:183]
    v_mfma_f32_16x16x32_bf16 v[184:187], a[140:143], a[68:71], v[184:187]
    v_mfma_f32_16x16x32_bf16 v[188:191], a[116:119], a[92:95], v[188:191]
    v_mfma_f32_16x16x32_bf16 v[192:195], a[140:143], a[92:95], v[192:195]
    v_cvt_pk_bf16_f32 v64, v180, v181
    v_cvt_pk_bf16_f32 v65, v182, v183
    ds_write_b64 v24, v[64:65] offset:12288
    v_cvt_pk_bf16_f32 v68, v184, v185
    v_cvt_pk_bf16_f32 v69, v186, v187
    ds_write_b64 v25, v[68:69] offset:12288
    v_cvt_pk_bf16_f32 v72, v188, v189
    v_cvt_pk_bf16_f32 v73, v190, v191
    ds_write_b64 v24, v[72:73] offset:18432
    v_cvt_pk_bf16_f32 v76, v192, v193
    v_cvt_pk_bf16_f32 v77, v194, v195
    ds_write_b64 v25, v[76:77] offset:18432
    v_cvt_pk_bf16_f32 v48, v148, v149
    v_cvt_pk_bf16_f32 v49, v150, v151
    ds_write_b64 v24, v[48:49] offset:0
    v_cvt_pk_bf16_f32 v52, v152, v153
    v_cvt_pk_bf16_f32 v53, v154, v155
    ds_write_b64 v25, v[52:53] offset:0
    v_cvt_pk_bf16_f32 v56, v156, v157
    v_cvt_pk_bf16_f32 v57, v158, v159
    ds_write_b64 v24, v[56:57] offset:6144
    v_cvt_pk_bf16_f32 v60, v160, v161
    v_cvt_pk_bf16_f32 v61, v162, v163
    ds_write_b64 v25, v[60:61] offset:6144
    s_add_u32 s37, s37, 1
    s_mov_b32 m0, s53
    v_add_u32 v24, s44, v20
    v_add_u32 v25, s44, v21
    v_pk_mul_f32 v[148:149], v[210:211], v[210:211]
    v_pk_mul_f32 v[150:151], v[210:211], v[210:211]
    v_pk_mul_f32 v[152:153], v[210:211], v[210:211]
    v_pk_mul_f32 v[154:155], v[210:211], v[210:211]
    v_pk_mul_f32 v[156:157], v[210:211], v[210:211]
    v_pk_mul_f32 v[158:159], v[210:211], v[210:211]
    v_pk_mul_f32 v[160:161], v[210:211], v[210:211]
    v_pk_mul_f32 v[162:163], v[210:211], v[210:211]
    buffer_load_dwordx4 a[112:115], v40, s[4:7], s46 offen offset:0 sc1
    buffer_load_dwordx4 a[136:139], v40, s[4:7], s47 offen offset:2048 sc1
    buffer_load_dwordx4 a[116:119], v40, s[4:7], s46 offen offset:1024 sc1
    buffer_load_dwordx4 a[140:143], v40, s[4:7], s47 offen offset:3072 sc1
    s_branch L_wo_loop_s
L_wo_tail_s:
    ds_write_b32 v47, v50 offset:8
    ds_write_b32 v47, v58 offset:6152
    ds_write_b32 v47, v66 offset:12296
    ds_write_b32 v47, v74 offset:18440
    s_add_u32 s91, s38, 81920
    buffer_load_dwordx4 v[120:123], v15, s[4:7], s91 offen sc1
    s_add_u32 s91, s38, 122880
    buffer_load_dwordx4 v[124:127], v15, s[4:7], s91 offen sc1
    v_mov_b32 v3, 204
L_p0_105:
    buffer_load_dword v4, v3, s[8:11], 0 offen sc1
    s_sub_u32 s36, s36, 1
    s_cbranch_scc1 L_exit
    s_waitcnt vmcnt(0)
    v_readfirstlane_b32 s90, v4
    s_nop 0
    s_cmp_eq_u32 s90, 0
    s_cbranch_scc1 L_p0_105
    s_and_b32 s90, s90, 2
    s_lshl_b32 s90, s90, 12
    v_xor_b32 v30, s90, v30
    v_xor_b32 v31, s90, v31
    s_mov_b32 s49, 6160384
    buffer_store_dwordx4 v[120:123], v30, s[4:7], s49 offen sc1
    s_mov_b32 s49, 6488064
    buffer_store_dwordx4 v[124:127], v30, s[4:7], s49 offen sc1
    s_mov_b32 s49, 6815744
    buffer_store_dwordx4 v[220:223], v30, s[4:7], s49 offen sc1
    s_waitcnt lgkmcnt(0)
    s_barrier
    s_add_u32 s56, s37, -1
    s_and_b32 s55, s56, 3
    s_mul_i32 s55, s55, 114688
    s_add_u32 s55, s55, 53248
    s_add_u32 s48, s38, s55
    s_and_b32 s55, s56, 1
    s_add_u32 s56, s56, 1
    v_mov_b32 v35, -16
    v_writelane_b32 v35, s56, 12
    s_mul_i32 s55, s55, 12288
    s_add_u32 m0, s54, s55
    buffer_load_dword v36, v33, s[4:7], s38 offen sc1
    s_add_u32 s56, s37, -2
    s_and_b32 s55, s56, 3
    s_mul_i32 s55, s55, 24576
    v_add_u32 v26, s55, v22
    v_add_u32 v27, s55, v23
    s_and_b32 s55, s56, 1
    s_mul_i32 s55, s55, 12288
    v_add_u32 v29, s55, v28
    s_mov_b32 s49, 7143424
    ds_read_b128 v[204:207], v26 offset:0
    ds_read_b128 v[180:183], v29 offset:0
    ds_read_b128 v[184:187], v29 offset:1024
    ds_read_b64 v[208:209], v27 offset:0
    ds_read_b128 v[188:191], v29 offset:2048
    ds_read_b128 v[212:215], v26 offset:1536
    ds_read_b128 v[192:195], v29 offset:3072
    ds_read_b128 v[196:199], v29 offset:4096
    ds_read_b64 v[216:217], v27 offset:1536
    ds_read_b128 v[200:203], v29 offset:5120
    s_waitcnt lgkmcnt(5)
    v_mfma_f32_16x16x32_bf16 v[220:223], v[180:183], v[204:207], 0
    v_mfma_f32_16x16x32_bf16 v[224:227], v[184:187], v[204:207], 0
    v_mfma_f32_16x16x32_bf16 v[224:227], v[188:191], v[208:211], v[224:227]
    ds_read_b128 v[204:207], v26 offset:3072
    ds_read_b128 v[180:183], v29 offset:6144
    ds_read_b128 v[184:187], v29 offset:7168
    ds_read_b64 v[208:209], v27 offset:3072
    ds_read_b128 v[188:191], v29 offset:8192
    s_waitcnt lgkmcnt(5)
    v_mfma_f32_16x16x32_bf16 v[220:223], v[192:195], v[212:215], v[220:223]
    v_mfma_f32_16x16x32_bf16 v[224:227], v[196:199], v[212:215], v[224:227]
    v_mfma_f32_16x16x32_bf16 v[224:227], v[200:203], v[216:219], v[224:227]
    ds_read_b128 v[212:215], v26 offset:4608
    ds_read_b128 v[192:195], v29 offset:9216
    ds_read_b128 v[196:199], v29 offset:10240
    ds_read_b64 v[216:217], v27 offset:4608
    ds_read_b128 v[200:203], v29 offset:11264
    s_waitcnt lgkmcnt(5)
    v_mfma_f32_16x16x32_bf16 v[220:223], v[180:183], v[204:207], v[220:223]
    v_mfma_f32_16x16x32_bf16 v[224:227], v[184:187], v[204:207], v[224:227]
    v_mfma_f32_16x16x32_bf16 v[224:227], v[188:191], v[208:211], v[224:227]
    s_waitcnt lgkmcnt(0)
    v_mfma_f32_16x16x32_bf16 v[220:223], v[192:195], v[212:215], v[220:223]
    v_mfma_f32_16x16x32_bf16 v[224:227], v[196:199], v[212:215], v[224:227]
    v_mfma_f32_16x16x32_bf16 v[224:227], v[200:203], v[216:219], v[224:227]
    s_nop 0
    v_cvt_pk_bf16_f32 v220, v220, v221
    v_cvt_pk_bf16_f32 v221, v222, v223
    s_nop 4
    v_cvt_pk_bf16_f32 v222, v224, v225
    v_cvt_pk_bf16_f32 v223, v226, v227
    v_mov_b32 v224, v220
    v_mov_b32 v225, v221
    v_mov_b32_dpp v220, v222 row_ror:8 row_mask:0xf bank_mask:0xc
    v_mov_b32_dpp v221, v223 row_ror:8 row_mask:0xf bank_mask:0xc
    v_mov_b32_dpp v222, v224 row_ror:8 row_mask:0xf bank_mask:0x3
    v_mov_b32_dpp v223, v225 row_ror:8 row_mask:0xf bank_mask:0x3
    buffer_store_dwordx4 v[220:223], v30, s[4:7], s49 offen sc1
    s_waitcnt vmcnt(1)
    v_cmp_lt_i32 vcc, v36, v35
    s_cbranch_vccz L_fok_107
L_fw_106:
    buffer_load_dword v36, v33, s[4:7], s38 offen sc1
    s_sub_u32 s36, s36, 1
    s_cbranch_scc1 L_exit
    s_waitcnt vmcnt(0)
    v_cmp_lt_i32 vcc, v36, v35
    s_cbranch_vccnz L_fw_106
L_fok_107:
    buffer_load_dwordx4 v37, s[4:7], s48 offen offset:0 sc1 lds
    buffer_load_dwordx4 v37, s[4:7], s48 offen offset:1024 sc1 lds
    buffer_load_dwordx4 v37, s[4:7], s48 offen offset:2048 sc1 lds
    s_waitcnt vmcnt(0) lgkmcnt(0)
    s_barrier
    s_add_u32 s56, s37, -1
    s_and_b32 s55, s56, 3
    s_mul_i32 s55, s55, 24576
    v_add_u32 v26, s55, v22
    v_add_u32 v27, s55, v23
    s_and_b32 s55, s56, 1
    s_mul_i32 s55, s55, 12288
    v_add_u32 v29, s55, v28
    s_mov_b32 s49, 5832704
    ds_read_b128 v[204:207], v26 offset:0
    ds_read_b128 v[180:183], v29 offset:0
    ds_read_b128 v[184:187], v29 offset:1024
    ds_read_b64 v[208:209], v27 offset:0
    ds_read_b128 v[188:191], v29 offset:2048
    ds_read_b128 v[212:215], v26 offset:1536
    ds_read_b128 v[192:195], v29 offset:3072
    ds_read_b128 v[196:199], v29 offset:4096
    ds_read_b64 v[216:217], v27 offset:1536
    ds_read_b128 v[200:203], v29 offset:5120
    s_waitcnt lgkmcnt(5)
    v_mfma_f32_16x16x32_bf16 v[220:223], v[180:183], v[204:207], 0
    v_mfma_f32_16x16x32_bf16 v[224:227], v[184:187], v[204:207], 0
    v_mfma_f32_16x16x32_bf16 v[224:227], v[188:191], v[208:211], v[224:227]
    ds_read_b128 v[204:207], v26 offset:3072
    ds_read_b128 v[180:183], v29 offset:6144
    ds_read_b128 v[184:187], v29 offset:7168
    ds_read_b64 v[208:209], v27 offset:3072
    ds_read_b128 v[188:191], v29 offset:8192
    s_waitcnt lgkmcnt(5)
    v_mfma_f32_16x16x32_bf16 v[220:223], v[192:195], v[212:215], v[220:223]
    v_mfma_f32_16x16x32_bf16 v[224:227], v[196:199], v[212:215], v[224:227]
    v_mfma_f32_16x16x32_bf16 v[224:227], v[200:203], v[216:219], v[224:227]
    ds_read_b128 v[212:215], v26 offset:4608
    ds_read_b128 v[192:195], v29 offset:9216
    ds_read_b128 v[196:199], v29 offset:10240
    ds_read_b64 v[216:217], v27 offset:4608
    ds_read_b128 v[200:203], v29 offset:11264
    s_waitcnt lgkmcnt(5)
    v_mfma_f32_16x16x32_bf16 v[220:223], v[180:183], v[204:207], v[220:223]
    v_mfma_f32_16x16x32_bf16 v[224:227], v[184:187], v[204:207], v[224:227]
    v_mfma_f32_16x16x32_bf16 v[224:227], v[188:191], v[208:211], v[224:227]
    s_waitcnt lgkmcnt(0)
    v_mfma_f32_16x16x32_bf16 v[220:223], v[192:195], v[212:215], v[220:223]
    v_mfma_f32_16x16x32_bf16 v[224:227], v[196:199], v[212:215], v[224:227]
    v_mfma_f32_16x16x32_bf16 v[224:227], v[200:203], v[216:219], v[224:227]
    s_nop 0
    v_cvt_pk_bf16_f32 v220, v220, v221
    v_cvt_pk_bf16_f32 v221, v222, v223
    s_nop 4
    v_cvt_pk_bf16_f32 v222, v224, v225
    v_cvt_pk_bf16_f32 v223, v226, v227
    v_mov_b32 v224, v220
    v_mov_b32 v225, v221
    v_mov_b32_dpp v220, v222 row_ror:8 row_mask:0xf bank_mask:0xc
    v_mov_b32_dpp v221, v223 row_ror:8 row_mask:0xf bank_mask:0xc
    v_mov_b32_dpp v222, v224 row_ror:8 row_mask:0xf bank_mask:0x3
    v_mov_b32_dpp v223, v225 row_ror:8 row_mask:0xf bank_mask:0x3
    buffer_store_dwordx4 v[220:223], v30, s[4:7], s49 offen sc1
    s_mov_b32 s51, 5832704
L_fp_108:
    buffer_load_dwordx4 v[120:123], v31, s[4:7], s51 offen sc1
    s_sub_u32 s36, s36, 1
    s_cbranch_scc1 L_exit
    s_waitcnt vmcnt(0)
    v_max3_u32 v41, v120, v121, v122
    v_max_u32 v41, v41, v123
    v_cmp_eq_u32 vcc, -1, v41
    s_cbranch_vccnz L_fp_108
    s_mov_b32 s51, 6160384
    buffer_load_dwordx4 v[148:151], v31, s[4:7], s51 offen sc1
    s_mov_b32 s51, 6488064
    buffer_load_dwordx4 v[152:155], v31, s[4:7], s51 offen sc1
    s_mov_b32 s51, 6815744
    buffer_load_dwordx4 v[156:159], v31, s[4:7], s51 offen sc1
    s_mov_b32 s51, 7143424
    buffer_load_dwordx4 v[160:163], v31, s[4:7], s51 offen sc1
    s_mov_b32 s52, 5079040
    v_mfma_f32_16x16x32_bf16 v[232:235], a[144:147], v[120:123], 0
    s_nop 7
    v_cndmask_b32 v234, v232, v233, s[58:59]
    v_cndmask_b32 v235, v233, v232, s[58:59]
    s_nop 1
    v_add_f32_dpp v235, v234, v235 row_ror:8 row_mask:0xf bank_mask:0xf
    v_cvt_pk_bf16_f32 v235, v235, v235
    buffer_store_short v235, v32, s[28:31], s52 offen offset:0
    s_waitcnt vmcnt(1)
    s_mov_b32 s52, 4751360
    v_mfma_f32_16x16x32_bf16 v[232:235], a[144:147], v[148:151], 0
    s_nop 7
    v_cndmask_b32 v234, v232, v233, s[58:59]
    v_cndmask_b32 v235, v233, v232, s[58:59]
    s_nop 1
    v_add_f32_dpp v235, v234, v235 row_ror:8 row_mask:0xf bank_mask:0xf
    v_cvt_pk_bf16_f32 v235, v235, v235
    buffer_store_short v235, v32, s[28:31], s52 offen offset:0
    s_mov_b32 s52, 4833280
    v_mfma_f32_16x16x32_bf16 v[232:235], a[144:147], v[152:155], 0
    s_nop 7
    v_cndmask_b32 v234, v232, v233, s[58:59]
    v_cndmask_b32 v235, v233, v232, s[58:59]
    s_nop 1
    v_add_f32_dpp v235, v234, v235 row_ror:8 row_mask:0xf bank_mask:0xf
    v_cvt_pk_bf16_f32 v235, v235, v235
    buffer_store_short v235, v32, s[28:31], s52 offen offset:0
    s_mov_b32 s52, 4915200
    v_mfma_f32_16x16x32_bf16 v[232:235], a[144:147], v[156:159], 0
    s_nop 7
    v_cndmask_b32 v234, v232, v233, s[58:59]
    v_cndmask_b32 v235, v233, v232, s[58:59]
    s_nop 1
    v_add_f32_dpp v235, v234, v235 row_ror:8 row_mask:0xf bank_mask:0xf
    v_cvt_pk_bf16_f32 v235, v235, v235
    buffer_store_short v235, v32, s[28:31], s52 offen offset:0
    s_mov_b32 s52, 4997120
    v_mfma_f32_16x16x32_bf16 v[232:235], a[144:147], v[160:163], 0
    s_nop 7
    v_cndmask_b32 v234, v232, v233, s[58:59]
    v_cndmask_b32 v235, v233, v232, s[58:59]
    s_nop 1
    v_add_f32_dpp v235, v234, v235 row_ror:8 row_mask:0xf bank_mask:0xf
    v_cvt_pk_bf16_f32 v235, v235, v235
    buffer_store_short v235, v32, s[28:31], s52 offen offset:0
    s_add_u32 s56, s37, 0
    s_and_b32 s55, s56, 3
    s_mul_i32 s55, s55, 114688
    s_add_u32 s55, s55, 53248
    s_add_u32 s48, s38, s55
    s_and_b32 s55, s56, 1
    s_add_u32 s56, s56, 1
    v_mov_b32 v35, -16
    v_writelane_b32 v35, s56, 12
    s_mul_i32 s55, s55, 12288
    s_add_u32 m0, s54, s55
    buffer_load_dword v36, v33, s[4:7], s38 offen sc1
    s_waitcnt vmcnt(0)
    v_cmp_lt_i32 vcc, v36, v35
    s_cbranch_vccz L_fok_110
L_fw_109:
    buffer_load_dword v36, v33, s[4:7], s38 offen sc1
    s_sub_u32 s36, s36, 1
    s_cbranch_scc1 L_exit
    s_waitcnt vmcnt(0)
    v_cmp_lt_i32 vcc, v36, v35
    s_cbranch_vccnz L_fw_109
L_fok_110:
    buffer_load_dwordx4 v37, s[4:7], s48 offen offset:0 sc1 lds
    buffer_load_dwordx4 v37, s[4:7], s48 offen offset:1024 sc1 lds
    buffer_load_dwordx4 v37, s[4:7], s48 offen offset:2048 sc1 lds
    s_waitcnt vmcnt(0) lgkmcnt(0)
    s_barrier
    s_add_u32 s56, s37, 0
    s_and_b32 s55, s56, 3
    s_mul_i32 s55, s55, 24576
    v_add_u32 v26, s55, v22
    v_add_u32 v27, s55, v23
    s_and_b32 s55, s56, 1
    s_mul_i32 s55, s55, 12288
    v_add_u32 v29, s55, v28
    s_mov_b32 s49, 5505024
    ds_read_b128 v[204:207], v26 offset:0
    ds_read_b128 v[180:183], v29 offset:0
    ds_read_b128 v[184:187], v29 offset:1024
    ds_read_b64 v[208:209], v27 offset:0
    ds_read_b128 v[188:191], v29 offset:2048
    ds_read_b128 v[212:215], v26 offset:1536
    ds_read_b128 v[192:195], v29 offset:3072
    ds_read_b128 v[196:199], v29 offset:4096
    ds_read_b64 v[216:217], v27 offset:1536
    ds_read_b128 v[200:203], v29 offset:5120
    s_waitcnt lgkmcnt(5)
    v_mfma_f32_16x16x32_bf16 v[220:223], v[180:183], v[204:207], 0
    v_mfma_f32_16x16x32_bf16 v[224:227], v[184:187], v[204:207], 0
    v_mfma_f32_16x16x32_bf16 v[224:227], v[188:191], v[208:211], v[224:227]
    ds_read_b128 v[204:207], v26 offset:3072
    ds_read_b128 v[180:183], v29 offset:6144
    ds_read_b128 v[184:187], v29 offset:7168
    ds_read_b64 v[208:209], v27 offset:3072
    ds_read_b128 v[188:191], v29 offset:8192
    s_waitcnt lgkmcnt(5)
    v_mfma_f32_16x16x32_bf16 v[220:223], v[192:195], v[212:215], v[220:223]
    v_mfma_f32_16x16x32_bf16 v[224:227], v[196:199], v[212:215], v[224:227]
    v_mfma_f32_16x16x32_bf16 v[224:227], v[200:203], v[216:219], v[224:227]
    ds_read_b128 v[212:215], v26 offset:4608
    ds_read_b128 v[192:195], v29 offset:9216
    ds_read_b128 v[196:199], v29 offset:10240
    ds_read_b64 v[216:217], v27 offset:4608
    ds_read_b128 v[200:203], v29 offset:11264
    s_waitcnt lgkmcnt(5)
    v_mfma_f32_16x16x32_bf16 v[220:223], v[180:183], v[204:207], v[220:223]
    v_mfma_f32_16x16x32_bf16 v[224:227], v[184:187], v[204:207], v[224:227]
    v_mfma_f32_16x16x32_bf16 v[224:227], v[188:191], v[208:211], v[224:227]
    s_waitcnt lgkmcnt(0)
    v_mfma_f32_16x16x32_bf16 v[220:223], v[192:195], v[212:215], v[220:223]
    v_mfma_f32_16x16x32_bf16 v[224:227], v[196:199], v[212:215], v[224:227]
    v_mfma_f32_16x16x32_bf16 v[224:227], v[200:203], v[216:219], v[224:227]
    s_nop 0
    v_cvt_pk_bf16_f32 v220, v220, v221
    v_cvt_pk_bf16_f32 v221, v222, v223
    s_nop 4
    v_cvt_pk_bf16_f32 v222, v224, v225
    v_cvt_pk_bf16_f32 v223, v226, v227
    v_mov_b32 v224, v220
    v_mov_b32 v225, v221
    v_mov_b32_dpp v220, v222 row_ror:8 row_mask:0xf bank_mask:0xc
    v_mov_b32_dpp v221, v223 row_ror:8 row_mask:0xf bank_mask:0xc
    v_mov_b32_dpp v222, v224 row_ror:8 row_mask:0xf bank_mask:0x3
    v_mov_b32_dpp v223, v225 row_ror:8 row_mask:0xf bank_mask:0x3
    buffer_store_dwordx4 v[220:223], v30, s[4:7], s49 offen sc1
    s_mov_b32 s51, 5505024
L_fp_111:
    buffer_load_dwordx4 v[120:123], v31, s[4:7], s51 offen sc1
    s_sub_u32 s36, s36, 1
    s_cbranch_scc1 L_exit
    s_waitcnt vmcnt(0)
    v_max3_u32 v41, v120, v121, v122
    v_max_u32 v41, v41, v123
    v_cmp_eq_u32 vcc, -1, v41
    s_cbranch_vccnz L_fp_111
    s_mov_b32 s52, 5160960
    v_mfma_f32_16x16x32_bf16 v[232:235], a[144:147], v[120:123], 0
    s_nop 7
    v_cndmask_b32 v234, v232, v233, s[58:59]
    v_cndmask_b32 v235, v233, v232, s[58:59]
    s_nop 1
    v_add_f32_dpp v235, v234, v235 row_ror:8 row_mask:0xf bank_mask:0xf
    v_cvt_pk_bf16_f32 v235, v235, v235
    buffer_store_short v235, v32, s[28:31], s52 offen offset:0
    s_endpgm
L_fw_86c:
    v_mov_b32 v148, -1
    v_mov_b32 v149, -1
    v_mov_b32 v150, -1
    v_mov_b32 v151, -1
    v_mov_b32 v152, -1
    v_mov_b32 v153, -1
    v_mov_b32 v154, -1
    v_mov_b32 v155, -1
    s_add_u32 s53, s53, 1310720
    s_branch L_fw_86
L_vm_96:
    buffer_load_dwordx4 v44, s[4:7], s43 offen offset:0 sc1 lds
    buffer_load_dwordx4 v44, s[4:7], s43 offen offset:1024 sc1 lds
    buffer_load_dwordx4 v44, s[4:7], s43 offen offset:2048 sc1 lds
    s_sub_u32 s36, s36, 1
    s_cbranch_scc1 L_exit
    v_add_u32 v5, s53, v12
    s_waitcnt vmcnt(0)
    ds_read_b128 v[136:139], v5 offset:0
    ds_read_b128 v[140:143], v5 offset:1024
    ds_read_b128 v[144:147], v5 offset:2048
    s_waitcnt lgkmcnt(0)
    v_max_u32 v4, v136, v137
    v_max3_u32 v4, v4, v138, v139
    v_max3_u32 v4, v4, v140, v141
    v_max3_u32 v4, v4, v142, v143
    v_max3_u32 v4, v4, v144, v145
    v_max3_u32 v4, v4, v146, v147
    v_cmp_eq_u32 vcc, -1, v4
    s_cbranch_vccnz L_vm_96
    buffer_load_dwordx4 v[92:95], v38, s[4:7], s43 offen offset:0 sc1
    buffer_load_dwordx4 v[96:99], v38, s[4:7], s43 offen offset:1280 sc1
    buffer_load_dwordx4 v[100:103], v38, s[4:7], s43 offen offset:2560 sc1
    buffer_load_dword v104, v39, s[4:7], s43 offen offset:0 sc1
    buffer_load_dword v105, v39, s[4:7], s43 offen offset:1280 sc1
    buffer_load_dword v106, v39, s[4:7], s43 offen offset:2560 sc1
    ds_read_b64_tr_b16 v[136:137], v16 offset:0
    ds_read_b64_tr_b16 v[138:139], v13 offset:0
    ds_read_b64_tr_b16 v[140:141], v16 offset:1024
    ds_read_b64_tr_b16 v[142:143], v13 offset:1024
    ds_read_b64_tr_b16 v[144:145], v16 offset:2048
    ds_read_b64_tr_b16 v[146:147], v13 offset:2048
    v_mov_b32 v148, 0
    v_mov_b32 v149, 0
    v_mov_b32 v150, 0
    v_mov_b32 v151, 0
    v_mov_b32 v152, 0
    v_mov_b32 v153, 0
    v_mov_b32 v154, 0
    v_mov_b32 v155, 0
    v_mov_b32 v156, 0
    v_mov_b32 v157, 0
    v_mov_b32 v158, 0
    v_mov_b32 v159, 0
    v_mov_b32 v160, 0
    v_mov_b32 v161, 0
    v_mov_b32 v162, 0
    v_mov_b32 v163, 0
    s_waitcnt lgkmcnt(0)
    v_smfmac_f32_16x16x64_bf16 v[148:151], v[136:139], a[0:7], v10
    v_smfmac_f32_16x16x64_bf16 v[152:155], v[136:139], a[24:31], v10
    v_smfmac_f32_16x16x64_bf16 v[156:159], v[136:139], a[48:55], v10
    v_smfmac_f32_16x16x64_bf16 v[160:163], v[136:139], a[72:79], v10
    v_smfmac_f32_16x16x64_bf16 v[148:151], v[140:143], a[8:15], v10
    v_smfmac_f32_16x16x64_bf16 v[152:155], v[140:143], a[32:39], v10
    v_smfmac_f32_16x16x64_bf16 v[156:159], v[140:143], a[56:63], v10
    v_smfmac_f32_16x16x64_bf16 v[160:163], v[140:143], a[80:87], v10
    v_smfmac_f32_16x16x64_bf16 v[148:151], v[144:147], a[16:23], v10
    v_smfmac_f32_16x16x64_bf16 v[152:155], v[144:147], a[40:47], v10
    v_smfmac_f32_16x16x64_bf16 v[156:159], v[144:147], a[64:71], v10
    v_smfmac_f32_16x16x64_bf16 v[160:163], v[144:147], a[88:95], v10
    v_pk_add_f32 v[148:149], v[148:149], v[150:151]
    v_cmp_u_f32 vcc, v148, v149
    v_cvt_pk_bf16_f32 v50, v148, v149
    v_cvt_pk_bf16_f32 v54, v148, v149
    v_pk_add_f32 v[152:153], v[152:153], v[154:155]
    v_cvt_pk_bf16_f32 v58, v152, v153
    v_cvt_pk_bf16_f32 v62, v152, v153
    v_pk_add_f32 v[156:157], v[156:157], v[158:159]
    v_cvt_pk_bf16_f32 v66, v156, v157
    v_cvt_pk_bf16_f32 v70, v156, v157
    v_pk_add_f32 v[160:161], v[160:161], v[162:163]
    v_cvt_pk_bf16_f32 v74, v160, v161
    v_cvt_pk_bf16_f32 v78, v160, v161
    s_cmp_eq_u32 s37, 63
    s_branch L_u_97
L_sp_100:
    v_max3_u32 v4, v104, v105, v106
    v_max3_u32 v4, v4, v92, v93
    v_max3_u32 v4, v4, v94, v95
    v_max3_u32 v4, v4, v96, v97
    v_max3_u32 v4, v4, v98, v99
    v_max3_u32 v4, v4, v100, v101
    v_max3_u32 v4, v4, v102, v103
    v_cmp_eq_u32 vcc, -1, v4
    s_cbranch_vccz L_sg_101
    buffer_load_dwordx4 v[92:95], v38, s[4:7], s43 offen offset:0 sc1
    buffer_load_dwordx4 v[96:99], v38, s[4:7], s43 offen offset:1280 sc1
    buffer_load_dwordx4 v[100:103], v38, s[4:7], s43 offen offset:2560 sc1
    buffer_load_dword v104, v39, s[4:7], s43 offen offset:0 sc1
    buffer_load_dword v105, v39, s[4:7], s43 offen offset:1280 sc1
    buffer_load_dword v106, v39, s[4:7], s43 offen offset:2560 sc1
    s_sub_u32 s36, s36, 1
    s_cbranch_scc1 L_exit
    s_branch L_sc_99
L_px_s:
    v_and_b32 v1, 15, v0
    v_lshrrev_b32 v2, 4, v0
    s_mul_i32 s90, s32, 12288
    v_lshl_add_u32 v10, v0, 4, s90
    s_mul_i32 s90, s32, 3072
    v_lshl_add_u32 v12, v0, 4, s90
    v_lshrrev_b32 v3, 2, v1
    v_lshlrev_b32 v3, 1, v3
    v_and_b32 v4, 1, v1
    v_or_b32 v3, v3, v4
    v_lshl_add_u32 v3, v2, 3, v3
    v_lshl_add_u32 v11, v3, 4, s90
    s_lshl_b32 s90, s32, 7
    v_min_u32 v3, 11, v0
    v_lshl_add_u32 v3, v3, 2, s90
    v_add_u32 v13, 458752, v3
    v_min_u32 v3, 2, v0
    v_lshl_add_u32 v3, v3, 2, s90
    v_add_u32 v14, 459264, v3
    v_add_u32 v22, 462336, v3
    s_add_u32 s90, s90, 459776
    v_mov_b32 v15, s90
    v_cmp_eq_u32 vcc, 0, v0
    v_mov_b32 v9, 2146435072
    s_nop 0
    v_cndmask_b32 v15, v9, v15, vcc
    s_nop 0
    v_mov_b32 v21, 0xd04e79ff
    s_mov_b32 s44, 0x3dd53b95
    v_lshl_add_u32 v3, v2, 2, 0
    v_cmp_le_u32 s[48:49], v3, v1
    v_lshl_add_u32 v3, v2, 2, 1
    v_cmp_le_u32 s[50:51], v3, v1
    v_lshl_add_u32 v3, v2, 2, 2
    v_cmp_le_u32 s[52:53], v3, v1
    v_lshl_add_u32 v3, v2, 2, 3
    v_cmp_le_u32 s[54:55], v3, v1
    v_mov_b32 v167, 0
    v_mov_b32 v171, 0
    v_mov_b32 v174, 0
    v_mov_b32 v175, 0
    s_waitcnt vmcnt(0)
    s_barrier
    s_mov_b32 s37, 0
    s_or_b32 s90, s34, s32
    s_cbranch_scc1 L_xg_112c
    v_lshlrev_b32 v1, 2, v0
L_arp_114:
    buffer_load_dword v2, v1, s[8:11], 0 offen sc1
    s_sub_u32 s36, s36, 1
    s_cbranch_scc1 L_exit
    s_waitcnt vmcnt(0)
    v_readlane_b32 s92, v2, 17
    s_nop 0
    s_cmp_lg_u32 s92, 256
    s_cbranch_scc1 L_arp_114
    v_mov_b32 v1, 196
    v_mov_b32 v2, 1
    s_mov_b64 exec, 1
    buffer_store_dword v2, v1, s[8:11], 0 offen sc1
    s_mov_b64 exec, -1
L_arr_113:
L_xg_112c:
    s_barrier
    v_mov_b32 v1, 196
L_gw_115:
    buffer_load_dword v2, v1, s[8:11], 0 offen sc1
    s_sub_u32 s36, s36, 1
    s_cbranch_scc1 L_exit
    s_waitcnt vmcnt(0)
    v_readfirstlane_b32 s90, v2
    s_nop 0
    s_cmp_eq_u32 s90, 0
    s_cbranch_scc1 L_gw_115
    s_cmp_lg_u32 s32, 0
    s_cbranch_scc1 L_xg_112
    s_lshl_b32 s92, s34, 14
    s_add_u32 s92, s92, 1966080
    s_add_u32 s93, s92, 8192
    v_lshlrev_b32 v3, 4, v0
    buffer_store_dwordx4 v[24:27], v3, s[4:7], s92 offen offset:0 sc1
    buffer_store_dwordx4 v[24:27], v3, s[4:7], s93 offen offset:0 sc1
    buffer_store_dwordx4 v[24:27], v3, s[4:7], s92 offen offset:1024 sc1
    buffer_store_dwordx4 v[24:27], v3, s[4:7], s93 offen offset:1024 sc1
    buffer_store_dwordx4 v[24:27], v3, s[4:7], s92 offen offset:2048 sc1
    buffer_store_dwordx4 v[24:27], v3, s[4:7], s93 offen offset:2048 sc1
    buffer_store_dwordx4 v[24:27], v3, s[4:7], s92 offen offset:3072 sc1
    buffer_store_dwordx4 v[24:27], v3, s[4:7], s93 offen offset:3072 sc1
    v_mov_b32 v3, 0
    s_mov_b32 s56, -1
    s_mov_b32 s57, -1
    s_mov_b32 s62, 0
    s_mov_b32 s63, 0
    s_waitcnt vmcnt(0)
L_pr_116:
    s_memtime s[58:59]
    s_waitcnt lgkmcnt(0)
    buffer_load_dword v4, v3, s[4:7], s92 offen sc1
    s_waitcnt vmcnt(0)
    s_memtime s[60:61]
    s_waitcnt lgkmcnt(0)
    s_sub_u32 s60, s60, s58
    s_min_u32 s56, s56, s60
    s_memtime s[58:59]
    s_waitcnt lgkmcnt(0)
    buffer_load_dword v4, v3, s[4:7], s93 offen sc1
    s_waitcnt vmcnt(0)
    s_memtime s[60:61]
    s_waitcnt lgkmcnt(0)
    s_sub_u32 s60, s60, s58
    s_min_u32 s57, s57, s60
    buffer_load_dword v4, v13, s[4:7], s38 offen sc1
    v_add_u32 v3, 128, v3
    s_add_u32 s62, s62, 1
    s_waitcnt vmcnt(0)
    v_cmp_eq_u32 vcc, 0, v4
    s_nop 0
    s_cmp_eq_u64 vcc, 0
    s_addc_u32 s63, s63, 0
    s_cmp_ge_u32 s63, 2
    s_cselect_b32 s62, 32, s62
    s_min_u32 s58, s56, s57
    s_max_u32 s59, s56, s57
    s_sub_u32 s59, s59, s58
    s_cmp_ge_u32 s59, 150
    s_cselect_b32 s58, s58, -1
    s_cmp_le_u32 s58, 540
    s_cselect_b32 s62, 32, s62
    s_cmp_lt_u32 s62, 32
    s_cbranch_scc1 L_pr_116
    s_cmp_lt_u32 s57, s56
    s_cselect_b32 s62, 2, 1
    s_nop 0
    v_mov_b32 v3, 460288
    v_mov_b32 v4, s62
    buffer_store_dword v4, v3, s[4:7], s38 offen sc1
    s_cmp_lg_u32 s34, 0
    s_cbranch_scc1 L_xg_112
    v_mov_b32 v3, 204
    buffer_store_dword v4, v3, s[8:11], 0 offen sc1
L_xg_112:
    s_barrier
    s_add_u32 s41, s38, 475136
L_pf_117:
    buffer_load_dword v16, v22, s[4:7], s38 offen sc1
    s_sub_u32 s36, s36, 1
    s_cbranch_scc1 L_exit
    s_waitcnt vmcnt(0)
    v_cmp_ge_u32 vcc, s37, v16
    s_cbranch_vccnz L_pf_117
    s_add_u32 s90, s41, 49152
    buffer_load_dwordx4 v[72:75], v10, s[4:7], s90 offen offset:0 sc1
    buffer_load_dwordx4 v[76:79], v10, s[4:7], s90 offen offset:1024 sc1
    buffer_load_dwordx4 v[80:83], v10, s[4:7], s90 offen offset:2048 sc1
    buffer_load_dwordx4 v[84:87], v10, s[4:7], s90 offen offset:3072 sc1
    s_add_u32 s90, s41, 53248
    buffer_load_dwordx4 v[88:91], v10, s[4:7], s90 offen offset:0 sc1
    buffer_load_dwordx4 v[92:95], v10, s[4:7], s90 offen offset:1024 sc1
    buffer_load_dwordx4 v[96:99], v10, s[4:7], s90 offen offset:2048 sc1
    buffer_load_dwordx4 v[100:103], v10, s[4:7], s90 offen offset:3072 sc1
    s_add_u32 s90, s41, 57344
    buffer_load_dwordx4 v[104:107], v10, s[4:7], s90 offen offset:0 sc1
    buffer_load_dwordx4 v[108:111], v10, s[4:7], s90 offen offset:1024 sc1
    buffer_load_dwordx4 v[112:115], v10, s[4:7], s90 offen offset:2048 sc1
    buffer_load_dwordx4 v[116:119], v10, s[4:7], s90 offen offset:3072 sc1
    s_add_u32 s90, s41, 0
    buffer_load_dwordx4 v[24:27], v10, s[4:7], s90 offen offset:0 sc1
    buffer_load_dwordx4 v[28:31], v10, s[4:7], s90 offen offset:1024 sc1
    buffer_load_dwordx4 v[32:35], v10, s[4:7], s90 offen offset:2048 sc1
    buffer_load_dwordx4 v[36:39], v10, s[4:7], s90 offen offset:3072 sc1
    s_add_u32 s90, s41, 4096
    buffer_load_dwordx4 v[40:43], v10, s[4:7], s90 offen offset:0 sc1
    buffer_load_dwordx4 v[44:47], v10, s[4:7], s90 offen offset:1024 sc1
    buffer_load_dwordx4 v[48:51], v10, s[4:7], s90 offen offset:2048 sc1
    buffer_load_dwordx4 v[52:55], v10, s[4:7], s90 offen offset:3072 sc1
    s_add_u32 s90, s41, 8192
    buffer_load_dwordx4 v[56:59], v10, s[4:7], s90 offen offset:0 sc1
    buffer_load_dwordx4 v[60:63], v10, s[4:7], s90 offen offset:1024 sc1
    buffer_load_dwordx4 v[64:67], v10, s[4:7], s90 offen offset:2048 sc1
    buffer_load_dwordx4 v[68:71], v10, s[4:7], s90 offen offset:3072 sc1
    s_waitcnt vmcnt(0)
L_px_loop_s:
    s_and_b32 s90, s37, 3
    s_mul_i32 s91, s90, 114688
    s_add_u32 s91, s91, s38
    s_add_u32 s42, s91, 40960
    s_add_u32 s43, s91, 53248
    s_add_u32 s90, s37, 1
    v_mov_b32 v17, s90
    s_and_b32 s90, s90, 3
    s_mul_i32 s91, s90, 98304
    s_add_u32 s91, s91, 475136
    s_add_u32 s41, s38, s91
    v_mfma_f32_16x16x32_bf16 v[144:147], v[72:75], v[24:27], 0
    v_mfma_f32_16x16x32_bf16 v[152:155], v[72:75], v[48:51], 0
    v_mfma_f32_16x16x32_bf16 v[156:159], v[96:99], v[48:51], 0
    v_mfma_f32_16x16x32_bf16 v[144:147], v[76:79], v[28:31], v[144:147]
    v_mfma_f32_16x16x32_bf16 v[152:155], v[76:79], v[52:55], v[152:155]
    v_mfma_f32_16x16x32_bf16 v[156:159], v[100:103], v[52:55], v[156:159]
    v_mfma_f32_16x16x32_bf16 v[144:147], v[80:83], v[32:35], v[144:147]
    v_mfma_f32_16x16x32_bf16 v[152:155], v[80:83], v[56:59], v[152:155]
    v_mfma_f32_16x16x32_bf16 v[156:159], v[104:107], v[56:59], v[156:159]
    v_mfma_f32_16x16x32_bf16 v[144:147], v[84:87], v[36:39], v[144:147]
    v_mfma_f32_16x16x32_bf16 v[152:155], v[84:87], v[60:63], v[152:155]
    v_mfma_f32_16x16x32_bf16 v[156:159], v[108:111], v[60:63], v[156:159]
    v_mfma_f32_16x16x32_bf16 v[144:147], v[88:91], v[40:43], v[144:147]
    v_mfma_f32_16x16x32_bf16 v[152:155], v[88:91], v[64:67], v[152:155]
    v_mfma_f32_16x16x32_bf16 v[156:159], v[112:115], v[64:67], v[156:159]
    v_mfma_f32_16x16x32_bf16 v[144:147], v[92:95], v[44:47], v[144:147]
    v_mfma_f32_16x16x32_bf16 v[152:155], v[92:95], v[68:71], v[152:155]
    v_mfma_f32_16x16x32_bf16 v[156:159], v[116:119], v[68:71], v[156:159]
    s_nop 0
    v_cndmask_b32 v144, v21, v144, s[48:49]
    v_cndmask_b32 v145, v21, v145, s[50:51]
    v_cndmask_b32 v146, v21, v146, s[52:53]
    v_cndmask_b32 v147, v21, v147, s[54:55]
    s_nop 2
    v_cndmask_b32 v156, v21, v156, s[48:49]
    v_cndmask_b32 v157, v21, v157, s[50:51]
    v_cndmask_b32 v158, v21, v158, s[52:53]
    v_cndmask_b32 v159, v21, v159, s[54:55]
L_pf_118:
    buffer_load_dword v16, v14, s[4:7], s38 offen sc1
    s_sub_u32 s36, s36, 1
    s_cbranch_scc1 L_exit
    s_waitcnt vmcnt(0)
    v_cmp_ge_u32 vcc, s37, v16
    s_cbranch_vccnz L_pf_118
    buffer_load_dwordx4 v[120:123], v11, s[4:7], s42 offen offset:0 sc1
    buffer_load_dwordx4 v[124:127], v11, s[4:7], s42 offen offset:512 sc1
    buffer_load_dwordx4 v[128:131], v11, s[4:7], s42 offen offset:1024 sc1
    buffer_load_dwordx4 v[132:135], v11, s[4:7], s42 offen offset:1536 sc1
    buffer_load_dwordx4 v[136:139], v11, s[4:7], s42 offen offset:2048 sc1
    buffer_load_dwordx4 v[140:143], v11, s[4:7], s42 offen offset:2560 sc1
    s_waitcnt vmcnt(5)
    v_mfma_f32_16x16x32_bf16 v[148:151], v[120:123], v[24:27], 0
    v_mfma_f32_16x16x32_bf16 v[160:163], v[120:123], v[48:51], 0
    s_waitcnt vmcnt(4)
    v_mfma_f32_16x16x32_bf16 v[148:151], v[124:127], v[28:31], v[148:151]
    v_mfma_f32_16x16x32_bf16 v[160:163], v[124:127], v[52:55], v[160:163]
    s_waitcnt vmcnt(3)
    v_mfma_f32_16x16x32_bf16 v[148:151], v[128:131], v[32:35], v[148:151]
    v_mfma_f32_16x16x32_bf16 v[160:163], v[128:131], v[56:59], v[160:163]
    s_waitcnt vmcnt(2)
    v_mfma_f32_16x16x32_bf16 v[148:151], v[132:135], v[36:39], v[148:151]
    v_mfma_f32_16x16x32_bf16 v[160:163], v[132:135], v[60:63], v[160:163]
    s_waitcnt vmcnt(1)
    v_mfma_f32_16x16x32_bf16 v[148:151], v[136:139], v[40:43], v[148:151]
    v_mfma_f32_16x16x32_bf16 v[160:163], v[136:139], v[64:67], v[160:163]
    s_waitcnt vmcnt(0)
    v_mfma_f32_16x16x32_bf16 v[148:151], v[140:143], v[44:47], v[148:151]
    v_mfma_f32_16x16x32_bf16 v[160:163], v[140:143], v[68:71], v[160:163]
    s_cmp_eq_u32 s37, 63
    s_nop 2
    s_cbranch_scc1 L_pxl_119
    s_add_u32 s90, s41, 49152
    v_max_f32 v18, v144, v145
    v_max3_f32 v18, v18, v146, v147
    v_max3_f32 v18, v18, v148, v149
    v_mov_b32 v19, v18
    buffer_load_dwordx4 v[72:75], v10, s[4:7], s90 offen offset:0 sc1
    s_nop 0
    v_permlane16_swap_b32 v18, v19
    v_max_f32 v18, v18, v19
    v_mov_b32 v19, v18
    s_nop 1
    v_permlane32_swap_b32 v18, v19
    buffer_load_dwordx4 v[76:79], v10, s[4:7], s90 offen offset:1024 sc1
    v_max_f32 v18, v18, v19
    v_mul_f32 v18, 0xbdd53b95, v18
    v_fma_f32 v144, v144, s44, v18
    v_fma_f32 v145, v145, s44, v18
    buffer_load_dwordx4 v[80:83], v10, s[4:7], s90 offen offset:2048 sc1
    v_fma_f32 v146, v146, s44, v18
    v_fma_f32 v147, v147, s44, v18
    v_fma_f32 v148, v148, s44, v18
    v_fma_f32 v149, v149, s44, v18
    buffer_load_dwordx4 v[84:87], v10, s[4:7], s90 offen offset:3072 sc1
    v_exp_f32 v144, v144
    v_exp_f32 v145, v145
    v_exp_f32 v146, v146
    v_exp_f32 v147, v147
    s_add_u32 s90, s41, 53248
    v_exp_f32 v148, v148
    v_exp_f32 v149, v149
    v_add_f32 v20, v144, v145
    v_add_f32 v20, v20, v146
    buffer_load_dwordx4 v[88:91], v10, s[4:7], s90 offen offset:0 sc1
    v_add_f32 v20, v20, v147
    v_add_f32 v20, v20, v148
    v_add_f32 v20, v20, v149
    v_mov_b32 v19, v20
    buffer_load_dwordx4 v[92:95], v10, s[4:7], s90 offen offset:1024 sc1
    s_nop 0
    v_permlane16_swap_b32 v20, v19
    v_add_f32 v20, v20, v19
    v_mov_b32 v19, v20
    s_nop 1
    v_permlane32_swap_b32 v20, v19
    buffer_load_dwordx4 v[96:99], v10, s[4:7], s90 offen offset:2048 sc1
    v_add_f32 v20, v20, v19
    v_rcp_f32 v20, v20
    s_nop 0
    v_mul_f32 v144, v144, v20
    v_mul_f32 v145, v145, v20
    buffer_load_dwordx4 v[100:103], v10, s[4:7], s90 offen offset:3072 sc1
    v_mul_f32 v146, v146, v20
    v_mul_f32 v147, v147, v20
    v_mul_f32 v148, v148, v20
    v_mul_f32 v149, v149, v20
    s_add_u32 s90, s41, 57344
    v_cvt_pk_bf16_f32 v164, v144, v145
    v_cvt_pk_bf16_f32 v165, v146, v147
    v_cvt_pk_bf16_f32 v166, v148, v149
    v_max_f32 v18, v152, v153
    buffer_load_dwordx4 v[104:107], v10, s[4:7], s90 offen offset:0 sc1
    v_max3_f32 v18, v18, v154, v155
    v_max3_f32 v18, v18, v160, v161
    v_max3_f32 v18, v18, v156, v157
    v_max3_f32 v18, v18, v158, v159
    buffer_load_dwordx4 v[108:111], v10, s[4:7], s90 offen offset:1024 sc1
    v_mov_b32 v19, v18
    s_nop 1
    v_permlane16_swap_b32 v18, v19
    v_max_f32 v18, v18, v19
    v_mov_b32 v19, v18
    buffer_load_dwordx4 v[112:115], v10, s[4:7], s90 offen offset:2048 sc1
    s_nop 0
    v_permlane32_swap_b32 v18, v19
    v_max_f32 v18, v18, v19
    v_mul_f32 v18, 0xbdd53b95, v18
    v_fma_f32 v152, v152, s44, v18
    buffer_load_dwordx4 v[116:119], v10, s[4:7], s90 offen offset:3072 sc1
    v_fma_f32 v153, v153, s44, v18
    v_fma_f32 v154, v154, s44, v18
    v_fma_f32 v155, v155, s44, v18
    v_fma_f32 v160, v160, s44, v18
    s_add_u32 s90, s41, 0
    v_fma_f32 v161, v161, s44, v18
    v_fma_f32 v156, v156, s44, v18
    v_fma_f32 v157, v157, s44, v18
    v_fma_f32 v158, v158, s44, v18
    buffer_load_dwordx4 v[24:27], v10, s[4:7], s90 offen offset:0 sc1
    v_fma_f32 v159, v159, s44, v18
    v_exp_f32 v152, v152
    v_exp_f32 v153, v153
    v_exp_f32 v154, v154
    buffer_load_dwordx4 v[28:31], v10, s[4:7], s90 offen offset:1024 sc1
    v_exp_f32 v155, v155
    v_exp_f32 v160, v160
    v_exp_f32 v161, v161
    v_exp_f32 v156, v156
    buffer_load_dwordx4 v[32:35], v10, s[4:7], s90 offen offset:2048 sc1
    v_exp_f32 v157, v157
    v_exp_f32 v158, v158
    v_exp_f32 v159, v159
    v_add_f32 v20, v152, v153
    buffer_load_dwordx4 v[36:39], v10, s[4:7], s90 offen offset:3072 sc1
    v_add_f32 v20, v20, v154
    v_add_f32 v20, v20, v155
    v_add_f32 v20, v20, v160
    v_add_f32 v20, v20, v161
    s_add_u32 s90, s41, 4096
    v_add_f32 v20, v20, v156
    v_add_f32 v20, v20, v157
    v_add_f32 v20, v20, v158
    v_add_f32 v20, v20, v159
    buffer_load_dwordx4 v[40:43], v10, s[4:7], s90 offen offset:0 sc1
    v_mov_b32 v19, v20
    s_nop 1
    v_permlane16_swap_b32 v20, v19
    v_add_f32 v20, v20, v19
    v_mov_b32 v19, v20
    buffer_load_dwordx4 v[44:47], v10, s[4:7], s90 offen offset:1024 sc1
    s_nop 0
    v_permlane32_swap_b32 v20, v19
    v_add_f32 v20, v20, v19
    v_rcp_f32 v20, v20
    s_nop 0
    v_mul_f32 v152, v152, v20
    buffer_load_dwordx4 v[48:51], v10, s[4:7], s90 offen offset:2048 sc1
    v_mul_f32 v153, v153, v20
    v_mul_f32 v154, v154, v20
    v_mul_f32 v155, v155, v20
    v_mul_f32 v160, v160, v20
    buffer_load_dwordx4 v[52:55], v10, s[4:7], s90 offen offset:3072 sc1
    v_mul_f32 v161, v161, v20
    v_mul_f32 v156, v156, v20
    v_mul_f32 v157, v157, v20
    v_mul_f32 v158, v158, v20
    s_add_u32 s90, s41, 8192
    v_mul_f32 v159, v159, v20
    v_cvt_pk_bf16_f32 v168, v152, v153
    v_cvt_pk_bf16_f32 v169, v154, v155
    v_cvt_pk_bf16_f32 v170, v160, v161
    buffer_load_dwordx4 v[56:59], v10, s[4:7], s90 offen offset:0 sc1
    v_cvt_pk_bf16_f32 v172, v156, v157
    v_cvt_pk_bf16_f32 v173, v158, v159
    buffer_load_dwordx4 v[60:63], v10, s[4:7], s90 offen offset:1024 sc1
    buffer_load_dwordx4 v[64:67], v10, s[4:7], s90 offen offset:2048 sc1
    buffer_load_dwordx4 v[68:71], v10, s[4:7], s90 offen offset:3072 sc1
    buffer_store_dwordx4 v[164:167], v12, s[4:7], s43 offen offset:0 sc1
    buffer_store_dwordx4 v[168:171], v12, s[4:7], s43 offen offset:1024 sc1
    buffer_store_dwordx4 v[172:175], v12, s[4:7], s43 offen offset:2048 sc1
    s_waitcnt vmcnt(0)
    buffer_store_dword v17, v15, s[4:7], s38 offen sc1
    s_add_u32 s37, s37, 1
    s_branch L_px_loop_s
L_pxl_119:
    v_max_f32 v18, v144, v145
    v_max3_f32 v18, v18, v146, v147
    v_max3_f32 v18, v18, v148, v149
    v_mov_b32 v19, v18
    s_nop 1
    v_permlane16_swap_b32 v18, v19
    v_max_f32 v18, v18, v19
    v_mov_b32 v19, v18
    s_nop 1
    v_permlane32_swap_b32 v18, v19
    v_max_f32 v18, v18, v19
    v_mul_f32 v18, 0xbdd53b95, v18
    v_fma_f32 v144, v144, s44, v18
    v_fma_f32 v145, v145, s44, v18
    v_fma_f32 v146, v146, s44, v18
    v_fma_f32 v147, v147, s44, v18
    v_fma_f32 v148, v148, s44, v18
    v_fma_f32 v149, v149, s44, v18
    v_exp_f32 v144, v144
    v_exp_f32 v145, v145
    v_exp_f32 v146, v146
    v_exp_f32 v147, v147
    v_exp_f32 v148, v148
    v_exp_f32 v149, v149
    v_add_f32 v20, v144, v145
    v_add_f32 v20, v20, v146
    v_add_f32 v20, v20, v147
    v_add_f32 v20, v20, v148
    v_add_f32 v20, v20, v149
    v_mov_b32 v19, v20
    s_nop 1
    v_permlane16_swap_b32 v20, v19
    v_add_f32 v20, v20, v19
    v_mov_b32 v19, v20
    s_nop 1
    v_permlane32_swap_b32 v20, v19
    v_add_f32 v20, v20, v19
    v_rcp_f32 v20, v20
    s_nop 0
    v_mul_f32 v144, v144, v20
    v_mul_f32 v145, v145, v20
    v_mul_f32 v146, v146, v20
    v_mul_f32 v147, v147, v20
    v_mul_f32 v148, v148, v20
    v_mul_f32 v149, v149, v20
    v_cvt_pk_bf16_f32 v164, v144, v145
    v_cvt_pk_bf16_f32 v165, v146, v147
    v_cvt_pk_bf16_f32 v166, v148, v149
    v_max_f32 v18, v152, v153
    v_max3_f32 v18, v18, v154, v155
    v_max3_f32 v18, v18, v160, v161
    v_max3_f32 v18, v18, v156, v157
    v_max3_f32 v18, v18, v158, v159
    v_mov_b32 v19, v18
    s_nop 1
    v_permlane16_swap_b32 v18, v19
    v_max_f32 v18, v18, v19
    v_mov_b32 v19, v18
    s_nop 1
    v_permlane32_swap_b32 v18, v19
    v_max_f32 v18, v18, v19
    v_mul_f32 v18, 0xbdd53b95, v18
    v_fma_f32 v152, v152, s44, v18
    v_fma_f32 v153, v153, s44, v18
    v_fma_f32 v154, v154, s44, v18
    v_fma_f32 v155, v155, s44, v18
    v_fma_f32 v160, v160, s44, v18
    v_fma_f32 v161, v161, s44, v18
    v_fma_f32 v156, v156, s44, v18
    v_fma_f32 v157, v157, s44, v18
    v_fma_f32 v158, v158, s44, v18
    v_fma_f32 v159, v159, s44, v18
    v_exp_f32 v152, v152
    v_exp_f32 v153, v153
    v_exp_f32 v154, v154
    v_exp_f32 v155, v155
    v_exp_f32 v160, v160
    v_exp_f32 v161, v161
    v_exp_f32 v156, v156
    v_exp_f32 v157, v157
    v_exp_f32 v158, v158
    v_exp_f32 v159, v159
    v_add_f32 v20, v152, v153
    v_add_f32 v20, v20, v154
    v_add_f32 v20, v20, v155
    v_add_f32 v20, v20, v160
    v_add_f32 v20, v20, v161
    v_add_f32 v20, v20, v156
    v_add_f32 v20, v20, v157
    v_add_f32 v20, v20, v158
    v_add_f32 v20, v20, v159
    v_mov_b32 v19, v20
    s_nop 1
    v_permlane16_swap_b32 v20, v19
    v_add_f32 v20, v20, v19
    v_mov_b32 v19, v20
    s_nop 1
    v_permlane32_swap_b32 v20, v19
    v_add_f32 v20, v20, v19
    v_rcp_f32 v20, v20
    s_nop 0
    v_mul_f32 v152, v152, v20
    v_mul_f32 v153, v153, v20
    v_mul_f32 v154, v154, v20
    v_mul_f32 v155, v155, v20
    v_mul_f32 v160, v160, v20
    v_mul_f32 v161, v161, v20
    v_mul_f32 v156, v156, v20
    v_mul_f32 v157, v157, v20
    v_mul_f32 v158, v158, v20
    v_mul_f32 v159, v159, v20
    v_cvt_pk_bf16_f32 v168, v152, v153
    v_cvt_pk_bf16_f32 v169, v154, v155
    v_cvt_pk_bf16_f32 v170, v160, v161
    v_cvt_pk_bf16_f32 v172, v156, v157
    v_cvt_pk_bf16_f32 v173, v158, v159
    buffer_store_dwordx4 v[164:167], v12, s[4:7], s43 offen offset:0 sc1
    buffer_store_dwordx4 v[168:171], v12, s[4:7], s43 offen offset:1024 sc1
    buffer_store_dwordx4 v[172:175], v12, s[4:7], s43 offen offset:2048 sc1
    s_waitcnt vmcnt(0)
    buffer_store_dword v17, v15, s[4:7], s38 offen sc1
    s_endpgm
L_pa_s:
    v_mov_b32 v1, 196
L_gw_120:
    buffer_load_dword v2, v1, s[8:11], 0 offen sc1
    s_sub_u32 s36, s36, 1
    s_cbranch_scc1 L_exit
    s_waitcnt vmcnt(0)
    v_readfirstlane_b32 s90, v2
    s_nop 0
    s_cmp_eq_u32 s90, 0
    s_cbranch_scc1 L_gw_120
    s_branch L_pa_body
.section .rodata,"a"
.p2align 6
.amdhsa_kernel concat_heads__sliding_local_dilated__memory_aug_recurrent_mem_tr__prompt_kernel
  .amdhsa_next_free_vgpr 512
  .amdhsa_next_free_sgpr 102
  .amdhsa_accum_offset 256
  .amdhsa_group_segment_fixed_size 0
  .amdhsa_kernarg_size 104
  .amdhsa_user_sgpr_count 2
  .amdhsa_user_sgpr_kernarg_segment_ptr 1
  .amdhsa_system_sgpr_workgroup_id_x 1
  .amdhsa_float_denorm_mode_32 3
.end_amdhsa_kernel
```

```asm
; @launch grid=(256,1,1) block=(256,1,1) lds=163840
.amdgcn_target "amdgcn-amd-amdhsa--gfx950"
.text
.globl concat_heads__sliding_local_dilated__memory_aug_recurrent_mem_tr__prompt_kernel
.p2align 8
.type concat_heads__sliding_local_dilated__memory_aug_recurrent_mem_tr__prompt_kernel,@function
concat_heads__sliding_local_dilated__memory_aug_recurrent_mem_tr__prompt_kernel:
    s_cmp_ge_u32 s2, 256
    s_cbranch_scc1 L_exit
    s_load_dwordx16 s[64:79], s[0:1], 0
    s_load_dwordx8 s[80:87], s[0:1], 64
    s_load_dwordx2 s[88:89], s[0:1], 96
    s_getreg_b32 s33, hwreg(HW_REG_XCC_ID, 0, 4)
    v_lshrrev_b32 v1, 6, v0
    v_and_b32 v0, 63, v0
    v_readfirstlane_b32 s32, v1
    s_mov_b32 s36, 0x40000
    s_mov_b32 s96, 0
    s_mov_b32 s97, 0
    s_and_b32 s90, s33, 4
    s_lshl_b32 s90, s90, 5
    s_and_b32 s91, s33, 3
    s_lshl_b32 s91, s91, 2
    s_add_u32 s90, s90, s91
    s_lshr_b32 s91, s33, 3
    s_lshl_b32 s91, s91, 4
    s_add_u32 s90, s90, s91
    v_mov_b32 v1, s90
    v_mov_b32 v2, 1
    v_mov_b32 v3, 0
    s_waitcnt lgkmcnt(0)
    s_mov_b32 s8, s86
    s_and_b32 s9, s87, 0xffff
    s_mov_b32 s10, 256
    s_mov_b32 s11, 0x20000
    s_mov_b32 s4, s88
    s_and_b32 s5, s89, 0xffff
    s_mov_b32 s6, 33554432
    s_mov_b32 s7, 0x20000
    s_mov_b32 s28, s84
    s_and_b32 s29, s85, 0xffff
    s_mov_b32 s30, 5242880
    s_mov_b32 s31, 0x20000
    s_cmp_lg_u32 s32, 0
    s_cbranch_scc1 L_norank
    s_mov_b64 exec, 1
    buffer_atomic_add v2, v1, s[8:11], 0 offen sc0 sc1
    s_mov_b64 exec, -1
    v_mov_b32 v240, -1
    v_mov_b32 v241, -1
    v_mov_b32 v242, -1
    v_mov_b32 v243, -1
    v_mov_b32 v244, 0
    v_lshlrev_b32 v4, 4, v0
    v_lshlrev_b32 v5, 2, v0
    s_mul_i32 s91, s2, 2560
    s_and_b32 s92, s2, 7
    s_lshl_b32 s92, s92, 21
    s_add_u32 s92, s92, 8388608
    s_lshr_b32 s93, s2, 3
    s_lshl_b32 s40, s93, 7
    s_add_u32 s40, s40, s92
    s_add_u32 s40, s40, 458752
    s_lshr_b32 s41, s93, 4
    s_mul_i32 s41, s41, 114688
    s_add_u32 s92, s92, s41
    s_and_b32 s93, s93, 15
    s_mul_i32 s93, s93, 2560
    s_add_u32 s92, s92, s93
    buffer_store_dwordx4 v[240:243], v4, s[4:7], s91 offen sc1
    buffer_store_dwordx4 v[240:243], v4, s[4:7], s91 offen offset:1024 sc1
    buffer_store_dword v240, v5, s[4:7], s91 offen offset:2048 sc1
    buffer_store_dword v240, v5, s[4:7], s91 offen offset:2304 sc1
    buffer_store_dwordx4 v[240:243], v4, s[4:7], s92 offen sc1
    buffer_store_dwordx4 v[240:243], v4, s[4:7], s92 offen offset:1024 sc1
    buffer_store_dword v240, v5, s[4:7], s92 offen offset:2048 sc1
    buffer_store_dword v240, v5, s[4:7], s92 offen offset:2304 sc1
    s_mov_b64 exec, 0xffffffff
    buffer_store_dword v244, v5, s[4:7], s40 offen sc1
    s_lshl_b32 s40, s2, 7
    s_add_u32 s40, s40, 1933312
    buffer_store_dword v244, v5, s[4:7], s40 offen sc1
    s_mov_b64 exec, -1
    s_waitcnt vmcnt(10)
    s_mov_b64 exec, 1
    ds_write_b32 v3, v2
    s_mov_b64 exec, -1
    s_waitcnt vmcnt(0) lgkmcnt(0)
    s_and_b32 s91, s33, 4
    s_lshl_b32 s91, s91, 5
    s_add_u32 s91, s91, 48
    v_mov_b32 v1, s91
    v_mov_b32 v4, 1
    s_mov_b64 exec, 1
    buffer_atomic_add v4, v1, s[8:11], 0 offen sc1
    s_mov_b64 exec, -1
    s_branch L_rank
L_norank:
    s_and_b32 s34, s33, 7
    s_lshr_b32 s93, s2, 3
    s_mul_i32 s93, s93, 3
    s_add_u32 s93, s93, s32
    s_sub_u32 s93, s93, 1
    v_add_u32 v4, 0, v0
    v_cmp_le_u32 vcc, 96, v4
    v_subrev_u32 v5, 96, v4
    s_nop 0
    v_cndmask_b32 v4, v4, v5, vcc
    v_lshlrev_b32 v4, 4, v4
    v_mov_b32 v5, 12288
    v_cndmask_b32 v5, 0, v5, vcc
    s_mul_i32 s90, s34, 1536
    v_add3_u32 v6, v4, v5, s90
    v_add_u32 v4, 64, v0
    v_cmp_le_u32 vcc, 96, v4
    v_subrev_u32 v5, 96, v4
    s_nop 0
    v_cndmask_b32 v4, v4, v5, vcc
    v_lshlrev_b32 v4, 4, v4
    v_mov_b32 v5, 12288
    v_cndmask_b32 v5, 0, v5, vcc
    s_mul_i32 s90, s34, 1536
    v_add3_u32 v7, v4, v5, s90
    v_add_u32 v4, 128, v0
    v_cmp_le_u32 vcc, 96, v4
    v_subrev_u32 v5, 96, v4
    s_nop 0
    v_cndmask_b32 v4, v4, v5, vcc
    v_lshlrev_b32 v4, 4, v4
    v_mov_b32 v5, 12288
    v_cndmask_b32 v5, 0, v5, vcc
    s_mul_i32 s90, s34, 1536
    v_add3_u32 v8, v4, v5, s90
    s_cmp_lt_u32 s93, 64
    s_cselect_b32 s12, s74, s76
    s_cselect_b32 s13, s75, s77
    s_cselect_b32 s91, 1, 0
    s_cmp_lt_u32 s93, 32
    s_cselect_b32 s12, s78, s12
    s_cselect_b32 s13, s79, s13
    s_cselect_b32 s91, 2, s91
    s_and_b32 s13, s13, 0xffff
    s_mov_b32 s14, 7864320
    s_mov_b32 s15, 0x20000
    s_mul_i32 s91, s91, 320
    s_mul_i32 s90, s93, 10
    s_add_u32 s90, s90, s91
    s_sub_u32 s90, s90, 640
    s_mul_i32 s90, s90, 12288
    buffer_load_dwordx4 v[248:251], v6, s[12:15], s90 offen
    buffer_load_dwordx4 v[248:251], v7, s[12:15], s90 offen
    buffer_load_dwordx4 v[248:251], v8, s[12:15], s90 offen
    s_add_u32 s90, s90, 24576
    buffer_load_dwordx4 v[248:251], v6, s[12:15], s90 offen
    buffer_load_dwordx4 v[248:251], v7, s[12:15], s90 offen
    buffer_load_dwordx4 v[248:251], v8, s[12:15], s90 offen
    s_add_u32 s90, s90, 24576
    buffer_load_dwordx4 v[248:251], v6, s[12:15], s90 offen
    buffer_load_dwordx4 v[248:251], v7, s[12:15], s90 offen
    buffer_load_dwordx4 v[248:251], v8, s[12:15], s90 offen
    s_add_u32 s90, s90, 24576
    buffer_load_dwordx4 v[248:251], v6, s[12:15], s90 offen
    buffer_load_dwordx4 v[248:251], v7, s[12:15], s90 offen
    buffer_load_dwordx4 v[248:251], v8, s[12:15], s90 offen
    s_add_u32 s90, s90, 24576
    buffer_load_dwordx4 v[248:251], v6, s[12:15], s90 offen
    buffer_load_dwordx4 v[248:251], v7, s[12:15], s90 offen
    buffer_load_dwordx4 v[248:251], v8, s[12:15], s90 offen
    s_add_u32 s90, s90, 24576
    v_add_u32 v4, 0, v0
    v_cmp_le_u32 vcc, 96, v4
    v_subrev_u32 v5, 96, v4
    s_nop 0
    v_cndmask_b32 v4, v4, v5, vcc
    v_lshlrev_b32 v4, 4, v4
    v_mov_b32 v5, 12288
    v_cndmask_b32 v5, 0, v5, vcc
    s_mul_i32 s90, s34, 1536
    v_add3_u32 v6, v4, v5, s90
    v_add_u32 v4, 64, v0
    v_cmp_le_u32 vcc, 96, v4
    v_subrev_u32 v5, 96, v4
    s_nop 0
    v_cndmask_b32 v4, v4, v5, vcc
    v_lshlrev_b32 v4, 4, v4
    v_mov_b32 v5, 12288
    v_cndmask_b32 v5, 0, v5, vcc
    s_mul_i32 s90, s34, 1536
    v_add3_u32 v7, v4, v5, s90
    v_add_u32 v4, 128, v0
    v_cmp_le_u32 vcc, 96, v4
    v_subrev_u32 v5, 96, v4
    s_nop 0
    v_cndmask_b32 v4, v4, v5, vcc
    v_lshlrev_b32 v4, 4, v4
    v_mov_b32 v5, 12288
    v_cndmask_b32 v5, 0, v5, vcc
    s_mul_i32 s90, s34, 1536
    v_add3_u32 v8, v4, v5, s90
    s_cmp_lt_u32 s93, 64
    s_cselect_b32 s12, s74, s76
    s_cselect_b32 s13, s75, s77
    s_cselect_b32 s91, 2, 1
    s_cmp_lt_u32 s93, 32
    s_cselect_b32 s12, s78, s12
    s_cselect_b32 s13, s79, s13
    s_cselect_b32 s91, 3, s91
    s_and_b32 s13, s13, 0xffff
    s_mov_b32 s14, 7864320
    s_mov_b32 s15, 0x20000
    s_mul_i32 s91, s91, 320
    s_mul_i32 s90, s93, 10
    s_add_u32 s90, s90, s91
    s_sub_u32 s90, s90, 640
    s_mul_i32 s90, s90, 12288
    buffer_load_dwordx4 v[248:251], v6, s[12:15], s90 offen
    buffer_load_dwordx4 v[248:251], v7, s[12:15], s90 offen
    buffer_load_dwordx4 v[248:251], v8, s[12:15], s90 offen
    s_add_u32 s90, s90, 24576
    buffer_load_dwordx4 v[248:251], v6, s[12:15], s90 offen
    buffer_load_dwordx4 v[248:251], v7, s[12:15], s90 offen
    buffer_load_dwordx4 v[248:251], v8, s[12:15], s90 offen
    s_add_u32 s90, s90, 24576
    buffer_load_dwordx4 v[248:251], v6, s[12:15], s90 offen
    buffer_load_dwordx4 v[248:251], v7, s[12:15], s90 offen
    buffer_load_dwordx4 v[248:251], v8, s[12:15], s90 offen
    s_add_u32 s90, s90, 24576
    buffer_load_dwordx4 v[248:251], v6, s[12:15], s90 offen
    buffer_load_dwordx4 v[248:251], v7, s[12:15], s90 offen
    buffer_load_dwordx4 v[248:251], v8, s[12:15], s90 offen
    s_add_u32 s90, s90, 24576
    buffer_load_dwordx4 v[248:251], v6, s[12:15], s90 offen
    buffer_load_dwordx4 v[248:251], v7, s[12:15], s90 offen
    buffer_load_dwordx4 v[248:251], v8, s[12:15], s90 offen
    s_add_u32 s90, s90, 24576
    s_waitcnt vmcnt(20)
L_rank:
    s_barrier
    ds_read_b32 v2, v3
    s_waitcnt lgkmcnt(0)
    v_readfirstlane_b32 s35, v2
    s_mov_b32 s34, s33
    s_barrier
    s_cmp_ge_u32 s33, 8
    s_cbranch_scc1 L_norole
    s_cmp_ge_u32 s35, 32
    s_cbranch_scc1 L_norole
    s_lshl_b32 s38, s34, 21
    s_add_u32 s38, s38, 8388608
    s_cmp_lt_u32 s35, 12
    s_cbranch_scc1 L_qkv_f
    s_cmp_lt_u32 s35, 18
    s_cbranch_scc1 L_v_f
    s_cmp_lt_u32 s35, 28
    s_cbranch_scc1 L_wo_f
    s_cmp_lt_u32 s35, 29
    s_cbranch_scc1 L_px_f
    s_branch L_pa_f
L_norole:
    v_mov_b32 v1, 192
    v_mov_b32 v2, 2
    s_mov_b64 exec, 1
    buffer_store_dword v2, v1, s[8:11], 0 offen sc1
    s_mov_b64 exec, -1
    s_branch L_slow
L_exit:
    s_endpgm
L_qkv_f:
    s_mov_b32 s12, s74
    s_and_b32 s13, s75, 0xffff
    s_mov_b32 s14, 7864320
    s_mov_b32 s15, 0x20000
    s_mov_b32 s16, s76
    s_and_b32 s17, s77, 0xffff
    s_mov_b32 s18, 7864320
    s_mov_b32 s19, 0x20000
    s_mov_b32 s40, s35
    s_mov_b32 s24, s70
    s_and_b32 s25, s71, 0xffff
    s_mov_b32 s26, 2621440
    s_mov_b32 s27, 0x20000
    v_and_b32 v1, 15, v0
    v_lshrrev_b32 v2, 4, v0
    v_lshrrev_b32 v3, 3, v0
    v_and_b32 v4, 7, v0
    s_lshl_b32 s90, s32, 3
    v_add_u32 v5, s90, v3
    s_and_b32 s91, s32, 1
    s_lshl_b32 s91, s91, 2
    v_and_b32 v6, 2, v3
    v_or_b32 v6, s91, v6
    v_xor_b32 v6, v6, v4
    v_lshlrev_b32 v6, 4, v6
    v_mul_u32_u24 v7, 12288, v5
    s_mul_i32 s92, s34, 1536
    s_lshl_b32 s93, s40, 7
    s_add_u32 s92, s92, s93
    v_add3_u32 v124, v6, v7, s92
    v_lshrrev_b32 v6, 1, v3
    v_or_b32 v6, s91, v6
    v_xor_b32 v6, v6, v4
    v_lshlrev_b32 v6, 4, v6
    v_mul_u32_u24 v7, 1280, v5
    v_add_u32 v10, v6, v7
    s_lshl_b32 s90, s32, 10
    s_add_u32 m0, s90, 81920
    s_mov_b32 s91, 0
    buffer_load_dwordx4 v124, s[12:15], s91 offen nt lds
    s_add_u32 m0, m0, 4096
    s_add_u32 s91, s91, 393216
    buffer_load_dwordx4 v124, s[12:15], s91 offen nt lds
    s_add_u32 m0, m0, 4096
    s_add_u32 s91, s91, 393216
    buffer_load_dwordx4 v124, s[12:15], s91 offen nt lds
    s_add_u32 m0, m0, 4096
    s_add_u32 s91, s91, 393216
    buffer_load_dwordx4 v124, s[12:15], s91 offen nt lds
    s_add_u32 m0, m0, 4096
    s_add_u32 s91, s91, 393216
    buffer_load_dwordx4 v124, s[12:15], s91 offen nt lds
    s_add_u32 m0, m0, 4096
    s_add_u32 s91, s91, 393216
    buffer_load_dwordx4 v124, s[12:15], s91 offen nt lds
    s_add_u32 m0, m0, 4096
    s_add_u32 s91, s91, 393216
    buffer_load_dwordx4 v124, s[12:15], s91 offen nt lds
    s_add_u32 m0, m0, 4096
    s_add_u32 s91, s91, 393216
    buffer_load_dwordx4 v124, s[12:15], s91 offen nt lds
    s_add_u32 m0, m0, 4096
    s_add_u32 s91, s91, 393216
    buffer_load_dwordx4 v124, s[12:15], s91 offen nt lds
    s_add_u32 m0, m0, 4096
    s_add_u32 s91, s91, 393216
    buffer_load_dwordx4 v124, s[12:15], s91 offen nt lds
    s_lshl_b32 s90, s32, 10
    s_add_u32 m0, s90, 40960
    s_mov_b32 s91, 0
    buffer_load_dwordx4 v124, s[16:19], s91 offen nt lds
    s_add_u32 m0, m0, 4096
    s_add_u32 s91, s91, 393216
    buffer_load_dwordx4 v124, s[16:19], s91 offen nt lds
    s_add_u32 m0, m0, 4096
    s_add_u32 s91, s91, 393216
    buffer_load_dwordx4 v124, s[16:19], s91 offen nt lds
    s_add_u32 m0, m0, 4096
    s_add_u32 s91, s91, 393216
    buffer_load_dwordx4 v124, s[16:19], s91 offen nt lds
    s_add_u32 m0, m0, 4096
    s_add_u32 s91, s91, 393216
    buffer_load_dwordx4 v124, s[16:19], s91 offen nt lds
    s_add_u32 m0, m0, 4096
    s_add_u32 s91, s91, 393216
    buffer_load_dwordx4 v124, s[16:19], s91 offen nt lds
    s_add_u32 m0, m0, 4096
    s_add_u32 s91, s91, 393216
    buffer_load_dwordx4 v124, s[16:19], s91 offen nt lds
    s_add_u32 m0, m0, 4096
    s_add_u32 s91, s91, 393216
    buffer_load_dwordx4 v124, s[16:19], s91 offen nt lds
    s_add_u32 m0, m0, 4096
    s_add_u32 s91, s91, 393216
    buffer_load_dwordx4 v124, s[16:19], s91 offen nt lds
    s_add_u32 m0, m0, 4096
    s_add_u32 s91, s91, 393216
    buffer_load_dwordx4 v124, s[16:19], s91 offen nt lds
    s_lshl_b32 s90, s32, 10
    s_add_u32 m0, s90, 122880
    s_mov_b32 s91, 3932160
    buffer_load_dwordx4 v124, s[12:15], s91 offen nt lds
    s_add_u32 m0, m0, 4096
    s_add_u32 s91, s91, 393216
    buffer_load_dwordx4 v124, s[12:15], s91 offen nt lds
    s_add_u32 m0, m0, 4096
    s_add_u32 s91, s91, 393216
    buffer_load_dwordx4 v124, s[12:15], s91 offen nt lds
    s_add_u32 m0, m0, 4096
    s_add_u32 s91, s91, 393216
    buffer_load_dwordx4 v124, s[12:15], s91 offen nt lds
    s_add_u32 m0, m0, 4096
    s_add_u32 s91, s91, 393216
    buffer_load_dwordx4 v124, s[12:15], s91 offen nt lds
    s_add_u32 m0, m0, 4096
    s_add_u32 s91, s91, 393216
    buffer_load_dwordx4 v124, s[12:15], s91 offen nt lds
    s_add_u32 m0, m0, 4096
    s_add_u32 s91, s91, 393216
    buffer_load_dwordx4 v124, s[12:15], s91 offen nt lds
    s_add_u32 m0, m0, 4096
    s_add_u32 s91, s91, 393216
    buffer_load_dwordx4 v124, s[12:15], s91 offen nt lds
    s_add_u32 m0, m0, 4096
    s_add_u32 s91, s91, 393216
    buffer_load_dwordx4 v124, s[12:15], s91 offen nt lds
    s_add_u32 m0, m0, 4096
    s_add_u32 s91, s91, 393216
    buffer_load_dwordx4 v124, s[12:15], s91 offen nt lds
    s_mov_b32 s46, 0
    s_lshl_b32 s90, s32, 10
    s_add_u32 m0, s90, 0
    s_nop 0
    buffer_load_dwordx4 v10, s[24:27], s46 offen offset:0 lds
    s_add_u32 m0, m0, 3968
    s_nop 0
    buffer_load_dwordx4 v10, s[24:27], s46 offen offset:128 lds
    s_add_u32 m0, m0, 3968
    s_nop 0
    buffer_load_dwordx4 v10, s[24:27], s46 offen offset:256 lds
    s_add_u32 m0, m0, 3968
    s_nop 0
    buffer_load_dwordx4 v10, s[24:27], s46 offen offset:384 lds
    s_add_u32 m0, m0, 3968
    s_nop 0
    buffer_load_dwordx4 v10, s[24:27], s46 offen offset:512 lds
    s_add_u32 m0, m0, 3968
    s_nop 0
    buffer_load_dwordx4 v10, s[24:27], s46 offen offset:640 lds
    s_add_u32 m0, m0, 3968
    s_nop 0
    buffer_load_dwordx4 v10, s[24:27], s46 offen offset:768 lds
    s_add_u32 m0, m0, 3968
    s_nop 0
    buffer_load_dwordx4 v10, s[24:27], s46 offen offset:896 lds
    s_add_u32 m0, m0, 3968
    s_nop 0
    buffer_load_dwordx4 v10, s[24:27], s46 offen offset:1024 lds
    s_add_u32 m0, m0, 3968
    s_nop 0
    buffer_load_dwordx4 v10, s[24:27], s46 offen offset:1152 lds
    s_mul_i32 s60, s40, 86
    s_lshr_b32 s60, s60, 8
    s_mul_i32 s59, s60, 3
    s_sub_u32 s59, s40, s59
    s_add_u32 s90, s40, 1
    s_mul_i32 s62, s90, 86
    s_lshr_b32 s62, s62, 8
    s_mul_i32 s63, s62, 3
    s_sub_u32 s63, s90, s63
    v_lshrrev_b32 v3, 1, v2
    v_and_b32 v5, 1, v2
    s_lshl_b32 s90, s32, 9
    v_lshlrev_b32 v6, 4, v1
    v_lshl_add_u32 v6, v3, 8, v6
    v_add_u32 v6, s90, v6
    s_mul_i32 s90, s60, 12288
    s_lshl_b32 s91, s59, 11
    s_add_u32 s90, s90, s91
    v_mul_u32_u24 v7, 6144, v5
    v_add3_u32 v19, v6, v7, s90
    v_mov_b32 v22, -1
    s_mov_b32 s56, 49152
    v_lshl_add_u32 v137, v5, 11, v6
    v_add_u32 v137, 135168, v137
    s_mul_i32 s90, s40, 1280
    s_add_u32 s90, s90, 10240
    v_lshlrev_b32 v6, 1, v5
    v_or_b32 v7, v6, v3
    v_lshl_add_u32 v7, v7, 4, v1
    v_lshlrev_b32 v7, 2, v7
    v_add_u32 v7, 1024, v7
    v_or_b32 v6, v6, v1
    v_lshl_add_u32 v6, v3, 4, v6
    v_lshlrev_b32 v6, 4, v6
    s_sub_u32 s91, s32, 1
    s_lshl_b32 s91, s91, 9
    v_add_u32 v6, s91, v6
    s_cmp_eq_u32 s32, 0
    s_cselect_b64 vcc, -1, 0
    v_cndmask_b32 v6, v6, v7, vcc
    v_add_u32 v135, s90, v6
    s_lshl_b32 s91, s32, 8
    s_add_u32 s91, s91, s90
    v_lshl_add_u32 v150, v0, 2, s91
    v_and_b32 v4, 2, v1
    v_cmp_eq_u32 vcc, 0, v4
    v_mov_b32 v9, 2146435072
    s_nop 0
    v_cndmask_b32 v135, v9, v135, vcc
    s_lshl_b32 s90, s40, 10
    v_lshrrev_b32 v3, 2, v1
    v_lshlrev_b32 v3, 1, v3
    v_and_b32 v6, 1, v1
    v_or_b32 v3, v3, v6
    v_lshl_add_u32 v3, v2, 3, v3
    v_lshl_add_u32 v136, v3, 4, s90
    v_cmp_ne_u32 vcc, 0, v4
    v_mov_b32 v9, 2146435072
    s_nop 0
    v_cndmask_b32 v136, v9, v136, vcc
    v_and_b32 v6, 9, v1
    v_lshl_or_b32 v6, v4, 1, v6
    v_and_b32 v7, 4, v1
    v_lshrrev_b32 v7, 1, v7
    v_or_b32 v6, v6, v7
    v_lshlrev_b32 v6, 4, v6
    v_lshl_add_u32 v6, v2, 8, v6
    s_cmp_eq_u32 s32, 2
    s_cselect_b32 s90, 2048, 0
    s_add_u32 s90, s90, 135168
    v_add_u32 v138, s90, v6
    s_lshl_b32 s90, s60, 7
    s_lshl_b32 s91, s59, 2
    s_add_u32 s91, s91, s90
    s_add_u32 s91, s91, 459264
    s_cmp_eq_u32 s32, 3
    s_cselect_b32 s91, s91, 2146435072
    s_cselect_b32 s55, -1, 0
    v_mov_b32 v139, s91
    v_cmp_eq_u32 vcc, 0, v0
    v_mov_b32 v9, 2146435072
    s_nop 0
    v_cndmask_b32 v139, v9, v139, vcc
    v_add_u32 v21, 3072, v139
    s_mul_i32 s90, s35, 32768
    s_lshl_b32 s91, s32, 11
    s_add_u32 s90, s90, s91
    s_lshl_b32 s92, s35, 10
    s_lshl_b32 s91, s32, 8
    s_add_u32 s92, s92, s91
    s_cmp_lt_u32 s35, 10
    s_cselect_b32 s90, s90, 2146435072
    s_cselect_b32 s92, s92, 2146435072
    s_lshl_b32 s91, s34, 8
    v_lshlrev_b32 v3, 4, v0
    v_xor_b32 v3, s91, v3
    v_add_u32 v142, s90, v3
    v_xor_b32 v3, 1024, v3
    v_add_u32 v143, s90, v3
    s_min_u32 s90, s35, 9
    s_lshl_b32 s90, s90, 7
    s_add_u32 s90, s90, 460800
    s_add_u32 s90, s90, s38
    v_and_b32 v3, 3, v0
    v_lshl_add_u32 v146, v3, 2, s90
    v_lshl_add_u32 v149, v0, 2, s92
    v_lshl_add_u32 v148, v1, 4, s92
    v_cmp_eq_u32 vcc, 0, v2
    v_mov_b32 v9, 2146435072
    s_nop 0
    v_cndmask_b32 v148, v9, v148, vcc
    v_and_b32 v7, 1, v1
    v_cmp_ne_u32 vcc, 0, v7
    v_mov_b32 v5, 0x3f80
    v_mov_b32 v6, 0x3f800000
    v_cndmask_b32 v5, v5, v6, vcc
    v_bfe_u32 v6, v1, 1, 1
    v_cmp_eq_u32 vcc, 0, v6
    s_nop 1
    v_cndmask_b32 v198, 0, v5, vcc
    v_mov_b32 v196, 0
    v_mov_b32 v200, 0
    v_cmp_eq_u32 vcc, 1, v6
    s_nop 1
    v_cndmask_b32 v199, 0, v5, vcc
    v_mov_b32 v197, 0
    v_mov_b32 v201, 0
    v_lshrrev_b32 v3, 2, v1
    v_and_b32 v4, 3, v1
    v_and_b32 v5, 1, v2
    v_lshl_add_u32 v6, v2, 3, v3
    v_lshlrev_b32 v6, 7, v6
    v_and_b32 v7, 2, v3
    v_lshl_or_b32 v7, v5, 2, v7
    v_lshrrev_b32 v8, 1, v4
    s_lshl_b32 s90, s32, 1
    v_or_b32 v8, s90, v8
    v_xor_b32 v7, v7, v8
    v_lshl_add_u32 v6, v7, 4, v6
    v_and_b32 v7, 1, v4
    v_lshl_add_u32 v6, v7, 3, v6
    v_add_u32 v125, 81920, v6
    v_add_u32 v126, 40960, v6
    v_add_u32 v127, 122880, v6
    s_lshl_b32 s90, s32, 9
    s_add_u32 s90, s90, 133120
    v_xor_b32 v6, 0, v5
    v_lshl_add_u32 v6, v6, 2, v3
    v_lshl_add_u32 v6, v2, 3, v6
    v_lshlrev_b32 v6, 5, v6
    v_lshl_or_b32 v7, v5, 1, 0
    v_xor_b32 v7, v7, v4
    v_lshl_add_u32 v6, v7, 3, v6
    v_add_u32 v24, 133120, v6
    v_xor_b32 v6, 1, v5
    v_lshl_add_u32 v6, v6, 2, v3
    v_lshl_add_u32 v6, v2, 3, v6
    v_lshlrev_b32 v6, 5, v6
    v_lshl_or_b32 v7, v5, 1, 1
    v_xor_b32 v7, v7, v4
    v_lshl_add_u32 v6, v7, 3, v6
    v_add_u32 v134, 133120, v6
    v_lshrrev_b32 v6, 3, v1
    v_lshlrev_b32 v6, 2, v6
    v_xor_b32 v6, v6, v1
    v_lshlrev_b32 v6, 5, v6
    v_xor_b32 v7, v2, v3
    v_lshl_add_u32 v6, v7, 3, v6
    v_add_u32 v23, s90, v6
    v_and_b32 v7, 2, v1
    v_cmp_ne_u32 vcc, 0, v7
    v_mov_b32 v6, 0x4444
    v_mov_b32 v8, 0xeeee
    v_cndmask_b32 v17, v6, v8, vcc
    v_lshlrev_b32 v6, 4, v0
    v_add_u32 v16, 122880, v6
    s_mul_i32 s90, s32, 2560
    v_lshl_add_u32 v13, v0, 4, s90
    v_lshl_add_u32 v14, v0, 2, s90
    s_add_u32 s48, s90, 122880
    v_mul_u32_u24 v6, 40, v0
    v_add_u32 v15, s48, v6
    v_mul_u32_u24 v6, 164, v0
    v_min_u32 v6, 10236, v6
    v_add_u32 v25, 122880, v6
    v_lshrrev_b32 v6, 3, v1
    v_lshlrev_b32 v6, 10, v6
    v_and_b32 v7, 7, v1
    v_lshl_add_u32 v6, v7, 7, v6
    v_lshrrev_b32 v7, 1, v1
    v_xor_b32 v7, v7, v2
    v_lshl_add_u32 v11, v7, 4, v6
    v_xor_b32 v12, 64, v11
    s_waitcnt vmcnt(30)
    s_barrier
    ds_read_b64_tr_b16 a[0:1], v125 offset:0
    ds_read_b64_tr_b16 a[2:3], v125 offset:512
    ds_read_b64_tr_b16 a[4:5], v125 offset:4096
    ds_read_b64_tr_b16 a[6:7], v125 offset:4608
    ds_read_b64_tr_b16 a[8:9], v125 offset:8192
    ds_read_b64_tr_b16 a[10:11], v125 offset:8704
    ds_read_b64_tr_b16 a[12:13], v125 offset:12288
    ds_read_b64_tr_b16 a[14:15], v125 offset:12800
    ds_read_b64_tr_b16 a[16:17], v125 offset:16384
    ds_read_b64_tr_b16 a[18:19], v125 offset:16896
    ds_read_b64_tr_b16 a[20:21], v125 offset:20480
    ds_read_b64_tr_b16 a[22:23], v125 offset:20992
    ds_read_b64_tr_b16 a[24:25], v125 offset:24576
    ds_read_b64_tr_b16 a[26:27], v125 offset:25088
    ds_read_b64_tr_b16 a[28:29], v125 offset:28672
    ds_read_b64_tr_b16 a[30:31], v125 offset:29184
    ds_read_b64_tr_b16 a[32:33], v125 offset:32768
    ds_read_b64_tr_b16 a[34:35], v125 offset:33280
    ds_read_b64_tr_b16 a[36:37], v125 offset:36864
    ds_read_b64_tr_b16 a[38:39], v125 offset:37376
    s_waitcnt lgkmcnt(0)
    s_barrier
    s_lshl_b32 s90, s32, 10
    s_add_u32 m0, s90, 81920
    s_mov_b32 s91, 3932160
    buffer_load_dwordx4 v124, s[16:19], s91 offen nt lds
    s_add_u32 m0, m0, 4096
    s_add_u32 s91, s91, 393216
    buffer_load_dwordx4 v124, s[16:19], s91 offen nt lds
    s_add_u32 m0, m0, 4096
    s_add_u32 s91, s91, 393216
    buffer_load_dwordx4 v124, s[16:19], s91 offen nt lds
    s_add_u32 m0, m0, 4096
    s_add_u32 s91, s91, 393216
    buffer_load_dwordx4 v124, s[16:19], s91 offen nt lds
    s_add_u32 m0, m0, 4096
    s_add_u32 s91, s91, 393216
    buffer_load_dwordx4 v124, s[16:19], s91 offen nt lds
    s_add_u32 m0, m0, 4096
    s_add_u32 s91, s91, 393216
    buffer_load_dwordx4 v124, s[16:19], s91 offen nt lds
    s_add_u32 m0, m0, 4096
    s_add_u32 s91, s91, 393216
    buffer_load_dwordx4 v124, s[16:19], s91 offen nt lds
    s_add_u32 m0, m0, 4096
    s_add_u32 s91, s91, 393216
    buffer_load_dwordx4 v124, s[16:19], s91 offen nt lds
    s_add_u32 m0, m0, 4096
    s_add_u32 s91, s91, 393216
    buffer_load_dwordx4 v124, s[16:19], s91 offen nt lds
    s_add_u32 m0, m0, 4096
    s_add_u32 s91, s91, 393216
    buffer_load_dwordx4 v124, s[16:19], s91 offen nt lds
    s_waitcnt vmcnt(30)
    s_barrier
    ds_read_b64_tr_b16 a[80:81], v126 offset:0
    ds_read_b64_tr_b16 a[82:83], v126 offset:512
    ds_read_b64_tr_b16 a[84:85], v126 offset:4096
    ds_read_b64_tr_b16 a[86:87], v126 offset:4608
    ds_read_b64_tr_b16 a[88:89], v126 offset:8192
    ds_read_b64_tr_b16 a[90:91], v126 offset:8704
    ds_read_b64_tr_b16 a[92:93], v126 offset:12288
    ds_read_b64_tr_b16 a[94:95], v126 offset:12800
    ds_read_b64_tr_b16 a[96:97], v126 offset:16384
    ds_read_b64_tr_b16 a[98:99], v126 offset:16896
    ds_read_b64_tr_b16 a[100:101], v126 offset:20480
    ds_read_b64_tr_b16 a[102:103], v126 offset:20992
    ds_read_b64_tr_b16 a[104:105], v126 offset:24576
    ds_read_b64_tr_b16 a[106:107], v126 offset:25088
    ds_read_b64_tr_b16 a[108:109], v126 offset:28672
    ds_read_b64_tr_b16 a[110:111], v126 offset:29184
    ds_read_b64_tr_b16 a[112:113], v126 offset:32768
    ds_read_b64_tr_b16 a[114:115], v126 offset:33280
    ds_read_b64_tr_b16 a[116:117], v126 offset:36864
    ds_read_b64_tr_b16 a[118:119], v126 offset:37376
    s_waitcnt lgkmcnt(0)
    s_barrier
    s_mov_b32 s46, 40960
    s_lshl_b32 s90, s32, 10
    s_add_u32 m0, s90, 40960
    s_nop 0
    buffer_load_dwordx4 v10, s[24:27], s46 offen offset:0 lds
    s_add_u32 m0, m0, 3968
    s_nop 0
    buffer_load_dwordx4 v10, s[24:27], s46 offen offset:128 lds
    s_add_u32 m0, m0, 3968
    s_nop 0
    buffer_load_dwordx4 v10, s[24:27], s46 offen offset:256 lds
    s_add_u32 m0, m0, 3968
    s_nop 0
    buffer_load_dwordx4 v10, s[24:27], s46 offen offset:384 lds
    s_add_u32 m0, m0, 3968
    s_nop 0
    buffer_load_dwordx4 v10, s[24:27], s46 offen offset:512 lds
    s_add_u32 m0, m0, 3968
    s_nop 0
    buffer_load_dwordx4 v10, s[24:27], s46 offen offset:640 lds
    s_add_u32 m0, m0, 3968
    s_nop 0
    buffer_load_dwordx4 v10, s[24:27], s46 offen offset:768 lds
    s_add_u32 m0, m0, 3968
    s_nop 0
    buffer_load_dwordx4 v10, s[24:27], s46 offen offset:896 lds
    s_add_u32 m0, m0, 3968
    s_nop 0
    buffer_load_dwordx4 v10, s[24:27], s46 offen offset:1024 lds
    s_add_u32 m0, m0, 3968
    s_nop 0
    buffer_load_dwordx4 v10, s[24:27], s46 offen offset:1152 lds
    s_waitcnt vmcnt(30)
    s_barrier
    ds_read_b64_tr_b16 a[40:41], v127 offset:0
    ds_read_b64_tr_b16 a[42:43], v127 offset:512
    ds_read_b64_tr_b16 a[44:45], v127 offset:4096
    ds_read_b64_tr_b16 a[46:47], v127 offset:4608
    ds_read_b64_tr_b16 a[48:49], v127 offset:8192
    ds_read_b64_tr_b16 a[50:51], v127 offset:8704
    ds_read_b64_tr_b16 a[52:53], v127 offset:12288
    ds_read_b64_tr_b16 a[54:55], v127 offset:12800
    ds_read_b64_tr_b16 a[56:57], v127 offset:16384
    ds_read_b64_tr_b16 a[58:59], v127 offset:16896
    ds_read_b64_tr_b16 a[60:61], v127 offset:20480
    ds_read_b64_tr_b16 a[62:63], v127 offset:20992
    ds_read_b64_tr_b16 a[64:65], v127 offset:24576
    ds_read_b64_tr_b16 a[66:67], v127 offset:25088
    ds_read_b64_tr_b16 a[68:69], v127 offset:28672
    ds_read_b64_tr_b16 a[70:71], v127 offset:29184
    ds_read_b64_tr_b16 a[72:73], v127 offset:32768
    ds_read_b64_tr_b16 a[74:75], v127 offset:33280
    ds_read_b64_tr_b16 a[76:77], v127 offset:36864
    ds_read_b64_tr_b16 a[78:79], v127 offset:37376
    s_waitcnt lgkmcnt(0)
    s_waitcnt vmcnt(10)
    s_barrier
    ds_read_b64_tr_b16 a[120:121], v125 offset:0
    ds_read_b64_tr_b16 a[122:123], v125 offset:512
    ds_read_b64_tr_b16 a[124:125], v125 offset:4096
    ds_read_b64_tr_b16 a[126:127], v125 offset:4608
    ds_read_b64_tr_b16 a[128:129], v125 offset:8192
    ds_read_b64_tr_b16 a[130:131], v125 offset:8704
    ds_read_b64_tr_b16 a[132:133], v125 offset:12288
    ds_read_b64_tr_b16 a[134:135], v125 offset:12800
    ds_read_b64_tr_b16 a[136:137], v125 offset:16384
    ds_read_b64_tr_b16 a[138:139], v125 offset:16896
    ds_read_b64_tr_b16 a[140:141], v125 offset:20480
    ds_read_b64_tr_b16 a[142:143], v125 offset:20992
    ds_read_b64_tr_b16 a[144:145], v125 offset:24576
    ds_read_b64_tr_b16 a[146:147], v125 offset:25088
    ds_read_b64_tr_b16 a[148:149], v125 offset:28672
    ds_read_b64_tr_b16 a[150:151], v125 offset:29184
    ds_read_b64_tr_b16 a[152:153], v125 offset:32768
    ds_read_b64_tr_b16 a[154:155], v125 offset:33280
    ds_read_b64_tr_b16 a[156:157], v125 offset:36864
    ds_read_b64_tr_b16 a[158:159], v125 offset:37376
    s_waitcnt lgkmcnt(0)
    s_mov_b32 s49, 40960
    s_mov_b32 s47, 40960
    s_mov_b32 s37, -1
    s_add_u32 s44, s38, 475136
    s_add_u32 s45, s44, s56
    s_mov_b32 s46, 40960
    v_add_u32 v140, 0, v137
    ds_read_b128 v[84:87], v11 offset:0
    ds_read_b128 v[88:91], v11 offset:2048
    ds_read_b128 v[92:95], v12 offset:0
    ds_read_b128 v[96:99], v12 offset:2048
    s_waitcnt lgkmcnt(2)
    v_mfma_f32_16x16x32_bf16 v[108:111], a[0:3], v[84:87], 0
    ds_read_b128 v[100:103], v11 offset:4096
    v_mfma_f32_16x16x32_bf16 v[112:115], a[0:3], v[88:91], 0
    ds_read_b128 v[104:107], v11 offset:6144
    v_mfma_f32_16x16x32_bf16 v[116:119], a[80:83], v[84:87], 0
    v_mfma_f32_16x16x32_bf16 v[120:123], a[80:83], v[88:91], 0
    s_waitcnt lgkmcnt(2)
    v_mfma_f32_16x16x32_bf16 v[108:111], a[4:7], v[92:95], v[108:111]
    ds_read_b128 v[84:87], v12 offset:4096
    v_mfma_f32_16x16x32_bf16 v[112:115], a[4:7], v[96:99], v[112:115]
    ds_read_b128 v[88:91], v12 offset:6144
    v_mfma_f32_16x16x32_bf16 v[116:119], a[84:87], v[92:95], v[116:119]
    v_mfma_f32_16x16x32_bf16 v[120:123], a[84:87], v[96:99], v[120:123]
    s_waitcnt lgkmcnt(2)
    v_mfma_f32_16x16x32_bf16 v[108:111], a[8:11], v[100:103], v[108:111]
    ds_read_b128 v[92:95], v11 offset:8192
    v_mfma_f32_16x16x32_bf16 v[112:115], a[8:11], v[104:107], v[112:115]
    ds_read_b128 v[96:99], v11 offset:10240
    v_mfma_f32_16x16x32_bf16 v[116:119], a[88:91], v[100:103], v[116:119]
    v_mfma_f32_16x16x32_bf16 v[120:123], a[88:91], v[104:107], v[120:123]
    s_waitcnt lgkmcnt(2)
    v_mfma_f32_16x16x32_bf16 v[108:111], a[12:15], v[84:87], v[108:111]
    ds_read_b128 v[100:103], v12 offset:8192
    v_mfma_f32_16x16x32_bf16 v[112:115], a[12:15], v[88:91], v[112:115]
    ds_read_b128 v[104:107], v12 offset:10240
    v_mfma_f32_16x16x32_bf16 v[116:119], a[92:95], v[84:87], v[116:119]
    v_mfma_f32_16x16x32_bf16 v[120:123], a[92:95], v[88:91], v[120:123]
    s_waitcnt lgkmcnt(2)
    v_mfma_f32_16x16x32_bf16 v[108:111], a[16:19], v[92:95], v[108:111]
    ds_read_b128 v[84:87], v11 offset:12288
    v_mfma_f32_16x16x32_bf16 v[112:115], a[16:19], v[96:99], v[112:115]
    ds_read_b128 v[88:91], v11 offset:14336
    v_mfma_f32_16x16x32_bf16 v[116:119], a[96:99], v[92:95], v[116:119]
    v_mfma_f32_16x16x32_bf16 v[120:123], a[96:99], v[96:99], v[120:123]
    s_waitcnt lgkmcnt(2)
    v_mfma_f32_16x16x32_bf16 v[108:111], a[20:23], v[100:103], v[108:111]
    ds_read_b128 v[92:95], v12 offset:12288
    v_mfma_f32_16x16x32_bf16 v[112:115], a[20:23], v[104:107], v[112:115]
    ds_read_b128 v[96:99], v12 offset:14336
    v_mfma_f32_16x16x32_bf16 v[116:119], a[100:103], v[100:103], v[116:119]
    v_mfma_f32_16x16x32_bf16 v[120:123], a[100:103], v[104:107], v[120:123]
    s_waitcnt lgkmcnt(2)
    v_mfma_f32_16x16x32_bf16 v[108:111], a[24:27], v[84:87], v[108:111]
    ds_read_b128 v[100:103], v11 offset:16384
    v_mfma_f32_16x16x32_bf16 v[112:115], a[24:27], v[88:91], v[112:115]
    ds_read_b128 v[104:107], v11 offset:18432
    v_mfma_f32_16x16x32_bf16 v[116:119], a[104:107], v[84:87], v[116:119]
    v_mfma_f32_16x16x32_bf16 v[120:123], a[104:107], v[88:91], v[120:123]
    s_waitcnt lgkmcnt(2)
    v_mfma_f32_16x16x32_bf16 v[108:111], a[28:31], v[92:95], v[108:111]
    ds_read_b128 v[84:87], v12 offset:16384
    v_mfma_f32_16x16x32_bf16 v[112:115], a[28:31], v[96:99], v[112:115]
    ds_read_b128 v[88:91], v12 offset:18432
    v_mfma_f32_16x16x32_bf16 v[116:119], a[108:111], v[92:95], v[116:119]
    v_mfma_f32_16x16x32_bf16 v[120:123], a[108:111], v[96:99], v[120:123]
    s_waitcnt lgkmcnt(2)
    v_mfma_f32_16x16x32_bf16 v[108:111], a[32:35], v[100:103], v[108:111]
    ds_read_b128 v[92:95], v11 offset:20480
    v_mfma_f32_16x16x32_bf16 v[112:115], a[32:35], v[104:107], v[112:115]
    ds_read_b128 v[96:99], v11 offset:22528
    v_mfma_f32_16x16x32_bf16 v[116:119], a[112:115], v[100:103], v[116:119]
    v_mfma_f32_16x16x32_bf16 v[120:123], a[112:115], v[104:107], v[120:123]
    s_waitcnt lgkmcnt(2)
    v_mfma_f32_16x16x32_bf16 v[108:111], a[36:39], v[84:87], v[108:111]
    ds_read_b128 v[100:103], v12 offset:20480
    v_mfma_f32_16x16x32_bf16 v[112:115], a[36:39], v[88:91], v[112:115]
    ds_read_b128 v[104:107], v12 offset:22528
    v_mfma_f32_16x16x32_bf16 v[116:119], a[116:119], v[84:87], v[116:119]
    v_mfma_f32_16x16x32_bf16 v[120:123], a[116:119], v[88:91], v[120:123]
    s_waitcnt lgkmcnt(2)
    v_mfma_f32_16x16x32_bf16 v[108:111], a[40:43], v[92:95], v[108:111]
    ds_read_b128 v[84:87], v11 offset:24576
    v_mfma_f32_16x16x32_bf16 v[112:115], a[40:43], v[96:99], v[112:115]
    ds_read_b128 v[88:91], v11 offset:26624
    v_mfma_f32_16x16x32_bf16 v[116:119], a[120:123], v[92:95], v[116:119]
    v_mfma_f32_16x16x32_bf16 v[120:123], a[120:123], v[96:99], v[120:123]
    s_waitcnt lgkmcnt(2)
    v_mfma_f32_16x16x32_bf16 v[108:111], a[44:47], v[100:103], v[108:111]
    ds_read_b128 v[92:95], v12 offset:24576
    v_mfma_f32_16x16x32_bf16 v[112:115], a[44:47], v[104:107], v[112:115]
    ds_read_b128 v[96:99], v12 offset:26624
    v_mfma_f32_16x16x32_bf16 v[116:119], a[124:127], v[100:103], v[116:119]
    v_mfma_f32_16x16x32_bf16 v[120:123], a[124:127], v[104:107], v[120:123]
    s_waitcnt lgkmcnt(2)
    v_mfma_f32_16x16x32_bf16 v[108:111], a[48:51], v[84:87], v[108:111]
    ds_read_b128 v[100:103], v11 offset:28672
    v_mfma_f32_16x16x32_bf16 v[112:115], a[48:51], v[88:91], v[112:115]
    ds_read_b128 v[104:107], v11 offset:30720
    v_mfma_f32_16x16x32_bf16 v[116:119], a[128:131], v[84:87], v[116:119]
    v_mfma_f32_16x16x32_bf16 v[120:123], a[128:131], v[88:91], v[120:123]
    s_waitcnt lgkmcnt(2)
    v_mfma_f32_16x16x32_bf16 v[108:111], a[52:55], v[92:95], v[108:111]
    ds_read_b128 v[84:87], v12 offset:28672
    v_mfma_f32_16x16x32_bf16 v[112:115], a[52:55], v[96:99], v[112:115]
    ds_read_b128 v[88:91], v12 offset:30720
    v_mfma_f32_16x16x32_bf16 v[116:119], a[132:135], v[92:95], v[116:119]
    v_mfma_f32_16x16x32_bf16 v[120:123], a[132:135], v[96:99], v[120:123]
    s_waitcnt lgkmcnt(2)
    v_mfma_f32_16x16x32_bf16 v[108:111], a[56:59], v[100:103], v[108:111]
    ds_read_b128 v[92:95], v11 offset:32768
    v_mfma_f32_16x16x32_bf16 v[112:115], a[56:59], v[104:107], v[112:115]
    ds_read_b128 v[96:99], v11 offset:34816
    v_mfma_f32_16x16x32_bf16 v[116:119], a[136:139], v[100:103], v[116:119]
    v_mfma_f32_16x16x32_bf16 v[120:123], a[136:139], v[104:107], v[120:123]
    s_waitcnt lgkmcnt(2)
    v_mfma_f32_16x16x32_bf16 v[108:111], a[60:63], v[84:87], v[108:111]
    ds_read_b128 v[100:103], v12 offset:32768
    v_mfma_f32_16x16x32_bf16 v[112:115], a[60:63], v[88:91], v[112:115]
    ds_read_b128 v[104:107], v12 offset:34816
    v_mfma_f32_16x16x32_bf16 v[116:119], a[140:143], v[84:87], v[116:119]
    v_mfma_f32_16x16x32_bf16 v[120:123], a[140:143], v[88:91], v[120:123]
    s_waitcnt lgkmcnt(2)
    v_mfma_f32_16x16x32_bf16 v[108:111], a[64:67], v[92:95], v[108:111]
    ds_read_b128 v[84:87], v11 offset:36864
    v_mfma_f32_16x16x32_bf16 v[112:115], a[64:67], v[96:99], v[112:115]
    ds_read_b128 v[88:91], v11 offset:38912
    v_mfma_f32_16x16x32_bf16 v[116:119], a[144:147], v[92:95], v[116:119]
    v_mfma_f32_16x16x32_bf16 v[120:123], a[144:147], v[96:99], v[120:123]
    s_waitcnt lgkmcnt(2)
    v_mfma_f32_16x16x32_bf16 v[108:111], a[68:71], v[100:103], v[108:111]
    ds_read_b128 v[92:95], v12 offset:36864
    v_mfma_f32_16x16x32_bf16 v[112:115], a[68:71], v[104:107], v[112:115]
    ds_read_b128 v[96:99], v12 offset:38912
    v_mfma_f32_16x16x32_bf16 v[116:119], a[148:151], v[100:103], v[116:119]
    v_mfma_f32_16x16x32_bf16 v[120:123], a[148:151], v[104:107], v[120:123]
    s_waitcnt lgkmcnt(0)
    v_mfma_f32_16x16x32_bf16 v[108:111], a[72:75], v[84:87], v[108:111]
    v_add_u32 v11, s49, v11
    v_mfma_f32_16x16x32_bf16 v[112:115], a[72:75], v[88:91], v[112:115]
    v_add_u32 v12, s49, v12
    v_mfma_f32_16x16x32_bf16 v[108:111], a[76:79], v[92:95], v[108:111]
    s_sub_u32 s47, s47, s49
    v_mfma_f32_16x16x32_bf16 v[112:115], a[76:79], v[96:99], v[112:115]
    s_sub_u32 s49, 0, s49
    v_mfma_f32_16x16x32_bf16 v[116:119], a[152:155], v[84:87], v[116:119]
    v_mfma_f32_16x16x32_bf16 v[120:123], a[152:155], v[88:91], v[120:123]
    v_mfma_f32_16x16x32_bf16 v[116:119], a[156:159], v[92:95], v[116:119]
    v_mfma_f32_16x16x32_bf16 v[120:123], a[156:159], v[96:99], v[120:123]
    v_cvt_pk_bf16_f32 v124, v108, v109
    v_cvt_pk_bf16_f32 v125, v110, v111
    v_cvt_pk_bf16_f32 v126, v112, v113
    v_cvt_pk_bf16_f32 v127, v114, v115
    s_nop 0
    v_permlane16_swap_b32 v124, v126
    v_permlane16_swap_b32 v125, v127
    v_cvt_pk_bf16_f32 v128, v116, v117
    v_cvt_pk_bf16_f32 v129, v118, v119
    v_cvt_pk_bf16_f32 v130, v120, v121
    v_cvt_pk_bf16_f32 v131, v122, v123
    s_nop 0
    v_permlane16_swap_b32 v128, v130
    v_permlane16_swap_b32 v129, v131
    ds_write_b128 v140, v[128:131]
    buffer_store_dwordx4 v[124:127], v19, s[4:7], s44 offen
    buffer_store_dwordx4 v[128:131], v19, s[4:7], s45 offen
    v_mov_b32 v1, 192
L_gw_1:
    buffer_load_dword v2, v1, s[8:11], 0 offen sc1
    s_sub_u32 s36, s36, 1
    s_cbranch_scc1 L_exit
    s_waitcnt vmcnt(0)
    v_readfirstlane_b32 s90, v2
    s_nop 0
    s_cmp_eq_u32 s90, 0
    s_cbranch_scc1 L_gw_1
    s_cmp_lg_u32 s90, 1
    s_cbranch_scc1 L_slow
    s_waitcnt vmcnt(0) lgkmcnt(0)
    s_barrier
    s_add_u32 s44, s38, 573440
    s_add_u32 s45, s44, s56
    s_mov_b32 s46, 81920
    v_add_u32 v140, 4096, v137
    ds_read_b128 v[84:87], v11 offset:0
    ds_read_b128 v[88:91], v11 offset:2048
    ds_read_b128 v[92:95], v12 offset:0
    ds_read_b128 v[96:99], v12 offset:2048
    s_lshl_b32 s90, s32, 10
    s_add_u32 m0, s90, s47
    s_waitcnt lgkmcnt(2)
    v_mfma_f32_16x16x32_bf16 v[108:111], a[0:3], v[84:87], 0
    ds_read_b128 v[100:103], v11 offset:4096
    s_and_b32 s50, s37, 3
    v_mfma_f32_16x16x32_bf16 v[112:115], a[0:3], v[88:91], 0
    ds_read_b128 v[104:107], v11 offset:6144
    s_mul_i32 s53, s50, 327680
    v_mfma_f32_16x16x32_bf16 v[116:119], a[80:83], v[84:87], 0
    buffer_load_dwordx4 v10, s[24:27], s46 offen offset:0 lds
    s_add_u32 m0, m0, 3968
    v_mfma_f32_16x16x32_bf16 v[120:123], a[80:83], v[88:91], 0
    s_waitcnt lgkmcnt(2)
    s_add_u32 s51, s37, 2
    v_mfma_f32_16x16x32_bf16 v[108:111], a[4:7], v[92:95], v[108:111]
    ds_read_b128 v[84:87], v12 offset:4096
    s_and_b32 s50, s51, 3
    v_mfma_f32_16x16x32_bf16 v[112:115], a[4:7], v[96:99], v[112:115]
    ds_read_b128 v[88:91], v12 offset:6144
    s_mul_i32 s50, s50, 98304
    v_mfma_f32_16x16x32_bf16 v[116:119], a[84:87], v[92:95], v[116:119]
    buffer_load_dwordx4 v10, s[24:27], s46 offen offset:128 lds
    s_add_u32 m0, m0, 3968
    v_mfma_f32_16x16x32_bf16 v[120:123], a[84:87], v[96:99], v[120:123]
    s_waitcnt lgkmcnt(2)
    s_add_u32 s50, s50, 475136
    v_mfma_f32_16x16x32_bf16 v[108:111], a[8:11], v[100:103], v[108:111]
    ds_read_b128 v[92:95], v11 offset:8192
    s_add_u32 s44, s38, s50
    v_mfma_f32_16x16x32_bf16 v[112:115], a[8:11], v[104:107], v[112:115]
    ds_read_b128 v[96:99], v11 offset:10240
    s_add_u32 s45, s44, s56
    v_mfma_f32_16x16x32_bf16 v[116:119], a[88:91], v[100:103], v[116:119]
    buffer_load_dwordx4 v10, s[24:27], s46 offen offset:256 lds
    s_add_u32 m0, m0, 3968
    v_mfma_f32_16x16x32_bf16 v[120:123], a[88:91], v[104:107], v[120:123]
    s_waitcnt lgkmcnt(2)
    s_and_b32 s50, s51, 3
    v_mfma_f32_16x16x32_bf16 v[108:111], a[12:15], v[84:87], v[108:111]
    ds_read_b128 v[100:103], v12 offset:8192
    s_lshl_b32 s50, s50, 12
    v_mfma_f32_16x16x32_bf16 v[112:115], a[12:15], v[88:91], v[112:115]
    ds_read_b128 v[104:107], v12 offset:10240
    v_add_u32 v140, s50, v137
    v_mfma_f32_16x16x32_bf16 v[116:119], a[92:95], v[84:87], v[116:119]
    buffer_load_dwordx4 v10, s[24:27], s46 offen offset:384 lds
    s_add_u32 m0, m0, 3968
    v_mfma_f32_16x16x32_bf16 v[120:123], a[92:95], v[88:91], v[120:123]
    s_waitcnt lgkmcnt(2)
    s_add_u32 s37, s37, 1
    v_mfma_f32_16x16x32_bf16 v[108:111], a[16:19], v[92:95], v[108:111]
    ds_read_b128 v[84:87], v11 offset:12288
    s_mov_b32 s52, 0
    v_mfma_f32_16x16x32_bf16 v[112:115], a[16:19], v[96:99], v[112:115]
    ds_read_b128 v[88:91], v11 offset:14336
    s_and_b32 s50, s37, 3
    v_mfma_f32_16x16x32_bf16 v[116:119], a[96:99], v[92:95], v[116:119]
    buffer_load_dwordx4 v10, s[24:27], s46 offen offset:512 lds
    s_add_u32 m0, m0, 3968
    v_mfma_f32_16x16x32_bf16 v[120:123], a[96:99], v[96:99], v[120:123]
    s_waitcnt lgkmcnt(2)
    s_mul_i32 s51, s50, 114688
    v_mfma_f32_16x16x32_bf16 v[108:111], a[20:23], v[100:103], v[108:111]
    ds_read_b128 v[92:95], v12 offset:12288
    s_add_u32 s41, s38, s51
    v_mfma_f32_16x16x32_bf16 v[112:115], a[20:23], v[104:107], v[112:115]
    ds_read_b128 v[96:99], v12 offset:14336
    s_and_b32 s54, s37, s55
    v_mfma_f32_16x16x32_bf16 v[116:119], a[100:103], v[100:103], v[116:119]
    buffer_load_dwordx4 v10, s[24:27], s46 offen offset:640 lds
    s_add_u32 m0, m0, 3968
    v_mfma_f32_16x16x32_bf16 v[120:123], a[100:103], v[104:107], v[120:123]
    s_waitcnt lgkmcnt(2)
    s_lshl_b32 s50, s50, 12
    v_mfma_f32_16x16x32_bf16 v[108:111], a[24:27], v[84:87], v[108:111]
    ds_read_b128 v[100:103], v11 offset:16384
    v_add_u32 v141, s50, v138
    v_mfma_f32_16x16x32_bf16 v[112:115], a[24:27], v[88:91], v[112:115]
    ds_read_b128 v[104:107], v11 offset:18432
    s_add_u32 s43, s41, 40960
    v_mfma_f32_16x16x32_bf16 v[116:119], a[104:107], v[84:87], v[116:119]
    buffer_load_dwordx4 v10, s[24:27], s46 offen offset:768 lds
    s_add_u32 m0, m0, 3968
    v_mfma_f32_16x16x32_bf16 v[120:123], a[104:107], v[88:91], v[120:123]
    s_waitcnt lgkmcnt(2)
    v_mfma_f32_16x16x32_bf16 v[108:111], a[28:31], v[92:95], v[108:111]
    ds_read_b128 v[84:87], v12 offset:16384
    v_mfma_f32_16x16x32_bf16 v[112:115], a[28:31], v[96:99], v[112:115]
    ds_read_b128 v[88:91], v12 offset:18432
    v_mfma_f32_16x16x32_bf16 v[116:119], a[108:111], v[92:95], v[116:119]
    buffer_load_dwordx4 v10, s[24:27], s46 offen offset:896 lds
    s_add_u32 m0, m0, 3968
    v_mfma_f32_16x16x32_bf16 v[120:123], a[108:111], v[96:99], v[120:123]
    s_waitcnt lgkmcnt(2)
    v_mfma_f32_16x16x32_bf16 v[108:111], a[32:35], v[100:103], v[108:111]
    ds_read_b128 v[92:95], v11 offset:20480
    v_mfma_f32_16x16x32_bf16 v[112:115], a[32:35], v[104:107], v[112:115]
    ds_read_b128 v[96:99], v11 offset:22528
    v_mfma_f32_16x16x32_bf16 v[116:119], a[112:115], v[100:103], v[116:119]
    buffer_load_dwordx4 v10, s[24:27], s46 offen offset:1024 lds
    s_add_u32 m0, m0, 3968
    v_mfma_f32_16x16x32_bf16 v[120:123], a[112:115], v[104:107], v[120:123]
    s_waitcnt lgkmcnt(2)
    v_mfma_f32_16x16x32_bf16 v[108:111], a[36:39], v[84:87], v[108:111]
    ds_read_b128 v[100:103], v12 offset:20480
    v_mfma_f32_16x16x32_bf16 v[112:115], a[36:39], v[88:91], v[112:115]
    ds_read_b128 v[104:107], v12 offset:22528
    v_mfma_f32_16x16x32_bf16 v[116:119], a[116:119], v[84:87], v[116:119]
    buffer_load_dwordx4 v10, s[24:27], s46 offen offset:1152 lds
    v_mfma_f32_16x16x32_bf16 v[120:123], a[116:119], v[88:91], v[120:123]
    s_waitcnt lgkmcnt(2)
    v_mfma_f32_16x16x32_bf16 v[108:111], a[40:43], v[92:95], v[108:111]
    ds_read_b128 v[84:87], v11 offset:24576
    v_mfma_f32_16x16x32_bf16 v[112:115], a[40:43], v[96:99], v[112:115]
    ds_read_b128 v[88:91], v11 offset:26624
    v_mfma_f32_16x16x32_bf16 v[116:119], a[120:123], v[92:95], v[116:119]
    v_mfma_f32_16x16x32_bf16 v[120:123], a[120:123], v[96:99], v[120:123]
    s_waitcnt lgkmcnt(2)
    v_mfma_f32_16x16x32_bf16 v[108:111], a[44:47], v[100:103], v[108:111]
    ds_read_b128 v[92:95], v12 offset:24576
    v_mfma_f32_16x16x32_bf16 v[112:115], a[44:47], v[104:107], v[112:115]
    ds_read_b128 v[96:99], v12 offset:26624
    v_mfma_f32_16x16x32_bf16 v[116:119], a[124:127], v[100:103], v[116:119]
    v_mfma_f32_16x16x32_bf16 v[120:123], a[124:127], v[104:107], v[120:123]
    s_waitcnt lgkmcnt(2)
    v_mfma_f32_16x16x32_bf16 v[108:111], a[48:51], v[84:87], v[108:111]
    ds_read_b128 v[100:103], v11 offset:28672
    v_mfma_f32_16x16x32_bf16 v[112:115], a[48:51], v[88:91], v[112:115]
    ds_read_b128 v[104:107], v11 offset:30720
    v_mfma_f32_16x16x32_bf16 v[116:119], a[128:131], v[84:87], v[116:119]
    v_mfma_f32_16x16x32_bf16 v[120:123], a[128:131], v[88:91], v[120:123]
    s_waitcnt lgkmcnt(2)
    v_mfma_f32_16x16x32_bf16 v[108:111], a[52:55], v[92:95], v[108:111]
    ds_read_b128 v[84:87], v12 offset:28672
    v_mfma_f32_16x16x32_bf16 v[112:115], a[52:55], v[96:99], v[112:115]
    ds_read_b128 v[88:91], v12 offset:30720
    v_mfma_f32_16x16x32_bf16 v[116:119], a[132:135], v[92:95], v[116:119]
    v_mfma_f32_16x16x32_bf16 v[120:123], a[132:135], v[96:99], v[120:123]
    s_waitcnt lgkmcnt(2)
    v_mfma_f32_16x16x32_bf16 v[108:111], a[56:59], v[100:103], v[108:111]
    ds_read_b128 v[92:95], v11 offset:32768
    v_mfma_f32_16x16x32_bf16 v[112:115], a[56:59], v[104:107], v[112:115]
    ds_read_b128 v[96:99], v11 offset:34816
    v_mfma_f32_16x16x32_bf16 v[116:119], a[136:139], v[100:103], v[116:119]
    v_mfma_f32_16x16x32_bf16 v[120:123], a[136:139], v[104:107], v[120:123]
    s_waitcnt lgkmcnt(2)
    v_mfma_f32_16x16x32_bf16 v[108:111], a[60:63], v[84:87], v[108:111]
    ds_read_b128 v[100:103], v12 offset:32768
    v_mfma_f32_16x16x32_bf16 v[112:115], a[60:63], v[88:91], v[112:115]
    ds_read_b128 v[104:107], v12 offset:34816
    v_mfma_f32_16x16x32_bf16 v[116:119], a[140:143], v[84:87], v[116:119]
    v_mfma_f32_16x16x32_bf16 v[120:123], a[140:143], v[88:91], v[120:123]
    s_waitcnt lgkmcnt(2)
    v_mfma_f32_16x16x32_bf16 v[108:111], a[64:67], v[92:95], v[108:111]
    ds_read_b128 v[84:87], v11 offset:36864
    v_mfma_f32_16x16x32_bf16 v[112:115], a[64:67], v[96:99], v[112:115]
    ds_read_b128 v[88:91], v11 offset:38912
    v_mfma_f32_16x16x32_bf16 v[116:119], a[144:147], v[92:95], v[116:119]
    v_mfma_f32_16x16x32_bf16 v[120:123], a[144:147], v[96:99], v[120:123]
    s_waitcnt lgkmcnt(2)
    v_mfma_f32_16x16x32_bf16 v[108:111], a[68:71], v[100:103], v[108:111]
    ds_read_b128 v[92:95], v12 offset:36864
    v_mfma_f32_16x16x32_bf16 v[112:115], a[68:71], v[104:107], v[112:115]
    ds_read_b128 v[96:99], v12 offset:38912
    v_mfma_f32_16x16x32_bf16 v[116:119], a[148:151], v[100:103], v[116:119]
    v_mfma_f32_16x16x32_bf16 v[120:123], a[148:151], v[104:107], v[120:123]
    s_waitcnt lgkmcnt(0)
    v_mfma_f32_16x16x32_bf16 v[108:111], a[72:75], v[84:87], v[108:111]
    v_add_u32 v11, s49, v11
    v_mfma_f32_16x16x32_bf16 v[112:115], a[72:75], v[88:91], v[112:115]
    v_add_u32 v12, s49, v12
    v_mfma_f32_16x16x32_bf16 v[108:111], a[76:79], v[92:95], v[108:111]
    s_sub_u32 s47, s47, s49
    v_mfma_f32_16x16x32_bf16 v[112:115], a[76:79], v[96:99], v[112:115]
    s_sub_u32 s49, 0, s49
    v_mfma_f32_16x16x32_bf16 v[116:119], a[152:155], v[84:87], v[116:119]
    v_mfma_f32_16x16x32_bf16 v[120:123], a[152:155], v[88:91], v[120:123]
    v_mfma_f32_16x16x32_bf16 v[116:119], a[156:159], v[92:95], v[116:119]
    v_mfma_f32_16x16x32_bf16 v[120:123], a[156:159], v[96:99], v[120:123]
    v_cvt_pk_bf16_f32 v124, v108, v109
    v_cvt_pk_bf16_f32 v125, v110, v111
    v_cvt_pk_bf16_f32 v126, v112, v113
    v_cvt_pk_bf16_f32 v127, v114, v115
    s_nop 0
    v_permlane16_swap_b32 v124, v126
    v_permlane16_swap_b32 v125, v127
    v_cvt_pk_bf16_f32 v128, v116, v117
    v_cvt_pk_bf16_f32 v129, v118, v119
    v_cvt_pk_bf16_f32 v130, v120, v121
    v_cvt_pk_bf16_f32 v131, v122, v123
    s_nop 0
    v_permlane16_swap_b32 v128, v130
    v_permlane16_swap_b32 v129, v131
    ds_write_b128 v140, v[128:131]
    buffer_store_dwordx4 v[124:127], v19, s[4:7], s44 offen
    buffer_store_dwordx4 v[128:131], v19, s[4:7], s45 offen
    v_mov_b32 v3, 460288
L_pf_2:
    buffer_load_dword v4, v3, s[4:7], s38 offen sc1
    s_sub_u32 s36, s36, 1
    s_cbranch_scc1 L_exit
    s_waitcnt vmcnt(0)
    v_readfirstlane_b32 s90, v4
    s_nop 0
    s_cmp_eq_u32 s90, 0
    s_cbranch_scc1 L_pf_2
    s_and_b32 s90, s90, 2
    s_lshl_b32 s90, s90, 12
    v_mov_b32 v3, s90
    v_mov_b32 v4, v3
    v_cmp_gt_u32 vcc, 16, v0
    s_nop 1
    v_cndmask_b32 v3, v3, v4, vcc
    v_add_u32 v142, v3, v142
    v_add_u32 v143, s90, v143
    v_add_u32 v144, 0, v142
    v_add_u32 v145, 0, v143
    s_mov_b32 m0, s48
    v_mov_b32 v3, 200
L_p0_3:
    buffer_load_dword v4, v3, s[8:11], 0 offen sc1
    s_sub_u32 s36, s36, 1
    s_cbranch_scc1 L_exit
    s_waitcnt vmcnt(0)
    v_readfirstlane_b32 s90, v4
    s_nop 0
    s_cmp_eq_u32 s90, 0
    s_cbranch_scc1 L_p0_3
    s_and_b32 s90, s90, 2
    s_lshl_b32 s90, s90, 12
    s_and_b32 s91, s34, 1
    s_lshl_b32 s91, s91, 12
    s_lshr_b32 s92, s34, 2
    s_lshl_b32 s92, s92, 13
    s_add_u32 s91, s91, s92
    s_and_b32 s92, s34, 2
    s_lshl_b32 s92, s92, 13
    s_add_u32 s91, s91, s92
    s_xor_b32 s91, s91, s90
    s_add_u32 s91, s91, 1933312
    v_lshrrev_b32 v4, 2, v0
    v_lshl_add_u32 v3, v4, 9, s91
    v_cmp_ne_u32 s[92:93], s34, v4
    v_cmp_gt_u32 vcc, 32, v0
    s_nop 0
    s_and_b64 vcc, vcc, s[92:93]
    s_and_b32 vcc_lo, vcc_lo, s55
    v_cndmask_b32 v146, v146, v3, vcc
L_qkv_loop_f:
    buffer_load_dwordx4 v13, s[4:7], s41 offen sc1 lds
    buffer_load_dwordx4 v13, s[4:7], s41 offen offset:1024 sc1 lds
    buffer_load_dword v14, s[4:7], s41 offen offset:2048 sc1 lds
    buffer_load_dword v14, s[4:7], s41 offen offset:2304 sc1 lds
    s_add_u32 s50, s37, 2
    s_and_b32 s50, s50, 3
    s_mul_i32 s50, s50, 114688
    s_add_u32 s42, s38, s50
    s_add_u32 s50, s37, 3
    s_min_u32 s50, s50, 63
    s_mul_i32 s46, s50, 40960
    s_add_u32 s51, s37, 1
    v_mov_b32 v20, s51
    s_mov_b32 m0, s48
    v_mov_b32 v68, 0
    v_mov_b32 v69, 0
    v_mov_b32 v70, 0
    v_mov_b32 v71, 0
    v_mov_b32 v72, 0
    v_mov_b32 v73, 0
    v_mov_b32 v74, 0
    v_mov_b32 v75, 0
    ds_read_b128 v[156:159], v141
    ds_read_b128 v[160:163], v141 offset:1024
L_poll_5:
    buffer_load_dwordx4 v13, s[4:7], s41 offen sc1 lds
    buffer_load_dwordx4 v13, s[4:7], s41 offen offset:1024 sc1 lds
    buffer_load_dword v14, s[4:7], s41 offen offset:2048 sc1 lds
    buffer_load_dword v14, s[4:7], s41 offen offset:2304 sc1 lds
    s_sub_u32 s36, s36, 1
    s_cbranch_scc1 L_exit
    s_waitcnt vmcnt(4)
    ds_read_b32 v18, v15
    s_waitcnt lgkmcnt(0)
    v_cmp_eq_u32 vcc, -1, v18
    s_cbranch_vccnz L_poll_5
    s_barrier
    ds_read_b128 v[28:31], v16 offset:0
    ds_read_b128 v[32:35], v16 offset:1024
    ds_read_b128 v[36:39], v16 offset:2048
    ds_read_b128 v[40:43], v16 offset:3072
    s_waitcnt lgkmcnt(3)
    v_smfmac_f32_16x16x64_bf16 v[68:71], v[28:31], a[0:7], v17
    ds_read_b128 v[44:47], v16 offset:4096
    v_smfmac_f32_16x16x64_bf16 v[72:75], v[28:31], a[80:87], v17
    ds_read_b128 v[48:51], v16 offset:5120
    s_waitcnt lgkmcnt(4)
    v_smfmac_f32_16x16x64_bf16 v[68:71], v[32:35], a[8:15], v17
    ds_read_b128 v[52:55], v16 offset:6144
    v_smfmac_f32_16x16x64_bf16 v[72:75], v[32:35], a[88:95], v17
    ds_read_b128 v[56:59], v16 offset:7168
    s_waitcnt lgkmcnt(5)
    v_smfmac_f32_16x16x64_bf16 v[68:71], v[36:39], a[16:23], v17
    ds_read_b128 v[60:63], v16 offset:8192
    s_waitcnt lgkmcnt(5)
    v_smfmac_f32_16x16x64_bf16 v[68:71], v[40:43], a[24:31], v17
    ds_read_b128 v[64:67], v16 offset:9216
    s_waitcnt lgkmcnt(5)
    v_smfmac_f32_16x16x64_bf16 v[68:71], v[44:47], a[32:39], v17
    s_waitcnt lgkmcnt(4)
    v_smfmac_f32_16x16x64_bf16 v[68:71], v[48:51], a[40:47], v17
    s_waitcnt lgkmcnt(3)
    v_smfmac_f32_16x16x64_bf16 v[68:71], v[52:55], a[48:55], v17
    s_waitcnt lgkmcnt(2)
    v_smfmac_f32_16x16x64_bf16 v[68:71], v[56:59], a[56:63], v17
    s_waitcnt lgkmcnt(1)
    v_smfmac_f32_16x16x64_bf16 v[68:71], v[60:63], a[64:71], v17
    buffer_store_dword v20, v21, s[4:7], s38 offen offset:0
    s_waitcnt lgkmcnt(0)
    v_smfmac_f32_16x16x64_bf16 v[68:71], v[64:67], a[72:79], v17
L_redo_4:
    v_smfmac_f32_16x16x64_bf16 v[72:75], v[36:39], a[96:103], v17
    v_smfmac_f32_16x16x64_bf16 v[72:75], v[40:43], a[104:111], v17
    v_smfmac_f32_16x16x64_bf16 v[72:75], v[44:47], a[112:119], v17
    v_add_f32 v68, v68, v70
    v_add_f32 v69, v69, v71
    v_smfmac_f32_16x16x64_bf16 v[72:75], v[48:51], a[120:127], v17
    v_cvt_pk_bf16_f32 v132, v68, v69
    ds_write_b32 v23, v132
    v_smfmac_f32_16x16x64_bf16 v[72:75], v[52:55], a[128:135], v17
    v_cmp_u_f32 vcc, v68, v69
    v_smfmac_f32_16x16x64_bf16 v[72:75], v[56:59], a[136:143], v17
    v_smfmac_f32_16x16x64_bf16 v[72:75], v[60:63], a[144:151], v17
    s_cbranch_vccnz L_nan_6
L_cont_7:
    v_smfmac_f32_16x16x64_bf16 v[72:75], v[64:67], a[152:159], v17
    s_waitcnt lgkmcnt(0)
    s_barrier
    ds_read_b64_tr_b16 v[76:77], v24 offset:0
    ds_read_b64_tr_b16 v[78:79], v134 offset:0
    ds_read_b64_tr_b16 v[80:81], v24 offset:1024
    ds_read_b64_tr_b16 v[82:83], v134 offset:1024
    s_cmp_eq_u32 s32, 0
    s_cbranch_scc1 L_w0_8
    s_cmp_eq_u32 s32, 3
    s_cbranch_scc1 L_w3_9
    v_pk_add_f32 v[72:73], v[72:73], v[74:75]
    v_cvt_pk_bf16_f32 v133, v72, v73
    ds_write_b32 v23, v133 offset:4
    s_waitcnt lgkmcnt(3)
    v_mfma_f32_16x16x32_bf16 v[164:167], v[156:159], v[76:79], 0
    s_waitcnt lgkmcnt(1)
    v_mfma_f32_16x16x32_bf16 v[164:167], v[160:163], v[80:83], v[164:167]
    s_waitcnt lgkmcnt(0)
    s_barrier
    s_nop 5
    buffer_store_dwordx4 v[164:167], v135, s[4:7], s41 offen
    ds_read_b128 v[84:87], v11 offset:0
    ds_read_b128 v[88:91], v11 offset:2048
    ds_read_b128 v[92:95], v12 offset:0
    ds_read_b128 v[96:99], v12 offset:2048
    s_branch L_join_10
L_w0_8:
    v_pk_add_f32 v[72:73], v[72:73], v[74:75]
    v_cvt_pk_bf16_f32 v133, v72, v73
    ds_write_b32 v23, v133 offset:4
    s_waitcnt lgkmcnt(0)
    s_barrier
    ds_read_b64_tr_b16 v[76:77], v24 offset:0
    ds_read_b64_tr_b16 v[78:79], v134 offset:0
    ds_read_b64_tr_b16 v[80:81], v24 offset:1024
    ds_read_b64_tr_b16 v[82:83], v134 offset:1024
    s_waitcnt lgkmcnt(2)
    v_mfma_f32_16x16x32_bf16 v[164:167], v[76:79], v[76:79], 0
    s_waitcnt lgkmcnt(0)
    v_mfma_f32_16x16x32_bf16 v[164:167], v[80:83], v[80:83], v[164:167]
    ds_read_b128 v[84:87], v11 offset:0
    ds_read_b128 v[88:91], v11 offset:2048
    ds_read_b128 v[92:95], v12 offset:0
    ds_read_b128 v[96:99], v12 offset:2048
    s_nop 3
    buffer_store_dword v166, v135, s[4:7], s41 offen
    buffer_store_dword v167, v135, s[4:7], s41 offen offset:8
    s_branch L_join_10
L_w3_9:
    v_pk_add_f32 v[72:73], v[72:73], v[74:75]
    v_cvt_pk_bf16_f32 v133, v72, v73
    ds_write_b32 v23, v133 offset:4
    s_waitcnt lgkmcnt(0)
    s_barrier
    ds_read_b64_tr_b16 v[76:77], v24 offset:0
    ds_read_b64_tr_b16 v[78:79], v134 offset:0
    ds_read_b64_tr_b16 v[80:81], v24 offset:1024
    ds_read_b64_tr_b16 v[82:83], v134 offset:1024
    buffer_store_dword v20, v21, s[4:7], s38 offen offset:32
    s_waitcnt lgkmcnt(0)
    ds_read_b128 v[84:87], v11 offset:0
    ds_read_b128 v[88:91], v11 offset:2048
    ds_read_b128 v[92:95], v12 offset:0
    ds_read_b128 v[96:99], v12 offset:2048
    s_waitcnt lgkmcnt(0)
    buffer_store_dwordx4 v[76:79], v136, s[4:7], s43 offen
    buffer_store_dwordx4 v[80:83], v136, s[4:7], s43 offen offset:512
L_join_10:
    s_cmp_eq_u32 s37, 63
    s_cbranch_scc1 L_end_11
    s_lshl_b32 s90, s32, 10
    s_add_u32 m0, s90, s47
    s_waitcnt lgkmcnt(2)
    v_mfma_f32_16x16x32_bf16 v[108:111], a[0:3], v[84:87], 0
    ds_read_b128 v[100:103], v11 offset:4096
    s_and_b32 s50, s37, 3
    v_mfma_f32_16x16x32_bf16 v[112:115], a[0:3], v[88:91], 0
    ds_read_b128 v[104:107], v11 offset:6144
    s_mul_i32 s53, s50, 327680
    v_mfma_f32_16x16x32_bf16 v[116:119], a[80:83], v[84:87], 0
    s_add_u32 s51, s37, 2
    s_and_b32 s50, s51, 3
    v_mfma_f32_16x16x32_bf16 v[120:123], a[80:83], v[88:91], 0
    s_waitcnt lgkmcnt(2)
    s_mul_i32 s50, s50, 98304
    v_mfma_f32_16x16x32_bf16 v[108:111], a[4:7], v[92:95], v[108:111]
    ds_read_b128 v[84:87], v12 offset:4096
    s_add_u32 s50, s50, 475136
    v_mfma_f32_16x16x32_bf16 v[112:115], a[4:7], v[96:99], v[112:115]
    ds_read_b128 v[88:91], v12 offset:6144
    s_add_u32 s44, s38, s50
    v_mfma_f32_16x16x32_bf16 v[116:119], a[84:87], v[92:95], v[116:119]
    s_add_u32 s45, s44, s56
    s_and_b32 s50, s51, 3
    v_mfma_f32_16x16x32_bf16 v[120:123], a[84:87], v[96:99], v[120:123]
    s_waitcnt lgkmcnt(2)
    s_lshl_b32 s50, s50, 12
    v_mfma_f32_16x16x32_bf16 v[108:111], a[8:11], v[100:103], v[108:111]
    ds_read_b128 v[92:95], v11 offset:8192
    v_add_u32 v140, s50, v137
    v_mfma_f32_16x16x32_bf16 v[112:115], a[8:11], v[104:107], v[112:115]
    ds_read_b128 v[96:99], v11 offset:10240
    s_add_u32 s37, s37, 1
    v_mfma_f32_16x16x32_bf16 v[116:119], a[88:91], v[100:103], v[116:119]
    s_mov_b32 s52, 0
    s_and_b32 s50, s37, 3
    v_mfma_f32_16x16x32_bf16 v[120:123], a[88:91], v[104:107], v[120:123]
    s_waitcnt lgkmcnt(2)
    s_mul_i32 s51, s50, 114688
    v_mfma_f32_16x16x32_bf16 v[108:111], a[12:15], v[84:87], v[108:111]
    ds_read_b128 v[100:103], v12 offset:8192
    s_add_u32 s41, s38, s51
    v_mfma_f32_16x16x32_bf16 v[112:115], a[12:15], v[88:91], v[112:115]
    ds_read_b128 v[104:107], v12 offset:10240
    s_and_b32 s54, s37, s55
    v_mfma_f32_16x16x32_bf16 v[116:119], a[92:95], v[84:87], v[116:119]
    buffer_store_dword v22, v150, s[4:7], s42 offen offset:0
    buffer_store_dword v22, v149, s[4:7], s42 offen offset:0
    v_mfma_f32_16x16x32_bf16 v[120:123], a[92:95], v[88:91], v[120:123]
    s_waitcnt lgkmcnt(2)
    s_lshl_b32 s50, s50, 12
    v_mfma_f32_16x16x32_bf16 v[108:111], a[16:19], v[92:95], v[108:111]
    ds_read_b128 v[84:87], v11 offset:12288
    v_add_u32 v141, s50, v138
    v_mfma_f32_16x16x32_bf16 v[112:115], a[16:19], v[96:99], v[112:115]
    ds_read_b128 v[88:91], v11 offset:14336
    s_add_u32 s43, s41, 40960
    v_mfma_f32_16x16x32_bf16 v[116:119], a[96:99], v[92:95], v[116:119]
    buffer_store_dword v22, v150, s[4:7], s42 offen offset:256
    v_mfma_f32_16x16x32_bf16 v[120:123], a[96:99], v[96:99], v[120:123]
    s_waitcnt lgkmcnt(2)
    v_mfma_f32_16x16x32_bf16 v[108:111], a[20:23], v[100:103], v[108:111]
    ds_read_b128 v[92:95], v12 offset:12288
    v_mfma_f32_16x16x32_bf16 v[112:115], a[20:23], v[104:107], v[112:115]
    ds_read_b128 v[96:99], v12 offset:14336
    v_mfma_f32_16x16x32_bf16 v[116:119], a[100:103], v[100:103], v[116:119]
    buffer_load_dwordx4 v10, s[24:27], s46 offen offset:0 lds
    s_add_u32 m0, m0, 3968
    v_mfma_f32_16x16x32_bf16 v[120:123], a[100:103], v[104:107], v[120:123]
    s_waitcnt lgkmcnt(2)
    v_mfma_f32_16x16x32_bf16 v[108:111], a[24:27], v[84:87], v[108:111]
    ds_read_b128 v[100:103], v11 offset:16384
    v_mfma_f32_16x16x32_bf16 v[112:115], a[24:27], v[88:91], v[112:115]
    ds_read_b128 v[104:107], v11 offset:18432
    v_mfma_f32_16x16x32_bf16 v[116:119], a[104:107], v[84:87], v[116:119]
    buffer_load_dwordx4 v10, s[24:27], s46 offen offset:128 lds
    s_add_u32 m0, m0, 3968
    v_mfma_f32_16x16x32_bf16 v[120:123], a[104:107], v[88:91], v[120:123]
    s_waitcnt lgkmcnt(2)
    v_mfma_f32_16x16x32_bf16 v[108:111], a[28:31], v[92:95], v[108:111]
    ds_read_b128 v[84:87], v12 offset:16384
    v_mfma_f32_16x16x32_bf16 v[112:115], a[28:31], v[96:99], v[112:115]
    ds_read_b128 v[88:91], v12 offset:18432
    v_mfma_f32_16x16x32_bf16 v[116:119], a[108:111], v[92:95], v[116:119]
    buffer_load_dwordx4 v10, s[24:27], s46 offen offset:256 lds
    s_add_u32 m0, m0, 3968
    v_mfma_f32_16x16x32_bf16 v[120:123], a[108:111], v[96:99], v[120:123]
    s_waitcnt lgkmcnt(2)
    v_mfma_f32_16x16x32_bf16 v[108:111], a[32:35], v[100:103], v[108:111]
    ds_read_b128 v[92:95], v11 offset:20480
    v_mfma_f32_16x16x32_bf16 v[112:115], a[32:35], v[104:107], v[112:115]
    ds_read_b128 v[96:99], v11 offset:22528
    v_mfma_f32_16x16x32_bf16 v[116:119], a[112:115], v[100:103], v[116:119]
    s_waitcnt vmcnt(6)
    buffer_store_dword v20, v139, s[4:7], s38 offen
    v_mfma_f32_16x16x32_bf16 v[120:123], a[112:115], v[104:107], v[120:123]
    s_waitcnt lgkmcnt(2)
    v_mfma_f32_16x16x32_bf16 v[108:111], a[36:39], v[84:87], v[108:111]
    ds_read_b128 v[100:103], v12 offset:20480
    v_mfma_f32_16x16x32_bf16 v[112:115], a[36:39], v[88:91], v[112:115]
    buffer_load_dword v147, v146, s[4:7], 0 offen sc1
    ds_read_b128 v[104:107], v12 offset:22528
    v_mfma_f32_16x16x32_bf16 v[116:119], a[116:119], v[84:87], v[116:119]
    buffer_load_dwordx4 v10, s[24:27], s46 offen offset:384 lds
    s_add_u32 m0, m0, 3968
    v_mfma_f32_16x16x32_bf16 v[120:123], a[116:119], v[88:91], v[120:123]
    s_waitcnt lgkmcnt(2)
    v_mfma_f32_16x16x32_bf16 v[108:111], a[40:43], v[92:95], v[108:111]
    ds_read_b128 v[84:87], v11 offset:24576
    v_mfma_f32_16x16x32_bf16 v[112:115], a[40:43], v[96:99], v[112:115]
    buffer_load_dword v147, v146, s[4:7], 0 offen sc1
    ds_read_b128 v[88:91], v11 offset:26624
    v_mfma_f32_16x16x32_bf16 v[116:119], a[120:123], v[92:95], v[116:119]
    buffer_load_dwordx4 v10, s[24:27], s46 offen offset:512 lds
    s_add_u32 m0, m0, 3968
    v_mfma_f32_16x16x32_bf16 v[120:123], a[120:123], v[96:99], v[120:123]
    s_waitcnt lgkmcnt(2)
    v_mfma_f32_16x16x32_bf16 v[108:111], a[44:47], v[100:103], v[108:111]
    ds_read_b128 v[92:95], v12 offset:24576
    v_mfma_f32_16x16x32_bf16 v[112:115], a[44:47], v[104:107], v[112:115]
    buffer_load_dword v147, v146, s[4:7], 0 offen sc1
    ds_read_b128 v[96:99], v12 offset:26624
    v_mfma_f32_16x16x32_bf16 v[116:119], a[124:127], v[100:103], v[116:119]
    buffer_load_dwordx4 v10, s[24:27], s46 offen offset:640 lds
    s_add_u32 m0, m0, 3968
    v_mfma_f32_16x16x32_bf16 v[120:123], a[124:127], v[104:107], v[120:123]
    s_waitcnt lgkmcnt(2)
    v_mfma_f32_16x16x32_bf16 v[108:111], a[48:51], v[84:87], v[108:111]
    ds_read_b128 v[100:103], v11 offset:28672
    v_mfma_f32_16x16x32_bf16 v[112:115], a[48:51], v[88:91], v[112:115]
    buffer_load_dword v147, v146, s[4:7], 0 offen sc1
    ds_read_b128 v[104:107], v11 offset:30720
    v_mfma_f32_16x16x32_bf16 v[116:119], a[128:131], v[84:87], v[116:119]
    buffer_load_dwordx4 v10, s[24:27], s46 offen offset:768 lds
    s_add_u32 m0, m0, 3968
    v_mfma_f32_16x16x32_bf16 v[120:123], a[128:131], v[88:91], v[120:123]
    s_waitcnt lgkmcnt(2)
    v_mfma_f32_16x16x32_bf16 v[108:111], a[52:55], v[92:95], v[108:111]
    ds_read_b128 v[84:87], v12 offset:28672
    v_mfma_f32_16x16x32_bf16 v[112:115], a[52:55], v[96:99], v[112:115]
    buffer_load_dword v147, v146, s[4:7], 0 offen sc1
    ds_read_b128 v[88:91], v12 offset:30720
    v_mfma_f32_16x16x32_bf16 v[116:119], a[132:135], v[92:95], v[116:119]
    buffer_load_dwordx4 v10, s[24:27], s46 offen offset:896 lds
    s_add_u32 m0, m0, 3968
    v_mfma_f32_16x16x32_bf16 v[120:123], a[132:135], v[96:99], v[120:123]
    s_waitcnt lgkmcnt(2)
    v_mfma_f32_16x16x32_bf16 v[108:111], a[56:59], v[100:103], v[108:111]
    ds_read_b128 v[92:95], v11 offset:32768
    v_mfma_f32_16x16x32_bf16 v[112:115], a[56:59], v[104:107], v[112:115]
    buffer_load_dword v147, v146, s[4:7], 0 offen sc1
    ds_read_b128 v[96:99], v11 offset:34816
    v_mfma_f32_16x16x32_bf16 v[116:119], a[136:139], v[100:103], v[116:119]
    buffer_load_dwordx4 v10, s[24:27], s46 offen offset:1024 lds
    s_add_u32 m0, m0, 3968
    v_mfma_f32_16x16x32_bf16 v[120:123], a[136:139], v[104:107], v[120:123]
    s_waitcnt lgkmcnt(2)
    v_mfma_f32_16x16x32_bf16 v[108:111], a[60:63], v[84:87], v[108:111]
    ds_read_b128 v[100:103], v12 offset:32768
    v_mfma_f32_16x16x32_bf16 v[112:115], a[60:63], v[88:91], v[112:115]
    buffer_load_dword v147, v146, s[4:7], 0 offen sc1
    ds_read_b128 v[104:107], v12 offset:34816
    v_mfma_f32_16x16x32_bf16 v[116:119], a[140:143], v[84:87], v[116:119]
    buffer_load_dwordx4 v10, s[24:27], s46 offen offset:1152 lds
    v_mfma_f32_16x16x32_bf16 v[120:123], a[140:143], v[88:91], v[120:123]
    s_waitcnt lgkmcnt(2)
    v_mfma_f32_16x16x32_bf16 v[108:111], a[64:67], v[92:95], v[108:111]
    ds_read_b128 v[84:87], v11 offset:36864
    v_mfma_f32_16x16x32_bf16 v[112:115], a[64:67], v[96:99], v[112:115]
L_sp_12:
    s_waitcnt vmcnt(6)
    v_cmp_gt_u32 vcc, s54, v147
    buffer_load_dword v147, v146, s[4:7], 0 offen sc1
    s_sub_u32 s36, s36, 1
    s_cbranch_scc1 L_exit
    s_cbranch_vccz L_sp_12x
    s_waitcnt vmcnt(6)
    v_cmp_gt_u32 vcc, s54, v147
    buffer_load_dword v147, v146, s[4:7], 0 offen sc1
    s_cbranch_vccz L_sp_12x
    s_waitcnt vmcnt(6)
    v_cmp_gt_u32 vcc, s54, v147
    buffer_load_dword v147, v146, s[4:7], 0 offen sc1
    s_cbranch_vccz L_sp_12x
    s_waitcnt vmcnt(6)
    v_cmp_gt_u32 vcc, s54, v147
    buffer_load_dword v147, v146, s[4:7], 0 offen sc1
    s_cbranch_vccnz L_sp_12
L_sp_12x:
    s_barrier
    buffer_load_dwordx4 v[168:171], v142, s[4:7], s53 offen sc1
    ds_read_b128 v[88:91], v11 offset:38912
    v_mfma_f32_16x16x32_bf16 v[116:119], a[144:147], v[92:95], v[116:119]
    v_mfma_f32_16x16x32_bf16 v[120:123], a[144:147], v[96:99], v[120:123]
    s_waitcnt lgkmcnt(2)
    v_mfma_f32_16x16x32_bf16 v[108:111], a[68:71], v[100:103], v[108:111]
    ds_read_b128 v[92:95], v12 offset:36864
    v_mfma_f32_16x16x32_bf16 v[112:115], a[68:71], v[104:107], v[112:115]
    ds_read_b128 v[96:99], v12 offset:38912
    v_mfma_f32_16x16x32_bf16 v[116:119], a[148:151], v[100:103], v[116:119]
    v_mfma_f32_16x16x32_bf16 v[120:123], a[148:151], v[104:107], v[120:123]
    buffer_load_dwordx4 v[172:175], v143, s[4:7], s53 offen sc1
    s_waitcnt lgkmcnt(0)
    v_mfma_f32_16x16x32_bf16 v[108:111], a[72:75], v[84:87], v[108:111]
    v_add_u32 v11, s49, v11
    v_mfma_f32_16x16x32_bf16 v[112:115], a[72:75], v[88:91], v[112:115]
    v_add_u32 v12, s49, v12
    v_mfma_f32_16x16x32_bf16 v[108:111], a[76:79], v[92:95], v[108:111]
    s_sub_u32 s47, s47, s49
    v_mfma_f32_16x16x32_bf16 v[112:115], a[76:79], v[96:99], v[112:115]
    s_sub_u32 s49, 0, s49
    v_mfma_f32_16x16x32_bf16 v[116:119], a[152:155], v[84:87], v[116:119]
    v_mfma_f32_16x16x32_bf16 v[120:123], a[152:155], v[88:91], v[120:123]
    v_mfma_f32_16x16x32_bf16 v[116:119], a[156:159], v[92:95], v[116:119]
    v_mfma_f32_16x16x32_bf16 v[120:123], a[156:159], v[96:99], v[120:123]
    v_cvt_pk_bf16_f32 v124, v108, v109
    v_cvt_pk_bf16_f32 v125, v110, v111
    v_cvt_pk_bf16_f32 v126, v112, v113
    v_cvt_pk_bf16_f32 v127, v114, v115
    s_nop 0
    v_permlane16_swap_b32 v124, v126
    v_permlane16_swap_b32 v125, v127
    v_cvt_pk_bf16_f32 v128, v116, v117
    v_cvt_pk_bf16_f32 v129, v118, v119
    v_cvt_pk_bf16_f32 v130, v120, v121
    v_cvt_pk_bf16_f32 v131, v122, v123
    s_nop 0
    v_permlane16_swap_b32 v128, v130
    v_permlane16_swap_b32 v129, v131
    ds_write_b128 v140, v[128:131]
    buffer_store_dwordx4 v[124:127], v19, s[4:7], s44 offen
    buffer_store_dwordx4 v[128:131], v19, s[4:7], s45 offen
    s_mov_b32 m0, s48
    s_waitcnt vmcnt(3)
    v_mfma_f32_16x16x32_bf16 v[184:187], v[198:201], v[168:171], 0
    v_mfma_f32_16x16x32_bf16 v[188:191], v[196:199], v[168:171], 0
    s_waitcnt vmcnt(2)
    v_mfma_f32_16x16x32_bf16 v[184:187], v[198:201], v[172:175], v[184:187]
    v_mfma_f32_16x16x32_bf16 v[188:191], v[196:199], v[172:175], v[188:191]
    s_nop 4
    v_cmp_u_f32 vcc, v184, v184
    v_cvt_pk_bf16_f32 v192, v184, v185
    v_cvt_pk_bf16_f32 v193, v186, v187
    v_cvt_pk_bf16_f32 v194, v188, v189
    v_cvt_pk_bf16_f32 v195, v190, v191
    s_cbranch_vccnz L_pp_13
L_pc_14:
    buffer_store_dwordx4 v[192:195], v148, s[4:7], s41 offen
    s_barrier
    s_branch L_qkv_loop_f
L_end_11:
    s_waitcnt vmcnt(0) lgkmcnt(0)
    buffer_store_dword v20, v139, s[4:7], s38 offen
    s_endpgm
L_nan_6:
    s_cmp_eq_u32 s52, 1
    s_cbranch_scc1 L_cont_7
    v_lshlrev_b32 v1, 4, v0
L_nan_6r:
    s_mov_b32 s90, s41
    v_mov_b32 v2, 0
    buffer_load_dwordx4 v[28:31], v1, s[4:7], s90 offen sc1
    s_add_u32 s90, s90, 1024
    buffer_load_dwordx4 v[32:35], v1, s[4:7], s90 offen sc1
    s_add_u32 s90, s90, 1024
    buffer_load_dwordx4 v[36:39], v1, s[4:7], s90 offen sc1
    s_add_u32 s90, s90, 1024
    buffer_load_dwordx4 v[40:43], v1, s[4:7], s90 offen sc1
    s_add_u32 s90, s90, 1024
    buffer_load_dwordx4 v[44:47], v1, s[4:7], s90 offen sc1
    s_add_u32 s90, s90, 1024
    buffer_load_dwordx4 v[48:51], v1, s[4:7], s90 offen sc1
    s_add_u32 s90, s90, 1024
    buffer_load_dwordx4 v[52:55], v1, s[4:7], s90 offen sc1
    s_add_u32 s90, s90, 1024
    buffer_load_dwordx4 v[56:59], v1, s[4:7], s90 offen sc1
    s_add_u32 s90, s90, 1024
    buffer_load_dwordx4 v[60:63], v1, s[4:7], s90 offen sc1
    s_add_u32 s90, s90, 1024
    buffer_load_dwordx4 v[64:67], v1, s[4:7], s90 offen sc1
    s_add_u32 s90, s90, 1024
    s_sub_u32 s36, s36, 1
    s_cbranch_scc1 L_exit
    s_waitcnt vmcnt(0) lgkmcnt(0)
    v_max3_u32 v2, v2, v28, v29
    v_max3_u32 v2, v2, v30, v31
    v_max3_u32 v2, v2, v32, v33
    v_max3_u32 v2, v2, v34, v35
    v_max3_u32 v2, v2, v36, v37
    v_max3_u32 v2, v2, v38, v39
    v_max3_u32 v2, v2, v40, v41
    v_max3_u32 v2, v2, v42, v43
    v_max3_u32 v2, v2, v44, v45
    v_max3_u32 v2, v2, v46, v47
    v_max3_u32 v2, v2, v48, v49
    v_max3_u32 v2, v2, v50, v51
    v_max3_u32 v2, v2, v52, v53
    v_max3_u32 v2, v2, v54, v55
    v_max3_u32 v2, v2, v56, v57
    v_max3_u32 v2, v2, v58, v59
    v_max3_u32 v2, v2, v60, v61
    v_max3_u32 v2, v2, v62, v63
    v_max3_u32 v2, v2, v64, v65
    v_max3_u32 v2, v2, v66, v67
    v_cmp_eq_u32 vcc, -1, v2
    s_cbranch_vccnz L_nan_6r
    s_mov_b32 s52, 1
    v_mov_b32 v68, 0
    v_mov_b32 v69, 0
    v_mov_b32 v70, 0
    v_mov_b32 v71, 0
    v_mov_b32 v72, 0
    v_mov_b32 v73, 0
    v_mov_b32 v74, 0
    v_mov_b32 v75, 0
    v_smfmac_f32_16x16x64_bf16 v[68:71], v[28:31], a[0:7], v17
    s_nop 0
    v_smfmac_f32_16x16x64_bf16 v[72:75], v[28:31], a[80:87], v17
    v_smfmac_f32_16x16x64_bf16 v[68:71], v[32:35], a[8:15], v17
    v_smfmac_f32_16x16x64_bf16 v[72:75], v[32:35], a[88:95], v17
    v_smfmac_f32_16x16x64_bf16 v[68:71], v[36:39], a[16:23], v17
    v_smfmac_f32_16x16x64_bf16 v[68:71], v[40:43], a[24:31], v17
    v_smfmac_f32_16x16x64_bf16 v[68:71], v[44:47], a[32:39], v17
    v_smfmac_f32_16x16x64_bf16 v[68:71], v[48:51], a[40:47], v17
    v_smfmac_f32_16x16x64_bf16 v[68:71], v[52:55], a[48:55], v17
    v_smfmac_f32_16x16x64_bf16 v[68:71], v[56:59], a[56:63], v17
    v_smfmac_f32_16x16x64_bf16 v[68:71], v[60:63], a[64:71], v17
    v_smfmac_f32_16x16x64_bf16 v[68:71], v[64:67], a[72:79], v17
    s_nop 3
    s_branch L_redo_4
L_pp_13:
    buffer_load_dwordx4 v[176:179], v144, s[4:7], s53 offen sc1
    buffer_load_dwordx4 v[180:183], v145, s[4:7], s53 offen sc1
    s_sub_u32 s36, s36, 1
    s_cbranch_scc1 L_exit
    v_max_u32 v151, v168, v169
    v_max3_u32 v151, v151, v170, v171
    v_max3_u32 v151, v151, v172, v173
    v_max3_u32 v151, v151, v174, v175
    v_cmp_eq_u32 vcc, -1, v151
    s_cbranch_vccz L_pc_14
    s_waitcnt vmcnt(1)
    v_mfma_f32_16x16x32_bf16 v[184:187], v[198:201], v[176:179], 0
    v_mfma_f32_16x16x32_bf16 v[188:191], v[196:199], v[176:179], 0
    s_waitcnt vmcnt(0)
    v_mfma_f32_16x16x32_bf16 v[184:187], v[198:201], v[180:183], v[184:187]
    v_mfma_f32_16x16x32_bf16 v[188:191], v[196:199], v[180:183], v[188:191]
    s_nop 4
    v_cmp_u_f32 vcc, v184, v184
    v_cvt_pk_bf16_f32 v192, v184, v185
    v_cvt_pk_bf16_f32 v193, v186, v187
    v_cvt_pk_bf16_f32 v194, v188, v189
    v_cvt_pk_bf16_f32 v195, v190, v191
    s_cbranch_vccnz L_pp_13_1
    s_branch L_pc_14
L_pp_13_1:
    buffer_load_dwordx4 v[168:171], v142, s[4:7], s53 offen sc1
    buffer_load_dwordx4 v[172:175], v143, s[4:7], s53 offen sc1
    s_sub_u32 s36, s36, 1
    s_cbranch_scc1 L_exit
    v_max_u32 v151, v176, v177
    v_max3_u32 v151, v151, v178, v179
    v_max3_u32 v151, v151, v180, v181
    v_max3_u32 v151, v151, v182, v183
    v_cmp_eq_u32 vcc, -1, v151
    s_cbranch_vccz L_pc_14
    s_waitcnt vmcnt(1)
    v_mfma_f32_16x16x32_bf16 v[184:187], v[198:201], v[168:171], 0
    v_mfma_f32_16x16x32_bf16 v[188:191], v[196:199], v[168:171], 0
    s_waitcnt vmcnt(0)
    v_mfma_f32_16x16x32_bf16 v[184:187], v[198:201], v[172:175], v[184:187]
    v_mfma_f32_16x16x32_bf16 v[188:191], v[196:199], v[172:175], v[188:191]
    s_nop 4
    v_cmp_u_f32 vcc, v184, v184
    v_cvt_pk_bf16_f32 v192, v184, v185
    v_cvt_pk_bf16_f32 v193, v186, v187
    v_cvt_pk_bf16_f32 v194, v188, v189
    v_cvt_pk_bf16_f32 v195, v190, v191
    s_cbranch_vccnz L_pp_13
    s_branch L_pc_14
L_v_f:
    s_mov_b32 s12, s78
    s_and_b32 s13, s79, 0xffff
    s_mov_b32 s14, 7864320
    s_mov_b32 s15, 0x20000
    s_sub_u32 s40, s35, 12
    s_lshl_b32 s40, s40, 1
    s_mov_b32 s24, s70
    s_and_b32 s25, s71, 0xffff
    s_mov_b32 s26, 2621440
    s_mov_b32 s27, 0x20000
    v_and_b32 v1, 15, v0
    v_lshrrev_b32 v2, 4, v0
    v_lshrrev_b32 v3, 3, v0
    v_and_b32 v4, 7, v0
    s_lshl_b32 s90, s32, 3
    v_add_u32 v5, s90, v3
    s_and_b32 s91, s32, 1
    s_lshl_b32 s91, s91, 2
    v_and_b32 v6, 2, v3
    v_or_b32 v6, s91, v6
    v_xor_b32 v6, v6, v4
    v_lshlrev_b32 v6, 4, v6
    v_mul_u32_u24 v7, 12288, v5
    s_mul_i32 s92, s34, 1536
    s_lshl_b32 s93, s40, 7
    s_add_u32 s92, s92, s93
    v_add3_u32 v124, v6, v7, s92
    v_lshrrev_b32 v6, 1, v3
    v_or_b32 v6, s91, v6
    v_xor_b32 v6, v6, v4
    v_lshlrev_b32 v6, 4, v6
    v_mul_u32_u24 v7, 1280, v5
    v_add_u32 v10, v6, v7
    s_lshl_b32 s90, s32, 10
    s_add_u32 m0, s90, 81920
    s_mov_b32 s91, 0
    buffer_load_dwordx4 v124, s[12:15], s91 offen nt lds
    s_add_u32 m0, m0, 4096
    s_add_u32 s91, s91, 393216
    buffer_load_dwordx4 v124, s[12:15], s91 offen nt lds
    s_add_u32 m0, m0, 4096
    s_add_u32 s91, s91, 393216
    buffer_load_dwordx4 v124, s[12:15], s91 offen nt lds
    s_add_u32 m0, m0, 4096
    s_add_u32 s91, s91, 393216
    buffer_load_dwordx4 v124, s[12:15], s91 offen nt lds
    s_add_u32 m0, m0, 4096
    s_add_u32 s91, s91, 393216
    buffer_load_dwordx4 v124, s[12:15], s91 offen nt lds
    s_add_u32 m0, m0, 4096
    s_add_u32 s91, s91, 393216
    buffer_load_dwordx4 v124, s[12:15], s91 offen nt lds
    s_add_u32 m0, m0, 4096
    s_add_u32 s91, s91, 393216
    buffer_load_dwordx4 v124, s[12:15], s91 offen nt lds
    s_add_u32 m0, m0, 4096
    s_add_u32 s91, s91, 393216
    buffer_load_dwordx4 v124, s[12:15], s91 offen nt lds
    s_add_u32 m0, m0, 4096
    s_add_u32 s91, s91, 393216
    buffer_load_dwordx4 v124, s[12:15], s91 offen nt lds
    s_add_u32 m0, m0, 4096
    s_add_u32 s91, s91, 393216
    buffer_load_dwordx4 v124, s[12:15], s91 offen nt lds
    s_lshl_b32 s90, s32, 10
    s_add_u32 m0, s90, 40960
    s_mov_b32 s91, 128
    buffer_load_dwordx4 v124, s[12:15], s91 offen nt lds
    s_add_u32 m0, m0, 4096
    s_add_u32 s91, s91, 393216
    buffer_load_dwordx4 v124, s[12:15], s91 offen nt lds
    s_add_u32 m0, m0, 4096
    s_add_u32 s91, s91, 393216
    buffer_load_dwordx4 v124, s[12:15], s91 offen nt lds
    s_add_u32 m0, m0, 4096
    s_add_u32 s91, s91, 393216
    buffer_load_dwordx4 v124, s[12:15], s91 offen nt lds
    s_add_u32 m0, m0, 4096
    s_add_u32 s91, s91, 393216
    buffer_load_dwordx4 v124, s[12:15], s91 offen nt lds
    s_add_u32 m0, m0, 4096
    s_add_u32 s91, s91, 393216
    buffer_load_dwordx4 v124, s[12:15], s91 offen nt lds
    s_add_u32 m0, m0, 4096
    s_add_u32 s91, s91, 393216
    buffer_load_dwordx4 v124, s[12:15], s91 offen nt lds
    s_add_u32 m0, m0, 4096
    s_add_u32 s91, s91, 393216
    buffer_load_dwordx4 v124, s[12:15], s91 offen nt lds
    s_add_u32 m0, m0, 4096
    s_add_u32 s91, s91, 393216
    buffer_load_dwordx4 v124, s[12:15], s91 offen nt lds
    s_add_u32 m0, m0, 4096
    s_add_u32 s91, s91, 393216
    buffer_load_dwordx4 v124, s[12:15], s91 offen nt lds
    s_lshl_b32 s90, s32, 10
    s_add_u32 m0, s90, 122880
    s_mov_b32 s91, 3932160
    buffer_load_dwordx4 v124, s[12:15], s91 offen nt lds
    s_add_u32 m0, m0, 4096
    s_add_u32 s91, s91, 393216
    buffer_load_dwordx4 v124, s[12:15], s91 offen nt lds
    s_add_u32 m0, m0, 4096
    s_add_u32 s91, s91, 393216
    buffer_load_dwordx4 v124, s[12:15], s91 offen nt lds
    s_add_u32 m0, m0, 4096
    s_add_u32 s91, s91, 393216
    buffer_load_dwordx4 v124, s[12:15], s91 offen nt lds
    s_add_u32 m0, m0, 4096
    s_add_u32 s91, s91, 393216
    buffer_load_dwordx4 v124, s[12:15], s91 offen nt lds
    s_add_u32 m0, m0, 4096
    s_add_u32 s91, s91, 393216
    buffer_load_dwordx4 v124, s[12:15], s91 offen nt lds
    s_add_u32 m0, m0, 4096
    s_add_u32 s91, s91, 393216
    buffer_load_dwordx4 v124, s[12:15], s91 offen nt lds
    s_add_u32 m0, m0, 4096
    s_add_u32 s91, s91, 393216
    buffer_load_dwordx4 v124, s[12:15], s91 offen nt lds
    s_add_u32 m0, m0, 4096
    s_add_u32 s91, s91, 393216
    buffer_load_dwordx4 v124, s[12:15], s91 offen nt lds
    s_add_u32 m0, m0, 4096
    s_add_u32 s91, s91, 393216
    buffer_load_dwordx4 v124, s[12:15], s91 offen nt lds
    s_mov_b32 s46, 0
    s_lshl_b32 s90, s32, 10
    s_add_u32 m0, s90, 0
    s_nop 0
    buffer_load_dwordx4 v10, s[24:27], s46 offen offset:0 lds
    s_add_u32 m0, m0, 3968
    s_nop 0
    buffer_load_dwordx4 v10, s[24:27], s46 offen offset:128 lds
    s_add_u32 m0, m0, 3968
    s_nop 0
    buffer_load_dwordx4 v10, s[24:27], s46 offen offset:256 lds
    s_add_u32 m0, m0, 3968
    s_nop 0
    buffer_load_dwordx4 v10, s[24:27], s46 offen offset:384 lds
    s_add_u32 m0, m0, 3968
    s_nop 0
    buffer_load_dwordx4 v10, s[24:27], s46 offen offset:512 lds
    s_add_u32 m0, m0, 3968
    s_nop 0
    buffer_load_dwordx4 v10, s[24:27], s46 offen offset:640 lds
    s_add_u32 m0, m0, 3968
    s_nop 0
    buffer_load_dwordx4 v10, s[24:27], s46 offen offset:768 lds
    s_add_u32 m0, m0, 3968
    s_nop 0
    buffer_load_dwordx4 v10, s[24:27], s46 offen offset:896 lds
    s_add_u32 m0, m0, 3968
    s_nop 0
    buffer_load_dwordx4 v10, s[24:27], s46 offen offset:1024 lds
    s_add_u32 m0, m0, 3968
    s_nop 0
    buffer_load_dwordx4 v10, s[24:27], s46 offen offset:1152 lds
    s_lshl_b32 s93, s40, 1
    s_add_u32 s93, s93, s32
    s_mul_i32 s93, s93, 7168
    s_add_u32 s93, s93, 884736
    s_add_u32 s61, s93, s38
    s_mul_i32 s60, s40, 86
    s_lshr_b32 s60, s60, 8
    s_mul_i32 s59, s60, 3
    s_sub_u32 s59, s40, s59
    s_add_u32 s90, s40, 1
    s_mul_i32 s62, s90, 86
    s_lshr_b32 s62, s62, 8
    s_mul_i32 s63, s62, 3
    s_sub_u32 s63, s90, s63
    v_lshrrev_b32 v3, 1, v2
    v_and_b32 v5, 1, v2
    s_lshl_b32 s90, s32, 9
    v_lshlrev_b32 v6, 4, v1
    v_lshl_add_u32 v6, v3, 8, v6
    v_add_u32 v6, s90, v6
    s_mul_i32 s90, s60, 12288
    s_lshl_b32 s91, s59, 11
    s_add_u32 s90, s90, s91
    v_mul_u32_u24 v7, 6144, v5
    v_add3_u32 v19, v6, v7, s90
    v_mov_b32 v22, -1
    s_mul_i32 s56, s62, 12288
    s_lshl_b32 s91, s63, 11
    s_add_u32 s56, s56, s91
    s_sub_u32 s56, s56, s90
    s_lshl_b32 s90, s40, 10
    s_lshl_b32 s91, s32, 8
    s_add_u32 s91, s91, s90
    s_add_u32 s91, s91, 25600
    v_lshl_add_u32 v135, v0, 2, s91
    v_and_b32 v6, 60, v0
    v_bfe_u32 v7, v0, 1, 1
    v_or_b32 v6, v6, v7
    v_and_b32 v7, 1, v0
    v_lshl_or_b32 v6, v7, 1, v6
    s_and_b32 s90, s32, 1
    s_lshl_b32 s90, s90, 3
    v_xor_b32 v6, s90, v6
    v_lshl_add_u32 v134, v6, 2, s91
    s_lshl_b32 s90, s60, 5
    s_lshl_b32 s91, s62, 5
    v_mov_b32 v3, s90
    v_mov_b32 v4, s91
    v_mov_b32 v6, s59
    v_mov_b32 v7, s63
    v_cmp_eq_u32 vcc, 0, v0
    s_nop 1
    v_cndmask_b32 v3, v4, v3, vcc
    v_cndmask_b32 v6, v7, v6, vcc
    v_add_u32 v4, v3, v6
    s_cmp_eq_u32 s32, 3
    s_cselect_b32 s91, 0, 2146435072
    s_add_u32 s91, s91, 462348
    v_lshl_add_u32 v21, v4, 2, s91
    v_lshl_add_u32 v4, v6, 2, v3
    s_lshl_b32 s91, s32, 2
    s_add_u32 s91, s91, 458752
    v_lshl_add_u32 v136, v4, 2, s91
    v_cmp_gt_u32 vcc, 2, v0
    v_mov_b32 v9, 2146435072
    s_nop 0
    v_cndmask_b32 v21, v9, v21, vcc
    v_cndmask_b32 v136, v9, v136, vcc
    s_lshl_b32 s90, s40, 1
    s_add_u32 s90, s90, s32
    s_sub_u32 s90, s90, 4
    s_lshl_b32 s90, s90, 11
    s_cmp_eq_u32 s40, 0
    s_cselect_b32 s90, 2146435072, s90
    v_lshl_add_u32 v137, v0, 4, s90
    v_mov_b32 v138, 460800
    v_lshrrev_b32 v3, 2, v1
    v_and_b32 v4, 3, v1
    v_and_b32 v5, 1, v2
    v_lshl_add_u32 v6, v2, 3, v3
    v_lshlrev_b32 v6, 7, v6
    v_and_b32 v7, 2, v3
    v_lshl_or_b32 v7, v5, 2, v7
    v_lshrrev_b32 v8, 1, v4
    s_lshl_b32 s90, s32, 1
    v_or_b32 v8, s90, v8
    v_xor_b32 v7, v7, v8
    v_lshl_add_u32 v6, v7, 4, v6
    v_and_b32 v7, 1, v4
    v_lshl_add_u32 v6, v7, 3, v6
    v_add_u32 v125, 81920, v6
    v_add_u32 v126, 40960, v6
    v_add_u32 v127, 122880, v6
    s_lshl_b32 s90, s32, 9
    s_add_u32 s90, s90, 133120
    v_and_b32 v7, 2, v1
    v_cmp_ne_u32 vcc, 0, v7
    v_mov_b32 v6, 0x4444
    v_mov_b32 v8, 0xeeee
    v_cndmask_b32 v17, v6, v8, vcc
    v_lshlrev_b32 v6, 4, v0
    v_add_u32 v16, 122880, v6
    s_mul_i32 s90, s32, 2560
    v_lshl_add_u32 v13, v0, 4, s90
    v_lshl_add_u32 v14, v0, 2, s90
    s_add_u32 s48, s90, 122880
    v_mul_u32_u24 v6, 40, v0
    v_add_u32 v15, s48, v6
    v_mul_u32_u24 v6, 164, v0
    v_min_u32 v6, 10236, v6
    v_add_u32 v25, 122880, v6
    v_lshrrev_b32 v6, 3, v1
    v_lshlrev_b32 v6, 10, v6
    v_and_b32 v7, 7, v1
    v_lshl_add_u32 v6, v7, 7, v6
    v_lshrrev_b32 v7, 1, v1
    v_xor_b32 v7, v7, v2
    v_lshl_add_u32 v11, v7, 4, v6
    v_xor_b32 v12, 64, v11
    s_waitcnt vmcnt(30)
    s_barrier
    ds_read_b64_tr_b16 a[0:1], v125 offset:0
    ds_read_b64_tr_b16 a[2:3], v125 offset:512
    ds_read_b64_tr_b16 a[4:5], v125 offset:4096
    ds_read_b64_tr_b16 a[6:7], v125 offset:4608
    ds_read_b64_tr_b16 a[8:9], v125 offset:8192
    ds_read_b64_tr_b16 a[10:11], v125 offset:8704
    ds_read_b64_tr_b16 a[12:13], v125 offset:12288
    ds_read_b64_tr_b16 a[14:15], v125 offset:12800
    ds_read_b64_tr_b16 a[16:17], v125 offset:16384
    ds_read_b64_tr_b16 a[18:19], v125 offset:16896
    ds_read_b64_tr_b16 a[20:21], v125 offset:20480
    ds_read_b64_tr_b16 a[22:23], v125 offset:20992
    ds_read_b64_tr_b16 a[24:25], v125 offset:24576
    ds_read_b64_tr_b16 a[26:27], v125 offset:25088
    ds_read_b64_tr_b16 a[28:29], v125 offset:28672
    ds_read_b64_tr_b16 a[30:31], v125 offset:29184
    ds_read_b64_tr_b16 a[32:33], v125 offset:32768
    ds_read_b64_tr_b16 a[34:35], v125 offset:33280
    ds_read_b64_tr_b16 a[36:37], v125 offset:36864
    ds_read_b64_tr_b16 a[38:39], v125 offset:37376
    s_waitcnt lgkmcnt(0)
    s_barrier
    s_lshl_b32 s90, s32, 10
    s_add_u32 m0, s90, 81920
    s_mov_b32 s91, 3932288
    buffer_load_dwordx4 v124, s[12:15], s91 offen nt lds
    s_add_u32 m0, m0, 4096
    s_add_u32 s91, s91, 393216
    buffer_load_dwordx4 v124, s[12:15], s91 offen nt lds
    s_add_u32 m0, m0, 4096
    s_add_u32 s91, s91, 393216
    buffer_load_dwordx4 v124, s[12:15], s91 offen nt lds
    s_add_u32 m0, m0, 4096
    s_add_u32 s91, s91, 393216
    buffer_load_dwordx4 v124, s[12:15], s91 offen nt lds
    s_add_u32 m0, m0, 4096
    s_add_u32 s91, s91, 393216
    buffer_load_dwordx4 v124, s[12:15], s91 offen nt lds
    s_add_u32 m0, m0, 4096
    s_add_u32 s91, s91, 393216
    buffer_load_dwordx4 v124, s[12:15], s91 offen nt lds
    s_add_u32 m0, m0, 4096
    s_add_u32 s91, s91, 393216
    buffer_load_dwordx4 v124, s[12:15], s91 offen nt lds
    s_add_u32 m0, m0, 4096
    s_add_u32 s91, s91, 393216
    buffer_load_dwordx4 v124, s[12:15], s91 offen nt lds
    s_add_u32 m0, m0, 4096
    s_add_u32 s91, s91, 393216
    buffer_load_dwordx4 v124, s[12:15], s91 offen nt lds
    s_add_u32 m0, m0, 4096
    s_add_u32 s91, s91, 393216
    buffer_load_dwordx4 v124, s[12:15], s91 offen nt lds
    s_waitcnt vmcnt(30)
    s_barrier
    ds_read_b64_tr_b16 a[80:81], v126 offset:0
    ds_read_b64_tr_b16 a[82:83], v126 offset:512
    ds_read_b64_tr_b16 a[84:85], v126 offset:4096
    ds_read_b64_tr_b16 a[86:87], v126 offset:4608
    ds_read_b64_tr_b16 a[88:89], v126 offset:8192
    ds_read_b64_tr_b16 a[90:91], v126 offset:8704
    ds_read_b64_tr_b16 a[92:93], v126 offset:12288
    ds_read_b64_tr_b16 a[94:95], v126 offset:12800
    ds_read_b64_tr_b16 a[96:97], v126 offset:16384
    ds_read_b64_tr_b16 a[98:99], v126 offset:16896
    ds_read_b64_tr_b16 a[100:101], v126 offset:20480
    ds_read_b64_tr_b16 a[102:103], v126 offset:20992
    ds_read_b64_tr_b16 a[104:105], v126 offset:24576
    ds_read_b64_tr_b16 a[106:107], v126 offset:25088
    ds_read_b64_tr_b16 a[108:109], v126 offset:28672
    ds_read_b64_tr_b16 a[110:111], v126 offset:29184
    ds_read_b64_tr_b16 a[112:113], v126 offset:32768
    ds_read_b64_tr_b16 a[114:115], v126 offset:33280
    ds_read_b64_tr_b16 a[116:117], v126 offset:36864
    ds_read_b64_tr_b16 a[118:119], v126 offset:37376
    s_waitcnt lgkmcnt(0)
    s_barrier
    s_mov_b32 s46, 40960
    s_lshl_b32 s90, s32, 10
    s_add_u32 m0, s90, 40960
    s_nop 0
    buffer_load_dwordx4 v10, s[24:27], s46 offen offset:0 lds
    s_add_u32 m0, m0, 3968
    s_nop 0
    buffer_load_dwordx4 v10, s[24:27], s46 offen offset:128 lds
    s_add_u32 m0, m0, 3968
    s_nop 0
    buffer_load_dwordx4 v10, s[24:27], s46 offen offset:256 lds
    s_add_u32 m0, m0, 3968
    s_nop 0
    buffer_load_dwordx4 v10, s[24:27], s46 offen offset:384 lds
    s_add_u32 m0, m0, 3968
    s_nop 0
    buffer_load_dwordx4 v10, s[24:27], s46 offen offset:512 lds
    s_add_u32 m0, m0, 3968
    s_nop 0
    buffer_load_dwordx4 v10, s[24:27], s46 offen offset:640 lds
    s_add_u32 m0, m0, 3968
    s_nop 0
    buffer_load_dwordx4 v10, s[24:27], s46 offen offset:768 lds
    s_add_u32 m0, m0, 3968
    s_nop 0
    buffer_load_dwordx4 v10, s[24:27], s46 offen offset:896 lds
    s_add_u32 m0, m0, 3968
    s_nop 0
    buffer_load_dwordx4 v10, s[24:27], s46 offen offset:1024 lds
    s_add_u32 m0, m0, 3968
    s_nop 0
    buffer_load_dwordx4 v10, s[24:27], s46 offen offset:1152 lds
    s_waitcnt vmcnt(30)
    s_barrier
    ds_read_b64_tr_b16 a[40:41], v127 offset:0
    ds_read_b64_tr_b16 a[42:43], v127 offset:512
    ds_read_b64_tr_b16 a[44:45], v127 offset:4096
    ds_read_b64_tr_b16 a[46:47], v127 offset:4608
    ds_read_b64_tr_b16 a[48:49], v127 offset:8192
    ds_read_b64_tr_b16 a[50:51], v127 offset:8704
    ds_read_b64_tr_b16 a[52:53], v127 offset:12288
    ds_read_b64_tr_b16 a[54:55], v127 offset:12800
    ds_read_b64_tr_b16 a[56:57], v127 offset:16384
    ds_read_b64_tr_b16 a[58:59], v127 offset:16896
    ds_read_b64_tr_b16 a[60:61], v127 offset:20480
    ds_read_b64_tr_b16 a[62:63], v127 offset:20992
    ds_read_b64_tr_b16 a[64:65], v127 offset:24576
    ds_read_b64_tr_b16 a[66:67], v127 offset:25088
    ds_read_b64_tr_b16 a[68:69], v127 offset:28672
    ds_read_b64_tr_b16 a[70:71], v127 offset:29184
    ds_read_b64_tr_b16 a[72:73], v127 offset:32768
    ds_read_b64_tr_b16 a[74:75], v127 offset:33280
    ds_read_b64_tr_b16 a[76:77], v127 offset:36864
    ds_read_b64_tr_b16 a[78:79], v127 offset:37376
    s_waitcnt lgkmcnt(0)
    s_waitcnt vmcnt(10)
    s_barrier
    ds_read_b64_tr_b16 a[120:121], v125 offset:0
    ds_read_b64_tr_b16 a[122:123], v125 offset:512
    ds_read_b64_tr_b16 a[124:125], v125 offset:4096
    ds_read_b64_tr_b16 a[126:127], v125 offset:4608
    ds_read_b64_tr_b16 a[128:129], v125 offset:8192
    ds_read_b64_tr_b16 a[130:131], v125 offset:8704
    ds_read_b64_tr_b16 a[132:133], v125 offset:12288
    ds_read_b64_tr_b16 a[134:135], v125 offset:12800
    ds_read_b64_tr_b16 a[136:137], v125 offset:16384
    ds_read_b64_tr_b16 a[138:139], v125 offset:16896
    ds_read_b64_tr_b16 a[140:141], v125 offset:20480
    ds_read_b64_tr_b16 a[142:143], v125 offset:20992
    ds_read_b64_tr_b16 a[144:145], v125 offset:24576
    ds_read_b64_tr_b16 a[146:147], v125 offset:25088
    ds_read_b64_tr_b16 a[148:149], v125 offset:28672
    ds_read_b64_tr_b16 a[150:151], v125 offset:29184
    ds_read_b64_tr_b16 a[152:153], v125 offset:32768
    ds_read_b64_tr_b16 a[154:155], v125 offset:33280
    ds_read_b64_tr_b16 a[156:157], v125 offset:36864
    ds_read_b64_tr_b16 a[158:159], v125 offset:37376
    s_waitcnt lgkmcnt(0)
    s_mov_b32 s49, 40960
    s_mov_b32 s47, 40960
    s_mov_b32 s37, -1
    s_add_u32 s44, s38, 65536
    s_add_u32 s45, s44, s56
    s_mov_b32 s46, 40960
    ds_read_b128 v[84:87], v11 offset:0
    ds_read_b128 v[88:91], v11 offset:2048
    ds_read_b128 v[92:95], v12 offset:0
    ds_read_b128 v[96:99], v12 offset:2048
    s_waitcnt lgkmcnt(2)
    v_mfma_f32_16x16x32_bf16 v[108:111], a[0:3], v[84:87], 0
    ds_read_b128 v[100:103], v11 offset:4096
    v_mfma_f32_16x16x32_bf16 v[112:115], a[0:3], v[88:91], 0
    ds_read_b128 v[104:107], v11 offset:6144
    v_mfma_f32_16x16x32_bf16 v[116:119], a[80:83], v[84:87], 0
    v_mfma_f32_16x16x32_bf16 v[120:123], a[80:83], v[88:91], 0
    s_waitcnt lgkmcnt(2)
    v_mfma_f32_16x16x32_bf16 v[108:111], a[4:7], v[92:95], v[108:111]
    ds_read_b128 v[84:87], v12 offset:4096
    v_mfma_f32_16x16x32_bf16 v[112:115], a[4:7], v[96:99], v[112:115]
    ds_read_b128 v[88:91], v12 offset:6144
    v_mfma_f32_16x16x32_bf16 v[116:119], a[84:87], v[92:95], v[116:119]
    v_mfma_f32_16x16x32_bf16 v[120:123], a[84:87], v[96:99], v[120:123]
    s_waitcnt lgkmcnt(2)
    v_mfma_f32_16x16x32_bf16 v[108:111], a[8:11], v[100:103], v[108:111]
    ds_read_b128 v[92:95], v11 offset:8192
    v_mfma_f32_16x16x32_bf16 v[112:115], a[8:11], v[104:107], v[112:115]
    ds_read_b128 v[96:99], v11 offset:10240
    v_mfma_f32_16x16x32_bf16 v[116:119], a[88:91], v[100:103], v[116:119]
    v_mfma_f32_16x16x32_bf16 v[120:123], a[88:91], v[104:107], v[120:123]
    s_waitcnt lgkmcnt(2)
    v_mfma_f32_16x16x32_bf16 v[108:111], a[12:15], v[84:87], v[108:111]
    ds_read_b128 v[100:103], v12 offset:8192
    v_mfma_f32_16x16x32_bf16 v[112:115], a[12:15], v[88:91], v[112:115]
    ds_read_b128 v[104:107], v12 offset:10240
    v_mfma_f32_16x16x32_bf16 v[116:119], a[92:95], v[84:87], v[116:119]
    v_mfma_f32_16x16x32_bf16 v[120:123], a[92:95], v[88:91], v[120:123]
    s_waitcnt lgkmcnt(2)
    v_mfma_f32_16x16x32_bf16 v[108:111], a[16:19], v[92:95], v[108:111]
    ds_read_b128 v[84:87], v11 offset:12288
    v_mfma_f32_16x16x32_bf16 v[112:115], a[16:19], v[96:99], v[112:115]
    ds_read_b128 v[88:91], v11 offset:14336
    v_mfma_f32_16x16x32_bf16 v[116:119], a[96:99], v[92:95], v[116:119]
    v_mfma_f32_16x16x32_bf16 v[120:123], a[96:99], v[96:99], v[120:123]
    s_waitcnt lgkmcnt(2)
    v_mfma_f32_16x16x32_bf16 v[108:111], a[20:23], v[100:103], v[108:111]
    ds_read_b128 v[92:95], v12 offset:12288
    v_mfma_f32_16x16x32_bf16 v[112:115], a[20:23], v[104:107], v[112:115]
    ds_read_b128 v[96:99], v12 offset:14336
    v_mfma_f32_16x16x32_bf16 v[116:119], a[100:103], v[100:103], v[116:119]
    v_mfma_f32_16x16x32_bf16 v[120:123], a[100:103], v[104:107], v[120:123]
    s_waitcnt lgkmcnt(2)
    v_mfma_f32_16x16x32_bf16 v[108:111], a[24:27], v[84:87], v[108:111]
    ds_read_b128 v[100:103], v11 offset:16384
    v_mfma_f32_16x16x32_bf16 v[112:115], a[24:27], v[88:91], v[112:115]
    ds_read_b128 v[104:107], v11 offset:18432
    v_mfma_f32_16x16x32_bf16 v[116:119], a[104:107], v[84:87], v[116:119]
    v_mfma_f32_16x16x32_bf16 v[120:123], a[104:107], v[88:91], v[120:123]
    s_waitcnt lgkmcnt(2)
    v_mfma_f32_16x16x32_bf16 v[108:111], a[28:31], v[92:95], v[108:111]
    ds_read_b128 v[84:87], v12 offset:16384
    v_mfma_f32_16x16x32_bf16 v[112:115], a[28:31], v[96:99], v[112:115]
    ds_read_b128 v[88:91], v12 offset:18432
    v_mfma_f32_16x16x32_bf16 v[116:119], a[108:111], v[92:95], v[116:119]
    v_mfma_f32_16x16x32_bf16 v[120:123], a[108:111], v[96:99], v[120:123]
    s_waitcnt lgkmcnt(2)
    v_mfma_f32_16x16x32_bf16 v[108:111], a[32:35], v[100:103], v[108:111]
    ds_read_b128 v[92:95], v11 offset:20480
    v_mfma_f32_16x16x32_bf16 v[112:115], a[32:35], v[104:107], v[112:115]
    ds_read_b128 v[96:99], v11 offset:22528
    v_mfma_f32_16x16x32_bf16 v[116:119], a[112:115], v[100:103], v[116:119]
    v_mfma_f32_16x16x32_bf16 v[120:123], a[112:115], v[104:107], v[120:123]
    s_waitcnt lgkmcnt(2)
    v_mfma_f32_16x16x32_bf16 v[108:111], a[36:39], v[84:87], v[108:111]
    ds_read_b128 v[100:103], v12 offset:20480
    v_mfma_f32_16x16x32_bf16 v[112:115], a[36:39], v[88:91], v[112:115]
    ds_read_b128 v[104:107], v12 offset:22528
    v_mfma_f32_16x16x32_bf16 v[116:119], a[116:119], v[84:87], v[116:119]
    v_mfma_f32_16x16x32_bf16 v[120:123], a[116:119], v[88:91], v[120:123]
    s_waitcnt lgkmcnt(2)
    v_mfma_f32_16x16x32_bf16 v[108:111], a[40:43], v[92:95], v[108:111]
    ds_read_b128 v[84:87], v11 offset:24576
    v_mfma_f32_16x16x32_bf16 v[112:115], a[40:43], v[96:99], v[112:115]
    ds_read_b128 v[88:91], v11 offset:26624
    v_mfma_f32_16x16x32_bf16 v[116:119], a[120:123], v[92:95], v[116:119]
    v_mfma_f32_16x16x32_bf16 v[120:123], a[120:123], v[96:99], v[120:123]
    s_waitcnt lgkmcnt(2)
    v_mfma_f32_16x16x32_bf16 v[108:111], a[44:47], v[100:103], v[108:111]
    ds_read_b128 v[92:95], v12 offset:24576
    v_mfma_f32_16x16x32_bf16 v[112:115], a[44:47], v[104:107], v[112:115]
    ds_read_b128 v[96:99], v12 offset:26624
    v_mfma_f32_16x16x32_bf16 v[116:119], a[124:127], v[100:103], v[116:119]
    v_mfma_f32_16x16x32_bf16 v[120:123], a[124:127], v[104:107], v[120:123]
    s_waitcnt lgkmcnt(2)
    v_mfma_f32_16x16x32_bf16 v[108:111], a[48:51], v[84:87], v[108:111]
    ds_read_b128 v[100:103], v11 offset:28672
    v_mfma_f32_16x16x32_bf16 v[112:115], a[48:51], v[88:91], v[112:115]
    ds_read_b128 v[104:107], v11 offset:30720
    v_mfma_f32_16x16x32_bf16 v[116:119], a[128:131], v[84:87], v[116:119]
    v_mfma_f32_16x16x32_bf16 v[120:123], a[128:131], v[88:91], v[120:123]
    s_waitcnt lgkmcnt(2)
    v_mfma_f32_16x16x32_bf16 v[108:111], a[52:55], v[92:95], v[108:111]
    ds_read_b128 v[84:87], v12 offset:28672
    v_mfma_f32_16x16x32_bf16 v[112:115], a[52:55], v[96:99], v[112:115]
    ds_read_b128 v[88:91], v12 offset:30720
    v_mfma_f32_16x16x32_bf16 v[116:119], a[132:135], v[92:95], v[116:119]
    v_mfma_f32_16x16x32_bf16 v[120:123], a[132:135], v[96:99], v[120:123]
    s_waitcnt lgkmcnt(2)
    v_mfma_f32_16x16x32_bf16 v[108:111], a[56:59], v[100:103], v[108:111]
    ds_read_b128 v[92:95], v11 offset:32768
    v_mfma_f32_16x16x32_bf16 v[112:115], a[56:59], v[104:107], v[112:115]
    ds_read_b128 v[96:99], v11 offset:34816
    v_mfma_f32_16x16x32_bf16 v[116:119], a[136:139], v[100:103], v[116:119]
    v_mfma_f32_16x16x32_bf16 v[120:123], a[136:139], v[104:107], v[120:123]
    s_waitcnt lgkmcnt(2)
    v_mfma_f32_16x16x32_bf16 v[108:111], a[60:63], v[84:87], v[108:111]
    ds_read_b128 v[100:103], v12 offset:32768
    v_mfma_f32_16x16x32_bf16 v[112:115], a[60:63], v[88:91], v[112:115]
    ds_read_b128 v[104:107], v12 offset:34816
    v_mfma_f32_16x16x32_bf16 v[116:119], a[140:143], v[84:87], v[116:119]
    v_mfma_f32_16x16x32_bf16 v[120:123], a[140:143], v[88:91], v[120:123]
    s_waitcnt lgkmcnt(2)
    v_mfma_f32_16x16x32_bf16 v[108:111], a[64:67], v[92:95], v[108:111]
    ds_read_b128 v[84:87], v11 offset:36864
    v_mfma_f32_16x16x32_bf16 v[112:115], a[64:67], v[96:99], v[112:115]
    ds_read_b128 v[88:91], v11 offset:38912
    v_mfma_f32_16x16x32_bf16 v[116:119], a[144:147], v[92:95], v[116:119]
    v_mfma_f32_16x16x32_bf16 v[120:123], a[144:147], v[96:99], v[120:123]
    s_waitcnt lgkmcnt(2)
    v_mfma_f32_16x16x32_bf16 v[108:111], a[68:71], v[100:103], v[108:111]
    ds_read_b128 v[92:95], v12 offset:36864
    v_mfma_f32_16x16x32_bf16 v[112:115], a[68:71], v[104:107], v[112:115]
    ds_read_b128 v[96:99], v12 offset:38912
    v_mfma_f32_16x16x32_bf16 v[116:119], a[148:151], v[100:103], v[116:119]
    v_mfma_f32_16x16x32_bf16 v[120:123], a[148:151], v[104:107], v[120:123]
    s_waitcnt lgkmcnt(0)
    v_mfma_f32_16x16x32_bf16 v[108:111], a[72:75], v[84:87], v[108:111]
    v_add_u32 v11, s49, v11
    v_mfma_f32_16x16x32_bf16 v[112:115], a[72:75], v[88:91], v[112:115]
    v_add_u32 v12, s49, v12
    v_mfma_f32_16x16x32_bf16 v[108:111], a[76:79], v[92:95], v[108:111]
    s_sub_u32 s47, s47, s49
    v_mfma_f32_16x16x32_bf16 v[112:115], a[76:79], v[96:99], v[112:115]
    s_sub_u32 s49, 0, s49
    v_mfma_f32_16x16x32_bf16 v[116:119], a[152:155], v[84:87], v[116:119]
    v_mfma_f32_16x16x32_bf16 v[120:123], a[152:155], v[88:91], v[120:123]
    v_mfma_f32_16x16x32_bf16 v[116:119], a[156:159], v[92:95], v[116:119]
    v_mfma_f32_16x16x32_bf16 v[120:123], a[156:159], v[96:99], v[120:123]
    v_cvt_pk_bf16_f32 v124, v108, v109
    v_cvt_pk_bf16_f32 v125, v110, v111
    v_cvt_pk_bf16_f32 v126, v112, v113
    v_cvt_pk_bf16_f32 v127, v114, v115
    s_nop 0
    v_permlane16_swap_b32 v124, v126
    v_permlane16_swap_b32 v125, v127
    v_cvt_pk_bf16_f32 v128, v116, v117
    v_cvt_pk_bf16_f32 v129, v118, v119
    v_cvt_pk_bf16_f32 v130, v120, v121
    v_cvt_pk_bf16_f32 v131, v122, v123
    s_nop 0
    v_permlane16_swap_b32 v128, v130
    v_permlane16_swap_b32 v129, v131
    buffer_store_dwordx4 v[124:127], v19, s[4:7], s44 offen
    buffer_store_dwordx4 v[128:131], v19, s[4:7], s45 offen
    v_mov_b32 v1, 192
L_gw_15:
    buffer_load_dword v2, v1, s[8:11], 0 offen sc1
    s_sub_u32 s36, s36, 1
    s_cbranch_scc1 L_exit
    s_waitcnt vmcnt(0)
    v_readfirstlane_b32 s90, v2
    s_nop 0
    s_cmp_eq_u32 s90, 0
    s_cbranch_scc1 L_gw_15
    s_cmp_lg_u32 s90, 1
    s_cbranch_scc1 L_slow
    s_waitcnt vmcnt(0) lgkmcnt(0)
    v_mov_b32 v20, 1
    buffer_store_dword v20, v136, s[4:7], s38 offen
    s_barrier
    s_add_u32 s44, s38, 180224
    s_add_u32 s45, s44, s56
    s_mov_b32 s46, 81920
    ds_read_b128 v[84:87], v11 offset:0
    ds_read_b128 v[88:91], v11 offset:2048
    ds_read_b128 v[92:95], v12 offset:0
    ds_read_b128 v[96:99], v12 offset:2048
    s_lshl_b32 s90, s32, 10
    s_add_u32 m0, s90, s47
    s_waitcnt lgkmcnt(2)
    v_mfma_f32_16x16x32_bf16 v[108:111], a[0:3], v[84:87], 0
    ds_read_b128 v[100:103], v11 offset:4096
    v_mfma_f32_16x16x32_bf16 v[112:115], a[0:3], v[88:91], 0
    ds_read_b128 v[104:107], v11 offset:6144
    v_mfma_f32_16x16x32_bf16 v[116:119], a[80:83], v[84:87], 0
    buffer_load_dwordx4 v10, s[24:27], s46 offen offset:0 lds
    s_add_u32 m0, m0, 3968
    v_mfma_f32_16x16x32_bf16 v[120:123], a[80:83], v[88:91], 0
    s_waitcnt lgkmcnt(2)
    v_mfma_f32_16x16x32_bf16 v[108:111], a[4:7], v[92:95], v[108:111]
    ds_read_b128 v[84:87], v12 offset:4096
    v_mfma_f32_16x16x32_bf16 v[112:115], a[4:7], v[96:99], v[112:115]
    ds_read_b128 v[88:91], v12 offset:6144
    v_mfma_f32_16x16x32_bf16 v[116:119], a[84:87], v[92:95], v[116:119]
    buffer_load_dwordx4 v10, s[24:27], s46 offen offset:128 lds
    s_add_u32 m0, m0, 3968
    v_mfma_f32_16x16x32_bf16 v[120:123], a[84:87], v[96:99], v[120:123]
    s_waitcnt lgkmcnt(2)
    v_mfma_f32_16x16x32_bf16 v[108:111], a[8:11], v[100:103], v[108:111]
    ds_read_b128 v[92:95], v11 offset:8192
    v_mfma_f32_16x16x32_bf16 v[112:115], a[8:11], v[104:107], v[112:115]
    ds_read_b128 v[96:99], v11 offset:10240
    v_mfma_f32_16x16x32_bf16 v[116:119], a[88:91], v[100:103], v[116:119]
    buffer_load_dwordx4 v10, s[24:27], s46 offen offset:256 lds
    s_add_u32 m0, m0, 3968
    v_mfma_f32_16x16x32_bf16 v[120:123], a[88:91], v[104:107], v[120:123]
    s_waitcnt lgkmcnt(2)
    v_mfma_f32_16x16x32_bf16 v[108:111], a[12:15], v[84:87], v[108:111]
    ds_read_b128 v[100:103], v12 offset:8192
    v_mfma_f32_16x16x32_bf16 v[112:115], a[12:15], v[88:91], v[112:115]
    ds_read_b128 v[104:107], v12 offset:10240
    v_mfma_f32_16x16x32_bf16 v[116:119], a[92:95], v[84:87], v[116:119]
    buffer_load_dwordx4 v10, s[24:27], s46 offen offset:384 lds
    s_add_u32 m0, m0, 3968
    v_mfma_f32_16x16x32_bf16 v[120:123], a[92:95], v[88:91], v[120:123]
    s_waitcnt lgkmcnt(2)
    v_mfma_f32_16x16x32_bf16 v[108:111], a[16:19], v[92:95], v[108:111]
    ds_read_b128 v[84:87], v11 offset:12288
    v_mfma_f32_16x16x32_bf16 v[112:115], a[16:19], v[96:99], v[112:115]
    ds_read_b128 v[88:91], v11 offset:14336
    v_mfma_f32_16x16x32_bf16 v[116:119], a[96:99], v[92:95], v[116:119]
    buffer_load_dwordx4 v10, s[24:27], s46 offen offset:512 lds
    s_add_u32 m0, m0, 3968
    v_mfma_f32_16x16x32_bf16 v[120:123], a[96:99], v[96:99], v[120:123]
    s_waitcnt lgkmcnt(2)
    v_mfma_f32_16x16x32_bf16 v[108:111], a[20:23], v[100:103], v[108:111]
    ds_read_b128 v[92:95], v12 offset:12288
    v_mfma_f32_16x16x32_bf16 v[112:115], a[20:23], v[104:107], v[112:115]
    ds_read_b128 v[96:99], v12 offset:14336
    v_mfma_f32_16x16x32_bf16 v[116:119], a[100:103], v[100:103], v[116:119]
    buffer_load_dwordx4 v10, s[24:27], s46 offen offset:640 lds
    s_add_u32 m0, m0, 3968
    v_mfma_f32_16x16x32_bf16 v[120:123], a[100:103], v[104:107], v[120:123]
    s_waitcnt lgkmcnt(2)
    v_mfma_f32_16x16x32_bf16 v[108:111], a[24:27], v[84:87], v[108:111]
    ds_read_b128 v[100:103], v11 offset:16384
    v_mfma_f32_16x16x32_bf16 v[112:115], a[24:27], v[88:91], v[112:115]
    ds_read_b128 v[104:107], v11 offset:18432
    v_mfma_f32_16x16x32_bf16 v[116:119], a[104:107], v[84:87], v[116:119]
    buffer_load_dwordx4 v10, s[24:27], s46 offen offset:768 lds
    s_add_u32 m0, m0, 3968
    v_mfma_f32_16x16x32_bf16 v[120:123], a[104:107], v[88:91], v[120:123]
    s_waitcnt lgkmcnt(2)
    v_mfma_f32_16x16x32_bf16 v[108:111], a[28:31], v[92:95], v[108:111]
    ds_read_b128 v[84:87], v12 offset:16384
    v_mfma_f32_16x16x32_bf16 v[112:115], a[28:31], v[96:99], v[112:115]
    ds_read_b128 v[88:91], v12 offset:18432
    v_mfma_f32_16x16x32_bf16 v[116:119], a[108:111], v[92:95], v[116:119]
    buffer_load_dwordx4 v10, s[24:27], s46 offen offset:896 lds
    s_add_u32 m0, m0, 3968
    v_mfma_f32_16x16x32_bf16 v[120:123], a[108:111], v[96:99], v[120:123]
    s_waitcnt lgkmcnt(2)
    v_mfma_f32_16x16x32_bf16 v[108:111], a[32:35], v[100:103], v[108:111]
    ds_read_b128 v[92:95], v11 offset:20480
    v_mfma_f32_16x16x32_bf16 v[112:115], a[32:35], v[104:107], v[112:115]
    ds_read_b128 v[96:99], v11 offset:22528
    v_mfma_f32_16x16x32_bf16 v[116:119], a[112:115], v[100:103], v[116:119]
    buffer_load_dwordx4 v10, s[24:27], s46 offen offset:1024 lds
    s_add_u32 m0, m0, 3968
    v_mfma_f32_16x16x32_bf16 v[120:123], a[112:115], v[104:107], v[120:123]
    s_waitcnt lgkmcnt(2)
    v_mfma_f32_16x16x32_bf16 v[108:111], a[36:39], v[84:87], v[108:111]
    ds_read_b128 v[100:103], v12 offset:20480
    v_mfma_f32_16x16x32_bf16 v[112:115], a[36:39], v[88:91], v[112:115]
    ds_read_b128 v[104:107], v12 offset:22528
    v_mfma_f32_16x16x32_bf16 v[116:119], a[116:119], v[84:87], v[116:119]
    buffer_load_dwordx4 v10, s[24:27], s46 offen offset:1152 lds
    v_mfma_f32_16x16x32_bf16 v[120:123], a[116:119], v[88:91], v[120:123]
    s_waitcnt lgkmcnt(2)
    v_mfma_f32_16x16x32_bf16 v[108:111], a[40:43], v[92:95], v[108:111]
    ds_read_b128 v[84:87], v11 offset:24576
    v_mfma_f32_16x16x32_bf16 v[112:115], a[40:43], v[96:99], v[112:115]
    ds_read_b128 v[88:91], v11 offset:26624
    v_mfma_f32_16x16x32_bf16 v[116:119], a[120:123], v[92:95], v[116:119]
    v_mfma_f32_16x16x32_bf16 v[120:123], a[120:123], v[96:99], v[120:123]
    s_waitcnt lgkmcnt(2)
    v_mfma_f32_16x16x32_bf16 v[108:111], a[44:47], v[100:103], v[108:111]
    ds_read_b128 v[92:95], v12 offset:24576
    v_mfma_f32_16x16x32_bf16 v[112:115], a[44:47], v[104:107], v[112:115]
    ds_read_b128 v[96:99], v12 offset:26624
    v_mfma_f32_16x16x32_bf16 v[116:119], a[124:127], v[100:103], v[116:119]
    v_mfma_f32_16x16x32_bf16 v[120:123], a[124:127], v[104:107], v[120:123]
    s_waitcnt lgkmcnt(2)
    v_mfma_f32_16x16x32_bf16 v[108:111], a[48:51], v[84:87], v[108:111]
    ds_read_b128 v[100:103], v11 offset:28672
    v_mfma_f32_16x16x32_bf16 v[112:115], a[48:51], v[88:91], v[112:115]
    ds_read_b128 v[104:107], v11 offset:30720
    v_mfma_f32_16x16x32_bf16 v[116:119], a[128:131], v[84:87], v[116:119]
    v_mfma_f32_16x16x32_bf16 v[120:123], a[128:131], v[88:91], v[120:123]
    s_waitcnt lgkmcnt(2)
    v_mfma_f32_16x16x32_bf16 v[108:111], a[52:55], v[92:95], v[108:111]
    ds_read_b128 v[84:87], v12 offset:28672
    v_mfma_f32_16x16x32_bf16 v[112:115], a[52:55], v[96:99], v[112:115]
    ds_read_b128 v[88:91], v12 offset:30720
    v_mfma_f32_16x16x32_bf16 v[116:119], a[132:135], v[92:95], v[116:119]
    v_mfma_f32_16x16x32_bf16 v[120:123], a[132:135], v[96:99], v[120:123]
    s_waitcnt lgkmcnt(2)
    v_mfma_f32_16x16x32_bf16 v[108:111], a[56:59], v[100:103], v[108:111]
    ds_read_b128 v[92:95], v11 offset:32768
    v_mfma_f32_16x16x32_bf16 v[112:115], a[56:59], v[104:107], v[112:115]
    ds_read_b128 v[96:99], v11 offset:34816
    v_mfma_f32_16x16x32_bf16 v[116:119], a[136:139], v[100:103], v[116:119]
    v_mfma_f32_16x16x32_bf16 v[120:123], a[136:139], v[104:107], v[120:123]
    s_waitcnt lgkmcnt(2)
    v_mfma_f32_16x16x32_bf16 v[108:111], a[60:63], v[84:87], v[108:111]
    ds_read_b128 v[100:103], v12 offset:32768
    v_mfma_f32_16x16x32_bf16 v[112:115], a[60:63], v[88:91], v[112:115]
    ds_read_b128 v[104:107], v12 offset:34816
    v_mfma_f32_16x16x32_bf16 v[116:119], a[140:143], v[84:87], v[116:119]
    v_mfma_f32_16x16x32_bf16 v[120:123], a[140:143], v[88:91], v[120:123]
    s_waitcnt lgkmcnt(2)
    v_mfma_f32_16x16x32_bf16 v[108:111], a[64:67], v[92:95], v[108:111]
    ds_read_b128 v[84:87], v11 offset:36864
    v_mfma_f32_16x16x32_bf16 v[112:115], a[64:67], v[96:99], v[112:115]
    ds_read_b128 v[88:91], v11 offset:38912
    v_mfma_f32_16x16x32_bf16 v[116:119], a[144:147], v[92:95], v[116:119]
    v_mfma_f32_16x16x32_bf16 v[120:123], a[144:147], v[96:99], v[120:123]
    s_waitcnt lgkmcnt(2)
    v_mfma_f32_16x16x32_bf16 v[108:111], a[68:71], v[100:103], v[108:111]
    ds_read_b128 v[92:95], v12 offset:36864
    v_mfma_f32_16x16x32_bf16 v[112:115], a[68:71], v[104:107], v[112:115]
    ds_read_b128 v[96:99], v12 offset:38912
    v_mfma_f32_16x16x32_bf16 v[116:119], a[148:151], v[100:103], v[116:119]
    v_mfma_f32_16x16x32_bf16 v[120:123], a[148:151], v[104:107], v[120:123]
    s_waitcnt lgkmcnt(0)
    v_mfma_f32_16x16x32_bf16 v[108:111], a[72:75], v[84:87], v[108:111]
    v_add_u32 v11, s49, v11
    v_mfma_f32_16x16x32_bf16 v[112:115], a[72:75], v[88:91], v[112:115]
    v_add_u32 v12, s49, v12
    v_mfma_f32_16x16x32_bf16 v[108:111], a[76:79], v[92:95], v[108:111]
    s_sub_u32 s47, s47, s49
    v_mfma_f32_16x16x32_bf16 v[112:115], a[76:79], v[96:99], v[112:115]
    s_sub_u32 s49, 0, s49
    v_mfma_f32_16x16x32_bf16 v[116:119], a[152:155], v[84:87], v[116:119]
    v_mfma_f32_16x16x32_bf16 v[120:123], a[152:155], v[88:91], v[120:123]
    v_mfma_f32_16x16x32_bf16 v[116:119], a[156:159], v[92:95], v[116:119]
    v_mfma_f32_16x16x32_bf16 v[120:123], a[156:159], v[96:99], v[120:123]
    v_cvt_pk_bf16_f32 v124, v108, v109
    v_cvt_pk_bf16_f32 v125, v110, v111
    v_cvt_pk_bf16_f32 v126, v112, v113
    v_cvt_pk_bf16_f32 v127, v114, v115
    s_nop 0
    v_permlane16_swap_b32 v124, v126
    v_permlane16_swap_b32 v125, v127
    v_cvt_pk_bf16_f32 v128, v116, v117
    v_cvt_pk_bf16_f32 v129, v118, v119
    v_cvt_pk_bf16_f32 v130, v120, v121
    v_cvt_pk_bf16_f32 v131, v122, v123
    s_nop 0
    v_permlane16_swap_b32 v128, v130
    v_permlane16_swap_b32 v129, v131
    buffer_store_dwordx4 v[124:127], v19, s[4:7], s44 offen
    buffer_store_dwordx4 v[128:131], v19, s[4:7], s45 offen
    s_waitcnt vmcnt(0) lgkmcnt(0)
    v_mov_b32 v20, 2
    buffer_store_dword v20, v136, s[4:7], s38 offen
    s_barrier
    s_add_u32 s44, s38, 294912
    s_add_u32 s45, s44, s56
    s_mov_b32 s46, 122880
    ds_read_b128 v[84:87], v11 offset:0
    ds_read_b128 v[88:91], v11 offset:2048
    ds_read_b128 v[92:95], v12 offset:0
    ds_read_b128 v[96:99], v12 offset:2048
    s_lshl_b32 s90, s32, 10
    s_add_u32 m0, s90, s47
    s_waitcnt lgkmcnt(2)
    v_mfma_f32_16x16x32_bf16 v[108:111], a[0:3], v[84:87], 0
    ds_read_b128 v[100:103], v11 offset:4096
    s_add_u32 s51, s37, 3
    v_mfma_f32_16x16x32_bf16 v[112:115], a[0:3], v[88:91], 0
    ds_read_b128 v[104:107], v11 offset:6144
    s_and_b32 s50, s51, 3
    v_mfma_f32_16x16x32_bf16 v[116:119], a[80:83], v[84:87], 0
    buffer_load_dwordx4 v10, s[24:27], s46 offen offset:0 lds
    s_add_u32 m0, m0, 3968
    v_mfma_f32_16x16x32_bf16 v[120:123], a[80:83], v[88:91], 0
    s_waitcnt lgkmcnt(2)
    s_mul_i32 s50, s50, 114688
    v_mfma_f32_16x16x32_bf16 v[108:111], a[4:7], v[92:95], v[108:111]
    ds_read_b128 v[84:87], v12 offset:4096
    s_add_u32 s50, s50, 65536
    v_mfma_f32_16x16x32_bf16 v[112:115], a[4:7], v[96:99], v[112:115]
    ds_read_b128 v[88:91], v12 offset:6144
    s_add_u32 s44, s38, s50
    v_mfma_f32_16x16x32_bf16 v[116:119], a[84:87], v[92:95], v[116:119]
    buffer_load_dwordx4 v10, s[24:27], s46 offen offset:128 lds
    s_add_u32 m0, m0, 3968
    v_mfma_f32_16x16x32_bf16 v[120:123], a[84:87], v[96:99], v[120:123]
    s_waitcnt lgkmcnt(2)
    s_add_u32 s45, s44, s56
    v_mfma_f32_16x16x32_bf16 v[108:111], a[8:11], v[100:103], v[108:111]
    ds_read_b128 v[92:95], v11 offset:8192
    s_add_u32 s37, s37, 1
    v_mfma_f32_16x16x32_bf16 v[112:115], a[8:11], v[104:107], v[112:115]
    ds_read_b128 v[96:99], v11 offset:10240
    s_mov_b32 s52, 0
    v_mfma_f32_16x16x32_bf16 v[116:119], a[88:91], v[100:103], v[116:119]
    buffer_load_dwordx4 v10, s[24:27], s46 offen offset:256 lds
    s_add_u32 m0, m0, 3968
    v_mfma_f32_16x16x32_bf16 v[120:123], a[88:91], v[104:107], v[120:123]
    s_waitcnt lgkmcnt(2)
    s_and_b32 s50, s37, 3
    v_mfma_f32_16x16x32_bf16 v[108:111], a[12:15], v[84:87], v[108:111]
    ds_read_b128 v[100:103], v12 offset:8192
    s_mul_i32 s51, s50, 114688
    v_mfma_f32_16x16x32_bf16 v[112:115], a[12:15], v[88:91], v[112:115]
    ds_read_b128 v[104:107], v12 offset:10240
    s_add_u32 s41, s38, s51
    v_mfma_f32_16x16x32_bf16 v[116:119], a[92:95], v[84:87], v[116:119]
    buffer_load_dwordx4 v10, s[24:27], s46 offen offset:384 lds
    s_add_u32 m0, m0, 3968
    v_mfma_f32_16x16x32_bf16 v[120:123], a[92:95], v[88:91], v[120:123]
    s_waitcnt lgkmcnt(2)
    v_mfma_f32_16x16x32_bf16 v[108:111], a[16:19], v[92:95], v[108:111]
    ds_read_b128 v[84:87], v11 offset:12288
    v_mfma_f32_16x16x32_bf16 v[112:115], a[16:19], v[96:99], v[112:115]
    ds_read_b128 v[88:91], v11 offset:14336
    v_mfma_f32_16x16x32_bf16 v[116:119], a[96:99], v[92:95], v[116:119]
    buffer_load_dwordx4 v10, s[24:27], s46 offen offset:512 lds
    s_add_u32 m0, m0, 3968
    v_mfma_f32_16x16x32_bf16 v[120:123], a[96:99], v[96:99], v[120:123]
    s_waitcnt lgkmcnt(2)
    v_mfma_f32_16x16x32_bf16 v[108:111], a[20:23], v[100:103], v[108:111]
    ds_read_b128 v[92:95], v12 offset:12288
    v_mfma_f32_16x16x32_bf16 v[112:115], a[20:23], v[104:107], v[112:115]
    ds_read_b128 v[96:99], v12 offset:14336
    v_mfma_f32_16x16x32_bf16 v[116:119], a[100:103], v[100:103], v[116:119]
    buffer_load_dwordx4 v10, s[24:27], s46 offen offset:640 lds
    s_add_u32 m0, m0, 3968
    v_mfma_f32_16x16x32_bf16 v[120:123], a[100:103], v[104:107], v[120:123]
    s_waitcnt lgkmcnt(2)
    v_mfma_f32_16x16x32_bf16 v[108:111], a[24:27], v[84:87], v[108:111]
    ds_read_b128 v[100:103], v11 offset:16384
    v_mfma_f32_16x16x32_bf16 v[112:115], a[24:27], v[88:91], v[112:115]
    ds_read_b128 v[104:107], v11 offset:18432
    v_mfma_f32_16x16x32_bf16 v[116:119], a[104:107], v[84:87], v[116:119]
    buffer_load_dwordx4 v10, s[24:27], s46 offen offset:768 lds
    s_add_u32 m0, m0, 3968
    v_mfma_f32_16x16x32_bf16 v[120:123], a[104:107], v[88:91], v[120:123]
    s_waitcnt lgkmcnt(2)
    v_mfma_f32_16x16x32_bf16 v[108:111], a[28:31], v[92:95], v[108:111]
    ds_read_b128 v[84:87], v12 offset:16384
    v_mfma_f32_16x16x32_bf16 v[112:115], a[28:31], v[96:99], v[112:115]
    ds_read_b128 v[88:91], v12 offset:18432
    v_mfma_f32_16x16x32_bf16 v[116:119], a[108:111], v[92:95], v[116:119]
    buffer_load_dwordx4 v10, s[24:27], s46 offen offset:896 lds
    s_add_u32 m0, m0, 3968
    v_mfma_f32_16x16x32_bf16 v[120:123], a[108:111], v[96:99], v[120:123]
    s_waitcnt lgkmcnt(2)
    v_mfma_f32_16x16x32_bf16 v[108:111], a[32:35], v[100:103], v[108:111]
    ds_read_b128 v[92:95], v11 offset:20480
    v_mfma_f32_16x16x32_bf16 v[112:115], a[32:35], v[104:107], v[112:115]
    ds_read_b128 v[96:99], v11 offset:22528
    v_mfma_f32_16x16x32_bf16 v[116:119], a[112:115], v[100:103], v[116:119]
    buffer_load_dwordx4 v10, s[24:27], s46 offen offset:1024 lds
    s_add_u32 m0, m0, 3968
    v_mfma_f32_16x16x32_bf16 v[120:123], a[112:115], v[104:107], v[120:123]
    s_waitcnt lgkmcnt(2)
    v_mfma_f32_16x16x32_bf16 v[108:111], a[36:39], v[84:87], v[108:111]
    ds_read_b128 v[100:103], v12 offset:20480
    v_mfma_f32_16x16x32_bf16 v[112:115], a[36:39], v[88:91], v[112:115]
    ds_read_b128 v[104:107], v12 offset:22528
    v_mfma_f32_16x16x32_bf16 v[116:119], a[116:119], v[84:87], v[116:119]
    buffer_load_dwordx4 v10, s[24:27], s46 offen offset:1152 lds
    v_mfma_f32_16x16x32_bf16 v[120:123], a[116:119], v[88:91], v[120:123]
    s_waitcnt lgkmcnt(2)
    v_mfma_f32_16x16x32_bf16 v[108:111], a[40:43], v[92:95], v[108:111]
    ds_read_b128 v[84:87], v11 offset:24576
    v_mfma_f32_16x16x32_bf16 v[112:115], a[40:43], v[96:99], v[112:115]
    ds_read_b128 v[88:91], v11 offset:26624
    v_mfma_f32_16x16x32_bf16 v[116:119], a[120:123], v[92:95], v[116:119]
    v_mfma_f32_16x16x32_bf16 v[120:123], a[120:123], v[96:99], v[120:123]
    s_waitcnt lgkmcnt(2)
    v_mfma_f32_16x16x32_bf16 v[108:111], a[44:47], v[100:103], v[108:111]
    ds_read_b128 v[92:95], v12 offset:24576
    v_mfma_f32_16x16x32_bf16 v[112:115], a[44:47], v[104:107], v[112:115]
    ds_read_b128 v[96:99], v12 offset:26624
    v_mfma_f32_16x16x32_bf16 v[116:119], a[124:127], v[100:103], v[116:119]
    v_mfma_f32_16x16x32_bf16 v[120:123], a[124:127], v[104:107], v[120:123]
    s_waitcnt lgkmcnt(2)
    v_mfma_f32_16x16x32_bf16 v[108:111], a[48:51], v[84:87], v[108:111]
    ds_read_b128 v[100:103], v11 offset:28672
    v_mfma_f32_16x16x32_bf16 v[112:115], a[48:51], v[88:91], v[112:115]
    ds_read_b128 v[104:107], v11 offset:30720
    v_mfma_f32_16x16x32_bf16 v[116:119], a[128:131], v[84:87], v[116:119]
    v_mfma_f32_16x16x32_bf16 v[120:123], a[128:131], v[88:91], v[120:123]
    s_waitcnt lgkmcnt(2)
    v_mfma_f32_16x16x32_bf16 v[108:111], a[52:55], v[92:95], v[108:111]
    ds_read_b128 v[84:87], v12 offset:28672
    v_mfma_f32_16x16x32_bf16 v[112:115], a[52:55], v[96:99], v[112:115]
    ds_read_b128 v[88:91], v12 offset:30720
    v_mfma_f32_16x16x32_bf16 v[116:119], a[132:135], v[92:95], v[116:119]
    v_mfma_f32_16x16x32_bf16 v[120:123], a[132:135], v[96:99], v[120:123]
    s_waitcnt lgkmcnt(2)
    v_mfma_f32_16x16x32_bf16 v[108:111], a[56:59], v[100:103], v[108:111]
    ds_read_b128 v[92:95], v11 offset:32768
    v_mfma_f32_16x16x32_bf16 v[112:115], a[56:59], v[104:107], v[112:115]
    ds_read_b128 v[96:99], v11 offset:34816
    v_mfma_f32_16x16x32_bf16 v[116:119], a[136:139], v[100:103], v[116:119]
    v_mfma_f32_16x16x32_bf16 v[120:123], a[136:139], v[104:107], v[120:123]
    s_waitcnt lgkmcnt(2)
    v_mfma_f32_16x16x32_bf16 v[108:111], a[60:63], v[84:87], v[108:111]
    ds_read_b128 v[100:103], v12 offset:32768
    v_mfma_f32_16x16x32_bf16 v[112:115], a[60:63], v[88:91], v[112:115]
    ds_read_b128 v[104:107], v12 offset:34816
    v_mfma_f32_16x16x32_bf16 v[116:119], a[140:143], v[84:87], v[116:119]
    v_mfma_f32_16x16x32_bf16 v[120:123], a[140:143], v[88:91], v[120:123]
    s_waitcnt lgkmcnt(2)
    v_mfma_f32_16x16x32_bf16 v[108:111], a[64:67], v[92:95], v[108:111]
    ds_read_b128 v[84:87], v11 offset:36864
    v_mfma_f32_16x16x32_bf16 v[112:115], a[64:67], v[96:99], v[112:115]
    ds_read_b128 v[88:91], v11 offset:38912
    v_mfma_f32_16x16x32_bf16 v[116:119], a[144:147], v[92:95], v[116:119]
    v_mfma_f32_16x16x32_bf16 v[120:123], a[144:147], v[96:99], v[120:123]
    s_waitcnt lgkmcnt(2)
    v_mfma_f32_16x16x32_bf16 v[108:111], a[68:71], v[100:103], v[108:111]
    ds_read_b128 v[92:95], v12 offset:36864
    v_mfma_f32_16x16x32_bf16 v[112:115], a[68:71], v[104:107], v[112:115]
    ds_read_b128 v[96:99], v12 offset:38912
    v_mfma_f32_16x16x32_bf16 v[116:119], a[148:151], v[100:103], v[116:119]
    v_mfma_f32_16x16x32_bf16 v[120:123], a[148:151], v[104:107], v[120:123]
    s_waitcnt lgkmcnt(0)
    v_mfma_f32_16x16x32_bf16 v[108:111], a[72:75], v[84:87], v[108:111]
    v_add_u32 v11, s49, v11
    v_mfma_f32_16x16x32_bf16 v[112:115], a[72:75], v[88:91], v[112:115]
    v_add_u32 v12, s49, v12
    v_mfma_f32_16x16x32_bf16 v[108:111], a[76:79], v[92:95], v[108:111]
    s_sub_u32 s47, s47, s49
    v_mfma_f32_16x16x32_bf16 v[112:115], a[76:79], v[96:99], v[112:115]
    s_sub_u32 s49, 0, s49
    v_mfma_f32_16x16x32_bf16 v[116:119], a[152:155], v[84:87], v[116:119]
    v_mfma_f32_16x16x32_bf16 v[120:123], a[152:155], v[88:91], v[120:123]
    v_mfma_f32_16x16x32_bf16 v[116:119], a[156:159], v[92:95], v[116:119]
    v_mfma_f32_16x16x32_bf16 v[120:123], a[156:159], v[96:99], v[120:123]
    v_cvt_pk_bf16_f32 v124, v108, v109
    v_cvt_pk_bf16_f32 v125, v110, v111
    v_cvt_pk_bf16_f32 v126, v112, v113
    v_cvt_pk_bf16_f32 v127, v114, v115
    s_nop 0
    v_permlane16_swap_b32 v124, v126
    v_permlane16_swap_b32 v125, v127
    v_cvt_pk_bf16_f32 v128, v116, v117
    v_cvt_pk_bf16_f32 v129, v118, v119
    v_cvt_pk_bf16_f32 v130, v120, v121
    v_cvt_pk_bf16_f32 v131, v122, v123
    s_nop 0
    v_permlane16_swap_b32 v128, v130
    v_permlane16_swap_b32 v129, v131
    buffer_store_dwordx4 v[124:127], v19, s[4:7], s44 offen
    buffer_store_dwordx4 v[128:131], v19, s[4:7], s45 offen
    v_mov_b32 v3, 200
L_p0_16:
    buffer_load_dword v4, v3, s[8:11], 0 offen sc1
    s_sub_u32 s36, s36, 1
    s_cbranch_scc1 L_exit
    s_waitcnt vmcnt(0)
    v_readfirstlane_b32 s90, v4
    s_nop 0
    s_cmp_eq_u32 s90, 0
    s_cbranch_scc1 L_p0_16
    s_and_b32 s90, s90, 2
    s_lshl_b32 s90, s90, 12
    v_and_b32 v3, 1, v0
    v_lshlrev_b32 v3, 12, v3
    v_bfe_u32 v5, v0, 2, 1
    v_lshl_add_u32 v3, v5, 13, v3
    v_bfe_u32 v4, v0, 1, 1
    v_lshl_add_u32 v3, v4, 14, v3
    v_xor_b32 v3, s90, v3
    s_lshl_b32 s91, s34, 9
    s_add_u32 s91, s91, 1933312
    s_xor_b32 s55, s32, 3
    s_or_b32 s55, s55, s40
    s_cselect_b32 s91, 2146435072, s91
    v_add_u32 v140, s91, v3
    v_cmp_gt_u32 vcc, 8, v0
    v_mov_b32 v9, 2146435072
    s_nop 0
    v_cndmask_b32 v140, v9, v140, vcc
    v_cmp_ne_u32 vcc, s34, v0
    v_mov_b32 v9, 2146435072
    s_nop 0
    v_cndmask_b32 v140, v9, v140, vcc
    s_lshr_b32 s91, s34, 2
    v_cmp_eq_u32 vcc, s91, v5
    s_nop 1
    v_cndmask_b32 v141, v9, v140, vcc
    v_cndmask_b32 v140, v140, v9, vcc
    v_and_b32 v3, 7, v0
    v_min_u32 v3, 5, v3
    v_bfe_u32 v4, v0, 3, 2
    v_lshlrev_b32 v4, 7, v4
    v_lshl_add_u32 v3, v3, 2, v4
    v_add_u32 v142, 462368, v3
    s_mov_b32 s61, s90
    s_lshl_b32 s93, s40, 1
    s_add_u32 s93, s93, s32
    s_lshl_b32 s93, s93, 1
    s_sub_u32 s93, s93, 8
    v_and_b32 v1, 15, v0
    v_lshrrev_b32 v2, 4, v0
    s_nop 0
    s_lshr_b32 s90, s93, 2
    s_lshl_b32 s90, s90, 15
    s_and_b32 s92, s93, 3
    s_lshl_b32 s92, s92, 10
    s_add_u32 s90, s90, s92
    v_mov_b32 v5, s34
    v_and_b32 v6, 7, v1
    v_lshlrev_b32 v6, 4, v6
    v_lshl_add_u32 v6, v5, 7, v6
    v_lshrrev_b32 v7, 3, v1
    v_lshl_add_u32 v6, v7, 12, v6
    v_lshrrev_b32 v5, 1, v2
    v_lshl_add_u32 v6, v5, 13, v6
    v_and_b32 v5, 1, v2
    v_lshl_add_u32 v6, v5, 14, v6
    v_add_u32 v143, s90, v6
    s_and_b32 s91, s34, 1
    s_lshl_b32 s91, s91, 12
    s_add_u32 s90, s90, s91
    s_lshr_b32 s91, s34, 2
    s_lshl_b32 s91, s91, 13
    s_add_u32 s90, s90, s91
    s_and_b32 s91, s34, 2
    s_lshl_b32 s91, s91, 13
    s_add_u32 s90, s90, s91
    v_lshl_add_u32 v144, v0, 4, s90
    s_lshl_b32 s91, s93, 10
    s_add_u32 s91, s91, 884736
    v_lshl_add_u32 v146, v0, 4, s91
    s_lshr_b32 s91, s34, 1
    s_mul_i32 s91, s91, 10240
    s_lshl_b32 s92, s93, 5
    s_add_u32 s91, s91, s92
    s_and_b32 s92, s34, 1
    s_mul_i32 s92, s92, 40960
    s_add_u32 s91, s91, s92
    s_add_u32 s91, s91, 1280
    v_mul_u32_u24 v6, 2560, v2
    v_lshl_add_u32 v6, v1, 1, v6
    v_add_u32 v145, s91, v6
    v_cmp_gt_u32 s[58:59], 8, v1
    v_and_b32 v5, 1, v1
    v_lshrrev_b32 v6, 3, v1
    v_lshl_add_u32 v5, v5, 1, v6
    v_bfe_u32 v6, v1, 2, 1
    v_cmp_ne_u32 vcc, 0, v6
    v_mov_b32 v6, 0x3f80
    v_mov_b32 v7, 0x3f800000
    v_cndmask_b32 v6, v6, v7, vcc
    v_cmp_eq_u32 vcc, 0, v5
    s_nop 1
    v_cndmask_b32 v7, 0, v6, vcc
    v_accvgpr_write_b32 a160, v7
    v_cmp_eq_u32 vcc, 1, v5
    s_nop 1
    v_cndmask_b32 v7, 0, v6, vcc
    v_accvgpr_write_b32 a161, v7
    v_cmp_eq_u32 vcc, 2, v5
    s_nop 1
    v_cndmask_b32 v7, 0, v6, vcc
    v_accvgpr_write_b32 a162, v7
    v_cmp_eq_u32 vcc, 3, v5
    s_nop 1
    v_cndmask_b32 v7, 0, v6, vcc
    v_accvgpr_write_b32 a163, v7
    v_xor_b32 v143, s61, v143
    v_xor_b32 v144, s61, v144
    s_cmp_lg_u32 s40, 0
    s_cselect_b64 vcc, -1, 0
    v_mov_b32 v9, 2146435072
    v_cndmask_b32 v143, v9, v143, vcc
    v_cndmask_b32 v144, v9, v144, vcc
    v_cndmask_b32 v145, v9, v145, vcc
    v_cndmask_b32 v146, v9, v146, vcc
L_v_loop_f:
    s_add_u32 s50, s37, 2
    s_and_b32 s50, s50, 3
    s_mul_i32 s50, s50, 114688
    s_add_u32 s42, s38, s50
    s_add_u32 s50, s37, 4
    s_min_u32 s50, s50, 63
    s_mul_i32 s46, s50, 40960
    s_add_u32 s51, s37, 1
    v_mov_b32 v20, s51
    s_mov_b32 m0, s48
    v_mov_b32 v68, 0
    v_mov_b32 v69, 0
    v_mov_b32 v70, 0
    v_mov_b32 v71, 0
    v_mov_b32 v72, 0
    v_mov_b32 v73, 0
    v_mov_b32 v74, 0
    v_mov_b32 v75, 0
    s_add_u32 s50, s37, 6
    s_min_u32 s50, s50, 63
    s_mul_i32 s57, s50, 40960
    s_and_b32 s50, s37, 3
    s_mul_i32 s51, s50, 40960
    s_add_u32 s43, s51, s38
    s_mul_i32 s51, s50, 327680
    s_add_u32 s53, s51, 4194304
    s_xor_b32 s50, s50, 2
    s_mul_i32 s51, s50, 327680
    s_add_u32 s54, s51, 4194304
    s_sub_u32 s51, s37, 6
    s_mul_i32 s60, s51, 81920
L_vg_17:
    buffer_load_dword v139, v138, s[4:7], s38 offen sc1
    s_sub_u32 s36, s36, 1
    s_cbranch_scc1 L_exit
    s_waitcnt vmcnt(0)
    v_cmp_gt_u32 vcc, s37, v139
    s_cbranch_vccnz L_vg_17
    buffer_load_dwordx4 v13, s[4:7], s41 offen sc1 lds
    buffer_load_dwordx4 v13, s[4:7], s41 offen offset:1024 sc1 lds
    buffer_load_dword v14, s[4:7], s41 offen offset:2048 sc1 lds
    buffer_load_dword v14, s[4:7], s41 offen offset:2304 sc1 lds
L_poll_19:
    buffer_load_dwordx4 v13, s[4:7], s41 offen sc1 lds
    buffer_load_dwordx4 v13, s[4:7], s41 offen offset:1024 sc1 lds
    buffer_load_dword v14, s[4:7], s41 offen offset:2048 sc1 lds
    buffer_load_dword v14, s[4:7], s41 offen offset:2304 sc1 lds
    s_sub_u32 s36, s36, 1
    s_cbranch_scc1 L_exit
    s_waitcnt vmcnt(4)
    ds_read_b32 v18, v15
    s_waitcnt lgkmcnt(0)
    v_cmp_eq_u32 vcc, -1, v18
    s_cbranch_vccnz L_poll_19
    s_barrier
    ds_read_b128 v[28:31], v16 offset:0
    ds_read_b128 v[32:35], v16 offset:1024
    ds_read_b128 v[36:39], v16 offset:2048
    ds_read_b128 v[40:43], v16 offset:3072
    s_waitcnt lgkmcnt(3)
    v_smfmac_f32_16x16x64_bf16 v[68:71], v[28:31], a[0:7], v17
    ds_read_b128 v[44:47], v16 offset:4096
    v_smfmac_f32_16x16x64_bf16 v[72:75], v[28:31], a[80:87], v17
    ds_read_b128 v[48:51], v16 offset:5120
    s_waitcnt lgkmcnt(4)
    v_smfmac_f32_16x16x64_bf16 v[68:71], v[32:35], a[8:15], v17
    ds_read_b128 v[52:55], v16 offset:6144
    v_smfmac_f32_16x16x64_bf16 v[72:75], v[32:35], a[88:95], v17
    ds_read_b128 v[56:59], v16 offset:7168
    s_waitcnt lgkmcnt(5)
    v_smfmac_f32_16x16x64_bf16 v[68:71], v[36:39], a[16:23], v17
    ds_read_b128 v[60:63], v16 offset:8192
    v_smfmac_f32_16x16x64_bf16 v[72:75], v[36:39], a[96:103], v17
    ds_read_b128 v[64:67], v16 offset:9216
    s_waitcnt lgkmcnt(6)
    v_smfmac_f32_16x16x64_bf16 v[68:71], v[40:43], a[24:31], v17
    v_smfmac_f32_16x16x64_bf16 v[72:75], v[40:43], a[104:111], v17
    s_waitcnt lgkmcnt(5)
    v_smfmac_f32_16x16x64_bf16 v[68:71], v[44:47], a[32:39], v17
    v_smfmac_f32_16x16x64_bf16 v[72:75], v[44:47], a[112:119], v17
    s_waitcnt lgkmcnt(4)
    v_smfmac_f32_16x16x64_bf16 v[68:71], v[48:51], a[40:47], v17
    s_waitcnt lgkmcnt(3)
    v_smfmac_f32_16x16x64_bf16 v[68:71], v[52:55], a[48:55], v17
    s_waitcnt lgkmcnt(2)
    v_smfmac_f32_16x16x64_bf16 v[68:71], v[56:59], a[56:63], v17
    s_waitcnt lgkmcnt(1)
    v_smfmac_f32_16x16x64_bf16 v[68:71], v[60:63], a[64:71], v17
    s_waitcnt lgkmcnt(0)
    v_smfmac_f32_16x16x64_bf16 v[68:71], v[64:67], a[72:79], v17
L_redo_18:
    v_smfmac_f32_16x16x64_bf16 v[72:75], v[48:51], a[120:127], v17
    v_smfmac_f32_16x16x64_bf16 v[72:75], v[52:55], a[128:135], v17
    buffer_store_dword v20, v21, s[4:7], s38 offen offset:0
    v_smfmac_f32_16x16x64_bf16 v[72:75], v[56:59], a[136:143], v17
    v_add_f32 v68, v68, v70
    v_add_f32 v69, v69, v71
    v_smfmac_f32_16x16x64_bf16 v[72:75], v[60:63], a[144:151], v17
    v_cmp_u_f32 vcc, v68, v69
    v_cvt_pk_bf16_f32 v132, v68, v69
    v_smfmac_f32_16x16x64_bf16 v[72:75], v[64:67], a[152:159], v17
    s_cbranch_vccnz L_nan_20
L_cont_21:
    buffer_store_dword v132, v134, s[4:7], s41 offen offset:0
    s_nop 5
    v_pk_add_f32 v[72:73], v[72:73], v[74:75]
    v_cvt_pk_bf16_f32 v133, v72, v73
    buffer_store_dword v133, v134, s[4:7], s41 offen offset:1024
    buffer_store_dword v20, v21, s[4:7], s38 offen offset:32
    ds_read_b128 v[84:87], v11 offset:0
    ds_read_b128 v[88:91], v11 offset:2048
    ds_read_b128 v[92:95], v12 offset:0
    ds_read_b128 v[96:99], v12 offset:2048
    s_cmp_eq_u32 s37, 63
    s_cbranch_scc1 L_end_22
    s_cmp_lg_u32 s55, 0
    s_cbranch_scc1 L_an_23x
    buffer_load_dword v139, v142, s[4:7], s38 offen sc1
    buffer_load_dword v139, v142, s[4:7], s38 offen sc1
    buffer_load_dword v139, v142, s[4:7], s38 offen sc1
    buffer_load_dword v139, v142, s[4:7], s38 offen sc1
    buffer_load_dword v139, v142, s[4:7], s38 offen sc1
    buffer_load_dword v139, v142, s[4:7], s38 offen sc1
L_sp_24:
    s_waitcnt vmcnt(5)
    v_cmp_ge_u32 vcc, s37, v139
    buffer_load_dword v139, v142, s[4:7], s38 offen sc1
    s_sub_u32 s36, s36, 1
    s_cbranch_scc1 L_exit
    s_cbranch_vccz L_sp_24x
    s_waitcnt vmcnt(5)
    v_cmp_ge_u32 vcc, s37, v139
    buffer_load_dword v139, v142, s[4:7], s38 offen sc1
    s_cbranch_vccz L_sp_24x
    s_waitcnt vmcnt(5)
    v_cmp_ge_u32 vcc, s37, v139
    buffer_load_dword v139, v142, s[4:7], s38 offen sc1
    s_cbranch_vccz L_sp_24x
    s_waitcnt vmcnt(5)
    v_cmp_ge_u32 vcc, s37, v139
    buffer_load_dword v139, v142, s[4:7], s38 offen sc1
    s_cbranch_vccnz L_sp_24
L_sp_24x:
L_an_23x:
    s_barrier
    s_lshl_b32 s90, s32, 10
    s_add_u32 m0, s90, s47
    s_waitcnt lgkmcnt(2)
    v_mfma_f32_16x16x32_bf16 v[108:111], a[0:3], v[84:87], 0
    ds_read_b128 v[100:103], v11 offset:4096
    s_add_u32 s51, s37, 3
    v_mfma_f32_16x16x32_bf16 v[112:115], a[0:3], v[88:91], 0
    ds_read_b128 v[104:107], v11 offset:6144
    s_and_b32 s50, s51, 3
    v_mfma_f32_16x16x32_bf16 v[116:119], a[80:83], v[84:87], 0
    buffer_load_dwordx4 v[148:151], v146, s[4:7], s43 offen offset:0 sc1
    buffer_load_dwordx4 v[152:155], v146, s[4:7], s43 offen offset:1024 sc1
    v_mfma_f32_16x16x32_bf16 v[120:123], a[80:83], v[88:91], 0
    s_waitcnt lgkmcnt(2)
    s_mul_i32 s50, s50, 114688
    v_mfma_f32_16x16x32_bf16 v[108:111], a[4:7], v[92:95], v[108:111]
    ds_read_b128 v[84:87], v12 offset:4096
    s_add_u32 s50, s50, 65536
    v_mfma_f32_16x16x32_bf16 v[112:115], a[4:7], v[96:99], v[112:115]
    ds_read_b128 v[88:91], v12 offset:6144
    s_add_u32 s44, s38, s50
    v_mfma_f32_16x16x32_bf16 v[116:119], a[84:87], v[92:95], v[116:119]
    s_cmp_lt_i32 s60, 0
    s_cselect_b32 s54, s38, s54
    buffer_load_dwordx4 v[156:159], v144, s[4:7], s54 offen offset:0 sc1
    buffer_load_dwordx4 v[160:163], v144, s[4:7], s54 offen offset:1024 sc1
    v_mfma_f32_16x16x32_bf16 v[120:123], a[84:87], v[96:99], v[120:123]
    s_waitcnt lgkmcnt(2)
    s_add_u32 s45, s44, s56
    v_mfma_f32_16x16x32_bf16 v[108:111], a[8:11], v[100:103], v[108:111]
    ds_read_b128 v[92:95], v11 offset:8192
    s_add_u32 s37, s37, 1
    v_mfma_f32_16x16x32_bf16 v[112:115], a[8:11], v[104:107], v[112:115]
    ds_read_b128 v[96:99], v11 offset:10240
    s_mov_b32 s52, 0
    v_mfma_f32_16x16x32_bf16 v[116:119], a[88:91], v[100:103], v[116:119]
    s_and_b32 s50, s37, 3
    s_mul_i32 s51, s50, 114688
    v_mfma_f32_16x16x32_bf16 v[120:123], a[88:91], v[104:107], v[120:123]
    s_waitcnt lgkmcnt(2)
    s_add_u32 s41, s38, s51
    v_mfma_f32_16x16x32_bf16 v[108:111], a[12:15], v[84:87], v[108:111]
    ds_read_b128 v[100:103], v12 offset:8192
    v_mfma_f32_16x16x32_bf16 v[112:115], a[12:15], v[88:91], v[112:115]
    ds_read_b128 v[104:107], v12 offset:10240
    v_mfma_f32_16x16x32_bf16 v[116:119], a[92:95], v[84:87], v[116:119]
    buffer_load_dwordx4 v[248:251], v137, s[24:27], s57 offen offset:0
    buffer_load_dwordx4 v[248:251], v137, s[24:27], s57 offen offset:1024
    v_mfma_f32_16x16x32_bf16 v[120:123], a[92:95], v[88:91], v[120:123]
    s_waitcnt lgkmcnt(2)
    v_mfma_f32_16x16x32_bf16 v[108:111], a[16:19], v[92:95], v[108:111]
    ds_read_b128 v[84:87], v11 offset:12288
    v_mfma_f32_16x16x32_bf16 v[112:115], a[16:19], v[96:99], v[112:115]
    ds_read_b128 v[88:91], v11 offset:14336
    v_mfma_f32_16x16x32_bf16 v[116:119], a[96:99], v[92:95], v[116:119]
    buffer_store_dword v20, v140, s[4:7], 0 offen sc1
    v_mfma_f32_16x16x32_bf16 v[120:123], a[96:99], v[96:99], v[120:123]
    s_waitcnt lgkmcnt(2)
    v_mfma_f32_16x16x32_bf16 v[108:111], a[20:23], v[100:103], v[108:111]
    ds_read_b128 v[92:95], v12 offset:12288
    v_mfma_f32_16x16x32_bf16 v[112:115], a[20:23], v[104:107], v[112:115]
    ds_read_b128 v[96:99], v12 offset:14336
    v_mfma_f32_16x16x32_bf16 v[116:119], a[100:103], v[100:103], v[116:119]
    s_waitcnt vmcnt(4)
    s_cmp_lt_i32 s60, -245760
    s_cbranch_scc1 L_fw_25c
L_fw_25:
    buffer_store_dwordx4 v[148:151], v143, s[4:7], s53 offen offset:0 sc1
    buffer_store_dwordx4 v[152:155], v143, s[4:7], s53 offen offset:1024 sc1
    v_mfma_f32_16x16x32_bf16 v[120:123], a[100:103], v[104:107], v[120:123]
    s_waitcnt lgkmcnt(2)
    v_mfma_f32_16x16x32_bf16 v[108:111], a[24:27], v[84:87], v[108:111]
    buffer_store_dword v20, v141, s[4:7], 0 offen sc1
    ds_read_b128 v[100:103], v11 offset:16384
    v_mfma_f32_16x16x32_bf16 v[112:115], a[24:27], v[88:91], v[112:115]
    ds_read_b128 v[104:107], v11 offset:18432
    v_mfma_f32_16x16x32_bf16 v[116:119], a[104:107], v[84:87], v[116:119]
    v_mfma_f32_16x16x32_bf16 v[120:123], a[104:107], v[88:91], v[120:123]
    s_waitcnt lgkmcnt(2)
    v_mfma_f32_16x16x32_bf16 v[108:111], a[28:31], v[92:95], v[108:111]
    ds_read_b128 v[84:87], v12 offset:16384
    v_mfma_f32_16x16x32_bf16 v[112:115], a[28:31], v[96:99], v[112:115]
    ds_read_b128 v[88:91], v12 offset:18432
    v_mfma_f32_16x16x32_bf16 v[116:119], a[108:111], v[92:95], v[116:119]
    buffer_store_dword v22, v135, s[4:7], s42 offen offset:0
    buffer_store_dword v22, v135, s[4:7], s42 offen offset:1024
    v_mfma_f32_16x16x32_bf16 v[120:123], a[108:111], v[96:99], v[120:123]
    s_waitcnt lgkmcnt(2)
    v_mfma_f32_16x16x32_bf16 v[108:111], a[32:35], v[100:103], v[108:111]
    ds_read_b128 v[92:95], v11 offset:20480
    v_mfma_f32_16x16x32_bf16 v[112:115], a[32:35], v[104:107], v[112:115]
    ds_read_b128 v[96:99], v11 offset:22528
    v_mfma_f32_16x16x32_bf16 v[116:119], a[112:115], v[100:103], v[116:119]
    buffer_load_dwordx4 v10, s[24:27], s46 offen offset:0 lds
    s_add_u32 m0, m0, 3968
    v_mfma_f32_16x16x32_bf16 v[120:123], a[112:115], v[104:107], v[120:123]
    s_waitcnt lgkmcnt(2)
    v_mfma_f32_16x16x32_bf16 v[108:111], a[36:39], v[84:87], v[108:111]
    ds_read_b128 v[100:103], v12 offset:20480
    v_mfma_f32_16x16x32_bf16 v[112:115], a[36:39], v[88:91], v[112:115]
    ds_read_b128 v[104:107], v12 offset:22528
    v_mfma_f32_16x16x32_bf16 v[116:119], a[116:119], v[84:87], v[116:119]
    buffer_load_dwordx4 v10, s[24:27], s46 offen offset:128 lds
    s_add_u32 m0, m0, 3968
    v_mfma_f32_16x16x32_bf16 v[120:123], a[116:119], v[88:91], v[120:123]
    s_waitcnt lgkmcnt(2)
    v_mfma_f32_16x16x32_bf16 v[108:111], a[40:43], v[92:95], v[108:111]
    ds_read_b128 v[84:87], v11 offset:24576
    v_mfma_f32_16x16x32_bf16 v[112:115], a[40:43], v[96:99], v[112:115]
    ds_read_b128 v[88:91], v11 offset:26624
    v_mfma_f32_16x16x32_bf16 v[116:119], a[120:123], v[92:95], v[116:119]
    buffer_load_dwordx4 v10, s[24:27], s46 offen offset:256 lds
    s_add_u32 m0, m0, 3968
    v_mfma_f32_16x16x32_bf16 v[120:123], a[120:123], v[96:99], v[120:123]
    s_waitcnt lgkmcnt(2)
    v_mfma_f32_16x16x32_bf16 v[108:111], a[44:47], v[100:103], v[108:111]
    ds_read_b128 v[92:95], v12 offset:24576
    v_mfma_f32_16x16x32_bf16 v[112:115], a[44:47], v[104:107], v[112:115]
    ds_read_b128 v[96:99], v12 offset:26624
    v_mfma_f32_16x16x32_bf16 v[116:119], a[124:127], v[100:103], v[116:119]
    buffer_load_dwordx4 v10, s[24:27], s46 offen offset:384 lds
    s_add_u32 m0, m0, 3968
    v_mfma_f32_16x16x32_bf16 v[120:123], a[124:127], v[104:107], v[120:123]
    s_waitcnt lgkmcnt(2)
    v_mfma_f32_16x16x32_bf16 v[108:111], a[48:51], v[84:87], v[108:111]
    ds_read_b128 v[100:103], v11 offset:28672
    v_mfma_f32_16x16x32_bf16 v[112:115], a[48:51], v[88:91], v[112:115]
    ds_read_b128 v[104:107], v11 offset:30720
    v_mfma_f32_16x16x32_bf16 v[116:119], a[128:131], v[84:87], v[116:119]
    buffer_load_dwordx4 v10, s[24:27], s46 offen offset:512 lds
    s_add_u32 m0, m0, 3968
    v_mfma_f32_16x16x32_bf16 v[120:123], a[128:131], v[88:91], v[120:123]
    s_waitcnt lgkmcnt(2)
    v_mfma_f32_16x16x32_bf16 v[108:111], a[52:55], v[92:95], v[108:111]
    ds_read_b128 v[84:87], v12 offset:28672
    v_mfma_f32_16x16x32_bf16 v[112:115], a[52:55], v[96:99], v[112:115]
    ds_read_b128 v[88:91], v12 offset:30720
    v_mfma_f32_16x16x32_bf16 v[116:119], a[132:135], v[92:95], v[116:119]
    buffer_load_dwordx4 v10, s[24:27], s46 offen offset:640 lds
    s_add_u32 m0, m0, 3968
    v_mfma_f32_16x16x32_bf16 v[120:123], a[132:135], v[96:99], v[120:123]
    s_waitcnt lgkmcnt(2)
    v_mfma_f32_16x16x32_bf16 v[108:111], a[56:59], v[100:103], v[108:111]
    ds_read_b128 v[92:95], v11 offset:32768
    v_mfma_f32_16x16x32_bf16 v[112:115], a[56:59], v[104:107], v[112:115]
    ds_read_b128 v[96:99], v11 offset:34816
    v_mfma_f32_16x16x32_bf16 v[116:119], a[136:139], v[100:103], v[116:119]
    buffer_load_dwordx4 v10, s[24:27], s46 offen offset:768 lds
    s_add_u32 m0, m0, 3968
    v_mfma_f32_16x16x32_bf16 v[120:123], a[136:139], v[104:107], v[120:123]
    s_waitcnt lgkmcnt(2)
    v_mfma_f32_16x16x32_bf16 v[108:111], a[60:63], v[84:87], v[108:111]
    ds_read_b128 v[100:103], v12 offset:32768
    v_mfma_f32_16x16x32_bf16 v[112:115], a[60:63], v[88:91], v[112:115]
    ds_read_b128 v[104:107], v12 offset:34816
    v_mfma_f32_16x16x32_bf16 v[116:119], a[140:143], v[84:87], v[116:119]
    buffer_load_dwordx4 v10, s[24:27], s46 offen offset:896 lds
    s_add_u32 m0, m0, 3968
    v_mfma_f32_16x16x32_bf16 v[120:123], a[140:143], v[88:91], v[120:123]
    s_waitcnt lgkmcnt(2)
    v_mfma_f32_16x16x32_bf16 v[108:111], a[64:67], v[92:95], v[108:111]
    ds_read_b128 v[84:87], v11 offset:36864
    v_mfma_f32_16x16x32_bf16 v[112:115], a[64:67], v[96:99], v[112:115]
    ds_read_b128 v[88:91], v11 offset:38912
    v_mfma_f32_16x16x32_bf16 v[116:119], a[144:147], v[92:95], v[116:119]
    buffer_load_dwordx4 v10, s[24:27], s46 offen offset:1024 lds
    s_add_u32 m0, m0, 3968
    v_mfma_f32_16x16x32_bf16 v[120:123], a[144:147], v[96:99], v[120:123]
    s_waitcnt lgkmcnt(2)
    v_mfma_f32_16x16x32_bf16 v[108:111], a[68:71], v[100:103], v[108:111]
    ds_read_b128 v[92:95], v12 offset:36864
    v_mfma_f32_16x16x32_bf16 v[112:115], a[68:71], v[104:107], v[112:115]
    ds_read_b128 v[96:99], v12 offset:38912
    v_mfma_f32_16x16x32_bf16 v[116:119], a[148:151], v[100:103], v[116:119]
    buffer_load_dwordx4 v10, s[24:27], s46 offen offset:1152 lds
    v_mfma_f32_16x16x32_bf16 v[120:123], a[148:151], v[104:107], v[120:123]
    s_waitcnt lgkmcnt(0)
    v_mfma_f32_16x16x32_bf16 v[108:111], a[72:75], v[84:87], v[108:111]
    v_add_u32 v11, s49, v11
    v_mfma_f32_16x16x32_bf16 v[112:115], a[72:75], v[88:91], v[112:115]
    v_add_u32 v12, s49, v12
    v_mfma_f32_16x16x32_bf16 v[108:111], a[76:79], v[92:95], v[108:111]
    s_sub_u32 s47, s47, s49
    v_mfma_f32_16x16x32_bf16 v[112:115], a[76:79], v[96:99], v[112:115]
    s_sub_u32 s49, 0, s49
    v_mfma_f32_16x16x32_bf16 v[116:119], a[152:155], v[84:87], v[116:119]
    v_mfma_f32_16x16x32_bf16 v[120:123], a[152:155], v[88:91], v[120:123]
    v_mfma_f32_16x16x32_bf16 v[116:119], a[156:159], v[92:95], v[116:119]
    v_mfma_f32_16x16x32_bf16 v[120:123], a[156:159], v[96:99], v[120:123]
    v_cvt_pk_bf16_f32 v124, v108, v109
    v_cvt_pk_bf16_f32 v125, v110, v111
    v_cvt_pk_bf16_f32 v126, v112, v113
    v_cvt_pk_bf16_f32 v127, v114, v115
    s_nop 0
    v_permlane16_swap_b32 v124, v126
    v_permlane16_swap_b32 v125, v127
    v_cvt_pk_bf16_f32 v128, v116, v117
    v_cvt_pk_bf16_f32 v129, v118, v119
    v_cvt_pk_bf16_f32 v130, v120, v121
    v_cvt_pk_bf16_f32 v131, v122, v123
    s_nop 0
    v_permlane16_swap_b32 v128, v130
    v_permlane16_swap_b32 v129, v131
    buffer_store_dwordx4 v[124:127], v19, s[4:7], s44 offen
    buffer_store_dwordx4 v[128:131], v19, s[4:7], s45 offen
    s_waitcnt vmcnt(18)
    s_cmp_lt_i32 s60, 0
    s_cbranch_scc1 L_fin_26
    v_mfma_f32_16x16x32_bf16 v[164:167], a[160:163], v[156:159], 0
    v_mfma_f32_16x16x32_bf16 v[168:171], a[160:163], v[160:163], 0
    s_nop 4
    v_cndmask_b32 v166, v164, v165, s[58:59]
    s_nop 1
    v_cndmask_b32 v170, v168, v169, s[58:59]
    v_cndmask_b32 v167, v165, v164, s[58:59]
    v_cndmask_b32 v171, v169, v168, s[58:59]
    s_nop 0
    v_add_f32_dpp v167, v166, v167 row_ror:8 row_mask:0xf bank_mask:0xf
    v_add_f32_dpp v171, v170, v171 row_ror:8 row_mask:0xf bank_mask:0xf
    v_cvt_pk_bf16_f32 v167, v167, v167
    v_cvt_pk_bf16_f32 v171, v171, v171
    buffer_store_short v167, v145, s[28:31], s60 offen offset:0
    buffer_store_short v171, v145, s[28:31], s60 offen offset:32
L_fin_26:
    s_branch L_v_loop_f
L_end_22:
    s_cmp_lt_i32 s60, 0
    s_cselect_b32 s54, s38, s54
    buffer_load_dwordx4 v[156:159], v144, s[4:7], s54 offen offset:0 sc1
    buffer_load_dwordx4 v[160:163], v144, s[4:7], s54 offen offset:1024 sc1
    s_waitcnt vmcnt(0) lgkmcnt(0)
    s_cmp_lt_i32 s60, 0
    s_cbranch_scc1 L_fin_27
    v_mfma_f32_16x16x32_bf16 v[164:167], a[160:163], v[156:159], 0
    v_mfma_f32_16x16x32_bf16 v[168:171], a[160:163], v[160:163], 0
    s_nop 4
    v_cndmask_b32 v166, v164, v165, s[58:59]
    s_nop 1
    v_cndmask_b32 v170, v168, v169, s[58:59]
    v_cndmask_b32 v167, v165, v164, s[58:59]
    v_cndmask_b32 v171, v169, v168, s[58:59]
    s_nop 0
    v_add_f32_dpp v167, v166, v167 row_ror:8 row_mask:0xf bank_mask:0xf
    v_add_f32_dpp v171, v170, v171 row_ror:8 row_mask:0xf bank_mask:0xf
    v_cvt_pk_bf16_f32 v167, v167, v167
    v_cvt_pk_bf16_f32 v171, v171, v171
    buffer_store_short v167, v145, s[28:31], s60 offen offset:0
    buffer_store_short v171, v145, s[28:31], s60 offen offset:32
L_fin_27:
    s_waitcnt vmcnt(0)
    s_cmp_lg_u32 s55, 0
    s_cbranch_scc1 L_wb_28
    buffer_wbl2 sc1
    s_waitcnt vmcnt(0)
L_wb_28:
    s_endpgm
L_nan_20:
    s_cmp_eq_u32 s52, 1
    s_cbranch_scc1 L_cont_21
    v_lshlrev_b32 v1, 4, v0
L_nan_20r:
    s_mov_b32 s90, s41
    v_mov_b32 v2, 0
    buffer_load_dwordx4 v[28:31], v1, s[4:7], s90 offen sc1
    s_add_u32 s90, s90, 1024
    buffer_load_dwordx4 v[32:35], v1, s[4:7], s90 offen sc1
    s_add_u32 s90, s90, 1024
    buffer_load_dwordx4 v[36:39], v1, s[4:7], s90 offen sc1
    s_add_u32 s90, s90, 1024
    buffer_load_dwordx4 v[40:43], v1, s[4:7], s90 offen sc1
    s_add_u32 s90, s90, 1024
    buffer_load_dwordx4 v[44:47], v1, s[4:7], s90 offen sc1
    s_add_u32 s90, s90, 1024
    buffer_load_dwordx4 v[48:51], v1, s[4:7], s90 offen sc1
    s_add_u32 s90, s90, 1024
    buffer_load_dwordx4 v[52:55], v1, s[4:7], s90 offen sc1
    s_add_u32 s90, s90, 1024
    buffer_load_dwordx4 v[56:59], v1, s[4:7], s90 offen sc1
    s_add_u32 s90, s90, 1024
    buffer_load_dwordx4 v[60:63], v1, s[4:7], s90 offen sc1
    s_add_u32 s90, s90, 1024
    buffer_load_dwordx4 v[64:67], v1, s[4:7], s90 offen sc1
    s_add_u32 s90, s90, 1024
    s_sub_u32 s36, s36, 1
    s_cbranch_scc1 L_exit
    s_waitcnt vmcnt(0) lgkmcnt(0)
    v_max3_u32 v2, v2, v28, v29
    v_max3_u32 v2, v2, v30, v31
    v_max3_u32 v2, v2, v32, v33
    v_max3_u32 v2, v2, v34, v35
    v_max3_u32 v2, v2, v36, v37
    v_max3_u32 v2, v2, v38, v39
    v_max3_u32 v2, v2, v40, v41
    v_max3_u32 v2, v2, v42, v43
    v_max3_u32 v2, v2, v44, v45
    v_max3_u32 v2, v2, v46, v47
    v_max3_u32 v2, v2, v48, v49
    v_max3_u32 v2, v2, v50, v51
    v_max3_u32 v2, v2, v52, v53
    v_max3_u32 v2, v2, v54, v55
    v_max3_u32 v2, v2, v56, v57
    v_max3_u32 v2, v2, v58, v59
    v_max3_u32 v2, v2, v60, v61
    v_max3_u32 v2, v2, v62, v63
    v_max3_u32 v2, v2, v64, v65
    v_max3_u32 v2, v2, v66, v67
    v_cmp_eq_u32 vcc, -1, v2
    s_cbranch_vccnz L_nan_20r
    s_mov_b32 s52, 1
    v_mov_b32 v68, 0
    v_mov_b32 v69, 0
    v_mov_b32 v70, 0
    v_mov_b32 v71, 0
    v_mov_b32 v72, 0
    v_mov_b32 v73, 0
    v_mov_b32 v74, 0
    v_mov_b32 v75, 0
    v_smfmac_f32_16x16x64_bf16 v[68:71], v[28:31], a[0:7], v17
    s_nop 0
    v_smfmac_f32_16x16x64_bf16 v[72:75], v[28:31], a[80:87], v17
    v_smfmac_f32_16x16x64_bf16 v[68:71], v[32:35], a[8:15], v17
    v_smfmac_f32_16x16x64_bf16 v[72:75], v[32:35], a[88:95], v17
    v_smfmac_f32_16x16x64_bf16 v[68:71], v[36:39], a[16:23], v17
    v_smfmac_f32_16x16x64_bf16 v[72:75], v[36:39], a[96:103], v17
    v_smfmac_f32_16x16x64_bf16 v[68:71], v[40:43], a[24:31], v17
    v_smfmac_f32_16x16x64_bf16 v[72:75], v[40:43], a[104:111], v17
    v_smfmac_f32_16x16x64_bf16 v[68:71], v[44:47], a[32:39], v17
    v_smfmac_f32_16x16x64_bf16 v[72:75], v[44:47], a[112:119], v17
    v_smfmac_f32_16x16x64_bf16 v[68:71], v[48:51], a[40:47], v17
    v_smfmac_f32_16x16x64_bf16 v[68:71], v[52:55], a[48:55], v17
    v_smfmac_f32_16x16x64_bf16 v[68:71], v[56:59], a[56:63], v17
    v_smfmac_f32_16x16x64_bf16 v[68:71], v[60:63], a[64:71], v17
    v_smfmac_f32_16x16x64_bf16 v[68:71], v[64:67], a[72:79], v17
    s_nop 2
    s_branch L_redo_18
L_fw_25c:
    v_mov_b32 v148, -1
    v_mov_b32 v149, -1
    v_mov_b32 v150, -1
    v_mov_b32 v151, -1
    v_mov_b32 v152, -1
    v_mov_b32 v153, -1
    v_mov_b32 v154, -1
    v_mov_b32 v155, -1
    s_add_u32 s53, s53, 2293760
    buffer_store_dwordx4 v[148:151], v143, s[4:7], s53 offen offset:0 sc1
    buffer_store_dwordx4 v[152:155], v143, s[4:7], s53 offen offset:1024 sc1
    s_sub_u32 s53, s53, 983040
    s_branch L_fw_25
L_wo_f:
    s_mov_b32 s12, s80
    s_and_b32 s13, s81, 0xffff
    s_mov_b32 s14, 7864320
    s_mov_b32 s15, 0x20000
    s_mov_b32 s16, s72
    s_and_b32 s17, s73, 0xffff
    s_mov_b32 s18, 10240
    s_mov_b32 s19, 0x20000
    s_sub_u32 s40, s35, 18
    v_and_b32 v1, 15, v0
    v_lshrrev_b32 v2, 4, v0
    v_lshrrev_b32 v3, 3, v0
    v_and_b32 v4, 7, v0
    v_and_b32 v6, 2, v3
    v_xor_b32 v6, v6, v4
    v_lshlrev_b32 v6, 4, v6
    v_mul_u32_u24 v7, 1280, v3
    s_lshl_b32 s90, s34, 2
    s_add_u32 s90, s90, s32
    s_mul_i32 s90, s90, 245760
    s_lshl_b32 s91, s40, 7
    s_add_u32 s90, s90, s91
    v_add3_u32 v180, v6, v7, s90
    v_xor_b32 v181, 64, v180
    s_mul_i32 s90, s40, 32768
    s_lshl_b32 s91, s32, 11
    s_add_u32 s90, s90, s91
    s_lshr_b32 s91, s32, 1
    s_mul_i32 s91, s91, 0
    s_xor_b32 s91, s91, s34
    v_mul_u32_u24 v7, 0, v2
    v_xor_b32 v7, s91, v7
    v_lshlrev_b32 v6, 4, v1
    v_lshl_add_u32 v7, v7, 8, v6
    v_lshl_add_u32 v7, v2, 13, v7
    v_add_u32 v14, s90, v7
    v_lshlrev_b32 v12, 4, v0
    v_lshlrev_b32 v13, 2, v0
    v_add_u32 v46, s90, v13
    s_xor_b32 s92, s91, 0
    s_lshl_b32 s92, s92, 8
    s_add_u32 s60, s92, 0
    s_xor_b32 s92, s91, 0
    s_lshl_b32 s92, s92, 8
    s_add_u32 s61, s92, 8192
    s_xor_b32 s92, s91, 0
    s_lshl_b32 s92, s92, 8
    s_add_u32 s62, s92, 16384
    s_xor_b32 s92, s91, 0
    s_lshl_b32 s92, s92, 8
    s_add_u32 s63, s92, 24576
    v_cmp_gt_u32 vcc, 2, v2
    v_mov_b32 v9, 2146435072
    s_nop 0
    v_cndmask_b32 v14, v9, v14, vcc
    s_lshl_b32 s92, s40, 7
    s_lshl_b32 s93, s32, 2
    s_add_u32 s92, s92, s93
    s_add_u32 s92, s92, 460800
    v_mov_b32 v244, s92
    v_cmp_eq_u32 vcc, 0, v0
    v_mov_b32 v9, 2146435072
    s_nop 0
    v_cndmask_b32 v244, v9, v244, vcc
    s_lshl_b32 s92, s32, 7
    s_add_u32 s92, s92, 462336
    v_min_u32 v3, 5, v0
    v_lshl_add_u32 v245, v3, 2, s92
    s_lshl_b32 s90, s40, 2
    s_add_u32 s90, s90, s32
    s_lshl_b32 s91, s90, 8
    v_add_u32 v17, s91, v6
    v_cmp_eq_u32 vcc, 0, v2
    v_mov_b32 v9, 2146435072
    s_nop 0
    v_cndmask_b32 v17, v9, v17, vcc
    v_lshrrev_b32 v3, 2, v1
    v_and_b32 v7, 1, v1
    v_lshl_or_b32 v4, v3, 1, v7
    v_mul_u32_u24 v4, 1280, v4
    v_and_b32 v5, 2, v1
    v_lshl_add_u32 v4, v5, 1, v4
    s_lshl_b32 s91, s90, 5
    v_add_u32 v4, s91, v4
    v_lshlrev_b32 v6, 6, v3
    v_lshl_add_u32 v6, v7, 5, v6
    v_lshl_add_u32 v6, v2, 3, v6
    v_lshl_add_u32 v6, v5, 1, v6
    s_mul_i32 s92, s32, 1152
    s_add_u32 s92, s92, 122880
    v_add_u32 v18, s92, v6
    buffer_load_dword v164, v4, s[16:19], 0 offen offset:0
    buffer_load_dword v165, v4, s[16:19], 0 offen offset:8
    buffer_load_dword v166, v4, s[16:19], 0 offen offset:16
    buffer_load_dword v167, v4, s[16:19], 0 offen offset:24
    v_mov_b32 v168, -1
    v_mov_b32 v169, -1
    v_mov_b32 v170, -1
    v_mov_b32 v171, -1
    s_mul_i32 s90, s32, 24576
    s_mov_b32 m0, s90
    s_mov_b32 s91, 0
    buffer_load_dwordx4 v180, s[12:15], s91 offen nt lds
    s_add_u32 m0, m0, 1024
    s_add_u32 s91, s91, 10240
    buffer_load_dwordx4 v181, s[12:15], s91 offen nt lds
    s_add_u32 m0, m0, 1024
    s_add_u32 s91, s91, 10240
    buffer_load_dwordx4 v180, s[12:15], s91 offen nt lds
    s_add_u32 m0, m0, 1024
    s_add_u32 s91, s91, 10240
    buffer_load_dwordx4 v181, s[12:15], s91 offen nt lds
    s_add_u32 m0, m0, 1024
    s_add_u32 s91, s91, 10240
    buffer_load_dwordx4 v180, s[12:15], s91 offen nt lds
    s_add_u32 m0, m0, 1024
    s_add_u32 s91, s91, 10240
    buffer_load_dwordx4 v181, s[12:15], s91 offen nt lds
    s_add_u32 m0, m0, 1024
    s_add_u32 s91, s91, 10240
    buffer_load_dwordx4 v180, s[12:15], s91 offen nt lds
    s_add_u32 m0, m0, 1024
    s_add_u32 s91, s91, 10240
    buffer_load_dwordx4 v181, s[12:15], s91 offen nt lds
    s_add_u32 m0, m0, 1024
    s_add_u32 s91, s91, 10240
    buffer_load_dwordx4 v180, s[12:15], s91 offen nt lds
    s_add_u32 m0, m0, 1024
    s_add_u32 s91, s91, 10240
    buffer_load_dwordx4 v181, s[12:15], s91 offen nt lds
    s_add_u32 m0, m0, 1024
    s_add_u32 s91, s91, 10240
    buffer_load_dwordx4 v180, s[12:15], s91 offen nt lds
    s_add_u32 m0, m0, 1024
    s_add_u32 s91, s91, 10240
    buffer_load_dwordx4 v181, s[12:15], s91 offen nt lds
    s_add_u32 m0, m0, 1024
    s_add_u32 s91, s91, 10240
    buffer_load_dwordx4 v180, s[12:15], s91 offen nt lds
    s_add_u32 m0, m0, 1024
    s_add_u32 s91, s91, 10240
    buffer_load_dwordx4 v181, s[12:15], s91 offen nt lds
    s_add_u32 m0, m0, 1024
    s_add_u32 s91, s91, 10240
    buffer_load_dwordx4 v180, s[12:15], s91 offen nt lds
    s_add_u32 m0, m0, 1024
    s_add_u32 s91, s91, 10240
    buffer_load_dwordx4 v181, s[12:15], s91 offen nt lds
    s_add_u32 m0, m0, 1024
    s_add_u32 s91, s91, 10240
    buffer_load_dwordx4 v180, s[12:15], s91 offen nt lds
    s_add_u32 m0, m0, 1024
    s_add_u32 s91, s91, 10240
    buffer_load_dwordx4 v181, s[12:15], s91 offen nt lds
    s_add_u32 m0, m0, 1024
    s_add_u32 s91, s91, 10240
    buffer_load_dwordx4 v180, s[12:15], s91 offen nt lds
    s_add_u32 m0, m0, 1024
    s_add_u32 s91, s91, 10240
    buffer_load_dwordx4 v181, s[12:15], s91 offen nt lds
    s_add_u32 m0, m0, 1024
    s_add_u32 s91, s91, 10240
    buffer_load_dwordx4 v180, s[12:15], s91 offen nt lds
    s_add_u32 m0, m0, 1024
    s_add_u32 s91, s91, 10240
    buffer_load_dwordx4 v181, s[12:15], s91 offen nt lds
    s_add_u32 m0, m0, 1024
    s_add_u32 s91, s91, 10240
    buffer_load_dwordx4 v180, s[12:15], s91 offen nt lds
    s_add_u32 m0, m0, 1024
    s_add_u32 s91, s91, 10240
    buffer_load_dwordx4 v181, s[12:15], s91 offen nt lds
    s_waitcnt vmcnt(24)
    v_min_u32 v164, -2, v164
    v_min_u32 v165, -2, v165
    v_min_u32 v166, -2, v166
    v_min_u32 v167, -2, v167
    v_and_b32 v7, 2, v1
    v_cmp_ne_u32 vcc, 0, v7
    v_mov_b32 v5, 0x4444
    v_mov_b32 v6, 0xeeee
    v_cndmask_b32 v10, v5, v6, vcc
    v_mov_b32 v5, 0xe484
    v_mov_b32 v6, 0xee9e
    v_cndmask_b32 v7, v5, v6, vcc
    v_mov_b32 v5, 0x84e4
    v_mov_b32 v6, 0x9eee
    v_cndmask_b32 v8, v5, v6, vcc
    v_cmp_gt_u32 vcc, 2, v2
    s_nop 1
    v_cndmask_b32 v11, v8, v7, vcc
    v_mov_b32 v84, 1065369472
    v_mov_b32 v85, 1065369472
    v_mov_b32 v86, 1065369472
    v_mov_b32 v87, 0
    v_mov_b32 v88, 1065369472
    v_mov_b32 v89, 1065369472
    v_mov_b32 v90, 1065369472
    v_mov_b32 v91, 0
    v_mov_b32 v51, 0
    v_mov_b32 v55, 0
    v_mov_b32 v59, 0
    v_mov_b32 v63, 0
    v_mov_b32 v67, 0
    v_mov_b32 v71, 0
    v_mov_b32 v75, 0
    v_mov_b32 v79, 0
    v_mov_b32 v210, 0
    v_mov_b32 v211, 0
    v_mov_b32 v218, 0
    v_mov_b32 v219, 0
    v_and_b32 v7, 1, v1
    v_cmp_ne_u32 vcc, 0, v7
    v_mov_b32 v5, 0x3f80
    v_mov_b32 v6, 0x3f800000
    v_cndmask_b32 v5, v5, v6, vcc
    v_bfe_u32 v6, v1, 1, 1
    v_cmp_eq_u32 vcc, 0, v6
    s_nop 1
    v_cndmask_b32 v110, 0, v5, vcc
    v_mov_b32 v108, 0
    v_mov_b32 v112, 0
    v_cmp_eq_u32 vcc, 1, v6
    s_nop 1
    v_cndmask_b32 v111, 0, v5, vcc
    v_mov_b32 v109, 0
    v_mov_b32 v113, 0
    v_mov_b32 v240, 0x3dd53b95
    v_mov_b32 v241, 0x3dd53b95
    s_lshl_b32 s90, s32, 8
    s_add_u32 s90, s90, 122880
    v_mul_u32_u24 v6, 1152, v2
    v_lshl_add_u32 v6, v1, 3, v6
    v_add_u32 v19, s90, v6
    s_mul_i32 s90, s32, 1536
    v_add_u32 v20, s90, v12
    s_add_u32 s90, s90, 1024
    v_lshl_add_u32 v21, v0, 3, s90
    s_mul_i32 s90, s32, 6144
    v_add_u32 v22, s90, v12
    s_add_u32 s90, s90, 1024
    v_lshl_add_u32 v23, v0, 3, s90
    v_add_u32 v28, 98304, v12
    s_mul_i32 s90, s32, 3072
    v_add_u32 v37, s90, v12
    v_add_u32 v44, 25600, v37
    s_add_u32 s54, s90, 98304
    s_mul_i32 s90, s32, 3840
    s_add_u32 s90, s90, 10240
    v_add_u32 v38, s90, v12
    s_add_u32 s90, s90, 1024
    v_add_u32 v39, s90, v13
    s_mul_i32 s90, s32, 12288
    v_add_u32 v40, s90, v12
    s_lshl_b32 s93, s40, 2
    s_add_u32 s93, s93, s32
    s_nop 0
    s_lshr_b32 s90, s93, 2
    s_lshl_b32 s90, s90, 15
    s_and_b32 s92, s93, 3
    s_lshl_b32 s92, s92, 10
    s_add_u32 s90, s90, s92
    v_mov_b32 v5, s34
    v_and_b32 v6, 7, v1
    v_lshlrev_b32 v6, 4, v6
    v_lshl_add_u32 v6, v5, 7, v6
    v_lshrrev_b32 v7, 3, v1
    v_lshl_add_u32 v6, v7, 12, v6
    v_lshrrev_b32 v5, 1, v2
    v_lshl_add_u32 v6, v5, 13, v6
    v_and_b32 v5, 1, v2
    v_lshl_add_u32 v6, v5, 14, v6
    v_add_u32 v30, s90, v6
    s_and_b32 s91, s34, 1
    s_lshl_b32 s91, s91, 12
    s_add_u32 s90, s90, s91
    s_lshr_b32 s91, s34, 2
    s_lshl_b32 s91, s91, 13
    s_add_u32 s90, s90, s91
    s_and_b32 s91, s34, 2
    s_lshl_b32 s91, s91, 13
    s_add_u32 s90, s90, s91
    v_lshl_add_u32 v31, v0, 4, s90
    s_lshl_b32 s91, s93, 10
    s_add_u32 s91, s91, 884736
    v_lshl_add_u32 v15, v0, 4, s91
    s_lshr_b32 s91, s34, 1
    s_mul_i32 s91, s91, 10240
    s_lshl_b32 s92, s93, 5
    s_add_u32 s91, s91, s92
    s_and_b32 s92, s34, 1
    s_mul_i32 s92, s92, 40960
    s_add_u32 s91, s91, s92
    s_add_u32 s91, s91, 1280
    v_mul_u32_u24 v6, 2560, v2
    v_lshl_add_u32 v6, v1, 1, v6
    v_add_u32 v32, s91, v6
    v_cmp_gt_u32 s[58:59], 8, v1
    v_and_b32 v5, 1, v1
    v_lshrrev_b32 v6, 3, v1
    v_lshl_add_u32 v5, v5, 1, v6
    v_bfe_u32 v6, v1, 2, 1
    v_cmp_ne_u32 vcc, 0, v6
    v_mov_b32 v6, 0x3f80
    v_mov_b32 v7, 0x3f800000
    v_cndmask_b32 v6, v6, v7, vcc
    v_cmp_eq_u32 vcc, 0, v5
    s_nop 1
    v_cndmask_b32 v7, 0, v6, vcc
    v_accvgpr_write_b32 a144, v7
    v_cmp_eq_u32 vcc, 1, v5
    s_nop 1
    v_cndmask_b32 v7, 0, v6, vcc
    v_accvgpr_write_b32 a145, v7
    v_cmp_eq_u32 vcc, 2, v5
    s_nop 1
    v_cndmask_b32 v7, 0, v6, vcc
    v_accvgpr_write_b32 a146, v7
    v_cmp_eq_u32 vcc, 3, v5
    s_nop 1
    v_cndmask_b32 v7, 0, v6, vcc
    v_accvgpr_write_b32 a147, v7
    s_lshl_b32 s90, s32, 7
    v_add_u32 v5, s90, v13
    v_add_u32 v6, 458752, v5
    v_add_u32 v7, 459728, v5
    v_cmp_gt_u32 vcc, 12, v0
    s_nop 1
    v_cndmask_b32 v33, v7, v6, vcc
    v_mov_b32 v5, -2
    v_cndmask_b32 v34, v5, 3, vcc
    v_cmp_gt_u32 vcc, 14, v0
    v_mov_b32 v9, 2146435072
    s_nop 0
    v_cndmask_b32 v33, v9, v33, vcc
    v_mov_b32 v5, -1000
    v_cndmask_b32 v34, v5, v34, vcc
    v_and_b32 v4, 3, v1
    v_lshlrev_b32 v6, 6, v4
    v_lshl_add_u32 v6, v3, 3, v6
    v_lshl_add_u32 v6, v2, 8, v6
    v_and_b32 v5, 1, v2
    v_lshl_add_u32 v6, v5, 5, v6
    s_mul_i32 s90, s32, 3072
    s_add_u32 s53, s90, 131072
    v_add_u32 v16, s53, v6
    v_xor_b32 v13, 32, v16
    v_and_b32 v4, 3, v1
    v_and_b32 v5, 1, v2
    v_lshl_add_u32 v6, v2, 3, v3
    v_lshlrev_b32 v6, 7, v6
    v_and_b32 v7, 2, v3
    v_lshl_or_b32 v7, v5, 2, v7
    v_lshrrev_b32 v8, 1, v4
    v_xor_b32 v7, v7, v8
    v_lshl_add_u32 v6, v7, 4, v6
    v_and_b32 v7, 1, v4
    v_lshl_add_u32 v6, v7, 3, v6
    s_mul_i32 s90, s32, 24576
    v_add_u32 v6, s90, v6
    v_xor_b32 v182, 0, v6
    v_xor_b32 v183, 32, v6
    v_xor_b32 v184, 64, v6
    v_xor_b32 v185, 96, v6
    s_waitcnt vmcnt(0)
    ds_read_b64_tr_b16 a[0:1], v182 offset:0
    ds_read_b64_tr_b16 a[2:3], v182 offset:512
    ds_read_b64_tr_b16 a[4:5], v182 offset:4096
    ds_read_b64_tr_b16 a[6:7], v182 offset:4608
    ds_read_b64_tr_b16 a[8:9], v182 offset:8192
    ds_read_b64_tr_b16 a[10:11], v182 offset:8704
    ds_read_b64_tr_b16 a[12:13], v182 offset:12288
    ds_read_b64_tr_b16 a[14:15], v182 offset:12800
    ds_read_b64_tr_b16 a[16:17], v182 offset:16384
    ds_read_b64_tr_b16 a[18:19], v182 offset:16896
    ds_read_b64_tr_b16 a[20:21], v182 offset:20480
    ds_read_b64_tr_b16 a[22:23], v182 offset:20992
    ds_read_b64_tr_b16 a[24:25], v183 offset:0
    ds_read_b64_tr_b16 a[26:27], v183 offset:512
    ds_read_b64_tr_b16 a[28:29], v183 offset:4096
    ds_read_b64_tr_b16 a[30:31], v183 offset:4608
    ds_read_b64_tr_b16 a[32:33], v183 offset:8192
    ds_read_b64_tr_b16 a[34:35], v183 offset:8704
    ds_read_b64_tr_b16 a[36:37], v183 offset:12288
    ds_read_b64_tr_b16 a[38:39], v183 offset:12800
    ds_read_b64_tr_b16 a[40:41], v183 offset:16384
    ds_read_b64_tr_b16 a[42:43], v183 offset:16896
    ds_read_b64_tr_b16 a[44:45], v183 offset:20480
    ds_read_b64_tr_b16 a[46:47], v183 offset:20992
    ds_read_b64_tr_b16 a[48:49], v184 offset:0
    ds_read_b64_tr_b16 a[50:51], v184 offset:512
    ds_read_b64_tr_b16 a[52:53], v184 offset:4096
    ds_read_b64_tr_b16 a[54:55], v184 offset:4608
    ds_read_b64_tr_b16 a[56:57], v184 offset:8192
    ds_read_b64_tr_b16 a[58:59], v184 offset:8704
    ds_read_b64_tr_b16 a[60:61], v184 offset:12288
    ds_read_b64_tr_b16 a[62:63], v184 offset:12800
    ds_read_b64_tr_b16 a[64:65], v184 offset:16384
    ds_read_b64_tr_b16 a[66:67], v184 offset:16896
    ds_read_b64_tr_b16 a[68:69], v184 offset:20480
    ds_read_b64_tr_b16 a[70:71], v184 offset:20992
    ds_read_b64_tr_b16 a[72:73], v185 offset:0
    ds_read_b64_tr_b16 a[74:75], v185 offset:512
    ds_read_b64_tr_b16 a[76:77], v185 offset:4096
    ds_read_b64_tr_b16 a[78:79], v185 offset:4608
    ds_read_b64_tr_b16 a[80:81], v185 offset:8192
    ds_read_b64_tr_b16 a[82:83], v185 offset:8704
    ds_read_b64_tr_b16 a[84:85], v185 offset:12288
    ds_read_b64_tr_b16 a[86:87], v185 offset:12800
    ds_read_b64_tr_b16 a[88:89], v185 offset:16384
    ds_read_b64_tr_b16 a[90:91], v185 offset:16896
    ds_read_b64_tr_b16 a[92:93], v185 offset:20480
    ds_read_b64_tr_b16 a[94:95], v185 offset:20992
    s_waitcnt lgkmcnt(0)
    s_barrier
    v_mov_b32 v1, 192
L_gw_29:
    buffer_load_dword v2, v1, s[8:11], 0 offen sc1
    s_sub_u32 s36, s36, 1
    s_cbranch_scc1 L_exit
    s_waitcnt vmcnt(0)
    v_readfirstlane_b32 s90, v2
    s_nop 0
    s_cmp_eq_u32 s90, 0
    s_cbranch_scc1 L_gw_29
    s_cmp_lg_u32 s90, 1
    s_cbranch_scc1 L_slow
    buffer_store_dwordx4 v[164:167], v17, s[4:7], s38 offen
    s_mov_b32 s37, -1
    v_add_u32 v35, -2, v34
    s_add_u32 s45, s38, 65536
    s_add_u32 s46, s45, 4096
    s_add_u32 s47, s45, 8192
    v_mov_b32 v24, v20
    v_mov_b32 v25, v21
    buffer_load_dword v36, v33, s[4:7], s38 offen sc1
    s_waitcnt vmcnt(0)
    v_cmp_lt_i32 vcc, v36, v35
    s_cbranch_vccz L_fok_31
L_fw_30:
    buffer_load_dword v36, v33, s[4:7], s38 offen sc1
    s_sub_u32 s36, s36, 1
    s_cbranch_scc1 L_exit
    s_waitcnt vmcnt(0)
    v_cmp_lt_i32 vcc, v36, v35
    s_cbranch_vccnz L_fw_30
L_fok_31:
    buffer_load_dwordx4 a[96:99], v40, s[4:7], s45 offen offset:0 sc1
    buffer_load_dwordx4 a[100:103], v40, s[4:7], s45 offen offset:1024 sc1
    buffer_load_dwordx4 a[104:107], v40, s[4:7], s45 offen offset:2048 sc1
    buffer_load_dwordx4 a[108:111], v40, s[4:7], s45 offen offset:3072 sc1
    buffer_load_dwordx4 a[112:115], v40, s[4:7], s46 offen offset:0 sc1
    buffer_load_dwordx4 a[116:119], v40, s[4:7], s46 offen offset:1024 sc1
    buffer_load_dwordx4 a[120:123], v40, s[4:7], s46 offen offset:2048 sc1
    buffer_load_dwordx4 a[124:127], v40, s[4:7], s46 offen offset:3072 sc1
    buffer_load_dwordx4 a[128:131], v40, s[4:7], s47 offen offset:0 sc1
    buffer_load_dwordx4 a[132:135], v40, s[4:7], s47 offen offset:1024 sc1
    buffer_load_dwordx4 a[136:139], v40, s[4:7], s47 offen offset:2048 sc1
    buffer_load_dwordx4 a[140:143], v40, s[4:7], s47 offen offset:3072 sc1
    s_waitcnt vmcnt(0)
    v_mfma_f32_16x16x32_bf16 v[148:151], a[96:99], a[0:3], 0
    v_mfma_f32_16x16x32_bf16 v[152:155], a[120:123], a[0:3], 0
    v_mfma_f32_16x16x32_bf16 v[156:159], a[96:99], a[24:27], 0
    v_mfma_f32_16x16x32_bf16 v[160:163], a[120:123], a[24:27], 0
    v_mfma_f32_16x16x32_bf16 v[180:183], a[96:99], a[48:51], 0
    v_mfma_f32_16x16x32_bf16 v[184:187], a[120:123], a[48:51], 0
    v_mfma_f32_16x16x32_bf16 v[188:191], a[96:99], a[72:75], 0
    v_mfma_f32_16x16x32_bf16 v[192:195], a[120:123], a[72:75], 0
    v_mfma_f32_16x16x32_bf16 v[148:151], a[100:103], a[4:7], v[148:151]
    v_mfma_f32_16x16x32_bf16 v[152:155], a[124:127], a[4:7], v[152:155]
    v_mfma_f32_16x16x32_bf16 v[156:159], a[100:103], a[28:31], v[156:159]
    v_mfma_f32_16x16x32_bf16 v[160:163], a[124:127], a[28:31], v[160:163]
    v_mfma_f32_16x16x32_bf16 v[180:183], a[100:103], a[52:55], v[180:183]
    v_mfma_f32_16x16x32_bf16 v[184:187], a[124:127], a[52:55], v[184:187]
    v_mfma_f32_16x16x32_bf16 v[188:191], a[100:103], a[76:79], v[188:191]
    v_mfma_f32_16x16x32_bf16 v[192:195], a[124:127], a[76:79], v[192:195]
    v_mfma_f32_16x16x32_bf16 v[148:151], a[104:107], a[8:11], v[148:151]
    v_mfma_f32_16x16x32_bf16 v[152:155], a[128:131], a[8:11], v[152:155]
    v_mfma_f32_16x16x32_bf16 v[156:159], a[104:107], a[32:35], v[156:159]
    v_mfma_f32_16x16x32_bf16 v[160:163], a[128:131], a[32:35], v[160:163]
    v_mfma_f32_16x16x32_bf16 v[180:183], a[104:107], a[56:59], v[180:183]
    v_mfma_f32_16x16x32_bf16 v[184:187], a[128:131], a[56:59], v[184:187]
    v_mfma_f32_16x16x32_bf16 v[188:191], a[104:107], a[80:83], v[188:191]
    v_mfma_f32_16x16x32_bf16 v[192:195], a[128:131], a[80:83], v[192:195]
    v_mfma_f32_16x16x32_bf16 v[148:151], a[108:111], a[12:15], v[148:151]
    v_mfma_f32_16x16x32_bf16 v[152:155], a[132:135], a[12:15], v[152:155]
    v_mfma_f32_16x16x32_bf16 v[156:159], a[108:111], a[36:39], v[156:159]
    v_mfma_f32_16x16x32_bf16 v[160:163], a[132:135], a[36:39], v[160:163]
    v_mfma_f32_16x16x32_bf16 v[180:183], a[108:111], a[60:63], v[180:183]
    v_mfma_f32_16x16x32_bf16 v[184:187], a[132:135], a[60:63], v[184:187]
    v_mfma_f32_16x16x32_bf16 v[188:191], a[108:111], a[84:87], v[188:191]
    v_mfma_f32_16x16x32_bf16 v[192:195], a[132:135], a[84:87], v[192:195]
    v_mfma_f32_16x16x32_bf16 v[148:151], a[112:115], a[16:19], v[148:151]
    v_mfma_f32_16x16x32_bf16 v[152:155], a[136:139], a[16:19], v[152:155]
    v_mfma_f32_16x16x32_bf16 v[156:159], a[112:115], a[40:43], v[156:159]
    v_mfma_f32_16x16x32_bf16 v[160:163], a[136:139], a[40:43], v[160:163]
    v_mfma_f32_16x16x32_bf16 v[180:183], a[112:115], a[64:67], v[180:183]
    v_mfma_f32_16x16x32_bf16 v[184:187], a[136:139], a[64:67], v[184:187]
    v_mfma_f32_16x16x32_bf16 v[188:191], a[112:115], a[88:91], v[188:191]
    v_mfma_f32_16x16x32_bf16 v[192:195], a[136:139], a[88:91], v[192:195]
    v_mfma_f32_16x16x32_bf16 v[148:151], a[116:119], a[20:23], v[148:151]
    v_mfma_f32_16x16x32_bf16 v[152:155], a[140:143], a[20:23], v[152:155]
    v_mfma_f32_16x16x32_bf16 v[156:159], a[116:119], a[44:47], v[156:159]
    v_mfma_f32_16x16x32_bf16 v[160:163], a[140:143], a[44:47], v[160:163]
    v_mfma_f32_16x16x32_bf16 v[180:183], a[116:119], a[68:71], v[180:183]
    v_mfma_f32_16x16x32_bf16 v[184:187], a[140:143], a[68:71], v[184:187]
    v_mfma_f32_16x16x32_bf16 v[188:191], a[116:119], a[92:95], v[188:191]
    v_mfma_f32_16x16x32_bf16 v[192:195], a[140:143], a[92:95], v[192:195]
    v_cvt_pk_bf16_f32 v64, v180, v181
    v_cvt_pk_bf16_f32 v65, v182, v183
    ds_write_b64 v24, v[64:65] offset:12288
    v_cvt_pk_bf16_f32 v68, v184, v185
    v_cvt_pk_bf16_f32 v69, v186, v187
    ds_write_b64 v25, v[68:69] offset:12288
    v_cvt_pk_bf16_f32 v72, v188, v189
    v_cvt_pk_bf16_f32 v73, v190, v191
    ds_write_b64 v24, v[72:73] offset:18432
    v_cvt_pk_bf16_f32 v76, v192, v193
    v_cvt_pk_bf16_f32 v77, v194, v195
    ds_write_b64 v25, v[76:77] offset:18432
    v_cvt_pk_bf16_f32 v48, v148, v149
    v_cvt_pk_bf16_f32 v49, v150, v151
    ds_write_b64 v24, v[48:49] offset:0
    v_cvt_pk_bf16_f32 v52, v152, v153
    v_cvt_pk_bf16_f32 v53, v154, v155
    ds_write_b64 v25, v[52:53] offset:0
    v_cvt_pk_bf16_f32 v56, v156, v157
    v_cvt_pk_bf16_f32 v57, v158, v159
    ds_write_b64 v24, v[56:57] offset:6144
    v_cvt_pk_bf16_f32 v60, v160, v161
    v_cvt_pk_bf16_f32 v61, v162, v163
    ds_write_b64 v25, v[60:61] offset:6144
    s_add_u32 s56, s37, 2
    s_and_b32 s55, s56, 3
    s_mul_i32 s55, s55, 114688
    s_add_u32 s55, s55, 65536
    s_add_u32 s45, s38, s55
    s_add_u32 s46, s45, 4096
    s_add_u32 s47, s45, 8192
    s_add_u32 s56, s37, -1
    s_and_b32 s55, s56, 3
    s_mul_i32 s55, s55, 114688
    s_add_u32 s55, s55, 53248
    s_add_u32 s48, s38, s55
    s_and_b32 s55, s56, 1
    s_add_u32 s56, s56, 1
    v_mov_b32 v35, -16
    v_writelane_b32 v35, s56, 12
    s_mul_i32 s55, s55, 12288
    s_add_u32 m0, s54, s55
    v_add_u32 v35, -1, v34
    buffer_load_dword v36, v33, s[4:7], s38 offen sc1
    s_waitcnt vmcnt(0)
    v_cmp_lt_i32 vcc, v36, v35
    s_cbranch_vccz L_fok_33
L_fw_32:
    buffer_load_dword v36, v33, s[4:7], s38 offen sc1
    s_sub_u32 s36, s36, 1
    s_cbranch_scc1 L_exit
    s_waitcnt vmcnt(0)
    v_cmp_lt_i32 vcc, v36, v35
    s_cbranch_vccnz L_fw_32
L_fok_33:
    buffer_load_dwordx4 a[96:99], v40, s[4:7], s45 offen offset:0 sc1
    buffer_load_dwordx4 a[100:103], v40, s[4:7], s45 offen offset:1024 sc1
    buffer_load_dwordx4 a[104:107], v40, s[4:7], s45 offen offset:2048 sc1
    buffer_load_dwordx4 a[108:111], v40, s[4:7], s45 offen offset:3072 sc1
    buffer_load_dwordx4 a[112:115], v40, s[4:7], s46 offen offset:0 sc1
    buffer_load_dwordx4 a[116:119], v40, s[4:7], s46 offen offset:1024 sc1
    buffer_load_dwordx4 a[120:123], v40, s[4:7], s46 offen offset:2048 sc1
    buffer_load_dwordx4 a[124:127], v40, s[4:7], s46 offen offset:3072 sc1
    buffer_load_dwordx4 a[128:131], v40, s[4:7], s47 offen offset:0 sc1
    buffer_load_dwordx4 a[132:135], v40, s[4:7], s47 offen offset:1024 sc1
    buffer_load_dwordx4 a[136:139], v40, s[4:7], s47 offen offset:2048 sc1
    buffer_load_dwordx4 a[140:143], v40, s[4:7], s47 offen offset:3072 sc1
    s_mov_b32 s50, s42
    s_add_u32 s56, s37, 1
    v_mov_b32 v47, v24
    s_and_b32 s55, s56, 3
    s_mul_i32 s41, s55, 327680
    s_mul_i32 s56, s55, 114688
    s_add_u32 s43, s38, s56
    s_xor_b32 s55, s55, 2
    s_mul_i32 s42, s55, 327680
    s_add_u32 s56, s37, 2
    v_mov_b32 v107, s56
    s_and_b32 s55, s56, 3
    s_mul_i32 s44, s55, 24576
    s_add_u32 s56, s37, -1
    s_and_b32 s55, s56, 3
    s_mul_i32 s55, s55, 40960
    s_add_u32 s49, s55, s38
    s_add_u32 s56, s37, -1
    s_and_b32 s55, s56, 3
    s_mul_i32 s55, s55, 24576
    v_add_u32 v26, s55, v22
    v_add_u32 v27, s55, v23
    s_and_b32 s55, s56, 1
    s_mul_i32 s55, s55, 12288
    v_add_u32 v29, s55, v28
    s_add_u32 s37, s37, 1
    s_mov_b32 m0, s53
    v_add_u32 v24, s44, v20
    v_add_u32 v25, s44, v21
    v_pk_mul_f32 v[148:149], v[210:211], v[210:211]
    v_pk_mul_f32 v[150:151], v[210:211], v[210:211]
    v_pk_mul_f32 v[152:153], v[210:211], v[210:211]
    v_pk_mul_f32 v[154:155], v[210:211], v[210:211]
    v_pk_mul_f32 v[156:157], v[210:211], v[210:211]
    v_pk_mul_f32 v[158:159], v[210:211], v[210:211]
    v_pk_mul_f32 v[160:161], v[210:211], v[210:211]
    v_pk_mul_f32 v[162:163], v[210:211], v[210:211]
    v_mov_b32 v120, 0
    v_mov_b32 v121, 0
    v_mov_b32 v122, 0
    v_mov_b32 v123, 0
    v_mov_b32 v124, 0
    v_mov_b32 v125, 0
    v_mov_b32 v126, 0
    v_mov_b32 v127, 0
    v_mov_b32 v128, 0
    v_mov_b32 v129, 0
    v_mov_b32 v130, 0
    v_mov_b32 v131, 0
    v_mov_b32 v132, 0
    v_mov_b32 v133, 0
    v_mov_b32 v134, 0
    v_mov_b32 v135, 0
    v_mov_b32 v116, 0
    v_mov_b32 v117, 0
    v_mov_b32 v118, 0
    v_mov_b32 v119, 0
L_wo_loop_f:
    buffer_load_dword v41, v245, s[4:7], s38 offen sc1
    buffer_load_dword v41, v245, s[4:7], s38 offen sc1
    buffer_load_dword v41, v245, s[4:7], s38 offen sc1
    buffer_load_dword v41, v245, s[4:7], s38 offen sc1
    buffer_load_dword v41, v245, s[4:7], s38 offen sc1
    buffer_load_dword v41, v245, s[4:7], s38 offen sc1
L_sp_37:
    s_waitcnt vmcnt(5)
    v_cmp_ge_u32 vcc, s37, v41
    buffer_load_dword v41, v245, s[4:7], s38 offen sc1
    s_sub_u32 s36, s36, 1
    s_cbranch_scc1 L_exit
    s_cbranch_vccz L_sp_37x
    s_waitcnt vmcnt(5)
    v_cmp_ge_u32 vcc, s37, v41
    buffer_load_dword v41, v245, s[4:7], s38 offen sc1
    s_cbranch_vccz L_sp_37x
    s_waitcnt vmcnt(5)
    v_cmp_ge_u32 vcc, s37, v41
    buffer_load_dword v41, v245, s[4:7], s38 offen sc1
    s_cbranch_vccz L_sp_37x
    s_waitcnt vmcnt(5)
    v_cmp_ge_u32 vcc, s37, v41
    buffer_load_dword v41, v245, s[4:7], s38 offen sc1
    s_cbranch_vccnz L_sp_37
L_sp_37x:
    buffer_load_dwordx4 v44, s[4:7], s43 offen offset:0 sc1 lds
    buffer_load_dwordx4 v44, s[4:7], s43 offen offset:1024 sc1 lds
    buffer_load_dwordx4 v44, s[4:7], s43 offen offset:2048 sc1 lds
    s_waitcnt vmcnt(2)
    ds_read_b64_tr_b16 v[136:137], v16 offset:0
    ds_read_b64_tr_b16 v[138:139], v13 offset:0
    s_waitcnt vmcnt(1)
    ds_read_b64_tr_b16 v[140:141], v16 offset:1024
    ds_read_b64_tr_b16 v[142:143], v13 offset:1024
    s_waitcnt vmcnt(0)
    ds_read_b64_tr_b16 v[144:145], v16 offset:2048
    ds_read_b64_tr_b16 v[146:147], v13 offset:2048
    buffer_load_dwordx4 v[92:95], v38, s[4:7], s43 offen offset:0 sc1
    buffer_load_dwordx4 v[96:99], v38, s[4:7], s43 offen offset:1280 sc1
    buffer_load_dwordx4 v[100:103], v38, s[4:7], s43 offen offset:2560 sc1
    s_cmp_eq_u32 s37, 63
    s_waitcnt lgkmcnt(4)
    v_smfmac_f32_16x16x64_bf16 v[148:151], v[136:139], a[0:7], v10
    v_smfmac_f32_16x16x64_bf16 v[152:155], v[136:139], a[24:31], v10
    v_smfmac_f32_16x16x64_bf16 v[156:159], v[136:139], a[48:55], v10
    buffer_load_dword v104, v39, s[4:7], s43 offen offset:0 sc1
    v_smfmac_f32_16x16x64_bf16 v[160:163], v[136:139], a[72:79], v10
    buffer_load_dword v105, v39, s[4:7], s43 offen offset:1280 sc1
    s_waitcnt lgkmcnt(2)
    v_smfmac_f32_16x16x64_bf16 v[148:151], v[140:143], a[8:15], v10
    buffer_load_dword v106, v39, s[4:7], s43 offen offset:2560 sc1
    v_smfmac_f32_16x16x64_bf16 v[152:155], v[140:143], a[32:39], v10
    v_smfmac_f32_16x16x64_bf16 v[156:159], v[140:143], a[56:63], v10
    v_smfmac_f32_16x16x64_bf16 v[160:163], v[140:143], a[80:87], v10
    s_waitcnt lgkmcnt(0)
    v_smfmac_f32_16x16x64_bf16 v[148:151], v[144:147], a[16:23], v10
    v_smfmac_f32_16x16x64_bf16 v[152:155], v[144:147], a[40:47], v10
    v_smfmac_f32_16x16x64_bf16 v[156:159], v[144:147], a[64:71], v10
    v_smfmac_f32_16x16x64_bf16 v[160:163], v[144:147], a[88:95], v10
    v_pk_add_f32 v[148:149], v[148:149], v[150:151]
    v_cmp_u_f32 vcc, v148, v149
    v_cvt_pk_bf16_f32 v50, v148, v149
    v_cvt_pk_bf16_f32 v54, v148, v149
    v_pk_add_f32 v[152:153], v[152:153], v[154:155]
    v_cvt_pk_bf16_f32 v58, v152, v153
    v_cvt_pk_bf16_f32 v62, v152, v153
    v_pk_add_f32 v[156:157], v[156:157], v[158:159]
    v_cvt_pk_bf16_f32 v66, v156, v157
    v_cvt_pk_bf16_f32 v70, v156, v157
    v_pk_add_f32 v[160:161], v[160:161], v[162:163]
    v_cvt_pk_bf16_f32 v74, v160, v161
    v_cvt_pk_bf16_f32 v78, v160, v161
    s_cbranch_vccnz L_vm_35
L_u_36:
    s_cbranch_scc1 L_wo_tail_f
L_sc_38:
    s_waitcnt vmcnt(4)
    v_pk_add_f32 v[236:237], v[92:93], v[96:97]
    v_pk_add_f32 v[238:239], v[94:95], v[98:99]
    s_waitcnt vmcnt(3)
    v_pk_add_f32 v[236:237], v[236:237], v[100:101]
    v_pk_add_f32 v[238:239], v[238:239], v[102:103]
    v_max3_f32 v41, v236, v237, v238
    v_pk_add_f32 v[242:243], v[236:237], v[238:239]
    s_waitcnt vmcnt(0)
    v_add_f32 v43, v104, v105
    v_add_f32 v43, v43, v106
    v_max3_f32 v41, v41, v239, v43
    v_add_f32 v242, v242, v43
    s_nop 0
    v_max_f32_dpp v42, v41, v41 quad_perm:[2,3,0,1] row_mask:0xf bank_mask:0xf
    v_max_f32_dpp v41, v41, v41 quad_perm:[2,3,0,1] row_mask:0xf bank_mask:0xf
    v_cmp_u_f32 vcc, v242, v243
    s_nop 0
    v_permlane16_swap_b32 v41, v42
    v_max_f32 v41, v41, v42
    v_mov_b32 v42, v41
    s_cbranch_vccnz L_sp_39
L_sg_40:
    s_nop 0
    v_permlane32_swap_b32 v41, v42
    v_max_f32 v41, v41, v42
    v_mul_f32 v242, 0xbdd53b95, v41
    v_pk_fma_f32 v[236:237], v[236:237], v[240:241], v[242:243] op_sel_hi:[1,1,0]
    v_pk_fma_f32 v[238:239], v[238:239], v[240:241], v[242:243] op_sel_hi:[1,1,0]
    v_fma_f32 v43, v43, v240, v242
    v_exp_f32 v236, v236
    v_exp_f32 v237, v237
    v_exp_f32 v238, v238
    v_exp_f32 v239, v239
    v_exp_f32 v43, v43
    v_cvt_pk_bf16_f32 v80, v236, v237
    v_cvt_pk_bf16_f32 v82, v238, v239
    v_cvt_pk_bf16_f32 v81, v43, 0
    v_cvt_pk_bf16_f32 v83, v43, 0
    s_nop 1
    v_smfmac_f32_16x16x64_bf16 v[116:119], v[80:83], v[84:91], v11
    v_smfmac_f32_16x16x64_bf16 v[120:123], v[80:83], v[48:55], v11
    v_smfmac_f32_16x16x64_bf16 v[124:127], v[80:83], v[56:63], v11
    v_smfmac_f32_16x16x64_bf16 v[128:131], v[80:83], v[64:71], v11
    v_add_f32 v116, v116, v118
    v_add_f32 v117, v117, v119
    v_smfmac_f32_16x16x64_bf16 v[132:135], v[80:83], v[72:79], v11
    v_rcp_f32 v116, v116
    v_rcp_f32 v117, v117
    v_pk_add_f32 v[120:121], v[120:121], v[122:123]
    v_pk_mul_f32 v[120:121], v[120:121], v[116:117]
    v_cvt_pk_bf16_f32 v236, v120, v121
    v_pk_add_f32 v[124:125], v[124:125], v[126:127]
    v_pk_mul_f32 v[124:125], v[124:125], v[116:117]
    v_cvt_pk_bf16_f32 v237, v124, v125
    ds_write2st64_b32 v18, v236, v237 offset0:0 offset1:1
    v_pk_add_f32 v[128:129], v[128:129], v[130:131]
    v_pk_mul_f32 v[128:129], v[128:129], v[116:117]
    v_cvt_pk_bf16_f32 v238, v128, v129
    v_pk_add_f32 v[132:133], v[132:133], v[134:135]
    v_pk_mul_f32 v[132:133], v[132:133], v[116:117]
    v_cvt_pk_bf16_f32 v239, v132, v133
    ds_write2st64_b32 v18, v238, v239 offset0:2 offset1:3
    buffer_store_dword v107, v244, s[4:7], s38 offen
    v_mov_b32 v120, 0
    v_mov_b32 v121, 0
    v_mov_b32 v122, 0
    v_mov_b32 v123, 0
    v_mov_b32 v124, 0
    v_mov_b32 v125, 0
    v_mov_b32 v126, 0
    v_mov_b32 v127, 0
    v_mov_b32 v128, 0
    v_mov_b32 v129, 0
    s_waitcnt lgkmcnt(0)
    s_barrier
    ds_read_b64_tr_b16 v[80:81], v19
    ds_read_b64_tr_b16 v[82:83], v19 offset:128
    v_mov_b32 v130, 0
    v_mov_b32 v131, 0
    v_mov_b32 v132, 0
    v_mov_b32 v133, 0
    v_mov_b32 v134, 0
    v_mov_b32 v135, 0
    v_mov_b32 v116, 0
    v_mov_b32 v117, 0
    v_mov_b32 v118, 0
    v_mov_b32 v119, 0
    s_waitcnt lgkmcnt(0)
    v_mfma_f32_16x16x32_bf16 v[172:175], v[110:113], v[80:83], 0
    v_mfma_f32_16x16x32_bf16 v[176:179], v[108:111], v[80:83], 0
    buffer_load_dword v36, v33, s[4:7], s38 offen sc1
    s_nop 3
    v_cvt_pk_bf16_f32 v236, v172, v173
    v_cvt_pk_bf16_f32 v237, v174, v175
    s_nop 0
    v_cvt_pk_bf16_f32 v238, v176, v177
    v_cvt_pk_bf16_f32 v239, v178, v179
    buffer_store_dwordx4 v[236:239], v14, s[4:7], s41 offen sc1
    ds_write_b32 v47, v50 offset:8
    ds_write_b32 v47, v58 offset:6152
    ds_write_b32 v47, v66 offset:12296
    ds_write_b32 v47, v74 offset:18440
    ds_read_b128 v[204:207], v26 offset:0
    ds_read_b128 v[180:183], v29 offset:0
    ds_read_b128 v[184:187], v29 offset:1024
    ds_read_b64 v[208:209], v27 offset:0
    ds_read_b128 v[188:191], v29 offset:2048
    ds_read_b128 v[212:215], v26 offset:1536
    ds_read_b128 v[192:195], v29 offset:3072
    ds_read_b128 v[196:199], v29 offset:4096
    ds_read_b64 v[216:217], v27 offset:1536
    ds_read_b128 v[200:203], v29 offset:5120
    s_add_u32 s55, s42, s60
    buffer_store_dword v168, v46, s[4:7], s55 offen sc1
    s_add_u32 s55, s42, s61
    buffer_store_dword v168, v46, s[4:7], s55 offen sc1
    s_waitcnt lgkmcnt(5)
    v_mfma_f32_16x16x32_bf16 v[220:223], v[180:183], v[204:207], 0
    v_mfma_f32_16x16x32_bf16 v[224:227], v[184:187], v[204:207], 0
    v_mfma_f32_16x16x32_bf16 v[224:227], v[188:191], v[208:211], v[224:227]
    ds_read_b128 v[204:207], v26 offset:3072
    ds_read_b128 v[180:183], v29 offset:6144
    ds_read_b128 v[184:187], v29 offset:7168
    ds_read_b64 v[208:209], v27 offset:3072
    ds_read_b128 v[188:191], v29 offset:8192
    s_add_u32 s56, s37, 2
    s_and_b32 s55, s56, 3
    s_mul_i32 s55, s55, 114688
    s_add_u32 s55, s55, 65536
    s_add_u32 s45, s38, s55
    s_add_u32 s46, s45, 4096
    s_add_u32 s47, s45, 8192
    s_add_u32 s56, s37, -1
    s_and_b32 s55, s56, 3
    s_mul_i32 s55, s55, 114688
    s_add_u32 s55, s55, 53248
    s_add_u32 s48, s38, s55
    s_and_b32 s55, s56, 1
    s_add_u32 s56, s56, 1
    v_mov_b32 v35, -16
    v_writelane_b32 v35, s56, 12
    s_mul_i32 s55, s55, 12288
    s_add_u32 m0, s54, s55
    s_waitcnt lgkmcnt(5)
    v_mfma_f32_16x16x32_bf16 v[220:223], v[192:195], v[212:215], v[220:223]
    v_mfma_f32_16x16x32_bf16 v[224:227], v[196:199], v[212:215], v[224:227]
    v_mfma_f32_16x16x32_bf16 v[224:227], v[200:203], v[216:219], v[224:227]
    ds_read_b128 v[212:215], v26 offset:4608
    ds_read_b128 v[192:195], v29 offset:9216
    ds_read_b128 v[196:199], v29 offset:10240
    ds_read_b64 v[216:217], v27 offset:4608
    ds_read_b128 v[200:203], v29 offset:11264
    s_waitcnt lgkmcnt(5)
    v_mfma_f32_16x16x32_bf16 v[220:223], v[180:183], v[204:207], v[220:223]
    v_mfma_f32_16x16x32_bf16 v[224:227], v[184:187], v[204:207], v[224:227]
    v_mfma_f32_16x16x32_bf16 v[224:227], v[188:191], v[208:211], v[224:227]
    s_waitcnt lgkmcnt(0)
    v_mfma_f32_16x16x32_bf16 v[220:223], v[192:195], v[212:215], v[220:223]
    v_mfma_f32_16x16x32_bf16 v[224:227], v[196:199], v[212:215], v[224:227]
    v_mfma_f32_16x16x32_bf16 v[224:227], v[200:203], v[216:219], v[224:227]
    s_waitcnt vmcnt(3)
    v_cmp_lt_i32 vcc, v36, v35
    s_cbranch_vccz L_fok_43
L_fw_42:
    buffer_load_dword v36, v33, s[4:7], s38 offen sc1
    s_sub_u32 s36, s36, 1
    s_cbranch_scc1 L_exit
    s_waitcnt vmcnt(0)
    v_cmp_lt_i32 vcc, v36, v35
    s_cbranch_vccnz L_fw_42
L_fok_43:
    buffer_load_dwordx4 v37, s[4:7], s48 offen offset:0 sc1 lds
    buffer_load_dwordx4 v37, s[4:7], s48 offen offset:1024 sc1 lds
    buffer_load_dwordx4 v37, s[4:7], s48 offen offset:2048 sc1 lds
    v_cvt_pk_bf16_f32 v220, v220, v221
    v_cvt_pk_bf16_f32 v221, v222, v223
    v_cvt_pk_bf16_f32 v222, v224, v225
    v_cvt_pk_bf16_f32 v223, v226, v227
    v_mov_b32 v224, v220
    v_mov_b32 v225, v221
    v_mov_b32_dpp v220, v222 row_ror:8 row_mask:0xf bank_mask:0xc
    v_mov_b32_dpp v221, v223 row_ror:8 row_mask:0xf bank_mask:0xc
    v_mov_b32_dpp v222, v224 row_ror:8 row_mask:0xf bank_mask:0x3
    v_mov_b32_dpp v223, v225 row_ror:8 row_mask:0xf bank_mask:0x3
    buffer_store_dwordx4 v[220:223], v15, s[4:7], s49 offen
    v_mfma_f32_16x16x32_bf16 v[148:151], a[96:99], a[0:3], 0
    s_mov_b32 s50, s42
    s_add_u32 s56, s37, 1
    v_mov_b32 v47, v24
    v_mfma_f32_16x16x32_bf16 v[152:155], a[120:123], a[0:3], 0
    s_and_b32 s55, s56, 3
    s_mul_i32 s41, s55, 327680
    s_mul_i32 s56, s55, 114688
    v_mfma_f32_16x16x32_bf16 v[156:159], a[96:99], a[24:27], 0
    s_add_u32 s43, s38, s56
    s_xor_b32 s55, s55, 2
    s_mul_i32 s42, s55, 327680
    v_mfma_f32_16x16x32_bf16 v[160:163], a[120:123], a[24:27], 0
    s_add_u32 s56, s37, 2
    v_mov_b32 v107, s56
    s_and_b32 s55, s56, 3
    v_mfma_f32_16x16x32_bf16 v[180:183], a[96:99], a[48:51], 0
    s_mul_i32 s44, s55, 24576
    s_add_u32 s56, s37, -1
    s_and_b32 s55, s56, 3
    v_mfma_f32_16x16x32_bf16 v[184:187], a[120:123], a[48:51], 0
    s_mul_i32 s55, s55, 40960
    s_add_u32 s49, s55, s38
    s_add_u32 s56, s37, -1
    v_mfma_f32_16x16x32_bf16 v[188:191], a[96:99], a[72:75], 0
    s_and_b32 s55, s56, 3
    s_mul_i32 s55, s55, 24576
    v_add_u32 v26, s55, v22
    v_mfma_f32_16x16x32_bf16 v[192:195], a[120:123], a[72:75], 0
    buffer_load_dwordx4 a[96:99], v40, s[4:7], s45 offen offset:0 sc1
    v_mfma_f32_16x16x32_bf16 v[148:151], a[100:103], a[4:7], v[148:151]
    v_add_u32 v27, s55, v23
    s_and_b32 s55, s56, 1
    s_mul_i32 s55, s55, 12288
    v_mfma_f32_16x16x32_bf16 v[152:155], a[124:127], a[4:7], v[152:155]
    buffer_load_dwordx4 a[120:123], v40, s[4:7], s46 offen offset:2048 sc1
    v_mfma_f32_16x16x32_bf16 v[156:159], a[100:103], a[28:31], v[156:159]
    v_add_u32 v29, s55, v28
    v_mfma_f32_16x16x32_bf16 v[160:163], a[124:127], a[28:31], v[160:163]
    v_mfma_f32_16x16x32_bf16 v[180:183], a[100:103], a[52:55], v[180:183]
    v_mfma_f32_16x16x32_bf16 v[184:187], a[124:127], a[52:55], v[184:187]
    v_mfma_f32_16x16x32_bf16 v[188:191], a[100:103], a[76:79], v[188:191]
    v_mfma_f32_16x16x32_bf16 v[192:195], a[124:127], a[76:79], v[192:195]
    buffer_load_dwordx4 a[100:103], v40, s[4:7], s45 offen offset:1024 sc1
    v_mfma_f32_16x16x32_bf16 v[148:151], a[104:107], a[8:11], v[148:151]
    v_mfma_f32_16x16x32_bf16 v[152:155], a[128:131], a[8:11], v[152:155]
    buffer_load_dwordx4 a[124:127], v40, s[4:7], s46 offen offset:3072 sc1
    v_mfma_f32_16x16x32_bf16 v[156:159], a[104:107], a[32:35], v[156:159]
    v_mfma_f32_16x16x32_bf16 v[160:163], a[128:131], a[32:35], v[160:163]
    v_mfma_f32_16x16x32_bf16 v[180:183], a[104:107], a[56:59], v[180:183]
    v_mfma_f32_16x16x32_bf16 v[184:187], a[128:131], a[56:59], v[184:187]
    v_mfma_f32_16x16x32_bf16 v[188:191], a[104:107], a[80:83], v[188:191]
    v_mfma_f32_16x16x32_bf16 v[192:195], a[128:131], a[80:83], v[192:195]
    buffer_load_dwordx4 a[104:107], v40, s[4:7], s45 offen offset:2048 sc1
    v_mfma_f32_16x16x32_bf16 v[148:151], a[108:111], a[12:15], v[148:151]
    v_mfma_f32_16x16x32_bf16 v[152:155], a[132:135], a[12:15], v[152:155]
    buffer_load_dwordx4 a[128:131], v40, s[4:7], s47 offen offset:0 sc1
    v_mfma_f32_16x16x32_bf16 v[156:159], a[108:111], a[36:39], v[156:159]
    v_mfma_f32_16x16x32_bf16 v[160:163], a[132:135], a[36:39], v[160:163]
    v_mfma_f32_16x16x32_bf16 v[180:183], a[108:111], a[60:63], v[180:183]
    v_mfma_f32_16x16x32_bf16 v[184:187], a[132:135], a[60:63], v[184:187]
    v_mfma_f32_16x16x32_bf16 v[188:191], a[108:111], a[84:87], v[188:191]
    v_mfma_f32_16x16x32_bf16 v[192:195], a[132:135], a[84:87], v[192:195]
    buffer_load_dwordx4 a[108:111], v40, s[4:7], s45 offen offset:3072 sc1
    v_mfma_f32_16x16x32_bf16 v[148:151], a[112:115], a[16:19], v[148:151]
    v_mfma_f32_16x16x32_bf16 v[152:155], a[136:139], a[16:19], v[152:155]
    buffer_load_dwordx4 a[132:135], v40, s[4:7], s47 offen offset:1024 sc1
    v_mfma_f32_16x16x32_bf16 v[156:159], a[112:115], a[40:43], v[156:159]
    v_mfma_f32_16x16x32_bf16 v[160:163], a[136:139], a[40:43], v[160:163]
    v_mfma_f32_16x16x32_bf16 v[180:183], a[112:115], a[64:67], v[180:183]
    v_mfma_f32_16x16x32_bf16 v[184:187], a[136:139], a[64:67], v[184:187]
    v_mfma_f32_16x16x32_bf16 v[188:191], a[112:115], a[88:91], v[188:191]
    v_mfma_f32_16x16x32_bf16 v[192:195], a[136:139], a[88:91], v[192:195]
    v_mfma_f32_16x16x32_bf16 v[148:151], a[116:119], a[20:23], v[148:151]
    v_mfma_f32_16x16x32_bf16 v[152:155], a[140:143], a[20:23], v[152:155]
    v_mfma_f32_16x16x32_bf16 v[156:159], a[116:119], a[44:47], v[156:159]
    v_mfma_f32_16x16x32_bf16 v[160:163], a[140:143], a[44:47], v[160:163]
    v_mfma_f32_16x16x32_bf16 v[180:183], a[116:119], a[68:71], v[180:183]
    v_mfma_f32_16x16x32_bf16 v[184:187], a[140:143], a[68:71], v[184:187]
    v_mfma_f32_16x16x32_bf16 v[188:191], a[116:119], a[92:95], v[188:191]
    v_mfma_f32_16x16x32_bf16 v[192:195], a[140:143], a[92:95], v[192:195]
    v_cvt_pk_bf16_f32 v64, v180, v181
    v_cvt_pk_bf16_f32 v65, v182, v183
    ds_write_b64 v24, v[64:65] offset:12288
    v_cvt_pk_bf16_f32 v68, v184, v185
    v_cvt_pk_bf16_f32 v69, v186, v187
    ds_write_b64 v25, v[68:69] offset:12288
    v_cvt_pk_bf16_f32 v72, v188, v189
    v_cvt_pk_bf16_f32 v73, v190, v191
    ds_write_b64 v24, v[72:73] offset:18432
    v_cvt_pk_bf16_f32 v76, v192, v193
    v_cvt_pk_bf16_f32 v77, v194, v195
    ds_write_b64 v25, v[76:77] offset:18432
    v_cvt_pk_bf16_f32 v48, v148, v149
    v_cvt_pk_bf16_f32 v49, v150, v151
    ds_write_b64 v24, v[48:49] offset:0
    v_cvt_pk_bf16_f32 v52, v152, v153
    v_cvt_pk_bf16_f32 v53, v154, v155
    ds_write_b64 v25, v[52:53] offset:0
    v_cvt_pk_bf16_f32 v56, v156, v157
    v_cvt_pk_bf16_f32 v57, v158, v159
    ds_write_b64 v24, v[56:57] offset:6144
    v_cvt_pk_bf16_f32 v60, v160, v161
    v_cvt_pk_bf16_f32 v61, v162, v163
    ds_write_b64 v25, v[60:61] offset:6144
    s_add_u32 s37, s37, 1
    s_mov_b32 m0, s53
    v_add_u32 v24, s44, v20
    v_add_u32 v25, s44, v21
    v_pk_mul_f32 v[148:149], v[210:211], v[210:211]
    v_pk_mul_f32 v[150:151], v[210:211], v[210:211]
    v_pk_mul_f32 v[152:153], v[210:211], v[210:211]
    v_pk_mul_f32 v[154:155], v[210:211], v[210:211]
    v_pk_mul_f32 v[156:157], v[210:211], v[210:211]
    v_pk_mul_f32 v[158:159], v[210:211], v[210:211]
    v_pk_mul_f32 v[160:161], v[210:211], v[210:211]
    v_pk_mul_f32 v[162:163], v[210:211], v[210:211]
    buffer_load_dwordx4 a[112:115], v40, s[4:7], s46 offen offset:0 sc1
    buffer_load_dwordx4 a[136:139], v40, s[4:7], s47 offen offset:2048 sc1
    buffer_load_dwordx4 a[116:119], v40, s[4:7], s46 offen offset:1024 sc1
    buffer_load_dwordx4 a[140:143], v40, s[4:7], s47 offen offset:3072 sc1
    s_branch L_wo_loop_f
L_wo_tail_f:
    ds_write_b32 v47, v50 offset:8
    ds_write_b32 v47, v58 offset:6152
    ds_write_b32 v47, v66 offset:12296
    ds_write_b32 v47, v74 offset:18440
    s_add_u32 s91, s38, 81920
    buffer_load_dwordx4 v[120:123], v15, s[4:7], s91 offen sc1
    s_add_u32 s91, s38, 122880
    buffer_load_dwordx4 v[124:127], v15, s[4:7], s91 offen sc1
    s_add_u32 s56, s37, -1
    s_and_b32 s55, s56, 3
    s_mul_i32 s55, s55, 114688
    s_add_u32 s55, s55, 53248
    s_add_u32 s48, s38, s55
    s_and_b32 s55, s56, 1
    s_add_u32 s56, s56, 1
    v_mov_b32 v35, -16
    v_writelane_b32 v35, s56, 12
    s_mul_i32 s55, s55, 12288
    s_add_u32 m0, s54, s55
    buffer_load_dword v36, v33, s[4:7], s38 offen sc1
    v_mov_b32 v3, 200
L_p0_44:
    buffer_load_dword v4, v3, s[8:11], 0 offen sc1
    s_sub_u32 s36, s36, 1
    s_cbranch_scc1 L_exit
    s_waitcnt vmcnt(0)
    v_readfirstlane_b32 s90, v4
    s_nop 0
    s_cmp_eq_u32 s90, 0
    s_cbranch_scc1 L_p0_44
    s_and_b32 s90, s90, 2
    s_lshl_b32 s90, s90, 12
    v_xor_b32 v30, s90, v30
    v_xor_b32 v31, s90, v31
    s_waitcnt lgkmcnt(0)
    s_barrier
    v_cmp_lt_i32 vcc, v36, v35
    s_cbranch_vccz L_fok_46
L_fw_45:
    buffer_load_dword v36, v33, s[4:7], s38 offen sc1
    s_sub_u32 s36, s36, 1
    s_cbranch_scc1 L_exit
    s_waitcnt vmcnt(0)
    v_cmp_lt_i32 vcc, v36, v35
    s_cbranch_vccnz L_fw_45
L_fok_46:
    buffer_load_dwordx4 v37, s[4:7], s48 offen offset:0 sc1 lds
    buffer_load_dwordx4 v37, s[4:7], s48 offen offset:1024 sc1 lds
    buffer_load_dwordx4 v37, s[4:7], s48 offen offset:2048 sc1 lds
    v_mov_b32 v128, v220
    v_mov_b32 v129, v221
    v_mov_b32 v130, v222
    v_mov_b32 v131, v223
    s_add_u32 s56, s37, -2
    s_and_b32 s55, s56, 3
    s_mul_i32 s55, s55, 24576
    v_add_u32 v26, s55, v22
    v_add_u32 v27, s55, v23
    s_and_b32 s55, s56, 1
    s_mul_i32 s55, s55, 12288
    v_add_u32 v29, s55, v28
    ds_read_b128 v[204:207], v26 offset:0
    ds_read_b128 v[180:183], v29 offset:0
    ds_read_b128 v[184:187], v29 offset:1024
    ds_read_b64 v[208:209], v27 offset:0
    ds_read_b128 v[188:191], v29 offset:2048
    ds_read_b128 v[212:215], v26 offset:1536
    ds_read_b128 v[192:195], v29 offset:3072
    ds_read_b128 v[196:199], v29 offset:4096
    ds_read_b64 v[216:217], v27 offset:1536
    ds_read_b128 v[200:203], v29 offset:5120
    s_waitcnt lgkmcnt(5)
    v_mfma_f32_16x16x32_bf16 v[220:223], v[180:183], v[204:207], 0
    v_mfma_f32_16x16x32_bf16 v[224:227], v[184:187], v[204:207], 0
    v_mfma_f32_16x16x32_bf16 v[224:227], v[188:191], v[208:211], v[224:227]
    ds_read_b128 v[204:207], v26 offset:3072
    ds_read_b128 v[180:183], v29 offset:6144
    ds_read_b128 v[184:187], v29 offset:7168
    ds_read_b64 v[208:209], v27 offset:3072
    ds_read_b128 v[188:191], v29 offset:8192
    s_waitcnt lgkmcnt(5)
    v_mfma_f32_16x16x32_bf16 v[220:223], v[192:195], v[212:215], v[220:223]
    v_mfma_f32_16x16x32_bf16 v[224:227], v[196:199], v[212:215], v[224:227]
    v_mfma_f32_16x16x32_bf16 v[224:227], v[200:203], v[216:219], v[224:227]
    ds_read_b128 v[212:215], v26 offset:4608
    ds_read_b128 v[192:195], v29 offset:9216
    ds_read_b128 v[196:199], v29 offset:10240
    ds_read_b64 v[216:217], v27 offset:4608
    ds_read_b128 v[200:203], v29 offset:11264
    s_waitcnt lgkmcnt(5)
    v_mfma_f32_16x16x32_bf16 v[220:223], v[180:183], v[204:207], v[220:223]
    v_mfma_f32_16x16x32_bf16 v[224:227], v[184:187], v[204:207], v[224:227]
    v_mfma_f32_16x16x32_bf16 v[224:227], v[188:191], v[208:211], v[224:227]
    s_waitcnt lgkmcnt(0)
    v_mfma_f32_16x16x32_bf16 v[220:223], v[192:195], v[212:215], v[220:223]
    v_mfma_f32_16x16x32_bf16 v[224:227], v[196:199], v[212:215], v[224:227]
    v_mfma_f32_16x16x32_bf16 v[224:227], v[200:203], v[216:219], v[224:227]
    s_nop 0
    v_cvt_pk_bf16_f32 v220, v220, v221
    v_cvt_pk_bf16_f32 v221, v222, v223
    s_nop 4
    v_cvt_pk_bf16_f32 v222, v224, v225
    v_cvt_pk_bf16_f32 v223, v226, v227
    v_mov_b32 v224, v220
    v_mov_b32 v225, v221
    v_mov_b32_dpp v220, v222 row_ror:8 row_mask:0xf bank_mask:0xc
    v_mov_b32_dpp v221, v223 row_ror:8 row_mask:0xf bank_mask:0xc
    v_mov_b32_dpp v222, v224 row_ror:8 row_mask:0xf bank_mask:0x3
    v_mov_b32_dpp v223, v225 row_ror:8 row_mask:0xf bank_mask:0x3
    v_mov_b32 v132, v220
    v_mov_b32 v133, v221
    v_mov_b32 v134, v222
    v_mov_b32 v135, v223
    s_waitcnt vmcnt(0)
    s_barrier
    s_add_u32 s56, s37, -1
    s_and_b32 s55, s56, 3
    s_mul_i32 s55, s55, 24576
    v_add_u32 v26, s55, v22
    v_add_u32 v27, s55, v23
    s_and_b32 s55, s56, 1
    s_mul_i32 s55, s55, 12288
    v_add_u32 v29, s55, v28
    ds_read_b128 v[204:207], v26 offset:0
    ds_read_b128 v[180:183], v29 offset:0
    ds_read_b128 v[184:187], v29 offset:1024
    ds_read_b64 v[208:209], v27 offset:0
    ds_read_b128 v[188:191], v29 offset:2048
    ds_read_b128 v[212:215], v26 offset:1536
    ds_read_b128 v[192:195], v29 offset:3072
    ds_read_b128 v[196:199], v29 offset:4096
    ds_read_b64 v[216:217], v27 offset:1536
    ds_read_b128 v[200:203], v29 offset:5120
    s_waitcnt lgkmcnt(5)
    v_mfma_f32_16x16x32_bf16 v[220:223], v[180:183], v[204:207], 0
    v_mfma_f32_16x16x32_bf16 v[224:227], v[184:187], v[204:207], 0
    v_mfma_f32_16x16x32_bf16 v[224:227], v[188:191], v[208:211], v[224:227]
    ds_read_b128 v[204:207], v26 offset:3072
    ds_read_b128 v[180:183], v29 offset:6144
    ds_read_b128 v[184:187], v29 offset:7168
    ds_read_b64 v[208:209], v27 offset:3072
    ds_read_b128 v[188:191], v29 offset:8192
    s_waitcnt lgkmcnt(5)
    v_mfma_f32_16x16x32_bf16 v[220:223], v[192:195], v[212:215], v[220:223]
    v_mfma_f32_16x16x32_bf16 v[224:227], v[196:199], v[212:215], v[224:227]
    v_mfma_f32_16x16x32_bf16 v[224:227], v[200:203], v[216:219], v[224:227]
    ds_read_b128 v[212:215], v26 offset:4608
    ds_read_b128 v[192:195], v29 offset:9216
    ds_read_b128 v[196:199], v29 offset:10240
    ds_read_b64 v[216:217], v27 offset:4608
    ds_read_b128 v[200:203], v29 offset:11264
    s_waitcnt lgkmcnt(5)
    v_mfma_f32_16x16x32_bf16 v[220:223], v[180:183], v[204:207], v[220:223]
    v_mfma_f32_16x16x32_bf16 v[224:227], v[184:187], v[204:207], v[224:227]
    v_mfma_f32_16x16x32_bf16 v[224:227], v[188:191], v[208:211], v[224:227]
    s_waitcnt lgkmcnt(0)
    v_mfma_f32_16x16x32_bf16 v[220:223], v[192:195], v[212:215], v[220:223]
    v_mfma_f32_16x16x32_bf16 v[224:227], v[196:199], v[212:215], v[224:227]
    v_mfma_f32_16x16x32_bf16 v[224:227], v[200:203], v[216:219], v[224:227]
    s_nop 0
    v_cvt_pk_bf16_f32 v220, v220, v221
    v_cvt_pk_bf16_f32 v221, v222, v223
    s_nop 4
    v_cvt_pk_bf16_f32 v222, v224, v225
    v_cvt_pk_bf16_f32 v223, v226, v227
    v_mov_b32 v224, v220
    v_mov_b32 v225, v221
    v_mov_b32_dpp v220, v222 row_ror:8 row_mask:0xf bank_mask:0xc
    v_mov_b32_dpp v221, v223 row_ror:8 row_mask:0xf bank_mask:0xc
    v_mov_b32_dpp v222, v224 row_ror:8 row_mask:0xf bank_mask:0x3
    v_mov_b32_dpp v223, v225 row_ror:8 row_mask:0xf bank_mask:0x3
    v_mov_b32 v80, v220
    v_mov_b32 v81, v221
    v_mov_b32 v82, v222
    v_mov_b32 v83, v223
    s_add_u32 s56, s37, 0
    s_and_b32 s55, s56, 3
    s_mul_i32 s55, s55, 114688
    s_add_u32 s55, s55, 53248
    s_add_u32 s48, s38, s55
    s_and_b32 s55, s56, 1
    s_add_u32 s56, s56, 1
    v_mov_b32 v35, -16
    v_writelane_b32 v35, s56, 12
    s_mul_i32 s55, s55, 12288
    s_add_u32 m0, s54, s55
    s_add_u32 s56, s37, 0
    s_and_b32 s55, s56, 3
    s_mul_i32 s55, s55, 24576
    v_add_u32 v26, s55, v22
    v_add_u32 v27, s55, v23
    s_and_b32 s55, s56, 1
    s_mul_i32 s55, s55, 12288
    v_add_u32 v29, s55, v28
    buffer_load_dword v36, v33, s[4:7], s38 offen sc1
    buffer_load_dword v36, v33, s[4:7], s38 offen sc1
    buffer_load_dword v36, v33, s[4:7], s38 offen sc1
    buffer_load_dword v36, v33, s[4:7], s38 offen sc1
    buffer_load_dword v36, v33, s[4:7], s38 offen sc1
L_sp_47:
    s_waitcnt vmcnt(4)
    v_cmp_lt_i32 vcc, v36, v35
    buffer_load_dword v36, v33, s[4:7], s38 offen sc1
    s_sub_u32 s36, s36, 1
    s_cbranch_scc1 L_exit
    s_cbranch_vccz L_sp_47x
    s_waitcnt vmcnt(4)
    v_cmp_lt_i32 vcc, v36, v35
    buffer_load_dword v36, v33, s[4:7], s38 offen sc1
    s_cbranch_vccz L_sp_47x
    s_waitcnt vmcnt(4)
    v_cmp_lt_i32 vcc, v36, v35
    buffer_load_dword v36, v33, s[4:7], s38 offen sc1
    s_cbranch_vccz L_sp_47x
    s_waitcnt vmcnt(4)
    v_cmp_lt_i32 vcc, v36, v35
    buffer_load_dword v36, v33, s[4:7], s38 offen sc1
    s_cbranch_vccnz L_sp_47
L_sp_47x:
    buffer_load_dwordx4 v37, s[4:7], s48 offen offset:0 sc1 lds
    buffer_load_dwordx4 v37, s[4:7], s48 offen offset:1024 sc1 lds
    buffer_load_dwordx4 v37, s[4:7], s48 offen offset:2048 sc1 lds
    s_waitcnt vmcnt(0)
    s_barrier
    s_mov_b32 s49, 7143424
    buffer_store_dwordx4 v[120:123], v30, s[4:7], s49 offen sc1
    s_mov_b32 s49, 6815744
    buffer_store_dwordx4 v[124:127], v30, s[4:7], s49 offen sc1
    s_mov_b32 s49, 6488064
    buffer_store_dwordx4 v[128:131], v30, s[4:7], s49 offen sc1
    s_mov_b32 s49, 6160384
    buffer_store_dwordx4 v[132:135], v30, s[4:7], s49 offen sc1
    s_mov_b32 s49, 5832704
    buffer_store_dwordx4 v[80:83], v30, s[4:7], s49 offen sc1
    ds_read_b128 v[204:207], v26 offset:0
    ds_read_b128 v[180:183], v29 offset:0
    ds_read_b128 v[184:187], v29 offset:1024
    ds_read_b64 v[208:209], v27 offset:0
    ds_read_b128 v[188:191], v29 offset:2048
    ds_read_b128 v[212:215], v26 offset:1536
    ds_read_b128 v[192:195], v29 offset:3072
    ds_read_b128 v[196:199], v29 offset:4096
    ds_read_b64 v[216:217], v27 offset:1536
    ds_read_b128 v[200:203], v29 offset:5120
    s_waitcnt lgkmcnt(5)
    v_mfma_f32_16x16x32_bf16 v[220:223], v[180:183], v[204:207], 0
    v_mfma_f32_16x16x32_bf16 v[224:227], v[184:187], v[204:207], 0
    v_mfma_f32_16x16x32_bf16 v[224:227], v[188:191], v[208:211], v[224:227]
    ds_read_b128 v[204:207], v26 offset:3072
    ds_read_b128 v[180:183], v29 offset:6144
    ds_read_b128 v[184:187], v29 offset:7168
    ds_read_b64 v[208:209], v27 offset:3072
    ds_read_b128 v[188:191], v29 offset:8192
    s_waitcnt lgkmcnt(5)
    v_mfma_f32_16x16x32_bf16 v[220:223], v[192:195], v[212:215], v[220:223]
    v_mfma_f32_16x16x32_bf16 v[224:227], v[196:199], v[212:215], v[224:227]
    v_mfma_f32_16x16x32_bf16 v[224:227], v[200:203], v[216:219], v[224:227]
    ds_read_b128 v[212:215], v26 offset:4608
    ds_read_b128 v[192:195], v29 offset:9216
    ds_read_b128 v[196:199], v29 offset:10240
    ds_read_b64 v[216:217], v27 offset:4608
    ds_read_b128 v[200:203], v29 offset:11264
    s_waitcnt lgkmcnt(5)
    v_mfma_f32_16x16x32_bf16 v[220:223], v[180:183], v[204:207], v[220:223]
    v_mfma_f32_16x16x32_bf16 v[224:227], v[184:187], v[204:207], v[224:227]
    v_mfma_f32_16x16x32_bf16 v[224:227], v[188:191], v[208:211], v[224:227]
    s_waitcnt lgkmcnt(0)
    v_mfma_f32_16x16x32_bf16 v[220:223], v[192:195], v[212:215], v[220:223]
    v_mfma_f32_16x16x32_bf16 v[224:227], v[196:199], v[212:215], v[224:227]
    v_mfma_f32_16x16x32_bf16 v[224:227], v[200:203], v[216:219], v[224:227]
    s_nop 0
    v_cvt_pk_bf16_f32 v220, v220, v221
    v_cvt_pk_bf16_f32 v221, v222, v223
    s_nop 4
    v_cvt_pk_bf16_f32 v222, v224, v225
    v_cvt_pk_bf16_f32 v223, v226, v227
    v_mov_b32 v224, v220
    v_mov_b32 v225, v221
    v_mov_b32_dpp v220, v222 row_ror:8 row_mask:0xf bank_mask:0xc
    v_mov_b32_dpp v221, v223 row_ror:8 row_mask:0xf bank_mask:0xc
    v_mov_b32_dpp v222, v224 row_ror:8 row_mask:0xf bank_mask:0x3
    v_mov_b32_dpp v223, v225 row_ror:8 row_mask:0xf bank_mask:0x3
    s_mov_b32 s49, 5505024
    buffer_store_dwordx4 v[220:223], v30, s[4:7], s49 offen sc1
    s_waitcnt vmcnt(0)
L_fp_48:
    s_mov_b32 s51, 5505024
    buffer_load_dwordx4 v[96:99], v31, s[4:7], s51 offen sc1
    s_mov_b32 s51, 7143424
    buffer_load_dwordx4 v[148:151], v31, s[4:7], s51 offen sc1
    s_mov_b32 s51, 6815744
    buffer_load_dwordx4 v[152:155], v31, s[4:7], s51 offen sc1
    s_mov_b32 s51, 6488064
    buffer_load_dwordx4 v[156:159], v31, s[4:7], s51 offen sc1
    s_mov_b32 s51, 6160384
    buffer_load_dwordx4 v[160:163], v31, s[4:7], s51 offen sc1
    s_mov_b32 s51, 5832704
    buffer_load_dwordx4 v[92:95], v31, s[4:7], s51 offen sc1
    s_sub_u32 s36, s36, 1
    s_cbranch_scc1 L_exit
    s_waitcnt vmcnt(0)
L_fp_48c:
    v_mov_b32 v41, 0
    v_max3_u32 v41, v41, v96, v97
    v_max3_u32 v41, v41, v98, v99
    v_max3_u32 v41, v41, v148, v149
    v_max3_u32 v41, v41, v150, v151
    v_max3_u32 v41, v41, v152, v153
    v_max3_u32 v41, v41, v154, v155
    v_max3_u32 v41, v41, v156, v157
    v_max3_u32 v41, v41, v158, v159
    v_max3_u32 v41, v41, v160, v161
    v_max3_u32 v41, v41, v162, v163
    v_max3_u32 v41, v41, v92, v93
    v_max3_u32 v41, v41, v94, v95
    v_cmp_eq_u32 vcc, -1, v41
    s_cbranch_vccnz L_fp_48
    s_mov_b32 s52, 5160960
    v_mfma_f32_16x16x32_bf16 v[232:235], a[144:147], v[96:99], 0
    s_nop 7
    v_cndmask_b32 v234, v232, v233, s[58:59]
    v_cndmask_b32 v235, v233, v232, s[58:59]
    s_nop 1
    v_add_f32_dpp v235, v234, v235 row_ror:8 row_mask:0xf bank_mask:0xf
    v_cvt_pk_bf16_f32 v235, v235, v235
    buffer_store_short v235, v32, s[28:31], s52 offen offset:0
    s_mov_b32 s52, 4751360
    v_mfma_f32_16x16x32_bf16 v[232:235], a[144:147], v[148:151], 0
    s_nop 7
    v_cndmask_b32 v234, v232, v233, s[58:59]
    v_cndmask_b32 v235, v233, v232, s[58:59]
    s_nop 1
    v_add_f32_dpp v235, v234, v235 row_ror:8 row_mask:0xf bank_mask:0xf
    v_cvt_pk_bf16_f32 v235, v235, v235
    buffer_store_short v235, v32, s[28:31], s52 offen offset:0
    s_mov_b32 s52, 4833280
    v_mfma_f32_16x16x32_bf16 v[232:235], a[144:147], v[152:155], 0
    s_nop 7
    v_cndmask_b32 v234, v232, v233, s[58:59]
    v_cndmask_b32 v235, v233, v232, s[58:59]
    s_nop 1
    v_add_f32_dpp v235, v234, v235 row_ror:8 row_mask:0xf bank_mask:0xf
    v_cvt_pk_bf16_f32 v235, v235, v235
    buffer_store_short v235, v32, s[28:31], s52 offen offset:0
    s_mov_b32 s52, 4915200
    v_mfma_f32_16x16x32_bf16 v[232:235], a[144:147], v[156:159], 0
    s_nop 7
    v_cndmask_b32 v234, v232, v233, s[58:59]
    v_cndmask_b32 v235, v233, v232, s[58:59]
    s_nop 1
    v_add_f32_dpp v235, v234, v235 row_ror:8 row_mask:0xf bank_mask:0xf
    v_cvt_pk_bf16_f32 v235, v235, v235
    buffer_store_short v235, v32, s[28:31], s52 offen offset:0
    s_mov_b32 s52, 4997120
    v_mfma_f32_16x16x32_bf16 v[232:235], a[144:147], v[160:163], 0
    s_nop 7
    v_cndmask_b32 v234, v232, v233, s[58:59]
    v_cndmask_b32 v235, v233, v232, s[58:59]
    s_nop 1
    v_add_f32_dpp v235, v234, v235 row_ror:8 row_mask:0xf bank_mask:0xf
    v_cvt_pk_bf16_f32 v235, v235, v235
    buffer_store_short v235, v32, s[28:31], s52 offen offset:0
    s_mov_b32 s52, 5079040
    v_mfma_f32_16x16x32_bf16 v[232:235], a[144:147], v[92:95], 0
    s_nop 7
    v_cndmask_b32 v234, v232, v233, s[58:59]
    v_cndmask_b32 v235, v233, v232, s[58:59]
    s_nop 1
    v_add_f32_dpp v235, v234, v235 row_ror:8 row_mask:0xf bank_mask:0xf
    v_cvt_pk_bf16_f32 v235, v235, v235
    buffer_store_short v235, v32, s[28:31], s52 offen offset:0
    s_endpgm
L_vm_35:
    buffer_load_dwordx4 v44, s[4:7], s43 offen offset:0 sc1 lds
    buffer_load_dwordx4 v44, s[4:7], s43 offen offset:1024 sc1 lds
    buffer_load_dwordx4 v44, s[4:7], s43 offen offset:2048 sc1 lds
    s_sub_u32 s36, s36, 1
    s_cbranch_scc1 L_exit
    v_add_u32 v5, s53, v12
    s_waitcnt vmcnt(0)
    ds_read_b128 v[136:139], v5 offset:0
    ds_read_b128 v[140:143], v5 offset:1024
    ds_read_b128 v[144:147], v5 offset:2048
    s_waitcnt lgkmcnt(0)
    v_max_u32 v4, v136, v137
    v_max3_u32 v4, v4, v138, v139
    v_max3_u32 v4, v4, v140, v141
    v_max3_u32 v4, v4, v142, v143
    v_max3_u32 v4, v4, v144, v145
    v_max3_u32 v4, v4, v146, v147
    v_cmp_eq_u32 vcc, -1, v4
    s_cbranch_vccnz L_vm_35
    buffer_load_dwordx4 v[92:95], v38, s[4:7], s43 offen offset:0 sc1
    buffer_load_dwordx4 v[96:99], v38, s[4:7], s43 offen offset:1280 sc1
    buffer_load_dwordx4 v[100:103], v38, s[4:7], s43 offen offset:2560 sc1
    buffer_load_dword v104, v39, s[4:7], s43 offen offset:0 sc1
    buffer_load_dword v105, v39, s[4:7], s43 offen offset:1280 sc1
    buffer_load_dword v106, v39, s[4:7], s43 offen offset:2560 sc1
    ds_read_b64_tr_b16 v[136:137], v16 offset:0
    ds_read_b64_tr_b16 v[138:139], v13 offset:0
    ds_read_b64_tr_b16 v[140:141], v16 offset:1024
    ds_read_b64_tr_b16 v[142:143], v13 offset:1024
    ds_read_b64_tr_b16 v[144:145], v16 offset:2048
    ds_read_b64_tr_b16 v[146:147], v13 offset:2048
    v_mov_b32 v148, 0
    v_mov_b32 v149, 0
    v_mov_b32 v150, 0
    v_mov_b32 v151, 0
    v_mov_b32 v152, 0
    v_mov_b32 v153, 0
    v_mov_b32 v154, 0
    v_mov_b32 v155, 0
    v_mov_b32 v156, 0
    v_mov_b32 v157, 0
    v_mov_b32 v158, 0
    v_mov_b32 v159, 0
    v_mov_b32 v160, 0
    v_mov_b32 v161, 0
    v_mov_b32 v162, 0
    v_mov_b32 v163, 0
    s_waitcnt lgkmcnt(0)
    v_smfmac_f32_16x16x64_bf16 v[148:151], v[136:139], a[0:7], v10
    v_smfmac_f32_16x16x64_bf16 v[152:155], v[136:139], a[24:31], v10
    v_smfmac_f32_16x16x64_bf16 v[156:159], v[136:139], a[48:55], v10
    v_smfmac_f32_16x16x64_bf16 v[160:163], v[136:139], a[72:79], v10
    v_smfmac_f32_16x16x64_bf16 v[148:151], v[140:143], a[8:15], v10
    v_smfmac_f32_16x16x64_bf16 v[152:155], v[140:143], a[32:39], v10
    v_smfmac_f32_16x16x64_bf16 v[156:159], v[140:143], a[56:63], v10
    v_smfmac_f32_16x16x64_bf16 v[160:163], v[140:143], a[80:87], v10
    v_smfmac_f32_16x16x64_bf16 v[148:151], v[144:147], a[16:23], v10
    v_smfmac_f32_16x16x64_bf16 v[152:155], v[144:147], a[40:47], v10
    v_smfmac_f32_16x16x64_bf16 v[156:159], v[144:147], a[64:71], v10
    v_smfmac_f32_16x16x64_bf16 v[160:163], v[144:147], a[88:95], v10
    v_pk_add_f32 v[148:149], v[148:149], v[150:151]
    v_cmp_u_f32 vcc, v148, v149
    v_cvt_pk_bf16_f32 v50, v148, v149
    v_cvt_pk_bf16_f32 v54, v148, v149
    v_pk_add_f32 v[152:153], v[152:153], v[154:155]
    v_cvt_pk_bf16_f32 v58, v152, v153
    v_cvt_pk_bf16_f32 v62, v152, v153
    v_pk_add_f32 v[156:157], v[156:157], v[158:159]
    v_cvt_pk_bf16_f32 v66, v156, v157
    v_cvt_pk_bf16_f32 v70, v156, v157
    v_pk_add_f32 v[160:161], v[160:161], v[162:163]
    v_cvt_pk_bf16_f32 v74, v160, v161
    v_cvt_pk_bf16_f32 v78, v160, v161
    s_cmp_eq_u32 s37, 63
    s_branch L_u_36
L_sp_39:
    v_max3_u32 v4, v104, v105, v106
    v_max3_u32 v4, v4, v92, v93
    v_max3_u32 v4, v4, v94, v95
    v_max3_u32 v4, v4, v96, v97
    v_max3_u32 v4, v4, v98, v99
    v_max3_u32 v4, v4, v100, v101
    v_max3_u32 v4, v4, v102, v103
    v_cmp_eq_u32 vcc, -1, v4
    s_cbranch_vccz L_sg_40
    buffer_load_dwordx4 v[92:95], v38, s[4:7], s43 offen offset:0 sc1
    buffer_load_dwordx4 v[96:99], v38, s[4:7], s43 offen offset:1280 sc1
    buffer_load_dwordx4 v[100:103], v38, s[4:7], s43 offen offset:2560 sc1
    buffer_load_dword v104, v39, s[4:7], s43 offen offset:0 sc1
    buffer_load_dword v105, v39, s[4:7], s43 offen offset:1280 sc1
    buffer_load_dword v106, v39, s[4:7], s43 offen offset:2560 sc1
    s_sub_u32 s36, s36, 1
    s_cbranch_scc1 L_exit
    s_branch L_sc_38
L_px_f:
    v_and_b32 v1, 15, v0
    v_lshrrev_b32 v2, 4, v0
    s_mul_i32 s90, s32, 12288
    v_lshl_add_u32 v10, v0, 4, s90
    s_mul_i32 s90, s32, 3072
    v_lshl_add_u32 v12, v0, 4, s90
    v_lshrrev_b32 v3, 2, v1
    v_lshlrev_b32 v3, 1, v3
    v_and_b32 v4, 1, v1
    v_or_b32 v3, v3, v4
    v_lshl_add_u32 v3, v2, 3, v3
    v_lshl_add_u32 v11, v3, 4, s90
    s_lshl_b32 s90, s32, 7
    v_min_u32 v3, 11, v0
    v_lshl_add_u32 v3, v3, 2, s90
    v_add_u32 v13, 458752, v3
    v_min_u32 v3, 2, v0
    v_lshl_add_u32 v3, v3, 2, s90
    v_add_u32 v14, 459264, v3
    v_add_u32 v22, 462336, v3
    s_add_u32 s90, s90, 459776
    v_mov_b32 v15, s90
    v_cmp_eq_u32 vcc, 0, v0
    v_mov_b32 v9, 2146435072
    s_nop 0
    v_cndmask_b32 v15, v9, v15, vcc
    s_nop 0
    v_mov_b32 v21, 0xd04e79ff
    s_mov_b32 s44, 0x3dd53b95
    v_lshl_add_u32 v3, v2, 2, 0
    v_cmp_le_u32 s[48:49], v3, v1
    v_lshl_add_u32 v3, v2, 2, 1
    v_cmp_le_u32 s[50:51], v3, v1
    v_lshl_add_u32 v3, v2, 2, 2
    v_cmp_le_u32 s[52:53], v3, v1
    v_lshl_add_u32 v3, v2, 2, 3
    v_cmp_le_u32 s[54:55], v3, v1
    v_mov_b32 v167, 0
    v_mov_b32 v171, 0
    v_mov_b32 v174, 0
    v_mov_b32 v175, 0
    s_waitcnt vmcnt(0)
    s_barrier
    s_mov_b32 s37, 0
    s_or_b32 s90, s34, s32
    s_cbranch_scc1 L_xg_49c
    v_lshlrev_b32 v1, 2, v0
L_arp_51:
    buffer_load_dword v2, v1, s[8:11], 0 offen sc1
    s_sub_u32 s36, s36, 1
    s_cbranch_scc1 L_exit
    s_waitcnt vmcnt(0)
    v_readlane_b32 s92, v2, 12
    v_readlane_b32 s93, v2, 44
    v_cmp_eq_u32 s[90:91], 32, v2
    s_add_u32 s92, s92, s93
    s_cmp_lg_u32 s92, 256
    s_cbranch_scc1 L_arp_51
    s_and_b32 s90, s90, s91
    s_and_b32 s90, s90, 15
    s_cmp_lg_u32 s90, 15
    s_cbranch_scc1 L_arr_50
    v_mov_b32 v1, 192
    v_mov_b32 v2, 1
    s_mov_b64 exec, 1
    buffer_store_dword v2, v1, s[8:11], 0 offen sc1
    s_mov_b64 exec, -1
L_arr_50:
L_xg_49c:
    s_barrier
    v_mov_b32 v1, 192
L_gw_52:
    buffer_load_dword v2, v1, s[8:11], 0 offen sc1
    s_sub_u32 s36, s36, 1
    s_cbranch_scc1 L_exit
    s_waitcnt vmcnt(0)
    v_readfirstlane_b32 s90, v2
    s_nop 0
    s_cmp_eq_u32 s90, 0
    s_cbranch_scc1 L_gw_52
    s_cmp_lg_u32 s90, 1
    s_cbranch_scc1 L_slow
    s_cmp_lg_u32 s32, 0
    s_cbranch_scc1 L_xg_49
    s_lshl_b32 s92, s34, 14
    s_add_u32 s92, s92, 1966080
    s_add_u32 s93, s92, 8192
    v_lshlrev_b32 v3, 4, v0
    buffer_store_dwordx4 v[24:27], v3, s[4:7], s92 offen offset:0 sc1
    buffer_store_dwordx4 v[24:27], v3, s[4:7], s93 offen offset:0 sc1
    buffer_store_dwordx4 v[24:27], v3, s[4:7], s92 offen offset:1024 sc1
    buffer_store_dwordx4 v[24:27], v3, s[4:7], s93 offen offset:1024 sc1
    buffer_store_dwordx4 v[24:27], v3, s[4:7], s92 offen offset:2048 sc1
    buffer_store_dwordx4 v[24:27], v3, s[4:7], s93 offen offset:2048 sc1
    buffer_store_dwordx4 v[24:27], v3, s[4:7], s92 offen offset:3072 sc1
    buffer_store_dwordx4 v[24:27], v3, s[4:7], s93 offen offset:3072 sc1
    v_mov_b32 v3, 0
    s_mov_b32 s56, -1
    s_mov_b32 s57, -1
    s_mov_b32 s62, 0
    s_mov_b32 s63, 0
    s_waitcnt vmcnt(0)
L_pr_53:
    s_memtime s[58:59]
    s_waitcnt lgkmcnt(0)
    buffer_load_dword v4, v3, s[4:7], s92 offen sc1
    s_waitcnt vmcnt(0)
    s_memtime s[60:61]
    s_waitcnt lgkmcnt(0)
    s_sub_u32 s60, s60, s58
    s_min_u32 s56, s56, s60
    s_memtime s[58:59]
    s_waitcnt lgkmcnt(0)
    buffer_load_dword v4, v3, s[4:7], s93 offen sc1
    s_waitcnt vmcnt(0)
    s_memtime s[60:61]
    s_waitcnt lgkmcnt(0)
    s_sub_u32 s60, s60, s58
    s_min_u32 s57, s57, s60
    buffer_load_dword v4, v13, s[4:7], s38 offen sc1
    v_add_u32 v3, 128, v3
    s_add_u32 s62, s62, 1
    s_waitcnt vmcnt(0)
    v_cmp_eq_u32 vcc, 0, v4
    s_nop 0
    s_cmp_eq_u64 vcc, 0
    s_addc_u32 s63, s63, 0
    s_cmp_ge_u32 s63, 2
    s_cselect_b32 s62, 32, s62
    s_min_u32 s58, s56, s57
    s_max_u32 s59, s56, s57
    s_sub_u32 s59, s59, s58
    s_cmp_ge_u32 s59, 150
    s_cselect_b32 s58, s58, -1
    s_cmp_le_u32 s58, 540
    s_cselect_b32 s62, 32, s62
    s_cmp_lt_u32 s62, 32
    s_cbranch_scc1 L_pr_53
    s_cmp_lt_u32 s57, s56
    s_cselect_b32 s62, 2, 1
    s_nop 0
    v_mov_b32 v3, 460288
    v_mov_b32 v4, s62
    buffer_store_dword v4, v3, s[4:7], s38 offen
    s_cmp_lg_u32 s34, 0
    s_cbranch_scc1 L_xg_49
    v_mov_b32 v3, 200
    buffer_store_dword v4, v3, s[8:11], 0 offen sc1
L_xg_49:
    s_barrier
    s_add_u32 s41, s38, 475136
    buffer_load_dword v16, v22, s[4:7], s38 offen sc1
    buffer_load_dword v16, v22, s[4:7], s38 offen sc1
L_sp_54:
    s_waitcnt vmcnt(1)
    v_cmp_ge_u32 vcc, s37, v16
    buffer_load_dword v16, v22, s[4:7], s38 offen sc1
    s_sub_u32 s36, s36, 1
    s_cbranch_scc1 L_exit
    s_cbranch_vccz L_sp_54x
    s_waitcnt vmcnt(1)
    v_cmp_ge_u32 vcc, s37, v16
    buffer_load_dword v16, v22, s[4:7], s38 offen sc1
    s_cbranch_vccz L_sp_54x
    s_waitcnt vmcnt(1)
    v_cmp_ge_u32 vcc, s37, v16
    buffer_load_dword v16, v22, s[4:7], s38 offen sc1
    s_cbranch_vccz L_sp_54x
    s_waitcnt vmcnt(1)
    v_cmp_ge_u32 vcc, s37, v16
    buffer_load_dword v16, v22, s[4:7], s38 offen sc1
    s_cbranch_vccnz L_sp_54
L_sp_54x:
    s_add_u32 s90, s41, 49152
    buffer_load_dwordx4 v[72:75], v10, s[4:7], s90 offen offset:0 sc1
    buffer_load_dwordx4 v[76:79], v10, s[4:7], s90 offen offset:1024 sc1
    buffer_load_dwordx4 v[80:83], v10, s[4:7], s90 offen offset:2048 sc1
    buffer_load_dwordx4 v[84:87], v10, s[4:7], s90 offen offset:3072 sc1
    s_add_u32 s90, s41, 53248
    buffer_load_dwordx4 v[88:91], v10, s[4:7], s90 offen offset:0 sc1
    buffer_load_dwordx4 v[92:95], v10, s[4:7], s90 offen offset:1024 sc1
    buffer_load_dwordx4 v[96:99], v10, s[4:7], s90 offen offset:2048 sc1
    buffer_load_dwordx4 v[100:103], v10, s[4:7], s90 offen offset:3072 sc1
    s_add_u32 s90, s41, 57344
    buffer_load_dwordx4 v[104:107], v10, s[4:7], s90 offen offset:0 sc1
    buffer_load_dwordx4 v[108:111], v10, s[4:7], s90 offen offset:1024 sc1
    buffer_load_dwordx4 v[112:115], v10, s[4:7], s90 offen offset:2048 sc1
    buffer_load_dwordx4 v[116:119], v10, s[4:7], s90 offen offset:3072 sc1
    s_add_u32 s90, s41, 0
    buffer_load_dwordx4 v[24:27], v10, s[4:7], s90 offen offset:0 sc1
    buffer_load_dwordx4 v[28:31], v10, s[4:7], s90 offen offset:1024 sc1
    buffer_load_dwordx4 v[32:35], v10, s[4:7], s90 offen offset:2048 sc1
    buffer_load_dwordx4 v[36:39], v10, s[4:7], s90 offen offset:3072 sc1
    s_add_u32 s90, s41, 4096
    buffer_load_dwordx4 v[40:43], v10, s[4:7], s90 offen offset:0 sc1
    buffer_load_dwordx4 v[44:47], v10, s[4:7], s90 offen offset:1024 sc1
    buffer_load_dwordx4 v[48:51], v10, s[4:7], s90 offen offset:2048 sc1
    buffer_load_dwordx4 v[52:55], v10, s[4:7], s90 offen offset:3072 sc1
    s_add_u32 s90, s41, 8192
    buffer_load_dwordx4 v[56:59], v10, s[4:7], s90 offen offset:0 sc1
    buffer_load_dwordx4 v[60:63], v10, s[4:7], s90 offen offset:1024 sc1
    buffer_load_dwordx4 v[64:67], v10, s[4:7], s90 offen offset:2048 sc1
    buffer_load_dwordx4 v[68:71], v10, s[4:7], s90 offen offset:3072 sc1
    s_waitcnt vmcnt(0)
L_px_loop_f:
    s_and_b32 s90, s37, 3
    s_mul_i32 s91, s90, 114688
    s_add_u32 s91, s91, s38
    s_add_u32 s42, s91, 40960
    s_add_u32 s43, s91, 53248
    s_add_u32 s90, s37, 1
    v_mov_b32 v17, s90
    s_and_b32 s90, s90, 3
    s_mul_i32 s91, s90, 98304
    s_add_u32 s91, s91, 475136
    s_add_u32 s41, s38, s91
    v_mfma_f32_16x16x32_bf16 v[144:147], v[72:75], v[24:27], 0
    v_mfma_f32_16x16x32_bf16 v[152:155], v[72:75], v[48:51], 0
    v_mfma_f32_16x16x32_bf16 v[156:159], v[96:99], v[48:51], 0
    v_mfma_f32_16x16x32_bf16 v[144:147], v[76:79], v[28:31], v[144:147]
    v_mfma_f32_16x16x32_bf16 v[152:155], v[76:79], v[52:55], v[152:155]
    v_mfma_f32_16x16x32_bf16 v[156:159], v[100:103], v[52:55], v[156:159]
    v_mfma_f32_16x16x32_bf16 v[144:147], v[80:83], v[32:35], v[144:147]
    v_mfma_f32_16x16x32_bf16 v[152:155], v[80:83], v[56:59], v[152:155]
    v_mfma_f32_16x16x32_bf16 v[156:159], v[104:107], v[56:59], v[156:159]
    v_mfma_f32_16x16x32_bf16 v[144:147], v[84:87], v[36:39], v[144:147]
    v_mfma_f32_16x16x32_bf16 v[152:155], v[84:87], v[60:63], v[152:155]
    v_mfma_f32_16x16x32_bf16 v[156:159], v[108:111], v[60:63], v[156:159]
    v_mfma_f32_16x16x32_bf16 v[144:147], v[88:91], v[40:43], v[144:147]
    v_mfma_f32_16x16x32_bf16 v[152:155], v[88:91], v[64:67], v[152:155]
    v_mfma_f32_16x16x32_bf16 v[156:159], v[112:115], v[64:67], v[156:159]
    v_mfma_f32_16x16x32_bf16 v[144:147], v[92:95], v[44:47], v[144:147]
    v_mfma_f32_16x16x32_bf16 v[152:155], v[92:95], v[68:71], v[152:155]
    v_mfma_f32_16x16x32_bf16 v[156:159], v[116:119], v[68:71], v[156:159]
    s_nop 0
    v_cndmask_b32 v144, v21, v144, s[48:49]
    v_cndmask_b32 v145, v21, v145, s[50:51]
    v_cndmask_b32 v146, v21, v146, s[52:53]
    v_cndmask_b32 v147, v21, v147, s[54:55]
    s_nop 2
    v_cndmask_b32 v156, v21, v156, s[48:49]
    v_cndmask_b32 v157, v21, v157, s[50:51]
    v_cndmask_b32 v158, v21, v158, s[52:53]
    v_cndmask_b32 v159, v21, v159, s[54:55]
    buffer_load_dword v16, v14, s[4:7], s38 offen sc1
    buffer_load_dword v16, v14, s[4:7], s38 offen sc1
L_sp_55:
    s_waitcnt vmcnt(1)
    v_cmp_ge_u32 vcc, s37, v16
    buffer_load_dword v16, v14, s[4:7], s38 offen sc1
    s_sub_u32 s36, s36, 1
    s_cbranch_scc1 L_exit
    s_cbranch_vccz L_sp_55x
    s_waitcnt vmcnt(1)
    v_cmp_ge_u32 vcc, s37, v16
    buffer_load_dword v16, v14, s[4:7], s38 offen sc1
    s_cbranch_vccz L_sp_55x
    s_waitcnt vmcnt(1)
    v_cmp_ge_u32 vcc, s37, v16
    buffer_load_dword v16, v14, s[4:7], s38 offen sc1
    s_cbranch_vccz L_sp_55x
    s_waitcnt vmcnt(1)
    v_cmp_ge_u32 vcc, s37, v16
    buffer_load_dword v16, v14, s[4:7], s38 offen sc1
    s_cbranch_vccnz L_sp_55
L_sp_55x:
    buffer_load_dwordx4 v[120:123], v11, s[4:7], s42 offen offset:0 sc1
    buffer_load_dwordx4 v[124:127], v11, s[4:7], s42 offen offset:512 sc1
    buffer_load_dwordx4 v[128:131], v11, s[4:7], s42 offen offset:1024 sc1
    buffer_load_dwordx4 v[132:135], v11, s[4:7], s42 offen offset:1536 sc1
    buffer_load_dwordx4 v[136:139], v11, s[4:7], s42 offen offset:2048 sc1
    buffer_load_dwordx4 v[140:143], v11, s[4:7], s42 offen offset:2560 sc1
    s_waitcnt vmcnt(5)
    v_mfma_f32_16x16x32_bf16 v[148:151], v[120:123], v[24:27], 0
    v_mfma_f32_16x16x32_bf16 v[160:163], v[120:123], v[48:51], 0
    s_waitcnt vmcnt(4)
    v_mfma_f32_16x16x32_bf16 v[148:151], v[124:127], v[28:31], v[148:151]
    v_mfma_f32_16x16x32_bf16 v[160:163], v[124:127], v[52:55], v[160:163]
    s_waitcnt vmcnt(3)
    v_mfma_f32_16x16x32_bf16 v[148:151], v[128:131], v[32:35], v[148:151]
    v_mfma_f32_16x16x32_bf16 v[160:163], v[128:131], v[56:59], v[160:163]
    s_waitcnt vmcnt(2)
    v_mfma_f32_16x16x32_bf16 v[148:151], v[132:135], v[36:39], v[148:151]
    v_mfma_f32_16x16x32_bf16 v[160:163], v[132:135], v[60:63], v[160:163]
    s_waitcnt vmcnt(1)
    v_mfma_f32_16x16x32_bf16 v[148:151], v[136:139], v[40:43], v[148:151]
    v_mfma_f32_16x16x32_bf16 v[160:163], v[136:139], v[64:67], v[160:163]
    s_waitcnt vmcnt(0)
    v_mfma_f32_16x16x32_bf16 v[148:151], v[140:143], v[44:47], v[148:151]
    v_mfma_f32_16x16x32_bf16 v[160:163], v[140:143], v[68:71], v[160:163]
    s_cmp_eq_u32 s37, 63
    s_nop 2
    s_cbranch_scc1 L_pxl_56
    s_add_u32 s90, s41, 49152
    v_max_f32 v18, v144, v145
    v_max3_f32 v18, v18, v146, v147
    v_max3_f32 v18, v18, v148, v149
    v_mov_b32 v19, v18
    buffer_load_dwordx4 v[72:75], v10, s[4:7], s90 offen offset:0 sc1
    s_nop 0
    v_permlane16_swap_b32 v18, v19
    v_max_f32 v18, v18, v19
    v_mov_b32 v19, v18
    s_nop 1
    v_permlane32_swap_b32 v18, v19
    buffer_load_dwordx4 v[76:79], v10, s[4:7], s90 offen offset:1024 sc1
    v_max_f32 v18, v18, v19
    v_mul_f32 v18, 0xbdd53b95, v18
    v_fma_f32 v144, v144, s44, v18
    v_fma_f32 v145, v145, s44, v18
    buffer_load_dwordx4 v[80:83], v10, s[4:7], s90 offen offset:2048 sc1
    v_fma_f32 v146, v146, s44, v18
    v_fma_f32 v147, v147, s44, v18
    v_fma_f32 v148, v148, s44, v18
    v_fma_f32 v149, v149, s44, v18
    buffer_load_dwordx4 v[84:87], v10, s[4:7], s90 offen offset:3072 sc1
    v_exp_f32 v144, v144
    v_exp_f32 v145, v145
    v_exp_f32 v146, v146
    v_exp_f32 v147, v147
    s_add_u32 s90, s41, 53248
    v_exp_f32 v148, v148
    v_exp_f32 v149, v149
    v_add_f32 v20, v144, v145
    v_add_f32 v20, v20, v146
    buffer_load_dwordx4 v[88:91], v10, s[4:7], s90 offen offset:0 sc1
    v_add_f32 v20, v20, v147
    v_add_f32 v20, v20, v148
    v_add_f32 v20, v20, v149
    v_mov_b32 v19, v20
    buffer_load_dwordx4 v[92:95], v10, s[4:7], s90 offen offset:1024 sc1
    s_nop 0
    v_permlane16_swap_b32 v20, v19
    v_add_f32 v20, v20, v19
    v_mov_b32 v19, v20
    s_nop 1
    v_permlane32_swap_b32 v20, v19
    buffer_load_dwordx4 v[96:99], v10, s[4:7], s90 offen offset:2048 sc1
    v_add_f32 v20, v20, v19
    v_rcp_f32 v20, v20
    s_nop 0
    v_mul_f32 v144, v144, v20
    v_mul_f32 v145, v145, v20
    buffer_load_dwordx4 v[100:103], v10, s[4:7], s90 offen offset:3072 sc1
    v_mul_f32 v146, v146, v20
    v_mul_f32 v147, v147, v20
    v_mul_f32 v148, v148, v20
    v_mul_f32 v149, v149, v20
    s_add_u32 s90, s41, 57344
    v_cvt_pk_bf16_f32 v164, v144, v145
    v_cvt_pk_bf16_f32 v165, v146, v147
    v_cvt_pk_bf16_f32 v166, v148, v149
    v_max_f32 v18, v152, v153
    buffer_load_dwordx4 v[104:107], v10, s[4:7], s90 offen offset:0 sc1
    v_max3_f32 v18, v18, v154, v155
    v_max3_f32 v18, v18, v160, v161
    v_max3_f32 v18, v18, v156, v157
    v_max3_f32 v18, v18, v158, v159
    buffer_load_dwordx4 v[108:111], v10, s[4:7], s90 offen offset:1024 sc1
    v_mov_b32 v19, v18
    s_nop 1
    v_permlane16_swap_b32 v18, v19
    v_max_f32 v18, v18, v19
    v_mov_b32 v19, v18
    buffer_load_dwordx4 v[112:115], v10, s[4:7], s90 offen offset:2048 sc1
    s_nop 0
    v_permlane32_swap_b32 v18, v19
    v_max_f32 v18, v18, v19
    v_mul_f32 v18, 0xbdd53b95, v18
    v_fma_f32 v152, v152, s44, v18
    buffer_load_dwordx4 v[116:119], v10, s[4:7], s90 offen offset:3072 sc1
    v_fma_f32 v153, v153, s44, v18
    v_fma_f32 v154, v154, s44, v18
    v_fma_f32 v155, v155, s44, v18
    v_fma_f32 v160, v160, s44, v18
    s_add_u32 s90, s41, 0
    v_fma_f32 v161, v161, s44, v18
    v_fma_f32 v156, v156, s44, v18
    v_fma_f32 v157, v157, s44, v18
    v_fma_f32 v158, v158, s44, v18
    buffer_load_dwordx4 v[24:27], v10, s[4:7], s90 offen offset:0 sc1
    v_fma_f32 v159, v159, s44, v18
    v_exp_f32 v152, v152
    v_exp_f32 v153, v153
    v_exp_f32 v154, v154
    buffer_load_dwordx4 v[28:31], v10, s[4:7], s90 offen offset:1024 sc1
    v_exp_f32 v155, v155
    v_exp_f32 v160, v160
    v_exp_f32 v161, v161
    v_exp_f32 v156, v156
    buffer_load_dwordx4 v[32:35], v10, s[4:7], s90 offen offset:2048 sc1
    v_exp_f32 v157, v157
    v_exp_f32 v158, v158
    v_exp_f32 v159, v159
    v_add_f32 v20, v152, v153
    buffer_load_dwordx4 v[36:39], v10, s[4:7], s90 offen offset:3072 sc1
    v_add_f32 v20, v20, v154
    v_add_f32 v20, v20, v155
    v_add_f32 v20, v20, v160
    v_add_f32 v20, v20, v161
    s_add_u32 s90, s41, 4096
    v_add_f32 v20, v20, v156
    v_add_f32 v20, v20, v157
    v_add_f32 v20, v20, v158
    v_add_f32 v20, v20, v159
    buffer_load_dwordx4 v[40:43], v10, s[4:7], s90 offen offset:0 sc1
    v_mov_b32 v19, v20
    s_nop 1
    v_permlane16_swap_b32 v20, v19
    v_add_f32 v20, v20, v19
    v_mov_b32 v19, v20
    buffer_load_dwordx4 v[44:47], v10, s[4:7], s90 offen offset:1024 sc1
    s_nop 0
    v_permlane32_swap_b32 v20, v19
    v_add_f32 v20, v20, v19
    v_rcp_f32 v20, v20
    s_nop 0
    v_mul_f32 v152, v152, v20
    buffer_load_dwordx4 v[48:51], v10, s[4:7], s90 offen offset:2048 sc1
    v_mul_f32 v153, v153, v20
    v_mul_f32 v154, v154, v20
    v_mul_f32 v155, v155, v20
    v_mul_f32 v160, v160, v20
    buffer_load_dwordx4 v[52:55], v10, s[4:7], s90 offen offset:3072 sc1
    v_mul_f32 v161, v161, v20
    v_mul_f32 v156, v156, v20
    v_mul_f32 v157, v157, v20
    v_mul_f32 v158, v158, v20
    s_add_u32 s90, s41, 8192
    v_mul_f32 v159, v159, v20
    v_cvt_pk_bf16_f32 v168, v152, v153
    v_cvt_pk_bf16_f32 v169, v154, v155
    v_cvt_pk_bf16_f32 v170, v160, v161
    buffer_load_dwordx4 v[56:59], v10, s[4:7], s90 offen offset:0 sc1
    v_cvt_pk_bf16_f32 v172, v156, v157
    v_cvt_pk_bf16_f32 v173, v158, v159
    buffer_load_dwordx4 v[60:63], v10, s[4:7], s90 offen offset:1024 sc1
    buffer_load_dwordx4 v[64:67], v10, s[4:7], s90 offen offset:2048 sc1
    buffer_load_dwordx4 v[68:71], v10, s[4:7], s90 offen offset:3072 sc1
    buffer_store_dwordx4 v[164:167], v12, s[4:7], s43 offen offset:0
    buffer_store_dwordx4 v[168:171], v12, s[4:7], s43 offen offset:1024
    buffer_store_dwordx4 v[172:175], v12, s[4:7], s43 offen offset:2048
    s_waitcnt vmcnt(0)
    buffer_store_dword v17, v15, s[4:7], s38 offen
    s_add_u32 s37, s37, 1
    s_branch L_px_loop_f
L_pxl_56:
    v_max_f32 v18, v144, v145
    v_max3_f32 v18, v18, v146, v147
    v_max3_f32 v18, v18, v148, v149
    v_mov_b32 v19, v18
    s_nop 1
    v_permlane16_swap_b32 v18, v19
    v_max_f32 v18, v18, v19
    v_mov_b32 v19, v18
    s_nop 1
    v_permlane32_swap_b32 v18, v19
    v_max_f32 v18, v18, v19
    v_mul_f32 v18, 0xbdd53b95, v18
    v_fma_f32 v144, v144, s44, v18
    v_fma_f32 v145, v145, s44, v18
    v_fma_f32 v146, v146, s44, v18
    v_fma_f32 v147, v147, s44, v18
    v_fma_f32 v148, v148, s44, v18
    v_fma_f32 v149, v149, s44, v18
    v_exp_f32 v144, v144
    v_exp_f32 v145, v145
    v_exp_f32 v146, v146
    v_exp_f32 v147, v147
    v_exp_f32 v148, v148
    v_exp_f32 v149, v149
    v_add_f32 v20, v144, v145
    v_add_f32 v20, v20, v146
    v_add_f32 v20, v20, v147
    v_add_f32 v20, v20, v148
    v_add_f32 v20, v20, v149
    v_mov_b32 v19, v20
    s_nop 1
    v_permlane16_swap_b32 v20, v19
    v_add_f32 v20, v20, v19
    v_mov_b32 v19, v20
    s_nop 1
    v_permlane32_swap_b32 v20, v19
    v_add_f32 v20, v20, v19
    v_rcp_f32 v20, v20
    s_nop 0
    v_mul_f32 v144, v144, v20
    v_mul_f32 v145, v145, v20
    v_mul_f32 v146, v146, v20
    v_mul_f32 v147, v147, v20
    v_mul_f32 v148, v148, v20
    v_mul_f32 v149, v149, v20
    v_cvt_pk_bf16_f32 v164, v144, v145
    v_cvt_pk_bf16_f32 v165, v146, v147
    v_cvt_pk_bf16_f32 v166, v148, v149
    v_max_f32 v18, v152, v153
    v_max3_f32 v18, v18, v154, v155
    v_max3_f32 v18, v18, v160, v161
    v_max3_f32 v18, v18, v156, v157
    v_max3_f32 v18, v18, v158, v159
    v_mov_b32 v19, v18
    s_nop 1
    v_permlane16_swap_b32 v18, v19
    v_max_f32 v18, v18, v19
    v_mov_b32 v19, v18
    s_nop 1
    v_permlane32_swap_b32 v18, v19
    v_max_f32 v18, v18, v19
    v_mul_f32 v18, 0xbdd53b95, v18
    v_fma_f32 v152, v152, s44, v18
    v_fma_f32 v153, v153, s44, v18
    v_fma_f32 v154, v154, s44, v18
    v_fma_f32 v155, v155, s44, v18
    v_fma_f32 v160, v160, s44, v18
    v_fma_f32 v161, v161, s44, v18
    v_fma_f32 v156, v156, s44, v18
    v_fma_f32 v157, v157, s44, v18
    v_fma_f32 v158, v158, s44, v18
    v_fma_f32 v159, v159, s44, v18
    v_exp_f32 v152, v152
    v_exp_f32 v153, v153
    v_exp_f32 v154, v154
    v_exp_f32 v155, v155
    v_exp_f32 v160, v160
    v_exp_f32 v161, v161
    v_exp_f32 v156, v156
    v_exp_f32 v157, v157
    v_exp_f32 v158, v158
    v_exp_f32 v159, v159
    v_add_f32 v20, v152, v153
    v_add_f32 v20, v20, v154
    v_add_f32 v20, v20, v155
    v_add_f32 v20, v20, v160
    v_add_f32 v20, v20, v161
    v_add_f32 v20, v20, v156
    v_add_f32 v20, v20, v157
    v_add_f32 v20, v20, v158
    v_add_f32 v20, v20, v159
    v_mov_b32 v19, v20
    s_nop 1
    v_permlane16_swap_b32 v20, v19
    v_add_f32 v20, v20, v19
    v_mov_b32 v19, v20
    s_nop 1
    v_permlane32_swap_b32 v20, v19
    v_add_f32 v20, v20, v19
    v_rcp_f32 v20, v20
    s_nop 0
    v_mul_f32 v152, v152, v20
    v_mul_f32 v153, v153, v20
    v_mul_f32 v154, v154, v20
    v_mul_f32 v155, v155, v20
    v_mul_f32 v160, v160, v20
    v_mul_f32 v161, v161, v20
    v_mul_f32 v156, v156, v20
    v_mul_f32 v157, v157, v20
    v_mul_f32 v158, v158, v20
    v_mul_f32 v159, v159, v20
    v_cvt_pk_bf16_f32 v168, v152, v153
    v_cvt_pk_bf16_f32 v169, v154, v155
    v_cvt_pk_bf16_f32 v170, v160, v161
    v_cvt_pk_bf16_f32 v172, v156, v157
    v_cvt_pk_bf16_f32 v173, v158, v159
    buffer_store_dwordx4 v[164:167], v12, s[4:7], s43 offen offset:0
    buffer_store_dwordx4 v[168:171], v12, s[4:7], s43 offen offset:1024
    buffer_store_dwordx4 v[172:175], v12, s[4:7], s43 offen offset:2048
    s_waitcnt vmcnt(0)
    buffer_store_dword v17, v15, s[4:7], s38 offen
    s_endpgm
L_pa_f:
    s_mov_b32 s24, s70
    s_and_b32 s25, s71, 0xffff
    s_mov_b32 s26, 2621440
    s_mov_b32 s27, 0x20000
    s_sub_u32 s93, s35, 29
    s_lshl_b32 s93, s93, 2
    s_add_u32 s93, s93, s32
    s_lshl_b32 s93, s93, 11
    v_lshl_add_u32 v4, v0, 4, s93
    v_mov_b32 v1, 192
L_gw_57:
    buffer_load_dword v2, v1, s[8:11], 0 offen sc1
    s_sub_u32 s36, s36, 1
    s_cbranch_scc1 L_exit
    s_waitcnt vmcnt(0)
    v_readfirstlane_b32 s90, v2
    s_nop 0
    s_cmp_eq_u32 s90, 0
    s_cbranch_scc1 L_gw_57
    s_cmp_lg_u32 s90, 1
    s_cbranch_scc1 L_slow
    s_mov_b32 s92, 0
L_tch_58:
    s_add_u32 s91, s92, s38
    buffer_load_dwordx4 v[248:251], v4, s[4:7], s91 offen
    buffer_load_dwordx4 v[248:251], v4, s[4:7], s91 offen offset:1024
    s_add_u32 s92, s92, 24576
    s_waitcnt vmcnt(24)
    s_cmp_lt_u32 s92, 475136
    s_cbranch_scc1 L_tch_58
    s_mov_b32 s92, 81920
L_tch_59:
    s_add_u32 s91, s92, 0
    buffer_load_dwordx4 v[248:251], v4, s[24:27], s91 offen
    buffer_load_dwordx4 v[248:251], v4, s[24:27], s91 offen offset:1024
    s_add_u32 s92, s92, 24576
    s_waitcnt vmcnt(24)
    s_cmp_lt_u32 s92, 245760
    s_cbranch_scc1 L_tch_59
    s_mov_b32 s92, 475136
L_tch_60:
    s_add_u32 s91, s92, s38
    buffer_load_dwordx4 v[248:251], v4, s[4:7], s91 offen
    buffer_load_dwordx4 v[248:251], v4, s[4:7], s91 offen offset:1024
    s_add_u32 s92, s92, 24576
    s_waitcnt vmcnt(24)
    s_cmp_lt_u32 s92, 1048576
    s_cbranch_scc1 L_tch_60
    s_waitcnt vmcnt(0)
    s_branch L_pa_body
L_pa_body:
    s_sub_u32 s90, s35, 29
    s_cmp_ge_u32 s90, 3
    s_cbranch_scc1 L_pa_end
    s_mul_i32 s52, s90, 3
    s_add_u32 s52, s52, s34
    s_and_b32 s52, s52, 7
    s_cmp_eq_u32 s90, 0
    s_cselect_b32 s91, 0x76543210, 0
    s_cmp_eq_u32 s90, 1
    s_cselect_b32 s91, 0x54c321b0, s91
    s_cmp_eq_u32 s90, 2
    s_cselect_b32 s91, 0xf9ea87d6, s91
    s_lshl_b32 s92, s34, 2
    s_lshr_b32 s91, s91, s92
    s_and_b32 s91, s91, 15
    s_min_u32 s90, s90, 1
    s_lshl_b32 s90, s90, 3
    s_add_u32 s54, s90, s91
    s_mul_i32 s40, s54, 112
    s_lshl_b32 s90, s32, 5
    s_add_u32 s40, s40, s90
    s_sub_u32 s40, s40, 16
    s_mov_b32 s12, s64
    s_and_b32 s13, s65, 0xffff
    s_mov_b32 s14, 2621440
    s_mov_b32 s15, 0x20000
    s_mov_b32 s16, s66
    s_and_b32 s17, s67, 0xffff
    s_mov_b32 s18, 2457600
    s_mov_b32 s19, 0x20000
    s_mov_b32 s20, s68
    s_and_b32 s21, s69, 0xffff
    s_mov_b32 s22, 819200
    s_mov_b32 s23, 0x20000
    v_and_b32 v1, 15, v0
    v_lshrrev_b32 v2, 4, v0
    s_add_u32 s90, s40, 0
    v_add_u32 v3, s90, v1
    v_cmp_gt_u32 vcc, 2048, v3
    v_mul_u32_u24 v3, 1280, v3
    v_lshl_add_u32 v3, v2, 4, v3
    v_mov_b32 v4, 2146435072
    v_cndmask_b32 v3, v4, v3, vcc
    buffer_load_dwordx4 a[0:3], v3, s[12:15], 0 offen offset:0
    buffer_load_dwordx4 a[4:7], v3, s[12:15], 0 offen offset:64
    buffer_load_dwordx4 a[8:11], v3, s[12:15], 0 offen offset:128
    buffer_load_dwordx4 a[12:15], v3, s[12:15], 0 offen offset:192
    buffer_load_dwordx4 a[16:19], v3, s[12:15], 0 offen offset:256
    buffer_load_dwordx4 a[20:23], v3, s[12:15], 0 offen offset:320
    buffer_load_dwordx4 a[24:27], v3, s[12:15], 0 offen offset:384
    buffer_load_dwordx4 a[28:31], v3, s[12:15], 0 offen offset:448
    buffer_load_dwordx4 a[32:35], v3, s[12:15], 0 offen offset:512
    buffer_load_dwordx4 a[36:39], v3, s[12:15], 0 offen offset:576
    buffer_load_dwordx4 a[40:43], v3, s[12:15], 0 offen offset:640
    buffer_load_dwordx4 a[44:47], v3, s[12:15], 0 offen offset:704
    buffer_load_dwordx4 a[48:51], v3, s[12:15], 0 offen offset:768
    buffer_load_dwordx4 a[52:55], v3, s[12:15], 0 offen offset:832
    buffer_load_dwordx4 a[56:59], v3, s[12:15], 0 offen offset:896
    buffer_load_dwordx4 a[60:63], v3, s[12:15], 0 offen offset:960
    buffer_load_dwordx4 a[64:67], v3, s[12:15], 0 offen offset:1024
    buffer_load_dwordx4 a[68:71], v3, s[12:15], 0 offen offset:1088
    buffer_load_dwordx4 a[72:75], v3, s[12:15], 0 offen offset:1152
    buffer_load_dwordx4 a[76:79], v3, s[12:15], 0 offen offset:1216
    s_add_u32 s90, s40, 16
    v_add_u32 v3, s90, v1
    v_cmp_gt_u32 vcc, 2048, v3
    v_mul_u32_u24 v3, 1280, v3
    v_lshl_add_u32 v3, v2, 4, v3
    v_mov_b32 v4, 2146435072
    v_cndmask_b32 v3, v4, v3, vcc
    buffer_load_dwordx4 a[80:83], v3, s[12:15], 0 offen offset:0
    buffer_load_dwordx4 a[84:87], v3, s[12:15], 0 offen offset:64
    buffer_load_dwordx4 a[88:91], v3, s[12:15], 0 offen offset:128
    buffer_load_dwordx4 a[92:95], v3, s[12:15], 0 offen offset:192
    buffer_load_dwordx4 a[96:99], v3, s[12:15], 0 offen offset:256
    buffer_load_dwordx4 a[100:103], v3, s[12:15], 0 offen offset:320
    buffer_load_dwordx4 a[104:107], v3, s[12:15], 0 offen offset:384
    buffer_load_dwordx4 a[108:111], v3, s[12:15], 0 offen offset:448
    buffer_load_dwordx4 a[112:115], v3, s[12:15], 0 offen offset:512
    buffer_load_dwordx4 a[116:119], v3, s[12:15], 0 offen offset:576
    buffer_load_dwordx4 a[120:123], v3, s[12:15], 0 offen offset:640
    buffer_load_dwordx4 a[124:127], v3, s[12:15], 0 offen offset:704
    buffer_load_dwordx4 a[128:131], v3, s[12:15], 0 offen offset:768
    buffer_load_dwordx4 a[132:135], v3, s[12:15], 0 offen offset:832
    buffer_load_dwordx4 a[136:139], v3, s[12:15], 0 offen offset:896
    buffer_load_dwordx4 a[140:143], v3, s[12:15], 0 offen offset:960
    buffer_load_dwordx4 a[144:147], v3, s[12:15], 0 offen offset:1024
    buffer_load_dwordx4 a[148:151], v3, s[12:15], 0 offen offset:1088
    buffer_load_dwordx4 a[152:155], v3, s[12:15], 0 offen offset:1152
    buffer_load_dwordx4 a[156:159], v3, s[12:15], 0 offen offset:1216
    v_add_u32 v3, 0, v0
    v_mul_u32_u24 v4, 6554, v3
    v_lshrrev_b32 v4, 16, v4
    v_mul_u32_u24 v5, 10, v4
    v_sub_u32 v5, v3, v5
    v_and_b32 v6, 19, v4
    v_and_b32 v7, 4, v4
    v_lshl_or_b32 v6, v7, 1, v6
    v_and_b32 v7, 8, v4
    v_lshrrev_b32 v7, 1, v7
    v_or_b32 v6, v6, v7
    s_lshl_b32 s90, s32, 5
    v_add_u32 v6, s90, v6
    v_mul_u32_u24 v6, 3840, v6
    v_lshl_add_u32 v10, v5, 4, v6
    v_add_u32 v3, 64, v0
    v_mul_u32_u24 v4, 6554, v3
    v_lshrrev_b32 v4, 16, v4
    v_mul_u32_u24 v5, 10, v4
    v_sub_u32 v5, v3, v5
    v_and_b32 v6, 19, v4
    v_and_b32 v7, 4, v4
    v_lshl_or_b32 v6, v7, 1, v6
    v_and_b32 v7, 8, v4
    v_lshrrev_b32 v7, 1, v7
    v_or_b32 v6, v6, v7
    s_lshl_b32 s90, s32, 5
    v_add_u32 v6, s90, v6
    v_mul_u32_u24 v6, 3840, v6
    v_lshl_add_u32 v11, v5, 4, v6
    v_add_u32 v3, 128, v0
    v_mul_u32_u24 v4, 6554, v3
    v_lshrrev_b32 v4, 16, v4
    v_mul_u32_u24 v5, 10, v4
    v_sub_u32 v5, v3, v5
    v_and_b32 v6, 19, v4
    v_and_b32 v7, 4, v4
    v_lshl_or_b32 v6, v7, 1, v6
    v_and_b32 v7, 8, v4
    v_lshrrev_b32 v7, 1, v7
    v_or_b32 v6, v6, v7
    s_lshl_b32 s90, s32, 5
    v_add_u32 v6, s90, v6
    v_mul_u32_u24 v6, 3840, v6
    v_lshl_add_u32 v12, v5, 4, v6
    v_add_u32 v3, 192, v0
    v_mul_u32_u24 v4, 6554, v3
    v_lshrrev_b32 v4, 16, v4
    v_mul_u32_u24 v5, 10, v4
    v_sub_u32 v5, v3, v5
    v_and_b32 v6, 19, v4
    v_and_b32 v7, 4, v4
    v_lshl_or_b32 v6, v7, 1, v6
    v_and_b32 v7, 8, v4
    v_lshrrev_b32 v7, 1, v7
    v_or_b32 v6, v6, v7
    s_lshl_b32 s90, s32, 5
    v_add_u32 v6, s90, v6
    v_mul_u32_u24 v6, 3840, v6
    v_lshl_add_u32 v13, v5, 4, v6
    v_add_u32 v3, 256, v0
    v_mul_u32_u24 v4, 6554, v3
    v_lshrrev_b32 v4, 16, v4
    v_mul_u32_u24 v5, 10, v4
    v_sub_u32 v5, v3, v5
    v_and_b32 v6, 19, v4
    v_and_b32 v7, 4, v4
    v_lshl_or_b32 v6, v7, 1, v6
    v_and_b32 v7, 8, v4
    v_lshrrev_b32 v7, 1, v7
    v_or_b32 v6, v6, v7
    s_lshl_b32 s90, s32, 5
    v_add_u32 v6, s90, v6
    v_mul_u32_u24 v6, 3840, v6
    v_lshl_add_u32 v14, v5, 4, v6
    v_lshrrev_b32 v3, 2, v1
    v_and_b32 v4, 3, v1
    v_and_b32 v5, 1, v2
    v_lshl_add_u32 v3, v5, 2, v3
    v_lshrrev_b32 v6, 1, v2
    v_lshl_add_u32 v3, v6, 4, v3
    v_mul_u32_u24 v3, 160, v3
    v_lshl_add_u32 v15, v4, 3, v3
    s_lshl_b32 s90, s32, 5
    v_add_u32 v3, s90, v1
    v_mul_u32_u24 v3, 168, v3
    v_add_u32 v3, 81920, v3
    v_lshl_add_u32 v17, v2, 3, v3
    v_lshl_add_u32 v28, v2, 4, v3
    v_add_u32 v28, -32, v28
    v_lshl_add_u32 v3, v5, 4, v1
    v_add_u32 v4, s90, v3
    v_add_u32 v3, s40, v3
    v_cmp_le_u32 s[92:93], 16, v4
    v_cmp_gt_u32 vcc, 2048, v3
    s_nop 0
    s_and_b64 vcc, vcc, s[92:93]
    v_mul_u32_u24 v3, 2560, v3
    v_lshl_add_u32 v3, v6, 4, v3
    v_mov_b32 v4, 2146435072
    v_cndmask_b32 v19, v4, v3, vcc
    v_and_b32 v3, 31, v0
    v_add_u32 v24, s40, v3
    v_add_u32 v3, s90, v3
    v_mul_u32_u24 v3, 168, v3
    v_lshrrev_b32 v4, 5, v0
    v_mul_u32_u24 v4, 40, v4
    v_add_u32 v3, v3, v4
    v_add_u32 v20, 81920, v3
    v_add_u32 v21, 101072, v3
    v_mov_b32 v27, 0xcf8547b1
    s_mov_b32 s49, 0x3ea52b5c
    s_cmp_lt_u32 s54, 19
    s_cbranch_scc1 L_pa_rows
    s_mov_b32 s24, s70
    s_and_b32 s25, s71, 0xffff
    s_mov_b32 s26, 2621440
    s_mov_b32 s27, 0x20000
    s_sub_u32 s90, s54, 19
    s_lshl_b32 s90, s90, 2
    s_add_u32 s90, s90, s32
    s_lshl_b32 s90, s90, 11
    v_lshl_add_u32 v3, v0, 4, s90
    s_mov_b32 s91, 245760
L_pa_xw:
    buffer_load_dwordx4 v[248:251], v3, s[24:27], s91 offen
    buffer_load_dwordx4 v[248:251], v3, s[24:27], s91 offen offset:1024
    s_add_u32 s91, s91, 40960
    s_waitcnt vmcnt(20)
    s_cmp_lt_u32 s91, 2621440
    s_cbranch_scc1 L_pa_xw
    s_mov_b32 s46, 0
    s_mov_b32 s47, 0
    s_mul_i32 s43, s52, 160
    s_mov_b32 s44, 0
    s_mov_b32 s45, 0
    s_mov_b32 s51, 45
    s_mov_b32 s48, s52
    s_mov_b32 s53, 0
L_pa_pf_61:
    s_mul_i32 s90, s32, 5120
    s_add_u32 m0, s90, s47
    s_mul_i32 s91, s44, 491520
    s_add_u32 s91, s91, s43
    buffer_load_dwordx4 v[248:251], v10, s[16:19], s91 offen
    s_add_u32 s47, s47, 20480
    s_cmp_eq_u32 s47, 81920
    s_cselect_b32 s47, 0, s47
    s_cmp_lg_u32 s51, 0
    s_cselect_b32 s90, 1, 0
    s_sub_u32 s51, s51, s90
    s_add_u32 s44, s44, s90
    s_cmp_eq_u32 s44, 5
    s_cselect_b32 s44, 0, s44
    s_cselect_b32 s90, 1280, 0
    s_addc_u32 s45, s45, 0
    s_add_u32 s43, s43, s90
    s_cmp_eq_u32 s45, 3
    s_cselect_b32 s45, 0, s45
    s_cselect_b32 s90, 3680, 0
    s_cmp_eq_u32 s43, 4960
    s_cselect_b32 s90, s43, s90
    s_sub_u32 s43, s43, s90
    s_add_u32 m0, m0, 1024
    buffer_load_dwordx4 v[248:251], v11, s[16:19], s91 offen
    s_add_u32 m0, m0, 1024
    buffer_load_dwordx4 v[248:251], v12, s[16:19], s91 offen
    s_add_u32 m0, m0, 1024
    buffer_load_dwordx4 v[248:251], v13, s[16:19], s91 offen
    s_add_u32 m0, m0, 1024
    buffer_load_dwordx4 v[248:251], v14, s[16:19], s91 offen
    s_waitcnt vmcnt(20)
    s_cmp_lg_u32 s51, 0
    s_cbranch_scc1 L_pa_pf_61
    v_add_u32 v3, 0, v0
    v_mul_u32_u24 v4, 6554, v3
    v_lshrrev_b32 v4, 16, v4
    v_mul_u32_u24 v5, 10, v4
    v_sub_u32 v5, v3, v5
    v_and_b32 v6, 19, v4
    v_and_b32 v7, 4, v4
    v_lshl_or_b32 v6, v7, 1, v6
    v_and_b32 v7, 8, v4
    v_lshrrev_b32 v7, 1, v7
    v_or_b32 v6, v6, v7
    s_lshl_b32 s90, s32, 5
    v_add_u32 v6, s90, v6
    v_mul_u32_u24 v6, 1280, v6
    v_lshl_add_u32 v10, v5, 4, v6
    v_add_u32 v3, 64, v0
    v_mul_u32_u24 v4, 6554, v3
    v_lshrrev_b32 v4, 16, v4
    v_mul_u32_u24 v5, 10, v4
    v_sub_u32 v5, v3, v5
    v_and_b32 v6, 19, v4
    v_and_b32 v7, 4, v4
    v_lshl_or_b32 v6, v7, 1, v6
    v_and_b32 v7, 8, v4
    v_lshrrev_b32 v7, 1, v7
    v_or_b32 v6, v6, v7
    s_lshl_b32 s90, s32, 5
    v_add_u32 v6, s90, v6
    v_mul_u32_u24 v6, 1280, v6
    v_lshl_add_u32 v11, v5, 4, v6
    v_add_u32 v3, 128, v0
    v_mul_u32_u24 v4, 6554, v3
    v_lshrrev_b32 v4, 16, v4
    v_mul_u32_u24 v5, 10, v4
    v_sub_u32 v5, v3, v5
    v_and_b32 v6, 19, v4
    v_and_b32 v7, 4, v4
    v_lshl_or_b32 v6, v7, 1, v6
    v_and_b32 v7, 8, v4
    v_lshrrev_b32 v7, 1, v7
    v_or_b32 v6, v6, v7
    s_lshl_b32 s90, s32, 5
    v_add_u32 v6, s90, v6
    v_mul_u32_u24 v6, 1280, v6
    v_lshl_add_u32 v12, v5, 4, v6
    v_add_u32 v3, 192, v0
    v_mul_u32_u24 v4, 6554, v3
    v_lshrrev_b32 v4, 16, v4
    v_mul_u32_u24 v5, 10, v4
    v_sub_u32 v5, v3, v5
    v_and_b32 v6, 19, v4
    v_and_b32 v7, 4, v4
    v_lshl_or_b32 v6, v7, 1, v6
    v_and_b32 v7, 8, v4
    v_lshrrev_b32 v7, 1, v7
    v_or_b32 v6, v6, v7
    s_lshl_b32 s90, s32, 5
    v_add_u32 v6, s90, v6
    v_mul_u32_u24 v6, 1280, v6
    v_lshl_add_u32 v13, v5, 4, v6
    v_add_u32 v3, 256, v0
    v_mul_u32_u24 v4, 6554, v3
    v_lshrrev_b32 v4, 16, v4
    v_mul_u32_u24 v5, 10, v4
    v_sub_u32 v5, v3, v5
    v_and_b32 v6, 19, v4
    v_and_b32 v7, 4, v4
    v_lshl_or_b32 v6, v7, 1, v6
    v_and_b32 v7, 8, v4
    v_lshrrev_b32 v7, 1, v7
    v_or_b32 v6, v6, v7
    s_lshl_b32 s90, s32, 5
    v_add_u32 v6, s90, v6
    v_mul_u32_u24 v6, 1280, v6
    v_lshl_add_u32 v14, v5, 4, v6
    s_mov_b32 s46, 0
    s_mov_b32 s47, 0
    s_mul_i32 s43, s52, 160
    s_mov_b32 s44, 0
    s_mov_b32 s45, 0
    s_mov_b32 s51, 40
    s_mov_b32 s48, s52
    s_mov_b32 s53, 0
L_pa_pf_62:
    s_mul_i32 s90, s32, 5120
    s_add_u32 m0, s90, s47
    s_mul_i32 s91, s44, 163840
    s_add_u32 s91, s91, s43
    buffer_load_dwordx4 v[248:251], v10, s[20:23], s91 offen
    s_add_u32 s47, s47, 20480
    s_cmp_eq_u32 s47, 81920
    s_cselect_b32 s47, 0, s47
    s_cmp_lg_u32 s51, 0
    s_cselect_b32 s90, 1, 0
    s_sub_u32 s51, s51, s90
    s_add_u32 s44, s44, s90
    s_cmp_eq_u32 s44, 5
    s_cselect_b32 s44, 0, s44
    s_cselect_b32 s90, 160, 0
    s_add_u32 s43, s43, s90
    s_cmp_eq_u32 s43, 1280
    s_cselect_b32 s43, 0, s43
    s_add_u32 m0, m0, 1024
    buffer_load_dwordx4 v[248:251], v11, s[20:23], s91 offen
    s_add_u32 m0, m0, 1024
    buffer_load_dwordx4 v[248:251], v12, s[20:23], s91 offen
    s_add_u32 m0, m0, 1024
    buffer_load_dwordx4 v[248:251], v13, s[20:23], s91 offen
    s_add_u32 m0, m0, 1024
    buffer_load_dwordx4 v[248:251], v14, s[20:23], s91 offen
    s_waitcnt vmcnt(20)
    s_cmp_lg_u32 s51, 0
    s_cbranch_scc1 L_pa_pf_62
    s_branch L_pa_end
L_pa_rows:
    s_mov_b32 s46, 0
    s_mov_b32 s47, 0
    s_mul_i32 s43, s52, 160
    s_mov_b32 s44, 0
    s_mov_b32 s45, 0
    s_mov_b32 s51, 119
    s_mov_b32 s48, s52
    s_mov_b32 s53, 0
    s_mul_i32 s90, s32, 5120
    s_add_u32 m0, s90, s47
    s_mul_i32 s91, s44, 491520
    s_add_u32 s91, s91, s43
    buffer_load_dwordx4 v10, s[16:19], s91 offen lds
    s_add_u32 s47, s47, 20480
    s_cmp_eq_u32 s47, 81920
    s_cselect_b32 s47, 0, s47
    s_cmp_lg_u32 s51, 0
    s_cselect_b32 s90, 1, 0
    s_sub_u32 s51, s51, s90
    s_add_u32 s44, s44, s90
    s_cmp_eq_u32 s44, 5
    s_cselect_b32 s44, 0, s44
    s_cselect_b32 s90, 1280, 0
    s_addc_u32 s45, s45, 0
    s_add_u32 s43, s43, s90
    s_cmp_eq_u32 s45, 3
    s_cselect_b32 s45, 0, s45
    s_cselect_b32 s90, 3680, 0
    s_cmp_eq_u32 s43, 4960
    s_cselect_b32 s90, s43, s90
    s_sub_u32 s43, s43, s90
    s_add_u32 m0, m0, 1024
    s_nop 0
    buffer_load_dwordx4 v11, s[16:19], s91 offen lds
    s_add_u32 m0, m0, 1024
    s_nop 0
    buffer_load_dwordx4 v12, s[16:19], s91 offen lds
    s_add_u32 m0, m0, 1024
    s_nop 0
    buffer_load_dwordx4 v13, s[16:19], s91 offen lds
    s_add_u32 m0, m0, 1024
    s_nop 0
    buffer_load_dwordx4 v14, s[16:19], s91 offen lds
    s_mul_i32 s90, s32, 5120
    s_add_u32 m0, s90, s47
    s_mul_i32 s91, s44, 491520
    s_add_u32 s91, s91, s43
    buffer_load_dwordx4 v10, s[16:19], s91 offen lds
    s_add_u32 s47, s47, 20480
    s_cmp_eq_u32 s47, 81920
    s_cselect_b32 s47, 0, s47
    s_cmp_lg_u32 s51, 0
    s_cselect_b32 s90, 1, 0
    s_sub_u32 s51, s51, s90
    s_add_u32 s44, s44, s90
    s_cmp_eq_u32 s44, 5
    s_cselect_b32 s44, 0, s44
    s_cselect_b32 s90, 1280, 0
    s_addc_u32 s45, s45, 0
    s_add_u32 s43, s43, s90
    s_cmp_eq_u32 s45, 3
    s_cselect_b32 s45, 0, s45
    s_cselect_b32 s90, 3680, 0
    s_cmp_eq_u32 s43, 4960
    s_cselect_b32 s90, s43, s90
    s_sub_u32 s43, s43, s90
    s_add_u32 m0, m0, 1024
    s_nop 0
    buffer_load_dwordx4 v11, s[16:19], s91 offen lds
    s_add_u32 m0, m0, 1024
    s_nop 0
    buffer_load_dwordx4 v12, s[16:19], s91 offen lds
    s_add_u32 m0, m0, 1024
    s_nop 0
    buffer_load_dwordx4 v13, s[16:19], s91 offen lds
    s_add_u32 m0, m0, 1024
    s_nop 0
    buffer_load_dwordx4 v14, s[16:19], s91 offen lds
    s_mul_i32 s90, s32, 5120
    s_add_u32 m0, s90, s47
    s_mul_i32 s91, s44, 491520
    s_add_u32 s91, s91, s43
    buffer_load_dwordx4 v10, s[16:19], s91 offen lds
    s_add_u32 s47, s47, 20480
    s_cmp_eq_u32 s47, 81920
    s_cselect_b32 s47, 0, s47
    s_cmp_lg_u32 s51, 0
    s_cselect_b32 s90, 1, 0
    s_sub_u32 s51, s51, s90
    s_add_u32 s44, s44, s90
    s_cmp_eq_u32 s44, 5
    s_cselect_b32 s44, 0, s44
    s_cselect_b32 s90, 1280, 0
    s_addc_u32 s45, s45, 0
    s_add_u32 s43, s43, s90
    s_cmp_eq_u32 s45, 3
    s_cselect_b32 s45, 0, s45
    s_cselect_b32 s90, 3680, 0
    s_cmp_eq_u32 s43, 4960
    s_cselect_b32 s90, s43, s90
    s_sub_u32 s43, s43, s90
    s_add_u32 m0, m0, 1024
    s_nop 0
    buffer_load_dwordx4 v11, s[16:19], s91 offen lds
    s_add_u32 m0, m0, 1024
    s_nop 0
    buffer_load_dwordx4 v12, s[16:19], s91 offen lds
    s_add_u32 m0, m0, 1024
    s_nop 0
    buffer_load_dwordx4 v13, s[16:19], s91 offen lds
    s_add_u32 m0, m0, 1024
    s_nop 0
    buffer_load_dwordx4 v14, s[16:19], s91 offen lds
    v_add_u32 v16, s46, v15
    s_waitcnt vmcnt(10) lgkmcnt(0)
    s_barrier
    ds_read_b64_tr_b16 v[96:97], v16 offset:0
    ds_read_b64_tr_b16 v[98:99], v16 offset:1280
    ds_read_b64_tr_b16 v[100:101], v16 offset:32
    ds_read_b64_tr_b16 v[102:103], v16 offset:1312
    ds_read_b64_tr_b16 v[104:105], v16 offset:64
    ds_read_b64_tr_b16 v[106:107], v16 offset:1344
    ds_read_b64_tr_b16 v[108:109], v16 offset:96
    ds_read_b64_tr_b16 v[110:111], v16 offset:1376
    ds_read_b64_tr_b16 v[112:113], v16 offset:128
    ds_read_b64_tr_b16 v[114:115], v16 offset:1408
L_pa_grp:
    s_mov_b32 s41, 0
L_pa_blk:
    s_waitcnt lgkmcnt(8)
    v_mfma_f32_16x16x32_bf16 v[136:139], v[96:99], a[0:3], 0
    ds_read_b64_tr_b16 v[116:117], v16 offset:5120
    s_add_u32 s46, s46, 20480
    s_cmp_eq_u32 s46, 81920
    v_mfma_f32_16x16x32_bf16 v[140:143], v[96:99], a[80:83], 0
    ds_read_b64_tr_b16 v[118:119], v16 offset:6400
    s_cselect_b32 s46, 0, s46
    s_mul_i32 s90, s32, 5120
    s_waitcnt lgkmcnt(8)
    v_mfma_f32_16x16x32_bf16 v[144:147], v[100:103], a[0:3], 0
    ds_read_b64_tr_b16 v[120:121], v16 offset:5152
    s_add_u32 m0, s90, s47
    s_mul_i32 s91, s44, 491520
    v_mfma_f32_16x16x32_bf16 v[148:151], v[100:103], a[80:83], 0
    ds_read_b64_tr_b16 v[122:123], v16 offset:6432
    s_add_u32 s91, s91, s43
    buffer_load_dwordx4 v10, s[16:19], s91 offen lds
    s_waitcnt lgkmcnt(8)
    v_mfma_f32_16x16x32_bf16 v[152:155], v[104:107], a[0:3], 0
    ds_read_b64_tr_b16 v[124:125], v16 offset:5184
    s_add_u32 s47, s47, 20480
    s_cmp_eq_u32 s47, 81920
    v_mfma_f32_16x16x32_bf16 v[156:159], v[104:107], a[80:83], 0
    ds_read_b64_tr_b16 v[126:127], v16 offset:6464
    s_cselect_b32 s47, 0, s47
    s_cmp_lg_u32 s51, 0
    s_waitcnt lgkmcnt(8)
    v_mfma_f32_16x16x32_bf16 v[160:163], v[108:111], a[0:3], 0
    ds_read_b64_tr_b16 v[128:129], v16 offset:5216
    s_cselect_b32 s90, 1, 0
    s_sub_u32 s51, s51, s90
    v_mfma_f32_16x16x32_bf16 v[164:167], v[108:111], a[80:83], 0
    ds_read_b64_tr_b16 v[130:131], v16 offset:6496
    s_add_u32 s44, s44, s90
    s_cmp_eq_u32 s44, 5
    s_waitcnt lgkmcnt(8)
    v_mfma_f32_16x16x32_bf16 v[168:171], v[112:115], a[0:3], 0
    ds_read_b64_tr_b16 v[132:133], v16 offset:5248
    s_cselect_b32 s44, 0, s44
    s_cselect_b32 s90, 1280, 0
    v_mfma_f32_16x16x32_bf16 v[172:175], v[112:115], a[80:83], 0
    ds_read_b64_tr_b16 v[134:135], v16 offset:6528
    s_addc_u32 s45, s45, 0
    s_add_u32 s43, s43, s90
    s_waitcnt lgkmcnt(8)
    v_mfma_f32_16x16x32_bf16 v[136:139], v[116:119], a[4:7], v[136:139]
    ds_read_b64_tr_b16 v[96:97], v16 offset:10240
    s_cmp_eq_u32 s45, 3
    s_cselect_b32 s45, 0, s45
    v_mfma_f32_16x16x32_bf16 v[140:143], v[116:119], a[84:87], v[140:143]
    ds_read_b64_tr_b16 v[98:99], v16 offset:11520
    s_cselect_b32 s90, 3680, 0
    s_cmp_eq_u32 s43, 4960
    s_waitcnt lgkmcnt(8)
    v_mfma_f32_16x16x32_bf16 v[144:147], v[120:123], a[4:7], v[144:147]
    ds_read_b64_tr_b16 v[100:101], v16 offset:10272
    s_cselect_b32 s90, s43, s90
    s_sub_u32 s43, s43, s90
    v_mfma_f32_16x16x32_bf16 v[148:151], v[120:123], a[84:87], v[148:151]
    ds_read_b64_tr_b16 v[102:103], v16 offset:11552
    s_add_u32 m0, m0, 1024
    s_nop 0
    buffer_load_dwordx4 v11, s[16:19], s91 offen lds
    s_waitcnt lgkmcnt(8)
    v_mfma_f32_16x16x32_bf16 v[152:155], v[124:127], a[4:7], v[152:155]
    ds_read_b64_tr_b16 v[104:105], v16 offset:10304
    s_add_u32 m0, m0, 1024
    v_mfma_f32_16x16x32_bf16 v[156:159], v[124:127], a[84:87], v[156:159]
    ds_read_b64_tr_b16 v[106:107], v16 offset:11584
    s_waitcnt lgkmcnt(8)
    v_mfma_f32_16x16x32_bf16 v[160:163], v[128:131], a[4:7], v[160:163]
    ds_read_b64_tr_b16 v[108:109], v16 offset:10336
    v_mfma_f32_16x16x32_bf16 v[164:167], v[128:131], a[84:87], v[164:167]
    ds_read_b64_tr_b16 v[110:111], v16 offset:11616
    s_waitcnt lgkmcnt(8)
    v_mfma_f32_16x16x32_bf16 v[168:171], v[132:135], a[4:7], v[168:171]
    ds_read_b64_tr_b16 v[112:113], v16 offset:10368
    buffer_load_dwordx4 v12, s[16:19], s91 offen lds
    s_add_u32 m0, m0, 1024
    v_mfma_f32_16x16x32_bf16 v[172:175], v[132:135], a[84:87], v[172:175]
    ds_read_b64_tr_b16 v[114:115], v16 offset:11648
    s_waitcnt lgkmcnt(8)
    v_mfma_f32_16x16x32_bf16 v[136:139], v[96:99], a[8:11], v[136:139]
    ds_read_b64_tr_b16 v[116:117], v16 offset:15360
    v_mfma_f32_16x16x32_bf16 v[140:143], v[96:99], a[88:91], v[140:143]
    ds_read_b64_tr_b16 v[118:119], v16 offset:16640
    s_waitcnt lgkmcnt(8)
    v_mfma_f32_16x16x32_bf16 v[144:147], v[100:103], a[8:11], v[144:147]
    ds_read_b64_tr_b16 v[120:121], v16 offset:15392
    v_mfma_f32_16x16x32_bf16 v[148:151], v[100:103], a[88:91], v[148:151]
    ds_read_b64_tr_b16 v[122:123], v16 offset:16672
    buffer_load_dwordx4 v13, s[16:19], s91 offen lds
    s_add_u32 m0, m0, 1024
    s_waitcnt lgkmcnt(8)
    v_mfma_f32_16x16x32_bf16 v[152:155], v[104:107], a[8:11], v[152:155]
    ds_read_b64_tr_b16 v[124:125], v16 offset:15424
    v_mfma_f32_16x16x32_bf16 v[156:159], v[104:107], a[88:91], v[156:159]
    ds_read_b64_tr_b16 v[126:127], v16 offset:16704
    s_waitcnt lgkmcnt(8)
    v_mfma_f32_16x16x32_bf16 v[160:163], v[108:111], a[8:11], v[160:163]
    ds_read_b64_tr_b16 v[128:129], v16 offset:15456
    v_mfma_f32_16x16x32_bf16 v[164:167], v[108:111], a[88:91], v[164:167]
    ds_read_b64_tr_b16 v[130:131], v16 offset:16736
    s_waitcnt lgkmcnt(8)
    v_mfma_f32_16x16x32_bf16 v[168:171], v[112:115], a[8:11], v[168:171]
    ds_read_b64_tr_b16 v[132:133], v16 offset:15488
    buffer_load_dwordx4 v14, s[16:19], s91 offen lds
    v_mfma_f32_16x16x32_bf16 v[172:175], v[112:115], a[88:91], v[172:175]
    ds_read_b64_tr_b16 v[134:135], v16 offset:16768
    s_waitcnt lgkmcnt(8)
    v_mfma_f32_16x16x32_bf16 v[136:139], v[116:119], a[12:15], v[136:139]
    v_mfma_f32_16x16x32_bf16 v[140:143], v[116:119], a[92:95], v[140:143]
    s_waitcnt lgkmcnt(6)
    v_mfma_f32_16x16x32_bf16 v[144:147], v[120:123], a[12:15], v[144:147]
    v_mfma_f32_16x16x32_bf16 v[148:151], v[120:123], a[92:95], v[148:151]
    v_add_u32 v16, s46, v15
    s_waitcnt vmcnt(10) lgkmcnt(0)
    s_barrier
    v_mfma_f32_16x16x32_bf16 v[152:155], v[124:127], a[12:15], v[152:155]
    ds_read_b64_tr_b16 v[96:97], v16 offset:0
    ds_read_b64_tr_b16 v[98:99], v16 offset:1280
    v_mfma_f32_16x16x32_bf16 v[156:159], v[124:127], a[92:95], v[156:159]
    ds_read_b64_tr_b16 v[100:101], v16 offset:32
    ds_read_b64_tr_b16 v[102:103], v16 offset:1312
    v_mfma_f32_16x16x32_bf16 v[160:163], v[128:131], a[12:15], v[160:163]
    ds_read_b64_tr_b16 v[104:105], v16 offset:64
    ds_read_b64_tr_b16 v[106:107], v16 offset:1344
    v_mfma_f32_16x16x32_bf16 v[164:167], v[128:131], a[92:95], v[164:167]
    ds_read_b64_tr_b16 v[108:109], v16 offset:96
    ds_read_b64_tr_b16 v[110:111], v16 offset:1376
    v_mfma_f32_16x16x32_bf16 v[168:171], v[132:135], a[12:15], v[168:171]
    ds_read_b64_tr_b16 v[112:113], v16 offset:128
    ds_read_b64_tr_b16 v[114:115], v16 offset:1408
    v_mfma_f32_16x16x32_bf16 v[172:175], v[132:135], a[92:95], v[172:175]
    s_waitcnt lgkmcnt(8)
    v_mfma_f32_16x16x32_bf16 v[136:139], v[96:99], a[16:19], v[136:139]
    ds_read_b64_tr_b16 v[116:117], v16 offset:5120
    s_add_u32 s46, s46, 20480
    s_cmp_eq_u32 s46, 81920
    v_mfma_f32_16x16x32_bf16 v[140:143], v[96:99], a[96:99], v[140:143]
    ds_read_b64_tr_b16 v[118:119], v16 offset:6400
    s_cselect_b32 s46, 0, s46
    s_mul_i32 s90, s32, 5120
    s_waitcnt lgkmcnt(8)
    v_mfma_f32_16x16x32_bf16 v[144:147], v[100:103], a[16:19], v[144:147]
    ds_read_b64_tr_b16 v[120:121], v16 offset:5152
    s_add_u32 m0, s90, s47
    s_mul_i32 s91, s44, 491520
    v_mfma_f32_16x16x32_bf16 v[148:151], v[100:103], a[96:99], v[148:151]
    ds_read_b64_tr_b16 v[122:123], v16 offset:6432
    s_add_u32 s91, s91, s43
    buffer_load_dwordx4 v10, s[16:19], s91 offen lds
    s_waitcnt lgkmcnt(8)
    v_mfma_f32_16x16x32_bf16 v[152:155], v[104:107], a[16:19], v[152:155]
    ds_read_b64_tr_b16 v[124:125], v16 offset:5184
    s_add_u32 s47, s47, 20480
    s_cmp_eq_u32 s47, 81920
    v_mfma_f32_16x16x32_bf16 v[156:159], v[104:107], a[96:99], v[156:159]
    ds_read_b64_tr_b16 v[126:127], v16 offset:6464
    s_cselect_b32 s47, 0, s47
    s_cmp_lg_u32 s51, 0
    s_waitcnt lgkmcnt(8)
    v_mfma_f32_16x16x32_bf16 v[160:163], v[108:111], a[16:19], v[160:163]
    ds_read_b64_tr_b16 v[128:129], v16 offset:5216
    s_cselect_b32 s90, 1, 0
    s_sub_u32 s51, s51, s90
    v_mfma_f32_16x16x32_bf16 v[164:167], v[108:111], a[96:99], v[164:167]
    ds_read_b64_tr_b16 v[130:131], v16 offset:6496
    s_add_u32 s44, s44, s90
    s_cmp_eq_u32 s44, 5
    s_waitcnt lgkmcnt(8)
    v_mfma_f32_16x16x32_bf16 v[168:171], v[112:115], a[16:19], v[168:171]
    ds_read_b64_tr_b16 v[132:133], v16 offset:5248
    s_cselect_b32 s44, 0, s44
    s_cselect_b32 s90, 1280, 0
    v_mfma_f32_16x16x32_bf16 v[172:175], v[112:115], a[96:99], v[172:175]
    ds_read_b64_tr_b16 v[134:135], v16 offset:6528
    s_addc_u32 s45, s45, 0
    s_add_u32 s43, s43, s90
    s_waitcnt lgkmcnt(8)
    v_mfma_f32_16x16x32_bf16 v[136:139], v[116:119], a[20:23], v[136:139]
    ds_read_b64_tr_b16 v[96:97], v16 offset:10240
    s_cmp_eq_u32 s45, 3
    s_cselect_b32 s45, 0, s45
    v_mfma_f32_16x16x32_bf16 v[140:143], v[116:119], a[100:103], v[140:143]
    ds_read_b64_tr_b16 v[98:99], v16 offset:11520
    s_cselect_b32 s90, 3680, 0
    s_cmp_eq_u32 s43, 4960
    s_waitcnt lgkmcnt(8)
    v_mfma_f32_16x16x32_bf16 v[144:147], v[120:123], a[20:23], v[144:147]
    ds_read_b64_tr_b16 v[100:101], v16 offset:10272
    s_cselect_b32 s90, s43, s90
    s_sub_u32 s43, s43, s90
    v_mfma_f32_16x16x32_bf16 v[148:151], v[120:123], a[100:103], v[148:151]
    ds_read_b64_tr_b16 v[102:103], v16 offset:11552
    s_add_u32 m0, m0, 1024
    s_nop 0
    buffer_load_dwordx4 v11, s[16:19], s91 offen lds
    s_waitcnt lgkmcnt(8)
    v_mfma_f32_16x16x32_bf16 v[152:155], v[124:127], a[20:23], v[152:155]
    ds_read_b64_tr_b16 v[104:105], v16 offset:10304
    s_add_u32 m0, m0, 1024
    v_mfma_f32_16x16x32_bf16 v[156:159], v[124:127], a[100:103], v[156:159]
    ds_read_b64_tr_b16 v[106:107], v16 offset:11584
    s_waitcnt lgkmcnt(8)
    v_mfma_f32_16x16x32_bf16 v[160:163], v[128:131], a[20:23], v[160:163]
    ds_read_b64_tr_b16 v[108:109], v16 offset:10336
    v_mfma_f32_16x16x32_bf16 v[164:167], v[128:131], a[100:103], v[164:167]
    ds_read_b64_tr_b16 v[110:111], v16 offset:11616
    s_waitcnt lgkmcnt(8)
    v_mfma_f32_16x16x32_bf16 v[168:171], v[132:135], a[20:23], v[168:171]
    ds_read_b64_tr_b16 v[112:113], v16 offset:10368
    buffer_load_dwordx4 v12, s[16:19], s91 offen lds
    s_add_u32 m0, m0, 1024
    v_mfma_f32_16x16x32_bf16 v[172:175], v[132:135], a[100:103], v[172:175]
    ds_read_b64_tr_b16 v[114:115], v16 offset:11648
    s_waitcnt lgkmcnt(8)
    v_mfma_f32_16x16x32_bf16 v[136:139], v[96:99], a[24:27], v[136:139]
    ds_read_b64_tr_b16 v[116:117], v16 offset:15360
    v_mfma_f32_16x16x32_bf16 v[140:143], v[96:99], a[104:107], v[140:143]
    ds_read_b64_tr_b16 v[118:119], v16 offset:16640
    s_waitcnt lgkmcnt(8)
    v_mfma_f32_16x16x32_bf16 v[144:147], v[100:103], a[24:27], v[144:147]
    ds_read_b64_tr_b16 v[120:121], v16 offset:15392
    v_mfma_f32_16x16x32_bf16 v[148:151], v[100:103], a[104:107], v[148:151]
    ds_read_b64_tr_b16 v[122:123], v16 offset:16672
    buffer_load_dwordx4 v13, s[16:19], s91 offen lds
    s_add_u32 m0, m0, 1024
    s_waitcnt lgkmcnt(8)
    v_mfma_f32_16x16x32_bf16 v[152:155], v[104:107], a[24:27], v[152:155]
    ds_read_b64_tr_b16 v[124:125], v16 offset:15424
    v_mfma_f32_16x16x32_bf16 v[156:159], v[104:107], a[104:107], v[156:159]
    ds_read_b64_tr_b16 v[126:127], v16 offset:16704
    s_waitcnt lgkmcnt(8)
    v_mfma_f32_16x16x32_bf16 v[160:163], v[108:111], a[24:27], v[160:163]
    ds_read_b64_tr_b16 v[128:129], v16 offset:15456
    v_mfma_f32_16x16x32_bf16 v[164:167], v[108:111], a[104:107], v[164:167]
    ds_read_b64_tr_b16 v[130:131], v16 offset:16736
    s_waitcnt lgkmcnt(8)
    v_mfma_f32_16x16x32_bf16 v[168:171], v[112:115], a[24:27], v[168:171]
    ds_read_b64_tr_b16 v[132:133], v16 offset:15488
    buffer_load_dwordx4 v14, s[16:19], s91 offen lds
    v_mfma_f32_16x16x32_bf16 v[172:175], v[112:115], a[104:107], v[172:175]
    ds_read_b64_tr_b16 v[134:135], v16 offset:16768
    s_waitcnt lgkmcnt(8)
    v_mfma_f32_16x16x32_bf16 v[136:139], v[116:119], a[28:31], v[136:139]
    v_mfma_f32_16x16x32_bf16 v[140:143], v[116:119], a[108:111], v[140:143]
    s_waitcnt lgkmcnt(6)
    v_mfma_f32_16x16x32_bf16 v[144:147], v[120:123], a[28:31], v[144:147]
    v_mfma_f32_16x16x32_bf16 v[148:151], v[120:123], a[108:111], v[148:151]
    v_add_u32 v16, s46, v15
    s_waitcnt vmcnt(10) lgkmcnt(0)
    s_barrier
    v_mfma_f32_16x16x32_bf16 v[152:155], v[124:127], a[28:31], v[152:155]
    ds_read_b64_tr_b16 v[96:97], v16 offset:0
    ds_read_b64_tr_b16 v[98:99], v16 offset:1280
    v_mfma_f32_16x16x32_bf16 v[156:159], v[124:127], a[108:111], v[156:159]
    ds_read_b64_tr_b16 v[100:101], v16 offset:32
    ds_read_b64_tr_b16 v[102:103], v16 offset:1312
    v_mfma_f32_16x16x32_bf16 v[160:163], v[128:131], a[28:31], v[160:163]
    ds_read_b64_tr_b16 v[104:105], v16 offset:64
    ds_read_b64_tr_b16 v[106:107], v16 offset:1344
    v_mfma_f32_16x16x32_bf16 v[164:167], v[128:131], a[108:111], v[164:167]
    ds_read_b64_tr_b16 v[108:109], v16 offset:96
    ds_read_b64_tr_b16 v[110:111], v16 offset:1376
    v_mfma_f32_16x16x32_bf16 v[168:171], v[132:135], a[28:31], v[168:171]
    ds_read_b64_tr_b16 v[112:113], v16 offset:128
    ds_read_b64_tr_b16 v[114:115], v16 offset:1408
    v_mfma_f32_16x16x32_bf16 v[172:175], v[132:135], a[108:111], v[172:175]
    s_waitcnt lgkmcnt(8)
    v_mfma_f32_16x16x32_bf16 v[136:139], v[96:99], a[32:35], v[136:139]
    ds_read_b64_tr_b16 v[116:117], v16 offset:5120
    s_add_u32 s46, s46, 20480
    s_cmp_eq_u32 s46, 81920
    v_mfma_f32_16x16x32_bf16 v[140:143], v[96:99], a[112:115], v[140:143]
    ds_read_b64_tr_b16 v[118:119], v16 offset:6400
    s_cselect_b32 s46, 0, s46
    s_mul_i32 s90, s32, 5120
    s_waitcnt lgkmcnt(8)
    v_mfma_f32_16x16x32_bf16 v[144:147], v[100:103], a[32:35], v[144:147]
    ds_read_b64_tr_b16 v[120:121], v16 offset:5152
    s_add_u32 m0, s90, s47
    s_mul_i32 s91, s44, 491520
    v_mfma_f32_16x16x32_bf16 v[148:151], v[100:103], a[112:115], v[148:151]
    ds_read_b64_tr_b16 v[122:123], v16 offset:6432
    s_add_u32 s91, s91, s43
    buffer_load_dwordx4 v10, s[16:19], s91 offen lds
    s_waitcnt lgkmcnt(8)
    v_mfma_f32_16x16x32_bf16 v[152:155], v[104:107], a[32:35], v[152:155]
    ds_read_b64_tr_b16 v[124:125], v16 offset:5184
    s_add_u32 s47, s47, 20480
    s_cmp_eq_u32 s47, 81920
    v_mfma_f32_16x16x32_bf16 v[156:159], v[104:107], a[112:115], v[156:159]
    ds_read_b64_tr_b16 v[126:127], v16 offset:6464
    s_cselect_b32 s47, 0, s47
    s_cmp_lg_u32 s51, 0
    s_waitcnt lgkmcnt(8)
    v_mfma_f32_16x16x32_bf16 v[160:163], v[108:111], a[32:35], v[160:163]
    ds_read_b64_tr_b16 v[128:129], v16 offset:5216
    s_cselect_b32 s90, 1, 0
    s_sub_u32 s51, s51, s90
    v_mfma_f32_16x16x32_bf16 v[164:167], v[108:111], a[112:115], v[164:167]
    ds_read_b64_tr_b16 v[130:131], v16 offset:6496
    s_add_u32 s44, s44, s90
    s_cmp_eq_u32 s44, 5
    s_waitcnt lgkmcnt(8)
    v_mfma_f32_16x16x32_bf16 v[168:171], v[112:115], a[32:35], v[168:171]
    ds_read_b64_tr_b16 v[132:133], v16 offset:5248
    s_cselect_b32 s44, 0, s44
    s_cselect_b32 s90, 1280, 0
    v_mfma_f32_16x16x32_bf16 v[172:175], v[112:115], a[112:115], v[172:175]
    ds_read_b64_tr_b16 v[134:135], v16 offset:6528
    s_addc_u32 s45, s45, 0
    s_add_u32 s43, s43, s90
    s_waitcnt lgkmcnt(8)
    v_mfma_f32_16x16x32_bf16 v[136:139], v[116:119], a[36:39], v[136:139]
    ds_read_b64_tr_b16 v[96:97], v16 offset:10240
    s_cmp_eq_u32 s45, 3
    s_cselect_b32 s45, 0, s45
    v_mfma_f32_16x16x32_bf16 v[140:143], v[116:119], a[116:119], v[140:143]
    ds_read_b64_tr_b16 v[98:99], v16 offset:11520
    s_cselect_b32 s90, 3680, 0
    s_cmp_eq_u32 s43, 4960
    s_waitcnt lgkmcnt(8)
    v_mfma_f32_16x16x32_bf16 v[144:147], v[120:123], a[36:39], v[144:147]
    ds_read_b64_tr_b16 v[100:101], v16 offset:10272
    s_cselect_b32 s90, s43, s90
    s_sub_u32 s43, s43, s90
    v_mfma_f32_16x16x32_bf16 v[148:151], v[120:123], a[116:119], v[148:151]
    ds_read_b64_tr_b16 v[102:103], v16 offset:11552
    s_add_u32 m0, m0, 1024
    s_nop 0
    buffer_load_dwordx4 v11, s[16:19], s91 offen lds
    s_waitcnt lgkmcnt(8)
    v_mfma_f32_16x16x32_bf16 v[152:155], v[124:127], a[36:39], v[152:155]
    ds_read_b64_tr_b16 v[104:105], v16 offset:10304
    s_add_u32 m0, m0, 1024
    v_mfma_f32_16x16x32_bf16 v[156:159], v[124:127], a[116:119], v[156:159]
    ds_read_b64_tr_b16 v[106:107], v16 offset:11584
    s_waitcnt lgkmcnt(8)
    v_mfma_f32_16x16x32_bf16 v[160:163], v[128:131], a[36:39], v[160:163]
    ds_read_b64_tr_b16 v[108:109], v16 offset:10336
    v_mfma_f32_16x16x32_bf16 v[164:167], v[128:131], a[116:119], v[164:167]
    ds_read_b64_tr_b16 v[110:111], v16 offset:11616
    s_waitcnt lgkmcnt(8)
    v_mfma_f32_16x16x32_bf16 v[168:171], v[132:135], a[36:39], v[168:171]
    ds_read_b64_tr_b16 v[112:113], v16 offset:10368
    buffer_load_dwordx4 v12, s[16:19], s91 offen lds
    s_add_u32 m0, m0, 1024
    v_mfma_f32_16x16x32_bf16 v[172:175], v[132:135], a[116:119], v[172:175]
    ds_read_b64_tr_b16 v[114:115], v16 offset:11648
    s_waitcnt lgkmcnt(8)
    v_mfma_f32_16x16x32_bf16 v[136:139], v[96:99], a[40:43], v[136:139]
    ds_read_b64_tr_b16 v[116:117], v16 offset:15360
    v_mfma_f32_16x16x32_bf16 v[140:143], v[96:99], a[120:123], v[140:143]
    ds_read_b64_tr_b16 v[118:119], v16 offset:16640
    s_waitcnt lgkmcnt(8)
    v_mfma_f32_16x16x32_bf16 v[144:147], v[100:103], a[40:43], v[144:147]
    ds_read_b64_tr_b16 v[120:121], v16 offset:15392
    v_mfma_f32_16x16x32_bf16 v[148:151], v[100:103], a[120:123], v[148:151]
    ds_read_b64_tr_b16 v[122:123], v16 offset:16672
    buffer_load_dwordx4 v13, s[16:19], s91 offen lds
    s_add_u32 m0, m0, 1024
    s_waitcnt lgkmcnt(8)
    v_mfma_f32_16x16x32_bf16 v[152:155], v[104:107], a[40:43], v[152:155]
    ds_read_b64_tr_b16 v[124:125], v16 offset:15424
    v_mfma_f32_16x16x32_bf16 v[156:159], v[104:107], a[120:123], v[156:159]
    ds_read_b64_tr_b16 v[126:127], v16 offset:16704
    s_waitcnt lgkmcnt(8)
    v_mfma_f32_16x16x32_bf16 v[160:163], v[108:111], a[40:43], v[160:163]
    ds_read_b64_tr_b16 v[128:129], v16 offset:15456
    v_mfma_f32_16x16x32_bf16 v[164:167], v[108:111], a[120:123], v[164:167]
    ds_read_b64_tr_b16 v[130:131], v16 offset:16736
    s_waitcnt lgkmcnt(8)
    v_mfma_f32_16x16x32_bf16 v[168:171], v[112:115], a[40:43], v[168:171]
    ds_read_b64_tr_b16 v[132:133], v16 offset:15488
    buffer_load_dwordx4 v14, s[16:19], s91 offen lds
    v_mfma_f32_16x16x32_bf16 v[172:175], v[112:115], a[120:123], v[172:175]
    ds_read_b64_tr_b16 v[134:135], v16 offset:16768
    s_waitcnt lgkmcnt(8)
    v_mfma_f32_16x16x32_bf16 v[136:139], v[116:119], a[44:47], v[136:139]
    v_mfma_f32_16x16x32_bf16 v[140:143], v[116:119], a[124:127], v[140:143]
    s_waitcnt lgkmcnt(6)
    v_mfma_f32_16x16x32_bf16 v[144:147], v[120:123], a[44:47], v[144:147]
    v_mfma_f32_16x16x32_bf16 v[148:151], v[120:123], a[124:127], v[148:151]
    v_add_u32 v16, s46, v15
    s_waitcnt vmcnt(10) lgkmcnt(0)
    s_barrier
    v_mfma_f32_16x16x32_bf16 v[152:155], v[124:127], a[44:47], v[152:155]
    ds_read_b64_tr_b16 v[96:97], v16 offset:0
    ds_read_b64_tr_b16 v[98:99], v16 offset:1280
    v_mfma_f32_16x16x32_bf16 v[156:159], v[124:127], a[124:127], v[156:159]
    ds_read_b64_tr_b16 v[100:101], v16 offset:32
    ds_read_b64_tr_b16 v[102:103], v16 offset:1312
    v_mfma_f32_16x16x32_bf16 v[160:163], v[128:131], a[44:47], v[160:163]
    ds_read_b64_tr_b16 v[104:105], v16 offset:64
    ds_read_b64_tr_b16 v[106:107], v16 offset:1344
    v_mfma_f32_16x16x32_bf16 v[164:167], v[128:131], a[124:127], v[164:167]
    ds_read_b64_tr_b16 v[108:109], v16 offset:96
    ds_read_b64_tr_b16 v[110:111], v16 offset:1376
    v_mfma_f32_16x16x32_bf16 v[168:171], v[132:135], a[44:47], v[168:171]
    ds_read_b64_tr_b16 v[112:113], v16 offset:128
    ds_read_b64_tr_b16 v[114:115], v16 offset:1408
    v_mfma_f32_16x16x32_bf16 v[172:175], v[132:135], a[124:127], v[172:175]
    s_waitcnt lgkmcnt(8)
    v_mfma_f32_16x16x32_bf16 v[136:139], v[96:99], a[48:51], v[136:139]
    ds_read_b64_tr_b16 v[116:117], v16 offset:5120
    s_add_u32 s46, s46, 20480
    s_cmp_eq_u32 s46, 81920
    v_mfma_f32_16x16x32_bf16 v[140:143], v[96:99], a[128:131], v[140:143]
    ds_read_b64_tr_b16 v[118:119], v16 offset:6400
    s_cselect_b32 s46, 0, s46
    s_mul_i32 s90, s32, 5120
    s_waitcnt lgkmcnt(8)
    v_mfma_f32_16x16x32_bf16 v[144:147], v[100:103], a[48:51], v[144:147]
    ds_read_b64_tr_b16 v[120:121], v16 offset:5152
    s_add_u32 m0, s90, s47
    s_mul_i32 s91, s44, 491520
    v_mfma_f32_16x16x32_bf16 v[148:151], v[100:103], a[128:131], v[148:151]
    ds_read_b64_tr_b16 v[122:123], v16 offset:6432
    s_add_u32 s91, s91, s43
    buffer_load_dwordx4 v10, s[16:19], s91 offen lds
    s_waitcnt lgkmcnt(8)
    v_mfma_f32_16x16x32_bf16 v[152:155], v[104:107], a[48:51], v[152:155]
    ds_read_b64_tr_b16 v[124:125], v16 offset:5184
    s_add_u32 s47, s47, 20480
    s_cmp_eq_u32 s47, 81920
    v_mfma_f32_16x16x32_bf16 v[156:159], v[104:107], a[128:131], v[156:159]
    ds_read_b64_tr_b16 v[126:127], v16 offset:6464
    s_cselect_b32 s47, 0, s47
    s_cmp_lg_u32 s51, 0
    s_waitcnt lgkmcnt(8)
    v_mfma_f32_16x16x32_bf16 v[160:163], v[108:111], a[48:51], v[160:163]
    ds_read_b64_tr_b16 v[128:129], v16 offset:5216
    s_cselect_b32 s90, 1, 0
    s_sub_u32 s51, s51, s90
    v_mfma_f32_16x16x32_bf16 v[164:167], v[108:111], a[128:131], v[164:167]
    ds_read_b64_tr_b16 v[130:131], v16 offset:6496
    s_add_u32 s44, s44, s90
    s_cmp_eq_u32 s44, 5
    s_waitcnt lgkmcnt(8)
    v_mfma_f32_16x16x32_bf16 v[168:171], v[112:115], a[48:51], v[168:171]
    ds_read_b64_tr_b16 v[132:133], v16 offset:5248
    s_cselect_b32 s44, 0, s44
    s_cselect_b32 s90, 1280, 0
    v_mfma_f32_16x16x32_bf16 v[172:175], v[112:115], a[128:131], v[172:175]
    ds_read_b64_tr_b16 v[134:135], v16 offset:6528
    s_addc_u32 s45, s45, 0
    s_add_u32 s43, s43, s90
    s_waitcnt lgkmcnt(8)
    v_mfma_f32_16x16x32_bf16 v[136:139], v[116:119], a[52:55], v[136:139]
    ds_read_b64_tr_b16 v[96:97], v16 offset:10240
    s_cmp_eq_u32 s45, 3
    s_cselect_b32 s45, 0, s45
    v_mfma_f32_16x16x32_bf16 v[140:143], v[116:119], a[132:135], v[140:143]
    ds_read_b64_tr_b16 v[98:99], v16 offset:11520
    s_cselect_b32 s90, 3680, 0
    s_cmp_eq_u32 s43, 4960
    s_waitcnt lgkmcnt(8)
    v_mfma_f32_16x16x32_bf16 v[144:147], v[120:123], a[52:55], v[144:147]
    ds_read_b64_tr_b16 v[100:101], v16 offset:10272
    s_cselect_b32 s90, s43, s90
    s_sub_u32 s43, s43, s90
    v_mfma_f32_16x16x32_bf16 v[148:151], v[120:123], a[132:135], v[148:151]
    ds_read_b64_tr_b16 v[102:103], v16 offset:11552
    s_add_u32 m0, m0, 1024
    s_nop 0
    buffer_load_dwordx4 v11, s[16:19], s91 offen lds
    s_waitcnt lgkmcnt(8)
    v_mfma_f32_16x16x32_bf16 v[152:155], v[124:127], a[52:55], v[152:155]
    ds_read_b64_tr_b16 v[104:105], v16 offset:10304
    s_add_u32 m0, m0, 1024
    v_mfma_f32_16x16x32_bf16 v[156:159], v[124:127], a[132:135], v[156:159]
    ds_read_b64_tr_b16 v[106:107], v16 offset:11584
    s_waitcnt lgkmcnt(8)
    v_mfma_f32_16x16x32_bf16 v[160:163], v[128:131], a[52:55], v[160:163]
    ds_read_b64_tr_b16 v[108:109], v16 offset:10336
    v_mfma_f32_16x16x32_bf16 v[164:167], v[128:131], a[132:135], v[164:167]
    ds_read_b64_tr_b16 v[110:111], v16 offset:11616
    s_waitcnt lgkmcnt(8)
    v_mfma_f32_16x16x32_bf16 v[168:171], v[132:135], a[52:55], v[168:171]
    ds_read_b64_tr_b16 v[112:113], v16 offset:10368
    buffer_load_dwordx4 v12, s[16:19], s91 offen lds
    s_add_u32 m0, m0, 1024
    v_mfma_f32_16x16x32_bf16 v[172:175], v[132:135], a[132:135], v[172:175]
    ds_read_b64_tr_b16 v[114:115], v16 offset:11648
    s_waitcnt lgkmcnt(8)
    v_mfma_f32_16x16x32_bf16 v[136:139], v[96:99], a[56:59], v[136:139]
    ds_read_b64_tr_b16 v[116:117], v16 offset:15360
    v_mfma_f32_16x16x32_bf16 v[140:143], v[96:99], a[136:139], v[140:143]
    ds_read_b64_tr_b16 v[118:119], v16 offset:16640
    s_waitcnt lgkmcnt(8)
    v_mfma_f32_16x16x32_bf16 v[144:147], v[100:103], a[56:59], v[144:147]
    ds_read_b64_tr_b16 v[120:121], v16 offset:15392
    v_mfma_f32_16x16x32_bf16 v[148:151], v[100:103], a[136:139], v[148:151]
    ds_read_b64_tr_b16 v[122:123], v16 offset:16672
    buffer_load_dwordx4 v13, s[16:19], s91 offen lds
    s_add_u32 m0, m0, 1024
    s_waitcnt lgkmcnt(8)
    v_mfma_f32_16x16x32_bf16 v[152:155], v[104:107], a[56:59], v[152:155]
    ds_read_b64_tr_b16 v[124:125], v16 offset:15424
    v_mfma_f32_16x16x32_bf16 v[156:159], v[104:107], a[136:139], v[156:159]
    ds_read_b64_tr_b16 v[126:127], v16 offset:16704
    s_waitcnt lgkmcnt(8)
    v_mfma_f32_16x16x32_bf16 v[160:163], v[108:111], a[56:59], v[160:163]
    ds_read_b64_tr_b16 v[128:129], v16 offset:15456
    v_mfma_f32_16x16x32_bf16 v[164:167], v[108:111], a[136:139], v[164:167]
    ds_read_b64_tr_b16 v[130:131], v16 offset:16736
    s_waitcnt lgkmcnt(8)
    v_mfma_f32_16x16x32_bf16 v[168:171], v[112:115], a[56:59], v[168:171]
    ds_read_b64_tr_b16 v[132:133], v16 offset:15488
    buffer_load_dwordx4 v14, s[16:19], s91 offen lds
    v_mfma_f32_16x16x32_bf16 v[172:175], v[112:115], a[136:139], v[172:175]
    ds_read_b64_tr_b16 v[134:135], v16 offset:16768
    s_waitcnt lgkmcnt(8)
    v_mfma_f32_16x16x32_bf16 v[136:139], v[116:119], a[60:63], v[136:139]
    v_mfma_f32_16x16x32_bf16 v[140:143], v[116:119], a[140:143], v[140:143]
    s_waitcnt lgkmcnt(6)
    v_mfma_f32_16x16x32_bf16 v[144:147], v[120:123], a[60:63], v[144:147]
    v_mfma_f32_16x16x32_bf16 v[148:151], v[120:123], a[140:143], v[148:151]
    v_add_u32 v16, s46, v15
    s_waitcnt vmcnt(10) lgkmcnt(0)
    s_barrier
    v_mfma_f32_16x16x32_bf16 v[152:155], v[124:127], a[60:63], v[152:155]
    ds_read_b64_tr_b16 v[96:97], v16 offset:0
    ds_read_b64_tr_b16 v[98:99], v16 offset:1280
    v_mfma_f32_16x16x32_bf16 v[156:159], v[124:127], a[140:143], v[156:159]
    ds_read_b64_tr_b16 v[100:101], v16 offset:32
    ds_read_b64_tr_b16 v[102:103], v16 offset:1312
    v_mfma_f32_16x16x32_bf16 v[160:163], v[128:131], a[60:63], v[160:163]
    ds_read_b64_tr_b16 v[104:105], v16 offset:64
    ds_read_b64_tr_b16 v[106:107], v16 offset:1344
    v_mfma_f32_16x16x32_bf16 v[164:167], v[128:131], a[140:143], v[164:167]
    ds_read_b64_tr_b16 v[108:109], v16 offset:96
    ds_read_b64_tr_b16 v[110:111], v16 offset:1376
    v_mfma_f32_16x16x32_bf16 v[168:171], v[132:135], a[60:63], v[168:171]
    ds_read_b64_tr_b16 v[112:113], v16 offset:128
    ds_read_b64_tr_b16 v[114:115], v16 offset:1408
    v_mfma_f32_16x16x32_bf16 v[172:175], v[132:135], a[140:143], v[172:175]
    s_waitcnt lgkmcnt(8)
    v_mfma_f32_16x16x32_bf16 v[136:139], v[96:99], a[64:67], v[136:139]
    ds_read_b64_tr_b16 v[116:117], v16 offset:5120
    s_add_u32 s46, s46, 20480
    s_cmp_eq_u32 s46, 81920
    v_mfma_f32_16x16x32_bf16 v[140:143], v[96:99], a[144:147], v[140:143]
    ds_read_b64_tr_b16 v[118:119], v16 offset:6400
    s_cselect_b32 s46, 0, s46
    s_mul_i32 s90, s32, 5120
    s_waitcnt lgkmcnt(8)
    v_mfma_f32_16x16x32_bf16 v[144:147], v[100:103], a[64:67], v[144:147]
    ds_read_b64_tr_b16 v[120:121], v16 offset:5152
    s_add_u32 m0, s90, s47
    s_mul_i32 s91, s44, 491520
    v_mfma_f32_16x16x32_bf16 v[148:151], v[100:103], a[144:147], v[148:151]
    ds_read_b64_tr_b16 v[122:123], v16 offset:6432
    s_add_u32 s91, s91, s43
    buffer_load_dwordx4 v10, s[16:19], s91 offen lds
    s_waitcnt lgkmcnt(8)
    v_mfma_f32_16x16x32_bf16 v[152:155], v[104:107], a[64:67], v[152:155]
    ds_read_b64_tr_b16 v[124:125], v16 offset:5184
    s_add_u32 s47, s47, 20480
    s_cmp_eq_u32 s47, 81920
    v_mfma_f32_16x16x32_bf16 v[156:159], v[104:107], a[144:147], v[156:159]
    ds_read_b64_tr_b16 v[126:127], v16 offset:6464
    s_cselect_b32 s47, 0, s47
    s_cmp_lg_u32 s51, 0
    s_waitcnt lgkmcnt(8)
    v_mfma_f32_16x16x32_bf16 v[160:163], v[108:111], a[64:67], v[160:163]
    ds_read_b64_tr_b16 v[128:129], v16 offset:5216
    s_cselect_b32 s90, 1, 0
    s_sub_u32 s51, s51, s90
    v_mfma_f32_16x16x32_bf16 v[164:167], v[108:111], a[144:147], v[164:167]
    ds_read_b64_tr_b16 v[130:131], v16 offset:6496
    s_add_u32 s44, s44, s90
    s_cmp_eq_u32 s44, 5
    s_waitcnt lgkmcnt(8)
    v_mfma_f32_16x16x32_bf16 v[168:171], v[112:115], a[64:67], v[168:171]
    ds_read_b64_tr_b16 v[132:133], v16 offset:5248
    s_cselect_b32 s44, 0, s44
    s_cselect_b32 s90, 1280, 0
    v_mfma_f32_16x16x32_bf16 v[172:175], v[112:115], a[144:147], v[172:175]
    ds_read_b64_tr_b16 v[134:135], v16 offset:6528
    s_addc_u32 s45, s45, 0
    s_add_u32 s43, s43, s90
    s_waitcnt lgkmcnt(8)
    v_mfma_f32_16x16x32_bf16 v[136:139], v[116:119], a[68:71], v[136:139]
    ds_read_b64_tr_b16 v[96:97], v16 offset:10240
    s_cmp_eq_u32 s45, 3
    s_cselect_b32 s45, 0, s45
    v_mfma_f32_16x16x32_bf16 v[140:143], v[116:119], a[148:151], v[140:143]
    ds_read_b64_tr_b16 v[98:99], v16 offset:11520
    s_cselect_b32 s90, 3680, 0
    s_cmp_eq_u32 s43, 4960
    s_waitcnt lgkmcnt(8)
    v_mfma_f32_16x16x32_bf16 v[144:147], v[120:123], a[68:71], v[144:147]
    ds_read_b64_tr_b16 v[100:101], v16 offset:10272
    s_cselect_b32 s90, s43, s90
    s_sub_u32 s43, s43, s90
    v_mfma_f32_16x16x32_bf16 v[148:151], v[120:123], a[148:151], v[148:151]
    ds_read_b64_tr_b16 v[102:103], v16 offset:11552
    s_add_u32 m0, m0, 1024
    s_nop 0
    buffer_load_dwordx4 v11, s[16:19], s91 offen lds
    s_waitcnt lgkmcnt(8)
    v_mfma_f32_16x16x32_bf16 v[152:155], v[124:127], a[68:71], v[152:155]
    ds_read_b64_tr_b16 v[104:105], v16 offset:10304
    s_add_u32 m0, m0, 1024
    v_mfma_f32_16x16x32_bf16 v[156:159], v[124:127], a[148:151], v[156:159]
    ds_read_b64_tr_b16 v[106:107], v16 offset:11584
    s_waitcnt lgkmcnt(8)
    v_mfma_f32_16x16x32_bf16 v[160:163], v[128:131], a[68:71], v[160:163]
    ds_read_b64_tr_b16 v[108:109], v16 offset:10336
    v_mfma_f32_16x16x32_bf16 v[164:167], v[128:131], a[148:151], v[164:167]
    ds_read_b64_tr_b16 v[110:111], v16 offset:11616
    s_waitcnt lgkmcnt(8)
    v_mfma_f32_16x16x32_bf16 v[168:171], v[132:135], a[68:71], v[168:171]
    ds_read_b64_tr_b16 v[112:113], v16 offset:10368
    buffer_load_dwordx4 v12, s[16:19], s91 offen lds
    s_add_u32 m0, m0, 1024
    v_mfma_f32_16x16x32_bf16 v[172:175], v[132:135], a[148:151], v[172:175]
    ds_read_b64_tr_b16 v[114:115], v16 offset:11648
    s_waitcnt lgkmcnt(8)
    v_mfma_f32_16x16x32_bf16 v[136:139], v[96:99], a[72:75], v[136:139]
    ds_read_b64_tr_b16 v[116:117], v16 offset:15360
    v_mfma_f32_16x16x32_bf16 v[140:143], v[96:99], a[152:155], v[140:143]
    ds_read_b64_tr_b16 v[118:119], v16 offset:16640
    s_waitcnt lgkmcnt(8)
    v_mfma_f32_16x16x32_bf16 v[144:147], v[100:103], a[72:75], v[144:147]
    ds_read_b64_tr_b16 v[120:121], v16 offset:15392
    v_mfma_f32_16x16x32_bf16 v[148:151], v[100:103], a[152:155], v[148:151]
    ds_read_b64_tr_b16 v[122:123], v16 offset:16672
    buffer_load_dwordx4 v13, s[16:19], s91 offen lds
    s_add_u32 m0, m0, 1024
    s_waitcnt lgkmcnt(8)
    v_mfma_f32_16x16x32_bf16 v[152:155], v[104:107], a[72:75], v[152:155]
    ds_read_b64_tr_b16 v[124:125], v16 offset:15424
    v_mfma_f32_16x16x32_bf16 v[156:159], v[104:107], a[152:155], v[156:159]
    ds_read_b64_tr_b16 v[126:127], v16 offset:16704
    s_waitcnt lgkmcnt(8)
    v_mfma_f32_16x16x32_bf16 v[160:163], v[108:111], a[72:75], v[160:163]
    ds_read_b64_tr_b16 v[128:129], v16 offset:15456
    v_mfma_f32_16x16x32_bf16 v[164:167], v[108:111], a[152:155], v[164:167]
    ds_read_b64_tr_b16 v[130:131], v16 offset:16736
    s_waitcnt lgkmcnt(8)
    v_mfma_f32_16x16x32_bf16 v[168:171], v[112:115], a[72:75], v[168:171]
    ds_read_b64_tr_b16 v[132:133], v16 offset:15488
    buffer_load_dwordx4 v14, s[16:19], s91 offen lds
    v_mfma_f32_16x16x32_bf16 v[172:175], v[112:115], a[152:155], v[172:175]
    ds_read_b64_tr_b16 v[134:135], v16 offset:16768
    s_waitcnt lgkmcnt(8)
    v_mfma_f32_16x16x32_bf16 v[136:139], v[116:119], a[76:79], v[136:139]
    v_mfma_f32_16x16x32_bf16 v[140:143], v[116:119], a[156:159], v[140:143]
    s_waitcnt lgkmcnt(6)
    v_mfma_f32_16x16x32_bf16 v[144:147], v[120:123], a[76:79], v[144:147]
    v_mfma_f32_16x16x32_bf16 v[148:151], v[120:123], a[156:159], v[148:151]
    v_add_u32 v16, s46, v15
    s_waitcnt vmcnt(10) lgkmcnt(0)
    s_barrier
    v_mfma_f32_16x16x32_bf16 v[152:155], v[124:127], a[76:79], v[152:155]
    ds_read_b64_tr_b16 v[96:97], v16 offset:0
    ds_read_b64_tr_b16 v[98:99], v16 offset:1280
    v_mfma_f32_16x16x32_bf16 v[156:159], v[124:127], a[156:159], v[156:159]
    ds_read_b64_tr_b16 v[100:101], v16 offset:32
    ds_read_b64_tr_b16 v[102:103], v16 offset:1312
    v_mfma_f32_16x16x32_bf16 v[160:163], v[128:131], a[76:79], v[160:163]
    ds_read_b64_tr_b16 v[104:105], v16 offset:64
    ds_read_b64_tr_b16 v[106:107], v16 offset:1344
    v_mfma_f32_16x16x32_bf16 v[164:167], v[128:131], a[156:159], v[164:167]
    ds_read_b64_tr_b16 v[108:109], v16 offset:96
    ds_read_b64_tr_b16 v[110:111], v16 offset:1376
    v_mfma_f32_16x16x32_bf16 v[168:171], v[132:135], a[76:79], v[168:171]
    ds_read_b64_tr_b16 v[112:113], v16 offset:128
    ds_read_b64_tr_b16 v[114:115], v16 offset:1408
    v_mfma_f32_16x16x32_bf16 v[172:175], v[132:135], a[156:159], v[172:175]
    v_add_u32 v18, s41, v17
    v_cvt_pk_bf16_f32 v176, v136, v137
    v_cvt_pk_bf16_f32 v177, v138, v139
    v_cvt_pk_bf16_f32 v178, v140, v141
    v_cvt_pk_bf16_f32 v179, v142, v143
    ds_write_b64 v18, v[176:177] offset:0
    ds_write_b64 v18, v[178:179] offset:2688
    v_cvt_pk_bf16_f32 v176, v144, v145
    v_cvt_pk_bf16_f32 v177, v146, v147
    v_cvt_pk_bf16_f32 v178, v148, v149
    v_cvt_pk_bf16_f32 v179, v150, v151
    ds_write_b64 v18, v[176:177] offset:32
    ds_write_b64 v18, v[178:179] offset:2720
    v_cvt_pk_bf16_f32 v176, v152, v153
    v_cvt_pk_bf16_f32 v177, v154, v155
    v_cvt_pk_bf16_f32 v178, v156, v157
    v_cvt_pk_bf16_f32 v179, v158, v159
    ds_write_b64 v18, v[176:177] offset:64
    ds_write_b64 v18, v[178:179] offset:2752
    v_cvt_pk_bf16_f32 v176, v160, v161
    v_cvt_pk_bf16_f32 v177, v162, v163
    v_cvt_pk_bf16_f32 v178, v164, v165
    v_cvt_pk_bf16_f32 v179, v166, v167
    ds_write_b64 v18, v[176:177] offset:96
    ds_write_b64 v18, v[178:179] offset:2784
    v_cvt_pk_bf16_f32 v176, v168, v169
    v_cvt_pk_bf16_f32 v177, v170, v171
    v_cvt_pk_bf16_f32 v178, v172, v173
    v_cvt_pk_bf16_f32 v179, v174, v175
    ds_write_b64 v18, v[176:177] offset:128
    ds_write_b64 v18, v[178:179] offset:2816
    s_waitcnt lgkmcnt(0)
    s_add_u32 s41, s41, 21504
    s_cmp_lt_u32 s41, 64512
    s_cbranch_scc1 L_pa_blk
    s_barrier
    s_mov_b32 s50, 0
L_pa_att:
    v_add_u32 v23, s50, v21
    v_add_u32 v22, s50, v20
    ds_read_b64 v[116:117], v22 offset:0
    ds_read_b64 v[118:119], v22 offset:8
    ds_read_b64 v[120:121], v22 offset:16
    ds_read_b64 v[122:123], v22 offset:24
    ds_read_b64 v[124:125], v22 offset:32
    ds_read_b64 v[126:127], v23 offset:2352
    ds_read_b64 v[128:129], v23 offset:2360
    ds_read_b64 v[130:131], v23 offset:2368
    ds_read_b64 v[132:133], v23 offset:2376
    ds_read_b64 v[134:135], v23 offset:2384
    ds_read_b64 v[136:137], v23 offset:2016
    ds_read_b64 v[138:139], v23 offset:2024
    ds_read_b64 v[140:141], v23 offset:2032
    ds_read_b64 v[142:143], v23 offset:2040
    ds_read_b64 v[144:145], v23 offset:2048
    s_waitcnt lgkmcnt(5)
    v_dot2_f32_bf16 v146, v116, v126, 0
    v_dot2_f32_bf16 v146, v117, v127, v146
    v_dot2_f32_bf16 v146, v118, v128, v146
    v_dot2_f32_bf16 v146, v119, v129, v146
    v_dot2_f32_bf16 v146, v120, v130, v146
    v_dot2_f32_bf16 v146, v121, v131, v146
    v_dot2_f32_bf16 v146, v122, v132, v146
    v_dot2_f32_bf16 v146, v123, v133, v146
    v_dot2_f32_bf16 v146, v124, v134, v146
    v_dot2_f32_bf16 v146, v125, v135, v146
    ds_read_b64 v[126:127], v23 offset:1680
    ds_read_b64 v[128:129], v23 offset:1688
    ds_read_b64 v[130:131], v23 offset:1696
    ds_read_b64 v[132:133], v23 offset:1704
    ds_read_b64 v[134:135], v23 offset:1712
    s_waitcnt lgkmcnt(5)
    v_dot2_f32_bf16 v147, v116, v136, 0
    v_dot2_f32_bf16 v147, v117, v137, v147
    v_dot2_f32_bf16 v147, v118, v138, v147
    v_dot2_f32_bf16 v147, v119, v139, v147
    v_dot2_f32_bf16 v147, v120, v140, v147
    v_dot2_f32_bf16 v147, v121, v141, v147
    v_dot2_f32_bf16 v147, v122, v142, v147
    v_dot2_f32_bf16 v147, v123, v143, v147
    v_dot2_f32_bf16 v147, v124, v144, v147
    v_dot2_f32_bf16 v147, v125, v145, v147
    ds_read_b64 v[136:137], v23 offset:1344
    ds_read_b64 v[138:139], v23 offset:1352
    ds_read_b64 v[140:141], v23 offset:1360
    ds_read_b64 v[142:143], v23 offset:1368
    ds_read_b64 v[144:145], v23 offset:1376
    s_waitcnt lgkmcnt(5)
    v_dot2_f32_bf16 v148, v116, v126, 0
    v_dot2_f32_bf16 v148, v117, v127, v148
    v_dot2_f32_bf16 v148, v118, v128, v148
    v_dot2_f32_bf16 v148, v119, v129, v148
    v_dot2_f32_bf16 v148, v120, v130, v148
    v_dot2_f32_bf16 v148, v121, v131, v148
    v_dot2_f32_bf16 v148, v122, v132, v148
    v_dot2_f32_bf16 v148, v123, v133, v148
    v_dot2_f32_bf16 v148, v124, v134, v148
    v_dot2_f32_bf16 v148, v125, v135, v148
    ds_read_b64 v[126:127], v23 offset:1008
    ds_read_b64 v[128:129], v23 offset:1016
    ds_read_b64 v[130:131], v23 offset:1024
    ds_read_b64 v[132:133], v23 offset:1032
    ds_read_b64 v[134:135], v23 offset:1040
    s_waitcnt lgkmcnt(5)
    v_dot2_f32_bf16 v149, v116, v136, 0
    v_dot2_f32_bf16 v149, v117, v137, v149
    v_dot2_f32_bf16 v149, v118, v138, v149
    v_dot2_f32_bf16 v149, v119, v139, v149
    v_dot2_f32_bf16 v149, v120, v140, v149
    v_dot2_f32_bf16 v149, v121, v141, v149
    v_dot2_f32_bf16 v149, v122, v142, v149
    v_dot2_f32_bf16 v149, v123, v143, v149
    v_dot2_f32_bf16 v149, v124, v144, v149
    v_dot2_f32_bf16 v149, v125, v145, v149
    ds_read_b64 v[136:137], v23 offset:672
    ds_read_b64 v[138:139], v23 offset:680
    ds_read_b64 v[140:141], v23 offset:688
    ds_read_b64 v[142:143], v23 offset:696
    ds_read_b64 v[144:145], v23 offset:704
    s_waitcnt lgkmcnt(5)
    v_dot2_f32_bf16 v150, v116, v126, 0
    v_dot2_f32_bf16 v150, v117, v127, v150
    v_dot2_f32_bf16 v150, v118, v128, v150
    v_dot2_f32_bf16 v150, v119, v129, v150
    v_dot2_f32_bf16 v150, v120, v130, v150
    v_dot2_f32_bf16 v150, v121, v131, v150
    v_dot2_f32_bf16 v150, v122, v132, v150
    v_dot2_f32_bf16 v150, v123, v133, v150
    v_dot2_f32_bf16 v150, v124, v134, v150
    v_dot2_f32_bf16 v150, v125, v135, v150
    ds_read_b64 v[126:127], v23 offset:336
    ds_read_b64 v[128:129], v23 offset:344
    ds_read_b64 v[130:131], v23 offset:352
    ds_read_b64 v[132:133], v23 offset:360
    ds_read_b64 v[134:135], v23 offset:368
    s_waitcnt lgkmcnt(5)
    v_dot2_f32_bf16 v151, v116, v136, 0
    v_dot2_f32_bf16 v151, v117, v137, v151
    v_dot2_f32_bf16 v151, v118, v138, v151
    v_dot2_f32_bf16 v151, v119, v139, v151
    v_dot2_f32_bf16 v151, v120, v140, v151
    v_dot2_f32_bf16 v151, v121, v141, v151
    v_dot2_f32_bf16 v151, v122, v142, v151
    v_dot2_f32_bf16 v151, v123, v143, v151
    v_dot2_f32_bf16 v151, v124, v144, v151
    v_dot2_f32_bf16 v151, v125, v145, v151
    ds_read_b64 v[136:137], v23 offset:0
    ds_read_b64 v[138:139], v23 offset:8
    ds_read_b64 v[140:141], v23 offset:16
    ds_read_b64 v[142:143], v23 offset:24
    ds_read_b64 v[144:145], v23 offset:32
    s_waitcnt lgkmcnt(5)
    v_dot2_f32_bf16 v152, v116, v126, 0
    v_dot2_f32_bf16 v152, v117, v127, v152
    v_dot2_f32_bf16 v152, v118, v128, v152
    v_dot2_f32_bf16 v152, v119, v129, v152
    v_dot2_f32_bf16 v152, v120, v130, v152
    v_dot2_f32_bf16 v152, v121, v131, v152
    v_dot2_f32_bf16 v152, v122, v132, v152
    v_dot2_f32_bf16 v152, v123, v133, v152
    v_dot2_f32_bf16 v152, v124, v134, v152
    v_dot2_f32_bf16 v152, v125, v135, v152
    ds_read_b64 v[126:127], v23 offset:23856
    ds_read_b64 v[128:129], v23 offset:23864
    ds_read_b64 v[130:131], v23 offset:23872
    ds_read_b64 v[132:133], v23 offset:23880
    ds_read_b64 v[134:135], v23 offset:23888
    s_waitcnt lgkmcnt(5)
    v_dot2_f32_bf16 v153, v116, v136, 0
    v_dot2_f32_bf16 v153, v117, v137, v153
    v_dot2_f32_bf16 v153, v118, v138, v153
    v_dot2_f32_bf16 v153, v119, v139, v153
    v_dot2_f32_bf16 v153, v120, v140, v153
    v_dot2_f32_bf16 v153, v121, v141, v153
    v_dot2_f32_bf16 v153, v122, v142, v153
    v_dot2_f32_bf16 v153, v123, v143, v153
    v_dot2_f32_bf16 v153, v124, v144, v153
    v_dot2_f32_bf16 v153, v125, v145, v153
    v_cmp_le_i32 vcc, 2, v24
    s_nop 1
    v_cndmask_b32 v147, v27, v147, vcc
    v_cmp_le_i32 vcc, 4, v24
    s_nop 1
    v_cndmask_b32 v148, v27, v148, vcc
    v_cmp_le_i32 vcc, 6, v24
    s_nop 1
    v_cndmask_b32 v149, v27, v149, vcc
    v_cmp_le_i32 vcc, 8, v24
    s_nop 1
    v_cndmask_b32 v150, v27, v150, vcc
    v_cmp_le_i32 vcc, 10, v24
    s_nop 1
    v_cndmask_b32 v151, v27, v151, vcc
    v_cmp_le_i32 vcc, 12, v24
    s_nop 1
    v_cndmask_b32 v152, v27, v152, vcc
    v_cmp_le_i32 vcc, 14, v24
    s_nop 1
    v_cndmask_b32 v153, v27, v153, vcc
    v_max_f32 v25, v146, v147
    v_max3_f32 v25, v25, v148, v149
    v_max3_f32 v25, v25, v150, v151
    v_max3_f32 v25, v25, v152, v153
    v_mul_f32 v25, 0xbea52b5c, v25
    v_fma_f32 v146, v146, s49, v25
    v_fma_f32 v147, v147, s49, v25
    v_fma_f32 v148, v148, s49, v25
    v_fma_f32 v149, v149, s49, v25
    v_fma_f32 v150, v150, s49, v25
    v_fma_f32 v151, v151, s49, v25
    v_fma_f32 v152, v152, s49, v25
    v_fma_f32 v153, v153, s49, v25
    v_exp_f32 v146, v146
    v_exp_f32 v147, v147
    v_exp_f32 v148, v148
    v_exp_f32 v149, v149
    v_exp_f32 v150, v150
    v_exp_f32 v151, v151
    v_exp_f32 v152, v152
    v_exp_f32 v153, v153
    v_add_f32 v26, v146, v147
    v_add_f32 v26, v26, v148
    v_add_f32 v26, v26, v149
    v_add_f32 v26, v26, v150
    v_add_f32 v26, v26, v151
    v_add_f32 v26, v26, v152
    v_add_f32 v26, v26, v153
    v_rcp_f32 v26, v26
    s_nop 0
    v_mul_f32 v146, v146, v26
    v_cvt_pk_bf16_f32 v154, v146, 0
    v_cvt_pk_bf16_f32 v155, 0, v146
    v_mul_f32 v147, v147, v26
    v_cvt_pk_bf16_f32 v156, v147, 0
    v_cvt_pk_bf16_f32 v157, 0, v147
    v_mul_f32 v148, v148, v26
    v_cvt_pk_bf16_f32 v158, v148, 0
    v_cvt_pk_bf16_f32 v159, 0, v148
    v_mul_f32 v149, v149, v26
    v_cvt_pk_bf16_f32 v160, v149, 0
    v_cvt_pk_bf16_f32 v161, 0, v149
    v_mul_f32 v150, v150, v26
    v_cvt_pk_bf16_f32 v162, v150, 0
    v_cvt_pk_bf16_f32 v163, 0, v150
    v_mul_f32 v151, v151, v26
    v_cvt_pk_bf16_f32 v164, v151, 0
    v_cvt_pk_bf16_f32 v165, 0, v151
    v_mul_f32 v152, v152, v26
    v_cvt_pk_bf16_f32 v166, v152, 0
    v_cvt_pk_bf16_f32 v167, 0, v152
    v_mul_f32 v153, v153, v26
    v_cvt_pk_bf16_f32 v168, v153, 0
    v_cvt_pk_bf16_f32 v169, 0, v153
    ds_read_b64 v[136:137], v23 offset:23520
    ds_read_b64 v[138:139], v23 offset:23528
    ds_read_b64 v[140:141], v23 offset:23536
    ds_read_b64 v[142:143], v23 offset:23544
    ds_read_b64 v[144:145], v23 offset:23552
    s_waitcnt lgkmcnt(5)
    v_dot2_f32_bf16 v170, v126, v154, 0
    v_dot2_f32_bf16 v171, v126, v155, 0
    v_dot2_f32_bf16 v172, v127, v154, 0
    v_dot2_f32_bf16 v173, v127, v155, 0
    v_dot2_f32_bf16 v174, v128, v154, 0
    v_dot2_f32_bf16 v175, v128, v155, 0
    v_dot2_f32_bf16 v176, v129, v154, 0
    v_dot2_f32_bf16 v177, v129, v155, 0
    v_dot2_f32_bf16 v178, v130, v154, 0
    v_dot2_f32_bf16 v179, v130, v155, 0
    v_dot2_f32_bf16 v180, v131, v154, 0
    v_dot2_f32_bf16 v181, v131, v155, 0
    v_dot2_f32_bf16 v182, v132, v154, 0
    v_dot2_f32_bf16 v183, v132, v155, 0
    v_dot2_f32_bf16 v184, v133, v154, 0
    v_dot2_f32_bf16 v185, v133, v155, 0
    v_dot2_f32_bf16 v186, v134, v154, 0
    v_dot2_f32_bf16 v187, v134, v155, 0
    v_dot2_f32_bf16 v188, v135, v154, 0
    v_dot2_f32_bf16 v189, v135, v155, 0
    ds_read_b64 v[126:127], v23 offset:23184
    ds_read_b64 v[128:129], v23 offset:23192
    ds_read_b64 v[130:131], v23 offset:23200
    ds_read_b64 v[132:133], v23 offset:23208
    ds_read_b64 v[134:135], v23 offset:23216
    s_waitcnt lgkmcnt(5)
    v_dot2_f32_bf16 v170, v136, v156, v170
    v_dot2_f32_bf16 v171, v136, v157, v171
    v_dot2_f32_bf16 v172, v137, v156, v172
    v_dot2_f32_bf16 v173, v137, v157, v173
    v_dot2_f32_bf16 v174, v138, v156, v174
    v_dot2_f32_bf16 v175, v138, v157, v175
    v_dot2_f32_bf16 v176, v139, v156, v176
    v_dot2_f32_bf16 v177, v139, v157, v177
    v_dot2_f32_bf16 v178, v140, v156, v178
    v_dot2_f32_bf16 v179, v140, v157, v179
    v_dot2_f32_bf16 v180, v141, v156, v180
    v_dot2_f32_bf16 v181, v141, v157, v181
    v_dot2_f32_bf16 v182, v142, v156, v182
    v_dot2_f32_bf16 v183, v142, v157, v183
    v_dot2_f32_bf16 v184, v143, v156, v184
    v_dot2_f32_bf16 v185, v143, v157, v185
    v_dot2_f32_bf16 v186, v144, v156, v186
    v_dot2_f32_bf16 v187, v144, v157, v187
    v_dot2_f32_bf16 v188, v145, v156, v188
    v_dot2_f32_bf16 v189, v145, v157, v189
    ds_read_b64 v[136:137], v23 offset:22848
    ds_read_b64 v[138:139], v23 offset:22856
    ds_read_b64 v[140:141], v23 offset:22864
    ds_read_b64 v[142:143], v23 offset:22872
    ds_read_b64 v[144:145], v23 offset:22880
    s_waitcnt lgkmcnt(5)
    v_dot2_f32_bf16 v170, v126, v158, v170
    v_dot2_f32_bf16 v171, v126, v159, v171
    v_dot2_f32_bf16 v172, v127, v158, v172
    v_dot2_f32_bf16 v173, v127, v159, v173
    v_dot2_f32_bf16 v174, v128, v158, v174
    v_dot2_f32_bf16 v175, v128, v159, v175
    v_dot2_f32_bf16 v176, v129, v158, v176
    v_dot2_f32_bf16 v177, v129, v159, v177
    v_dot2_f32_bf16 v178, v130, v158, v178
    v_dot2_f32_bf16 v179, v130, v159, v179
    v_dot2_f32_bf16 v180, v131, v158, v180
    v_dot2_f32_bf16 v181, v131, v159, v181
    v_dot2_f32_bf16 v182, v132, v158, v182
    v_dot2_f32_bf16 v183, v132, v159, v183
    v_dot2_f32_bf16 v184, v133, v158, v184
    v_dot2_f32_bf16 v185, v133, v159, v185
    v_dot2_f32_bf16 v186, v134, v158, v186
    v_dot2_f32_bf16 v187, v134, v159, v187
    v_dot2_f32_bf16 v188, v135, v158, v188
    v_dot2_f32_bf16 v189, v135, v159, v189
    ds_read_b64 v[126:127], v23 offset:22512
    ds_read_b64 v[128:129], v23 offset:22520
    ds_read_b64 v[130:131], v23 offset:22528
    ds_read_b64 v[132:133], v23 offset:22536
    ds_read_b64 v[134:135], v23 offset:22544
    s_waitcnt lgkmcnt(5)
    v_dot2_f32_bf16 v170, v136, v160, v170
    v_dot2_f32_bf16 v171, v136, v161, v171
    v_dot2_f32_bf16 v172, v137, v160, v172
    v_dot2_f32_bf16 v173, v137, v161, v173
    v_dot2_f32_bf16 v174, v138, v160, v174
    v_dot2_f32_bf16 v175, v138, v161, v175
    v_dot2_f32_bf16 v176, v139, v160, v176
    v_dot2_f32_bf16 v177, v139, v161, v177
    v_dot2_f32_bf16 v178, v140, v160, v178
    v_dot2_f32_bf16 v179, v140, v161, v179
    v_dot2_f32_bf16 v180, v141, v160, v180
    v_dot2_f32_bf16 v181, v141, v161, v181
    v_dot2_f32_bf16 v182, v142, v160, v182
    v_dot2_f32_bf16 v183, v142, v161, v183
    v_dot2_f32_bf16 v184, v143, v160, v184
    v_dot2_f32_bf16 v185, v143, v161, v185
    v_dot2_f32_bf16 v186, v144, v160, v186
    v_dot2_f32_bf16 v187, v144, v161, v187
    v_dot2_f32_bf16 v188, v145, v160, v188
    v_dot2_f32_bf16 v189, v145, v161, v189
    ds_read_b64 v[136:137], v23 offset:22176
    ds_read_b64 v[138:139], v23 offset:22184
    ds_read_b64 v[140:141], v23 offset:22192
    ds_read_b64 v[142:143], v23 offset:22200
    ds_read_b64 v[144:145], v23 offset:22208
    s_waitcnt lgkmcnt(5)
    v_dot2_f32_bf16 v170, v126, v162, v170
    v_dot2_f32_bf16 v171, v126, v163, v171
    v_dot2_f32_bf16 v172, v127, v162, v172
    v_dot2_f32_bf16 v173, v127, v163, v173
    v_dot2_f32_bf16 v174, v128, v162, v174
    v_dot2_f32_bf16 v175, v128, v163, v175
    v_dot2_f32_bf16 v176, v129, v162, v176
    v_dot2_f32_bf16 v177, v129, v163, v177
    v_dot2_f32_bf16 v178, v130, v162, v178
    v_dot2_f32_bf16 v179, v130, v163, v179
    v_dot2_f32_bf16 v180, v131, v162, v180
    v_dot2_f32_bf16 v181, v131, v163, v181
    v_dot2_f32_bf16 v182, v132, v162, v182
    v_dot2_f32_bf16 v183, v132, v163, v183
    v_dot2_f32_bf16 v184, v133, v162, v184
    v_dot2_f32_bf16 v185, v133, v163, v185
    v_dot2_f32_bf16 v186, v134, v162, v186
    v_dot2_f32_bf16 v187, v134, v163, v187
    v_dot2_f32_bf16 v188, v135, v162, v188
    v_dot2_f32_bf16 v189, v135, v163, v189
    ds_read_b64 v[126:127], v23 offset:21840
    ds_read_b64 v[128:129], v23 offset:21848
    ds_read_b64 v[130:131], v23 offset:21856
    ds_read_b64 v[132:133], v23 offset:21864
    ds_read_b64 v[134:135], v23 offset:21872
    s_waitcnt lgkmcnt(5)
    v_dot2_f32_bf16 v170, v136, v164, v170
    v_dot2_f32_bf16 v171, v136, v165, v171
    v_dot2_f32_bf16 v172, v137, v164, v172
    v_dot2_f32_bf16 v173, v137, v165, v173
    v_dot2_f32_bf16 v174, v138, v164, v174
    v_dot2_f32_bf16 v175, v138, v165, v175
    v_dot2_f32_bf16 v176, v139, v164, v176
    v_dot2_f32_bf16 v177, v139, v165, v177
    v_dot2_f32_bf16 v178, v140, v164, v178
    v_dot2_f32_bf16 v179, v140, v165, v179
    v_dot2_f32_bf16 v180, v141, v164, v180
    v_dot2_f32_bf16 v181, v141, v165, v181
    v_dot2_f32_bf16 v182, v142, v164, v182
    v_dot2_f32_bf16 v183, v142, v165, v183
    v_dot2_f32_bf16 v184, v143, v164, v184
    v_dot2_f32_bf16 v185, v143, v165, v185
    v_dot2_f32_bf16 v186, v144, v164, v186
    v_dot2_f32_bf16 v187, v144, v165, v187
    v_dot2_f32_bf16 v188, v145, v164, v188
    v_dot2_f32_bf16 v189, v145, v165, v189
    ds_read_b64 v[136:137], v23 offset:21504
    ds_read_b64 v[138:139], v23 offset:21512
    ds_read_b64 v[140:141], v23 offset:21520
    ds_read_b64 v[142:143], v23 offset:21528
    ds_read_b64 v[144:145], v23 offset:21536
    s_waitcnt lgkmcnt(5)
    v_dot2_f32_bf16 v170, v126, v166, v170
    v_dot2_f32_bf16 v171, v126, v167, v171
    v_dot2_f32_bf16 v172, v127, v166, v172
    v_dot2_f32_bf16 v173, v127, v167, v173
    v_dot2_f32_bf16 v174, v128, v166, v174
    v_dot2_f32_bf16 v175, v128, v167, v175
    v_dot2_f32_bf16 v176, v129, v166, v176
    v_dot2_f32_bf16 v177, v129, v167, v177
    v_dot2_f32_bf16 v178, v130, v166, v178
    v_dot2_f32_bf16 v179, v130, v167, v179
    v_dot2_f32_bf16 v180, v131, v166, v180
    v_dot2_f32_bf16 v181, v131, v167, v181
    v_dot2_f32_bf16 v182, v132, v166, v182
    v_dot2_f32_bf16 v183, v132, v167, v183
    v_dot2_f32_bf16 v184, v133, v166, v184
    v_dot2_f32_bf16 v185, v133, v167, v185
    v_dot2_f32_bf16 v186, v134, v166, v186
    v_dot2_f32_bf16 v187, v134, v167, v187
    v_dot2_f32_bf16 v188, v135, v166, v188
    v_dot2_f32_bf16 v189, v135, v167, v189
    s_waitcnt lgkmcnt(0)
    v_dot2_f32_bf16 v170, v136, v168, v170
    v_dot2_f32_bf16 v171, v136, v169, v171
    v_dot2_f32_bf16 v172, v137, v168, v172
    v_dot2_f32_bf16 v173, v137, v169, v173
    v_dot2_f32_bf16 v174, v138, v168, v174
    v_dot2_f32_bf16 v175, v138, v169, v175
    v_dot2_f32_bf16 v176, v139, v168, v176
    v_dot2_f32_bf16 v177, v139, v169, v177
    v_dot2_f32_bf16 v178, v140, v168, v178
    v_dot2_f32_bf16 v179, v140, v169, v179
    v_dot2_f32_bf16 v180, v141, v168, v180
    v_dot2_f32_bf16 v181, v141, v169, v181
    v_dot2_f32_bf16 v182, v142, v168, v182
    v_dot2_f32_bf16 v183, v142, v169, v183
    v_dot2_f32_bf16 v184, v143, v168, v184
    v_dot2_f32_bf16 v185, v143, v169, v185
    v_dot2_f32_bf16 v186, v144, v168, v186
    v_dot2_f32_bf16 v187, v144, v169, v187
    v_dot2_f32_bf16 v188, v145, v168, v188
    v_dot2_f32_bf16 v189, v145, v169, v189
    v_cvt_pk_bf16_f32 v116, v170, v171
    v_cvt_pk_bf16_f32 v117, v172, v173
    v_cvt_pk_bf16_f32 v118, v174, v175
    v_cvt_pk_bf16_f32 v119, v176, v177
    v_cvt_pk_bf16_f32 v120, v178, v179
    v_cvt_pk_bf16_f32 v121, v180, v181
    v_cvt_pk_bf16_f32 v122, v182, v183
    v_cvt_pk_bf16_f32 v123, v184, v185
    v_cvt_pk_bf16_f32 v124, v186, v187
    v_cvt_pk_bf16_f32 v125, v188, v189
    ds_write_b64 v22, v[116:117] offset:0
    ds_write_b64 v22, v[118:119] offset:8
    ds_write_b64 v22, v[120:121] offset:16
    ds_write_b64 v22, v[122:123] offset:24
    ds_write_b64 v22, v[124:125] offset:32
    s_waitcnt lgkmcnt(0)
    s_add_u32 s50, s50, 80
    s_cmp_lt_u32 s50, 160
    s_cbranch_scc1 L_pa_att
    s_cmp_lg_u32 s48, 0
    s_cbranch_scc1 L_pa_o1
    ds_read_b64 a[160:161], v28 offset:32
    ds_read_b64 a[162:163], v28 offset:40
    ds_read_b64 a[240:241], v28 offset:2720
    ds_read_b64 a[242:243], v28 offset:2728
    ds_read_b64 a[164:165], v28 offset:96
    ds_read_b64 a[166:167], v28 offset:104
    ds_read_b64 a[244:245], v28 offset:2784
    ds_read_b64 a[246:247], v28 offset:2792
    s_mov_b32 exec_hi, 0
    ds_read_b64 a[168:169], v28 offset:160
    ds_read_b64 a[170:171], v28 offset:168
    ds_read_b64 a[248:249], v28 offset:2848
    ds_read_b64 a[250:251], v28 offset:2856
    s_mov_b64 exec, -1
    s_branch L_pa_oe
L_pa_o1:
    s_cmp_lg_u32 s48, 1
    s_cbranch_scc1 L_pa_o2
    s_mov_b32 exec_lo, 0
    ds_read_b64 a[168:169], v28 offset:0
    ds_read_b64 a[170:171], v28 offset:8
    ds_read_b64 a[248:249], v28 offset:2688
    ds_read_b64 a[250:251], v28 offset:2696
    s_mov_b64 exec, -1
    ds_read_b64 a[172:173], v28 offset:64
    ds_read_b64 a[174:175], v28 offset:72
    ds_read_b64 a[252:253], v28 offset:2752
    ds_read_b64 a[254:255], v28 offset:2760
    ds_read_b64 a[176:177], v28 offset:128
    ds_read_b64 a[178:179], v28 offset:136
    ds_read_b64 v[32:33], v28 offset:2816
    ds_read_b64 v[34:35], v28 offset:2824
    s_branch L_pa_oe
L_pa_o2:
    s_cmp_lg_u32 s48, 2
    s_cbranch_scc1 L_pa_o3
    ds_read_b64 a[180:181], v28 offset:32
    ds_read_b64 a[182:183], v28 offset:40
    ds_read_b64 v[36:37], v28 offset:2720
    ds_read_b64 v[38:39], v28 offset:2728
    ds_read_b64 a[184:185], v28 offset:96
    ds_read_b64 a[186:187], v28 offset:104
    ds_read_b64 v[40:41], v28 offset:2784
    ds_read_b64 v[42:43], v28 offset:2792
    s_mov_b32 exec_hi, 0
    ds_read_b64 a[188:189], v28 offset:160
    ds_read_b64 a[190:191], v28 offset:168
    ds_read_b64 v[44:45], v28 offset:2848
    ds_read_b64 v[46:47], v28 offset:2856
    s_mov_b64 exec, -1
    s_branch L_pa_oe
L_pa_o3:
    s_cmp_lg_u32 s48, 3
    s_cbranch_scc1 L_pa_o4
    s_mov_b32 exec_lo, 0
    ds_read_b64 a[188:189], v28 offset:0
    ds_read_b64 a[190:191], v28 offset:8
    ds_read_b64 v[44:45], v28 offset:2688
    ds_read_b64 v[46:47], v28 offset:2696
    s_mov_b64 exec, -1
    ds_read_b64 a[192:193], v28 offset:64
    ds_read_b64 a[194:195], v28 offset:72
    ds_read_b64 v[48:49], v28 offset:2752
    ds_read_b64 v[50:51], v28 offset:2760
    ds_read_b64 a[196:197], v28 offset:128
    ds_read_b64 a[198:199], v28 offset:136
    ds_read_b64 v[52:53], v28 offset:2816
    ds_read_b64 v[54:55], v28 offset:2824
    s_branch L_pa_oe
L_pa_o4:
    s_cmp_lg_u32 s48, 4
    s_cbranch_scc1 L_pa_o5
    ds_read_b64 a[200:201], v28 offset:32
    ds_read_b64 a[202:203], v28 offset:40
    ds_read_b64 v[56:57], v28 offset:2720
    ds_read_b64 v[58:59], v28 offset:2728
    ds_read_b64 a[204:205], v28 offset:96
    ds_read_b64 a[206:207], v28 offset:104
    ds_read_b64 v[60:61], v28 offset:2784
    ds_read_b64 v[62:63], v28 offset:2792
    s_mov_b32 exec_hi, 0
    ds_read_b64 a[208:209], v28 offset:160
    ds_read_b64 a[210:211], v28 offset:168
    ds_read_b64 v[64:65], v28 offset:2848
    ds_read_b64 v[66:67], v28 offset:2856
    s_mov_b64 exec, -1
    s_branch L_pa_oe
L_pa_o5:
    s_cmp_lg_u32 s48, 5
    s_cbranch_scc1 L_pa_o6
    s_mov_b32 exec_lo, 0
    ds_read_b64 a[208:209], v28 offset:0
    ds_read_b64 a[210:211], v28 offset:8
    ds_read_b64 v[64:65], v28 offset:2688
    ds_read_b64 v[66:67], v28 offset:2696
    s_mov_b64 exec, -1
    ds_read_b64 a[212:213], v28 offset:64
    ds_read_b64 a[214:215], v28 offset:72
    ds_read_b64 v[68:69], v28 offset:2752
    ds_read_b64 v[70:71], v28 offset:2760
    ds_read_b64 a[216:217], v28 offset:128
    ds_read_b64 a[218:219], v28 offset:136
    ds_read_b64 v[72:73], v28 offset:2816
    ds_read_b64 v[74:75], v28 offset:2824
    s_branch L_pa_oe
L_pa_o6:
    s_cmp_lg_u32 s48, 6
    s_cbranch_scc1 L_pa_o7
    ds_read_b64 a[220:221], v28 offset:32
    ds_read_b64 a[222:223], v28 offset:40
    ds_read_b64 v[76:77], v28 offset:2720
    ds_read_b64 v[78:79], v28 offset:2728
    ds_read_b64 a[224:225], v28 offset:96
    ds_read_b64 a[226:227], v28 offset:104
    ds_read_b64 v[80:81], v28 offset:2784
    ds_read_b64 v[82:83], v28 offset:2792
    s_mov_b32 exec_hi, 0
    ds_read_b64 a[228:229], v28 offset:160
    ds_read_b64 a[230:231], v28 offset:168
    ds_read_b64 v[84:85], v28 offset:2848
    ds_read_b64 v[86:87], v28 offset:2856
    s_mov_b64 exec, -1
    s_branch L_pa_oe
L_pa_o7:
    s_mov_b32 exec_lo, 0
    ds_read_b64 a[228:229], v28 offset:0
    ds_read_b64 a[230:231], v28 offset:8
    ds_read_b64 v[84:85], v28 offset:2688
    ds_read_b64 v[86:87], v28 offset:2696
    s_mov_b64 exec, -1
    ds_read_b64 a[232:233], v28 offset:64
    ds_read_b64 a[234:235], v28 offset:72
    ds_read_b64 v[88:89], v28 offset:2752
    ds_read_b64 v[90:91], v28 offset:2760
    ds_read_b64 a[236:237], v28 offset:128
    ds_read_b64 a[238:239], v28 offset:136
    ds_read_b64 v[92:93], v28 offset:2816
    ds_read_b64 v[94:95], v28 offset:2824
L_pa_oe:
    s_waitcnt lgkmcnt(0)
    s_add_u32 s48, s48, 1
    s_and_b32 s48, s48, 7
    s_cmp_lg_u32 s48, s52
    s_cbranch_scc1 L_pa_grp
    v_add_u32 v3, 0, v0
    v_mul_u32_u24 v4, 6554, v3
    v_lshrrev_b32 v4, 16, v4
    v_mul_u32_u24 v5, 10, v4
    v_sub_u32 v5, v3, v5
    v_and_b32 v6, 19, v4
    v_and_b32 v7, 4, v4
    v_lshl_or_b32 v6, v7, 1, v6
    v_and_b32 v7, 8, v4
    v_lshrrev_b32 v7, 1, v7
    v_or_b32 v6, v6, v7
    s_lshl_b32 s90, s32, 5
    v_add_u32 v6, s90, v6
    v_mul_u32_u24 v6, 1280, v6
    v_lshl_add_u32 v10, v5, 4, v6
    v_add_u32 v3, 64, v0
    v_mul_u32_u24 v4, 6554, v3
    v_lshrrev_b32 v4, 16, v4
    v_mul_u32_u24 v5, 10, v4
    v_sub_u32 v5, v3, v5
    v_and_b32 v6, 19, v4
    v_and_b32 v7, 4, v4
    v_lshl_or_b32 v6, v7, 1, v6
    v_and_b32 v7, 8, v4
    v_lshrrev_b32 v7, 1, v7
    v_or_b32 v6, v6, v7
    s_lshl_b32 s90, s32, 5
    v_add_u32 v6, s90, v6
    v_mul_u32_u24 v6, 1280, v6
    v_lshl_add_u32 v11, v5, 4, v6
    v_add_u32 v3, 128, v0
    v_mul_u32_u24 v4, 6554, v3
    v_lshrrev_b32 v4, 16, v4
    v_mul_u32_u24 v5, 10, v4
    v_sub_u32 v5, v3, v5
    v_and_b32 v6, 19, v4
    v_and_b32 v7, 4, v4
    v_lshl_or_b32 v6, v7, 1, v6
    v_and_b32 v7, 8, v4
    v_lshrrev_b32 v7, 1, v7
    v_or_b32 v6, v6, v7
    s_lshl_b32 s90, s32, 5
    v_add_u32 v6, s90, v6
    v_mul_u32_u24 v6, 1280, v6
    v_lshl_add_u32 v12, v5, 4, v6
    v_add_u32 v3, 192, v0
    v_mul_u32_u24 v4, 6554, v3
    v_lshrrev_b32 v4, 16, v4
    v_mul_u32_u24 v5, 10, v4
    v_sub_u32 v5, v3, v5
    v_and_b32 v6, 19, v4
    v_and_b32 v7, 4, v4
    v_lshl_or_b32 v6, v7, 1, v6
    v_and_b32 v7, 8, v4
    v_lshrrev_b32 v7, 1, v7
    v_or_b32 v6, v6, v7
    s_lshl_b32 s90, s32, 5
    v_add_u32 v6, s90, v6
    v_mul_u32_u24 v6, 1280, v6
    v_lshl_add_u32 v13, v5, 4, v6
    v_add_u32 v3, 256, v0
    v_mul_u32_u24 v4, 6554, v3
    v_lshrrev_b32 v4, 16, v4
    v_mul_u32_u24 v5, 10, v4
    v_sub_u32 v5, v3, v5
    v_and_b32 v6, 19, v4
    v_and_b32 v7, 4, v4
    v_lshl_or_b32 v6, v7, 1, v6
    v_and_b32 v7, 8, v4
    v_lshrrev_b32 v7, 1, v7
    v_or_b32 v6, v6, v7
    s_lshl_b32 s90, s32, 5
    v_add_u32 v6, s90, v6
    v_mul_u32_u24 v6, 1280, v6
    v_lshl_add_u32 v14, v5, 4, v6
    s_waitcnt vmcnt(0) lgkmcnt(0)
    s_barrier
    s_mov_b32 s46, 0
    s_mov_b32 s47, 0
    s_mul_i32 s43, s52, 160
    s_mov_b32 s44, 0
    s_mov_b32 s45, 0
    s_mov_b32 s51, 39
    s_mov_b32 s48, s52
    s_mov_b32 s53, 0
    s_mul_i32 s90, s32, 5120
    s_add_u32 m0, s90, s47
    s_mul_i32 s91, s44, 163840
    s_add_u32 s91, s91, s43
    buffer_load_dwordx4 v10, s[20:23], s91 offen lds
    s_add_u32 s47, s47, 20480
    s_cmp_eq_u32 s47, 81920
    s_cselect_b32 s47, 0, s47
    s_cmp_lg_u32 s51, 0
    s_cselect_b32 s90, 1, 0
    s_sub_u32 s51, s51, s90
    s_add_u32 s44, s44, s90
    s_cmp_eq_u32 s44, 5
    s_cselect_b32 s44, 0, s44
    s_cselect_b32 s90, 160, 0
    s_add_u32 s43, s43, s90
    s_cmp_eq_u32 s43, 1280
    s_cselect_b32 s43, 0, s43
    s_add_u32 m0, m0, 1024
    s_nop 0
    buffer_load_dwordx4 v11, s[20:23], s91 offen lds
    s_add_u32 m0, m0, 1024
    s_nop 0
    buffer_load_dwordx4 v12, s[20:23], s91 offen lds
    s_add_u32 m0, m0, 1024
    s_nop 0
    buffer_load_dwordx4 v13, s[20:23], s91 offen lds
    s_add_u32 m0, m0, 1024
    s_nop 0
    buffer_load_dwordx4 v14, s[20:23], s91 offen lds
    s_mul_i32 s90, s32, 5120
    s_add_u32 m0, s90, s47
    s_mul_i32 s91, s44, 163840
    s_add_u32 s91, s91, s43
    buffer_load_dwordx4 v10, s[20:23], s91 offen lds
    s_add_u32 s47, s47, 20480
    s_cmp_eq_u32 s47, 81920
    s_cselect_b32 s47, 0, s47
    s_cmp_lg_u32 s51, 0
    s_cselect_b32 s90, 1, 0
    s_sub_u32 s51, s51, s90
    s_add_u32 s44, s44, s90
    s_cmp_eq_u32 s44, 5
    s_cselect_b32 s44, 0, s44
    s_cselect_b32 s90, 160, 0
    s_add_u32 s43, s43, s90
    s_cmp_eq_u32 s43, 1280
    s_cselect_b32 s43, 0, s43
    s_add_u32 m0, m0, 1024
    s_nop 0
    buffer_load_dwordx4 v11, s[20:23], s91 offen lds
    s_add_u32 m0, m0, 1024
    s_nop 0
    buffer_load_dwordx4 v12, s[20:23], s91 offen lds
    s_add_u32 m0, m0, 1024
    s_nop 0
    buffer_load_dwordx4 v13, s[20:23], s91 offen lds
    s_add_u32 m0, m0, 1024
    s_nop 0
    buffer_load_dwordx4 v14, s[20:23], s91 offen lds
    s_mul_i32 s90, s32, 5120
    s_add_u32 m0, s90, s47
    s_mul_i32 s91, s44, 163840
    s_add_u32 s91, s91, s43
    buffer_load_dwordx4 v10, s[20:23], s91 offen lds
    s_add_u32 s47, s47, 20480
    s_cmp_eq_u32 s47, 81920
    s_cselect_b32 s47, 0, s47
    s_cmp_lg_u32 s51, 0
    s_cselect_b32 s90, 1, 0
    s_sub_u32 s51, s51, s90
    s_add_u32 s44, s44, s90
    s_cmp_eq_u32 s44, 5
    s_cselect_b32 s44, 0, s44
    s_cselect_b32 s90, 160, 0
    s_add_u32 s43, s43, s90
    s_cmp_eq_u32 s43, 1280
    s_cselect_b32 s43, 0, s43
    s_add_u32 m0, m0, 1024
    s_nop 0
    buffer_load_dwordx4 v11, s[20:23], s91 offen lds
    s_add_u32 m0, m0, 1024
    s_nop 0
    buffer_load_dwordx4 v12, s[20:23], s91 offen lds
    s_add_u32 m0, m0, 1024
    s_nop 0
    buffer_load_dwordx4 v13, s[20:23], s91 offen lds
    s_add_u32 m0, m0, 1024
    s_nop 0
    buffer_load_dwordx4 v14, s[20:23], s91 offen lds
    v_add_u32 v16, s46, v15
    s_waitcnt vmcnt(10) lgkmcnt(0)
    s_barrier
    ds_read_b64_tr_b16 v[96:97], v16 offset:0
    ds_read_b64_tr_b16 v[98:99], v16 offset:1280
    ds_read_b64_tr_b16 v[100:101], v16 offset:32
    ds_read_b64_tr_b16 v[102:103], v16 offset:1312
    ds_read_b64_tr_b16 v[104:105], v16 offset:64
    ds_read_b64_tr_b16 v[106:107], v16 offset:1344
    ds_read_b64_tr_b16 v[108:109], v16 offset:96
    ds_read_b64_tr_b16 v[110:111], v16 offset:1376
    ds_read_b64_tr_b16 v[112:113], v16 offset:128
    ds_read_b64_tr_b16 v[114:115], v16 offset:1408
    s_mul_i32 s42, s52, 160
L_pa_oblk:
    s_waitcnt lgkmcnt(8)
    v_mfma_f32_16x16x32_bf16 v[136:139], v[96:99], a[160:163], 0
    ds_read_b64_tr_b16 v[116:117], v16 offset:5120
    s_add_u32 s46, s46, 20480
    s_cmp_eq_u32 s46, 81920
    v_mfma_f32_16x16x32_bf16 v[140:143], v[96:99], a[240:243], 0
    ds_read_b64_tr_b16 v[118:119], v16 offset:6400
    s_cselect_b32 s46, 0, s46
    s_mul_i32 s90, s32, 5120
    s_waitcnt lgkmcnt(8)
    v_mfma_f32_16x16x32_bf16 v[144:147], v[100:103], a[160:163], 0
    ds_read_b64_tr_b16 v[120:121], v16 offset:5152
    s_add_u32 m0, s90, s47
    s_mul_i32 s91, s44, 163840
    v_mfma_f32_16x16x32_bf16 v[148:151], v[100:103], a[240:243], 0
    ds_read_b64_tr_b16 v[122:123], v16 offset:6432
    s_add_u32 s91, s91, s43
    buffer_load_dwordx4 v10, s[20:23], s91 offen lds
    s_waitcnt lgkmcnt(8)
    v_mfma_f32_16x16x32_bf16 v[152:155], v[104:107], a[160:163], 0
    ds_read_b64_tr_b16 v[124:125], v16 offset:5184
    s_add_u32 s47, s47, 20480
    s_cmp_eq_u32 s47, 81920
    v_mfma_f32_16x16x32_bf16 v[156:159], v[104:107], a[240:243], 0
    ds_read_b64_tr_b16 v[126:127], v16 offset:6464
    s_cselect_b32 s47, 0, s47
    s_cmp_lg_u32 s51, 0
    s_waitcnt lgkmcnt(8)
    v_mfma_f32_16x16x32_bf16 v[160:163], v[108:111], a[160:163], 0
    ds_read_b64_tr_b16 v[128:129], v16 offset:5216
    s_cselect_b32 s90, 1, 0
    s_sub_u32 s51, s51, s90
    v_mfma_f32_16x16x32_bf16 v[164:167], v[108:111], a[240:243], 0
    ds_read_b64_tr_b16 v[130:131], v16 offset:6496
    s_add_u32 s44, s44, s90
    s_cmp_eq_u32 s44, 5
    s_waitcnt lgkmcnt(8)
    v_mfma_f32_16x16x32_bf16 v[168:171], v[112:115], a[160:163], 0
    ds_read_b64_tr_b16 v[132:133], v16 offset:5248
    s_cselect_b32 s44, 0, s44
    s_cselect_b32 s90, 160, 0
    v_mfma_f32_16x16x32_bf16 v[172:175], v[112:115], a[240:243], 0
    ds_read_b64_tr_b16 v[134:135], v16 offset:6528
    s_add_u32 s43, s43, s90
    s_cmp_eq_u32 s43, 1280
    s_waitcnt lgkmcnt(8)
    v_mfma_f32_16x16x32_bf16 v[136:139], v[116:119], a[164:167], v[136:139]
    ds_read_b64_tr_b16 v[96:97], v16 offset:10240
    s_cselect_b32 s43, 0, s43
    s_add_u32 m0, m0, 1024
    v_mfma_f32_16x16x32_bf16 v[140:143], v[116:119], a[244:247], v[140:143]
    ds_read_b64_tr_b16 v[98:99], v16 offset:11520
    buffer_load_dwordx4 v11, s[20:23], s91 offen lds
    s_add_u32 m0, m0, 1024
    s_waitcnt lgkmcnt(8)
    v_mfma_f32_16x16x32_bf16 v[144:147], v[120:123], a[164:167], v[144:147]
    ds_read_b64_tr_b16 v[100:101], v16 offset:10272
    v_mfma_f32_16x16x32_bf16 v[148:151], v[120:123], a[244:247], v[148:151]
    ds_read_b64_tr_b16 v[102:103], v16 offset:11552
    s_waitcnt lgkmcnt(8)
    v_mfma_f32_16x16x32_bf16 v[152:155], v[124:127], a[164:167], v[152:155]
    ds_read_b64_tr_b16 v[104:105], v16 offset:10304
    v_mfma_f32_16x16x32_bf16 v[156:159], v[124:127], a[244:247], v[156:159]
    ds_read_b64_tr_b16 v[106:107], v16 offset:11584
    s_waitcnt lgkmcnt(8)
    v_mfma_f32_16x16x32_bf16 v[160:163], v[128:131], a[164:167], v[160:163]
    ds_read_b64_tr_b16 v[108:109], v16 offset:10336
    buffer_load_dwordx4 v12, s[20:23], s91 offen lds
    s_add_u32 m0, m0, 1024
    v_mfma_f32_16x16x32_bf16 v[164:167], v[128:131], a[244:247], v[164:167]
    ds_read_b64_tr_b16 v[110:111], v16 offset:11616
    s_waitcnt lgkmcnt(8)
    v_mfma_f32_16x16x32_bf16 v[168:171], v[132:135], a[164:167], v[168:171]
    ds_read_b64_tr_b16 v[112:113], v16 offset:10368
    v_mfma_f32_16x16x32_bf16 v[172:175], v[132:135], a[244:247], v[172:175]
    ds_read_b64_tr_b16 v[114:115], v16 offset:11648
    s_waitcnt lgkmcnt(8)
    v_mfma_f32_16x16x32_bf16 v[136:139], v[96:99], a[168:171], v[136:139]
    ds_read_b64_tr_b16 v[116:117], v16 offset:15360
    v_mfma_f32_16x16x32_bf16 v[140:143], v[96:99], a[248:251], v[140:143]
    ds_read_b64_tr_b16 v[118:119], v16 offset:16640
    buffer_load_dwordx4 v13, s[20:23], s91 offen lds
    s_add_u32 m0, m0, 1024
    s_waitcnt lgkmcnt(8)
    v_mfma_f32_16x16x32_bf16 v[144:147], v[100:103], a[168:171], v[144:147]
    ds_read_b64_tr_b16 v[120:121], v16 offset:15392
    v_mfma_f32_16x16x32_bf16 v[148:151], v[100:103], a[248:251], v[148:151]
    ds_read_b64_tr_b16 v[122:123], v16 offset:16672
    s_waitcnt lgkmcnt(8)
    v_mfma_f32_16x16x32_bf16 v[152:155], v[104:107], a[168:171], v[152:155]
    ds_read_b64_tr_b16 v[124:125], v16 offset:15424
    v_mfma_f32_16x16x32_bf16 v[156:159], v[104:107], a[248:251], v[156:159]
    ds_read_b64_tr_b16 v[126:127], v16 offset:16704
    s_waitcnt lgkmcnt(8)
    v_mfma_f32_16x16x32_bf16 v[160:163], v[108:111], a[168:171], v[160:163]
    ds_read_b64_tr_b16 v[128:129], v16 offset:15456
    buffer_load_dwordx4 v14, s[20:23], s91 offen lds
    v_mfma_f32_16x16x32_bf16 v[164:167], v[108:111], a[248:251], v[164:167]
    ds_read_b64_tr_b16 v[130:131], v16 offset:16736
    s_waitcnt lgkmcnt(8)
    v_mfma_f32_16x16x32_bf16 v[168:171], v[112:115], a[168:171], v[168:171]
    ds_read_b64_tr_b16 v[132:133], v16 offset:15488
    v_mfma_f32_16x16x32_bf16 v[172:175], v[112:115], a[248:251], v[172:175]
    ds_read_b64_tr_b16 v[134:135], v16 offset:16768
    s_waitcnt lgkmcnt(8)
    v_mfma_f32_16x16x32_bf16 v[136:139], v[116:119], a[172:175], v[136:139]
    v_mfma_f32_16x16x32_bf16 v[140:143], v[116:119], a[252:255], v[140:143]
    s_waitcnt lgkmcnt(6)
    v_mfma_f32_16x16x32_bf16 v[144:147], v[120:123], a[172:175], v[144:147]
    v_mfma_f32_16x16x32_bf16 v[148:151], v[120:123], a[252:255], v[148:151]
    v_add_u32 v16, s46, v15
    s_waitcnt vmcnt(10) lgkmcnt(0)
    s_barrier
    v_mfma_f32_16x16x32_bf16 v[152:155], v[124:127], a[172:175], v[152:155]
    ds_read_b64_tr_b16 v[96:97], v16 offset:0
    ds_read_b64_tr_b16 v[98:99], v16 offset:1280
    v_mfma_f32_16x16x32_bf16 v[156:159], v[124:127], a[252:255], v[156:159]
    ds_read_b64_tr_b16 v[100:101], v16 offset:32
    ds_read_b64_tr_b16 v[102:103], v16 offset:1312
    v_mfma_f32_16x16x32_bf16 v[160:163], v[128:131], a[172:175], v[160:163]
    ds_read_b64_tr_b16 v[104:105], v16 offset:64
    ds_read_b64_tr_b16 v[106:107], v16 offset:1344
    v_mfma_f32_16x16x32_bf16 v[164:167], v[128:131], a[252:255], v[164:167]
    ds_read_b64_tr_b16 v[108:109], v16 offset:96
    ds_read_b64_tr_b16 v[110:111], v16 offset:1376
    v_mfma_f32_16x16x32_bf16 v[168:171], v[132:135], a[172:175], v[168:171]
    ds_read_b64_tr_b16 v[112:113], v16 offset:128
    ds_read_b64_tr_b16 v[114:115], v16 offset:1408
    v_mfma_f32_16x16x32_bf16 v[172:175], v[132:135], a[252:255], v[172:175]
    s_waitcnt lgkmcnt(8)
    v_mfma_f32_16x16x32_bf16 v[136:139], v[96:99], a[176:179], v[136:139]
    ds_read_b64_tr_b16 v[116:117], v16 offset:5120
    s_add_u32 s46, s46, 20480
    s_cmp_eq_u32 s46, 81920
    v_mfma_f32_16x16x32_bf16 v[140:143], v[96:99], v[32:35], v[140:143]
    ds_read_b64_tr_b16 v[118:119], v16 offset:6400
    s_cselect_b32 s46, 0, s46
    s_mul_i32 s90, s32, 5120
    s_waitcnt lgkmcnt(8)
    v_mfma_f32_16x16x32_bf16 v[144:147], v[100:103], a[176:179], v[144:147]
    ds_read_b64_tr_b16 v[120:121], v16 offset:5152
    s_add_u32 m0, s90, s47
    s_mul_i32 s91, s44, 163840
    v_mfma_f32_16x16x32_bf16 v[148:151], v[100:103], v[32:35], v[148:151]
    ds_read_b64_tr_b16 v[122:123], v16 offset:6432
    s_add_u32 s91, s91, s43
    buffer_load_dwordx4 v10, s[20:23], s91 offen lds
    s_waitcnt lgkmcnt(8)
    v_mfma_f32_16x16x32_bf16 v[152:155], v[104:107], a[176:179], v[152:155]
    ds_read_b64_tr_b16 v[124:125], v16 offset:5184
    s_add_u32 s47, s47, 20480
    s_cmp_eq_u32 s47, 81920
    v_mfma_f32_16x16x32_bf16 v[156:159], v[104:107], v[32:35], v[156:159]
    ds_read_b64_tr_b16 v[126:127], v16 offset:6464
    s_cselect_b32 s47, 0, s47
    s_cmp_lg_u32 s51, 0
    s_waitcnt lgkmcnt(8)
    v_mfma_f32_16x16x32_bf16 v[160:163], v[108:111], a[176:179], v[160:163]
    ds_read_b64_tr_b16 v[128:129], v16 offset:5216
    s_cselect_b32 s90, 1, 0
    s_sub_u32 s51, s51, s90
    v_mfma_f32_16x16x32_bf16 v[164:167], v[108:111], v[32:35], v[164:167]
    ds_read_b64_tr_b16 v[130:131], v16 offset:6496
    s_add_u32 s44, s44, s90
    s_cmp_eq_u32 s44, 5
    s_waitcnt lgkmcnt(8)
    v_mfma_f32_16x16x32_bf16 v[168:171], v[112:115], a[176:179], v[168:171]
    ds_read_b64_tr_b16 v[132:133], v16 offset:5248
    s_cselect_b32 s44, 0, s44
    s_cselect_b32 s90, 160, 0
    v_mfma_f32_16x16x32_bf16 v[172:175], v[112:115], v[32:35], v[172:175]
    ds_read_b64_tr_b16 v[134:135], v16 offset:6528
    s_add_u32 s43, s43, s90
    s_cmp_eq_u32 s43, 1280
    s_waitcnt lgkmcnt(8)
    v_mfma_f32_16x16x32_bf16 v[136:139], v[116:119], a[180:183], v[136:139]
    ds_read_b64_tr_b16 v[96:97], v16 offset:10240
    s_cselect_b32 s43, 0, s43
    s_add_u32 m0, m0, 1024
    v_mfma_f32_16x16x32_bf16 v[140:143], v[116:119], v[36:39], v[140:143]
    ds_read_b64_tr_b16 v[98:99], v16 offset:11520
    buffer_load_dwordx4 v11, s[20:23], s91 offen lds
    s_add_u32 m0, m0, 1024
    s_waitcnt lgkmcnt(8)
    v_mfma_f32_16x16x32_bf16 v[144:147], v[120:123], a[180:183], v[144:147]
    ds_read_b64_tr_b16 v[100:101], v16 offset:10272
    v_mfma_f32_16x16x32_bf16 v[148:151], v[120:123], v[36:39], v[148:151]
    ds_read_b64_tr_b16 v[102:103], v16 offset:11552
    s_waitcnt lgkmcnt(8)
    v_mfma_f32_16x16x32_bf16 v[152:155], v[124:127], a[180:183], v[152:155]
    ds_read_b64_tr_b16 v[104:105], v16 offset:10304
    v_mfma_f32_16x16x32_bf16 v[156:159], v[124:127], v[36:39], v[156:159]
    ds_read_b64_tr_b16 v[106:107], v16 offset:11584
    s_waitcnt lgkmcnt(8)
    v_mfma_f32_16x16x32_bf16 v[160:163], v[128:131], a[180:183], v[160:163]
    ds_read_b64_tr_b16 v[108:109], v16 offset:10336
    buffer_load_dwordx4 v12, s[20:23], s91 offen lds
    s_add_u32 m0, m0, 1024
    v_mfma_f32_16x16x32_bf16 v[164:167], v[128:131], v[36:39], v[164:167]
    ds_read_b64_tr_b16 v[110:111], v16 offset:11616
    s_waitcnt lgkmcnt(8)
    v_mfma_f32_16x16x32_bf16 v[168:171], v[132:135], a[180:183], v[168:171]
    ds_read_b64_tr_b16 v[112:113], v16 offset:10368
    v_mfma_f32_16x16x32_bf16 v[172:175], v[132:135], v[36:39], v[172:175]
    ds_read_b64_tr_b16 v[114:115], v16 offset:11648
    s_waitcnt lgkmcnt(8)
    v_mfma_f32_16x16x32_bf16 v[136:139], v[96:99], a[184:187], v[136:139]
    ds_read_b64_tr_b16 v[116:117], v16 offset:15360
    v_mfma_f32_16x16x32_bf16 v[140:143], v[96:99], v[40:43], v[140:143]
    ds_read_b64_tr_b16 v[118:119], v16 offset:16640
    buffer_load_dwordx4 v13, s[20:23], s91 offen lds
    s_add_u32 m0, m0, 1024
    s_waitcnt lgkmcnt(8)
    v_mfma_f32_16x16x32_bf16 v[144:147], v[100:103], a[184:187], v[144:147]
    ds_read_b64_tr_b16 v[120:121], v16 offset:15392
    v_mfma_f32_16x16x32_bf16 v[148:151], v[100:103], v[40:43], v[148:151]
    ds_read_b64_tr_b16 v[122:123], v16 offset:16672
    s_waitcnt lgkmcnt(8)
    v_mfma_f32_16x16x32_bf16 v[152:155], v[104:107], a[184:187], v[152:155]
    ds_read_b64_tr_b16 v[124:125], v16 offset:15424
    v_mfma_f32_16x16x32_bf16 v[156:159], v[104:107], v[40:43], v[156:159]
    ds_read_b64_tr_b16 v[126:127], v16 offset:16704
    s_waitcnt lgkmcnt(8)
    v_mfma_f32_16x16x32_bf16 v[160:163], v[108:111], a[184:187], v[160:163]
    ds_read_b64_tr_b16 v[128:129], v16 offset:15456
    buffer_load_dwordx4 v14, s[20:23], s91 offen lds
    v_mfma_f32_16x16x32_bf16 v[164:167], v[108:111], v[40:43], v[164:167]
    ds_read_b64_tr_b16 v[130:131], v16 offset:16736
    s_waitcnt lgkmcnt(8)
    v_mfma_f32_16x16x32_bf16 v[168:171], v[112:115], a[184:187], v[168:171]
    ds_read_b64_tr_b16 v[132:133], v16 offset:15488
    v_mfma_f32_16x16x32_bf16 v[172:175], v[112:115], v[40:43], v[172:175]
    ds_read_b64_tr_b16 v[134:135], v16 offset:16768
    s_waitcnt lgkmcnt(8)
    v_mfma_f32_16x16x32_bf16 v[136:139], v[116:119], a[188:191], v[136:139]
    v_mfma_f32_16x16x32_bf16 v[140:143], v[116:119], v[44:47], v[140:143]
    s_waitcnt lgkmcnt(6)
    v_mfma_f32_16x16x32_bf16 v[144:147], v[120:123], a[188:191], v[144:147]
    v_mfma_f32_16x16x32_bf16 v[148:151], v[120:123], v[44:47], v[148:151]
    v_add_u32 v16, s46, v15
    s_waitcnt vmcnt(10) lgkmcnt(0)
    s_barrier
    v_mfma_f32_16x16x32_bf16 v[152:155], v[124:127], a[188:191], v[152:155]
    ds_read_b64_tr_b16 v[96:97], v16 offset:0
    ds_read_b64_tr_b16 v[98:99], v16 offset:1280
    v_mfma_f32_16x16x32_bf16 v[156:159], v[124:127], v[44:47], v[156:159]
    ds_read_b64_tr_b16 v[100:101], v16 offset:32
    ds_read_b64_tr_b16 v[102:103], v16 offset:1312
    v_mfma_f32_16x16x32_bf16 v[160:163], v[128:131], a[188:191], v[160:163]
    ds_read_b64_tr_b16 v[104:105], v16 offset:64
    ds_read_b64_tr_b16 v[106:107], v16 offset:1344
    v_mfma_f32_16x16x32_bf16 v[164:167], v[128:131], v[44:47], v[164:167]
    ds_read_b64_tr_b16 v[108:109], v16 offset:96
    ds_read_b64_tr_b16 v[110:111], v16 offset:1376
    v_mfma_f32_16x16x32_bf16 v[168:171], v[132:135], a[188:191], v[168:171]
    ds_read_b64_tr_b16 v[112:113], v16 offset:128
    ds_read_b64_tr_b16 v[114:115], v16 offset:1408
    v_mfma_f32_16x16x32_bf16 v[172:175], v[132:135], v[44:47], v[172:175]
    s_waitcnt lgkmcnt(8)
    v_mfma_f32_16x16x32_bf16 v[136:139], v[96:99], a[192:195], v[136:139]
    ds_read_b64_tr_b16 v[116:117], v16 offset:5120
    s_add_u32 s46, s46, 20480
    s_cmp_eq_u32 s46, 81920
    v_mfma_f32_16x16x32_bf16 v[140:143], v[96:99], v[48:51], v[140:143]
    ds_read_b64_tr_b16 v[118:119], v16 offset:6400
    s_cselect_b32 s46, 0, s46
    s_mul_i32 s90, s32, 5120
    s_waitcnt lgkmcnt(8)
    v_mfma_f32_16x16x32_bf16 v[144:147], v[100:103], a[192:195], v[144:147]
    ds_read_b64_tr_b16 v[120:121], v16 offset:5152
    s_add_u32 m0, s90, s47
    s_mul_i32 s91, s44, 163840
    v_mfma_f32_16x16x32_bf16 v[148:151], v[100:103], v[48:51], v[148:151]
    ds_read_b64_tr_b16 v[122:123], v16 offset:6432
    s_add_u32 s91, s91, s43
    buffer_load_dwordx4 v10, s[20:23], s91 offen lds
    s_waitcnt lgkmcnt(8)
    v_mfma_f32_16x16x32_bf16 v[152:155], v[104:107], a[192:195], v[152:155]
    ds_read_b64_tr_b16 v[124:125], v16 offset:5184
    s_add_u32 s47, s47, 20480
    s_cmp_eq_u32 s47, 81920
    v_mfma_f32_16x16x32_bf16 v[156:159], v[104:107], v[48:51], v[156:159]
    ds_read_b64_tr_b16 v[126:127], v16 offset:6464
    s_cselect_b32 s47, 0, s47
    s_cmp_lg_u32 s51, 0
    s_waitcnt lgkmcnt(8)
    v_mfma_f32_16x16x32_bf16 v[160:163], v[108:111], a[192:195], v[160:163]
    ds_read_b64_tr_b16 v[128:129], v16 offset:5216
    s_cselect_b32 s90, 1, 0
    s_sub_u32 s51, s51, s90
    v_mfma_f32_16x16x32_bf16 v[164:167], v[108:111], v[48:51], v[164:167]
    ds_read_b64_tr_b16 v[130:131], v16 offset:6496
    s_add_u32 s44, s44, s90
    s_cmp_eq_u32 s44, 5
    s_waitcnt lgkmcnt(8)
    v_mfma_f32_16x16x32_bf16 v[168:171], v[112:115], a[192:195], v[168:171]
    ds_read_b64_tr_b16 v[132:133], v16 offset:5248
    s_cselect_b32 s44, 0, s44
    s_cselect_b32 s90, 160, 0
    v_mfma_f32_16x16x32_bf16 v[172:175], v[112:115], v[48:51], v[172:175]
    ds_read_b64_tr_b16 v[134:135], v16 offset:6528
    s_add_u32 s43, s43, s90
    s_cmp_eq_u32 s43, 1280
    s_waitcnt lgkmcnt(8)
    v_mfma_f32_16x16x32_bf16 v[136:139], v[116:119], a[196:199], v[136:139]
    ds_read_b64_tr_b16 v[96:97], v16 offset:10240
    s_cselect_b32 s43, 0, s43
    s_add_u32 m0, m0, 1024
    v_mfma_f32_16x16x32_bf16 v[140:143], v[116:119], v[52:55], v[140:143]
    ds_read_b64_tr_b16 v[98:99], v16 offset:11520
    buffer_load_dwordx4 v11, s[20:23], s91 offen lds
    s_add_u32 m0, m0, 1024
    s_waitcnt lgkmcnt(8)
    v_mfma_f32_16x16x32_bf16 v[144:147], v[120:123], a[196:199], v[144:147]
    ds_read_b64_tr_b16 v[100:101], v16 offset:10272
    v_mfma_f32_16x16x32_bf16 v[148:151], v[120:123], v[52:55], v[148:151]
    ds_read_b64_tr_b16 v[102:103], v16 offset:11552
    s_waitcnt lgkmcnt(8)
    v_mfma_f32_16x16x32_bf16 v[152:155], v[124:127], a[196:199], v[152:155]
    ds_read_b64_tr_b16 v[104:105], v16 offset:10304
    v_mfma_f32_16x16x32_bf16 v[156:159], v[124:127], v[52:55], v[156:159]
    ds_read_b64_tr_b16 v[106:107], v16 offset:11584
    s_waitcnt lgkmcnt(8)
    v_mfma_f32_16x16x32_bf16 v[160:163], v[128:131], a[196:199], v[160:163]
    ds_read_b64_tr_b16 v[108:109], v16 offset:10336
    buffer_load_dwordx4 v12, s[20:23], s91 offen lds
    s_add_u32 m0, m0, 1024
    v_mfma_f32_16x16x32_bf16 v[164:167], v[128:131], v[52:55], v[164:167]
    ds_read_b64_tr_b16 v[110:111], v16 offset:11616
    s_waitcnt lgkmcnt(8)
    v_mfma_f32_16x16x32_bf16 v[168:171], v[132:135], a[196:199], v[168:171]
    ds_read_b64_tr_b16 v[112:113], v16 offset:10368
    v_mfma_f32_16x16x32_bf16 v[172:175], v[132:135], v[52:55], v[172:175]
    ds_read_b64_tr_b16 v[114:115], v16 offset:11648
    s_waitcnt lgkmcnt(8)
    v_mfma_f32_16x16x32_bf16 v[136:139], v[96:99], a[200:203], v[136:139]
    ds_read_b64_tr_b16 v[116:117], v16 offset:15360
    v_mfma_f32_16x16x32_bf16 v[140:143], v[96:99], v[56:59], v[140:143]
    ds_read_b64_tr_b16 v[118:119], v16 offset:16640
    buffer_load_dwordx4 v13, s[20:23], s91 offen lds
    s_add_u32 m0, m0, 1024
    s_waitcnt lgkmcnt(8)
    v_mfma_f32_16x16x32_bf16 v[144:147], v[100:103], a[200:203], v[144:147]
    ds_read_b64_tr_b16 v[120:121], v16 offset:15392
    v_mfma_f32_16x16x32_bf16 v[148:151], v[100:103], v[56:59], v[148:151]
    ds_read_b64_tr_b16 v[122:123], v16 offset:16672
    s_waitcnt lgkmcnt(8)
    v_mfma_f32_16x16x32_bf16 v[152:155], v[104:107], a[200:203], v[152:155]
    ds_read_b64_tr_b16 v[124:125], v16 offset:15424
    v_mfma_f32_16x16x32_bf16 v[156:159], v[104:107], v[56:59], v[156:159]
    ds_read_b64_tr_b16 v[126:127], v16 offset:16704
    s_waitcnt lgkmcnt(8)
    v_mfma_f32_16x16x32_bf16 v[160:163], v[108:111], a[200:203], v[160:163]
    ds_read_b64_tr_b16 v[128:129], v16 offset:15456
    buffer_load_dwordx4 v14, s[20:23], s91 offen lds
    v_mfma_f32_16x16x32_bf16 v[164:167], v[108:111], v[56:59], v[164:167]
    ds_read_b64_tr_b16 v[130:131], v16 offset:16736
    s_waitcnt lgkmcnt(8)
    v_mfma_f32_16x16x32_bf16 v[168:171], v[112:115], a[200:203], v[168:171]
    ds_read_b64_tr_b16 v[132:133], v16 offset:15488
    v_mfma_f32_16x16x32_bf16 v[172:175], v[112:115], v[56:59], v[172:175]
    ds_read_b64_tr_b16 v[134:135], v16 offset:16768
    s_waitcnt lgkmcnt(8)
    v_mfma_f32_16x16x32_bf16 v[136:139], v[116:119], a[204:207], v[136:139]
    v_mfma_f32_16x16x32_bf16 v[140:143], v[116:119], v[60:63], v[140:143]
    s_waitcnt lgkmcnt(6)
    v_mfma_f32_16x16x32_bf16 v[144:147], v[120:123], a[204:207], v[144:147]
    v_mfma_f32_16x16x32_bf16 v[148:151], v[120:123], v[60:63], v[148:151]
    v_add_u32 v16, s46, v15
    s_waitcnt vmcnt(10) lgkmcnt(0)
    s_barrier
    v_mfma_f32_16x16x32_bf16 v[152:155], v[124:127], a[204:207], v[152:155]
    ds_read_b64_tr_b16 v[96:97], v16 offset:0
    ds_read_b64_tr_b16 v[98:99], v16 offset:1280
    v_mfma_f32_16x16x32_bf16 v[156:159], v[124:127], v[60:63], v[156:159]
    ds_read_b64_tr_b16 v[100:101], v16 offset:32
    ds_read_b64_tr_b16 v[102:103], v16 offset:1312
    v_mfma_f32_16x16x32_bf16 v[160:163], v[128:131], a[204:207], v[160:163]
    ds_read_b64_tr_b16 v[104:105], v16 offset:64
    ds_read_b64_tr_b16 v[106:107], v16 offset:1344
    v_mfma_f32_16x16x32_bf16 v[164:167], v[128:131], v[60:63], v[164:167]
    ds_read_b64_tr_b16 v[108:109], v16 offset:96
    ds_read_b64_tr_b16 v[110:111], v16 offset:1376
    v_mfma_f32_16x16x32_bf16 v[168:171], v[132:135], a[204:207], v[168:171]
    ds_read_b64_tr_b16 v[112:113], v16 offset:128
    ds_read_b64_tr_b16 v[114:115], v16 offset:1408
    v_mfma_f32_16x16x32_bf16 v[172:175], v[132:135], v[60:63], v[172:175]
    s_waitcnt lgkmcnt(8)
    v_mfma_f32_16x16x32_bf16 v[136:139], v[96:99], a[208:211], v[136:139]
    ds_read_b64_tr_b16 v[116:117], v16 offset:5120
    s_add_u32 s46, s46, 20480
    s_cmp_eq_u32 s46, 81920
    v_mfma_f32_16x16x32_bf16 v[140:143], v[96:99], v[64:67], v[140:143]
    ds_read_b64_tr_b16 v[118:119], v16 offset:6400
    s_cselect_b32 s46, 0, s46
    s_mul_i32 s90, s32, 5120
    s_waitcnt lgkmcnt(8)
    v_mfma_f32_16x16x32_bf16 v[144:147], v[100:103], a[208:211], v[144:147]
    ds_read_b64_tr_b16 v[120:121], v16 offset:5152
    s_add_u32 m0, s90, s47
    s_mul_i32 s91, s44, 163840
    v_mfma_f32_16x16x32_bf16 v[148:151], v[100:103], v[64:67], v[148:151]
    ds_read_b64_tr_b16 v[122:123], v16 offset:6432
    s_add_u32 s91, s91, s43
    buffer_load_dwordx4 v10, s[20:23], s91 offen lds
    s_waitcnt lgkmcnt(8)
    v_mfma_f32_16x16x32_bf16 v[152:155], v[104:107], a[208:211], v[152:155]
    ds_read_b64_tr_b16 v[124:125], v16 offset:5184
    s_add_u32 s47, s47, 20480
    s_cmp_eq_u32 s47, 81920
    v_mfma_f32_16x16x32_bf16 v[156:159], v[104:107], v[64:67], v[156:159]
    ds_read_b64_tr_b16 v[126:127], v16 offset:6464
    s_cselect_b32 s47, 0, s47
    s_cmp_lg_u32 s51, 0
    s_waitcnt lgkmcnt(8)
    v_mfma_f32_16x16x32_bf16 v[160:163], v[108:111], a[208:211], v[160:163]
    ds_read_b64_tr_b16 v[128:129], v16 offset:5216
    s_cselect_b32 s90, 1, 0
    s_sub_u32 s51, s51, s90
    v_mfma_f32_16x16x32_bf16 v[164:167], v[108:111], v[64:67], v[164:167]
    ds_read_b64_tr_b16 v[130:131], v16 offset:6496
    s_add_u32 s44, s44, s90
    s_cmp_eq_u32 s44, 5
    s_waitcnt lgkmcnt(8)
    v_mfma_f32_16x16x32_bf16 v[168:171], v[112:115], a[208:211], v[168:171]
    ds_read_b64_tr_b16 v[132:133], v16 offset:5248
    s_cselect_b32 s44, 0, s44
    s_cselect_b32 s90, 160, 0
    v_mfma_f32_16x16x32_bf16 v[172:175], v[112:115], v[64:67], v[172:175]
    ds_read_b64_tr_b16 v[134:135], v16 offset:6528
    s_add_u32 s43, s43, s90
    s_cmp_eq_u32 s43, 1280
    s_waitcnt lgkmcnt(8)
    v_mfma_f32_16x16x32_bf16 v[136:139], v[116:119], a[212:215], v[136:139]
    ds_read_b64_tr_b16 v[96:97], v16 offset:10240
    s_cselect_b32 s43, 0, s43
    s_add_u32 m0, m0, 1024
    v_mfma_f32_16x16x32_bf16 v[140:143], v[116:119], v[68:71], v[140:143]
    ds_read_b64_tr_b16 v[98:99], v16 offset:11520
    buffer_load_dwordx4 v11, s[20:23], s91 offen lds
    s_add_u32 m0, m0, 1024
    s_waitcnt lgkmcnt(8)
    v_mfma_f32_16x16x32_bf16 v[144:147], v[120:123], a[212:215], v[144:147]
    ds_read_b64_tr_b16 v[100:101], v16 offset:10272
    v_mfma_f32_16x16x32_bf16 v[148:151], v[120:123], v[68:71], v[148:151]
    ds_read_b64_tr_b16 v[102:103], v16 offset:11552
    s_waitcnt lgkmcnt(8)
    v_mfma_f32_16x16x32_bf16 v[152:155], v[124:127], a[212:215], v[152:155]
    ds_read_b64_tr_b16 v[104:105], v16 offset:10304
    v_mfma_f32_16x16x32_bf16 v[156:159], v[124:127], v[68:71], v[156:159]
    ds_read_b64_tr_b16 v[106:107], v16 offset:11584
    s_waitcnt lgkmcnt(8)
    v_mfma_f32_16x16x32_bf16 v[160:163], v[128:131], a[212:215], v[160:163]
    ds_read_b64_tr_b16 v[108:109], v16 offset:10336
    buffer_load_dwordx4 v12, s[20:23], s91 offen lds
    s_add_u32 m0, m0, 1024
    v_mfma_f32_16x16x32_bf16 v[164:167], v[128:131], v[68:71], v[164:167]
    ds_read_b64_tr_b16 v[110:111], v16 offset:11616
    s_waitcnt lgkmcnt(8)
    v_mfma_f32_16x16x32_bf16 v[168:171], v[132:135], a[212:215], v[168:171]
    ds_read_b64_tr_b16 v[112:113], v16 offset:10368
    v_mfma_f32_16x16x32_bf16 v[172:175], v[132:135], v[68:71], v[172:175]
    ds_read_b64_tr_b16 v[114:115], v16 offset:11648
    s_waitcnt lgkmcnt(8)
    v_mfma_f32_16x16x32_bf16 v[136:139], v[96:99], a[216:219], v[136:139]
    ds_read_b64_tr_b16 v[116:117], v16 offset:15360
    v_mfma_f32_16x16x32_bf16 v[140:143], v[96:99], v[72:75], v[140:143]
    ds_read_b64_tr_b16 v[118:119], v16 offset:16640
    buffer_load_dwordx4 v13, s[20:23], s91 offen lds
    s_add_u32 m0, m0, 1024
    s_waitcnt lgkmcnt(8)
    v_mfma_f32_16x16x32_bf16 v[144:147], v[100:103], a[216:219], v[144:147]
    ds_read_b64_tr_b16 v[120:121], v16 offset:15392
    v_mfma_f32_16x16x32_bf16 v[148:151], v[100:103], v[72:75], v[148:151]
    ds_read_b64_tr_b16 v[122:123], v16 offset:16672
    s_waitcnt lgkmcnt(8)
    v_mfma_f32_16x16x32_bf16 v[152:155], v[104:107], a[216:219], v[152:155]
    ds_read_b64_tr_b16 v[124:125], v16 offset:15424
    v_mfma_f32_16x16x32_bf16 v[156:159], v[104:107], v[72:75], v[156:159]
    ds_read_b64_tr_b16 v[126:127], v16 offset:16704
    s_waitcnt lgkmcnt(8)
    v_mfma_f32_16x16x32_bf16 v[160:163], v[108:111], a[216:219], v[160:163]
    ds_read_b64_tr_b16 v[128:129], v16 offset:15456
    buffer_load_dwordx4 v14, s[20:23], s91 offen lds
    v_mfma_f32_16x16x32_bf16 v[164:167], v[108:111], v[72:75], v[164:167]
    ds_read_b64_tr_b16 v[130:131], v16 offset:16736
    s_waitcnt lgkmcnt(8)
    v_mfma_f32_16x16x32_bf16 v[168:171], v[112:115], a[216:219], v[168:171]
    ds_read_b64_tr_b16 v[132:133], v16 offset:15488
    v_mfma_f32_16x16x32_bf16 v[172:175], v[112:115], v[72:75], v[172:175]
    ds_read_b64_tr_b16 v[134:135], v16 offset:16768
    s_waitcnt lgkmcnt(8)
    v_mfma_f32_16x16x32_bf16 v[136:139], v[116:119], a[220:223], v[136:139]
    v_mfma_f32_16x16x32_bf16 v[140:143], v[116:119], v[76:79], v[140:143]
    s_waitcnt lgkmcnt(6)
    v_mfma_f32_16x16x32_bf16 v[144:147], v[120:123], a[220:223], v[144:147]
    v_mfma_f32_16x16x32_bf16 v[148:151], v[120:123], v[76:79], v[148:151]
    v_add_u32 v16, s46, v15
    s_waitcnt vmcnt(10) lgkmcnt(0)
    s_barrier
    v_mfma_f32_16x16x32_bf16 v[152:155], v[124:127], a[220:223], v[152:155]
    ds_read_b64_tr_b16 v[96:97], v16 offset:0
    ds_read_b64_tr_b16 v[98:99], v16 offset:1280
    v_mfma_f32_16x16x32_bf16 v[156:159], v[124:127], v[76:79], v[156:159]
    ds_read_b64_tr_b16 v[100:101], v16 offset:32
    ds_read_b64_tr_b16 v[102:103], v16 offset:1312
    v_mfma_f32_16x16x32_bf16 v[160:163], v[128:131], a[220:223], v[160:163]
    ds_read_b64_tr_b16 v[104:105], v16 offset:64
    ds_read_b64_tr_b16 v[106:107], v16 offset:1344
    v_mfma_f32_16x16x32_bf16 v[164:167], v[128:131], v[76:79], v[164:167]
    ds_read_b64_tr_b16 v[108:109], v16 offset:96
    ds_read_b64_tr_b16 v[110:111], v16 offset:1376
    v_mfma_f32_16x16x32_bf16 v[168:171], v[132:135], a[220:223], v[168:171]
    ds_read_b64_tr_b16 v[112:113], v16 offset:128
    ds_read_b64_tr_b16 v[114:115], v16 offset:1408
    v_mfma_f32_16x16x32_bf16 v[172:175], v[132:135], v[76:79], v[172:175]
    s_waitcnt lgkmcnt(8)
    v_mfma_f32_16x16x32_bf16 v[136:139], v[96:99], a[224:227], v[136:139]
    ds_read_b64_tr_b16 v[116:117], v16 offset:5120
    s_add_u32 s46, s46, 20480
    s_cmp_eq_u32 s46, 81920
    v_mfma_f32_16x16x32_bf16 v[140:143], v[96:99], v[80:83], v[140:143]
    ds_read_b64_tr_b16 v[118:119], v16 offset:6400
    s_cselect_b32 s46, 0, s46
    s_mul_i32 s90, s32, 5120
    s_waitcnt lgkmcnt(8)
    v_mfma_f32_16x16x32_bf16 v[144:147], v[100:103], a[224:227], v[144:147]
    ds_read_b64_tr_b16 v[120:121], v16 offset:5152
    s_add_u32 m0, s90, s47
    s_mul_i32 s91, s44, 163840
    v_mfma_f32_16x16x32_bf16 v[148:151], v[100:103], v[80:83], v[148:151]
    ds_read_b64_tr_b16 v[122:123], v16 offset:6432
    s_add_u32 s91, s91, s43
    buffer_load_dwordx4 v10, s[20:23], s91 offen lds
    s_waitcnt lgkmcnt(8)
    v_mfma_f32_16x16x32_bf16 v[152:155], v[104:107], a[224:227], v[152:155]
    ds_read_b64_tr_b16 v[124:125], v16 offset:5184
    s_add_u32 s47, s47, 20480
    s_cmp_eq_u32 s47, 81920
    v_mfma_f32_16x16x32_bf16 v[156:159], v[104:107], v[80:83], v[156:159]
    ds_read_b64_tr_b16 v[126:127], v16 offset:6464
    s_cselect_b32 s47, 0, s47
    s_cmp_lg_u32 s51, 0
    s_waitcnt lgkmcnt(8)
    v_mfma_f32_16x16x32_bf16 v[160:163], v[108:111], a[224:227], v[160:163]
    ds_read_b64_tr_b16 v[128:129], v16 offset:5216
    s_cselect_b32 s90, 1, 0
    s_sub_u32 s51, s51, s90
    v_mfma_f32_16x16x32_bf16 v[164:167], v[108:111], v[80:83], v[164:167]
    ds_read_b64_tr_b16 v[130:131], v16 offset:6496
    s_add_u32 s44, s44, s90
    s_cmp_eq_u32 s44, 5
    s_waitcnt lgkmcnt(8)
    v_mfma_f32_16x16x32_bf16 v[168:171], v[112:115], a[224:227], v[168:171]
    ds_read_b64_tr_b16 v[132:133], v16 offset:5248
    s_cselect_b32 s44, 0, s44
    s_cselect_b32 s90, 160, 0
    v_mfma_f32_16x16x32_bf16 v[172:175], v[112:115], v[80:83], v[172:175]
    ds_read_b64_tr_b16 v[134:135], v16 offset:6528
    s_add_u32 s43, s43, s90
    s_cmp_eq_u32 s43, 1280
    s_waitcnt lgkmcnt(8)
    v_mfma_f32_16x16x32_bf16 v[136:139], v[116:119], a[228:231], v[136:139]
    ds_read_b64_tr_b16 v[96:97], v16 offset:10240
    s_cselect_b32 s43, 0, s43
    s_add_u32 m0, m0, 1024
    v_mfma_f32_16x16x32_bf16 v[140:143], v[116:119], v[84:87], v[140:143]
    ds_read_b64_tr_b16 v[98:99], v16 offset:11520
    buffer_load_dwordx4 v11, s[20:23], s91 offen lds
    s_add_u32 m0, m0, 1024
    s_waitcnt lgkmcnt(8)
    v_mfma_f32_16x16x32_bf16 v[144:147], v[120:123], a[228:231], v[144:147]
    ds_read_b64_tr_b16 v[100:101], v16 offset:10272
    v_mfma_f32_16x16x32_bf16 v[148:151], v[120:123], v[84:87], v[148:151]
    ds_read_b64_tr_b16 v[102:103], v16 offset:11552
    s_waitcnt lgkmcnt(8)
    v_mfma_f32_16x16x32_bf16 v[152:155], v[124:127], a[228:231], v[152:155]
    ds_read_b64_tr_b16 v[104:105], v16 offset:10304
    v_mfma_f32_16x16x32_bf16 v[156:159], v[124:127], v[84:87], v[156:159]
    ds_read_b64_tr_b16 v[106:107], v16 offset:11584
    s_waitcnt lgkmcnt(8)
    v_mfma_f32_16x16x32_bf16 v[160:163], v[128:131], a[228:231], v[160:163]
    ds_read_b64_tr_b16 v[108:109], v16 offset:10336
    buffer_load_dwordx4 v12, s[20:23], s91 offen lds
    s_add_u32 m0, m0, 1024
    v_mfma_f32_16x16x32_bf16 v[164:167], v[128:131], v[84:87], v[164:167]
    ds_read_b64_tr_b16 v[110:111], v16 offset:11616
    s_waitcnt lgkmcnt(8)
    v_mfma_f32_16x16x32_bf16 v[168:171], v[132:135], a[228:231], v[168:171]
    ds_read_b64_tr_b16 v[112:113], v16 offset:10368
    v_mfma_f32_16x16x32_bf16 v[172:175], v[132:135], v[84:87], v[172:175]
    ds_read_b64_tr_b16 v[114:115], v16 offset:11648
    s_waitcnt lgkmcnt(8)
    v_mfma_f32_16x16x32_bf16 v[136:139], v[96:99], a[232:235], v[136:139]
    ds_read_b64_tr_b16 v[116:117], v16 offset:15360
    v_mfma_f32_16x16x32_bf16 v[140:143], v[96:99], v[88:91], v[140:143]
    ds_read_b64_tr_b16 v[118:119], v16 offset:16640
    buffer_load_dwordx4 v13, s[20:23], s91 offen lds
    s_add_u32 m0, m0, 1024
    s_waitcnt lgkmcnt(8)
    v_mfma_f32_16x16x32_bf16 v[144:147], v[100:103], a[232:235], v[144:147]
    ds_read_b64_tr_b16 v[120:121], v16 offset:15392
    v_mfma_f32_16x16x32_bf16 v[148:151], v[100:103], v[88:91], v[148:151]
    ds_read_b64_tr_b16 v[122:123], v16 offset:16672
    s_waitcnt lgkmcnt(8)
    v_mfma_f32_16x16x32_bf16 v[152:155], v[104:107], a[232:235], v[152:155]
    ds_read_b64_tr_b16 v[124:125], v16 offset:15424
    v_mfma_f32_16x16x32_bf16 v[156:159], v[104:107], v[88:91], v[156:159]
    ds_read_b64_tr_b16 v[126:127], v16 offset:16704
    s_waitcnt lgkmcnt(8)
    v_mfma_f32_16x16x32_bf16 v[160:163], v[108:111], a[232:235], v[160:163]
    ds_read_b64_tr_b16 v[128:129], v16 offset:15456
    buffer_load_dwordx4 v14, s[20:23], s91 offen lds
    v_mfma_f32_16x16x32_bf16 v[164:167], v[108:111], v[88:91], v[164:167]
    ds_read_b64_tr_b16 v[130:131], v16 offset:16736
    s_waitcnt lgkmcnt(8)
    v_mfma_f32_16x16x32_bf16 v[168:171], v[112:115], a[232:235], v[168:171]
    ds_read_b64_tr_b16 v[132:133], v16 offset:15488
    v_mfma_f32_16x16x32_bf16 v[172:175], v[112:115], v[88:91], v[172:175]
    ds_read_b64_tr_b16 v[134:135], v16 offset:16768
    s_waitcnt lgkmcnt(8)
    v_mfma_f32_16x16x32_bf16 v[136:139], v[116:119], a[236:239], v[136:139]
    v_mfma_f32_16x16x32_bf16 v[140:143], v[116:119], v[92:95], v[140:143]
    s_waitcnt lgkmcnt(6)
    v_mfma_f32_16x16x32_bf16 v[144:147], v[120:123], a[236:239], v[144:147]
    v_mfma_f32_16x16x32_bf16 v[148:151], v[120:123], v[92:95], v[148:151]
    v_add_u32 v16, s46, v15
    s_waitcnt vmcnt(10) lgkmcnt(0)
    s_barrier
    v_mfma_f32_16x16x32_bf16 v[152:155], v[124:127], a[236:239], v[152:155]
    ds_read_b64_tr_b16 v[96:97], v16 offset:0
    ds_read_b64_tr_b16 v[98:99], v16 offset:1280
    v_mfma_f32_16x16x32_bf16 v[156:159], v[124:127], v[92:95], v[156:159]
    ds_read_b64_tr_b16 v[100:101], v16 offset:32
    ds_read_b64_tr_b16 v[102:103], v16 offset:1312
    v_mfma_f32_16x16x32_bf16 v[160:163], v[128:131], a[236:239], v[160:163]
    ds_read_b64_tr_b16 v[104:105], v16 offset:64
    ds_read_b64_tr_b16 v[106:107], v16 offset:1344
    v_mfma_f32_16x16x32_bf16 v[164:167], v[128:131], v[92:95], v[164:167]
    ds_read_b64_tr_b16 v[108:109], v16 offset:96
    ds_read_b64_tr_b16 v[110:111], v16 offset:1376
    v_mfma_f32_16x16x32_bf16 v[168:171], v[132:135], a[236:239], v[168:171]
    ds_read_b64_tr_b16 v[112:113], v16 offset:128
    ds_read_b64_tr_b16 v[114:115], v16 offset:1408
    v_mfma_f32_16x16x32_bf16 v[172:175], v[132:135], v[92:95], v[172:175]
    v_cvt_pk_bf16_f32 v176, v136, v137
    v_cvt_pk_bf16_f32 v177, v138, v139
    v_cvt_pk_bf16_f32 v178, v140, v141
    v_cvt_pk_bf16_f32 v179, v142, v143
    s_nop 0
    v_permlane16_swap_b32 v176, v178
    v_permlane16_swap_b32 v177, v179
    buffer_store_dwordx4 v[176:179], v19, s[28:31], s42 offen offset:0
    s_nop 1
    v_cvt_pk_bf16_f32 v176, v144, v145
    v_cvt_pk_bf16_f32 v177, v146, v147
    v_cvt_pk_bf16_f32 v178, v148, v149
    v_cvt_pk_bf16_f32 v179, v150, v151
    s_nop 0
    v_permlane16_swap_b32 v176, v178
    v_permlane16_swap_b32 v177, v179
    buffer_store_dwordx4 v[176:179], v19, s[28:31], s42 offen offset:32
    s_nop 1
    v_cvt_pk_bf16_f32 v176, v152, v153
    v_cvt_pk_bf16_f32 v177, v154, v155
    v_cvt_pk_bf16_f32 v178, v156, v157
    v_cvt_pk_bf16_f32 v179, v158, v159
    s_nop 0
    v_permlane16_swap_b32 v176, v178
    v_permlane16_swap_b32 v177, v179
    buffer_store_dwordx4 v[176:179], v19, s[28:31], s42 offen offset:64
    s_nop 1
    v_cvt_pk_bf16_f32 v176, v160, v161
    v_cvt_pk_bf16_f32 v177, v162, v163
    v_cvt_pk_bf16_f32 v178, v164, v165
    v_cvt_pk_bf16_f32 v179, v166, v167
    s_nop 0
    v_permlane16_swap_b32 v176, v178
    v_permlane16_swap_b32 v177, v179
    buffer_store_dwordx4 v[176:179], v19, s[28:31], s42 offen offset:96
    s_nop 1
    v_cvt_pk_bf16_f32 v176, v168, v169
    v_cvt_pk_bf16_f32 v177, v170, v171
    v_cvt_pk_bf16_f32 v178, v172, v173
    v_cvt_pk_bf16_f32 v179, v174, v175
    s_nop 0
    v_permlane16_swap_b32 v176, v178
    v_permlane16_swap_b32 v177, v179
    buffer_store_dwordx4 v[176:179], v19, s[28:31], s42 offen offset:128
    s_add_u32 s42, s42, 160
    s_cmp_eq_u32 s42, 1280
    s_cselect_b32 s42, 0, s42
    s_add_u32 s53, s53, 1
    s_cmp_lt_u32 s53, 8
    s_cbranch_scc1 L_pa_oblk
L_pa_end:
    s_waitcnt vmcnt(0)
    s_endpgm
L_slow:
    s_waitcnt vmcnt(0) lgkmcnt(0)
    s_barrier
    s_and_b32 s34, s2, 7
    s_lshr_b32 s35, s2, 3
    s_add_u32 s4, s88, 33554432
    s_addc_u32 s5, s89, 0
    s_and_b32 s5, s5, 0xffff
    s_cmp_lg_u32 s32, 0
    s_cbranch_scc1 L_slow_go
    v_mov_b32 v240, -1
    v_mov_b32 v241, -1
    v_mov_b32 v242, -1
    v_mov_b32 v243, -1
    v_mov_b32 v244, 0
    v_lshlrev_b32 v4, 4, v0
    v_lshlrev_b32 v5, 2, v0
    s_mul_i32 s91, s2, 2560
    s_and_b32 s92, s2, 7
    s_lshl_b32 s92, s92, 21
    s_add_u32 s92, s92, 8388608
    s_lshr_b32 s93, s2, 3
    s_lshl_b32 s40, s93, 7
    s_add_u32 s40, s40, s92
    s_add_u32 s40, s40, 458752
    s_lshr_b32 s41, s93, 4
    s_mul_i32 s41, s41, 114688
    s_add_u32 s92, s92, s41
    s_and_b32 s93, s93, 15
    s_mul_i32 s93, s93, 2560
    s_add_u32 s92, s92, s93
    buffer_store_dwordx4 v[240:243], v4, s[4:7], s91 offen sc1
    buffer_store_dwordx4 v[240:243], v4, s[4:7], s91 offen offset:1024 sc1
    buffer_store_dword v240, v5, s[4:7], s91 offen offset:2048 sc1
    buffer_store_dword v240, v5, s[4:7], s91 offen offset:2304 sc1
    buffer_store_dwordx4 v[240:243], v4, s[4:7], s92 offen sc1
    buffer_store_dwordx4 v[240:243], v4, s[4:7], s92 offen offset:1024 sc1
    buffer_store_dword v240, v5, s[4:7], s92 offen offset:2048 sc1
    buffer_store_dword v240, v5, s[4:7], s92 offen offset:2304 sc1
    s_mov_b64 exec, 0xffffffff
    buffer_store_dword v244, v5, s[4:7], s40 offen sc1
    s_lshl_b32 s40, s2, 7
    s_add_u32 s40, s40, 1933312
    buffer_store_dword v244, v5, s[4:7], s40 offen sc1
    s_mov_b64 exec, -1
    s_waitcnt vmcnt(0)
    v_mov_b32 v1, 68
    v_mov_b32 v4, 1
    s_mov_b64 exec, 1
    buffer_atomic_add v4, v1, s[8:11], 0 offen sc1
    s_mov_b64 exec, -1
L_slow_go:
    s_lshl_b32 s38, s34, 21
    s_add_u32 s38, s38, 8388608
    s_cmp_lt_u32 s35, 12
    s_cbranch_scc1 L_qkv_s
    s_cmp_lt_u32 s35, 18
    s_cbranch_scc1 L_v_s
    s_cmp_lt_u32 s35, 28
    s_cbranch_scc1 L_wo_s
    s_cmp_lt_u32 s35, 29
    s_cbranch_scc1 L_px_s
    s_branch L_pa_s
L_qkv_s:
    s_mov_b32 s12, s74
    s_and_b32 s13, s75, 0xffff
    s_mov_b32 s14, 7864320
    s_mov_b32 s15, 0x20000
    s_mov_b32 s16, s76
    s_and_b32 s17, s77, 0xffff
    s_mov_b32 s18, 7864320
    s_mov_b32 s19, 0x20000
    s_mov_b32 s40, s35
    s_mov_b32 s24, s70
    s_and_b32 s25, s71, 0xffff
    s_mov_b32 s26, 2621440
    s_mov_b32 s27, 0x20000
    v_and_b32 v1, 15, v0
    v_lshrrev_b32 v2, 4, v0
    v_lshrrev_b32 v3, 3, v0
    v_and_b32 v4, 7, v0
    s_lshl_b32 s90, s32, 3
    v_add_u32 v5, s90, v3
    s_and_b32 s91, s32, 1
    s_lshl_b32 s91, s91, 2
    v_and_b32 v6, 2, v3
    v_or_b32 v6, s91, v6
    v_xor_b32 v6, v6, v4
    v_lshlrev_b32 v6, 4, v6
    v_mul_u32_u24 v7, 12288, v5
    s_mul_i32 s92, s34, 1536
    s_lshl_b32 s93, s40, 7
    s_add_u32 s92, s92, s93
    v_add3_u32 v124, v6, v7, s92
    v_lshrrev_b32 v6, 1, v3
    v_or_b32 v6, s91, v6
    v_xor_b32 v6, v6, v4
    v_lshlrev_b32 v6, 4, v6
    v_mul_u32_u24 v7, 1280, v5
    v_add_u32 v10, v6, v7
    s_lshl_b32 s90, s32, 10
    s_add_u32 m0, s90, 81920
    s_mov_b32 s91, 0
    buffer_load_dwordx4 v124, s[12:15], s91 offen nt lds
    s_add_u32 m0, m0, 4096
    s_add_u32 s91, s91, 393216
    buffer_load_dwordx4 v124, s[12:15], s91 offen nt lds
    s_add_u32 m0, m0, 4096
    s_add_u32 s91, s91, 393216
    buffer_load_dwordx4 v124, s[12:15], s91 offen nt lds
    s_add_u32 m0, m0, 4096
    s_add_u32 s91, s91, 393216
    buffer_load_dwordx4 v124, s[12:15], s91 offen nt lds
    s_add_u32 m0, m0, 4096
    s_add_u32 s91, s91, 393216
    buffer_load_dwordx4 v124, s[12:15], s91 offen nt lds
    s_add_u32 m0, m0, 4096
    s_add_u32 s91, s91, 393216
    buffer_load_dwordx4 v124, s[12:15], s91 offen nt lds
    s_add_u32 m0, m0, 4096
    s_add_u32 s91, s91, 393216
    buffer_load_dwordx4 v124, s[12:15], s91 offen nt lds
    s_add_u32 m0, m0, 4096
    s_add_u32 s91, s91, 393216
    buffer_load_dwordx4 v124, s[12:15], s91 offen nt lds
    s_add_u32 m0, m0, 4096
    s_add_u32 s91, s91, 393216
    buffer_load_dwordx4 v124, s[12:15], s91 offen nt lds
    s_add_u32 m0, m0, 4096
    s_add_u32 s91, s91, 393216
    buffer_load_dwordx4 v124, s[12:15], s91 offen nt lds
    s_lshl_b32 s90, s32, 10
    s_add_u32 m0, s90, 40960
    s_mov_b32 s91, 0
    buffer_load_dwordx4 v124, s[16:19], s91 offen nt lds
    s_add_u32 m0, m0, 4096
    s_add_u32 s91, s91, 393216
    buffer_load_dwordx4 v124, s[16:19], s91 offen nt lds
    s_add_u32 m0, m0, 4096
    s_add_u32 s91, s91, 393216
    buffer_load_dwordx4 v124, s[16:19], s91 offen nt lds
    s_add_u32 m0, m0, 4096
    s_add_u32 s91, s91, 393216
    buffer_load_dwordx4 v124, s[16:19], s91 offen nt lds
    s_add_u32 m0, m0, 4096
    s_add_u32 s91, s91, 393216
    buffer_load_dwordx4 v124, s[16:19], s91 offen nt lds
    s_add_u32 m0, m0, 4096
    s_add_u32 s91, s91, 393216
    buffer_load_dwordx4 v124, s[16:19], s91 offen nt lds
    s_add_u32 m0, m0, 4096
    s_add_u32 s91, s91, 393216
    buffer_load_dwordx4 v124, s[16:19], s91 offen nt lds
    s_add_u32 m0, m0, 4096
    s_add_u32 s91, s91, 393216
    buffer_load_dwordx4 v124, s[16:19], s91 offen nt lds
    s_add_u32 m0, m0, 4096
    s_add_u32 s91, s91, 393216
    buffer_load_dwordx4 v124, s[16:19], s91 offen nt lds
    s_add_u32 m0, m0, 4096
    s_add_u32 s91, s91, 393216
    buffer_load_dwordx4 v124, s[16:19], s91 offen nt lds
    s_lshl_b32 s90, s32, 10
    s_add_u32 m0, s90, 122880
    s_mov_b32 s91, 3932160
    buffer_load_dwordx4 v124, s[12:15], s91 offen nt lds
    s_add_u32 m0, m0, 4096
    s_add_u32 s91, s91, 393216
    buffer_load_dwordx4 v124, s[12:15], s91 offen nt lds
    s_add_u32 m0, m0, 4096
    s_add_u32 s91, s91, 393216
    buffer_load_dwordx4 v124, s[12:15], s91 offen nt lds
    s_add_u32 m0, m0, 4096
    s_add_u32 s91, s91, 393216
    buffer_load_dwordx4 v124, s[12:15], s91 offen nt lds
    s_add_u32 m0, m0, 4096
    s_add_u32 s91, s91, 393216
    buffer_load_dwordx4 v124, s[12:15], s91 offen nt lds
    s_add_u32 m0, m0, 4096
    s_add_u32 s91, s91, 393216
    buffer_load_dwordx4 v124, s[12:15], s91 offen nt lds
    s_add_u32 m0, m0, 4096
    s_add_u32 s91, s91, 393216
    buffer_load_dwordx4 v124, s[12:15], s91 offen nt lds
    s_add_u32 m0, m0, 4096
    s_add_u32 s91, s91, 393216
    buffer_load_dwordx4 v124, s[12:15], s91 offen nt lds
    s_add_u32 m0, m0, 4096
    s_add_u32 s91, s91, 393216
    buffer_load_dwordx4 v124, s[12:15], s91 offen nt lds
    s_add_u32 m0, m0, 4096
    s_add_u32 s91, s91, 393216
    buffer_load_dwordx4 v124, s[12:15], s91 offen nt lds
    s_mov_b32 s46, 0
    s_lshl_b32 s90, s32, 10
    s_add_u32 m0, s90, 0
    s_nop 0
    buffer_load_dwordx4 v10, s[24:27], s46 offen offset:0 lds
    s_add_u32 m0, m0, 3968
    s_nop 0
    buffer_load_dwordx4 v10, s[24:27], s46 offen offset:128 lds
    s_add_u32 m0, m0, 3968
    s_nop 0
    buffer_load_dwordx4 v10, s[24:27], s46 offen offset:256 lds
    s_add_u32 m0, m0, 3968
    s_nop 0
    buffer_load_dwordx4 v10, s[24:27], s46 offen offset:384 lds
    s_add_u32 m0, m0, 3968
    s_nop 0
    buffer_load_dwordx4 v10, s[24:27], s46 offen offset:512 lds
    s_add_u32 m0, m0, 3968
    s_nop 0
    buffer_load_dwordx4 v10, s[24:27], s46 offen offset:640 lds
    s_add_u32 m0, m0, 3968
    s_nop 0
    buffer_load_dwordx4 v10, s[24:27], s46 offen offset:768 lds
    s_add_u32 m0, m0, 3968
    s_nop 0
    buffer_load_dwordx4 v10, s[24:27], s46 offen offset:896 lds
    s_add_u32 m0, m0, 3968
    s_nop 0
    buffer_load_dwordx4 v10, s[24:27], s46 offen offset:1024 lds
    s_add_u32 m0, m0, 3968
    s_nop 0
    buffer_load_dwordx4 v10, s[24:27], s46 offen offset:1152 lds
    s_mul_i32 s60, s40, 86
    s_lshr_b32 s60, s60, 8
    s_mul_i32 s59, s60, 3
    s_sub_u32 s59, s40, s59
    s_add_u32 s90, s40, 1
    s_mul_i32 s62, s90, 86
    s_lshr_b32 s62, s62, 8
    s_mul_i32 s63, s62, 3
    s_sub_u32 s63, s90, s63
    v_lshrrev_b32 v3, 1, v2
    v_and_b32 v5, 1, v2
    s_lshl_b32 s90, s32, 9
    v_lshlrev_b32 v6, 4, v1
    v_lshl_add_u32 v6, v3, 8, v6
    v_add_u32 v6, s90, v6
    s_mul_i32 s90, s60, 12288
    s_lshl_b32 s91, s59, 11
    s_add_u32 s90, s90, s91
    v_mul_u32_u24 v7, 6144, v5
    v_add3_u32 v19, v6, v7, s90
    v_mov_b32 v22, -1
    s_mov_b32 s56, 49152
    v_lshl_add_u32 v137, v5, 11, v6
    v_add_u32 v137, 135168, v137
    s_mul_i32 s90, s40, 1280
    s_add_u32 s90, s90, 10240
    v_lshlrev_b32 v6, 1, v5
    v_or_b32 v7, v6, v3
    v_lshl_add_u32 v7, v7, 4, v1
    v_lshlrev_b32 v7, 2, v7
    v_add_u32 v7, 1024, v7
    v_or_b32 v6, v6, v1
    v_lshl_add_u32 v6, v3, 4, v6
    v_lshlrev_b32 v6, 4, v6
    s_sub_u32 s91, s32, 1
    s_lshl_b32 s91, s91, 9
    v_add_u32 v6, s91, v6
    s_cmp_eq_u32 s32, 0
    s_cselect_b64 vcc, -1, 0
    v_cndmask_b32 v6, v6, v7, vcc
    v_add_u32 v135, s90, v6
    s_lshl_b32 s91, s32, 8
    s_add_u32 s91, s91, s90
    v_lshl_add_u32 v150, v0, 2, s91
    v_and_b32 v4, 2, v1
    v_cmp_eq_u32 vcc, 0, v4
    v_mov_b32 v9, 2146435072
    s_nop 0
    v_cndmask_b32 v135, v9, v135, vcc
    s_lshl_b32 s90, s40, 10
    v_lshrrev_b32 v3, 2, v1
    v_lshlrev_b32 v3, 1, v3
    v_and_b32 v6, 1, v1
    v_or_b32 v3, v3, v6
    v_lshl_add_u32 v3, v2, 3, v3
    v_lshl_add_u32 v136, v3, 4, s90
    v_cmp_ne_u32 vcc, 0, v4
    v_mov_b32 v9, 2146435072
    s_nop 0
    v_cndmask_b32 v136, v9, v136, vcc
    v_and_b32 v6, 9, v1
    v_lshl_or_b32 v6, v4, 1, v6
    v_and_b32 v7, 4, v1
    v_lshrrev_b32 v7, 1, v7
    v_or_b32 v6, v6, v7
    v_lshlrev_b32 v6, 4, v6
    v_lshl_add_u32 v6, v2, 8, v6
    s_cmp_eq_u32 s32, 2
    s_cselect_b32 s90, 2048, 0
    s_add_u32 s90, s90, 135168
    v_add_u32 v138, s90, v6
    s_lshl_b32 s90, s60, 7
    s_lshl_b32 s91, s59, 2
    s_add_u32 s91, s91, s90
    s_add_u32 s91, s91, 459264
    s_cmp_eq_u32 s32, 3
    s_cselect_b32 s91, s91, 2146435072
    s_cselect_b32 s55, -1, 0
    v_mov_b32 v139, s91
    v_cmp_eq_u32 vcc, 0, v0
    v_mov_b32 v9, 2146435072
    s_nop 0
    v_cndmask_b32 v139, v9, v139, vcc
    v_add_u32 v21, 3072, v139
    s_mul_i32 s90, s35, 32768
    s_lshl_b32 s91, s32, 11
    s_add_u32 s90, s90, s91
    s_lshl_b32 s92, s35, 10
    s_lshl_b32 s91, s32, 8
    s_add_u32 s92, s92, s91
    s_cmp_lt_u32 s35, 10
    s_cselect_b32 s90, s90, 2146435072
    s_cselect_b32 s92, s92, 2146435072
    s_lshl_b32 s91, s34, 8
    v_lshlrev_b32 v3, 4, v0
    v_xor_b32 v3, s91, v3
    v_add_u32 v142, s90, v3
    v_xor_b32 v3, 1024, v3
    v_add_u32 v143, s90, v3
    s_min_u32 s90, s35, 9
    s_lshl_b32 s90, s90, 7
    s_add_u32 s90, s90, 460800
    s_add_u32 s90, s90, s38
    v_and_b32 v3, 3, v0
    v_lshl_add_u32 v146, v3, 2, s90
    v_lshl_add_u32 v149, v0, 2, s92
    v_lshl_add_u32 v148, v1, 4, s92
    v_cmp_eq_u32 vcc, 0, v2
    v_mov_b32 v9, 2146435072
    s_nop 0
    v_cndmask_b32 v148, v9, v148, vcc
    v_and_b32 v7, 1, v1
    v_cmp_ne_u32 vcc, 0, v7
    v_mov_b32 v5, 0x3f80
    v_mov_b32 v6, 0x3f800000
    v_cndmask_b32 v5, v5, v6, vcc
    v_bfe_u32 v6, v1, 1, 1
    v_cmp_eq_u32 vcc, 0, v6
    s_nop 1
    v_cndmask_b32 v198, 0, v5, vcc
    v_mov_b32 v196, 0
    v_mov_b32 v200, 0
    v_cmp_eq_u32 vcc, 1, v6
    s_nop 1
    v_cndmask_b32 v199, 0, v5, vcc
    v_mov_b32 v197, 0
    v_mov_b32 v201, 0
    v_lshrrev_b32 v3, 2, v1
    v_and_b32 v4, 3, v1
    v_and_b32 v5, 1, v2
    v_lshl_add_u32 v6, v2, 3, v3
    v_lshlrev_b32 v6, 7, v6
    v_and_b32 v7, 2, v3
    v_lshl_or_b32 v7, v5, 2, v7
    v_lshrrev_b32 v8, 1, v4
    s_lshl_b32 s90, s32, 1
    v_or_b32 v8, s90, v8
    v_xor_b32 v7, v7, v8
    v_lshl_add_u32 v6, v7, 4, v6
    v_and_b32 v7, 1, v4
    v_lshl_add_u32 v6, v7, 3, v6
    v_add_u32 v125, 81920, v6
    v_add_u32 v126, 40960, v6
    v_add_u32 v127, 122880, v6
    s_lshl_b32 s90, s32, 9
    s_add_u32 s90, s90, 133120
    v_xor_b32 v6, 0, v5
    v_lshl_add_u32 v6, v6, 2, v3
    v_lshl_add_u32 v6, v2, 3, v6
    v_lshlrev_b32 v6, 5, v6
    v_lshl_or_b32 v7, v5, 1, 0
    v_xor_b32 v7, v7, v4
    v_lshl_add_u32 v6, v7, 3, v6
    v_add_u32 v24, 133120, v6
    v_xor_b32 v6, 1, v5
    v_lshl_add_u32 v6, v6, 2, v3
    v_lshl_add_u32 v6, v2, 3, v6
    v_lshlrev_b32 v6, 5, v6
    v_lshl_or_b32 v7, v5, 1, 1
    v_xor_b32 v7, v7, v4
    v_lshl_add_u32 v6, v7, 3, v6
    v_add_u32 v134, 133120, v6
    v_lshrrev_b32 v6, 3, v1
    v_lshlrev_b32 v6, 2, v6
    v_xor_b32 v6, v6, v1
    v_lshlrev_b32 v6, 5, v6
    v_xor_b32 v7, v2, v3
    v_lshl_add_u32 v6, v7, 3, v6
    v_add_u32 v23, s90, v6
    v_and_b32 v7, 2, v1
    v_cmp_ne_u32 vcc, 0, v7
    v_mov_b32 v6, 0x4444
    v_mov_b32 v8, 0xeeee
    v_cndmask_b32 v17, v6, v8, vcc
    v_lshlrev_b32 v6, 4, v0
    v_add_u32 v16, 122880, v6
    s_mul_i32 s90, s32, 2560
    v_lshl_add_u32 v13, v0, 4, s90
    v_lshl_add_u32 v14, v0, 2, s90
    s_add_u32 s48, s90, 122880
    v_mul_u32_u24 v6, 40, v0
    v_add_u32 v15, s48, v6
    v_mul_u32_u24 v6, 164, v0
    v_min_u32 v6, 10236, v6
    v_add_u32 v25, 122880, v6
    v_lshrrev_b32 v6, 3, v1
    v_lshlrev_b32 v6, 10, v6
    v_and_b32 v7, 7, v1
    v_lshl_add_u32 v6, v7, 7, v6
    v_lshrrev_b32 v7, 1, v1
    v_xor_b32 v7, v7, v2
    v_lshl_add_u32 v11, v7, 4, v6
    v_xor_b32 v12, 64, v11
    s_waitcnt vmcnt(30)
    s_barrier
    ds_read_b64_tr_b16 a[0:1], v125 offset:0
    ds_read_b64_tr_b16 a[2:3], v125 offset:512
    ds_read_b64_tr_b16 a[4:5], v125 offset:4096
    ds_read_b64_tr_b16 a[6:7], v125 offset:4608
    ds_read_b64_tr_b16 a[8:9], v125 offset:8192
    ds_read_b64_tr_b16 a[10:11], v125 offset:8704
    ds_read_b64_tr_b16 a[12:13], v125 offset:12288
    ds_read_b64_tr_b16 a[14:15], v125 offset:12800
    ds_read_b64_tr_b16 a[16:17], v125 offset:16384
    ds_read_b64_tr_b16 a[18:19], v125 offset:16896
    ds_read_b64_tr_b16 a[20:21], v125 offset:20480
    ds_read_b64_tr_b16 a[22:23], v125 offset:20992
    ds_read_b64_tr_b16 a[24:25], v125 offset:24576
    ds_read_b64_tr_b16 a[26:27], v125 offset:25088
    ds_read_b64_tr_b16 a[28:29], v125 offset:28672
    ds_read_b64_tr_b16 a[30:31], v125 offset:29184
    ds_read_b64_tr_b16 a[32:33], v125 offset:32768
    ds_read_b64_tr_b16 a[34:35], v125 offset:33280
    ds_read_b64_tr_b16 a[36:37], v125 offset:36864
    ds_read_b64_tr_b16 a[38:39], v125 offset:37376
    s_waitcnt lgkmcnt(0)
    s_barrier
    s_lshl_b32 s90, s32, 10
    s_add_u32 m0, s90, 81920
    s_mov_b32 s91, 3932160
    buffer_load_dwordx4 v124, s[16:19], s91 offen nt lds
    s_add_u32 m0, m0, 4096
    s_add_u32 s91, s91, 393216
    buffer_load_dwordx4 v124, s[16:19], s91 offen nt lds
    s_add_u32 m0, m0, 4096
    s_add_u32 s91, s91, 393216
    buffer_load_dwordx4 v124, s[16:19], s91 offen nt lds
    s_add_u32 m0, m0, 4096
    s_add_u32 s91, s91, 393216
    buffer_load_dwordx4 v124, s[16:19], s91 offen nt lds
    s_add_u32 m0, m0, 4096
    s_add_u32 s91, s91, 393216
    buffer_load_dwordx4 v124, s[16:19], s91 offen nt lds
    s_add_u32 m0, m0, 4096
    s_add_u32 s91, s91, 393216
    buffer_load_dwordx4 v124, s[16:19], s91 offen nt lds
    s_add_u32 m0, m0, 4096
    s_add_u32 s91, s91, 393216
    buffer_load_dwordx4 v124, s[16:19], s91 offen nt lds
    s_add_u32 m0, m0, 4096
    s_add_u32 s91, s91, 393216
    buffer_load_dwordx4 v124, s[16:19], s91 offen nt lds
    s_add_u32 m0, m0, 4096
    s_add_u32 s91, s91, 393216
    buffer_load_dwordx4 v124, s[16:19], s91 offen nt lds
    s_add_u32 m0, m0, 4096
    s_add_u32 s91, s91, 393216
    buffer_load_dwordx4 v124, s[16:19], s91 offen nt lds
    s_waitcnt vmcnt(30)
    s_barrier
    ds_read_b64_tr_b16 a[80:81], v126 offset:0
    ds_read_b64_tr_b16 a[82:83], v126 offset:512
    ds_read_b64_tr_b16 a[84:85], v126 offset:4096
    ds_read_b64_tr_b16 a[86:87], v126 offset:4608
    ds_read_b64_tr_b16 a[88:89], v126 offset:8192
    ds_read_b64_tr_b16 a[90:91], v126 offset:8704
    ds_read_b64_tr_b16 a[92:93], v126 offset:12288
    ds_read_b64_tr_b16 a[94:95], v126 offset:12800
    ds_read_b64_tr_b16 a[96:97], v126 offset:16384
    ds_read_b64_tr_b16 a[98:99], v126 offset:16896
    ds_read_b64_tr_b16 a[100:101], v126 offset:20480
    ds_read_b64_tr_b16 a[102:103], v126 offset:20992
    ds_read_b64_tr_b16 a[104:105], v126 offset:24576
    ds_read_b64_tr_b16 a[106:107], v126 offset:25088
    ds_read_b64_tr_b16 a[108:109], v126 offset:28672
    ds_read_b64_tr_b16 a[110:111], v126 offset:29184
    ds_read_b64_tr_b16 a[112:113], v126 offset:32768
    ds_read_b64_tr_b16 a[114:115], v126 offset:33280
    ds_read_b64_tr_b16 a[116:117], v126 offset:36864
    ds_read_b64_tr_b16 a[118:119], v126 offset:37376
    s_waitcnt lgkmcnt(0)
    s_barrier
    s_mov_b32 s46, 40960
    s_lshl_b32 s90, s32, 10
    s_add_u32 m0, s90, 40960
    s_nop 0
    buffer_load_dwordx4 v10, s[24:27], s46 offen offset:0 lds
    s_add_u32 m0, m0, 3968
    s_nop 0
    buffer_load_dwordx4 v10, s[24:27], s46 offen offset:128 lds
    s_add_u32 m0, m0, 3968
    s_nop 0
    buffer_load_dwordx4 v10, s[24:27], s46 offen offset:256 lds
    s_add_u32 m0, m0, 3968
    s_nop 0
    buffer_load_dwordx4 v10, s[24:27], s46 offen offset:384 lds
    s_add_u32 m0, m0, 3968
    s_nop 0
    buffer_load_dwordx4 v10, s[24:27], s46 offen offset:512 lds
    s_add_u32 m0, m0, 3968
    s_nop 0
    buffer_load_dwordx4 v10, s[24:27], s46 offen offset:640 lds
    s_add_u32 m0, m0, 3968
    s_nop 0
    buffer_load_dwordx4 v10, s[24:27], s46 offen offset:768 lds
    s_add_u32 m0, m0, 3968
    s_nop 0
    buffer_load_dwordx4 v10, s[24:27], s46 offen offset:896 lds
    s_add_u32 m0, m0, 3968
    s_nop 0
    buffer_load_dwordx4 v10, s[24:27], s46 offen offset:1024 lds
    s_add_u32 m0, m0, 3968
    s_nop 0
    buffer_load_dwordx4 v10, s[24:27], s46 offen offset:1152 lds
    s_waitcnt vmcnt(30)
    s_barrier
    ds_read_b64_tr_b16 a[40:41], v127 offset:0
    ds_read_b64_tr_b16 a[42:43], v127 offset:512
    ds_read_b64_tr_b16 a[44:45], v127 offset:4096
    ds_read_b64_tr_b16 a[46:47], v127 offset:4608
    ds_read_b64_tr_b16 a[48:49], v127 offset:8192
    ds_read_b64_tr_b16 a[50:51], v127 offset:8704
    ds_read_b64_tr_b16 a[52:53], v127 offset:12288
    ds_read_b64_tr_b16 a[54:55], v127 offset:12800
    ds_read_b64_tr_b16 a[56:57], v127 offset:16384
    ds_read_b64_tr_b16 a[58:59], v127 offset:16896
    ds_read_b64_tr_b16 a[60:61], v127 offset:20480
    ds_read_b64_tr_b16 a[62:63], v127 offset:20992
    ds_read_b64_tr_b16 a[64:65], v127 offset:24576
    ds_read_b64_tr_b16 a[66:67], v127 offset:25088
    ds_read_b64_tr_b16 a[68:69], v127 offset:28672
    ds_read_b64_tr_b16 a[70:71], v127 offset:29184
    ds_read_b64_tr_b16 a[72:73], v127 offset:32768
    ds_read_b64_tr_b16 a[74:75], v127 offset:33280
    ds_read_b64_tr_b16 a[76:77], v127 offset:36864
    ds_read_b64_tr_b16 a[78:79], v127 offset:37376
    s_waitcnt lgkmcnt(0)
    s_waitcnt vmcnt(10)
    s_barrier
    ds_read_b64_tr_b16 a[120:121], v125 offset:0
    ds_read_b64_tr_b16 a[122:123], v125 offset:512
    ds_read_b64_tr_b16 a[124:125], v125 offset:4096
    ds_read_b64_tr_b16 a[126:127], v125 offset:4608
    ds_read_b64_tr_b16 a[128:129], v125 offset:8192
    ds_read_b64_tr_b16 a[130:131], v125 offset:8704
    ds_read_b64_tr_b16 a[132:133], v125 offset:12288
    ds_read_b64_tr_b16 a[134:135], v125 offset:12800
    ds_read_b64_tr_b16 a[136:137], v125 offset:16384
    ds_read_b64_tr_b16 a[138:139], v125 offset:16896
    ds_read_b64_tr_b16 a[140:141], v125 offset:20480
    ds_read_b64_tr_b16 a[142:143], v125 offset:20992
    ds_read_b64_tr_b16 a[144:145], v125 offset:24576
    ds_read_b64_tr_b16 a[146:147], v125 offset:25088
    ds_read_b64_tr_b16 a[148:149], v125 offset:28672
    ds_read_b64_tr_b16 a[150:151], v125 offset:29184
    ds_read_b64_tr_b16 a[152:153], v125 offset:32768
    ds_read_b64_tr_b16 a[154:155], v125 offset:33280
    ds_read_b64_tr_b16 a[156:157], v125 offset:36864
    ds_read_b64_tr_b16 a[158:159], v125 offset:37376
    s_waitcnt lgkmcnt(0)
    s_mov_b32 s49, 40960
    s_mov_b32 s47, 40960
    s_mov_b32 s37, -1
    s_add_u32 s44, s38, 475136
    s_add_u32 s45, s44, s56
    s_mov_b32 s46, 40960
    v_add_u32 v140, 0, v137
    ds_read_b128 v[84:87], v11 offset:0
    ds_read_b128 v[88:91], v11 offset:2048
    ds_read_b128 v[92:95], v12 offset:0
    ds_read_b128 v[96:99], v12 offset:2048
    s_waitcnt lgkmcnt(2)
    v_mfma_f32_16x16x32_bf16 v[108:111], a[0:3], v[84:87], 0
    ds_read_b128 v[100:103], v11 offset:4096
    v_mfma_f32_16x16x32_bf16 v[112:115], a[0:3], v[88:91], 0
    ds_read_b128 v[104:107], v11 offset:6144
    v_mfma_f32_16x16x32_bf16 v[116:119], a[80:83], v[84:87], 0
    v_mfma_f32_16x16x32_bf16 v[120:123], a[80:83], v[88:91], 0
    s_waitcnt lgkmcnt(2)
    v_mfma_f32_16x16x32_bf16 v[108:111], a[4:7], v[92:95], v[108:111]
    ds_read_b128 v[84:87], v12 offset:4096
    v_mfma_f32_16x16x32_bf16 v[112:115], a[4:7], v[96:99], v[112:115]
    ds_read_b128 v[88:91], v12 offset:6144
    v_mfma_f32_16x16x32_bf16 v[116:119], a[84:87], v[92:95], v[116:119]
    v_mfma_f32_16x16x32_bf16 v[120:123], a[84:87], v[96:99], v[120:123]
    s_waitcnt lgkmcnt(2)
    v_mfma_f32_16x16x32_bf16 v[108:111], a[8:11], v[100:103], v[108:111]
    ds_read_b128 v[92:95], v11 offset:8192
    v_mfma_f32_16x16x32_bf16 v[112:115], a[8:11], v[104:107], v[112:115]
    ds_read_b128 v[96:99], v11 offset:10240
    v_mfma_f32_16x16x32_bf16 v[116:119], a[88:91], v[100:103], v[116:119]
    v_mfma_f32_16x16x32_bf16 v[120:123], a[88:91], v[104:107], v[120:123]
    s_waitcnt lgkmcnt(2)
    v_mfma_f32_16x16x32_bf16 v[108:111], a[12:15], v[84:87], v[108:111]
    ds_read_b128 v[100:103], v12 offset:8192
    v_mfma_f32_16x16x32_bf16 v[112:115], a[12:15], v[88:91], v[112:115]
    ds_read_b128 v[104:107], v12 offset:10240
    v_mfma_f32_16x16x32_bf16 v[116:119], a[92:95], v[84:87], v[116:119]
    v_mfma_f32_16x16x32_bf16 v[120:123], a[92:95], v[88:91], v[120:123]
    s_waitcnt lgkmcnt(2)
    v_mfma_f32_16x16x32_bf16 v[108:111], a[16:19], v[92:95], v[108:111]
    ds_read_b128 v[84:87], v11 offset:12288
    v_mfma_f32_16x16x32_bf16 v[112:115], a[16:19], v[96:99], v[112:115]
    ds_read_b128 v[88:91], v11 offset:14336
    v_mfma_f32_16x16x32_bf16 v[116:119], a[96:99], v[92:95], v[116:119]
    v_mfma_f32_16x16x32_bf16 v[120:123], a[96:99], v[96:99], v[120:123]
    s_waitcnt lgkmcnt(2)
    v_mfma_f32_16x16x32_bf16 v[108:111], a[20:23], v[100:103], v[108:111]
    ds_read_b128 v[92:95], v12 offset:12288
    v_mfma_f32_16x16x32_bf16 v[112:115], a[20:23], v[104:107], v[112:115]
    ds_read_b128 v[96:99], v12 offset:14336
    v_mfma_f32_16x16x32_bf16 v[116:119], a[100:103], v[100:103], v[116:119]
    v_mfma_f32_16x16x32_bf16 v[120:123], a[100:103], v[104:107], v[120:123]
    s_waitcnt lgkmcnt(2)
    v_mfma_f32_16x16x32_bf16 v[108:111], a[24:27], v[84:87], v[108:111]
    ds_read_b128 v[100:103], v11 offset:16384
    v_mfma_f32_16x16x32_bf16 v[112:115], a[24:27], v[88:91], v[112:115]
    ds_read_b128 v[104:107], v11 offset:18432
    v_mfma_f32_16x16x32_bf16 v[116:119], a[104:107], v[84:87], v[116:119]
    v_mfma_f32_16x16x32_bf16 v[120:123], a[104:107], v[88:91], v[120:123]
    s_waitcnt lgkmcnt(2)
    v_mfma_f32_16x16x32_bf16 v[108:111], a[28:31], v[92:95], v[108:111]
    ds_read_b128 v[84:87], v12 offset:16384
    v_mfma_f32_16x16x32_bf16 v[112:115], a[28:31], v[96:99], v[112:115]
    ds_read_b128 v[88:91], v12 offset:18432
    v_mfma_f32_16x16x32_bf16 v[116:119], a[108:111], v[92:95], v[116:119]
    v_mfma_f32_16x16x32_bf16 v[120:123], a[108:111], v[96:99], v[120:123]
    s_waitcnt lgkmcnt(2)
    v_mfma_f32_16x16x32_bf16 v[108:111], a[32:35], v[100:103], v[108:111]
    ds_read_b128 v[92:95], v11 offset:20480
    v_mfma_f32_16x16x32_bf16 v[112:115], a[32:35], v[104:107], v[112:115]
    ds_read_b128 v[96:99], v11 offset:22528
    v_mfma_f32_16x16x32_bf16 v[116:119], a[112:115], v[100:103], v[116:119]
    v_mfma_f32_16x16x32_bf16 v[120:123], a[112:115], v[104:107], v[120:123]
    s_waitcnt lgkmcnt(2)
    v_mfma_f32_16x16x32_bf16 v[108:111], a[36:39], v[84:87], v[108:111]
    ds_read_b128 v[100:103], v12 offset:20480
    v_mfma_f32_16x16x32_bf16 v[112:115], a[36:39], v[88:91], v[112:115]
    ds_read_b128 v[104:107], v12 offset:22528
    v_mfma_f32_16x16x32_bf16 v[116:119], a[116:119], v[84:87], v[116:119]
    v_mfma_f32_16x16x32_bf16 v[120:123], a[116:119], v[88:91], v[120:123]
    s_waitcnt lgkmcnt(2)
    v_mfma_f32_16x16x32_bf16 v[108:111], a[40:43], v[92:95], v[108:111]
    ds_read_b128 v[84:87], v11 offset:24576
    v_mfma_f32_16x16x32_bf16 v[112:115], a[40:43], v[96:99], v[112:115]
    ds_read_b128 v[88:91], v11 offset:26624
    v_mfma_f32_16x16x32_bf16 v[116:119], a[120:123], v[92:95], v[116:119]
    v_mfma_f32_16x16x32_bf16 v[120:123], a[120:123], v[96:99], v[120:123]
    s_waitcnt lgkmcnt(2)
    v_mfma_f32_16x16x32_bf16 v[108:111], a[44:47], v[100:103], v[108:111]
    ds_read_b128 v[92:95], v12 offset:24576
    v_mfma_f32_16x16x32_bf16 v[112:115], a[44:47], v[104:107], v[112:115]
    ds_read_b128 v[96:99], v12 offset:26624
    v_mfma_f32_16x16x32_bf16 v[116:119], a[124:127], v[100:103], v[116:119]
    v_mfma_f32_16x16x32_bf16 v[120:123], a[124:127], v[104:107], v[120:123]
    s_waitcnt lgkmcnt(2)
    v_mfma_f32_16x16x32_bf16 v[108:111], a[48:51], v[84:87], v[108:111]
    ds_read_b128 v[100:103], v11 offset:28672
    v_mfma_f32_16x16x32_bf16 v[112:115], a[48:51], v[88:91], v[112:115]
    ds_read_b128 v[104:107], v11 offset:30720
    v_mfma_f32_16x16x32_bf16 v[116:119], a[128:131], v[84:87], v[116:119]
    v_mfma_f32_16x16x32_bf16 v[120:123], a[128:131], v[88:91], v[120:123]
    s_waitcnt lgkmcnt(2)
    v_mfma_f32_16x16x32_bf16 v[108:111], a[52:55], v[92:95], v[108:111]
    ds_read_b128 v[84:87], v12 offset:28672
    v_mfma_f32_16x16x32_bf16 v[112:115], a[52:55], v[96:99], v[112:115]
    ds_read_b128 v[88:91], v12 offset:30720
    v_mfma_f32_16x16x32_bf16 v[116:119], a[132:135], v[92:95], v[116:119]
    v_mfma_f32_16x16x32_bf16 v[120:123], a[132:135], v[96:99], v[120:123]
    s_waitcnt lgkmcnt(2)
    v_mfma_f32_16x16x32_bf16 v[108:111], a[56:59], v[100:103], v[108:111]
    ds_read_b128 v[92:95], v11 offset:32768
    v_mfma_f32_16x16x32_bf16 v[112:115], a[56:59], v[104:107], v[112:115]
    ds_read_b128 v[96:99], v11 offset:34816
    v_mfma_f32_16x16x32_bf16 v[116:119], a[136:139], v[100:103], v[116:119]
    v_mfma_f32_16x16x32_bf16 v[120:123], a[136:139], v[104:107], v[120:123]
    s_waitcnt lgkmcnt(2)
    v_mfma_f32_16x16x32_bf16 v[108:111], a[60:63], v[84:87], v[108:111]
    ds_read_b128 v[100:103], v12 offset:32768
    v_mfma_f32_16x16x32_bf16 v[112:115], a[60:63], v[88:91], v[112:115]
    ds_read_b128 v[104:107], v12 offset:34816
    v_mfma_f32_16x16x32_bf16 v[116:119], a[140:143], v[84:87], v[116:119]
    v_mfma_f32_16x16x32_bf16 v[120:123], a[140:143], v[88:91], v[120:123]
    s_waitcnt lgkmcnt(2)
    v_mfma_f32_16x16x32_bf16 v[108:111], a[64:67], v[92:95], v[108:111]
    ds_read_b128 v[84:87], v11 offset:36864
    v_mfma_f32_16x16x32_bf16 v[112:115], a[64:67], v[96:99], v[112:115]
    ds_read_b128 v[88:91], v11 offset:38912
    v_mfma_f32_16x16x32_bf16 v[116:119], a[144:147], v[92:95], v[116:119]
    v_mfma_f32_16x16x32_bf16 v[120:123], a[144:147], v[96:99], v[120:123]
    s_waitcnt lgkmcnt(2)
    v_mfma_f32_16x16x32_bf16 v[108:111], a[68:71], v[100:103], v[108:111]
    ds_read_b128 v[92:95], v12 offset:36864
    v_mfma_f32_16x16x32_bf16 v[112:115], a[68:71], v[104:107], v[112:115]
    ds_read_b128 v[96:99], v12 offset:38912
    v_mfma_f32_16x16x32_bf16 v[116:119], a[148:151], v[100:103], v[116:119]
    v_mfma_f32_16x16x32_bf16 v[120:123], a[148:151], v[104:107], v[120:123]
    s_waitcnt lgkmcnt(0)
    v_mfma_f32_16x16x32_bf16 v[108:111], a[72:75], v[84:87], v[108:111]
    v_add_u32 v11, s49, v11
    v_mfma_f32_16x16x32_bf16 v[112:115], a[72:75], v[88:91], v[112:115]
    v_add_u32 v12, s49, v12
    v_mfma_f32_16x16x32_bf16 v[108:111], a[76:79], v[92:95], v[108:111]
    s_sub_u32 s47, s47, s49
    v_mfma_f32_16x16x32_bf16 v[112:115], a[76:79], v[96:99], v[112:115]
    s_sub_u32 s49, 0, s49
    v_mfma_f32_16x16x32_bf16 v[116:119], a[152:155], v[84:87], v[116:119]
    v_mfma_f32_16x16x32_bf16 v[120:123], a[152:155], v[88:91], v[120:123]
    v_mfma_f32_16x16x32_bf16 v[116:119], a[156:159], v[92:95], v[116:119]
    v_mfma_f32_16x16x32_bf16 v[120:123], a[156:159], v[96:99], v[120:123]
    v_cvt_pk_bf16_f32 v124, v108, v109
    v_cvt_pk_bf16_f32 v125, v110, v111
    v_cvt_pk_bf16_f32 v126, v112, v113
    v_cvt_pk_bf16_f32 v127, v114, v115
    s_nop 0
    v_permlane16_swap_b32 v124, v126
    v_permlane16_swap_b32 v125, v127
    v_cvt_pk_bf16_f32 v128, v116, v117
    v_cvt_pk_bf16_f32 v129, v118, v119
    v_cvt_pk_bf16_f32 v130, v120, v121
    v_cvt_pk_bf16_f32 v131, v122, v123
    s_nop 0
    v_permlane16_swap_b32 v128, v130
    v_permlane16_swap_b32 v129, v131
    ds_write_b128 v140, v[128:131]
    buffer_store_dwordx4 v[124:127], v19, s[4:7], s44 offen sc1
    buffer_store_dwordx4 v[128:131], v19, s[4:7], s45 offen sc1
    v_mov_b32 v1, 196
L_gw_63:
    buffer_load_dword v2, v1, s[8:11], 0 offen sc1
    s_sub_u32 s36, s36, 1
    s_cbranch_scc1 L_exit
    s_waitcnt vmcnt(0)
    v_readfirstlane_b32 s90, v2
    s_nop 0
    s_cmp_eq_u32 s90, 0
    s_cbranch_scc1 L_gw_63
    s_waitcnt vmcnt(0) lgkmcnt(0)
    s_barrier
    s_add_u32 s44, s38, 573440
    s_add_u32 s45, s44, s56
    s_mov_b32 s46, 81920
    v_add_u32 v140, 4096, v137
    ds_read_b128 v[84:87], v11 offset:0
    ds_read_b128 v[88:91], v11 offset:2048
    ds_read_b128 v[92:95], v12 offset:0
    ds_read_b128 v[96:99], v12 offset:2048
    s_lshl_b32 s90, s32, 10
    s_add_u32 m0, s90, s47
    s_waitcnt lgkmcnt(2)
    v_mfma_f32_16x16x32_bf16 v[108:111], a[0:3], v[84:87], 0
    ds_read_b128 v[100:103], v11 offset:4096
    s_and_b32 s50, s37, 3
    v_mfma_f32_16x16x32_bf16 v[112:115], a[0:3], v[88:91], 0
    ds_read_b128 v[104:107], v11 offset:6144
    s_mul_i32 s53, s50, 327680
    v_mfma_f32_16x16x32_bf16 v[116:119], a[80:83], v[84:87], 0
    buffer_load_dwordx4 v10, s[24:27], s46 offen offset:0 lds
    s_add_u32 m0, m0, 3968
    v_mfma_f32_16x16x32_bf16 v[120:123], a[80:83], v[88:91], 0
    s_waitcnt lgkmcnt(2)
    s_add_u32 s51, s37, 2
    v_mfma_f32_16x16x32_bf16 v[108:111], a[4:7], v[92:95], v[108:111]
    ds_read_b128 v[84:87], v12 offset:4096
    s_and_b32 s50, s51, 3
    v_mfma_f32_16x16x32_bf16 v[112:115], a[4:7], v[96:99], v[112:115]
    ds_read_b128 v[88:91], v12 offset:6144
    s_mul_i32 s50, s50, 98304
    v_mfma_f32_16x16x32_bf16 v[116:119], a[84:87], v[92:95], v[116:119]
    buffer_load_dwordx4 v10, s[24:27], s46 offen offset:128 lds
    s_add_u32 m0, m0, 3968
    v_mfma_f32_16x16x32_bf16 v[120:123], a[84:87], v[96:99], v[120:123]
    s_waitcnt lgkmcnt(2)
    s_add_u32 s50, s50, 475136
    v_mfma_f32_16x16x32_bf16 v[108:111], a[8:11], v[100:103], v[108:111]
    ds_read_b128 v[92:95], v11 offset:8192
    s_add_u32 s44, s38, s50
    v_mfma_f32_16x16x32_bf16 v[112:115], a[8:11], v[104:107], v[112:115]
    ds_read_b128 v[96:99], v11 offset:10240
    s_add_u32 s45, s44, s56
    v_mfma_f32_16x16x32_bf16 v[116:119], a[88:91], v[100:103], v[116:119]
    buffer_load_dwordx4 v10, s[24:27], s46 offen offset:256 lds
    s_add_u32 m0, m0, 3968
    v_mfma_f32_16x16x32_bf16 v[120:123], a[88:91], v[104:107], v[120:123]
    s_waitcnt lgkmcnt(2)
    s_and_b32 s50, s51, 3
    v_mfma_f32_16x16x32_bf16 v[108:111], a[12:15], v[84:87], v[108:111]
    ds_read_b128 v[100:103], v12 offset:8192
    s_lshl_b32 s50, s50, 12
    v_mfma_f32_16x16x32_bf16 v[112:115], a[12:15], v[88:91], v[112:115]
    ds_read_b128 v[104:107], v12 offset:10240
    v_add_u32 v140, s50, v137
    v_mfma_f32_16x16x32_bf16 v[116:119], a[92:95], v[84:87], v[116:119]
    buffer_load_dwordx4 v10, s[24:27], s46 offen offset:384 lds
    s_add_u32 m0, m0, 3968
    v_mfma_f32_16x16x32_bf16 v[120:123], a[92:95], v[88:91], v[120:123]
    s_waitcnt lgkmcnt(2)
    s_add_u32 s37, s37, 1
    v_mfma_f32_16x16x32_bf16 v[108:111], a[16:19], v[92:95], v[108:111]
    ds_read_b128 v[84:87], v11 offset:12288
    s_mov_b32 s52, 0
    v_mfma_f32_16x16x32_bf16 v[112:115], a[16:19], v[96:99], v[112:115]
    ds_read_b128 v[88:91], v11 offset:14336
    s_and_b32 s50, s37, 3
    v_mfma_f32_16x16x32_bf16 v[116:119], a[96:99], v[92:95], v[116:119]
    buffer_load_dwordx4 v10, s[24:27], s46 offen offset:512 lds
    s_add_u32 m0, m0, 3968
    v_mfma_f32_16x16x32_bf16 v[120:123], a[96:99], v[96:99], v[120:123]
    s_waitcnt lgkmcnt(2)
    s_mul_i32 s51, s50, 114688
    v_mfma_f32_16x16x32_bf16 v[108:111], a[20:23], v[100:103], v[108:111]
    ds_read_b128 v[92:95], v12 offset:12288
    s_add_u32 s41, s38, s51
    v_mfma_f32_16x16x32_bf16 v[112:115], a[20:23], v[104:107], v[112:115]
    ds_read_b128 v[96:99], v12 offset:14336
    s_and_b32 s54, s37, s55
    v_mfma_f32_16x16x32_bf16 v[116:119], a[100:103], v[100:103], v[116:119]
    buffer_load_dwordx4 v10, s[24:27], s46 offen offset:640 lds
    s_add_u32 m0, m0, 3968
    v_mfma_f32_16x16x32_bf16 v[120:123], a[100:103], v[104:107], v[120:123]
    s_waitcnt lgkmcnt(2)
    s_lshl_b32 s50, s50, 12
    v_mfma_f32_16x16x32_bf16 v[108:111], a[24:27], v[84:87], v[108:111]
    ds_read_b128 v[100:103], v11 offset:16384
    v_add_u32 v141, s50, v138
    v_mfma_f32_16x16x32_bf16 v[112:115], a[24:27], v[88:91], v[112:115]
    ds_read_b128 v[104:107], v11 offset:18432
    s_add_u32 s43, s41, 40960
    v_mfma_f32_16x16x32_bf16 v[116:119], a[104:107], v[84:87], v[116:119]
    buffer_load_dwordx4 v10, s[24:27], s46 offen offset:768 lds
    s_add_u32 m0, m0, 3968
    v_mfma_f32_16x16x32_bf16 v[120:123], a[104:107], v[88:91], v[120:123]
    s_waitcnt lgkmcnt(2)
    v_mfma_f32_16x16x32_bf16 v[108:111], a[28:31], v[92:95], v[108:111]
    ds_read_b128 v[84:87], v12 offset:16384
    v_mfma_f32_16x16x32_bf16 v[112:115], a[28:31], v[96:99], v[112:115]
    ds_read_b128 v[88:91], v12 offset:18432
    v_mfma_f32_16x16x32_bf16 v[116:119], a[108:111], v[92:95], v[116:119]
    buffer_load_dwordx4 v10, s[24:27], s46 offen offset:896 lds
    s_add_u32 m0, m0, 3968
    v_mfma_f32_16x16x32_bf16 v[120:123], a[108:111], v[96:99], v[120:123]
    s_waitcnt lgkmcnt(2)
    v_mfma_f32_16x16x32_bf16 v[108:111], a[32:35], v[100:103], v[108:111]
    ds_read_b128 v[92:95], v11 offset:20480
    v_mfma_f32_16x16x32_bf16 v[112:115], a[32:35], v[104:107], v[112:115]
    ds_read_b128 v[96:99], v11 offset:22528
    v_mfma_f32_16x16x32_bf16 v[116:119], a[112:115], v[100:103], v[116:119]
    buffer_load_dwordx4 v10, s[24:27], s46 offen offset:1024 lds
    s_add_u32 m0, m0, 3968
    v_mfma_f32_16x16x32_bf16 v[120:123], a[112:115], v[104:107], v[120:123]
    s_waitcnt lgkmcnt(2)
    v_mfma_f32_16x16x32_bf16 v[108:111], a[36:39], v[84:87], v[108:111]
    ds_read_b128 v[100:103], v12 offset:20480
    v_mfma_f32_16x16x32_bf16 v[112:115], a[36:39], v[88:91], v[112:115]
    ds_read_b128 v[104:107], v12 offset:22528
    v_mfma_f32_16x16x32_bf16 v[116:119], a[116:119], v[84:87], v[116:119]
    buffer_load_dwordx4 v10, s[24:27], s46 offen offset:1152 lds
    v_mfma_f32_16x16x32_bf16 v[120:123], a[116:119], v[88:91], v[120:123]
    s_waitcnt lgkmcnt(2)
    v_mfma_f32_16x16x32_bf16 v[108:111], a[40:43], v[92:95], v[108:111]
    ds_read_b128 v[84:87], v11 offset:24576
    v_mfma_f32_16x16x32_bf16 v[112:115], a[40:43], v[96:99], v[112:115]
    ds_read_b128 v[88:91], v11 offset:26624
    v_mfma_f32_16x16x32_bf16 v[116:119], a[120:123], v[92:95], v[116:119]
    v_mfma_f32_16x16x32_bf16 v[120:123], a[120:123], v[96:99], v[120:123]
    s_waitcnt lgkmcnt(2)
    v_mfma_f32_16x16x32_bf16 v[108:111], a[44:47], v[100:103], v[108:111]
    ds_read_b128 v[92:95], v12 offset:24576
    v_mfma_f32_16x16x32_bf16 v[112:115], a[44:47], v[104:107], v[112:115]
    ds_read_b128 v[96:99], v12 offset:26624
    v_mfma_f32_16x16x32_bf16 v[116:119], a[124:127], v[100:103], v[116:119]
    v_mfma_f32_16x16x32_bf16 v[120:123], a[124:127], v[104:107], v[120:123]
    s_waitcnt lgkmcnt(2)
    v_mfma_f32_16x16x32_bf16 v[108:111], a[48:51], v[84:87], v[108:111]
    ds_read_b128 v[100:103], v11 offset:28672
    v_mfma_f32_16x16x32_bf16 v[112:115], a[48:51], v[88:91], v[112:115]
    ds_read_b128 v[104:107], v11 offset:30720
    v_mfma_f32_16x16x32_bf16 v[116:119], a[128:131], v[84:87], v[116:119]
    v_mfma_f32_16x16x32_bf16 v[120:123], a[128:131], v[88:91], v[120:123]
    s_waitcnt lgkmcnt(2)
    v_mfma_f32_16x16x32_bf16 v[108:111], a[52:55], v[92:95], v[108:111]
    ds_read_b128 v[84:87], v12 offset:28672
    v_mfma_f32_16x16x32_bf16 v[112:115], a[52:55], v[96:99], v[112:115]
    ds_read_b128 v[88:91], v12 offset:30720
    v_mfma_f32_16x16x32_bf16 v[116:119], a[132:135], v[92:95], v[116:119]
    v_mfma_f32_16x16x32_bf16 v[120:123], a[132:135], v[96:99], v[120:123]
    s_waitcnt lgkmcnt(2)
    v_mfma_f32_16x16x32_bf16 v[108:111], a[56:59], v[100:103], v[108:111]
    ds_read_b128 v[92:95], v11 offset:32768
    v_mfma_f32_16x16x32_bf16 v[112:115], a[56:59], v[104:107], v[112:115]
    ds_read_b128 v[96:99], v11 offset:34816
    v_mfma_f32_16x16x32_bf16 v[116:119], a[136:139], v[100:103], v[116:119]
    v_mfma_f32_16x16x32_bf16 v[120:123], a[136:139], v[104:107], v[120:123]
    s_waitcnt lgkmcnt(2)
    v_mfma_f32_16x16x32_bf16 v[108:111], a[60:63], v[84:87], v[108:111]
    ds_read_b128 v[100:103], v12 offset:32768
    v_mfma_f32_16x16x32_bf16 v[112:115], a[60:63], v[88:91], v[112:115]
    ds_read_b128 v[104:107], v12 offset:34816
    v_mfma_f32_16x16x32_bf16 v[116:119], a[140:143], v[84:87], v[116:119]
    v_mfma_f32_16x16x32_bf16 v[120:123], a[140:143], v[88:91], v[120:123]
    s_waitcnt lgkmcnt(2)
    v_mfma_f32_16x16x32_bf16 v[108:111], a[64:67], v[92:95], v[108:111]
    ds_read_b128 v[84:87], v11 offset:36864
    v_mfma_f32_16x16x32_bf16 v[112:115], a[64:67], v[96:99], v[112:115]
    ds_read_b128 v[88:91], v11 offset:38912
    v_mfma_f32_16x16x32_bf16 v[116:119], a[144:147], v[92:95], v[116:119]
    v_mfma_f32_16x16x32_bf16 v[120:123], a[144:147], v[96:99], v[120:123]
    s_waitcnt lgkmcnt(2)
    v_mfma_f32_16x16x32_bf16 v[108:111], a[68:71], v[100:103], v[108:111]
    ds_read_b128 v[92:95], v12 offset:36864
    v_mfma_f32_16x16x32_bf16 v[112:115], a[68:71], v[104:107], v[112:115]
    ds_read_b128 v[96:99], v12 offset:38912
    v_mfma_f32_16x16x32_bf16 v[116:119], a[148:151], v[100:103], v[116:119]
    v_mfma_f32_16x16x32_bf16 v[120:123], a[148:151], v[104:107], v[120:123]
    s_waitcnt lgkmcnt(0)
    v_mfma_f32_16x16x32_bf16 v[108:111], a[72:75], v[84:87], v[108:111]
    v_add_u32 v11, s49, v11
    v_mfma_f32_16x16x32_bf16 v[112:115], a[72:75], v[88:91], v[112:115]
    v_add_u32 v12, s49, v12
    v_mfma_f32_16x16x32_bf16 v[108:111], a[76:79], v[92:95], v[108:111]
    s_sub_u32 s47, s47, s49
    v_mfma_f32_16x16x32_bf16 v[112:115], a[76:79], v[96:99], v[112:115]
    s_sub_u32 s49, 0, s49
    v_mfma_f32_16x16x32_bf16 v[116:119], a[152:155], v[84:87], v[116:119]
    v_mfma_f32_16x16x32_bf16 v[120:123], a[152:155], v[88:91], v[120:123]
    v_mfma_f32_16x16x32_bf16 v[116:119], a[156:159], v[92:95], v[116:119]
    v_mfma_f32_16x16x32_bf16 v[120:123], a[156:159], v[96:99], v[120:123]
    v_cvt_pk_bf16_f32 v124, v108, v109
    v_cvt_pk_bf16_f32 v125, v110, v111
    v_cvt_pk_bf16_f32 v126, v112, v113
    v_cvt_pk_bf16_f32 v127, v114, v115
    s_nop 0
    v_permlane16_swap_b32 v124, v126
    v_permlane16_swap_b32 v125, v127
    v_cvt_pk_bf16_f32 v128, v116, v117
    v_cvt_pk_bf16_f32 v129, v118, v119
    v_cvt_pk_bf16_f32 v130, v120, v121
    v_cvt_pk_bf16_f32 v131, v122, v123
    s_nop 0
    v_permlane16_swap_b32 v128, v130
    v_permlane16_swap_b32 v129, v131
    ds_write_b128 v140, v[128:131]
    buffer_store_dwordx4 v[124:127], v19, s[4:7], s44 offen sc1
    buffer_store_dwordx4 v[128:131], v19, s[4:7], s45 offen sc1
    v_mov_b32 v3, 460288
L_pf_64:
    buffer_load_dword v4, v3, s[4:7], s38 offen sc1
    s_sub_u32 s36, s36, 1
    s_cbranch_scc1 L_exit
    s_waitcnt vmcnt(0)
    v_readfirstlane_b32 s90, v4
    s_nop 0
    s_cmp_eq_u32 s90, 0
    s_cbranch_scc1 L_pf_64
    s_and_b32 s90, s90, 2
    s_lshl_b32 s90, s90, 12
    v_mov_b32 v3, s90
    v_mov_b32 v4, v3
    v_cmp_gt_u32 vcc, 16, v0
    s_nop 1
    v_cndmask_b32 v3, v3, v4, vcc
    v_add_u32 v142, v3, v142
    v_add_u32 v143, s90, v143
    v_add_u32 v144, 0, v142
    v_add_u32 v145, 0, v143
    s_mov_b32 m0, s48
    v_mov_b32 v3, 204
L_p0_65:
    buffer_load_dword v4, v3, s[8:11], 0 offen sc1
    s_sub_u32 s36, s36, 1
    s_cbranch_scc1 L_exit
    s_waitcnt vmcnt(0)
    v_readfirstlane_b32 s90, v4
    s_nop 0
    s_cmp_eq_u32 s90, 0
    s_cbranch_scc1 L_p0_65
    s_and_b32 s90, s90, 2
    s_lshl_b32 s90, s90, 12
    s_and_b32 s91, s34, 1
    s_lshl_b32 s91, s91, 12
    s_lshr_b32 s92, s34, 2
    s_lshl_b32 s92, s92, 13
    s_add_u32 s91, s91, s92
    s_and_b32 s92, s34, 2
    s_lshl_b32 s92, s92, 13
    s_add_u32 s91, s91, s92
    s_xor_b32 s91, s91, s90
    s_add_u32 s91, s91, 1933312
    v_lshrrev_b32 v4, 2, v0
    v_lshl_add_u32 v3, v4, 9, s91
    v_cmp_ne_u32 s[92:93], s34, v4
    v_cmp_gt_u32 vcc, 32, v0
    s_nop 0
    s_and_b64 vcc, vcc, s[92:93]
    s_and_b32 vcc_lo, vcc_lo, s55
    v_cndmask_b32 v146, v146, v3, vcc
L_qkv_loop_s:
    buffer_load_dwordx4 v13, s[4:7], s41 offen sc1 lds
    buffer_load_dwordx4 v13, s[4:7], s41 offen offset:1024 sc1 lds
    buffer_load_dword v14, s[4:7], s41 offen offset:2048 sc1 lds
    buffer_load_dword v14, s[4:7], s41 offen offset:2304 sc1 lds
    s_add_u32 s50, s37, 2
    s_and_b32 s50, s50, 3
    s_mul_i32 s50, s50, 114688
    s_add_u32 s42, s38, s50
    s_add_u32 s50, s37, 3
    s_min_u32 s50, s50, 63
    s_mul_i32 s46, s50, 40960
    s_add_u32 s51, s37, 1
    v_mov_b32 v20, s51
    s_mov_b32 m0, s48
    v_mov_b32 v68, 0
    v_mov_b32 v69, 0
    v_mov_b32 v70, 0
    v_mov_b32 v71, 0
    v_mov_b32 v72, 0
    v_mov_b32 v73, 0
    v_mov_b32 v74, 0
    v_mov_b32 v75, 0
    ds_read_b128 v[156:159], v141
    ds_read_b128 v[160:163], v141 offset:1024
L_poll_67:
    buffer_load_dwordx4 v13, s[4:7], s41 offen sc1 lds
    buffer_load_dwordx4 v13, s[4:7], s41 offen offset:1024 sc1 lds
    buffer_load_dword v14, s[4:7], s41 offen offset:2048 sc1 lds
    buffer_load_dword v14, s[4:7], s41 offen offset:2304 sc1 lds
    s_sub_u32 s36, s36, 1
    s_cbranch_scc1 L_exit
    s_waitcnt vmcnt(4)
    ds_read_b32 v18, v15
    s_waitcnt lgkmcnt(0)
    v_cmp_eq_u32 vcc, -1, v18
    s_cbranch_vccnz L_poll_67
    s_barrier
    ds_read_b128 v[28:31], v16 offset:0
    ds_read_b128 v[32:35], v16 offset:1024
    ds_read_b128 v[36:39], v16 offset:2048
    ds_read_b128 v[40:43], v16 offset:3072
    s_waitcnt lgkmcnt(3)
    v_smfmac_f32_16x16x64_bf16 v[68:71], v[28:31], a[0:7], v17
    ds_read_b128 v[44:47], v16 offset:4096
    v_smfmac_f32_16x16x64_bf16 v[72:75], v[28:31], a[80:87], v17
    ds_read_b128 v[48:51], v16 offset:5120
    s_waitcnt lgkmcnt(4)
    v_smfmac_f32_16x16x64_bf16 v[68:71], v[32:35], a[8:15], v17
    ds_read_b128 v[52:55], v16 offset:6144
    v_smfmac_f32_16x16x64_bf16 v[72:75], v[32:35], a[88:95], v17
    ds_read_b128 v[56:59], v16 offset:7168
    s_waitcnt lgkmcnt(5)
    v_smfmac_f32_16x16x64_bf16 v[68:71], v[36:39], a[16:23], v17
    ds_read_b128 v[60:63], v16 offset:8192
    s_waitcnt lgkmcnt(5)
    v_smfmac_f32_16x16x64_bf16 v[68:71], v[40:43], a[24:31], v17
    ds_read_b128 v[64:67], v16 offset:9216
    s_waitcnt lgkmcnt(5)
    v_smfmac_f32_16x16x64_bf16 v[68:71], v[44:47], a[32:39], v17
    s_waitcnt lgkmcnt(4)
    v_smfmac_f32_16x16x64_bf16 v[68:71], v[48:51], a[40:47], v17
    s_waitcnt lgkmcnt(3)
    v_smfmac_f32_16x16x64_bf16 v[68:71], v[52:55], a[48:55], v17
    s_waitcnt lgkmcnt(2)
    v_smfmac_f32_16x16x64_bf16 v[68:71], v[56:59], a[56:63], v17
    s_waitcnt lgkmcnt(1)
    v_smfmac_f32_16x16x64_bf16 v[68:71], v[60:63], a[64:71], v17
    buffer_store_dword v20, v21, s[4:7], s38 offen offset:0 sc1
    s_waitcnt lgkmcnt(0)
    v_smfmac_f32_16x16x64_bf16 v[68:71], v[64:67], a[72:79], v17
L_redo_66:
    v_smfmac_f32_16x16x64_bf16 v[72:75], v[36:39], a[96:103], v17
    v_smfmac_f32_16x16x64_bf16 v[72:75], v[40:43], a[104:111], v17
    v_smfmac_f32_16x16x64_bf16 v[72:75], v[44:47], a[112:119], v17
    v_add_f32 v68, v68, v70
    v_add_f32 v69, v69, v71
    v_smfmac_f32_16x16x64_bf16 v[72:75], v[48:51], a[120:127], v17
    v_cvt_pk_bf16_f32 v132, v68, v69
    ds_write_b32 v23, v132
    v_smfmac_f32_16x16x64_bf16 v[72:75], v[52:55], a[128:135], v17
    v_cmp_u_f32 vcc, v68, v69
    v_smfmac_f32_16x16x64_bf16 v[72:75], v[56:59], a[136:143], v17
    v_smfmac_f32_16x16x64_bf16 v[72:75], v[60:63], a[144:151], v17
    s_cbranch_vccnz L_nan_68
L_cont_69:
    v_smfmac_f32_16x16x64_bf16 v[72:75], v[64:67], a[152:159], v17
    s_waitcnt lgkmcnt(0)
    s_barrier
    ds_read_b64_tr_b16 v[76:77], v24 offset:0
    ds_read_b64_tr_b16 v[78:79], v134 offset:0
    ds_read_b64_tr_b16 v[80:81], v24 offset:1024
    ds_read_b64_tr_b16 v[82:83], v134 offset:1024
    s_cmp_eq_u32 s32, 0
    s_cbranch_scc1 L_w0_70
    s_cmp_eq_u32 s32, 3
    s_cbranch_scc1 L_w3_71
    v_pk_add_f32 v[72:73], v[72:73], v[74:75]
    v_cvt_pk_bf16_f32 v133, v72, v73
    ds_write_b32 v23, v133 offset:4
    s_waitcnt lgkmcnt(3)
    v_mfma_f32_16x16x32_bf16 v[164:167], v[156:159], v[76:79], 0
    s_waitcnt lgkmcnt(1)
    v_mfma_f32_16x16x32_bf16 v[164:167], v[160:163], v[80:83], v[164:167]
    s_waitcnt lgkmcnt(0)
    s_barrier
    s_nop 5
    buffer_store_dwordx4 v[164:167], v135, s[4:7], s41 offen sc1
    ds_read_b128 v[84:87], v11 offset:0
    ds_read_b128 v[88:91], v11 offset:2048
    ds_read_b128 v[92:95], v12 offset:0
    ds_read_b128 v[96:99], v12 offset:2048
    s_branch L_join_72
L_w0_70:
    v_pk_add_f32 v[72:73], v[72:73], v[74:75]
    v_cvt_pk_bf16_f32 v133, v72, v73
    ds_write_b32 v23, v133 offset:4
    s_waitcnt lgkmcnt(0)
    s_barrier
    ds_read_b64_tr_b16 v[76:77], v24 offset:0
    ds_read_b64_tr_b16 v[78:79], v134 offset:0
    ds_read_b64_tr_b16 v[80:81], v24 offset:1024
    ds_read_b64_tr_b16 v[82:83], v134 offset:1024
    s_waitcnt lgkmcnt(2)
    v_mfma_f32_16x16x32_bf16 v[164:167], v[76:79], v[76:79], 0
    s_waitcnt lgkmcnt(0)
    v_mfma_f32_16x16x32_bf16 v[164:167], v[80:83], v[80:83], v[164:167]
    ds_read_b128 v[84:87], v11 offset:0
    ds_read_b128 v[88:91], v11 offset:2048
    ds_read_b128 v[92:95], v12 offset:0
    ds_read_b128 v[96:99], v12 offset:2048
    s_nop 3
    buffer_store_dword v166, v135, s[4:7], s41 offen sc1
    buffer_store_dword v167, v135, s[4:7], s41 offen offset:8 sc1
    s_branch L_join_72
L_w3_71:
    v_pk_add_f32 v[72:73], v[72:73], v[74:75]
    v_cvt_pk_bf16_f32 v133, v72, v73
    ds_write_b32 v23, v133 offset:4
    s_waitcnt lgkmcnt(0)
    s_barrier
    ds_read_b64_tr_b16 v[76:77], v24 offset:0
    ds_read_b64_tr_b16 v[78:79], v134 offset:0
    ds_read_b64_tr_b16 v[80:81], v24 offset:1024
    ds_read_b64_tr_b16 v[82:83], v134 offset:1024
    buffer_store_dword v20, v21, s[4:7], s38 offen offset:32 sc1
    s_waitcnt lgkmcnt(0)
    ds_read_b128 v[84:87], v11 offset:0
    ds_read_b128 v[88:91], v11 offset:2048
    ds_read_b128 v[92:95], v12 offset:0
    ds_read_b128 v[96:99], v12 offset:2048
    s_waitcnt lgkmcnt(0)
    buffer_store_dwordx4 v[76:79], v136, s[4:7], s43 offen sc1
    buffer_store_dwordx4 v[80:83], v136, s[4:7], s43 offen offset:512 sc1
L_join_72:
    s_cmp_eq_u32 s37, 63
    s_cbranch_scc1 L_end_73
    s_lshl_b32 s90, s32, 10
    s_add_u32 m0, s90, s47
    s_waitcnt lgkmcnt(2)
    v_mfma_f32_16x16x32_bf16 v[108:111], a[0:3], v[84:87], 0
    ds_read_b128 v[100:103], v11 offset:4096
    s_and_b32 s50, s37, 3
    v_mfma_f32_16x16x32_bf16 v[112:115], a[0:3], v[88:91], 0
    ds_read_b128 v[104:107], v11 offset:6144
    s_mul_i32 s53, s50, 327680
    v_mfma_f32_16x16x32_bf16 v[116:119], a[80:83], v[84:87], 0
    s_add_u32 s51, s37, 2
    s_and_b32 s50, s51, 3
    v_mfma_f32_16x16x32_bf16 v[120:123], a[80:83], v[88:91], 0
    s_waitcnt lgkmcnt(2)
    s_mul_i32 s50, s50, 98304
    v_mfma_f32_16x16x32_bf16 v[108:111], a[4:7], v[92:95], v[108:111]
    ds_read_b128 v[84:87], v12 offset:4096
    s_add_u32 s50, s50, 475136
    v_mfma_f32_16x16x32_bf16 v[112:115], a[4:7], v[96:99], v[112:115]
    ds_read_b128 v[88:91], v12 offset:6144
    s_add_u32 s44, s38, s50
    v_mfma_f32_16x16x32_bf16 v[116:119], a[84:87], v[92:95], v[116:119]
    s_add_u32 s45, s44, s56
    s_and_b32 s50, s51, 3
    v_mfma_f32_16x16x32_bf16 v[120:123], a[84:87], v[96:99], v[120:123]
    s_waitcnt lgkmcnt(2)
    s_lshl_b32 s50, s50, 12
    v_mfma_f32_16x16x32_bf16 v[108:111], a[8:11], v[100:103], v[108:111]
    ds_read_b128 v[92:95], v11 offset:8192
    v_add_u32 v140, s50, v137
    v_mfma_f32_16x16x32_bf16 v[112:115], a[8:11], v[104:107], v[112:115]
    ds_read_b128 v[96:99], v11 offset:10240
    s_add_u32 s37, s37, 1
    v_mfma_f32_16x16x32_bf16 v[116:119], a[88:91], v[100:103], v[116:119]
    s_mov_b32 s52, 0
    s_and_b32 s50, s37, 3
    v_mfma_f32_16x16x32_bf16 v[120:123], a[88:91], v[104:107], v[120:123]
    s_waitcnt lgkmcnt(2)
    s_mul_i32 s51, s50, 114688
    v_mfma_f32_16x16x32_bf16 v[108:111], a[12:15], v[84:87], v[108:111]
    ds_read_b128 v[100:103], v12 offset:8192
    s_add_u32 s41, s38, s51
    v_mfma_f32_16x16x32_bf16 v[112:115], a[12:15], v[88:91], v[112:115]
    ds_read_b128 v[104:107], v12 offset:10240
    s_and_b32 s54, s37, s55
    v_mfma_f32_16x16x32_bf16 v[116:119], a[92:95], v[84:87], v[116:119]
    buffer_store_dword v22, v150, s[4:7], s42 offen offset:0 sc1
    buffer_store_dword v22, v149, s[4:7], s42 offen offset:0 sc1
    v_mfma_f32_16x16x32_bf16 v[120:123], a[92:95], v[88:91], v[120:123]
    s_waitcnt lgkmcnt(2)
    s_lshl_b32 s50, s50, 12
    v_mfma_f32_16x16x32_bf16 v[108:111], a[16:19], v[92:95], v[108:111]
    ds_read_b128 v[84:87], v11 offset:12288
    v_add_u32 v141, s50, v138
    v_mfma_f32_16x16x32_bf16 v[112:115], a[16:19], v[96:99], v[112:115]
    ds_read_b128 v[88:91], v11 offset:14336
    s_add_u32 s43, s41, 40960
    v_mfma_f32_16x16x32_bf16 v[116:119], a[96:99], v[92:95], v[116:119]
    buffer_store_dword v22, v150, s[4:7], s42 offen offset:256 sc1
    v_mfma_f32_16x16x32_bf16 v[120:123], a[96:99], v[96:99], v[120:123]
    s_waitcnt lgkmcnt(2)
    v_mfma_f32_16x16x32_bf16 v[108:111], a[20:23], v[100:103], v[108:111]
    ds_read_b128 v[92:95], v12 offset:12288
    v_mfma_f32_16x16x32_bf16 v[112:115], a[20:23], v[104:107], v[112:115]
    ds_read_b128 v[96:99], v12 offset:14336
    v_mfma_f32_16x16x32_bf16 v[116:119], a[100:103], v[100:103], v[116:119]
    buffer_load_dwordx4 v10, s[24:27], s46 offen offset:0 lds
    s_add_u32 m0, m0, 3968
    v_mfma_f32_16x16x32_bf16 v[120:123], a[100:103], v[104:107], v[120:123]
    s_waitcnt lgkmcnt(2)
    v_mfma_f32_16x16x32_bf16 v[108:111], a[24:27], v[84:87], v[108:111]
    ds_read_b128 v[100:103], v11 offset:16384
    v_mfma_f32_16x16x32_bf16 v[112:115], a[24:27], v[88:91], v[112:115]
    ds_read_b128 v[104:107], v11 offset:18432
    v_mfma_f32_16x16x32_bf16 v[116:119], a[104:107], v[84:87], v[116:119]
    buffer_load_dwordx4 v10, s[24:27], s46 offen offset:128 lds
    s_add_u32 m0, m0, 3968
    v_mfma_f32_16x16x32_bf16 v[120:123], a[104:107], v[88:91], v[120:123]
    s_waitcnt lgkmcnt(2)
    v_mfma_f32_16x16x32_bf16 v[108:111], a[28:31], v[92:95], v[108:111]
    ds_read_b128 v[84:87], v12 offset:16384
    v_mfma_f32_16x16x32_bf16 v[112:115], a[28:31], v[96:99], v[112:115]
    ds_read_b128 v[88:91], v12 offset:18432
    v_mfma_f32_16x16x32_bf16 v[116:119], a[108:111], v[92:95], v[116:119]
    buffer_load_dwordx4 v10, s[24:27], s46 offen offset:256 lds
    s_add_u32 m0, m0, 3968
    v_mfma_f32_16x16x32_bf16 v[120:123], a[108:111], v[96:99], v[120:123]
    s_waitcnt lgkmcnt(2)
    v_mfma_f32_16x16x32_bf16 v[108:111], a[32:35], v[100:103], v[108:111]
    ds_read_b128 v[92:95], v11 offset:20480
    v_mfma_f32_16x16x32_bf16 v[112:115], a[32:35], v[104:107], v[112:115]
    ds_read_b128 v[96:99], v11 offset:22528
    v_mfma_f32_16x16x32_bf16 v[116:119], a[112:115], v[100:103], v[116:119]
    s_waitcnt vmcnt(6)
    buffer_store_dword v20, v139, s[4:7], s38 offen sc1
    v_mfma_f32_16x16x32_bf16 v[120:123], a[112:115], v[104:107], v[120:123]
    s_waitcnt lgkmcnt(2)
    v_mfma_f32_16x16x32_bf16 v[108:111], a[36:39], v[84:87], v[108:111]
    ds_read_b128 v[100:103], v12 offset:20480
    v_mfma_f32_16x16x32_bf16 v[112:115], a[36:39], v[88:91], v[112:115]
    buffer_load_dword v147, v146, s[4:7], 0 offen sc1
    ds_read_b128 v[104:107], v12 offset:22528
    v_mfma_f32_16x16x32_bf16 v[116:119], a[116:119], v[84:87], v[116:119]
    buffer_load_dwordx4 v10, s[24:27], s46 offen offset:384 lds
    s_add_u32 m0, m0, 3968
    v_mfma_f32_16x16x32_bf16 v[120:123], a[116:119], v[88:91], v[120:123]
    s_waitcnt lgkmcnt(2)
    v_mfma_f32_16x16x32_bf16 v[108:111], a[40:43], v[92:95], v[108:111]
    ds_read_b128 v[84:87], v11 offset:24576
    v_mfma_f32_16x16x32_bf16 v[112:115], a[40:43], v[96:99], v[112:115]
    buffer_load_dword v147, v146, s[4:7], 0 offen sc1
    ds_read_b128 v[88:91], v11 offset:26624
    v_mfma_f32_16x16x32_bf16 v[116:119], a[120:123], v[92:95], v[116:119]
    buffer_load_dwordx4 v10, s[24:27], s46 offen offset:512 lds
    s_add_u32 m0, m0, 3968
    v_mfma_f32_16x16x32_bf16 v[120:123], a[120:123], v[96:99], v[120:123]
    s_waitcnt lgkmcnt(2)
    v_mfma_f32_16x16x32_bf16 v[108:111], a[44:47], v[100:103], v[108:111]
    ds_read_b128 v[92:95], v12 offset:24576
    v_mfma_f32_16x16x32_bf16 v[112:115], a[44:47], v[104:107], v[112:115]
    buffer_load_dword v147, v146, s[4:7], 0 offen sc1
    ds_read_b128 v[96:99], v12 offset:26624
    v_mfma_f32_16x16x32_bf16 v[116:119], a[124:127], v[100:103], v[116:119]
    buffer_load_dwordx4 v10, s[24:27], s46 offen offset:640 lds
    s_add_u32 m0, m0, 3968
    v_mfma_f32_16x16x32_bf16 v[120:123], a[124:127], v[104:107], v[120:123]
    s_waitcnt lgkmcnt(2)
    v_mfma_f32_16x16x32_bf16 v[108:111], a[48:51], v[84:87], v[108:111]
    ds_read_b128 v[100:103], v11 offset:28672
    v_mfma_f32_16x16x32_bf16 v[112:115], a[48:51], v[88:91], v[112:115]
    buffer_load_dword v147, v146, s[4:7], 0 offen sc1
    ds_read_b128 v[104:107], v11 offset:30720
    v_mfma_f32_16x16x32_bf16 v[116:119], a[128:131], v[84:87], v[116:119]
    buffer_load_dwordx4 v10, s[24:27], s46 offen offset:768 lds
    s_add_u32 m0, m0, 3968
    v_mfma_f32_16x16x32_bf16 v[120:123], a[128:131], v[88:91], v[120:123]
    s_waitcnt lgkmcnt(2)
    v_mfma_f32_16x16x32_bf16 v[108:111], a[52:55], v[92:95], v[108:111]
    ds_read_b128 v[84:87], v12 offset:28672
    v_mfma_f32_16x16x32_bf16 v[112:115], a[52:55], v[96:99], v[112:115]
    buffer_load_dword v147, v146, s[4:7], 0 offen sc1
    ds_read_b128 v[88:91], v12 offset:30720
    v_mfma_f32_16x16x32_bf16 v[116:119], a[132:135], v[92:95], v[116:119]
    buffer_load_dwordx4 v10, s[24:27], s46 offen offset:896 lds
    s_add_u32 m0, m0, 3968
    v_mfma_f32_16x16x32_bf16 v[120:123], a[132:135], v[96:99], v[120:123]
    s_waitcnt lgkmcnt(2)
    v_mfma_f32_16x16x32_bf16 v[108:111], a[56:59], v[100:103], v[108:111]
    ds_read_b128 v[92:95], v11 offset:32768
    v_mfma_f32_16x16x32_bf16 v[112:115], a[56:59], v[104:107], v[112:115]
    buffer_load_dword v147, v146, s[4:7], 0 offen sc1
    ds_read_b128 v[96:99], v11 offset:34816
    v_mfma_f32_16x16x32_bf16 v[116:119], a[136:139], v[100:103], v[116:119]
    buffer_load_dwordx4 v10, s[24:27], s46 offen offset:1024 lds
    s_add_u32 m0, m0, 3968
    v_mfma_f32_16x16x32_bf16 v[120:123], a[136:139], v[104:107], v[120:123]
    s_waitcnt lgkmcnt(2)
    v_mfma_f32_16x16x32_bf16 v[108:111], a[60:63], v[84:87], v[108:111]
    ds_read_b128 v[100:103], v12 offset:32768
    v_mfma_f32_16x16x32_bf16 v[112:115], a[60:63], v[88:91], v[112:115]
    buffer_load_dword v147, v146, s[4:7], 0 offen sc1
    ds_read_b128 v[104:107], v12 offset:34816
    v_mfma_f32_16x16x32_bf16 v[116:119], a[140:143], v[84:87], v[116:119]
    buffer_load_dwordx4 v10, s[24:27], s46 offen offset:1152 lds
    v_mfma_f32_16x16x32_bf16 v[120:123], a[140:143], v[88:91], v[120:123]
    s_waitcnt lgkmcnt(2)
    v_mfma_f32_16x16x32_bf16 v[108:111], a[64:67], v[92:95], v[108:111]
    ds_read_b128 v[84:87], v11 offset:36864
    v_mfma_f32_16x16x32_bf16 v[112:115], a[64:67], v[96:99], v[112:115]
L_sp_74:
    s_waitcnt vmcnt(6)
    v_cmp_gt_u32 vcc, s54, v147
    buffer_load_dword v147, v146, s[4:7], 0 offen sc1
    s_sub_u32 s36, s36, 1
    s_cbranch_scc1 L_exit
    s_cbranch_vccz L_sp_74x
    s_waitcnt vmcnt(6)
    v_cmp_gt_u32 vcc, s54, v147
    buffer_load_dword v147, v146, s[4:7], 0 offen sc1
    s_cbranch_vccz L_sp_74x
    s_waitcnt vmcnt(6)
    v_cmp_gt_u32 vcc, s54, v147
    buffer_load_dword v147, v146, s[4:7], 0 offen sc1
    s_cbranch_vccz L_sp_74x
    s_waitcnt vmcnt(6)
    v_cmp_gt_u32 vcc, s54, v147
    buffer_load_dword v147, v146, s[4:7], 0 offen sc1
    s_cbranch_vccnz L_sp_74
L_sp_74x:
    s_barrier
    buffer_load_dwordx4 v[168:171], v142, s[4:7], s53 offen sc1
    ds_read_b128 v[88:91], v11 offset:38912
    v_mfma_f32_16x16x32_bf16 v[116:119], a[144:147], v[92:95], v[116:119]
    v_mfma_f32_16x16x32_bf16 v[120:123], a[144:147], v[96:99], v[120:123]
    s_waitcnt lgkmcnt(2)
    v_mfma_f32_16x16x32_bf16 v[108:111], a[68:71], v[100:103], v[108:111]
    ds_read_b128 v[92:95], v12 offset:36864
    v_mfma_f32_16x16x32_bf16 v[112:115], a[68:71], v[104:107], v[112:115]
    ds_read_b128 v[96:99], v12 offset:38912
    v_mfma_f32_16x16x32_bf16 v[116:119], a[148:151], v[100:103], v[116:119]
    v_mfma_f32_16x16x32_bf16 v[120:123], a[148:151], v[104:107], v[120:123]
    buffer_load_dwordx4 v[172:175], v143, s[4:7], s53 offen sc1
    s_waitcnt lgkmcnt(0)
    v_mfma_f32_16x16x32_bf16 v[108:111], a[72:75], v[84:87], v[108:111]
    v_add_u32 v11, s49, v11
    v_mfma_f32_16x16x32_bf16 v[112:115], a[72:75], v[88:91], v[112:115]
    v_add_u32 v12, s49, v12
    v_mfma_f32_16x16x32_bf16 v[108:111], a[76:79], v[92:95], v[108:111]
    s_sub_u32 s47, s47, s49
    v_mfma_f32_16x16x32_bf16 v[112:115], a[76:79], v[96:99], v[112:115]
    s_sub_u32 s49, 0, s49
    v_mfma_f32_16x16x32_bf16 v[116:119], a[152:155], v[84:87], v[116:119]
    v_mfma_f32_16x16x32_bf16 v[120:123], a[152:155], v[88:91], v[120:123]
    v_mfma_f32_16x16x32_bf16 v[116:119], a[156:159], v[92:95], v[116:119]
    v_mfma_f32_16x16x32_bf16 v[120:123], a[156:159], v[96:99], v[120:123]
    v_cvt_pk_bf16_f32 v124, v108, v109
    v_cvt_pk_bf16_f32 v125, v110, v111
    v_cvt_pk_bf16_f32 v126, v112, v113
    v_cvt_pk_bf16_f32 v127, v114, v115
    s_nop 0
    v_permlane16_swap_b32 v124, v126
    v_permlane16_swap_b32 v125, v127
    v_cvt_pk_bf16_f32 v128, v116, v117
    v_cvt_pk_bf16_f32 v129, v118, v119
    v_cvt_pk_bf16_f32 v130, v120, v121
    v_cvt_pk_bf16_f32 v131, v122, v123
    s_nop 0
    v_permlane16_swap_b32 v128, v130
    v_permlane16_swap_b32 v129, v131
    ds_write_b128 v140, v[128:131]
    buffer_store_dwordx4 v[124:127], v19, s[4:7], s44 offen sc1
    buffer_store_dwordx4 v[128:131], v19, s[4:7], s45 offen sc1
    s_mov_b32 m0, s48
    s_waitcnt vmcnt(3)
    v_mfma_f32_16x16x32_bf16 v[184:187], v[198:201], v[168:171], 0
    v_mfma_f32_16x16x32_bf16 v[188:191], v[196:199], v[168:171], 0
    s_waitcnt vmcnt(2)
    v_mfma_f32_16x16x32_bf16 v[184:187], v[198:201], v[172:175], v[184:187]
    v_mfma_f32_16x16x32_bf16 v[188:191], v[196:199], v[172:175], v[188:191]
    s_nop 4
    v_cmp_u_f32 vcc, v184, v184
    v_cvt_pk_bf16_f32 v192, v184, v185
    v_cvt_pk_bf16_f32 v193, v186, v187
    v_cvt_pk_bf16_f32 v194, v188, v189
    v_cvt_pk_bf16_f32 v195, v190, v191
    s_cbranch_vccnz L_pp_75
L_pc_76:
    buffer_store_dwordx4 v[192:195], v148, s[4:7], s41 offen sc1
    s_barrier
    s_branch L_qkv_loop_s
L_end_73:
    s_waitcnt vmcnt(0) lgkmcnt(0)
    buffer_store_dword v20, v139, s[4:7], s38 offen sc1
    s_endpgm
L_nan_68:
    s_cmp_eq_u32 s52, 1
    s_cbranch_scc1 L_cont_69
    v_lshlrev_b32 v1, 4, v0
L_nan_68r:
    s_mov_b32 s90, s41
    v_mov_b32 v2, 0
    buffer_load_dwordx4 v[28:31], v1, s[4:7], s90 offen sc1
    s_add_u32 s90, s90, 1024
    buffer_load_dwordx4 v[32:35], v1, s[4:7], s90 offen sc1
    s_add_u32 s90, s90, 1024
    buffer_load_dwordx4 v[36:39], v1, s[4:7], s90 offen sc1
    s_add_u32 s90, s90, 1024
    buffer_load_dwordx4 v[40:43], v1, s[4:7], s90 offen sc1
    s_add_u32 s90, s90, 1024
    buffer_load_dwordx4 v[44:47], v1, s[4:7], s90 offen sc1
    s_add_u32 s90, s90, 1024
    buffer_load_dwordx4 v[48:51], v1, s[4:7], s90 offen sc1
    s_add_u32 s90, s90, 1024
    buffer_load_dwordx4 v[52:55], v1, s[4:7], s90 offen sc1
    s_add_u32 s90, s90, 1024
    buffer_load_dwordx4 v[56:59], v1, s[4:7], s90 offen sc1
    s_add_u32 s90, s90, 1024
    buffer_load_dwordx4 v[60:63], v1, s[4:7], s90 offen sc1
    s_add_u32 s90, s90, 1024
    buffer_load_dwordx4 v[64:67], v1, s[4:7], s90 offen sc1
    s_add_u32 s90, s90, 1024
    s_sub_u32 s36, s36, 1
    s_cbranch_scc1 L_exit
    s_waitcnt vmcnt(0) lgkmcnt(0)
    v_max3_u32 v2, v2, v28, v29
    v_max3_u32 v2, v2, v30, v31
    v_max3_u32 v2, v2, v32, v33
    v_max3_u32 v2, v2, v34, v35
    v_max3_u32 v2, v2, v36, v37
    v_max3_u32 v2, v2, v38, v39
    v_max3_u32 v2, v2, v40, v41
    v_max3_u32 v2, v2, v42, v43
    v_max3_u32 v2, v2, v44, v45
    v_max3_u32 v2, v2, v46, v47
    v_max3_u32 v2, v2, v48, v49
    v_max3_u32 v2, v2, v50, v51
    v_max3_u32 v2, v2, v52, v53
    v_max3_u32 v2, v2, v54, v55
    v_max3_u32 v2, v2, v56, v57
    v_max3_u32 v2, v2, v58, v59
    v_max3_u32 v2, v2, v60, v61
    v_max3_u32 v2, v2, v62, v63
    v_max3_u32 v2, v2, v64, v65
    v_max3_u32 v2, v2, v66, v67
    v_cmp_eq_u32 vcc, -1, v2
    s_cbranch_vccnz L_nan_68r
    s_mov_b32 s52, 1
    v_mov_b32 v68, 0
    v_mov_b32 v69, 0
    v_mov_b32 v70, 0
    v_mov_b32 v71, 0
    v_mov_b32 v72, 0
    v_mov_b32 v73, 0
    v_mov_b32 v74, 0
    v_mov_b32 v75, 0
    v_smfmac_f32_16x16x64_bf16 v[68:71], v[28:31], a[0:7], v17
    s_nop 0
    v_smfmac_f32_16x16x64_bf16 v[72:75], v[28:31], a[80:87], v17
    v_smfmac_f32_16x16x64_bf16 v[68:71], v[32:35], a[8:15], v17
    v_smfmac_f32_16x16x64_bf16 v[72:75], v[32:35], a[88:95], v17
    v_smfmac_f32_16x16x64_bf16 v[68:71], v[36:39], a[16:23], v17
    v_smfmac_f32_16x16x64_bf16 v[68:71], v[40:43], a[24:31], v17
    v_smfmac_f32_16x16x64_bf16 v[68:71], v[44:47], a[32:39], v17
    v_smfmac_f32_16x16x64_bf16 v[68:71], v[48:51], a[40:47], v17
    v_smfmac_f32_16x16x64_bf16 v[68:71], v[52:55], a[48:55], v17
    v_smfmac_f32_16x16x64_bf16 v[68:71], v[56:59], a[56:63], v17
    v_smfmac_f32_16x16x64_bf16 v[68:71], v[60:63], a[64:71], v17
    v_smfmac_f32_16x16x64_bf16 v[68:71], v[64:67], a[72:79], v17
    s_nop 3
    s_branch L_redo_66
L_pp_75:
    buffer_load_dwordx4 v[176:179], v144, s[4:7], s53 offen sc1
    buffer_load_dwordx4 v[180:183], v145, s[4:7], s53 offen sc1
    s_sub_u32 s36, s36, 1
    s_cbranch_scc1 L_exit
    v_max_u32 v151, v168, v169
    v_max3_u32 v151, v151, v170, v171
    v_max3_u32 v151, v151, v172, v173
    v_max3_u32 v151, v151, v174, v175
    v_cmp_eq_u32 vcc, -1, v151
    s_cbranch_vccz L_pc_76
    s_waitcnt vmcnt(1)
    v_mfma_f32_16x16x32_bf16 v[184:187], v[198:201], v[176:179], 0
    v_mfma_f32_16x16x32_bf16 v[188:191], v[196:199], v[176:179], 0
    s_waitcnt vmcnt(0)
    v_mfma_f32_16x16x32_bf16 v[184:187], v[198:201], v[180:183], v[184:187]
    v_mfma_f32_16x16x32_bf16 v[188:191], v[196:199], v[180:183], v[188:191]
    s_nop 4
    v_cmp_u_f32 vcc, v184, v184
    v_cvt_pk_bf16_f32 v192, v184, v185
    v_cvt_pk_bf16_f32 v193, v186, v187
    v_cvt_pk_bf16_f32 v194, v188, v189
    v_cvt_pk_bf16_f32 v195, v190, v191
    s_cbranch_vccnz L_pp_75_1
    s_branch L_pc_76
L_pp_75_1:
    buffer_load_dwordx4 v[168:171], v142, s[4:7], s53 offen sc1
    buffer_load_dwordx4 v[172:175], v143, s[4:7], s53 offen sc1
    s_sub_u32 s36, s36, 1
    s_cbranch_scc1 L_exit
    v_max_u32 v151, v176, v177
    v_max3_u32 v151, v151, v178, v179
    v_max3_u32 v151, v151, v180, v181
    v_max3_u32 v151, v151, v182, v183
    v_cmp_eq_u32 vcc, -1, v151
    s_cbranch_vccz L_pc_76
    s_waitcnt vmcnt(1)
    v_mfma_f32_16x16x32_bf16 v[184:187], v[198:201], v[168:171], 0
    v_mfma_f32_16x16x32_bf16 v[188:191], v[196:199], v[168:171], 0
    s_waitcnt vmcnt(0)
    v_mfma_f32_16x16x32_bf16 v[184:187], v[198:201], v[172:175], v[184:187]
    v_mfma_f32_16x16x32_bf16 v[188:191], v[196:199], v[172:175], v[188:191]
    s_nop 4
    v_cmp_u_f32 vcc, v184, v184
    v_cvt_pk_bf16_f32 v192, v184, v185
    v_cvt_pk_bf16_f32 v193, v186, v187
    v_cvt_pk_bf16_f32 v194, v188, v189
    v_cvt_pk_bf16_f32 v195, v190, v191
    s_cbranch_vccnz L_pp_75
    s_branch L_pc_76
L_v_s:
    s_mov_b32 s12, s78
    s_and_b32 s13, s79, 0xffff
    s_mov_b32 s14, 7864320
    s_mov_b32 s15, 0x20000
    s_sub_u32 s40, s35, 12
    s_lshl_b32 s40, s40, 1
    s_mov_b32 s24, s70
    s_and_b32 s25, s71, 0xffff
    s_mov_b32 s26, 2621440
    s_mov_b32 s27, 0x20000
    v_and_b32 v1, 15, v0
    v_lshrrev_b32 v2, 4, v0
    v_lshrrev_b32 v3, 3, v0
    v_and_b32 v4, 7, v0
    s_lshl_b32 s90, s32, 3
    v_add_u32 v5, s90, v3
    s_and_b32 s91, s32, 1
    s_lshl_b32 s91, s91, 2
    v_and_b32 v6, 2, v3
    v_or_b32 v6, s91, v6
    v_xor_b32 v6, v6, v4
    v_lshlrev_b32 v6, 4, v6
    v_mul_u32_u24 v7, 12288, v5
    s_mul_i32 s92, s34, 1536
    s_lshl_b32 s93, s40, 7
    s_add_u32 s92, s92, s93
    v_add3_u32 v124, v6, v7, s92
    v_lshrrev_b32 v6, 1, v3
    v_or_b32 v6, s91, v6
    v_xor_b32 v6, v6, v4
    v_lshlrev_b32 v6, 4, v6
    v_mul_u32_u24 v7, 1280, v5
    v_add_u32 v10, v6, v7
    s_lshl_b32 s90, s32, 10
    s_add_u32 m0, s90, 81920
    s_mov_b32 s91, 0
    buffer_load_dwordx4 v124, s[12:15], s91 offen nt lds
    s_add_u32 m0, m0, 4096
    s_add_u32 s91, s91, 393216
    buffer_load_dwordx4 v124, s[12:15], s91 offen nt lds
    s_add_u32 m0, m0, 4096
    s_add_u32 s91, s91, 393216
    buffer_load_dwordx4 v124, s[12:15], s91 offen nt lds
    s_add_u32 m0, m0, 4096
    s_add_u32 s91, s91, 393216
    buffer_load_dwordx4 v124, s[12:15], s91 offen nt lds
    s_add_u32 m0, m0, 4096
    s_add_u32 s91, s91, 393216
    buffer_load_dwordx4 v124, s[12:15], s91 offen nt lds
    s_add_u32 m0, m0, 4096
    s_add_u32 s91, s91, 393216
    buffer_load_dwordx4 v124, s[12:15], s91 offen nt lds
    s_add_u32 m0, m0, 4096
    s_add_u32 s91, s91, 393216
    buffer_load_dwordx4 v124, s[12:15], s91 offen nt lds
    s_add_u32 m0, m0, 4096
    s_add_u32 s91, s91, 393216
    buffer_load_dwordx4 v124, s[12:15], s91 offen nt lds
    s_add_u32 m0, m0, 4096
    s_add_u32 s91, s91, 393216
    buffer_load_dwordx4 v124, s[12:15], s91 offen nt lds
    s_add_u32 m0, m0, 4096
    s_add_u32 s91, s91, 393216
    buffer_load_dwordx4 v124, s[12:15], s91 offen nt lds
    s_lshl_b32 s90, s32, 10
    s_add_u32 m0, s90, 40960
    s_mov_b32 s91, 128
    buffer_load_dwordx4 v124, s[12:15], s91 offen nt lds
    s_add_u32 m0, m0, 4096
    s_add_u32 s91, s91, 393216
    buffer_load_dwordx4 v124, s[12:15], s91 offen nt lds
    s_add_u32 m0, m0, 4096
    s_add_u32 s91, s91, 393216
    buffer_load_dwordx4 v124, s[12:15], s91 offen nt lds
    s_add_u32 m0, m0, 4096
    s_add_u32 s91, s91, 393216
    buffer_load_dwordx4 v124, s[12:15], s91 offen nt lds
    s_add_u32 m0, m0, 4096
    s_add_u32 s91, s91, 393216
    buffer_load_dwordx4 v124, s[12:15], s91 offen nt lds
    s_add_u32 m0, m0, 4096
    s_add_u32 s91, s91, 393216
    buffer_load_dwordx4 v124, s[12:15], s91 offen nt lds
    s_add_u32 m0, m0, 4096
    s_add_u32 s91, s91, 393216
    buffer_load_dwordx4 v124, s[12:15], s91 offen nt lds
    s_add_u32 m0, m0, 4096
    s_add_u32 s91, s91, 393216
    buffer_load_dwordx4 v124, s[12:15], s91 offen nt lds
    s_add_u32 m0, m0, 4096
    s_add_u32 s91, s91, 393216
    buffer_load_dwordx4 v124, s[12:15], s91 offen nt lds
    s_add_u32 m0, m0, 4096
    s_add_u32 s91, s91, 393216
    buffer_load_dwordx4 v124, s[12:15], s91 offen nt lds
    s_lshl_b32 s90, s32, 10
    s_add_u32 m0, s90, 122880
    s_mov_b32 s91, 3932160
    buffer_load_dwordx4 v124, s[12:15], s91 offen nt lds
    s_add_u32 m0, m0, 4096
    s_add_u32 s91, s91, 393216
    buffer_load_dwordx4 v124, s[12:15], s91 offen nt lds
    s_add_u32 m0, m0, 4096
    s_add_u32 s91, s91, 393216
    buffer_load_dwordx4 v124, s[12:15], s91 offen nt lds
    s_add_u32 m0, m0, 4096
    s_add_u32 s91, s91, 393216
    buffer_load_dwordx4 v124, s[12:15], s91 offen nt lds
    s_add_u32 m0, m0, 4096
    s_add_u32 s91, s91, 393216
    buffer_load_dwordx4 v124, s[12:15], s91 offen nt lds
    s_add_u32 m0, m0, 4096
    s_add_u32 s91, s91, 393216
    buffer_load_dwordx4 v124, s[12:15], s91 offen nt lds
    s_add_u32 m0, m0, 4096
    s_add_u32 s91, s91, 393216
    buffer_load_dwordx4 v124, s[12:15], s91 offen nt lds
    s_add_u32 m0, m0, 4096
    s_add_u32 s91, s91, 393216
    buffer_load_dwordx4 v124, s[12:15], s91 offen nt lds
    s_add_u32 m0, m0, 4096
    s_add_u32 s91, s91, 393216
    buffer_load_dwordx4 v124, s[12:15], s91 offen nt lds
    s_add_u32 m0, m0, 4096
    s_add_u32 s91, s91, 393216
    buffer_load_dwordx4 v124, s[12:15], s91 offen nt lds
    s_mov_b32 s46, 0
    s_lshl_b32 s90, s32, 10
    s_add_u32 m0, s90, 0
    s_nop 0
    buffer_load_dwordx4 v10, s[24:27], s46 offen offset:0 lds
    s_add_u32 m0, m0, 3968
    s_nop 0
    buffer_load_dwordx4 v10, s[24:27], s46 offen offset:128 lds
    s_add_u32 m0, m0, 3968
    s_nop 0
    buffer_load_dwordx4 v10, s[24:27], s46 offen offset:256 lds
    s_add_u32 m0, m0, 3968
    s_nop 0
    buffer_load_dwordx4 v10, s[24:27], s46 offen offset:384 lds
    s_add_u32 m0, m0, 3968
    s_nop 0
    buffer_load_dwordx4 v10, s[24:27], s46 offen offset:512 lds
    s_add_u32 m0, m0, 3968
    s_nop 0
    buffer_load_dwordx4 v10, s[24:27], s46 offen offset:640 lds
    s_add_u32 m0, m0, 3968
    s_nop 0
    buffer_load_dwordx4 v10, s[24:27], s46 offen offset:768 lds
    s_add_u32 m0, m0, 3968
    s_nop 0
    buffer_load_dwordx4 v10, s[24:27], s46 offen offset:896 lds
    s_add_u32 m0, m0, 3968
    s_nop 0
    buffer_load_dwordx4 v10, s[24:27], s46 offen offset:1024 lds
    s_add_u32 m0, m0, 3968
    s_nop 0
    buffer_load_dwordx4 v10, s[24:27], s46 offen offset:1152 lds
    s_lshl_b32 s93, s40, 1
    s_add_u32 s93, s93, s32
    s_mul_i32 s93, s93, 7168
    s_add_u32 s93, s93, 884736
    s_add_u32 s61, s93, s38
    s_mul_i32 s60, s40, 86
    s_lshr_b32 s60, s60, 8
    s_mul_i32 s59, s60, 3
    s_sub_u32 s59, s40, s59
    s_add_u32 s90, s40, 1
    s_mul_i32 s62, s90, 86
    s_lshr_b32 s62, s62, 8
    s_mul_i32 s63, s62, 3
    s_sub_u32 s63, s90, s63
    v_lshrrev_b32 v3, 1, v2
    v_and_b32 v5, 1, v2
    s_lshl_b32 s90, s32, 9
    v_lshlrev_b32 v6, 4, v1
    v_lshl_add_u32 v6, v3, 8, v6
    v_add_u32 v6, s90, v6
    s_mul_i32 s90, s60, 12288
    s_lshl_b32 s91, s59, 11
    s_add_u32 s90, s90, s91
    v_mul_u32_u24 v7, 6144, v5
    v_add3_u32 v19, v6, v7, s90
    v_mov_b32 v22, -1
    s_mul_i32 s56, s62, 12288
    s_lshl_b32 s91, s63, 11
    s_add_u32 s56, s56, s91
    s_sub_u32 s56, s56, s90
    s_lshl_b32 s90, s40, 10
    s_lshl_b32 s91, s32, 8
    s_add_u32 s91, s91, s90
    s_add_u32 s91, s91, 25600
    v_lshl_add_u32 v135, v0, 2, s91
    v_and_b32 v6, 60, v0
    v_bfe_u32 v7, v0, 1, 1
    v_or_b32 v6, v6, v7
    v_and_b32 v7, 1, v0
    v_lshl_or_b32 v6, v7, 1, v6
    s_and_b32 s90, s32, 1
    s_lshl_b32 s90, s90, 3
    v_xor_b32 v6, s90, v6
    v_lshl_add_u32 v134, v6, 2, s91
    s_lshl_b32 s90, s60, 5
    s_lshl_b32 s91, s62, 5
    v_mov_b32 v3, s90
    v_mov_b32 v4, s91
    v_mov_b32 v6, s59
    v_mov_b32 v7, s63
    v_cmp_eq_u32 vcc, 0, v0
    s_nop 1
    v_cndmask_b32 v3, v4, v3, vcc
    v_cndmask_b32 v6, v7, v6, vcc
    v_add_u32 v4, v3, v6
    s_cmp_eq_u32 s32, 3
    s_cselect_b32 s91, 0, 2146435072
    s_add_u32 s91, s91, 462348
    v_lshl_add_u32 v21, v4, 2, s91
    v_lshl_add_u32 v4, v6, 2, v3
    s_lshl_b32 s91, s32, 2
    s_add_u32 s91, s91, 458752
    v_lshl_add_u32 v136, v4, 2, s91
    v_cmp_gt_u32 vcc, 2, v0
    v_mov_b32 v9, 2146435072
    s_nop 0
    v_cndmask_b32 v21, v9, v21, vcc
    v_cndmask_b32 v136, v9, v136, vcc
    s_lshl_b32 s90, s40, 1
    s_add_u32 s90, s90, s32
    s_sub_u32 s90, s90, 4
    s_lshl_b32 s90, s90, 11
    s_cmp_eq_u32 s40, 0
    s_cselect_b32 s90, 2146435072, s90
    v_lshl_add_u32 v137, v0, 4, s90
    v_mov_b32 v138, 460800
    v_lshrrev_b32 v3, 2, v1
    v_and_b32 v4, 3, v1
    v_and_b32 v5, 1, v2
    v_lshl_add_u32 v6, v2, 3, v3
    v_lshlrev_b32 v6, 7, v6
    v_and_b32 v7, 2, v3
    v_lshl_or_b32 v7, v5, 2, v7
    v_lshrrev_b32 v8, 1, v4
    s_lshl_b32 s90, s32, 1
    v_or_b32 v8, s90, v8
    v_xor_b32 v7, v7, v8
    v_lshl_add_u32 v6, v7, 4, v6
    v_and_b32 v7, 1, v4
    v_lshl_add_u32 v6, v7, 3, v6
    v_add_u32 v125, 81920, v6
    v_add_u32 v126, 40960, v6
    v_add_u32 v127, 122880, v6
    s_lshl_b32 s90, s32, 9
    s_add_u32 s90, s90, 133120
    v_and_b32 v7, 2, v1
    v_cmp_ne_u32 vcc, 0, v7
    v_mov_b32 v6, 0x4444
    v_mov_b32 v8, 0xeeee
    v_cndmask_b32 v17, v6, v8, vcc
    v_lshlrev_b32 v6, 4, v0
    v_add_u32 v16, 122880, v6
    s_mul_i32 s90, s32, 2560
    v_lshl_add_u32 v13, v0, 4, s90
    v_lshl_add_u32 v14, v0, 2, s90
    s_add_u32 s48, s90, 122880
    v_mul_u32_u24 v6, 40, v0
    v_add_u32 v15, s48, v6
    v_mul_u32_u24 v6, 164, v0
    v_min_u32 v6, 10236, v6
    v_add_u32 v25, 122880, v6
    v_lshrrev_b32 v6, 3, v1
    v_lshlrev_b32 v6, 10, v6
    v_and_b32 v7, 7, v1
    v_lshl_add_u32 v6, v7, 7, v6
    v_lshrrev_b32 v7, 1, v1
    v_xor_b32 v7, v7, v2
    v_lshl_add_u32 v11, v7, 4, v6
    v_xor_b32 v12, 64, v11
    s_waitcnt vmcnt(30)
    s_barrier
    ds_read_b64_tr_b16 a[0:1], v125 offset:0
    ds_read_b64_tr_b16 a[2:3], v125 offset:512
    ds_read_b64_tr_b16 a[4:5], v125 offset:4096
    ds_read_b64_tr_b16 a[6:7], v125 offset:4608
    ds_read_b64_tr_b16 a[8:9], v125 offset:8192
    ds_read_b64_tr_b16 a[10:11], v125 offset:8704
    ds_read_b64_tr_b16 a[12:13], v125 offset:12288
    ds_read_b64_tr_b16 a[14:15], v125 offset:12800
    ds_read_b64_tr_b16 a[16:17], v125 offset:16384
    ds_read_b64_tr_b16 a[18:19], v125 offset:16896
    ds_read_b64_tr_b16 a[20:21], v125 offset:20480
    ds_read_b64_tr_b16 a[22:23], v125 offset:20992
    ds_read_b64_tr_b16 a[24:25], v125 offset:24576
    ds_read_b64_tr_b16 a[26:27], v125 offset:25088
    ds_read_b64_tr_b16 a[28:29], v125 offset:28672
    ds_read_b64_tr_b16 a[30:31], v125 offset:29184
    ds_read_b64_tr_b16 a[32:33], v125 offset:32768
    ds_read_b64_tr_b16 a[34:35], v125 offset:33280
    ds_read_b64_tr_b16 a[36:37], v125 offset:36864
    ds_read_b64_tr_b16 a[38:39], v125 offset:37376
    s_waitcnt lgkmcnt(0)
    s_barrier
    s_lshl_b32 s90, s32, 10
    s_add_u32 m0, s90, 81920
    s_mov_b32 s91, 3932288
    buffer_load_dwordx4 v124, s[12:15], s91 offen nt lds
    s_add_u32 m0, m0, 4096
    s_add_u32 s91, s91, 393216
    buffer_load_dwordx4 v124, s[12:15], s91 offen nt lds
    s_add_u32 m0, m0, 4096
    s_add_u32 s91, s91, 393216
    buffer_load_dwordx4 v124, s[12:15], s91 offen nt lds
    s_add_u32 m0, m0, 4096
    s_add_u32 s91, s91, 393216
    buffer_load_dwordx4 v124, s[12:15], s91 offen nt lds
    s_add_u32 m0, m0, 4096
    s_add_u32 s91, s91, 393216
    buffer_load_dwordx4 v124, s[12:15], s91 offen nt lds
    s_add_u32 m0, m0, 4096
    s_add_u32 s91, s91, 393216
    buffer_load_dwordx4 v124, s[12:15], s91 offen nt lds
    s_add_u32 m0, m0, 4096
    s_add_u32 s91, s91, 393216
    buffer_load_dwordx4 v124, s[12:15], s91 offen nt lds
    s_add_u32 m0, m0, 4096
    s_add_u32 s91, s91, 393216
    buffer_load_dwordx4 v124, s[12:15], s91 offen nt lds
    s_add_u32 m0, m0, 4096
    s_add_u32 s91, s91, 393216
    buffer_load_dwordx4 v124, s[12:15], s91 offen nt lds
    s_add_u32 m0, m0, 4096
    s_add_u32 s91, s91, 393216
    buffer_load_dwordx4 v124, s[12:15], s91 offen nt lds
    s_waitcnt vmcnt(30)
    s_barrier
    ds_read_b64_tr_b16 a[80:81], v126 offset:0
    ds_read_b64_tr_b16 a[82:83], v126 offset:512
    ds_read_b64_tr_b16 a[84:85], v126 offset:4096
    ds_read_b64_tr_b16 a[86:87], v126 offset:4608
    ds_read_b64_tr_b16 a[88:89], v126 offset:8192
    ds_read_b64_tr_b16 a[90:91], v126 offset:8704
    ds_read_b64_tr_b16 a[92:93], v126 offset:12288
    ds_read_b64_tr_b16 a[94:95], v126 offset:12800
    ds_read_b64_tr_b16 a[96:97], v126 offset:16384
    ds_read_b64_tr_b16 a[98:99], v126 offset:16896
    ds_read_b64_tr_b16 a[100:101], v126 offset:20480
    ds_read_b64_tr_b16 a[102:103], v126 offset:20992
    ds_read_b64_tr_b16 a[104:105], v126 offset:24576
    ds_read_b64_tr_b16 a[106:107], v126 offset:25088
    ds_read_b64_tr_b16 a[108:109], v126 offset:28672
    ds_read_b64_tr_b16 a[110:111], v126 offset:29184
    ds_read_b64_tr_b16 a[112:113], v126 offset:32768
    ds_read_b64_tr_b16 a[114:115], v126 offset:33280
    ds_read_b64_tr_b16 a[116:117], v126 offset:36864
    ds_read_b64_tr_b16 a[118:119], v126 offset:37376
    s_waitcnt lgkmcnt(0)
    s_barrier
    s_mov_b32 s46, 40960
    s_lshl_b32 s90, s32, 10
    s_add_u32 m0, s90, 40960
    s_nop 0
    buffer_load_dwordx4 v10, s[24:27], s46 offen offset:0 lds
    s_add_u32 m0, m0, 3968
    s_nop 0
    buffer_load_dwordx4 v10, s[24:27], s46 offen offset:128 lds
    s_add_u32 m0, m0, 3968
    s_nop 0
    buffer_load_dwordx4 v10, s[24:27], s46 offen offset:256 lds
    s_add_u32 m0, m0, 3968
    s_nop 0
    buffer_load_dwordx4 v10, s[24:27], s46 offen offset:384 lds
    s_add_u32 m0, m0, 3968
    s_nop 0
    buffer_load_dwordx4 v10, s[24:27], s46 offen offset:512 lds
    s_add_u32 m0, m0, 3968
    s_nop 0
    buffer_load_dwordx4 v10, s[24:27], s46 offen offset:640 lds
    s_add_u32 m0, m0, 3968
    s_nop 0
    buffer_load_dwordx4 v10, s[24:27], s46 offen offset:768 lds
    s_add_u32 m0, m0, 3968
    s_nop 0
    buffer_load_dwordx4 v10, s[24:27], s46 offen offset:896 lds
    s_add_u32 m0, m0, 3968
    s_nop 0
    buffer_load_dwordx4 v10, s[24:27], s46 offen offset:1024 lds
    s_add_u32 m0, m0, 3968
    s_nop 0
    buffer_load_dwordx4 v10, s[24:27], s46 offen offset:1152 lds
    s_waitcnt vmcnt(30)
    s_barrier
    ds_read_b64_tr_b16 a[40:41], v127 offset:0
    ds_read_b64_tr_b16 a[42:43], v127 offset:512
    ds_read_b64_tr_b16 a[44:45], v127 offset:4096
    ds_read_b64_tr_b16 a[46:47], v127 offset:4608
    ds_read_b64_tr_b16 a[48:49], v127 offset:8192
    ds_read_b64_tr_b16 a[50:51], v127 offset:8704
    ds_read_b64_tr_b16 a[52:53], v127 offset:12288
    ds_read_b64_tr_b16 a[54:55], v127 offset:12800
    ds_read_b64_tr_b16 a[56:57], v127 offset:16384
    ds_read_b64_tr_b16 a[58:59], v127 offset:16896
    ds_read_b64_tr_b16 a[60:61], v127 offset:20480
    ds_read_b64_tr_b16 a[62:63], v127 offset:20992
    ds_read_b64_tr_b16 a[64:65], v127 offset:24576
    ds_read_b64_tr_b16 a[66:67], v127 offset:25088
    ds_read_b64_tr_b16 a[68:69], v127 offset:28672
    ds_read_b64_tr_b16 a[70:71], v127 offset:29184
    ds_read_b64_tr_b16 a[72:73], v127 offset:32768
    ds_read_b64_tr_b16 a[74:75], v127 offset:33280
    ds_read_b64_tr_b16 a[76:77], v127 offset:36864
    ds_read_b64_tr_b16 a[78:79], v127 offset:37376
    s_waitcnt lgkmcnt(0)
    s_waitcnt vmcnt(10)
    s_barrier
    ds_read_b64_tr_b16 a[120:121], v125 offset:0
    ds_read_b64_tr_b16 a[122:123], v125 offset:512
    ds_read_b64_tr_b16 a[124:125], v125 offset:4096
    ds_read_b64_tr_b16 a[126:127], v125 offset:4608
    ds_read_b64_tr_b16 a[128:129], v125 offset:8192
    ds_read_b64_tr_b16 a[130:131], v125 offset:8704
    ds_read_b64_tr_b16 a[132:133], v125 offset:12288
    ds_read_b64_tr_b16 a[134:135], v125 offset:12800
    ds_read_b64_tr_b16 a[136:137], v125 offset:16384
    ds_read_b64_tr_b16 a[138:139], v125 offset:16896
    ds_read_b64_tr_b16 a[140:141], v125 offset:20480
    ds_read_b64_tr_b16 a[142:143], v125 offset:20992
    ds_read_b64_tr_b16 a[144:145], v125 offset:24576
    ds_read_b64_tr_b16 a[146:147], v125 offset:25088
    ds_read_b64_tr_b16 a[148:149], v125 offset:28672
    ds_read_b64_tr_b16 a[150:151], v125 offset:29184
    ds_read_b64_tr_b16 a[152:153], v125 offset:32768
    ds_read_b64_tr_b16 a[154:155], v125 offset:33280
    ds_read_b64_tr_b16 a[156:157], v125 offset:36864
    ds_read_b64_tr_b16 a[158:159], v125 offset:37376
    s_waitcnt lgkmcnt(0)
    s_mov_b32 s49, 40960
    s_mov_b32 s47, 40960
    s_mov_b32 s37, -1
    s_add_u32 s44, s38, 65536
    s_add_u32 s45, s44, s56
    s_mov_b32 s46, 40960
    ds_read_b128 v[84:87], v11 offset:0
    ds_read_b128 v[88:91], v11 offset:2048
    ds_read_b128 v[92:95], v12 offset:0
    ds_read_b128 v[96:99], v12 offset:2048
    s_waitcnt lgkmcnt(2)
    v_mfma_f32_16x16x32_bf16 v[108:111], a[0:3], v[84:87], 0
    ds_read_b128 v[100:103], v11 offset:4096
    v_mfma_f32_16x16x32_bf16 v[112:115], a[0:3], v[88:91], 0
    ds_read_b128 v[104:107], v11 offset:6144
    v_mfma_f32_16x16x32_bf16 v[116:119], a[80:83], v[84:87], 0
    v_mfma_f32_16x16x32_bf16 v[120:123], a[80:83], v[88:91], 0
    s_waitcnt lgkmcnt(2)
    v_mfma_f32_16x16x32_bf16 v[108:111], a[4:7], v[92:95], v[108:111]
    ds_read_b128 v[84:87], v12 offset:4096
    v_mfma_f32_16x16x32_bf16 v[112:115], a[4:7], v[96:99], v[112:115]
    ds_read_b128 v[88:91], v12 offset:6144
    v_mfma_f32_16x16x32_bf16 v[116:119], a[84:87], v[92:95], v[116:119]
    v_mfma_f32_16x16x32_bf16 v[120:123], a[84:87], v[96:99], v[120:123]
    s_waitcnt lgkmcnt(2)
    v_mfma_f32_16x16x32_bf16 v[108:111], a[8:11], v[100:103], v[108:111]
    ds_read_b128 v[92:95], v11 offset:8192
    v_mfma_f32_16x16x32_bf16 v[112:115], a[8:11], v[104:107], v[112:115]
    ds_read_b128 v[96:99], v11 offset:10240
    v_mfma_f32_16x16x32_bf16 v[116:119], a[88:91], v[100:103], v[116:119]
    v_mfma_f32_16x16x32_bf16 v[120:123], a[88:91], v[104:107], v[120:123]
    s_waitcnt lgkmcnt(2)
    v_mfma_f32_16x16x32_bf16 v[108:111], a[12:15], v[84:87], v[108:111]
    ds_read_b128 v[100:103], v12 offset:8192
    v_mfma_f32_16x16x32_bf16 v[112:115], a[12:15], v[88:91], v[112:115]
    ds_read_b128 v[104:107], v12 offset:10240
    v_mfma_f32_16x16x32_bf16 v[116:119], a[92:95], v[84:87], v[116:119]
    v_mfma_f32_16x16x32_bf16 v[120:123], a[92:95], v[88:91], v[120:123]
    s_waitcnt lgkmcnt(2)
    v_mfma_f32_16x16x32_bf16 v[108:111], a[16:19], v[92:95], v[108:111]
    ds_read_b128 v[84:87], v11 offset:12288
    v_mfma_f32_16x16x32_bf16 v[112:115], a[16:19], v[96:99], v[112:115]
    ds_read_b128 v[88:91], v11 offset:14336
    v_mfma_f32_16x16x32_bf16 v[116:119], a[96:99], v[92:95], v[116:119]
    v_mfma_f32_16x16x32_bf16 v[120:123], a[96:99], v[96:99], v[120:123]
    s_waitcnt lgkmcnt(2)
    v_mfma_f32_16x16x32_bf16 v[108:111], a[20:23], v[100:103], v[108:111]
    ds_read_b128 v[92:95], v12 offset:12288
    v_mfma_f32_16x16x32_bf16 v[112:115], a[20:23], v[104:107], v[112:115]
    ds_read_b128 v[96:99], v12 offset:14336
    v_mfma_f32_16x16x32_bf16 v[116:119], a[100:103], v[100:103], v[116:119]
    v_mfma_f32_16x16x32_bf16 v[120:123], a[100:103], v[104:107], v[120:123]
    s_waitcnt lgkmcnt(2)
    v_mfma_f32_16x16x32_bf16 v[108:111], a[24:27], v[84:87], v[108:111]
    ds_read_b128 v[100:103], v11 offset:16384
    v_mfma_f32_16x16x32_bf16 v[112:115], a[24:27], v[88:91], v[112:115]
    ds_read_b128 v[104:107], v11 offset:18432
    v_mfma_f32_16x16x32_bf16 v[116:119], a[104:107], v[84:87], v[116:119]
    v_mfma_f32_16x16x32_bf16 v[120:123], a[104:107], v[88:91], v[120:123]
    s_waitcnt lgkmcnt(2)
    v_mfma_f32_16x16x32_bf16 v[108:111], a[28:31], v[92:95], v[108:111]
    ds_read_b128 v[84:87], v12 offset:16384
    v_mfma_f32_16x16x32_bf16 v[112:115], a[28:31], v[96:99], v[112:115]
    ds_read_b128 v[88:91], v12 offset:18432
    v_mfma_f32_16x16x32_bf16 v[116:119], a[108:111], v[92:95], v[116:119]
    v_mfma_f32_16x16x32_bf16 v[120:123], a[108:111], v[96:99], v[120:123]
    s_waitcnt lgkmcnt(2)
    v_mfma_f32_16x16x32_bf16 v[108:111], a[32:35], v[100:103], v[108:111]
    ds_read_b128 v[92:95], v11 offset:20480
    v_mfma_f32_16x16x32_bf16 v[112:115], a[32:35], v[104:107], v[112:115]
    ds_read_b128 v[96:99], v11 offset:22528
    v_mfma_f32_16x16x32_bf16 v[116:119], a[112:115], v[100:103], v[116:119]
    v_mfma_f32_16x16x32_bf16 v[120:123], a[112:115], v[104:107], v[120:123]
    s_waitcnt lgkmcnt(2)
    v_mfma_f32_16x16x32_bf16 v[108:111], a[36:39], v[84:87], v[108:111]
    ds_read_b128 v[100:103], v12 offset:20480
    v_mfma_f32_16x16x32_bf16 v[112:115], a[36:39], v[88:91], v[112:115]
    ds_read_b128 v[104:107], v12 offset:22528
    v_mfma_f32_16x16x32_bf16 v[116:119], a[116:119], v[84:87], v[116:119]
    v_mfma_f32_16x16x32_bf16 v[120:123], a[116:119], v[88:91], v[120:123]
    s_waitcnt lgkmcnt(2)
    v_mfma_f32_16x16x32_bf16 v[108:111], a[40:43], v[92:95], v[108:111]
    ds_read_b128 v[84:87], v11 offset:24576
    v_mfma_f32_16x16x32_bf16 v[112:115], a[40:43], v[96:99], v[112:115]
    ds_read_b128 v[88:91], v11 offset:26624
    v_mfma_f32_16x16x32_bf16 v[116:119], a[120:123], v[92:95], v[116:119]
    v_mfma_f32_16x16x32_bf16 v[120:123], a[120:123], v[96:99], v[120:123]
    s_waitcnt lgkmcnt(2)
    v_mfma_f32_16x16x32_bf16 v[108:111], a[44:47], v[100:103], v[108:111]
    ds_read_b128 v[92:95], v12 offset:24576
    v_mfma_f32_16x16x32_bf16 v[112:115], a[44:47], v[104:107], v[112:115]
    ds_read_b128 v[96:99], v12 offset:26624
    v_mfma_f32_16x16x32_bf16 v[116:119], a[124:127], v[100:103], v[116:119]
    v_mfma_f32_16x16x32_bf16 v[120:123], a[124:127], v[104:107], v[120:123]
    s_waitcnt lgkmcnt(2)
    v_mfma_f32_16x16x32_bf16 v[108:111], a[48:51], v[84:87], v[108:111]
    ds_read_b128 v[100:103], v11 offset:28672
    v_mfma_f32_16x16x32_bf16 v[112:115], a[48:51], v[88:91], v[112:115]
    ds_read_b128 v[104:107], v11 offset:30720
    v_mfma_f32_16x16x32_bf16 v[116:119], a[128:131], v[84:87], v[116:119]
    v_mfma_f32_16x16x32_bf16 v[120:123], a[128:131], v[88:91], v[120:123]
    s_waitcnt lgkmcnt(2)
    v_mfma_f32_16x16x32_bf16 v[108:111], a[52:55], v[92:95], v[108:111]
    ds_read_b128 v[84:87], v12 offset:28672
    v_mfma_f32_16x16x32_bf16 v[112:115], a[52:55], v[96:99], v[112:115]
    ds_read_b128 v[88:91], v12 offset:30720
    v_mfma_f32_16x16x32_bf16 v[116:119], a[132:135], v[92:95], v[116:119]
    v_mfma_f32_16x16x32_bf16 v[120:123], a[132:135], v[96:99], v[120:123]
    s_waitcnt lgkmcnt(2)
    v_mfma_f32_16x16x32_bf16 v[108:111], a[56:59], v[100:103], v[108:111]
    ds_read_b128 v[92:95], v11 offset:32768
    v_mfma_f32_16x16x32_bf16 v[112:115], a[56:59], v[104:107], v[112:115]
    ds_read_b128 v[96:99], v11 offset:34816
    v_mfma_f32_16x16x32_bf16 v[116:119], a[136:139], v[100:103], v[116:119]
    v_mfma_f32_16x16x32_bf16 v[120:123], a[136:139], v[104:107], v[120:123]
    s_waitcnt lgkmcnt(2)
    v_mfma_f32_16x16x32_bf16 v[108:111], a[60:63], v[84:87], v[108:111]
    ds_read_b128 v[100:103], v12 offset:32768
    v_mfma_f32_16x16x32_bf16 v[112:115], a[60:63], v[88:91], v[112:115]
    ds_read_b128 v[104:107], v12 offset:34816
    v_mfma_f32_16x16x32_bf16 v[116:119], a[140:143], v[84:87], v[116:119]
    v_mfma_f32_16x16x32_bf16 v[120:123], a[140:143], v[88:91], v[120:123]
    s_waitcnt lgkmcnt(2)
    v_mfma_f32_16x16x32_bf16 v[108:111], a[64:67], v[92:95], v[108:111]
    ds_read_b128 v[84:87], v11 offset:36864
    v_mfma_f32_16x16x32_bf16 v[112:115], a[64:67], v[96:99], v[112:115]
    ds_read_b128 v[88:91], v11 offset:38912
    v_mfma_f32_16x16x32_bf16 v[116:119], a[144:147], v[92:95], v[116:119]
    v_mfma_f32_16x16x32_bf16 v[120:123], a[144:147], v[96:99], v[120:123]
    s_waitcnt lgkmcnt(2)
    v_mfma_f32_16x16x32_bf16 v[108:111], a[68:71], v[100:103], v[108:111]
    ds_read_b128 v[92:95], v12 offset:36864
    v_mfma_f32_16x16x32_bf16 v[112:115], a[68:71], v[104:107], v[112:115]
    ds_read_b128 v[96:99], v12 offset:38912
    v_mfma_f32_16x16x32_bf16 v[116:119], a[148:151], v[100:103], v[116:119]
    v_mfma_f32_16x16x32_bf16 v[120:123], a[148:151], v[104:107], v[120:123]
    s_waitcnt lgkmcnt(0)
    v_mfma_f32_16x16x32_bf16 v[108:111], a[72:75], v[84:87], v[108:111]
    v_add_u32 v11, s49, v11
    v_mfma_f32_16x16x32_bf16 v[112:115], a[72:75], v[88:91], v[112:115]
    v_add_u32 v12, s49, v12
    v_mfma_f32_16x16x32_bf16 v[108:111], a[76:79], v[92:95], v[108:111]
    s_sub_u32 s47, s47, s49
    v_mfma_f32_16x16x32_bf16 v[112:115], a[76:79], v[96:99], v[112:115]
    s_sub_u32 s49, 0, s49
    v_mfma_f32_16x16x32_bf16 v[116:119], a[152:155], v[84:87], v[116:119]
    v_mfma_f32_16x16x32_bf16 v[120:123], a[152:155], v[88:91], v[120:123]
    v_mfma_f32_16x16x32_bf16 v[116:119], a[156:159], v[92:95], v[116:119]
    v_mfma_f32_16x16x32_bf16 v[120:123], a[156:159], v[96:99], v[120:123]
    v_cvt_pk_bf16_f32 v124, v108, v109
    v_cvt_pk_bf16_f32 v125, v110, v111
    v_cvt_pk_bf16_f32 v126, v112, v113
    v_cvt_pk_bf16_f32 v127, v114, v115
    s_nop 0
    v_permlane16_swap_b32 v124, v126
    v_permlane16_swap_b32 v125, v127
    v_cvt_pk_bf16_f32 v128, v116, v117
    v_cvt_pk_bf16_f32 v129, v118, v119
    v_cvt_pk_bf16_f32 v130, v120, v121
    v_cvt_pk_bf16_f32 v131, v122, v123
    s_nop 0
    v_permlane16_swap_b32 v128, v130
    v_permlane16_swap_b32 v129, v131
    buffer_store_dwordx4 v[124:127], v19, s[4:7], s44 offen sc1
    buffer_store_dwordx4 v[128:131], v19, s[4:7], s45 offen sc1
    v_mov_b32 v1, 196
L_gw_77:
    buffer_load_dword v2, v1, s[8:11], 0 offen sc1
    s_sub_u32 s36, s36, 1
    s_cbranch_scc1 L_exit
    s_waitcnt vmcnt(0)
    v_readfirstlane_b32 s90, v2
    s_nop 0
    s_cmp_eq_u32 s90, 0
    s_cbranch_scc1 L_gw_77
    s_waitcnt vmcnt(0) lgkmcnt(0)
    v_mov_b32 v20, 1
    buffer_store_dword v20, v136, s[4:7], s38 offen sc1
    s_barrier
    s_add_u32 s44, s38, 180224
    s_add_u32 s45, s44, s56
    s_mov_b32 s46, 81920
    ds_read_b128 v[84:87], v11 offset:0
    ds_read_b128 v[88:91], v11 offset:2048
    ds_read_b128 v[92:95], v12 offset:0
    ds_read_b128 v[96:99], v12 offset:2048
    s_lshl_b32 s90, s32, 10
    s_add_u32 m0, s90, s47
    s_waitcnt lgkmcnt(2)
    v_mfma_f32_16x16x32_bf16 v[108:111], a[0:3], v[84:87], 0
    ds_read_b128 v[100:103], v11 offset:4096
    v_mfma_f32_16x16x32_bf16 v[112:115], a[0:3], v[88:91], 0
    ds_read_b128 v[104:107], v11 offset:6144
    v_mfma_f32_16x16x32_bf16 v[116:119], a[80:83], v[84:87], 0
    buffer_load_dwordx4 v10, s[24:27], s46 offen offset:0 lds
    s_add_u32 m0, m0, 3968
    v_mfma_f32_16x16x32_bf16 v[120:123], a[80:83], v[88:91], 0
    s_waitcnt lgkmcnt(2)
    v_mfma_f32_16x16x32_bf16 v[108:111], a[4:7], v[92:95], v[108:111]
    ds_read_b128 v[84:87], v12 offset:4096
    v_mfma_f32_16x16x32_bf16 v[112:115], a[4:7], v[96:99], v[112:115]
    ds_read_b128 v[88:91], v12 offset:6144
    v_mfma_f32_16x16x32_bf16 v[116:119], a[84:87], v[92:95], v[116:119]
    buffer_load_dwordx4 v10, s[24:27], s46 offen offset:128 lds
    s_add_u32 m0, m0, 3968
    v_mfma_f32_16x16x32_bf16 v[120:123], a[84:87], v[96:99], v[120:123]
    s_waitcnt lgkmcnt(2)
    v_mfma_f32_16x16x32_bf16 v[108:111], a[8:11], v[100:103], v[108:111]
    ds_read_b128 v[92:95], v11 offset:8192
    v_mfma_f32_16x16x32_bf16 v[112:115], a[8:11], v[104:107], v[112:115]
    ds_read_b128 v[96:99], v11 offset:10240
    v_mfma_f32_16x16x32_bf16 v[116:119], a[88:91], v[100:103], v[116:119]
    buffer_load_dwordx4 v10, s[24:27], s46 offen offset:256 lds
    s_add_u32 m0, m0, 3968
    v_mfma_f32_16x16x32_bf16 v[120:123], a[88:91], v[104:107], v[120:123]
    s_waitcnt lgkmcnt(2)
    v_mfma_f32_16x16x32_bf16 v[108:111], a[12:15], v[84:87], v[108:111]
    ds_read_b128 v[100:103], v12 offset:8192
    v_mfma_f32_16x16x32_bf16 v[112:115], a[12:15], v[88:91], v[112:115]
    ds_read_b128 v[104:107], v12 offset:10240
    v_mfma_f32_16x16x32_bf16 v[116:119], a[92:95], v[84:87], v[116:119]
    buffer_load_dwordx4 v10, s[24:27], s46 offen offset:384 lds
    s_add_u32 m0, m0, 3968
    v_mfma_f32_16x16x32_bf16 v[120:123], a[92:95], v[88:91], v[120:123]
    s_waitcnt lgkmcnt(2)
    v_mfma_f32_16x16x32_bf16 v[108:111], a[16:19], v[92:95], v[108:111]
    ds_read_b128 v[84:87], v11 offset:12288
    v_mfma_f32_16x16x32_bf16 v[112:115], a[16:19], v[96:99], v[112:115]
    ds_read_b128 v[88:91], v11 offset:14336
    v_mfma_f32_16x16x32_bf16 v[116:119], a[96:99], v[92:95], v[116:119]
    buffer_load_dwordx4 v10, s[24:27], s46 offen offset:512 lds
    s_add_u32 m0, m0, 3968
    v_mfma_f32_16x16x32_bf16 v[120:123], a[96:99], v[96:99], v[120:123]
    s_waitcnt lgkmcnt(2)
    v_mfma_f32_16x16x32_bf16 v[108:111], a[20:23], v[100:103], v[108:111]
    ds_read_b128 v[92:95], v12 offset:12288
    v_mfma_f32_16x16x32_bf16 v[112:115], a[20:23], v[104:107], v[112:115]
    ds_read_b128 v[96:99], v12 offset:14336
    v_mfma_f32_16x16x32_bf16 v[116:119], a[100:103], v[100:103], v[116:119]
    buffer_load_dwordx4 v10, s[24:27], s46 offen offset:640 lds
    s_add_u32 m0, m0, 3968
    v_mfma_f32_16x16x32_bf16 v[120:123], a[100:103], v[104:107], v[120:123]
    s_waitcnt lgkmcnt(2)
    v_mfma_f32_16x16x32_bf16 v[108:111], a[24:27], v[84:87], v[108:111]
    ds_read_b128 v[100:103], v11 offset:16384
    v_mfma_f32_16x16x32_bf16 v[112:115], a[24:27], v[88:91], v[112:115]
    ds_read_b128 v[104:107], v11 offset:18432
    v_mfma_f32_16x16x32_bf16 v[116:119], a[104:107], v[84:87], v[116:119]
    buffer_load_dwordx4 v10, s[24:27], s46 offen offset:768 lds
    s_add_u32 m0, m0, 3968
    v_mfma_f32_16x16x32_bf16 v[120:123], a[104:107], v[88:91], v[120:123]
    s_waitcnt lgkmcnt(2)
    v_mfma_f32_16x16x32_bf16 v[108:111], a[28:31], v[92:95], v[108:111]
    ds_read_b128 v[84:87], v12 offset:16384
    v_mfma_f32_16x16x32_bf16 v[112:115], a[28:31], v[96:99], v[112:115]
    ds_read_b128 v[88:91], v12 offset:18432
    v_mfma_f32_16x16x32_bf16 v[116:119], a[108:111], v[92:95], v[116:119]
    buffer_load_dwordx4 v10, s[24:27], s46 offen offset:896 lds
    s_add_u32 m0, m0, 3968
    v_mfma_f32_16x16x32_bf16 v[120:123], a[108:111], v[96:99], v[120:123]
    s_waitcnt lgkmcnt(2)
    v_mfma_f32_16x16x32_bf16 v[108:111], a[32:35], v[100:103], v[108:111]
    ds_read_b128 v[92:95], v11 offset:20480
    v_mfma_f32_16x16x32_bf16 v[112:115], a[32:35], v[104:107], v[112:115]
    ds_read_b128 v[96:99], v11 offset:22528
    v_mfma_f32_16x16x32_bf16 v[116:119], a[112:115], v[100:103], v[116:119]
    buffer_load_dwordx4 v10, s[24:27], s46 offen offset:1024 lds
    s_add_u32 m0, m0, 3968
    v_mfma_f32_16x16x32_bf16 v[120:123], a[112:115], v[104:107], v[120:123]
    s_waitcnt lgkmcnt(2)
    v_mfma_f32_16x16x32_bf16 v[108:111], a[36:39], v[84:87], v[108:111]
    ds_read_b128 v[100:103], v12 offset:20480
    v_mfma_f32_16x16x32_bf16 v[112:115], a[36:39], v[88:91], v[112:115]
    ds_read_b128 v[104:107], v12 offset:22528
    v_mfma_f32_16x16x32_bf16 v[116:119], a[116:119], v[84:87], v[116:119]
    buffer_load_dwordx4 v10, s[24:27], s46 offen offset:1152 lds
    v_mfma_f32_16x16x32_bf16 v[120:123], a[116:119], v[88:91], v[120:123]
    s_waitcnt lgkmcnt(2)
    v_mfma_f32_16x16x32_bf16 v[108:111], a[40:43], v[92:95], v[108:111]
    ds_read_b128 v[84:87], v11 offset:24576
    v_mfma_f32_16x16x32_bf16 v[112:115], a[40:43], v[96:99], v[112:115]
    ds_read_b128 v[88:91], v11 offset:26624
    v_mfma_f32_16x16x32_bf16 v[116:119], a[120:123], v[92:95], v[116:119]
    v_mfma_f32_16x16x32_bf16 v[120:123], a[120:123], v[96:99], v[120:123]
    s_waitcnt lgkmcnt(2)
    v_mfma_f32_16x16x32_bf16 v[108:111], a[44:47], v[100:103], v[108:111]
    ds_read_b128 v[92:95], v12 offset:24576
    v_mfma_f32_16x16x32_bf16 v[112:115], a[44:47], v[104:107], v[112:115]
    ds_read_b128 v[96:99], v12 offset:26624
    v_mfma_f32_16x16x32_bf16 v[116:119], a[124:127], v[100:103], v[116:119]
    v_mfma_f32_16x16x32_bf16 v[120:123], a[124:127], v[104:107], v[120:123]
    s_waitcnt lgkmcnt(2)
    v_mfma_f32_16x16x32_bf16 v[108:111], a[48:51], v[84:87], v[108:111]
    ds_read_b128 v[100:103], v11 offset:28672
    v_mfma_f32_16x16x32_bf16 v[112:115], a[48:51], v[88:91], v[112:115]
    ds_read_b128 v[104:107], v11 offset:30720
    v_mfma_f32_16x16x32_bf16 v[116:119], a[128:131], v[84:87], v[116:119]
    v_mfma_f32_16x16x32_bf16 v[120:123], a[128:131], v[88:91], v[120:123]
    s_waitcnt lgkmcnt(2)
    v_mfma_f32_16x16x32_bf16 v[108:111], a[52:55], v[92:95], v[108:111]
    ds_read_b128 v[84:87], v12 offset:28672
    v_mfma_f32_16x16x32_bf16 v[112:115], a[52:55], v[96:99], v[112:115]
    ds_read_b128 v[88:91], v12 offset:30720
    v_mfma_f32_16x16x32_bf16 v[116:119], a[132:135], v[92:95], v[116:119]
    v_mfma_f32_16x16x32_bf16 v[120:123], a[132:135], v[96:99], v[120:123]
    s_waitcnt lgkmcnt(2)
    v_mfma_f32_16x16x32_bf16 v[108:111], a[56:59], v[100:103], v[108:111]
    ds_read_b128 v[92:95], v11 offset:32768
    v_mfma_f32_16x16x32_bf16 v[112:115], a[56:59], v[104:107], v[112:115]
    ds_read_b128 v[96:99], v11 offset:34816
    v_mfma_f32_16x16x32_bf16 v[116:119], a[136:139], v[100:103], v[116:119]
    v_mfma_f32_16x16x32_bf16 v[120:123], a[136:139], v[104:107], v[120:123]
    s_waitcnt lgkmcnt(2)
    v_mfma_f32_16x16x32_bf16 v[108:111], a[60:63], v[84:87], v[108:111]
    ds_read_b128 v[100:103], v12 offset:32768
    v_mfma_f32_16x16x32_bf16 v[112:115], a[60:63], v[88:91], v[112:115]
    ds_read_b128 v[104:107], v12 offset:34816
    v_mfma_f32_16x16x32_bf16 v[116:119], a[140:143], v[84:87], v[116:119]
    v_mfma_f32_16x16x32_bf16 v[120:123], a[140:143], v[88:91], v[120:123]
    s_waitcnt lgkmcnt(2)
    v_mfma_f32_16x16x32_bf16 v[108:111], a[64:67], v[92:95], v[108:111]
    ds_read_b128 v[84:87], v11 offset:36864
    v_mfma_f32_16x16x32_bf16 v[112:115], a[64:67], v[96:99], v[112:115]
    ds_read_b128 v[88:91], v11 offset:38912
    v_mfma_f32_16x16x32_bf16 v[116:119], a[144:147], v[92:95], v[116:119]
    v_mfma_f32_16x16x32_bf16 v[120:123], a[144:147], v[96:99], v[120:123]
    s_waitcnt lgkmcnt(2)
    v_mfma_f32_16x16x32_bf16 v[108:111], a[68:71], v[100:103], v[108:111]
    ds_read_b128 v[92:95], v12 offset:36864
    v_mfma_f32_16x16x32_bf16 v[112:115], a[68:71], v[104:107], v[112:115]
    ds_read_b128 v[96:99], v12 offset:38912
    v_mfma_f32_16x16x32_bf16 v[116:119], a[148:151], v[100:103], v[116:119]
    v_mfma_f32_16x16x32_bf16 v[120:123], a[148:151], v[104:107], v[120:123]
    s_waitcnt lgkmcnt(0)
    v_mfma_f32_16x16x32_bf16 v[108:111], a[72:75], v[84:87], v[108:111]
    v_add_u32 v11, s49, v11
    v_mfma_f32_16x16x32_bf16 v[112:115], a[72:75], v[88:91], v[112:115]
    v_add_u32 v12, s49, v12
    v_mfma_f32_16x16x32_bf16 v[108:111], a[76:79], v[92:95], v[108:111]
    s_sub_u32 s47, s47, s49
    v_mfma_f32_16x16x32_bf16 v[112:115], a[76:79], v[96:99], v[112:115]
    s_sub_u32 s49, 0, s49
    v_mfma_f32_16x16x32_bf16 v[116:119], a[152:155], v[84:87], v[116:119]
    v_mfma_f32_16x16x32_bf16 v[120:123], a[152:155], v[88:91], v[120:123]
    v_mfma_f32_16x16x32_bf16 v[116:119], a[156:159], v[92:95], v[116:119]
    v_mfma_f32_16x16x32_bf16 v[120:123], a[156:159], v[96:99], v[120:123]
    v_cvt_pk_bf16_f32 v124, v108, v109
    v_cvt_pk_bf16_f32 v125, v110, v111
    v_cvt_pk_bf16_f32 v126, v112, v113
    v_cvt_pk_bf16_f32 v127, v114, v115
    s_nop 0
    v_permlane16_swap_b32 v124, v126
    v_permlane16_swap_b32 v125, v127
    v_cvt_pk_bf16_f32 v128, v116, v117
    v_cvt_pk_bf16_f32 v129, v118, v119
    v_cvt_pk_bf16_f32 v130, v120, v121
    v_cvt_pk_bf16_f32 v131, v122, v123
    s_nop 0
    v_permlane16_swap_b32 v128, v130
    v_permlane16_swap_b32 v129, v131
    buffer_store_dwordx4 v[124:127], v19, s[4:7], s44 offen sc1
    buffer_store_dwordx4 v[128:131], v19, s[4:7], s45 offen sc1
    s_waitcnt vmcnt(0) lgkmcnt(0)
    v_mov_b32 v20, 2
    buffer_store_dword v20, v136, s[4:7], s38 offen sc1
    s_barrier
    s_add_u32 s44, s38, 294912
    s_add_u32 s45, s44, s56
    s_mov_b32 s46, 122880
    ds_read_b128 v[84:87], v11 offset:0
    ds_read_b128 v[88:91], v11 offset:2048
    ds_read_b128 v[92:95], v12 offset:0
    ds_read_b128 v[96:99], v12 offset:2048
    s_lshl_b32 s90, s32, 10
    s_add_u32 m0, s90, s47
    s_waitcnt lgkmcnt(2)
    v_mfma_f32_16x16x32_bf16 v[108:111], a[0:3], v[84:87], 0
    ds_read_b128 v[100:103], v11 offset:4096
    s_add_u32 s51, s37, 3
    v_mfma_f32_16x16x32_bf16 v[112:115], a[0:3], v[88:91], 0
    ds_read_b128 v[104:107], v11 offset:6144
    s_and_b32 s50, s51, 3
    v_mfma_f32_16x16x32_bf16 v[116:119], a[80:83], v[84:87], 0
    buffer_load_dwordx4 v10, s[24:27], s46 offen offset:0 lds
    s_add_u32 m0, m0, 3968
    v_mfma_f32_16x16x32_bf16 v[120:123], a[80:83], v[88:91], 0
    s_waitcnt lgkmcnt(2)
    s_mul_i32 s50, s50, 114688
    v_mfma_f32_16x16x32_bf16 v[108:111], a[4:7], v[92:95], v[108:111]
    ds_read_b128 v[84:87], v12 offset:4096
    s_add_u32 s50, s50, 65536
    v_mfma_f32_16x16x32_bf16 v[112:115], a[4:7], v[96:99], v[112:115]
    ds_read_b128 v[88:91], v12 offset:6144
    s_add_u32 s44, s38, s50
    v_mfma_f32_16x16x32_bf16 v[116:119], a[84:87], v[92:95], v[116:119]
    buffer_load_dwordx4 v10, s[24:27], s46 offen offset:128 lds
    s_add_u32 m0, m0, 3968
    v_mfma_f32_16x16x32_bf16 v[120:123], a[84:87], v[96:99], v[120:123]
    s_waitcnt lgkmcnt(2)
    s_add_u32 s45, s44, s56
    v_mfma_f32_16x16x32_bf16 v[108:111], a[8:11], v[100:103], v[108:111]
    ds_read_b128 v[92:95], v11 offset:8192
    s_add_u32 s37, s37, 1
    v_mfma_f32_16x16x32_bf16 v[112:115], a[8:11], v[104:107], v[112:115]
    ds_read_b128 v[96:99], v11 offset:10240
    s_mov_b32 s52, 0
    v_mfma_f32_16x16x32_bf16 v[116:119], a[88:91], v[100:103], v[116:119]
    buffer_load_dwordx4 v10, s[24:27], s46 offen offset:256 lds
    s_add_u32 m0, m0, 3968
    v_mfma_f32_16x16x32_bf16 v[120:123], a[88:91], v[104:107], v[120:123]
    s_waitcnt lgkmcnt(2)
    s_and_b32 s50, s37, 3
    v_mfma_f32_16x16x32_bf16 v[108:111], a[12:15], v[84:87], v[108:111]
    ds_read_b128 v[100:103], v12 offset:8192
    s_mul_i32 s51, s50, 114688
    v_mfma_f32_16x16x32_bf16 v[112:115], a[12:15], v[88:91], v[112:115]
    ds_read_b128 v[104:107], v12 offset:10240
    s_add_u32 s41, s38, s51
    v_mfma_f32_16x16x32_bf16 v[116:119], a[92:95], v[84:87], v[116:119]
    buffer_load_dwordx4 v10, s[24:27], s46 offen offset:384 lds
    s_add_u32 m0, m0, 3968
    v_mfma_f32_16x16x32_bf16 v[120:123], a[92:95], v[88:91], v[120:123]
    s_waitcnt lgkmcnt(2)
    v_mfma_f32_16x16x32_bf16 v[108:111], a[16:19], v[92:95], v[108:111]
    ds_read_b128 v[84:87], v11 offset:12288
    v_mfma_f32_16x16x32_bf16 v[112:115], a[16:19], v[96:99], v[112:115]
    ds_read_b128 v[88:91], v11 offset:14336
    v_mfma_f32_16x16x32_bf16 v[116:119], a[96:99], v[92:95], v[116:119]
    buffer_load_dwordx4 v10, s[24:27], s46 offen offset:512 lds
    s_add_u32 m0, m0, 3968
    v_mfma_f32_16x16x32_bf16 v[120:123], a[96:99], v[96:99], v[120:123]
    s_waitcnt lgkmcnt(2)
    v_mfma_f32_16x16x32_bf16 v[108:111], a[20:23], v[100:103], v[108:111]
    ds_read_b128 v[92:95], v12 offset:12288
    v_mfma_f32_16x16x32_bf16 v[112:115], a[20:23], v[104:107], v[112:115]
    ds_read_b128 v[96:99], v12 offset:14336
    v_mfma_f32_16x16x32_bf16 v[116:119], a[100:103], v[100:103], v[116:119]
    buffer_load_dwordx4 v10, s[24:27], s46 offen offset:640 lds
    s_add_u32 m0, m0, 3968
    v_mfma_f32_16x16x32_bf16 v[120:123], a[100:103], v[104:107], v[120:123]
    s_waitcnt lgkmcnt(2)
    v_mfma_f32_16x16x32_bf16 v[108:111], a[24:27], v[84:87], v[108:111]
    ds_read_b128 v[100:103], v11 offset:16384
    v_mfma_f32_16x16x32_bf16 v[112:115], a[24:27], v[88:91], v[112:115]
    ds_read_b128 v[104:107], v11 offset:18432
    v_mfma_f32_16x16x32_bf16 v[116:119], a[104:107], v[84:87], v[116:119]
    buffer_load_dwordx4 v10, s[24:27], s46 offen offset:768 lds
    s_add_u32 m0, m0, 3968
    v_mfma_f32_16x16x32_bf16 v[120:123], a[104:107], v[88:91], v[120:123]
    s_waitcnt lgkmcnt(2)
    v_mfma_f32_16x16x32_bf16 v[108:111], a[28:31], v[92:95], v[108:111]
    ds_read_b128 v[84:87], v12 offset:16384
    v_mfma_f32_16x16x32_bf16 v[112:115], a[28:31], v[96:99], v[112:115]
    ds_read_b128 v[88:91], v12 offset:18432
    v_mfma_f32_16x16x32_bf16 v[116:119], a[108:111], v[92:95], v[116:119]
    buffer_load_dwordx4 v10, s[24:27], s46 offen offset:896 lds
    s_add_u32 m0, m0, 3968
    v_mfma_f32_16x16x32_bf16 v[120:123], a[108:111], v[96:99], v[120:123]
    s_waitcnt lgkmcnt(2)
    v_mfma_f32_16x16x32_bf16 v[108:111], a[32:35], v[100:103], v[108:111]
    ds_read_b128 v[92:95], v11 offset:20480
    v_mfma_f32_16x16x32_bf16 v[112:115], a[32:35], v[104:107], v[112:115]
    ds_read_b128 v[96:99], v11 offset:22528
    v_mfma_f32_16x16x32_bf16 v[116:119], a[112:115], v[100:103], v[116:119]
    buffer_load_dwordx4 v10, s[24:27], s46 offen offset:1024 lds
    s_add_u32 m0, m0, 3968
    v_mfma_f32_16x16x32_bf16 v[120:123], a[112:115], v[104:107], v[120:123]
    s_waitcnt lgkmcnt(2)
    v_mfma_f32_16x16x32_bf16 v[108:111], a[36:39], v[84:87], v[108:111]
    ds_read_b128 v[100:103], v12 offset:20480
    v_mfma_f32_16x16x32_bf16 v[112:115], a[36:39], v[88:91], v[112:115]
    ds_read_b128 v[104:107], v12 offset:22528
    v_mfma_f32_16x16x32_bf16 v[116:119], a[116:119], v[84:87], v[116:119]
    buffer_load_dwordx4 v10, s[24:27], s46 offen offset:1152 lds
    v_mfma_f32_16x16x32_bf16 v[120:123], a[116:119], v[88:91], v[120:123]
    s_waitcnt lgkmcnt(2)
    v_mfma_f32_16x16x32_bf16 v[108:111], a[40:43], v[92:95], v[108:111]
    ds_read_b128 v[84:87], v11 offset:24576
    v_mfma_f32_16x16x32_bf16 v[112:115], a[40:43], v[96:99], v[112:115]
    ds_read_b128 v[88:91], v11 offset:26624
    v_mfma_f32_16x16x32_bf16 v[116:119], a[120:123], v[92:95], v[116:119]
    v_mfma_f32_16x16x32_bf16 v[120:123], a[120:123], v[96:99], v[120:123]
    s_waitcnt lgkmcnt(2)
    v_mfma_f32_16x16x32_bf16 v[108:111], a[44:47], v[100:103], v[108:111]
    ds_read_b128 v[92:95], v12 offset:24576
    v_mfma_f32_16x16x32_bf16 v[112:115], a[44:47], v[104:107], v[112:115]
    ds_read_b128 v[96:99], v12 offset:26624
    v_mfma_f32_16x16x32_bf16 v[116:119], a[124:127], v[100:103], v[116:119]
    v_mfma_f32_16x16x32_bf16 v[120:123], a[124:127], v[104:107], v[120:123]
    s_waitcnt lgkmcnt(2)
    v_mfma_f32_16x16x32_bf16 v[108:111], a[48:51], v[84:87], v[108:111]
    ds_read_b128 v[100:103], v11 offset:28672
    v_mfma_f32_16x16x32_bf16 v[112:115], a[48:51], v[88:91], v[112:115]
    ds_read_b128 v[104:107], v11 offset:30720
    v_mfma_f32_16x16x32_bf16 v[116:119], a[128:131], v[84:87], v[116:119]
    v_mfma_f32_16x16x32_bf16 v[120:123], a[128:131], v[88:91], v[120:123]
    s_waitcnt lgkmcnt(2)
    v_mfma_f32_16x16x32_bf16 v[108:111], a[52:55], v[92:95], v[108:111]
    ds_read_b128 v[84:87], v12 offset:28672
    v_mfma_f32_16x16x32_bf16 v[112:115], a[52:55], v[96:99], v[112:115]
    ds_read_b128 v[88:91], v12 offset:30720
    v_mfma_f32_16x16x32_bf16 v[116:119], a[132:135], v[92:95], v[116:119]
    v_mfma_f32_16x16x32_bf16 v[120:123], a[132:135], v[96:99], v[120:123]
    s_waitcnt lgkmcnt(2)
    v_mfma_f32_16x16x32_bf16 v[108:111], a[56:59], v[100:103], v[108:111]
    ds_read_b128 v[92:95], v11 offset:32768
    v_mfma_f32_16x16x32_bf16 v[112:115], a[56:59], v[104:107], v[112:115]
    ds_read_b128 v[96:99], v11 offset:34816
    v_mfma_f32_16x16x32_bf16 v[116:119], a[136:139], v[100:103], v[116:119]
    v_mfma_f32_16x16x32_bf16 v[120:123], a[136:139], v[104:107], v[120:123]
    s_waitcnt lgkmcnt(2)
    v_mfma_f32_16x16x32_bf16 v[108:111], a[60:63], v[84:87], v[108:111]
    ds_read_b128 v[100:103], v12 offset:32768
    v_mfma_f32_16x16x32_bf16 v[112:115], a[60:63], v[88:91], v[112:115]
    ds_read_b128 v[104:107], v12 offset:34816
    v_mfma_f32_16x16x32_bf16 v[116:119], a[140:143], v[84:87], v[116:119]
    v_mfma_f32_16x16x32_bf16 v[120:123], a[140:143], v[88:91], v[120:123]
    s_waitcnt lgkmcnt(2)
    v_mfma_f32_16x16x32_bf16 v[108:111], a[64:67], v[92:95], v[108:111]
    ds_read_b128 v[84:87], v11 offset:36864
    v_mfma_f32_16x16x32_bf16 v[112:115], a[64:67], v[96:99], v[112:115]
    ds_read_b128 v[88:91], v11 offset:38912
    v_mfma_f32_16x16x32_bf16 v[116:119], a[144:147], v[92:95], v[116:119]
    v_mfma_f32_16x16x32_bf16 v[120:123], a[144:147], v[96:99], v[120:123]
    s_waitcnt lgkmcnt(2)
    v_mfma_f32_16x16x32_bf16 v[108:111], a[68:71], v[100:103], v[108:111]
    ds_read_b128 v[92:95], v12 offset:36864
    v_mfma_f32_16x16x32_bf16 v[112:115], a[68:71], v[104:107], v[112:115]
    ds_read_b128 v[96:99], v12 offset:38912
    v_mfma_f32_16x16x32_bf16 v[116:119], a[148:151], v[100:103], v[116:119]
    v_mfma_f32_16x16x32_bf16 v[120:123], a[148:151], v[104:107], v[120:123]
    s_waitcnt lgkmcnt(0)
    v_mfma_f32_16x16x32_bf16 v[108:111], a[72:75], v[84:87], v[108:111]
    v_add_u32 v11, s49, v11
    v_mfma_f32_16x16x32_bf16 v[112:115], a[72:75], v[88:91], v[112:115]
    v_add_u32 v12, s49, v12
    v_mfma_f32_16x16x32_bf16 v[108:111], a[76:79], v[92:95], v[108:111]
    s_sub_u32 s47, s47, s49
    v_mfma_f32_16x16x32_bf16 v[112:115], a[76:79], v[96:99], v[112:115]
    s_sub_u32 s49, 0, s49
    v_mfma_f32_16x16x32_bf16 v[116:119], a[152:155], v[84:87], v[116:119]
    v_mfma_f32_16x16x32_bf16 v[120:123], a[152:155], v[88:91], v[120:123]
    v_mfma_f32_16x16x32_bf16 v[116:119], a[156:159], v[92:95], v[116:119]
    v_mfma_f32_16x16x32_bf16 v[120:123], a[156:159], v[96:99], v[120:123]
    v_cvt_pk_bf16_f32 v124, v108, v109
    v_cvt_pk_bf16_f32 v125, v110, v111
    v_cvt_pk_bf16_f32 v126, v112, v113
    v_cvt_pk_bf16_f32 v127, v114, v115
    s_nop 0
    v_permlane16_swap_b32 v124, v126
    v_permlane16_swap_b32 v125, v127
    v_cvt_pk_bf16_f32 v128, v116, v117
    v_cvt_pk_bf16_f32 v129, v118, v119
    v_cvt_pk_bf16_f32 v130, v120, v121
    v_cvt_pk_bf16_f32 v131, v122, v123
    s_nop 0
    v_permlane16_swap_b32 v128, v130
    v_permlane16_swap_b32 v129, v131
    buffer_store_dwordx4 v[124:127], v19, s[4:7], s44 offen sc1
    buffer_store_dwordx4 v[128:131], v19, s[4:7], s45 offen sc1
    v_mov_b32 v3, 204
L_p0_78:
    buffer_load_dword v4, v3, s[8:11], 0 offen sc1
    s_sub_u32 s36, s36, 1
    s_cbranch_scc1 L_exit
    s_waitcnt vmcnt(0)
    v_readfirstlane_b32 s90, v4
    s_nop 0
    s_cmp_eq_u32 s90, 0
    s_cbranch_scc1 L_p0_78
    s_and_b32 s90, s90, 2
    s_lshl_b32 s90, s90, 12
    v_and_b32 v3, 1, v0
    v_lshlrev_b32 v3, 12, v3
    v_bfe_u32 v5, v0, 2, 1
    v_lshl_add_u32 v3, v5, 13, v3
    v_bfe_u32 v4, v0, 1, 1
    v_lshl_add_u32 v3, v4, 14, v3
    v_xor_b32 v3, s90, v3
    s_lshl_b32 s91, s34, 9
    s_add_u32 s91, s91, 1933312
    s_xor_b32 s55, s32, 3
    s_or_b32 s55, s55, s40
    s_cselect_b32 s91, 2146435072, s91
    v_add_u32 v140, s91, v3
    v_cmp_gt_u32 vcc, 8, v0
    v_mov_b32 v9, 2146435072
    s_nop 0
    v_cndmask_b32 v140, v9, v140, vcc
    v_cmp_ne_u32 vcc, s34, v0
    v_mov_b32 v9, 2146435072
    s_nop 0
    v_cndmask_b32 v140, v9, v140, vcc
    s_lshr_b32 s91, s34, 2
    v_cmp_eq_u32 vcc, s91, v5
    s_nop 1
    v_cndmask_b32 v141, v9, v140, vcc
    v_cndmask_b32 v140, v140, v9, vcc
    v_and_b32 v3, 7, v0
    v_min_u32 v3, 5, v3
    v_bfe_u32 v4, v0, 3, 2
    v_lshlrev_b32 v4, 7, v4
    v_lshl_add_u32 v3, v3, 2, v4
    v_add_u32 v142, 462368, v3
    s_mov_b32 s61, s90
    s_lshl_b32 s93, s40, 1
    s_add_u32 s93, s93, s32
    s_lshl_b32 s93, s93, 1
    s_sub_u32 s93, s93, 8
    v_and_b32 v1, 15, v0
    v_lshrrev_b32 v2, 4, v0
    s_nop 0
    s_lshr_b32 s90, s93, 2
    s_lshl_b32 s90, s90, 15
    s_and_b32 s92, s93, 3
    s_lshl_b32 s92, s92, 10
    s_add_u32 s90, s90, s92
    v_mov_b32 v5, s34
    v_and_b32 v6, 7, v1
    v_lshlrev_b32 v6, 4, v6
    v_lshl_add_u32 v6, v5, 7, v6
    v_lshrrev_b32 v7, 3, v1
    v_lshl_add_u32 v6, v7, 12, v6
    v_lshrrev_b32 v5, 1, v2
    v_lshl_add_u32 v6, v5, 13, v6
    v_and_b32 v5, 1, v2
    v_lshl_add_u32 v6, v5, 14, v6
    v_add_u32 v143, s90, v6
    s_and_b32 s91, s34, 1
    s_lshl_b32 s91, s91, 12
    s_add_u32 s90, s90, s91
    s_lshr_b32 s91, s34, 2
    s_lshl_b32 s91, s91, 13
    s_add_u32 s90, s90, s91
    s_and_b32 s91, s34, 2
    s_lshl_b32 s91, s91, 13
    s_add_u32 s90, s90, s91
    v_lshl_add_u32 v144, v0, 4, s90
    s_lshl_b32 s91, s93, 10
    s_add_u32 s91, s91, 884736
    v_lshl_add_u32 v146, v0, 4, s91
    s_lshr_b32 s91, s34, 1
    s_mul_i32 s91, s91, 10240
    s_lshl_b32 s92, s93, 5
    s_add_u32 s91, s91, s92
    s_and_b32 s92, s34, 1
    s_mul_i32 s92, s92, 40960
    s_add_u32 s91, s91, s92
    s_add_u32 s91, s91, 1280
    v_mul_u32_u24 v6, 2560, v2
    v_lshl_add_u32 v6, v1, 1, v6
    v_add_u32 v145, s91, v6
    v_cmp_gt_u32 s[58:59], 8, v1
    v_and_b32 v5, 1, v1
    v_lshrrev_b32 v6, 3, v1
    v_lshl_add_u32 v5, v5, 1, v6
    v_bfe_u32 v6, v1, 2, 1
    v_cmp_ne_u32 vcc, 0, v6
    v_mov_b32 v6, 0x3f80
    v_mov_b32 v7, 0x3f800000
    v_cndmask_b32 v6, v6, v7, vcc
    v_cmp_eq_u32 vcc, 0, v5
    s_nop 1
    v_cndmask_b32 v7, 0, v6, vcc
    v_accvgpr_write_b32 a160, v7
    v_cmp_eq_u32 vcc, 1, v5
    s_nop 1
    v_cndmask_b32 v7, 0, v6, vcc
    v_accvgpr_write_b32 a161, v7
    v_cmp_eq_u32 vcc, 2, v5
    s_nop 1
    v_cndmask_b32 v7, 0, v6, vcc
    v_accvgpr_write_b32 a162, v7
    v_cmp_eq_u32 vcc, 3, v5
    s_nop 1
    v_cndmask_b32 v7, 0, v6, vcc
    v_accvgpr_write_b32 a163, v7
    v_xor_b32 v143, s61, v143
    v_xor_b32 v144, s61, v144
    s_cmp_lg_u32 s40, 0
    s_cselect_b64 vcc, -1, 0
    v_mov_b32 v9, 2146435072
    v_cndmask_b32 v143, v9, v143, vcc
    v_cndmask_b32 v144, v9, v144, vcc
    v_cndmask_b32 v145, v9, v145, vcc
    v_cndmask_b32 v146, v9, v146, vcc
L_v_loop_s:
    s_add_u32 s50, s37, 2
    s_and_b32 s50, s50, 3
    s_mul_i32 s50, s50, 114688
    s_add_u32 s42, s38, s50
    s_add_u32 s50, s37, 4
    s_min_u32 s50, s50, 63
    s_mul_i32 s46, s50, 40960
    s_add_u32 s51, s37, 1
    v_mov_b32 v20, s51
    s_mov_b32 m0, s48
    v_mov_b32 v68, 0
    v_mov_b32 v69, 0
    v_mov_b32 v70, 0
    v_mov_b32 v71, 0
    v_mov_b32 v72, 0
    v_mov_b32 v73, 0
    v_mov_b32 v74, 0
    v_mov_b32 v75, 0
    s_add_u32 s50, s37, 6
    s_min_u32 s50, s50, 63
    s_mul_i32 s57, s50, 40960
    s_and_b32 s50, s37, 3
    s_mul_i32 s51, s50, 40960
    s_add_u32 s43, s51, s38
    s_mul_i32 s51, s50, 327680
    s_add_u32 s53, s51, 4194304
    s_xor_b32 s50, s50, 2
    s_mul_i32 s51, s50, 327680
    s_add_u32 s54, s51, 4194304
    s_sub_u32 s51, s37, 6
    s_mul_i32 s60, s51, 81920
L_vg_79:
    buffer_load_dword v139, v138, s[4:7], s38 offen sc1
    s_sub_u32 s36, s36, 1
    s_cbranch_scc1 L_exit
    s_waitcnt vmcnt(0)
    v_cmp_gt_u32 vcc, s37, v139
    s_cbranch_vccnz L_vg_79
    buffer_load_dwordx4 v13, s[4:7], s41 offen sc1 lds
    buffer_load_dwordx4 v13, s[4:7], s41 offen offset:1024 sc1 lds
    buffer_load_dword v14, s[4:7], s41 offen offset:2048 sc1 lds
    buffer_load_dword v14, s[4:7], s41 offen offset:2304 sc1 lds
L_poll_81:
    buffer_load_dwordx4 v13, s[4:7], s41 offen sc1 lds
    buffer_load_dwordx4 v13, s[4:7], s41 offen offset:1024 sc1 lds
    buffer_load_dword v14, s[4:7], s41 offen offset:2048 sc1 lds
    buffer_load_dword v14, s[4:7], s41 offen offset:2304 sc1 lds
    s_sub_u32 s36, s36, 1
    s_cbranch_scc1 L_exit
    s_waitcnt vmcnt(4)
    ds_read_b32 v18, v15
    s_waitcnt lgkmcnt(0)
    v_cmp_eq_u32 vcc, -1, v18
    s_cbranch_vccnz L_poll_81
    s_barrier
    ds_read_b128 v[28:31], v16 offset:0
    ds_read_b128 v[32:35], v16 offset:1024
    ds_read_b128 v[36:39], v16 offset:2048
    ds_read_b128 v[40:43], v16 offset:3072
    s_waitcnt lgkmcnt(3)
    v_smfmac_f32_16x16x64_bf16 v[68:71], v[28:31], a[0:7], v17
    ds_read_b128 v[44:47], v16 offset:4096
    v_smfmac_f32_16x16x64_bf16 v[72:75], v[28:31], a[80:87], v17
    ds_read_b128 v[48:51], v16 offset:5120
    s_waitcnt lgkmcnt(4)
    v_smfmac_f32_16x16x64_bf16 v[68:71], v[32:35], a[8:15], v17
    ds_read_b128 v[52:55], v16 offset:6144
    v_smfmac_f32_16x16x64_bf16 v[72:75], v[32:35], a[88:95], v17
    ds_read_b128 v[56:59], v16 offset:7168
    s_waitcnt lgkmcnt(5)
    v_smfmac_f32_16x16x64_bf16 v[68:71], v[36:39], a[16:23], v17
    ds_read_b128 v[60:63], v16 offset:8192
    v_smfmac_f32_16x16x64_bf16 v[72:75], v[36:39], a[96:103], v17
    ds_read_b128 v[64:67], v16 offset:9216
    s_waitcnt lgkmcnt(6)
    v_smfmac_f32_16x16x64_bf16 v[68:71], v[40:43], a[24:31], v17
    v_smfmac_f32_16x16x64_bf16 v[72:75], v[40:43], a[104:111], v17
    s_waitcnt lgkmcnt(5)
    v_smfmac_f32_16x16x64_bf16 v[68:71], v[44:47], a[32:39], v17
    v_smfmac_f32_16x16x64_bf16 v[72:75], v[44:47], a[112:119], v17
    s_waitcnt lgkmcnt(4)
    v_smfmac_f32_16x16x64_bf16 v[68:71], v[48:51], a[40:47], v17
    s_waitcnt lgkmcnt(3)
    v_smfmac_f32_16x16x64_bf16 v[68:71], v[52:55], a[48:55], v17
    s_waitcnt lgkmcnt(2)
    v_smfmac_f32_16x16x64_bf16 v[68:71], v[56:59], a[56:63], v17
    s_waitcnt lgkmcnt(1)
    v_smfmac_f32_16x16x64_bf16 v[68:71], v[60:63], a[64:71], v17
    s_waitcnt lgkmcnt(0)
    v_smfmac_f32_16x16x64_bf16 v[68:71], v[64:67], a[72:79], v17
L_redo_80:
    v_smfmac_f32_16x16x64_bf16 v[72:75], v[48:51], a[120:127], v17
    v_smfmac_f32_16x16x64_bf16 v[72:75], v[52:55], a[128:135], v17
    buffer_store_dword v20, v21, s[4:7], s38 offen offset:0 sc1
    v_smfmac_f32_16x16x64_bf16 v[72:75], v[56:59], a[136:143], v17
    v_add_f32 v68, v68, v70
    v_add_f32 v69, v69, v71
    v_smfmac_f32_16x16x64_bf16 v[72:75], v[60:63], a[144:151], v17
    v_cmp_u_f32 vcc, v68, v69
    v_cvt_pk_bf16_f32 v132, v68, v69
    v_smfmac_f32_16x16x64_bf16 v[72:75], v[64:67], a[152:159], v17
    s_cbranch_vccnz L_nan_82
L_cont_83:
    buffer_store_dword v132, v134, s[4:7], s41 offen offset:0 sc1
    s_nop 5
    v_pk_add_f32 v[72:73], v[72:73], v[74:75]
    v_cvt_pk_bf16_f32 v133, v72, v73
    buffer_store_dword v133, v134, s[4:7], s41 offen offset:1024 sc1
    buffer_store_dword v20, v21, s[4:7], s38 offen offset:32 sc1
    ds_read_b128 v[84:87], v11 offset:0
    ds_read_b128 v[88:91], v11 offset:2048
    ds_read_b128 v[92:95], v12 offset:0
    ds_read_b128 v[96:99], v12 offset:2048
    s_cmp_eq_u32 s37, 63
    s_cbranch_scc1 L_end_84
    s_cmp_lg_u32 s55, 0
    s_cbranch_scc1 L_an_85x
    buffer_load_dword v139, v142, s[4:7], s38 offen sc1
    buffer_load_dword v139, v142, s[4:7], s38 offen sc1
    buffer_load_dword v139, v142, s[4:7], s38 offen sc1
    buffer_load_dword v139, v142, s[4:7], s38 offen sc1
    buffer_load_dword v139, v142, s[4:7], s38 offen sc1
    buffer_load_dword v139, v142, s[4:7], s38 offen sc1
L_sp_86:
    s_waitcnt vmcnt(5)
    v_cmp_ge_u32 vcc, s37, v139
    buffer_load_dword v139, v142, s[4:7], s38 offen sc1
    s_sub_u32 s36, s36, 1
    s_cbranch_scc1 L_exit
    s_cbranch_vccz L_sp_86x
    s_waitcnt vmcnt(5)
    v_cmp_ge_u32 vcc, s37, v139
    buffer_load_dword v139, v142, s[4:7], s38 offen sc1
    s_cbranch_vccz L_sp_86x
    s_waitcnt vmcnt(5)
    v_cmp_ge_u32 vcc, s37, v139
    buffer_load_dword v139, v142, s[4:7], s38 offen sc1
    s_cbranch_vccz L_sp_86x
    s_waitcnt vmcnt(5)
    v_cmp_ge_u32 vcc, s37, v139
    buffer_load_dword v139, v142, s[4:7], s38 offen sc1
    s_cbranch_vccnz L_sp_86
L_sp_86x:
L_an_85x:
    s_barrier
    s_lshl_b32 s90, s32, 10
    s_add_u32 m0, s90, s47
    s_waitcnt lgkmcnt(2)
    v_mfma_f32_16x16x32_bf16 v[108:111], a[0:3], v[84:87], 0
    ds_read_b128 v[100:103], v11 offset:4096
    s_add_u32 s51, s37, 3
    v_mfma_f32_16x16x32_bf16 v[112:115], a[0:3], v[88:91], 0
    ds_read_b128 v[104:107], v11 offset:6144
    s_and_b32 s50, s51, 3
    v_mfma_f32_16x16x32_bf16 v[116:119], a[80:83], v[84:87], 0
    buffer_load_dwordx4 v[148:151], v146, s[4:7], s43 offen offset:0 sc1
    buffer_load_dwordx4 v[152:155], v146, s[4:7], s43 offen offset:1024 sc1
    v_mfma_f32_16x16x32_bf16 v[120:123], a[80:83], v[88:91], 0
    s_waitcnt lgkmcnt(2)
    s_mul_i32 s50, s50, 114688
    v_mfma_f32_16x16x32_bf16 v[108:111], a[4:7], v[92:95], v[108:111]
    ds_read_b128 v[84:87], v12 offset:4096
    s_add_u32 s50, s50, 65536
    v_mfma_f32_16x16x32_bf16 v[112:115], a[4:7], v[96:99], v[112:115]
    ds_read_b128 v[88:91], v12 offset:6144
    s_add_u32 s44, s38, s50
    v_mfma_f32_16x16x32_bf16 v[116:119], a[84:87], v[92:95], v[116:119]
    s_cmp_lt_i32 s60, 0
    s_cselect_b32 s54, s38, s54
    buffer_load_dwordx4 v[156:159], v144, s[4:7], s54 offen offset:0 sc1
    buffer_load_dwordx4 v[160:163], v144, s[4:7], s54 offen offset:1024 sc1
    v_mfma_f32_16x16x32_bf16 v[120:123], a[84:87], v[96:99], v[120:123]
    s_waitcnt lgkmcnt(2)
    s_add_u32 s45, s44, s56
    v_mfma_f32_16x16x32_bf16 v[108:111], a[8:11], v[100:103], v[108:111]
    ds_read_b128 v[92:95], v11 offset:8192
    s_add_u32 s37, s37, 1
    v_mfma_f32_16x16x32_bf16 v[112:115], a[8:11], v[104:107], v[112:115]
    ds_read_b128 v[96:99], v11 offset:10240
    s_mov_b32 s52, 0
    v_mfma_f32_16x16x32_bf16 v[116:119], a[88:91], v[100:103], v[116:119]
    s_and_b32 s50, s37, 3
    s_mul_i32 s51, s50, 114688
    v_mfma_f32_16x16x32_bf16 v[120:123], a[88:91], v[104:107], v[120:123]
    s_waitcnt lgkmcnt(2)
    s_add_u32 s41, s38, s51
    v_mfma_f32_16x16x32_bf16 v[108:111], a[12:15], v[84:87], v[108:111]
    ds_read_b128 v[100:103], v12 offset:8192
    v_mfma_f32_16x16x32_bf16 v[112:115], a[12:15], v[88:91], v[112:115]
    ds_read_b128 v[104:107], v12 offset:10240
    v_mfma_f32_16x16x32_bf16 v[116:119], a[92:95], v[84:87], v[116:119]
    buffer_load_dwordx4 v[248:251], v137, s[24:27], s57 offen offset:0
    buffer_load_dwordx4 v[248:251], v137, s[24:27], s57 offen offset:1024
    v_mfma_f32_16x16x32_bf16 v[120:123], a[92:95], v[88:91], v[120:123]
    s_waitcnt lgkmcnt(2)
    v_mfma_f32_16x16x32_bf16 v[108:111], a[16:19], v[92:95], v[108:111]
    ds_read_b128 v[84:87], v11 offset:12288
    v_mfma_f32_16x16x32_bf16 v[112:115], a[16:19], v[96:99], v[112:115]
    ds_read_b128 v[88:91], v11 offset:14336
    v_mfma_f32_16x16x32_bf16 v[116:119], a[96:99], v[92:95], v[116:119]
    buffer_store_dword v20, v140, s[4:7], 0 offen sc1
    v_mfma_f32_16x16x32_bf16 v[120:123], a[96:99], v[96:99], v[120:123]
    s_waitcnt lgkmcnt(2)
    v_mfma_f32_16x16x32_bf16 v[108:111], a[20:23], v[100:103], v[108:111]
    ds_read_b128 v[92:95], v12 offset:12288
    v_mfma_f32_16x16x32_bf16 v[112:115], a[20:23], v[104:107], v[112:115]
    ds_read_b128 v[96:99], v12 offset:14336
    v_mfma_f32_16x16x32_bf16 v[116:119], a[100:103], v[100:103], v[116:119]
    s_waitcnt vmcnt(4)
    s_cmp_lt_i32 s60, -245760
    s_cbranch_scc1 L_fw_87c
L_fw_87:
    buffer_store_dwordx4 v[148:151], v143, s[4:7], s53 offen offset:0 sc1
    buffer_store_dwordx4 v[152:155], v143, s[4:7], s53 offen offset:1024 sc1
    v_mfma_f32_16x16x32_bf16 v[120:123], a[100:103], v[104:107], v[120:123]
    s_waitcnt lgkmcnt(2)
    v_mfma_f32_16x16x32_bf16 v[108:111], a[24:27], v[84:87], v[108:111]
    buffer_store_dword v20, v141, s[4:7], 0 offen sc1
    ds_read_b128 v[100:103], v11 offset:16384
    v_mfma_f32_16x16x32_bf16 v[112:115], a[24:27], v[88:91], v[112:115]
    ds_read_b128 v[104:107], v11 offset:18432
    v_mfma_f32_16x16x32_bf16 v[116:119], a[104:107], v[84:87], v[116:119]
    v_mfma_f32_16x16x32_bf16 v[120:123], a[104:107], v[88:91], v[120:123]
    s_waitcnt lgkmcnt(2)
    v_mfma_f32_16x16x32_bf16 v[108:111], a[28:31], v[92:95], v[108:111]
    ds_read_b128 v[84:87], v12 offset:16384
    v_mfma_f32_16x16x32_bf16 v[112:115], a[28:31], v[96:99], v[112:115]
    ds_read_b128 v[88:91], v12 offset:18432
    v_mfma_f32_16x16x32_bf16 v[116:119], a[108:111], v[92:95], v[116:119]
    buffer_store_dword v22, v135, s[4:7], s42 offen offset:0 sc1
    buffer_store_dword v22, v135, s[4:7], s42 offen offset:1024 sc1
    v_mfma_f32_16x16x32_bf16 v[120:123], a[108:111], v[96:99], v[120:123]
    s_waitcnt lgkmcnt(2)
    v_mfma_f32_16x16x32_bf16 v[108:111], a[32:35], v[100:103], v[108:111]
    ds_read_b128 v[92:95], v11 offset:20480
    v_mfma_f32_16x16x32_bf16 v[112:115], a[32:35], v[104:107], v[112:115]
    ds_read_b128 v[96:99], v11 offset:22528
    v_mfma_f32_16x16x32_bf16 v[116:119], a[112:115], v[100:103], v[116:119]
    buffer_load_dwordx4 v10, s[24:27], s46 offen offset:0 lds
    s_add_u32 m0, m0, 3968
    v_mfma_f32_16x16x32_bf16 v[120:123], a[112:115], v[104:107], v[120:123]
    s_waitcnt lgkmcnt(2)
    v_mfma_f32_16x16x32_bf16 v[108:111], a[36:39], v[84:87], v[108:111]
    ds_read_b128 v[100:103], v12 offset:20480
    v_mfma_f32_16x16x32_bf16 v[112:115], a[36:39], v[88:91], v[112:115]
    ds_read_b128 v[104:107], v12 offset:22528
    v_mfma_f32_16x16x32_bf16 v[116:119], a[116:119], v[84:87], v[116:119]
    buffer_load_dwordx4 v10, s[24:27], s46 offen offset:128 lds
    s_add_u32 m0, m0, 3968
    v_mfma_f32_16x16x32_bf16 v[120:123], a[116:119], v[88:91], v[120:123]
    s_waitcnt lgkmcnt(2)
    v_mfma_f32_16x16x32_bf16 v[108:111], a[40:43], v[92:95], v[108:111]
    ds_read_b128 v[84:87], v11 offset:24576
    v_mfma_f32_16x16x32_bf16 v[112:115], a[40:43], v[96:99], v[112:115]
    ds_read_b128 v[88:91], v11 offset:26624
    v_mfma_f32_16x16x32_bf16 v[116:119], a[120:123], v[92:95], v[116:119]
    buffer_load_dwordx4 v10, s[24:27], s46 offen offset:256 lds
    s_add_u32 m0, m0, 3968
    v_mfma_f32_16x16x32_bf16 v[120:123], a[120:123], v[96:99], v[120:123]
    s_waitcnt lgkmcnt(2)
    v_mfma_f32_16x16x32_bf16 v[108:111], a[44:47], v[100:103], v[108:111]
    ds_read_b128 v[92:95], v12 offset:24576
    v_mfma_f32_16x16x32_bf16 v[112:115], a[44:47], v[104:107], v[112:115]
    ds_read_b128 v[96:99], v12 offset:26624
    v_mfma_f32_16x16x32_bf16 v[116:119], a[124:127], v[100:103], v[116:119]
    buffer_load_dwordx4 v10, s[24:27], s46 offen offset:384 lds
    s_add_u32 m0, m0, 3968
    v_mfma_f32_16x16x32_bf16 v[120:123], a[124:127], v[104:107], v[120:123]
    s_waitcnt lgkmcnt(2)
    v_mfma_f32_16x16x32_bf16 v[108:111], a[48:51], v[84:87], v[108:111]
    ds_read_b128 v[100:103], v11 offset:28672
    v_mfma_f32_16x16x32_bf16 v[112:115], a[48:51], v[88:91], v[112:115]
    ds_read_b128 v[104:107], v11 offset:30720
    v_mfma_f32_16x16x32_bf16 v[116:119], a[128:131], v[84:87], v[116:119]
    buffer_load_dwordx4 v10, s[24:27], s46 offen offset:512 lds
    s_add_u32 m0, m0, 3968
    v_mfma_f32_16x16x32_bf16 v[120:123], a[128:131], v[88:91], v[120:123]
    s_waitcnt lgkmcnt(2)
    v_mfma_f32_16x16x32_bf16 v[108:111], a[52:55], v[92:95], v[108:111]
    ds_read_b128 v[84:87], v12 offset:28672
    v_mfma_f32_16x16x32_bf16 v[112:115], a[52:55], v[96:99], v[112:115]
    ds_read_b128 v[88:91], v12 offset:30720
    v_mfma_f32_16x16x32_bf16 v[116:119], a[132:135], v[92:95], v[116:119]
    buffer_load_dwordx4 v10, s[24:27], s46 offen offset:640 lds
    s_add_u32 m0, m0, 3968
    v_mfma_f32_16x16x32_bf16 v[120:123], a[132:135], v[96:99], v[120:123]
    s_waitcnt lgkmcnt(2)
    v_mfma_f32_16x16x32_bf16 v[108:111], a[56:59], v[100:103], v[108:111]
    ds_read_b128 v[92:95], v11 offset:32768
    v_mfma_f32_16x16x32_bf16 v[112:115], a[56:59], v[104:107], v[112:115]
    ds_read_b128 v[96:99], v11 offset:34816
    v_mfma_f32_16x16x32_bf16 v[116:119], a[136:139], v[100:103], v[116:119]
    buffer_load_dwordx4 v10, s[24:27], s46 offen offset:768 lds
    s_add_u32 m0, m0, 3968
    v_mfma_f32_16x16x32_bf16 v[120:123], a[136:139], v[104:107], v[120:123]
    s_waitcnt lgkmcnt(2)
    v_mfma_f32_16x16x32_bf16 v[108:111], a[60:63], v[84:87], v[108:111]
    ds_read_b128 v[100:103], v12 offset:32768
    v_mfma_f32_16x16x32_bf16 v[112:115], a[60:63], v[88:91], v[112:115]
    ds_read_b128 v[104:107], v12 offset:34816
    v_mfma_f32_16x16x32_bf16 v[116:119], a[140:143], v[84:87], v[116:119]
    buffer_load_dwordx4 v10, s[24:27], s46 offen offset:896 lds
    s_add_u32 m0, m0, 3968
    v_mfma_f32_16x16x32_bf16 v[120:123], a[140:143], v[88:91], v[120:123]
    s_waitcnt lgkmcnt(2)
    v_mfma_f32_16x16x32_bf16 v[108:111], a[64:67], v[92:95], v[108:111]
    ds_read_b128 v[84:87], v11 offset:36864
    v_mfma_f32_16x16x32_bf16 v[112:115], a[64:67], v[96:99], v[112:115]
    ds_read_b128 v[88:91], v11 offset:38912
    v_mfma_f32_16x16x32_bf16 v[116:119], a[144:147], v[92:95], v[116:119]
    buffer_load_dwordx4 v10, s[24:27], s46 offen offset:1024 lds
    s_add_u32 m0, m0, 3968
    v_mfma_f32_16x16x32_bf16 v[120:123], a[144:147], v[96:99], v[120:123]
    s_waitcnt lgkmcnt(2)
    v_mfma_f32_16x16x32_bf16 v[108:111], a[68:71], v[100:103], v[108:111]
    ds_read_b128 v[92:95], v12 offset:36864
    v_mfma_f32_16x16x32_bf16 v[112:115], a[68:71], v[104:107], v[112:115]
    ds_read_b128 v[96:99], v12 offset:38912
    v_mfma_f32_16x16x32_bf16 v[116:119], a[148:151], v[100:103], v[116:119]
    buffer_load_dwordx4 v10, s[24:27], s46 offen offset:1152 lds
    v_mfma_f32_16x16x32_bf16 v[120:123], a[148:151], v[104:107], v[120:123]
    s_waitcnt lgkmcnt(0)
    v_mfma_f32_16x16x32_bf16 v[108:111], a[72:75], v[84:87], v[108:111]
    v_add_u32 v11, s49, v11
    v_mfma_f32_16x16x32_bf16 v[112:115], a[72:75], v[88:91], v[112:115]
    v_add_u32 v12, s49, v12
    v_mfma_f32_16x16x32_bf16 v[108:111], a[76:79], v[92:95], v[108:111]
    s_sub_u32 s47, s47, s49
    v_mfma_f32_16x16x32_bf16 v[112:115], a[76:79], v[96:99], v[112:115]
    s_sub_u32 s49, 0, s49
    v_mfma_f32_16x16x32_bf16 v[116:119], a[152:155], v[84:87], v[116:119]
    v_mfma_f32_16x16x32_bf16 v[120:123], a[152:155], v[88:91], v[120:123]
    v_mfma_f32_16x16x32_bf16 v[116:119], a[156:159], v[92:95], v[116:119]
    v_mfma_f32_16x16x32_bf16 v[120:123], a[156:159], v[96:99], v[120:123]
    v_cvt_pk_bf16_f32 v124, v108, v109
    v_cvt_pk_bf16_f32 v125, v110, v111
    v_cvt_pk_bf16_f32 v126, v112, v113
    v_cvt_pk_bf16_f32 v127, v114, v115
    s_nop 0
    v_permlane16_swap_b32 v124, v126
    v_permlane16_swap_b32 v125, v127
    v_cvt_pk_bf16_f32 v128, v116, v117
    v_cvt_pk_bf16_f32 v129, v118, v119
    v_cvt_pk_bf16_f32 v130, v120, v121
    v_cvt_pk_bf16_f32 v131, v122, v123
    s_nop 0
    v_permlane16_swap_b32 v128, v130
    v_permlane16_swap_b32 v129, v131
    buffer_store_dwordx4 v[124:127], v19, s[4:7], s44 offen sc1
    buffer_store_dwordx4 v[128:131], v19, s[4:7], s45 offen sc1
    s_waitcnt vmcnt(18)
    s_cmp_lt_i32 s60, 0
    s_cbranch_scc1 L_fin_88
    v_mfma_f32_16x16x32_bf16 v[164:167], a[160:163], v[156:159], 0
    v_mfma_f32_16x16x32_bf16 v[168:171], a[160:163], v[160:163], 0
    s_nop 4
    v_cndmask_b32 v166, v164, v165, s[58:59]
    s_nop 1
    v_cndmask_b32 v170, v168, v169, s[58:59]
    v_cndmask_b32 v167, v165, v164, s[58:59]
    v_cndmask_b32 v171, v169, v168, s[58:59]
    s_nop 0
    v_add_f32_dpp v167, v166, v167 row_ror:8 row_mask:0xf bank_mask:0xf
    v_add_f32_dpp v171, v170, v171 row_ror:8 row_mask:0xf bank_mask:0xf
    v_cvt_pk_bf16_f32 v167, v167, v167
    v_cvt_pk_bf16_f32 v171, v171, v171
    buffer_store_short v167, v145, s[28:31], s60 offen offset:0
    buffer_store_short v171, v145, s[28:31], s60 offen offset:32
L_fin_88:
    s_branch L_v_loop_s
L_end_84:
    s_cmp_lt_i32 s60, 0
    s_cselect_b32 s54, s38, s54
    buffer_load_dwordx4 v[156:159], v144, s[4:7], s54 offen offset:0 sc1
    buffer_load_dwordx4 v[160:163], v144, s[4:7], s54 offen offset:1024 sc1
    s_waitcnt vmcnt(0) lgkmcnt(0)
    s_cmp_lt_i32 s60, 0
    s_cbranch_scc1 L_fin_89
    v_mfma_f32_16x16x32_bf16 v[164:167], a[160:163], v[156:159], 0
    v_mfma_f32_16x16x32_bf16 v[168:171], a[160:163], v[160:163], 0
    s_nop 4
    v_cndmask_b32 v166, v164, v165, s[58:59]
    s_nop 1
    v_cndmask_b32 v170, v168, v169, s[58:59]
    v_cndmask_b32 v167, v165, v164, s[58:59]
    v_cndmask_b32 v171, v169, v168, s[58:59]
    s_nop 0
    v_add_f32_dpp v167, v166, v167 row_ror:8 row_mask:0xf bank_mask:0xf
    v_add_f32_dpp v171, v170, v171 row_ror:8 row_mask:0xf bank_mask:0xf
    v_cvt_pk_bf16_f32 v167, v167, v167
    v_cvt_pk_bf16_f32 v171, v171, v171
    buffer_store_short v167, v145, s[28:31], s60 offen offset:0
    buffer_store_short v171, v145, s[28:31], s60 offen offset:32
L_fin_89:
    s_waitcnt vmcnt(0)
    s_cmp_lg_u32 s55, 0
    s_cbranch_scc1 L_wb_90
    buffer_wbl2 sc1
    s_waitcnt vmcnt(0)
L_wb_90:
    s_endpgm
L_nan_82:
    s_cmp_eq_u32 s52, 1
    s_cbranch_scc1 L_cont_83
    v_lshlrev_b32 v1, 4, v0
L_nan_82r:
    s_mov_b32 s90, s41
    v_mov_b32 v2, 0
    buffer_load_dwordx4 v[28:31], v1, s[4:7], s90 offen sc1
    s_add_u32 s90, s90, 1024
    buffer_load_dwordx4 v[32:35], v1, s[4:7], s90 offen sc1
    s_add_u32 s90, s90, 1024
    buffer_load_dwordx4 v[36:39], v1, s[4:7], s90 offen sc1
    s_add_u32 s90, s90, 1024
    buffer_load_dwordx4 v[40:43], v1, s[4:7], s90 offen sc1
    s_add_u32 s90, s90, 1024
    buffer_load_dwordx4 v[44:47], v1, s[4:7], s90 offen sc1
    s_add_u32 s90, s90, 1024
    buffer_load_dwordx4 v[48:51], v1, s[4:7], s90 offen sc1
    s_add_u32 s90, s90, 1024
    buffer_load_dwordx4 v[52:55], v1, s[4:7], s90 offen sc1
    s_add_u32 s90, s90, 1024
    buffer_load_dwordx4 v[56:59], v1, s[4:7], s90 offen sc1
    s_add_u32 s90, s90, 1024
    buffer_load_dwordx4 v[60:63], v1, s[4:7], s90 offen sc1
    s_add_u32 s90, s90, 1024
    buffer_load_dwordx4 v[64:67], v1, s[4:7], s90 offen sc1
    s_add_u32 s90, s90, 1024
    s_sub_u32 s36, s36, 1
    s_cbranch_scc1 L_exit
    s_waitcnt vmcnt(0) lgkmcnt(0)
    v_max3_u32 v2, v2, v28, v29
    v_max3_u32 v2, v2, v30, v31
    v_max3_u32 v2, v2, v32, v33
    v_max3_u32 v2, v2, v34, v35
    v_max3_u32 v2, v2, v36, v37
    v_max3_u32 v2, v2, v38, v39
    v_max3_u32 v2, v2, v40, v41
    v_max3_u32 v2, v2, v42, v43
    v_max3_u32 v2, v2, v44, v45
    v_max3_u32 v2, v2, v46, v47
    v_max3_u32 v2, v2, v48, v49
    v_max3_u32 v2, v2, v50, v51
    v_max3_u32 v2, v2, v52, v53
    v_max3_u32 v2, v2, v54, v55
    v_max3_u32 v2, v2, v56, v57
    v_max3_u32 v2, v2, v58, v59
    v_max3_u32 v2, v2, v60, v61
    v_max3_u32 v2, v2, v62, v63
    v_max3_u32 v2, v2, v64, v65
    v_max3_u32 v2, v2, v66, v67
    v_cmp_eq_u32 vcc, -1, v2
    s_cbranch_vccnz L_nan_82r
    s_mov_b32 s52, 1
    v_mov_b32 v68, 0
    v_mov_b32 v69, 0
    v_mov_b32 v70, 0
    v_mov_b32 v71, 0
    v_mov_b32 v72, 0
    v_mov_b32 v73, 0
    v_mov_b32 v74, 0
    v_mov_b32 v75, 0
    v_smfmac_f32_16x16x64_bf16 v[68:71], v[28:31], a[0:7], v17
    s_nop 0
    v_smfmac_f32_16x16x64_bf16 v[72:75], v[28:31], a[80:87], v17
    v_smfmac_f32_16x16x64_bf16 v[68:71], v[32:35], a[8:15], v17
    v_smfmac_f32_16x16x64_bf16 v[72:75], v[32:35], a[88:95], v17
    v_smfmac_f32_16x16x64_bf16 v[68:71], v[36:39], a[16:23], v17
    v_smfmac_f32_16x16x64_bf16 v[72:75], v[36:39], a[96:103], v17
    v_smfmac_f32_16x16x64_bf16 v[68:71], v[40:43], a[24:31], v17
    v_smfmac_f32_16x16x64_bf16 v[72:75], v[40:43], a[104:111], v17
    v_smfmac_f32_16x16x64_bf16 v[68:71], v[44:47], a[32:39], v17
    v_smfmac_f32_16x16x64_bf16 v[72:75], v[44:47], a[112:119], v17
    v_smfmac_f32_16x16x64_bf16 v[68:71], v[48:51], a[40:47], v17
    v_smfmac_f32_16x16x64_bf16 v[68:71], v[52:55], a[48:55], v17
    v_smfmac_f32_16x16x64_bf16 v[68:71], v[56:59], a[56:63], v17
    v_smfmac_f32_16x16x64_bf16 v[68:71], v[60:63], a[64:71], v17
    v_smfmac_f32_16x16x64_bf16 v[68:71], v[64:67], a[72:79], v17
    s_nop 2
    s_branch L_redo_80
L_wo_s:
    s_mov_b32 s12, s80
    s_and_b32 s13, s81, 0xffff
    s_mov_b32 s14, 7864320
    s_mov_b32 s15, 0x20000
    s_mov_b32 s16, s72
    s_and_b32 s17, s73, 0xffff
    s_mov_b32 s18, 10240
    s_mov_b32 s19, 0x20000
    s_sub_u32 s40, s35, 18
    v_and_b32 v1, 15, v0
    v_lshrrev_b32 v2, 4, v0
    v_lshrrev_b32 v3, 3, v0
    v_and_b32 v4, 7, v0
    v_and_b32 v6, 2, v3
    v_xor_b32 v6, v6, v4
    v_lshlrev_b32 v6, 4, v6
    v_mul_u32_u24 v7, 1280, v3
    s_lshl_b32 s90, s34, 2
    s_add_u32 s90, s90, s32
    s_mul_i32 s90, s90, 245760
    s_lshl_b32 s91, s40, 7
    s_add_u32 s90, s90, s91
    v_add3_u32 v180, v6, v7, s90
    v_xor_b32 v181, 64, v180
    s_mul_i32 s90, s40, 32768
    s_lshl_b32 s91, s32, 11
    s_add_u32 s90, s90, s91
    s_lshr_b32 s91, s32, 1
    s_mul_i32 s91, s91, 0
    s_xor_b32 s91, s91, s34
    v_mul_u32_u24 v7, 0, v2
    v_xor_b32 v7, s91, v7
    v_lshlrev_b32 v6, 4, v1
    v_lshl_add_u32 v7, v7, 8, v6
    v_lshl_add_u32 v7, v2, 13, v7
    v_add_u32 v14, s90, v7
    v_lshlrev_b32 v12, 4, v0
    v_lshlrev_b32 v13, 2, v0
    v_add_u32 v46, s90, v13
    s_xor_b32 s92, s91, 0
    s_lshl_b32 s92, s92, 8
    s_add_u32 s60, s92, 0
    s_xor_b32 s92, s91, 0
    s_lshl_b32 s92, s92, 8
    s_add_u32 s61, s92, 8192
    s_xor_b32 s92, s91, 0
    s_lshl_b32 s92, s92, 8
    s_add_u32 s62, s92, 16384
    s_xor_b32 s92, s91, 0
    s_lshl_b32 s92, s92, 8
    s_add_u32 s63, s92, 24576
    v_cmp_gt_u32 vcc, 2, v2
    v_mov_b32 v9, 2146435072
    s_nop 0
    v_cndmask_b32 v14, v9, v14, vcc
    s_lshl_b32 s92, s40, 7
    s_lshl_b32 s93, s32, 2
    s_add_u32 s92, s92, s93
    s_add_u32 s92, s92, 460800
    v_mov_b32 v244, s92
    v_cmp_eq_u32 vcc, 0, v0
    v_mov_b32 v9, 2146435072
    s_nop 0
    v_cndmask_b32 v244, v9, v244, vcc
    s_lshl_b32 s92, s32, 7
    s_add_u32 s92, s92, 462336
    v_min_u32 v3, 5, v0
    v_lshl_add_u32 v245, v3, 2, s92
    s_lshl_b32 s90, s40, 2
    s_add_u32 s90, s90, s32
    s_lshl_b32 s91, s90, 8
    v_add_u32 v17, s91, v6
    v_cmp_eq_u32 vcc, 0, v2
    v_mov_b32 v9, 2146435072
    s_nop 0
    v_cndmask_b32 v17, v9, v17, vcc
    v_lshrrev_b32 v3, 2, v1
    v_and_b32 v7, 1, v1
    v_lshl_or_b32 v4, v3, 1, v7
    v_mul_u32_u24 v4, 1280, v4
    v_and_b32 v5, 2, v1
    v_lshl_add_u32 v4, v5, 1, v4
    s_lshl_b32 s91, s90, 5
    v_add_u32 v4, s91, v4
    v_lshlrev_b32 v6, 6, v3
    v_lshl_add_u32 v6, v7, 5, v6
    v_lshl_add_u32 v6, v2, 3, v6
    v_lshl_add_u32 v6, v5, 1, v6
    s_mul_i32 s92, s32, 1152
    s_add_u32 s92, s92, 122880
    v_add_u32 v18, s92, v6
    buffer_load_dword v164, v4, s[16:19], 0 offen offset:0
    buffer_load_dword v165, v4, s[16:19], 0 offen offset:8
    buffer_load_dword v166, v4, s[16:19], 0 offen offset:16
    buffer_load_dword v167, v4, s[16:19], 0 offen offset:24
    v_mov_b32 v168, -1
    v_mov_b32 v169, -1
    v_mov_b32 v170, -1
    v_mov_b32 v171, -1
    s_mul_i32 s90, s32, 24576
    s_mov_b32 m0, s90
    s_mov_b32 s91, 0
    buffer_load_dwordx4 v180, s[12:15], s91 offen nt lds
    s_add_u32 m0, m0, 1024
    s_add_u32 s91, s91, 10240
    buffer_load_dwordx4 v181, s[12:15], s91 offen nt lds
    s_add_u32 m0, m0, 1024
    s_add_u32 s91, s91, 10240
    buffer_load_dwordx4 v180, s[12:15], s91 offen nt lds
    s_add_u32 m0, m0, 1024
    s_add_u32 s91, s91, 10240
    buffer_load_dwordx4 v181, s[12:15], s91 offen nt lds
    s_add_u32 m0, m0, 1024
    s_add_u32 s91, s91, 10240
    buffer_load_dwordx4 v180, s[12:15], s91 offen nt lds
    s_add_u32 m0, m0, 1024
    s_add_u32 s91, s91, 10240
    buffer_load_dwordx4 v181, s[12:15], s91 offen nt lds
    s_add_u32 m0, m0, 1024
    s_add_u32 s91, s91, 10240
    buffer_load_dwordx4 v180, s[12:15], s91 offen nt lds
    s_add_u32 m0, m0, 1024
    s_add_u32 s91, s91, 10240
    buffer_load_dwordx4 v181, s[12:15], s91 offen nt lds
    s_add_u32 m0, m0, 1024
    s_add_u32 s91, s91, 10240
    buffer_load_dwordx4 v180, s[12:15], s91 offen nt lds
    s_add_u32 m0, m0, 1024
    s_add_u32 s91, s91, 10240
    buffer_load_dwordx4 v181, s[12:15], s91 offen nt lds
    s_add_u32 m0, m0, 1024
    s_add_u32 s91, s91, 10240
    buffer_load_dwordx4 v180, s[12:15], s91 offen nt lds
    s_add_u32 m0, m0, 1024
    s_add_u32 s91, s91, 10240
    buffer_load_dwordx4 v181, s[12:15], s91 offen nt lds
    s_add_u32 m0, m0, 1024
    s_add_u32 s91, s91, 10240
    buffer_load_dwordx4 v180, s[12:15], s91 offen nt lds
    s_add_u32 m0, m0, 1024
    s_add_u32 s91, s91, 10240
    buffer_load_dwordx4 v181, s[12:15], s91 offen nt lds
    s_add_u32 m0, m0, 1024
    s_add_u32 s91, s91, 10240
    buffer_load_dwordx4 v180, s[12:15], s91 offen nt lds
    s_add_u32 m0, m0, 1024
    s_add_u32 s91, s91, 10240
    buffer_load_dwordx4 v181, s[12:15], s91 offen nt lds
    s_add_u32 m0, m0, 1024
    s_add_u32 s91, s91, 10240
    buffer_load_dwordx4 v180, s[12:15], s91 offen nt lds
    s_add_u32 m0, m0, 1024
    s_add_u32 s91, s91, 10240
    buffer_load_dwordx4 v181, s[12:15], s91 offen nt lds
    s_add_u32 m0, m0, 1024
    s_add_u32 s91, s91, 10240
    buffer_load_dwordx4 v180, s[12:15], s91 offen nt lds
    s_add_u32 m0, m0, 1024
    s_add_u32 s91, s91, 10240
    buffer_load_dwordx4 v181, s[12:15], s91 offen nt lds
    s_add_u32 m0, m0, 1024
    s_add_u32 s91, s91, 10240
    buffer_load_dwordx4 v180, s[12:15], s91 offen nt lds
    s_add_u32 m0, m0, 1024
    s_add_u32 s91, s91, 10240
    buffer_load_dwordx4 v181, s[12:15], s91 offen nt lds
    s_add_u32 m0, m0, 1024
    s_add_u32 s91, s91, 10240
    buffer_load_dwordx4 v180, s[12:15], s91 offen nt lds
    s_add_u32 m0, m0, 1024
    s_add_u32 s91, s91, 10240
    buffer_load_dwordx4 v181, s[12:15], s91 offen nt lds
    s_waitcnt vmcnt(24)
    v_min_u32 v164, -2, v164
    v_min_u32 v165, -2, v165
    v_min_u32 v166, -2, v166
    v_min_u32 v167, -2, v167
    v_and_b32 v7, 2, v1
    v_cmp_ne_u32 vcc, 0, v7
    v_mov_b32 v5, 0x4444
    v_mov_b32 v6, 0xeeee
    v_cndmask_b32 v10, v5, v6, vcc
    v_mov_b32 v5, 0xe484
    v_mov_b32 v6, 0xee9e
    v_cndmask_b32 v7, v5, v6, vcc
    v_mov_b32 v5, 0x84e4
    v_mov_b32 v6, 0x9eee
    v_cndmask_b32 v8, v5, v6, vcc
    v_cmp_gt_u32 vcc, 2, v2
    s_nop 1
    v_cndmask_b32 v11, v8, v7, vcc
    v_mov_b32 v84, 1065369472
    v_mov_b32 v85, 1065369472
    v_mov_b32 v86, 1065369472
    v_mov_b32 v87, 0
    v_mov_b32 v88, 1065369472
    v_mov_b32 v89, 1065369472
    v_mov_b32 v90, 1065369472
    v_mov_b32 v91, 0
    v_mov_b32 v51, 0
    v_mov_b32 v55, 0
    v_mov_b32 v59, 0
    v_mov_b32 v63, 0
    v_mov_b32 v67, 0
    v_mov_b32 v71, 0
    v_mov_b32 v75, 0
    v_mov_b32 v79, 0
    v_mov_b32 v210, 0
    v_mov_b32 v211, 0
    v_mov_b32 v218, 0
    v_mov_b32 v219, 0
    v_and_b32 v7, 1, v1
    v_cmp_ne_u32 vcc, 0, v7
    v_mov_b32 v5, 0x3f80
    v_mov_b32 v6, 0x3f800000
    v_cndmask_b32 v5, v5, v6, vcc
    v_bfe_u32 v6, v1, 1, 1
    v_cmp_eq_u32 vcc, 0, v6
    s_nop 1
    v_cndmask_b32 v110, 0, v5, vcc
    v_mov_b32 v108, 0
    v_mov_b32 v112, 0
    v_cmp_eq_u32 vcc, 1, v6
    s_nop 1
    v_cndmask_b32 v111, 0, v5, vcc
    v_mov_b32 v109, 0
    v_mov_b32 v113, 0
    v_mov_b32 v240, 0x3dd53b95
    v_mov_b32 v241, 0x3dd53b95
    s_lshl_b32 s90, s32, 8
    s_add_u32 s90, s90, 122880
    v_mul_u32_u24 v6, 1152, v2
    v_lshl_add_u32 v6, v1, 3, v6
    v_add_u32 v19, s90, v6
    s_mul_i32 s90, s32, 1536
    v_add_u32 v20, s90, v12
    s_add_u32 s90, s90, 1024
    v_lshl_add_u32 v21, v0, 3, s90
    s_mul_i32 s90, s32, 6144
    v_add_u32 v22, s90, v12
    s_add_u32 s90, s90, 1024
    v_lshl_add_u32 v23, v0, 3, s90
    v_add_u32 v28, 98304, v12
    s_mul_i32 s90, s32, 3072
    v_add_u32 v37, s90, v12
    v_add_u32 v44, 25600, v37
    s_add_u32 s54, s90, 98304
    s_mul_i32 s90, s32, 3840
    s_add_u32 s90, s90, 10240
    v_add_u32 v38, s90, v12
    s_add_u32 s90, s90, 1024
    v_add_u32 v39, s90, v13
    s_mul_i32 s90, s32, 12288
    v_add_u32 v40, s90, v12
    s_lshl_b32 s93, s40, 2
    s_add_u32 s93, s93, s32
    s_nop 0
    s_lshr_b32 s90, s93, 2
    s_lshl_b32 s90, s90, 15
    s_and_b32 s92, s93, 3
    s_lshl_b32 s92, s92, 10
    s_add_u32 s90, s90, s92
    v_mov_b32 v5, s34
    v_and_b32 v6, 7, v1
    v_lshlrev_b32 v6, 4, v6
    v_lshl_add_u32 v6, v5, 7, v6
    v_lshrrev_b32 v7, 3, v1
    v_lshl_add_u32 v6, v7, 12, v6
    v_lshrrev_b32 v5, 1, v2
    v_lshl_add_u32 v6, v5, 13, v6
    v_and_b32 v5, 1, v2
    v_lshl_add_u32 v6, v5, 14, v6
    v_add_u32 v30, s90, v6
    s_and_b32 s91, s34, 1
    s_lshl_b32 s91, s91, 12
    s_add_u32 s90, s90, s91
    s_lshr_b32 s91, s34, 2
    s_lshl_b32 s91, s91, 13
    s_add_u32 s90, s90, s91
    s_and_b32 s91, s34, 2
    s_lshl_b32 s91, s91, 13
    s_add_u32 s90, s90, s91
    v_lshl_add_u32 v31, v0, 4, s90
    s_lshl_b32 s91, s93, 10
    s_add_u32 s91, s91, 884736
    v_lshl_add_u32 v15, v0, 4, s91
    s_lshr_b32 s91, s34, 1
    s_mul_i32 s91, s91, 10240
    s_lshl_b32 s92, s93, 5
    s_add_u32 s91, s91, s92
    s_and_b32 s92, s34, 1
    s_mul_i32 s92, s92, 40960
    s_add_u32 s91, s91, s92
    s_add_u32 s91, s91, 1280
    v_mul_u32_u24 v6, 2560, v2
    v_lshl_add_u32 v6, v1, 1, v6
    v_add_u32 v32, s91, v6
    v_cmp_gt_u32 s[58:59], 8, v1
    v_and_b32 v5, 1, v1
    v_lshrrev_b32 v6, 3, v1
    v_lshl_add_u32 v5, v5, 1, v6
    v_bfe_u32 v6, v1, 2, 1
    v_cmp_ne_u32 vcc, 0, v6
    v_mov_b32 v6, 0x3f80
    v_mov_b32 v7, 0x3f800000
    v_cndmask_b32 v6, v6, v7, vcc
    v_cmp_eq_u32 vcc, 0, v5
    s_nop 1
    v_cndmask_b32 v7, 0, v6, vcc
    v_accvgpr_write_b32 a144, v7
    v_cmp_eq_u32 vcc, 1, v5
    s_nop 1
    v_cndmask_b32 v7, 0, v6, vcc
    v_accvgpr_write_b32 a145, v7
    v_cmp_eq_u32 vcc, 2, v5
    s_nop 1
    v_cndmask_b32 v7, 0, v6, vcc
    v_accvgpr_write_b32 a146, v7
    v_cmp_eq_u32 vcc, 3, v5
    s_nop 1
    v_cndmask_b32 v7, 0, v6, vcc
    v_accvgpr_write_b32 a147, v7
    s_lshl_b32 s90, s32, 7
    v_add_u32 v5, s90, v13
    v_add_u32 v6, 458752, v5
    v_add_u32 v7, 459728, v5
    v_cmp_gt_u32 vcc, 12, v0
    s_nop 1
    v_cndmask_b32 v33, v7, v6, vcc
    v_mov_b32 v5, -2
    v_cndmask_b32 v34, v5, 3, vcc
    v_cmp_gt_u32 vcc, 14, v0
    v_mov_b32 v9, 2146435072
    s_nop 0
    v_cndmask_b32 v33, v9, v33, vcc
    v_mov_b32 v5, -1000
    v_cndmask_b32 v34, v5, v34, vcc
    v_and_b32 v4, 3, v1
    v_lshlrev_b32 v6, 6, v4
    v_lshl_add_u32 v6, v3, 3, v6
    v_lshl_add_u32 v6, v2, 8, v6
    v_and_b32 v5, 1, v2
    v_lshl_add_u32 v6, v5, 5, v6
    s_mul_i32 s90, s32, 3072
    s_add_u32 s53, s90, 131072
    v_add_u32 v16, s53, v6
    v_xor_b32 v13, 32, v16
    v_and_b32 v4, 3, v1
    v_and_b32 v5, 1, v2
    v_lshl_add_u32 v6, v2, 3, v3
    v_lshlrev_b32 v6, 7, v6
    v_and_b32 v7, 2, v3
    v_lshl_or_b32 v7, v5, 2, v7
    v_lshrrev_b32 v8, 1, v4
    v_xor_b32 v7, v7, v8
    v_lshl_add_u32 v6, v7, 4, v6
    v_and_b32 v7, 1, v4
    v_lshl_add_u32 v6, v7, 3, v6
    s_mul_i32 s90, s32, 24576
    v_add_u32 v6, s90, v6
    v_xor_b32 v182, 0, v6
    v_xor_b32 v183, 32, v6
    v_xor_b32 v184, 64, v6
    v_xor_b32 v185, 96, v6
    s_waitcnt vmcnt(0)
    ds_read_b64_tr_b16 a[0:1], v182 offset:0
    ds_read_b64_tr_b16 a[2:3], v182 offset:512
    ds_read_b64_tr_b16 a[4:5], v182 offset:4096
    ds_read_b64_tr_b16 a[6:7], v182 offset:4608
    ds_read_b64_tr_b16 a[8:9], v182 offset:8192
    ds_read_b64_tr_b16 a[10:11], v182 offset:8704
    ds_read_b64_tr_b16 a[12:13], v182 offset:12288
    ds_read_b64_tr_b16 a[14:15], v182 offset:12800
    ds_read_b64_tr_b16 a[16:17], v182 offset:16384
    ds_read_b64_tr_b16 a[18:19], v182 offset:16896
    ds_read_b64_tr_b16 a[20:21], v182 offset:20480
    ds_read_b64_tr_b16 a[22:23], v182 offset:20992
    ds_read_b64_tr_b16 a[24:25], v183 offset:0
    ds_read_b64_tr_b16 a[26:27], v183 offset:512
    ds_read_b64_tr_b16 a[28:29], v183 offset:4096
    ds_read_b64_tr_b16 a[30:31], v183 offset:4608
    ds_read_b64_tr_b16 a[32:33], v183 offset:8192
    ds_read_b64_tr_b16 a[34:35], v183 offset:8704
    ds_read_b64_tr_b16 a[36:37], v183 offset:12288
    ds_read_b64_tr_b16 a[38:39], v183 offset:12800
    ds_read_b64_tr_b16 a[40:41], v183 offset:16384
    ds_read_b64_tr_b16 a[42:43], v183 offset:16896
    ds_read_b64_tr_b16 a[44:45], v183 offset:20480
    ds_read_b64_tr_b16 a[46:47], v183 offset:20992
    ds_read_b64_tr_b16 a[48:49], v184 offset:0
    ds_read_b64_tr_b16 a[50:51], v184 offset:512
    ds_read_b64_tr_b16 a[52:53], v184 offset:4096
    ds_read_b64_tr_b16 a[54:55], v184 offset:4608
    ds_read_b64_tr_b16 a[56:57], v184 offset:8192
    ds_read_b64_tr_b16 a[58:59], v184 offset:8704
    ds_read_b64_tr_b16 a[60:61], v184 offset:12288
    ds_read_b64_tr_b16 a[62:63], v184 offset:12800
    ds_read_b64_tr_b16 a[64:65], v184 offset:16384
    ds_read_b64_tr_b16 a[66:67], v184 offset:16896
    ds_read_b64_tr_b16 a[68:69], v184 offset:20480
    ds_read_b64_tr_b16 a[70:71], v184 offset:20992
    ds_read_b64_tr_b16 a[72:73], v185 offset:0
    ds_read_b64_tr_b16 a[74:75], v185 offset:512
    ds_read_b64_tr_b16 a[76:77], v185 offset:4096
    ds_read_b64_tr_b16 a[78:79], v185 offset:4608
    ds_read_b64_tr_b16 a[80:81], v185 offset:8192
    ds_read_b64_tr_b16 a[82:83], v185 offset:8704
    ds_read_b64_tr_b16 a[84:85], v185 offset:12288
    ds_read_b64_tr_b16 a[86:87], v185 offset:12800
    ds_read_b64_tr_b16 a[88:89], v185 offset:16384
    ds_read_b64_tr_b16 a[90:91], v185 offset:16896
    ds_read_b64_tr_b16 a[92:93], v185 offset:20480
    ds_read_b64_tr_b16 a[94:95], v185 offset:20992
    s_waitcnt lgkmcnt(0)
    s_barrier
    v_mov_b32 v1, 196
L_gw_91:
    buffer_load_dword v2, v1, s[8:11], 0 offen sc1
    s_sub_u32 s36, s36, 1
    s_cbranch_scc1 L_exit
    s_waitcnt vmcnt(0)
    v_readfirstlane_b32 s90, v2
    s_nop 0
    s_cmp_eq_u32 s90, 0
    s_cbranch_scc1 L_gw_91
    buffer_store_dwordx4 v[164:167], v17, s[4:7], s38 offen sc1
    s_mov_b32 s37, -1
    v_add_u32 v35, -2, v34
    s_add_u32 s45, s38, 65536
    s_add_u32 s46, s45, 4096
    s_add_u32 s47, s45, 8192
    v_mov_b32 v24, v20
    v_mov_b32 v25, v21
    buffer_load_dword v36, v33, s[4:7], s38 offen sc1
    s_waitcnt vmcnt(0)
    v_cmp_lt_i32 vcc, v36, v35
    s_cbranch_vccz L_fok_93
L_fw_92:
    buffer_load_dword v36, v33, s[4:7], s38 offen sc1
    s_sub_u32 s36, s36, 1
    s_cbranch_scc1 L_exit
    s_waitcnt vmcnt(0)
    v_cmp_lt_i32 vcc, v36, v35
    s_cbranch_vccnz L_fw_92
L_fok_93:
    buffer_load_dwordx4 a[96:99], v40, s[4:7], s45 offen offset:0 sc1
    buffer_load_dwordx4 a[100:103], v40, s[4:7], s45 offen offset:1024 sc1
    buffer_load_dwordx4 a[104:107], v40, s[4:7], s45 offen offset:2048 sc1
    buffer_load_dwordx4 a[108:111], v40, s[4:7], s45 offen offset:3072 sc1
    buffer_load_dwordx4 a[112:115], v40, s[4:7], s46 offen offset:0 sc1
    buffer_load_dwordx4 a[116:119], v40, s[4:7], s46 offen offset:1024 sc1
    buffer_load_dwordx4 a[120:123], v40, s[4:7], s46 offen offset:2048 sc1
    buffer_load_dwordx4 a[124:127], v40, s[4:7], s46 offen offset:3072 sc1
    buffer_load_dwordx4 a[128:131], v40, s[4:7], s47 offen offset:0 sc1
    buffer_load_dwordx4 a[132:135], v40, s[4:7], s47 offen offset:1024 sc1
    buffer_load_dwordx4 a[136:139], v40, s[4:7], s47 offen offset:2048 sc1
    buffer_load_dwordx4 a[140:143], v40, s[4:7], s47 offen offset:3072 sc1
    s_waitcnt vmcnt(0)
    v_mfma_f32_16x16x32_bf16 v[148:151], a[96:99], a[0:3], 0
    v_mfma_f32_16x16x32_bf16 v[152:155], a[120:123], a[0:3], 0
    v_mfma_f32_16x16x32_bf16 v[156:159], a[96:99], a[24:27], 0
    v_mfma_f32_16x16x32_bf16 v[160:163], a[120:123], a[24:27], 0
    v_mfma_f32_16x16x32_bf16 v[180:183], a[96:99], a[48:51], 0
    v_mfma_f32_16x16x32_bf16 v[184:187], a[120:123], a[48:51], 0
    v_mfma_f32_16x16x32_bf16 v[188:191], a[96:99], a[72:75], 0
    v_mfma_f32_16x16x32_bf16 v[192:195], a[120:123], a[72:75], 0
    v_mfma_f32_16x16x32_bf16 v[148:151], a[100:103], a[4:7], v[148:151]
    v_mfma_f32_16x16x32_bf16 v[152:155], a[124:127], a[4:7], v[152:155]
    v_mfma_f32_16x16x32_bf16 v[156:159], a[100:103], a[28:31], v[156:159]
    v_mfma_f32_16x16x32_bf16 v[160:163], a[124:127], a[28:31], v[160:163]
    v_mfma_f32_16x16x32_bf16 v[180:183], a[100:103], a[52:55], v[180:183]
    v_mfma_f32_16x16x32_bf16 v[184:187], a[124:127], a[52:55], v[184:187]
    v_mfma_f32_16x16x32_bf16 v[188:191], a[100:103], a[76:79], v[188:191]
    v_mfma_f32_16x16x32_bf16 v[192:195], a[124:127], a[76:79], v[192:195]
    v_mfma_f32_16x16x32_bf16 v[148:151], a[104:107], a[8:11], v[148:151]
    v_mfma_f32_16x16x32_bf16 v[152:155], a[128:131], a[8:11], v[152:155]
    v_mfma_f32_16x16x32_bf16 v[156:159], a[104:107], a[32:35], v[156:159]
    v_mfma_f32_16x16x32_bf16 v[160:163], a[128:131], a[32:35], v[160:163]
    v_mfma_f32_16x16x32_bf16 v[180:183], a[104:107], a[56:59], v[180:183]
    v_mfma_f32_16x16x32_bf16 v[184:187], a[128:131], a[56:59], v[184:187]
    v_mfma_f32_16x16x32_bf16 v[188:191], a[104:107], a[80:83], v[188:191]
    v_mfma_f32_16x16x32_bf16 v[192:195], a[128:131], a[80:83], v[192:195]
    v_mfma_f32_16x16x32_bf16 v[148:151], a[108:111], a[12:15], v[148:151]
    v_mfma_f32_16x16x32_bf16 v[152:155], a[132:135], a[12:15], v[152:155]
    v_mfma_f32_16x16x32_bf16 v[156:159], a[108:111], a[36:39], v[156:159]
    v_mfma_f32_16x16x32_bf16 v[160:163], a[132:135], a[36:39], v[160:163]
    v_mfma_f32_16x16x32_bf16 v[180:183], a[108:111], a[60:63], v[180:183]
    v_mfma_f32_16x16x32_bf16 v[184:187], a[132:135], a[60:63], v[184:187]
    v_mfma_f32_16x16x32_bf16 v[188:191], a[108:111], a[84:87], v[188:191]
    v_mfma_f32_16x16x32_bf16 v[192:195], a[132:135], a[84:87], v[192:195]
    v_mfma_f32_16x16x32_bf16 v[148:151], a[112:115], a[16:19], v[148:151]
    v_mfma_f32_16x16x32_bf16 v[152:155], a[136:139], a[16:19], v[152:155]
    v_mfma_f32_16x16x32_bf16 v[156:159], a[112:115], a[40:43], v[156:159]
    v_mfma_f32_16x16x32_bf16 v[160:163], a[136:139], a[40:43], v[160:163]
    v_mfma_f32_16x16x32_bf16 v[180:183], a[112:115], a[64:67], v[180:183]
    v_mfma_f32_16x16x32_bf16 v[184:187], a[136:139], a[64:67], v[184:187]
    v_mfma_f32_16x16x32_bf16 v[188:191], a[112:115], a[88:91], v[188:191]
    v_mfma_f32_16x16x32_bf16 v[192:195], a[136:139], a[88:91], v[192:195]
    v_mfma_f32_16x16x32_bf16 v[148:151], a[116:119], a[20:23], v[148:151]
    v_mfma_f32_16x16x32_bf16 v[152:155], a[140:143], a[20:23], v[152:155]
    v_mfma_f32_16x16x32_bf16 v[156:159], a[116:119], a[44:47], v[156:159]
    v_mfma_f32_16x16x32_bf16 v[160:163], a[140:143], a[44:47], v[160:163]
    v_mfma_f32_16x16x32_bf16 v[180:183], a[116:119], a[68:71], v[180:183]
    v_mfma_f32_16x16x32_bf16 v[184:187], a[140:143], a[68:71], v[184:187]
    v_mfma_f32_16x16x32_bf16 v[188:191], a[116:119], a[92:95], v[188:191]
    v_mfma_f32_16x16x32_bf16 v[192:195], a[140:143], a[92:95], v[192:195]
    v_cvt_pk_bf16_f32 v64, v180, v181
    v_cvt_pk_bf16_f32 v65, v182, v183
    ds_write_b64 v24, v[64:65] offset:12288
    v_cvt_pk_bf16_f32 v68, v184, v185
    v_cvt_pk_bf16_f32 v69, v186, v187
    ds_write_b64 v25, v[68:69] offset:12288
    v_cvt_pk_bf16_f32 v72, v188, v189
    v_cvt_pk_bf16_f32 v73, v190, v191
    ds_write_b64 v24, v[72:73] offset:18432
    v_cvt_pk_bf16_f32 v76, v192, v193
    v_cvt_pk_bf16_f32 v77, v194, v195
    ds_write_b64 v25, v[76:77] offset:18432
    v_cvt_pk_bf16_f32 v48, v148, v149
    v_cvt_pk_bf16_f32 v49, v150, v151
    ds_write_b64 v24, v[48:49] offset:0
    v_cvt_pk_bf16_f32 v52, v152, v153
    v_cvt_pk_bf16_f32 v53, v154, v155
    ds_write_b64 v25, v[52:53] offset:0
    v_cvt_pk_bf16_f32 v56, v156, v157
    v_cvt_pk_bf16_f32 v57, v158, v159
    ds_write_b64 v24, v[56:57] offset:6144
    v_cvt_pk_bf16_f32 v60, v160, v161
    v_cvt_pk_bf16_f32 v61, v162, v163
    ds_write_b64 v25, v[60:61] offset:6144
    s_add_u32 s56, s37, 2
    s_and_b32 s55, s56, 3
    s_mul_i32 s55, s55, 114688
    s_add_u32 s55, s55, 65536
    s_add_u32 s45, s38, s55
    s_add_u32 s46, s45, 4096
    s_add_u32 s47, s45, 8192
    s_add_u32 s56, s37, -1
    s_and_b32 s55, s56, 3
    s_mul_i32 s55, s55, 114688
    s_add_u32 s55, s55, 53248
    s_add_u32 s48, s38, s55
    s_and_b32 s55, s56, 1
    s_add_u32 s56, s56, 1
    v_mov_b32 v35, -16
    v_writelane_b32 v35, s56, 12
    s_mul_i32 s55, s55, 12288
    s_add_u32 m0, s54, s55
    v_add_u32 v35, -1, v34
    buffer_load_dword v36, v33, s[4:7], s38 offen sc1
    s_waitcnt vmcnt(0)
    v_cmp_lt_i32 vcc, v36, v35
    s_cbranch_vccz L_fok_95
L_fw_94:
    buffer_load_dword v36, v33, s[4:7], s38 offen sc1
    s_sub_u32 s36, s36, 1
    s_cbranch_scc1 L_exit
    s_waitcnt vmcnt(0)
    v_cmp_lt_i32 vcc, v36, v35
    s_cbranch_vccnz L_fw_94
L_fok_95:
    buffer_load_dwordx4 a[96:99], v40, s[4:7], s45 offen offset:0 sc1
    buffer_load_dwordx4 a[100:103], v40, s[4:7], s45 offen offset:1024 sc1
    buffer_load_dwordx4 a[104:107], v40, s[4:7], s45 offen offset:2048 sc1
    buffer_load_dwordx4 a[108:111], v40, s[4:7], s45 offen offset:3072 sc1
    buffer_load_dwordx4 a[112:115], v40, s[4:7], s46 offen offset:0 sc1
    buffer_load_dwordx4 a[116:119], v40, s[4:7], s46 offen offset:1024 sc1
    buffer_load_dwordx4 a[120:123], v40, s[4:7], s46 offen offset:2048 sc1
    buffer_load_dwordx4 a[124:127], v40, s[4:7], s46 offen offset:3072 sc1
    buffer_load_dwordx4 a[128:131], v40, s[4:7], s47 offen offset:0 sc1
    buffer_load_dwordx4 a[132:135], v40, s[4:7], s47 offen offset:1024 sc1
    buffer_load_dwordx4 a[136:139], v40, s[4:7], s47 offen offset:2048 sc1
    buffer_load_dwordx4 a[140:143], v40, s[4:7], s47 offen offset:3072 sc1
    s_mov_b32 s50, s42
    s_add_u32 s56, s37, 1
    v_mov_b32 v47, v24
    s_and_b32 s55, s56, 3
    s_mul_i32 s41, s55, 327680
    s_mul_i32 s56, s55, 114688
    s_add_u32 s43, s38, s56
    s_xor_b32 s55, s55, 2
    s_mul_i32 s42, s55, 327680
    s_add_u32 s56, s37, 2
    v_mov_b32 v107, s56
    s_and_b32 s55, s56, 3
    s_mul_i32 s44, s55, 24576
    s_add_u32 s56, s37, -1
    s_and_b32 s55, s56, 3
    s_mul_i32 s55, s55, 40960
    s_add_u32 s49, s55, s38
    s_add_u32 s56, s37, -1
    s_and_b32 s55, s56, 3
    s_mul_i32 s55, s55, 24576
    v_add_u32 v26, s55, v22
    v_add_u32 v27, s55, v23
    s_and_b32 s55, s56, 1
    s_mul_i32 s55, s55, 12288
    v_add_u32 v29, s55, v28
    s_add_u32 s37, s37, 1
    s_mov_b32 m0, s53
    v_add_u32 v24, s44, v20
    v_add_u32 v25, s44, v21
    v_pk_mul_f32 v[148:149], v[210:211], v[210:211]
    v_pk_mul_f32 v[150:151], v[210:211], v[210:211]
    v_pk_mul_f32 v[152:153], v[210:211], v[210:211]
    v_pk_mul_f32 v[154:155], v[210:211], v[210:211]
    v_pk_mul_f32 v[156:157], v[210:211], v[210:211]
    v_pk_mul_f32 v[158:159], v[210:211], v[210:211]
    v_pk_mul_f32 v[160:161], v[210:211], v[210:211]
    v_pk_mul_f32 v[162:163], v[210:211], v[210:211]
    v_mov_b32 v120, 0
    v_mov_b32 v121, 0
    v_mov_b32 v122, 0
    v_mov_b32 v123, 0
    v_mov_b32 v124, 0
    v_mov_b32 v125, 0
    v_mov_b32 v126, 0
    v_mov_b32 v127, 0
    v_mov_b32 v128, 0
    v_mov_b32 v129, 0
    v_mov_b32 v130, 0
    v_mov_b32 v131, 0
    v_mov_b32 v132, 0
    v_mov_b32 v133, 0
    v_mov_b32 v134, 0
    v_mov_b32 v135, 0
    v_mov_b32 v116, 0
    v_mov_b32 v117, 0
    v_mov_b32 v118, 0
    v_mov_b32 v119, 0
L_wo_loop_s:
    buffer_load_dword v41, v245, s[4:7], s38 offen sc1
    buffer_load_dword v41, v245, s[4:7], s38 offen sc1
    buffer_load_dword v41, v245, s[4:7], s38 offen sc1
    buffer_load_dword v41, v245, s[4:7], s38 offen sc1
    buffer_load_dword v41, v245, s[4:7], s38 offen sc1
    buffer_load_dword v41, v245, s[4:7], s38 offen sc1
L_sp_99:
    s_waitcnt vmcnt(5)
    v_cmp_ge_u32 vcc, s37, v41
    buffer_load_dword v41, v245, s[4:7], s38 offen sc1
    s_sub_u32 s36, s36, 1
    s_cbranch_scc1 L_exit
    s_cbranch_vccz L_sp_99x
    s_waitcnt vmcnt(5)
    v_cmp_ge_u32 vcc, s37, v41
    buffer_load_dword v41, v245, s[4:7], s38 offen sc1
    s_cbranch_vccz L_sp_99x
    s_waitcnt vmcnt(5)
    v_cmp_ge_u32 vcc, s37, v41
    buffer_load_dword v41, v245, s[4:7], s38 offen sc1
    s_cbranch_vccz L_sp_99x
    s_waitcnt vmcnt(5)
    v_cmp_ge_u32 vcc, s37, v41
    buffer_load_dword v41, v245, s[4:7], s38 offen sc1
    s_cbranch_vccnz L_sp_99
L_sp_99x:
    buffer_load_dwordx4 v44, s[4:7], s43 offen offset:0 sc1 lds
    buffer_load_dwordx4 v44, s[4:7], s43 offen offset:1024 sc1 lds
    buffer_load_dwordx4 v44, s[4:7], s43 offen offset:2048 sc1 lds
    s_waitcnt vmcnt(2)
    ds_read_b64_tr_b16 v[136:137], v16 offset:0
    ds_read_b64_tr_b16 v[138:139], v13 offset:0
    s_waitcnt vmcnt(1)
    ds_read_b64_tr_b16 v[140:141], v16 offset:1024
    ds_read_b64_tr_b16 v[142:143], v13 offset:1024
    s_waitcnt vmcnt(0)
    ds_read_b64_tr_b16 v[144:145], v16 offset:2048
    ds_read_b64_tr_b16 v[146:147], v13 offset:2048
    buffer_load_dwordx4 v[92:95], v38, s[4:7], s43 offen offset:0 sc1
    buffer_load_dwordx4 v[96:99], v38, s[4:7], s43 offen offset:1280 sc1
    buffer_load_dwordx4 v[100:103], v38, s[4:7], s43 offen offset:2560 sc1
    s_cmp_eq_u32 s37, 63
    s_waitcnt lgkmcnt(4)
    v_smfmac_f32_16x16x64_bf16 v[148:151], v[136:139], a[0:7], v10
    v_smfmac_f32_16x16x64_bf16 v[152:155], v[136:139], a[24:31], v10
    v_smfmac_f32_16x16x64_bf16 v[156:159], v[136:139], a[48:55], v10
    buffer_load_dword v104, v39, s[4:7], s43 offen offset:0 sc1
    v_smfmac_f32_16x16x64_bf16 v[160:163], v[136:139], a[72:79], v10
    buffer_load_dword v105, v39, s[4:7], s43 offen offset:1280 sc1
    s_waitcnt lgkmcnt(2)
    v_smfmac_f32_16x16x64_bf16 v[148:151], v[140:143], a[8:15], v10
    buffer_load_dword v106, v39, s[4:7], s43 offen offset:2560 sc1
    v_smfmac_f32_16x16x64_bf16 v[152:155], v[140:143], a[32:39], v10
    v_smfmac_f32_16x16x64_bf16 v[156:159], v[140:143], a[56:63], v10
    v_smfmac_f32_16x16x64_bf16 v[160:163], v[140:143], a[80:87], v10
    s_waitcnt lgkmcnt(0)
    v_smfmac_f32_16x16x64_bf16 v[148:151], v[144:147], a[16:23], v10
    v_smfmac_f32_16x16x64_bf16 v[152:155], v[144:147], a[40:47], v10
    v_smfmac_f32_16x16x64_bf16 v[156:159], v[144:147], a[64:71], v10
    v_smfmac_f32_16x16x64_bf16 v[160:163], v[144:147], a[88:95], v10
    v_pk_add_f32 v[148:149], v[148:149], v[150:151]
    v_cmp_u_f32 vcc, v148, v149
    v_cvt_pk_bf16_f32 v50, v148, v149
    v_cvt_pk_bf16_f32 v54, v148, v149
    v_pk_add_f32 v[152:153], v[152:153], v[154:155]
    v_cvt_pk_bf16_f32 v58, v152, v153
    v_cvt_pk_bf16_f32 v62, v152, v153
    v_pk_add_f32 v[156:157], v[156:157], v[158:159]
    v_cvt_pk_bf16_f32 v66, v156, v157
    v_cvt_pk_bf16_f32 v70, v156, v157
    v_pk_add_f32 v[160:161], v[160:161], v[162:163]
    v_cvt_pk_bf16_f32 v74, v160, v161
    v_cvt_pk_bf16_f32 v78, v160, v161
    s_cbranch_vccnz L_vm_97
L_u_98:
    s_cbranch_scc1 L_wo_tail_s
L_sc_100:
    s_waitcnt vmcnt(4)
    v_pk_add_f32 v[236:237], v[92:93], v[96:97]
    v_pk_add_f32 v[238:239], v[94:95], v[98:99]
    s_waitcnt vmcnt(3)
    v_pk_add_f32 v[236:237], v[236:237], v[100:101]
    v_pk_add_f32 v[238:239], v[238:239], v[102:103]
    v_max3_f32 v41, v236, v237, v238
    v_pk_add_f32 v[242:243], v[236:237], v[238:239]
    s_waitcnt vmcnt(0)
    v_add_f32 v43, v104, v105
    v_add_f32 v43, v43, v106
    v_max3_f32 v41, v41, v239, v43
    v_add_f32 v242, v242, v43
    s_nop 0
    v_max_f32_dpp v42, v41, v41 quad_perm:[2,3,0,1] row_mask:0xf bank_mask:0xf
    v_max_f32_dpp v41, v41, v41 quad_perm:[2,3,0,1] row_mask:0xf bank_mask:0xf
    v_cmp_u_f32 vcc, v242, v243
    s_nop 0
    v_permlane16_swap_b32 v41, v42
    v_max_f32 v41, v41, v42
    v_mov_b32 v42, v41
    s_cbranch_vccnz L_sp_101
L_sg_102:
    s_nop 0
    v_permlane32_swap_b32 v41, v42
    v_max_f32 v41, v41, v42
    v_mul_f32 v242, 0xbdd53b95, v41
    v_pk_fma_f32 v[236:237], v[236:237], v[240:241], v[242:243] op_sel_hi:[1,1,0]
    v_pk_fma_f32 v[238:239], v[238:239], v[240:241], v[242:243] op_sel_hi:[1,1,0]
    v_fma_f32 v43, v43, v240, v242
    v_exp_f32 v236, v236
    v_exp_f32 v237, v237
    v_exp_f32 v238, v238
    v_exp_f32 v239, v239
    v_exp_f32 v43, v43
    v_cvt_pk_bf16_f32 v80, v236, v237
    v_cvt_pk_bf16_f32 v82, v238, v239
    v_cvt_pk_bf16_f32 v81, v43, 0
    v_cvt_pk_bf16_f32 v83, v43, 0
    s_nop 1
    v_smfmac_f32_16x16x64_bf16 v[116:119], v[80:83], v[84:91], v11
    v_smfmac_f32_16x16x64_bf16 v[120:123], v[80:83], v[48:55], v11
    v_smfmac_f32_16x16x64_bf16 v[124:127], v[80:83], v[56:63], v11
    v_smfmac_f32_16x16x64_bf16 v[128:131], v[80:83], v[64:71], v11
    v_add_f32 v116, v116, v118
    v_add_f32 v117, v117, v119
    v_smfmac_f32_16x16x64_bf16 v[132:135], v[80:83], v[72:79], v11
    v_rcp_f32 v116, v116
    v_rcp_f32 v117, v117
    v_pk_add_f32 v[120:121], v[120:121], v[122:123]
    v_pk_mul_f32 v[120:121], v[120:121], v[116:117]
    v_cvt_pk_bf16_f32 v236, v120, v121
    v_pk_add_f32 v[124:125], v[124:125], v[126:127]
    v_pk_mul_f32 v[124:125], v[124:125], v[116:117]
    v_cvt_pk_bf16_f32 v237, v124, v125
    ds_write2st64_b32 v18, v236, v237 offset0:0 offset1:1
    v_pk_add_f32 v[128:129], v[128:129], v[130:131]
    v_pk_mul_f32 v[128:129], v[128:129], v[116:117]
    v_cvt_pk_bf16_f32 v238, v128, v129
    v_pk_add_f32 v[132:133], v[132:133], v[134:135]
    v_pk_mul_f32 v[132:133], v[132:133], v[116:117]
    v_cvt_pk_bf16_f32 v239, v132, v133
    ds_write2st64_b32 v18, v238, v239 offset0:2 offset1:3
    buffer_store_dword v107, v244, s[4:7], s38 offen sc1
    v_mov_b32 v120, 0
    v_mov_b32 v121, 0
    v_mov_b32 v122, 0
    v_mov_b32 v123, 0
    v_mov_b32 v124, 0
    v_mov_b32 v125, 0
    v_mov_b32 v126, 0
    v_mov_b32 v127, 0
    v_mov_b32 v128, 0
    v_mov_b32 v129, 0
    s_waitcnt lgkmcnt(0)
    s_barrier
    ds_read_b64_tr_b16 v[80:81], v19
    ds_read_b64_tr_b16 v[82:83], v19 offset:128
    v_mov_b32 v130, 0
    v_mov_b32 v131, 0
    v_mov_b32 v132, 0
    v_mov_b32 v133, 0
    v_mov_b32 v134, 0
    v_mov_b32 v135, 0
    v_mov_b32 v116, 0
    v_mov_b32 v117, 0
    v_mov_b32 v118, 0
    v_mov_b32 v119, 0
    s_waitcnt lgkmcnt(0)
    v_mfma_f32_16x16x32_bf16 v[172:175], v[110:113], v[80:83], 0
    v_mfma_f32_16x16x32_bf16 v[176:179], v[108:111], v[80:83], 0
    buffer_load_dword v36, v33, s[4:7], s38 offen sc1
    s_nop 3
    v_cvt_pk_bf16_f32 v236, v172, v173
    v_cvt_pk_bf16_f32 v237, v174, v175
    s_nop 0
    v_cvt_pk_bf16_f32 v238, v176, v177
    v_cvt_pk_bf16_f32 v239, v178, v179
    buffer_store_dwordx4 v[236:239], v14, s[4:7], s41 offen sc1
    ds_write_b32 v47, v50 offset:8
    ds_write_b32 v47, v58 offset:6152
    ds_write_b32 v47, v66 offset:12296
    ds_write_b32 v47, v74 offset:18440
    ds_read_b128 v[204:207], v26 offset:0
    ds_read_b128 v[180:183], v29 offset:0
    ds_read_b128 v[184:187], v29 offset:1024
    ds_read_b64 v[208:209], v27 offset:0
    ds_read_b128 v[188:191], v29 offset:2048
    ds_read_b128 v[212:215], v26 offset:1536
    ds_read_b128 v[192:195], v29 offset:3072
    ds_read_b128 v[196:199], v29 offset:4096
    ds_read_b64 v[216:217], v27 offset:1536
    ds_read_b128 v[200:203], v29 offset:5120
    s_add_u32 s55, s42, s60
    buffer_store_dword v168, v46, s[4:7], s55 offen sc1
    s_add_u32 s55, s42, s61
    buffer_store_dword v168, v46, s[4:7], s55 offen sc1
    s_waitcnt lgkmcnt(5)
    v_mfma_f32_16x16x32_bf16 v[220:223], v[180:183], v[204:207], 0
    v_mfma_f32_16x16x32_bf16 v[224:227], v[184:187], v[204:207], 0
    v_mfma_f32_16x16x32_bf16 v[224:227], v[188:191], v[208:211], v[224:227]
    ds_read_b128 v[204:207], v26 offset:3072
    ds_read_b128 v[180:183], v29 offset:6144
    ds_read_b128 v[184:187], v29 offset:7168
    ds_read_b64 v[208:209], v27 offset:3072
    ds_read_b128 v[188:191], v29 offset:8192
    s_add_u32 s56, s37, 2
    s_and_b32 s55, s56, 3
    s_mul_i32 s55, s55, 114688
    s_add_u32 s55, s55, 65536
    s_add_u32 s45, s38, s55
    s_add_u32 s46, s45, 4096
    s_add_u32 s47, s45, 8192
    s_add_u32 s56, s37, -1
    s_and_b32 s55, s56, 3
    s_mul_i32 s55, s55, 114688
    s_add_u32 s55, s55, 53248
    s_add_u32 s48, s38, s55
    s_and_b32 s55, s56, 1
    s_add_u32 s56, s56, 1
    v_mov_b32 v35, -16
    v_writelane_b32 v35, s56, 12
    s_mul_i32 s55, s55, 12288
    s_add_u32 m0, s54, s55
    s_waitcnt lgkmcnt(5)
    v_mfma_f32_16x16x32_bf16 v[220:223], v[192:195], v[212:215], v[220:223]
    v_mfma_f32_16x16x32_bf16 v[224:227], v[196:199], v[212:215], v[224:227]
    v_mfma_f32_16x16x32_bf16 v[224:227], v[200:203], v[216:219], v[224:227]
    ds_read_b128 v[212:215], v26 offset:4608
    ds_read_b128 v[192:195], v29 offset:9216
    ds_read_b128 v[196:199], v29 offset:10240
    ds_read_b64 v[216:217], v27 offset:4608
    ds_read_b128 v[200:203], v29 offset:11264
    s_waitcnt lgkmcnt(5)
    v_mfma_f32_16x16x32_bf16 v[220:223], v[180:183], v[204:207], v[220:223]
    v_mfma_f32_16x16x32_bf16 v[224:227], v[184:187], v[204:207], v[224:227]
    v_mfma_f32_16x16x32_bf16 v[224:227], v[188:191], v[208:211], v[224:227]
    s_waitcnt lgkmcnt(0)
    v_mfma_f32_16x16x32_bf16 v[220:223], v[192:195], v[212:215], v[220:223]
    v_mfma_f32_16x16x32_bf16 v[224:227], v[196:199], v[212:215], v[224:227]
    v_mfma_f32_16x16x32_bf16 v[224:227], v[200:203], v[216:219], v[224:227]
    s_waitcnt vmcnt(3)
    v_cmp_lt_i32 vcc, v36, v35
    s_cbranch_vccz L_fok_105
L_fw_104:
    buffer_load_dword v36, v33, s[4:7], s38 offen sc1
    s_sub_u32 s36, s36, 1
    s_cbranch_scc1 L_exit
    s_waitcnt vmcnt(0)
    v_cmp_lt_i32 vcc, v36, v35
    s_cbranch_vccnz L_fw_104
L_fok_105:
    buffer_load_dwordx4 v37, s[4:7], s48 offen offset:0 sc1 lds
    buffer_load_dwordx4 v37, s[4:7], s48 offen offset:1024 sc1 lds
    buffer_load_dwordx4 v37, s[4:7], s48 offen offset:2048 sc1 lds
    v_cvt_pk_bf16_f32 v220, v220, v221
    v_cvt_pk_bf16_f32 v221, v222, v223
    v_cvt_pk_bf16_f32 v222, v224, v225
    v_cvt_pk_bf16_f32 v223, v226, v227
    v_mov_b32 v224, v220
    v_mov_b32 v225, v221
    v_mov_b32_dpp v220, v222 row_ror:8 row_mask:0xf bank_mask:0xc
    v_mov_b32_dpp v221, v223 row_ror:8 row_mask:0xf bank_mask:0xc
    v_mov_b32_dpp v222, v224 row_ror:8 row_mask:0xf bank_mask:0x3
    v_mov_b32_dpp v223, v225 row_ror:8 row_mask:0xf bank_mask:0x3
    buffer_store_dwordx4 v[220:223], v15, s[4:7], s49 offen sc1
    v_mfma_f32_16x16x32_bf16 v[148:151], a[96:99], a[0:3], 0
    s_mov_b32 s50, s42
    s_add_u32 s56, s37, 1
    v_mov_b32 v47, v24
    v_mfma_f32_16x16x32_bf16 v[152:155], a[120:123], a[0:3], 0
    s_and_b32 s55, s56, 3
    s_mul_i32 s41, s55, 327680
    s_mul_i32 s56, s55, 114688
    v_mfma_f32_16x16x32_bf16 v[156:159], a[96:99], a[24:27], 0
    s_add_u32 s43, s38, s56
    s_xor_b32 s55, s55, 2
    s_mul_i32 s42, s55, 327680
    v_mfma_f32_16x16x32_bf16 v[160:163], a[120:123], a[24:27], 0
    s_add_u32 s56, s37, 2
    v_mov_b32 v107, s56
    s_and_b32 s55, s56, 3
    v_mfma_f32_16x16x32_bf16 v[180:183], a[96:99], a[48:51], 0
    s_mul_i32 s44, s55, 24576
    s_add_u32 s56, s37, -1
    s_and_b32 s55, s56, 3
    v_mfma_f32_16x16x32_bf16 v[184:187], a[120:123], a[48:51], 0
    s_mul_i32 s55, s55, 40960
    s_add_u32 s49, s55, s38
    s_add_u32 s56, s37, -1
    v_mfma_f32_16x16x32_bf16 v[188:191], a[96:99], a[72:75], 0
    s_and_b32 s55, s56, 3
    s_mul_i32 s55, s55, 24576
    v_add_u32 v26, s55, v22
    v_mfma_f32_16x16x32_bf16 v[192:195], a[120:123], a[72:75], 0
    buffer_load_dwordx4 a[96:99], v40, s[4:7], s45 offen offset:0 sc1
    v_mfma_f32_16x16x32_bf16 v[148:151], a[100:103], a[4:7], v[148:151]
    v_add_u32 v27, s55, v23
    s_and_b32 s55, s56, 1
    s_mul_i32 s55, s55, 12288
    v_mfma_f32_16x16x32_bf16 v[152:155], a[124:127], a[4:7], v[152:155]
    buffer_load_dwordx4 a[120:123], v40, s[4:7], s46 offen offset:2048 sc1
    v_mfma_f32_16x16x32_bf16 v[156:159], a[100:103], a[28:31], v[156:159]
    v_add_u32 v29, s55, v28
    v_mfma_f32_16x16x32_bf16 v[160:163], a[124:127], a[28:31], v[160:163]
    v_mfma_f32_16x16x32_bf16 v[180:183], a[100:103], a[52:55], v[180:183]
    v_mfma_f32_16x16x32_bf16 v[184:187], a[124:127], a[52:55], v[184:187]
    v_mfma_f32_16x16x32_bf16 v[188:191], a[100:103], a[76:79], v[188:191]
    v_mfma_f32_16x16x32_bf16 v[192:195], a[124:127], a[76:79], v[192:195]
    buffer_load_dwordx4 a[100:103], v40, s[4:7], s45 offen offset:1024 sc1
    v_mfma_f32_16x16x32_bf16 v[148:151], a[104:107], a[8:11], v[148:151]
    v_mfma_f32_16x16x32_bf16 v[152:155], a[128:131], a[8:11], v[152:155]
    buffer_load_dwordx4 a[124:127], v40, s[4:7], s46 offen offset:3072 sc1
    v_mfma_f32_16x16x32_bf16 v[156:159], a[104:107], a[32:35], v[156:159]
    v_mfma_f32_16x16x32_bf16 v[160:163], a[128:131], a[32:35], v[160:163]
    v_mfma_f32_16x16x32_bf16 v[180:183], a[104:107], a[56:59], v[180:183]
    v_mfma_f32_16x16x32_bf16 v[184:187], a[128:131], a[56:59], v[184:187]
    v_mfma_f32_16x16x32_bf16 v[188:191], a[104:107], a[80:83], v[188:191]
    v_mfma_f32_16x16x32_bf16 v[192:195], a[128:131], a[80:83], v[192:195]
    buffer_load_dwordx4 a[104:107], v40, s[4:7], s45 offen offset:2048 sc1
    v_mfma_f32_16x16x32_bf16 v[148:151], a[108:111], a[12:15], v[148:151]
    v_mfma_f32_16x16x32_bf16 v[152:155], a[132:135], a[12:15], v[152:155]
    buffer_load_dwordx4 a[128:131], v40, s[4:7], s47 offen offset:0 sc1
    v_mfma_f32_16x16x32_bf16 v[156:159], a[108:111], a[36:39], v[156:159]
    v_mfma_f32_16x16x32_bf16 v[160:163], a[132:135], a[36:39], v[160:163]
    v_mfma_f32_16x16x32_bf16 v[180:183], a[108:111], a[60:63], v[180:183]
    v_mfma_f32_16x16x32_bf16 v[184:187], a[132:135], a[60:63], v[184:187]
    v_mfma_f32_16x16x32_bf16 v[188:191], a[108:111], a[84:87], v[188:191]
    v_mfma_f32_16x16x32_bf16 v[192:195], a[132:135], a[84:87], v[192:195]
    buffer_load_dwordx4 a[108:111], v40, s[4:7], s45 offen offset:3072 sc1
    v_mfma_f32_16x16x32_bf16 v[148:151], a[112:115], a[16:19], v[148:151]
    v_mfma_f32_16x16x32_bf16 v[152:155], a[136:139], a[16:19], v[152:155]
    buffer_load_dwordx4 a[132:135], v40, s[4:7], s47 offen offset:1024 sc1
    v_mfma_f32_16x16x32_bf16 v[156:159], a[112:115], a[40:43], v[156:159]
    v_mfma_f32_16x16x32_bf16 v[160:163], a[136:139], a[40:43], v[160:163]
    v_mfma_f32_16x16x32_bf16 v[180:183], a[112:115], a[64:67], v[180:183]
    v_mfma_f32_16x16x32_bf16 v[184:187], a[136:139], a[64:67], v[184:187]
    v_mfma_f32_16x16x32_bf16 v[188:191], a[112:115], a[88:91], v[188:191]
    v_mfma_f32_16x16x32_bf16 v[192:195], a[136:139], a[88:91], v[192:195]
    v_mfma_f32_16x16x32_bf16 v[148:151], a[116:119], a[20:23], v[148:151]
    v_mfma_f32_16x16x32_bf16 v[152:155], a[140:143], a[20:23], v[152:155]
    v_mfma_f32_16x16x32_bf16 v[156:159], a[116:119], a[44:47], v[156:159]
    v_mfma_f32_16x16x32_bf16 v[160:163], a[140:143], a[44:47], v[160:163]
    v_mfma_f32_16x16x32_bf16 v[180:183], a[116:119], a[68:71], v[180:183]
    v_mfma_f32_16x16x32_bf16 v[184:187], a[140:143], a[68:71], v[184:187]
    v_mfma_f32_16x16x32_bf16 v[188:191], a[116:119], a[92:95], v[188:191]
    v_mfma_f32_16x16x32_bf16 v[192:195], a[140:143], a[92:95], v[192:195]
    v_cvt_pk_bf16_f32 v64, v180, v181
    v_cvt_pk_bf16_f32 v65, v182, v183
    ds_write_b64 v24, v[64:65] offset:12288
    v_cvt_pk_bf16_f32 v68, v184, v185
    v_cvt_pk_bf16_f32 v69, v186, v187
    ds_write_b64 v25, v[68:69] offset:12288
    v_cvt_pk_bf16_f32 v72, v188, v189
    v_cvt_pk_bf16_f32 v73, v190, v191
    ds_write_b64 v24, v[72:73] offset:18432
    v_cvt_pk_bf16_f32 v76, v192, v193
    v_cvt_pk_bf16_f32 v77, v194, v195
    ds_write_b64 v25, v[76:77] offset:18432
    v_cvt_pk_bf16_f32 v48, v148, v149
    v_cvt_pk_bf16_f32 v49, v150, v151
    ds_write_b64 v24, v[48:49] offset:0
    v_cvt_pk_bf16_f32 v52, v152, v153
    v_cvt_pk_bf16_f32 v53, v154, v155
    ds_write_b64 v25, v[52:53] offset:0
    v_cvt_pk_bf16_f32 v56, v156, v157
    v_cvt_pk_bf16_f32 v57, v158, v159
    ds_write_b64 v24, v[56:57] offset:6144
    v_cvt_pk_bf16_f32 v60, v160, v161
    v_cvt_pk_bf16_f32 v61, v162, v163
    ds_write_b64 v25, v[60:61] offset:6144
    s_add_u32 s37, s37, 1
    s_mov_b32 m0, s53
    v_add_u32 v24, s44, v20
    v_add_u32 v25, s44, v21
    v_pk_mul_f32 v[148:149], v[210:211], v[210:211]
    v_pk_mul_f32 v[150:151], v[210:211], v[210:211]
    v_pk_mul_f32 v[152:153], v[210:211], v[210:211]
    v_pk_mul_f32 v[154:155], v[210:211], v[210:211]
    v_pk_mul_f32 v[156:157], v[210:211], v[210:211]
    v_pk_mul_f32 v[158:159], v[210:211], v[210:211]
    v_pk_mul_f32 v[160:161], v[210:211], v[210:211]
    v_pk_mul_f32 v[162:163], v[210:211], v[210:211]
    buffer_load_dwordx4 a[112:115], v40, s[4:7], s46 offen offset:0 sc1
    buffer_load_dwordx4 a[136:139], v40, s[4:7], s47 offen offset:2048 sc1
    buffer_load_dwordx4 a[116:119], v40, s[4:7], s46 offen offset:1024 sc1
    buffer_load_dwordx4 a[140:143], v40, s[4:7], s47 offen offset:3072 sc1
    s_branch L_wo_loop_s
L_wo_tail_s:
    ds_write_b32 v47, v50 offset:8
    ds_write_b32 v47, v58 offset:6152
    ds_write_b32 v47, v66 offset:12296
    ds_write_b32 v47, v74 offset:18440
    s_add_u32 s91, s38, 81920
    buffer_load_dwordx4 v[120:123], v15, s[4:7], s91 offen sc1
    s_add_u32 s91, s38, 122880
    buffer_load_dwordx4 v[124:127], v15, s[4:7], s91 offen sc1
    s_add_u32 s56, s37, -1
    s_and_b32 s55, s56, 3
    s_mul_i32 s55, s55, 114688
    s_add_u32 s55, s55, 53248
    s_add_u32 s48, s38, s55
    s_and_b32 s55, s56, 1
    s_add_u32 s56, s56, 1
    v_mov_b32 v35, -16
    v_writelane_b32 v35, s56, 12
    s_mul_i32 s55, s55, 12288
    s_add_u32 m0, s54, s55
    buffer_load_dword v36, v33, s[4:7], s38 offen sc1
    v_mov_b32 v3, 204
L_p0_106:
    buffer_load_dword v4, v3, s[8:11], 0 offen sc1
    s_sub_u32 s36, s36, 1
    s_cbranch_scc1 L_exit
    s_waitcnt vmcnt(0)
    v_readfirstlane_b32 s90, v4
    s_nop 0
    s_cmp_eq_u32 s90, 0
    s_cbranch_scc1 L_p0_106
    s_and_b32 s90, s90, 2
    s_lshl_b32 s90, s90, 12
    v_xor_b32 v30, s90, v30
    v_xor_b32 v31, s90, v31
    s_waitcnt lgkmcnt(0)
    s_barrier
    v_cmp_lt_i32 vcc, v36, v35
    s_cbranch_vccz L_fok_108
L_fw_107:
    buffer_load_dword v36, v33, s[4:7], s38 offen sc1
    s_sub_u32 s36, s36, 1
    s_cbranch_scc1 L_exit
    s_waitcnt vmcnt(0)
    v_cmp_lt_i32 vcc, v36, v35
    s_cbranch_vccnz L_fw_107
L_fok_108:
    buffer_load_dwordx4 v37, s[4:7], s48 offen offset:0 sc1 lds
    buffer_load_dwordx4 v37, s[4:7], s48 offen offset:1024 sc1 lds
    buffer_load_dwordx4 v37, s[4:7], s48 offen offset:2048 sc1 lds
    v_mov_b32 v128, v220
    v_mov_b32 v129, v221
    v_mov_b32 v130, v222
    v_mov_b32 v131, v223
    s_add_u32 s56, s37, -2
    s_and_b32 s55, s56, 3
    s_mul_i32 s55, s55, 24576
    v_add_u32 v26, s55, v22
    v_add_u32 v27, s55, v23
    s_and_b32 s55, s56, 1
    s_mul_i32 s55, s55, 12288
    v_add_u32 v29, s55, v28
    ds_read_b128 v[204:207], v26 offset:0
    ds_read_b128 v[180:183], v29 offset:0
    ds_read_b128 v[184:187], v29 offset:1024
    ds_read_b64 v[208:209], v27 offset:0
    ds_read_b128 v[188:191], v29 offset:2048
    ds_read_b128 v[212:215], v26 offset:1536
    ds_read_b128 v[192:195], v29 offset:3072
    ds_read_b128 v[196:199], v29 offset:4096
    ds_read_b64 v[216:217], v27 offset:1536
    ds_read_b128 v[200:203], v29 offset:5120
    s_waitcnt lgkmcnt(5)
    v_mfma_f32_16x16x32_bf16 v[220:223], v[180:183], v[204:207], 0
    v_mfma_f32_16x16x32_bf16 v[224:227], v[184:187], v[204:207], 0
    v_mfma_f32_16x16x32_bf16 v[224:227], v[188:191], v[208:211], v[224:227]
    ds_read_b128 v[204:207], v26 offset:3072
    ds_read_b128 v[180:183], v29 offset:6144
    ds_read_b128 v[184:187], v29 offset:7168
    ds_read_b64 v[208:209], v27 offset:3072
    ds_read_b128 v[188:191], v29 offset:8192
    s_waitcnt lgkmcnt(5)
    v_mfma_f32_16x16x32_bf16 v[220:223], v[192:195], v[212:215], v[220:223]
    v_mfma_f32_16x16x32_bf16 v[224:227], v[196:199], v[212:215], v[224:227]
    v_mfma_f32_16x16x32_bf16 v[224:227], v[200:203], v[216:219], v[224:227]
    ds_read_b128 v[212:215], v26 offset:4608
    ds_read_b128 v[192:195], v29 offset:9216
    ds_read_b128 v[196:199], v29 offset:10240
    ds_read_b64 v[216:217], v27 offset:4608
    ds_read_b128 v[200:203], v29 offset:11264
    s_waitcnt lgkmcnt(5)
    v_mfma_f32_16x16x32_bf16 v[220:223], v[180:183], v[204:207], v[220:223]
    v_mfma_f32_16x16x32_bf16 v[224:227], v[184:187], v[204:207], v[224:227]
    v_mfma_f32_16x16x32_bf16 v[224:227], v[188:191], v[208:211], v[224:227]
    s_waitcnt lgkmcnt(0)
    v_mfma_f32_16x16x32_bf16 v[220:223], v[192:195], v[212:215], v[220:223]
    v_mfma_f32_16x16x32_bf16 v[224:227], v[196:199], v[212:215], v[224:227]
    v_mfma_f32_16x16x32_bf16 v[224:227], v[200:203], v[216:219], v[224:227]
    s_nop 0
    v_cvt_pk_bf16_f32 v220, v220, v221
    v_cvt_pk_bf16_f32 v221, v222, v223
    s_nop 4
    v_cvt_pk_bf16_f32 v222, v224, v225
    v_cvt_pk_bf16_f32 v223, v226, v227
    v_mov_b32 v224, v220
    v_mov_b32 v225, v221
    v_mov_b32_dpp v220, v222 row_ror:8 row_mask:0xf bank_mask:0xc
    v_mov_b32_dpp v221, v223 row_ror:8 row_mask:0xf bank_mask:0xc
    v_mov_b32_dpp v222, v224 row_ror:8 row_mask:0xf bank_mask:0x3
    v_mov_b32_dpp v223, v225 row_ror:8 row_mask:0xf bank_mask:0x3
    v_mov_b32 v132, v220
    v_mov_b32 v133, v221
    v_mov_b32 v134, v222
    v_mov_b32 v135, v223
    s_waitcnt vmcnt(0)
    s_barrier
    s_add_u32 s56, s37, -1
    s_and_b32 s55, s56, 3
    s_mul_i32 s55, s55, 24576
    v_add_u32 v26, s55, v22
    v_add_u32 v27, s55, v23
    s_and_b32 s55, s56, 1
    s_mul_i32 s55, s55, 12288
    v_add_u32 v29, s55, v28
    ds_read_b128 v[204:207], v26 offset:0
    ds_read_b128 v[180:183], v29 offset:0
    ds_read_b128 v[184:187], v29 offset:1024
    ds_read_b64 v[208:209], v27 offset:0
    ds_read_b128 v[188:191], v29 offset:2048
    ds_read_b128 v[212:215], v26 offset:1536
    ds_read_b128 v[192:195], v29 offset:3072
    ds_read_b128 v[196:199], v29 offset:4096
    ds_read_b64 v[216:217], v27 offset:1536
    ds_read_b128 v[200:203], v29 offset:5120
    s_waitcnt lgkmcnt(5)
    v_mfma_f32_16x16x32_bf16 v[220:223], v[180:183], v[204:207], 0
    v_mfma_f32_16x16x32_bf16 v[224:227], v[184:187], v[204:207], 0
    v_mfma_f32_16x16x32_bf16 v[224:227], v[188:191], v[208:211], v[224:227]
    ds_read_b128 v[204:207], v26 offset:3072
    ds_read_b128 v[180:183], v29 offset:6144
    ds_read_b128 v[184:187], v29 offset:7168
    ds_read_b64 v[208:209], v27 offset:3072
    ds_read_b128 v[188:191], v29 offset:8192
    s_waitcnt lgkmcnt(5)
    v_mfma_f32_16x16x32_bf16 v[220:223], v[192:195], v[212:215], v[220:223]
    v_mfma_f32_16x16x32_bf16 v[224:227], v[196:199], v[212:215], v[224:227]
    v_mfma_f32_16x16x32_bf16 v[224:227], v[200:203], v[216:219], v[224:227]
    ds_read_b128 v[212:215], v26 offset:4608
    ds_read_b128 v[192:195], v29 offset:9216
    ds_read_b128 v[196:199], v29 offset:10240
    ds_read_b64 v[216:217], v27 offset:4608
    ds_read_b128 v[200:203], v29 offset:11264
    s_waitcnt lgkmcnt(5)
    v_mfma_f32_16x16x32_bf16 v[220:223], v[180:183], v[204:207], v[220:223]
    v_mfma_f32_16x16x32_bf16 v[224:227], v[184:187], v[204:207], v[224:227]
    v_mfma_f32_16x16x32_bf16 v[224:227], v[188:191], v[208:211], v[224:227]
    s_waitcnt lgkmcnt(0)
    v_mfma_f32_16x16x32_bf16 v[220:223], v[192:195], v[212:215], v[220:223]
    v_mfma_f32_16x16x32_bf16 v[224:227], v[196:199], v[212:215], v[224:227]
    v_mfma_f32_16x16x32_bf16 v[224:227], v[200:203], v[216:219], v[224:227]
    s_nop 0
    v_cvt_pk_bf16_f32 v220, v220, v221
    v_cvt_pk_bf16_f32 v221, v222, v223
    s_nop 4
    v_cvt_pk_bf16_f32 v222, v224, v225
    v_cvt_pk_bf16_f32 v223, v226, v227
    v_mov_b32 v224, v220
    v_mov_b32 v225, v221
    v_mov_b32_dpp v220, v222 row_ror:8 row_mask:0xf bank_mask:0xc
    v_mov_b32_dpp v221, v223 row_ror:8 row_mask:0xf bank_mask:0xc
    v_mov_b32_dpp v222, v224 row_ror:8 row_mask:0xf bank_mask:0x3
    v_mov_b32_dpp v223, v225 row_ror:8 row_mask:0xf bank_mask:0x3
    v_mov_b32 v80, v220
    v_mov_b32 v81, v221
    v_mov_b32 v82, v222
    v_mov_b32 v83, v223
    s_add_u32 s56, s37, 0
    s_and_b32 s55, s56, 3
    s_mul_i32 s55, s55, 114688
    s_add_u32 s55, s55, 53248
    s_add_u32 s48, s38, s55
    s_and_b32 s55, s56, 1
    s_add_u32 s56, s56, 1
    v_mov_b32 v35, -16
    v_writelane_b32 v35, s56, 12
    s_mul_i32 s55, s55, 12288
    s_add_u32 m0, s54, s55
    s_add_u32 s56, s37, 0
    s_and_b32 s55, s56, 3
    s_mul_i32 s55, s55, 24576
    v_add_u32 v26, s55, v22
    v_add_u32 v27, s55, v23
    s_and_b32 s55, s56, 1
    s_mul_i32 s55, s55, 12288
    v_add_u32 v29, s55, v28
    buffer_load_dword v36, v33, s[4:7], s38 offen sc1
    buffer_load_dword v36, v33, s[4:7], s38 offen sc1
    buffer_load_dword v36, v33, s[4:7], s38 offen sc1
    buffer_load_dword v36, v33, s[4:7], s38 offen sc1
    buffer_load_dword v36, v33, s[4:7], s38 offen sc1
L_sp_109:
    s_waitcnt vmcnt(4)
    v_cmp_lt_i32 vcc, v36, v35
    buffer_load_dword v36, v33, s[4:7], s38 offen sc1
    s_sub_u32 s36, s36, 1
    s_cbranch_scc1 L_exit
    s_cbranch_vccz L_sp_109x
    s_waitcnt vmcnt(4)
    v_cmp_lt_i32 vcc, v36, v35
    buffer_load_dword v36, v33, s[4:7], s38 offen sc1
    s_cbranch_vccz L_sp_109x
    s_waitcnt vmcnt(4)
    v_cmp_lt_i32 vcc, v36, v35
    buffer_load_dword v36, v33, s[4:7], s38 offen sc1
    s_cbranch_vccz L_sp_109x
    s_waitcnt vmcnt(4)
    v_cmp_lt_i32 vcc, v36, v35
    buffer_load_dword v36, v33, s[4:7], s38 offen sc1
    s_cbranch_vccnz L_sp_109
L_sp_109x:
    buffer_load_dwordx4 v37, s[4:7], s48 offen offset:0 sc1 lds
    buffer_load_dwordx4 v37, s[4:7], s48 offen offset:1024 sc1 lds
    buffer_load_dwordx4 v37, s[4:7], s48 offen offset:2048 sc1 lds
    s_waitcnt vmcnt(0)
    s_barrier
    s_mov_b32 s49, 7143424
    buffer_store_dwordx4 v[120:123], v30, s[4:7], s49 offen sc1
    s_mov_b32 s49, 6815744
    buffer_store_dwordx4 v[124:127], v30, s[4:7], s49 offen sc1
    s_mov_b32 s49, 6488064
    buffer_store_dwordx4 v[128:131], v30, s[4:7], s49 offen sc1
    s_mov_b32 s49, 6160384
    buffer_store_dwordx4 v[132:135], v30, s[4:7], s49 offen sc1
    s_mov_b32 s49, 5832704
    buffer_store_dwordx4 v[80:83], v30, s[4:7], s49 offen sc1
    ds_read_b128 v[204:207], v26 offset:0
    ds_read_b128 v[180:183], v29 offset:0
    ds_read_b128 v[184:187], v29 offset:1024
    ds_read_b64 v[208:209], v27 offset:0
    ds_read_b128 v[188:191], v29 offset:2048
    ds_read_b128 v[212:215], v26 offset:1536
    ds_read_b128 v[192:195], v29 offset:3072
    ds_read_b128 v[196:199], v29 offset:4096
    ds_read_b64 v[216:217], v27 offset:1536
    ds_read_b128 v[200:203], v29 offset:5120
    s_waitcnt lgkmcnt(5)
    v_mfma_f32_16x16x32_bf16 v[220:223], v[180:183], v[204:207], 0
    v_mfma_f32_16x16x32_bf16 v[224:227], v[184:187], v[204:207], 0
    v_mfma_f32_16x16x32_bf16 v[224:227], v[188:191], v[208:211], v[224:227]
    ds_read_b128 v[204:207], v26 offset:3072
    ds_read_b128 v[180:183], v29 offset:6144
    ds_read_b128 v[184:187], v29 offset:7168
    ds_read_b64 v[208:209], v27 offset:3072
    ds_read_b128 v[188:191], v29 offset:8192
    s_waitcnt lgkmcnt(5)
    v_mfma_f32_16x16x32_bf16 v[220:223], v[192:195], v[212:215], v[220:223]
    v_mfma_f32_16x16x32_bf16 v[224:227], v[196:199], v[212:215], v[224:227]
    v_mfma_f32_16x16x32_bf16 v[224:227], v[200:203], v[216:219], v[224:227]
    ds_read_b128 v[212:215], v26 offset:4608
    ds_read_b128 v[192:195], v29 offset:9216
    ds_read_b128 v[196:199], v29 offset:10240
    ds_read_b64 v[216:217], v27 offset:4608
    ds_read_b128 v[200:203], v29 offset:11264
    s_waitcnt lgkmcnt(5)
    v_mfma_f32_16x16x32_bf16 v[220:223], v[180:183], v[204:207], v[220:223]
    v_mfma_f32_16x16x32_bf16 v[224:227], v[184:187], v[204:207], v[224:227]
    v_mfma_f32_16x16x32_bf16 v[224:227], v[188:191], v[208:211], v[224:227]
    s_waitcnt lgkmcnt(0)
    v_mfma_f32_16x16x32_bf16 v[220:223], v[192:195], v[212:215], v[220:223]
    v_mfma_f32_16x16x32_bf16 v[224:227], v[196:199], v[212:215], v[224:227]
    v_mfma_f32_16x16x32_bf16 v[224:227], v[200:203], v[216:219], v[224:227]
    s_nop 0
    v_cvt_pk_bf16_f32 v220, v220, v221
    v_cvt_pk_bf16_f32 v221, v222, v223
    s_nop 4
    v_cvt_pk_bf16_f32 v222, v224, v225
    v_cvt_pk_bf16_f32 v223, v226, v227
    v_mov_b32 v224, v220
    v_mov_b32 v225, v221
    v_mov_b32_dpp v220, v222 row_ror:8 row_mask:0xf bank_mask:0xc
    v_mov_b32_dpp v221, v223 row_ror:8 row_mask:0xf bank_mask:0xc
    v_mov_b32_dpp v222, v224 row_ror:8 row_mask:0xf bank_mask:0x3
    v_mov_b32_dpp v223, v225 row_ror:8 row_mask:0xf bank_mask:0x3
    s_mov_b32 s49, 5505024
    buffer_store_dwordx4 v[220:223], v30, s[4:7], s49 offen sc1
    s_waitcnt vmcnt(0)
L_fp_110:
    s_mov_b32 s51, 5505024
    buffer_load_dwordx4 v[96:99], v31, s[4:7], s51 offen sc1
    s_mov_b32 s51, 7143424
    buffer_load_dwordx4 v[148:151], v31, s[4:7], s51 offen sc1
    s_mov_b32 s51, 6815744
    buffer_load_dwordx4 v[152:155], v31, s[4:7], s51 offen sc1
    s_mov_b32 s51, 6488064
    buffer_load_dwordx4 v[156:159], v31, s[4:7], s51 offen sc1
    s_mov_b32 s51, 6160384
    buffer_load_dwordx4 v[160:163], v31, s[4:7], s51 offen sc1
    s_mov_b32 s51, 5832704
    buffer_load_dwordx4 v[92:95], v31, s[4:7], s51 offen sc1
    s_sub_u32 s36, s36, 1
    s_cbranch_scc1 L_exit
    s_waitcnt vmcnt(0)
L_fp_110c:
    v_mov_b32 v41, 0
    v_max3_u32 v41, v41, v96, v97
    v_max3_u32 v41, v41, v98, v99
    v_max3_u32 v41, v41, v148, v149
    v_max3_u32 v41, v41, v150, v151
    v_max3_u32 v41, v41, v152, v153
    v_max3_u32 v41, v41, v154, v155
    v_max3_u32 v41, v41, v156, v157
    v_max3_u32 v41, v41, v158, v159
    v_max3_u32 v41, v41, v160, v161
    v_max3_u32 v41, v41, v162, v163
    v_max3_u32 v41, v41, v92, v93
    v_max3_u32 v41, v41, v94, v95
    v_cmp_eq_u32 vcc, -1, v41
    s_cbranch_vccnz L_fp_110
    s_mov_b32 s52, 5160960
    v_mfma_f32_16x16x32_bf16 v[232:235], a[144:147], v[96:99], 0
    s_nop 7
    v_cndmask_b32 v234, v232, v233, s[58:59]
    v_cndmask_b32 v235, v233, v232, s[58:59]
    s_nop 1
    v_add_f32_dpp v235, v234, v235 row_ror:8 row_mask:0xf bank_mask:0xf
    v_cvt_pk_bf16_f32 v235, v235, v235
    buffer_store_short v235, v32, s[28:31], s52 offen offset:0
    s_mov_b32 s52, 4751360
    v_mfma_f32_16x16x32_bf16 v[232:235], a[144:147], v[148:151], 0
    s_nop 7
    v_cndmask_b32 v234, v232, v233, s[58:59]
    v_cndmask_b32 v235, v233, v232, s[58:59]
    s_nop 1
    v_add_f32_dpp v235, v234, v235 row_ror:8 row_mask:0xf bank_mask:0xf
    v_cvt_pk_bf16_f32 v235, v235, v235
    buffer_store_short v235, v32, s[28:31], s52 offen offset:0
    s_mov_b32 s52, 4833280
    v_mfma_f32_16x16x32_bf16 v[232:235], a[144:147], v[152:155], 0
    s_nop 7
    v_cndmask_b32 v234, v232, v233, s[58:59]
    v_cndmask_b32 v235, v233, v232, s[58:59]
    s_nop 1
    v_add_f32_dpp v235, v234, v235 row_ror:8 row_mask:0xf bank_mask:0xf
    v_cvt_pk_bf16_f32 v235, v235, v235
    buffer_store_short v235, v32, s[28:31], s52 offen offset:0
    s_mov_b32 s52, 4915200
    v_mfma_f32_16x16x32_bf16 v[232:235], a[144:147], v[156:159], 0
    s_nop 7
    v_cndmask_b32 v234, v232, v233, s[58:59]
    v_cndmask_b32 v235, v233, v232, s[58:59]
    s_nop 1
    v_add_f32_dpp v235, v234, v235 row_ror:8 row_mask:0xf bank_mask:0xf
    v_cvt_pk_bf16_f32 v235, v235, v235
    buffer_store_short v235, v32, s[28:31], s52 offen offset:0
    s_mov_b32 s52, 4997120
    v_mfma_f32_16x16x32_bf16 v[232:235], a[144:147], v[160:163], 0
    s_nop 7
    v_cndmask_b32 v234, v232, v233, s[58:59]
    v_cndmask_b32 v235, v233, v232, s[58:59]
    s_nop 1
    v_add_f32_dpp v235, v234, v235 row_ror:8 row_mask:0xf bank_mask:0xf
    v_cvt_pk_bf16_f32 v235, v235, v235
    buffer_store_short v235, v32, s[28:31], s52 offen offset:0
    s_mov_b32 s52, 5079040
    v_mfma_f32_16x16x32_bf16 v[232:235], a[144:147], v[92:95], 0
    s_nop 7
    v_cndmask_b32 v234, v232, v233, s[58:59]
    v_cndmask_b32 v235, v233, v232, s[58:59]
    s_nop 1
    v_add_f32_dpp v235, v234, v235 row_ror:8 row_mask:0xf bank_mask:0xf
    v_cvt_pk_bf16_f32 v235, v235, v235
    buffer_store_short v235, v32, s[28:31], s52 offen offset:0
    s_endpgm
L_fw_87c:
    v_mov_b32 v148, -1
    v_mov_b32 v149, -1
    v_mov_b32 v150, -1
    v_mov_b32 v151, -1
    v_mov_b32 v152, -1
    v_mov_b32 v153, -1
    v_mov_b32 v154, -1
    v_mov_b32 v155, -1
    s_add_u32 s53, s53, 2293760
    buffer_store_dwordx4 v[148:151], v143, s[4:7], s53 offen offset:0 sc1
    buffer_store_dwordx4 v[152:155], v143, s[4:7], s53 offen offset:1024 sc1
    s_sub_u32 s53, s53, 983040
    s_branch L_fw_87
L_vm_97:
    buffer_load_dwordx4 v44, s[4:7], s43 offen offset:0 sc1 lds
    buffer_load_dwordx4 v44, s[4:7], s43 offen offset:1024 sc1 lds
    buffer_load_dwordx4 v44, s[4:7], s43 offen offset:2048 sc1 lds
    s_sub_u32 s36, s36, 1
    s_cbranch_scc1 L_exit
    v_add_u32 v5, s53, v12
    s_waitcnt vmcnt(0)
    ds_read_b128 v[136:139], v5 offset:0
    ds_read_b128 v[140:143], v5 offset:1024
    ds_read_b128 v[144:147], v5 offset:2048
    s_waitcnt lgkmcnt(0)
    v_max_u32 v4, v136, v137
    v_max3_u32 v4, v4, v138, v139
    v_max3_u32 v4, v4, v140, v141
    v_max3_u32 v4, v4, v142, v143
    v_max3_u32 v4, v4, v144, v145
    v_max3_u32 v4, v4, v146, v147
    v_cmp_eq_u32 vcc, -1, v4
    s_cbranch_vccnz L_vm_97
    buffer_load_dwordx4 v[92:95], v38, s[4:7], s43 offen offset:0 sc1
    buffer_load_dwordx4 v[96:99], v38, s[4:7], s43 offen offset:1280 sc1
    buffer_load_dwordx4 v[100:103], v38, s[4:7], s43 offen offset:2560 sc1
    buffer_load_dword v104, v39, s[4:7], s43 offen offset:0 sc1
    buffer_load_dword v105, v39, s[4:7], s43 offen offset:1280 sc1
    buffer_load_dword v106, v39, s[4:7], s43 offen offset:2560 sc1
    ds_read_b64_tr_b16 v[136:137], v16 offset:0
    ds_read_b64_tr_b16 v[138:139], v13 offset:0
    ds_read_b64_tr_b16 v[140:141], v16 offset:1024
    ds_read_b64_tr_b16 v[142:143], v13 offset:1024
    ds_read_b64_tr_b16 v[144:145], v16 offset:2048
    ds_read_b64_tr_b16 v[146:147], v13 offset:2048
    v_mov_b32 v148, 0
    v_mov_b32 v149, 0
    v_mov_b32 v150, 0
    v_mov_b32 v151, 0
    v_mov_b32 v152, 0
    v_mov_b32 v153, 0
    v_mov_b32 v154, 0
    v_mov_b32 v155, 0
    v_mov_b32 v156, 0
    v_mov_b32 v157, 0
    v_mov_b32 v158, 0
    v_mov_b32 v159, 0
    v_mov_b32 v160, 0
    v_mov_b32 v161, 0
    v_mov_b32 v162, 0
    v_mov_b32 v163, 0
    s_waitcnt lgkmcnt(0)
    v_smfmac_f32_16x16x64_bf16 v[148:151], v[136:139], a[0:7], v10
    v_smfmac_f32_16x16x64_bf16 v[152:155], v[136:139], a[24:31], v10
    v_smfmac_f32_16x16x64_bf16 v[156:159], v[136:139], a[48:55], v10
    v_smfmac_f32_16x16x64_bf16 v[160:163], v[136:139], a[72:79], v10
    v_smfmac_f32_16x16x64_bf16 v[148:151], v[140:143], a[8:15], v10
    v_smfmac_f32_16x16x64_bf16 v[152:155], v[140:143], a[32:39], v10
    v_smfmac_f32_16x16x64_bf16 v[156:159], v[140:143], a[56:63], v10
    v_smfmac_f32_16x16x64_bf16 v[160:163], v[140:143], a[80:87], v10
    v_smfmac_f32_16x16x64_bf16 v[148:151], v[144:147], a[16:23], v10
    v_smfmac_f32_16x16x64_bf16 v[152:155], v[144:147], a[40:47], v10
    v_smfmac_f32_16x16x64_bf16 v[156:159], v[144:147], a[64:71], v10
    v_smfmac_f32_16x16x64_bf16 v[160:163], v[144:147], a[88:95], v10
    v_pk_add_f32 v[148:149], v[148:149], v[150:151]
    v_cmp_u_f32 vcc, v148, v149
    v_cvt_pk_bf16_f32 v50, v148, v149
    v_cvt_pk_bf16_f32 v54, v148, v149
    v_pk_add_f32 v[152:153], v[152:153], v[154:155]
    v_cvt_pk_bf16_f32 v58, v152, v153
    v_cvt_pk_bf16_f32 v62, v152, v153
    v_pk_add_f32 v[156:157], v[156:157], v[158:159]
    v_cvt_pk_bf16_f32 v66, v156, v157
    v_cvt_pk_bf16_f32 v70, v156, v157
    v_pk_add_f32 v[160:161], v[160:161], v[162:163]
    v_cvt_pk_bf16_f32 v74, v160, v161
    v_cvt_pk_bf16_f32 v78, v160, v161
    s_cmp_eq_u32 s37, 63
    s_branch L_u_98
L_sp_101:
    v_max3_u32 v4, v104, v105, v106
    v_max3_u32 v4, v4, v92, v93
    v_max3_u32 v4, v4, v94, v95
    v_max3_u32 v4, v4, v96, v97
    v_max3_u32 v4, v4, v98, v99
    v_max3_u32 v4, v4, v100, v101
    v_max3_u32 v4, v4, v102, v103
    v_cmp_eq_u32 vcc, -1, v4
    s_cbranch_vccz L_sg_102
    buffer_load_dwordx4 v[92:95], v38, s[4:7], s43 offen offset:0 sc1
    buffer_load_dwordx4 v[96:99], v38, s[4:7], s43 offen offset:1280 sc1
    buffer_load_dwordx4 v[100:103], v38, s[4:7], s43 offen offset:2560 sc1
    buffer_load_dword v104, v39, s[4:7], s43 offen offset:0 sc1
    buffer_load_dword v105, v39, s[4:7], s43 offen offset:1280 sc1
    buffer_load_dword v106, v39, s[4:7], s43 offen offset:2560 sc1
    s_sub_u32 s36, s36, 1
    s_cbranch_scc1 L_exit
    s_branch L_sc_100
L_px_s:
    v_and_b32 v1, 15, v0
    v_lshrrev_b32 v2, 4, v0
    s_mul_i32 s90, s32, 12288
    v_lshl_add_u32 v10, v0, 4, s90
    s_mul_i32 s90, s32, 3072
    v_lshl_add_u32 v12, v0, 4, s90
    v_lshrrev_b32 v3, 2, v1
    v_lshlrev_b32 v3, 1, v3
    v_and_b32 v4, 1, v1
    v_or_b32 v3, v3, v4
    v_lshl_add_u32 v3, v2, 3, v3
    v_lshl_add_u32 v11, v3, 4, s90
    s_lshl_b32 s90, s32, 7
    v_min_u32 v3, 11, v0
    v_lshl_add_u32 v3, v3, 2, s90
    v_add_u32 v13, 458752, v3
    v_min_u32 v3, 2, v0
    v_lshl_add_u32 v3, v3, 2, s90
    v_add_u32 v14, 459264, v3
    v_add_u32 v22, 462336, v3
    s_add_u32 s90, s90, 459776
    v_mov_b32 v15, s90
    v_cmp_eq_u32 vcc, 0, v0
    v_mov_b32 v9, 2146435072
    s_nop 0
    v_cndmask_b32 v15, v9, v15, vcc
    s_nop 0
    v_mov_b32 v21, 0xd04e79ff
    s_mov_b32 s44, 0x3dd53b95
    v_lshl_add_u32 v3, v2, 2, 0
    v_cmp_le_u32 s[48:49], v3, v1
    v_lshl_add_u32 v3, v2, 2, 1
    v_cmp_le_u32 s[50:51], v3, v1
    v_lshl_add_u32 v3, v2, 2, 2
    v_cmp_le_u32 s[52:53], v3, v1
    v_lshl_add_u32 v3, v2, 2, 3
    v_cmp_le_u32 s[54:55], v3, v1
    v_mov_b32 v167, 0
    v_mov_b32 v171, 0
    v_mov_b32 v174, 0
    v_mov_b32 v175, 0
    s_waitcnt vmcnt(0)
    s_barrier
    s_mov_b32 s37, 0
    s_or_b32 s90, s34, s32
    s_cbranch_scc1 L_xg_111c
    v_lshlrev_b32 v1, 2, v0
L_arp_113:
    buffer_load_dword v2, v1, s[8:11], 0 offen sc1
    s_sub_u32 s36, s36, 1
    s_cbranch_scc1 L_exit
    s_waitcnt vmcnt(0)
    v_readlane_b32 s92, v2, 17
    s_nop 0
    s_cmp_lg_u32 s92, 256
    s_cbranch_scc1 L_arp_113
    v_mov_b32 v1, 196
    v_mov_b32 v2, 1
    s_mov_b64 exec, 1
    buffer_store_dword v2, v1, s[8:11], 0 offen sc1
    s_mov_b64 exec, -1
L_arr_112:
L_xg_111c:
    s_barrier
    v_mov_b32 v1, 196
L_gw_114:
    buffer_load_dword v2, v1, s[8:11], 0 offen sc1
    s_sub_u32 s36, s36, 1
    s_cbranch_scc1 L_exit
    s_waitcnt vmcnt(0)
    v_readfirstlane_b32 s90, v2
    s_nop 0
    s_cmp_eq_u32 s90, 0
    s_cbranch_scc1 L_gw_114
    s_cmp_lg_u32 s32, 0
    s_cbranch_scc1 L_xg_111
    s_lshl_b32 s92, s34, 14
    s_add_u32 s92, s92, 1966080
    s_add_u32 s93, s92, 8192
    v_lshlrev_b32 v3, 4, v0
    buffer_store_dwordx4 v[24:27], v3, s[4:7], s92 offen offset:0 sc1
    buffer_store_dwordx4 v[24:27], v3, s[4:7], s93 offen offset:0 sc1
    buffer_store_dwordx4 v[24:27], v3, s[4:7], s92 offen offset:1024 sc1
    buffer_store_dwordx4 v[24:27], v3, s[4:7], s93 offen offset:1024 sc1
    buffer_store_dwordx4 v[24:27], v3, s[4:7], s92 offen offset:2048 sc1
    buffer_store_dwordx4 v[24:27], v3, s[4:7], s93 offen offset:2048 sc1
    buffer_store_dwordx4 v[24:27], v3, s[4:7], s92 offen offset:3072 sc1
    buffer_store_dwordx4 v[24:27], v3, s[4:7], s93 offen offset:3072 sc1
    v_mov_b32 v3, 0
    s_mov_b32 s56, -1
    s_mov_b32 s57, -1
    s_mov_b32 s62, 0
    s_mov_b32 s63, 0
    s_waitcnt vmcnt(0)
L_pr_115:
    s_memtime s[58:59]
    s_waitcnt lgkmcnt(0)
    buffer_load_dword v4, v3, s[4:7], s92 offen sc1
    s_waitcnt vmcnt(0)
    s_memtime s[60:61]
    s_waitcnt lgkmcnt(0)
    s_sub_u32 s60, s60, s58
    s_min_u32 s56, s56, s60
    s_memtime s[58:59]
    s_waitcnt lgkmcnt(0)
    buffer_load_dword v4, v3, s[4:7], s93 offen sc1
    s_waitcnt vmcnt(0)
    s_memtime s[60:61]
    s_waitcnt lgkmcnt(0)
    s_sub_u32 s60, s60, s58
    s_min_u32 s57, s57, s60
    buffer_load_dword v4, v13, s[4:7], s38 offen sc1
    v_add_u32 v3, 128, v3
    s_add_u32 s62, s62, 1
    s_waitcnt vmcnt(0)
    v_cmp_eq_u32 vcc, 0, v4
    s_nop 0
    s_cmp_eq_u64 vcc, 0
    s_addc_u32 s63, s63, 0
    s_cmp_ge_u32 s63, 2
    s_cselect_b32 s62, 32, s62
    s_min_u32 s58, s56, s57
    s_max_u32 s59, s56, s57
    s_sub_u32 s59, s59, s58
    s_cmp_ge_u32 s59, 150
    s_cselect_b32 s58, s58, -1
    s_cmp_le_u32 s58, 540
    s_cselect_b32 s62, 32, s62
    s_cmp_lt_u32 s62, 32
    s_cbranch_scc1 L_pr_115
    s_cmp_lt_u32 s57, s56
    s_cselect_b32 s62, 2, 1
    s_nop 0
    v_mov_b32 v3, 460288
    v_mov_b32 v4, s62
    buffer_store_dword v4, v3, s[4:7], s38 offen sc1
    s_cmp_lg_u32 s34, 0
    s_cbranch_scc1 L_xg_111
    v_mov_b32 v3, 204
    buffer_store_dword v4, v3, s[8:11], 0 offen sc1
L_xg_111:
    s_barrier
    s_add_u32 s41, s38, 475136
    buffer_load_dword v16, v22, s[4:7], s38 offen sc1
    buffer_load_dword v16, v22, s[4:7], s38 offen sc1
L_sp_116:
    s_waitcnt vmcnt(1)
    v_cmp_ge_u32 vcc, s37, v16
    buffer_load_dword v16, v22, s[4:7], s38 offen sc1
    s_sub_u32 s36, s36, 1
    s_cbranch_scc1 L_exit
    s_cbranch_vccz L_sp_116x
    s_waitcnt vmcnt(1)
    v_cmp_ge_u32 vcc, s37, v16
    buffer_load_dword v16, v22, s[4:7], s38 offen sc1
    s_cbranch_vccz L_sp_116x
    s_waitcnt vmcnt(1)
    v_cmp_ge_u32 vcc, s37, v16
    buffer_load_dword v16, v22, s[4:7], s38 offen sc1
    s_cbranch_vccz L_sp_116x
    s_waitcnt vmcnt(1)
    v_cmp_ge_u32 vcc, s37, v16
    buffer_load_dword v16, v22, s[4:7], s38 offen sc1
    s_cbranch_vccnz L_sp_116
L_sp_116x:
    s_add_u32 s90, s41, 49152
    buffer_load_dwordx4 v[72:75], v10, s[4:7], s90 offen offset:0 sc1
    buffer_load_dwordx4 v[76:79], v10, s[4:7], s90 offen offset:1024 sc1
    buffer_load_dwordx4 v[80:83], v10, s[4:7], s90 offen offset:2048 sc1
    buffer_load_dwordx4 v[84:87], v10, s[4:7], s90 offen offset:3072 sc1
    s_add_u32 s90, s41, 53248
    buffer_load_dwordx4 v[88:91], v10, s[4:7], s90 offen offset:0 sc1
    buffer_load_dwordx4 v[92:95], v10, s[4:7], s90 offen offset:1024 sc1
    buffer_load_dwordx4 v[96:99], v10, s[4:7], s90 offen offset:2048 sc1
    buffer_load_dwordx4 v[100:103], v10, s[4:7], s90 offen offset:3072 sc1
    s_add_u32 s90, s41, 57344
    buffer_load_dwordx4 v[104:107], v10, s[4:7], s90 offen offset:0 sc1
    buffer_load_dwordx4 v[108:111], v10, s[4:7], s90 offen offset:1024 sc1
    buffer_load_dwordx4 v[112:115], v10, s[4:7], s90 offen offset:2048 sc1
    buffer_load_dwordx4 v[116:119], v10, s[4:7], s90 offen offset:3072 sc1
    s_add_u32 s90, s41, 0
    buffer_load_dwordx4 v[24:27], v10, s[4:7], s90 offen offset:0 sc1
    buffer_load_dwordx4 v[28:31], v10, s[4:7], s90 offen offset:1024 sc1
    buffer_load_dwordx4 v[32:35], v10, s[4:7], s90 offen offset:2048 sc1
    buffer_load_dwordx4 v[36:39], v10, s[4:7], s90 offen offset:3072 sc1
    s_add_u32 s90, s41, 4096
    buffer_load_dwordx4 v[40:43], v10, s[4:7], s90 offen offset:0 sc1
    buffer_load_dwordx4 v[44:47], v10, s[4:7], s90 offen offset:1024 sc1
    buffer_load_dwordx4 v[48:51], v10, s[4:7], s90 offen offset:2048 sc1
    buffer_load_dwordx4 v[52:55], v10, s[4:7], s90 offen offset:3072 sc1
    s_add_u32 s90, s41, 8192
    buffer_load_dwordx4 v[56:59], v10, s[4:7], s90 offen offset:0 sc1
    buffer_load_dwordx4 v[60:63], v10, s[4:7], s90 offen offset:1024 sc1
    buffer_load_dwordx4 v[64:67], v10, s[4:7], s90 offen offset:2048 sc1
    buffer_load_dwordx4 v[68:71], v10, s[4:7], s90 offen offset:3072 sc1
    s_waitcnt vmcnt(0)
L_px_loop_s:
    s_and_b32 s90, s37, 3
    s_mul_i32 s91, s90, 114688
    s_add_u32 s91, s91, s38
    s_add_u32 s42, s91, 40960
    s_add_u32 s43, s91, 53248
    s_add_u32 s90, s37, 1
    v_mov_b32 v17, s90
    s_and_b32 s90, s90, 3
    s_mul_i32 s91, s90, 98304
    s_add_u32 s91, s91, 475136
    s_add_u32 s41, s38, s91
    v_mfma_f32_16x16x32_bf16 v[144:147], v[72:75], v[24:27], 0
    v_mfma_f32_16x16x32_bf16 v[152:155], v[72:75], v[48:51], 0
    v_mfma_f32_16x16x32_bf16 v[156:159], v[96:99], v[48:51], 0
    v_mfma_f32_16x16x32_bf16 v[144:147], v[76:79], v[28:31], v[144:147]
    v_mfma_f32_16x16x32_bf16 v[152:155], v[76:79], v[52:55], v[152:155]
    v_mfma_f32_16x16x32_bf16 v[156:159], v[100:103], v[52:55], v[156:159]
    v_mfma_f32_16x16x32_bf16 v[144:147], v[80:83], v[32:35], v[144:147]
    v_mfma_f32_16x16x32_bf16 v[152:155], v[80:83], v[56:59], v[152:155]
    v_mfma_f32_16x16x32_bf16 v[156:159], v[104:107], v[56:59], v[156:159]
    v_mfma_f32_16x16x32_bf16 v[144:147], v[84:87], v[36:39], v[144:147]
    v_mfma_f32_16x16x32_bf16 v[152:155], v[84:87], v[60:63], v[152:155]
    v_mfma_f32_16x16x32_bf16 v[156:159], v[108:111], v[60:63], v[156:159]
    v_mfma_f32_16x16x32_bf16 v[144:147], v[88:91], v[40:43], v[144:147]
    v_mfma_f32_16x16x32_bf16 v[152:155], v[88:91], v[64:67], v[152:155]
    v_mfma_f32_16x16x32_bf16 v[156:159], v[112:115], v[64:67], v[156:159]
    v_mfma_f32_16x16x32_bf16 v[144:147], v[92:95], v[44:47], v[144:147]
    v_mfma_f32_16x16x32_bf16 v[152:155], v[92:95], v[68:71], v[152:155]
    v_mfma_f32_16x16x32_bf16 v[156:159], v[116:119], v[68:71], v[156:159]
    s_nop 0
    v_cndmask_b32 v144, v21, v144, s[48:49]
    v_cndmask_b32 v145, v21, v145, s[50:51]
    v_cndmask_b32 v146, v21, v146, s[52:53]
    v_cndmask_b32 v147, v21, v147, s[54:55]
    s_nop 2
    v_cndmask_b32 v156, v21, v156, s[48:49]
    v_cndmask_b32 v157, v21, v157, s[50:51]
    v_cndmask_b32 v158, v21, v158, s[52:53]
    v_cndmask_b32 v159, v21, v159, s[54:55]
    buffer_load_dword v16, v14, s[4:7], s38 offen sc1
    buffer_load_dword v16, v14, s[4:7], s38 offen sc1
L_sp_117:
    s_waitcnt vmcnt(1)
    v_cmp_ge_u32 vcc, s37, v16
    buffer_load_dword v16, v14, s[4:7], s38 offen sc1
    s_sub_u32 s36, s36, 1
    s_cbranch_scc1 L_exit
    s_cbranch_vccz L_sp_117x
    s_waitcnt vmcnt(1)
    v_cmp_ge_u32 vcc, s37, v16
    buffer_load_dword v16, v14, s[4:7], s38 offen sc1
    s_cbranch_vccz L_sp_117x
    s_waitcnt vmcnt(1)
    v_cmp_ge_u32 vcc, s37, v16
    buffer_load_dword v16, v14, s[4:7], s38 offen sc1
    s_cbranch_vccz L_sp_117x
    s_waitcnt vmcnt(1)
    v_cmp_ge_u32 vcc, s37, v16
    buffer_load_dword v16, v14, s[4:7], s38 offen sc1
    s_cbranch_vccnz L_sp_117
L_sp_117x:
    buffer_load_dwordx4 v[120:123], v11, s[4:7], s42 offen offset:0 sc1
    buffer_load_dwordx4 v[124:127], v11, s[4:7], s42 offen offset:512 sc1
    buffer_load_dwordx4 v[128:131], v11, s[4:7], s42 offen offset:1024 sc1
    buffer_load_dwordx4 v[132:135], v11, s[4:7], s42 offen offset:1536 sc1
    buffer_load_dwordx4 v[136:139], v11, s[4:7], s42 offen offset:2048 sc1
    buffer_load_dwordx4 v[140:143], v11, s[4:7], s42 offen offset:2560 sc1
    s_waitcnt vmcnt(5)
    v_mfma_f32_16x16x32_bf16 v[148:151], v[120:123], v[24:27], 0
    v_mfma_f32_16x16x32_bf16 v[160:163], v[120:123], v[48:51], 0
    s_waitcnt vmcnt(4)
    v_mfma_f32_16x16x32_bf16 v[148:151], v[124:127], v[28:31], v[148:151]
    v_mfma_f32_16x16x32_bf16 v[160:163], v[124:127], v[52:55], v[160:163]
    s_waitcnt vmcnt(3)
    v_mfma_f32_16x16x32_bf16 v[148:151], v[128:131], v[32:35], v[148:151]
    v_mfma_f32_16x16x32_bf16 v[160:163], v[128:131], v[56:59], v[160:163]
    s_waitcnt vmcnt(2)
    v_mfma_f32_16x16x32_bf16 v[148:151], v[132:135], v[36:39], v[148:151]
    v_mfma_f32_16x16x32_bf16 v[160:163], v[132:135], v[60:63], v[160:163]
    s_waitcnt vmcnt(1)
    v_mfma_f32_16x16x32_bf16 v[148:151], v[136:139], v[40:43], v[148:151]
    v_mfma_f32_16x16x32_bf16 v[160:163], v[136:139], v[64:67], v[160:163]
    s_waitcnt vmcnt(0)
    v_mfma_f32_16x16x32_bf16 v[148:151], v[140:143], v[44:47], v[148:151]
    v_mfma_f32_16x16x32_bf16 v[160:163], v[140:143], v[68:71], v[160:163]
    s_cmp_eq_u32 s37, 63
    s_nop 2
    s_cbranch_scc1 L_pxl_118
    s_add_u32 s90, s41, 49152
    v_max_f32 v18, v144, v145
    v_max3_f32 v18, v18, v146, v147
    v_max3_f32 v18, v18, v148, v149
    v_mov_b32 v19, v18
    buffer_load_dwordx4 v[72:75], v10, s[4:7], s90 offen offset:0 sc1
    s_nop 0
    v_permlane16_swap_b32 v18, v19
    v_max_f32 v18, v18, v19
    v_mov_b32 v19, v18
    s_nop 1
    v_permlane32_swap_b32 v18, v19
    buffer_load_dwordx4 v[76:79], v10, s[4:7], s90 offen offset:1024 sc1
    v_max_f32 v18, v18, v19
    v_mul_f32 v18, 0xbdd53b95, v18
    v_fma_f32 v144, v144, s44, v18
    v_fma_f32 v145, v145, s44, v18
    buffer_load_dwordx4 v[80:83], v10, s[4:7], s90 offen offset:2048 sc1
    v_fma_f32 v146, v146, s44, v18
    v_fma_f32 v147, v147, s44, v18
    v_fma_f32 v148, v148, s44, v18
    v_fma_f32 v149, v149, s44, v18
    buffer_load_dwordx4 v[84:87], v10, s[4:7], s90 offen offset:3072 sc1
    v_exp_f32 v144, v144
    v_exp_f32 v145, v145
    v_exp_f32 v146, v146
    v_exp_f32 v147, v147
    s_add_u32 s90, s41, 53248
    v_exp_f32 v148, v148
    v_exp_f32 v149, v149
    v_add_f32 v20, v144, v145
    v_add_f32 v20, v20, v146
    buffer_load_dwordx4 v[88:91], v10, s[4:7], s90 offen offset:0 sc1
    v_add_f32 v20, v20, v147
    v_add_f32 v20, v20, v148
    v_add_f32 v20, v20, v149
    v_mov_b32 v19, v20
    buffer_load_dwordx4 v[92:95], v10, s[4:7], s90 offen offset:1024 sc1
    s_nop 0
    v_permlane16_swap_b32 v20, v19
    v_add_f32 v20, v20, v19
    v_mov_b32 v19, v20
    s_nop 1
    v_permlane32_swap_b32 v20, v19
    buffer_load_dwordx4 v[96:99], v10, s[4:7], s90 offen offset:2048 sc1
    v_add_f32 v20, v20, v19
    v_rcp_f32 v20, v20
    s_nop 0
    v_mul_f32 v144, v144, v20
    v_mul_f32 v145, v145, v20
    buffer_load_dwordx4 v[100:103], v10, s[4:7], s90 offen offset:3072 sc1
    v_mul_f32 v146, v146, v20
    v_mul_f32 v147, v147, v20
    v_mul_f32 v148, v148, v20
    v_mul_f32 v149, v149, v20
    s_add_u32 s90, s41, 57344
    v_cvt_pk_bf16_f32 v164, v144, v145
    v_cvt_pk_bf16_f32 v165, v146, v147
    v_cvt_pk_bf16_f32 v166, v148, v149
    v_max_f32 v18, v152, v153
    buffer_load_dwordx4 v[104:107], v10, s[4:7], s90 offen offset:0 sc1
    v_max3_f32 v18, v18, v154, v155
    v_max3_f32 v18, v18, v160, v161
    v_max3_f32 v18, v18, v156, v157
    v_max3_f32 v18, v18, v158, v159
    buffer_load_dwordx4 v[108:111], v10, s[4:7], s90 offen offset:1024 sc1
    v_mov_b32 v19, v18
    s_nop 1
    v_permlane16_swap_b32 v18, v19
    v_max_f32 v18, v18, v19
    v_mov_b32 v19, v18
    buffer_load_dwordx4 v[112:115], v10, s[4:7], s90 offen offset:2048 sc1
    s_nop 0
    v_permlane32_swap_b32 v18, v19
    v_max_f32 v18, v18, v19
    v_mul_f32 v18, 0xbdd53b95, v18
    v_fma_f32 v152, v152, s44, v18
    buffer_load_dwordx4 v[116:119], v10, s[4:7], s90 offen offset:3072 sc1
    v_fma_f32 v153, v153, s44, v18
    v_fma_f32 v154, v154, s44, v18
    v_fma_f32 v155, v155, s44, v18
    v_fma_f32 v160, v160, s44, v18
    s_add_u32 s90, s41, 0
    v_fma_f32 v161, v161, s44, v18
    v_fma_f32 v156, v156, s44, v18
    v_fma_f32 v157, v157, s44, v18
    v_fma_f32 v158, v158, s44, v18
    buffer_load_dwordx4 v[24:27], v10, s[4:7], s90 offen offset:0 sc1
    v_fma_f32 v159, v159, s44, v18
    v_exp_f32 v152, v152
    v_exp_f32 v153, v153
    v_exp_f32 v154, v154
    buffer_load_dwordx4 v[28:31], v10, s[4:7], s90 offen offset:1024 sc1
    v_exp_f32 v155, v155
    v_exp_f32 v160, v160
    v_exp_f32 v161, v161
    v_exp_f32 v156, v156
    buffer_load_dwordx4 v[32:35], v10, s[4:7], s90 offen offset:2048 sc1
    v_exp_f32 v157, v157
    v_exp_f32 v158, v158
    v_exp_f32 v159, v159
    v_add_f32 v20, v152, v153
    buffer_load_dwordx4 v[36:39], v10, s[4:7], s90 offen offset:3072 sc1
    v_add_f32 v20, v20, v154
    v_add_f32 v20, v20, v155
    v_add_f32 v20, v20, v160
    v_add_f32 v20, v20, v161
    s_add_u32 s90, s41, 4096
    v_add_f32 v20, v20, v156
    v_add_f32 v20, v20, v157
    v_add_f32 v20, v20, v158
    v_add_f32 v20, v20, v159
    buffer_load_dwordx4 v[40:43], v10, s[4:7], s90 offen offset:0 sc1
    v_mov_b32 v19, v20
    s_nop 1
    v_permlane16_swap_b32 v20, v19
    v_add_f32 v20, v20, v19
    v_mov_b32 v19, v20
    buffer_load_dwordx4 v[44:47], v10, s[4:7], s90 offen offset:1024 sc1
    s_nop 0
    v_permlane32_swap_b32 v20, v19
    v_add_f32 v20, v20, v19
    v_rcp_f32 v20, v20
    s_nop 0
    v_mul_f32 v152, v152, v20
    buffer_load_dwordx4 v[48:51], v10, s[4:7], s90 offen offset:2048 sc1
    v_mul_f32 v153, v153, v20
    v_mul_f32 v154, v154, v20
    v_mul_f32 v155, v155, v20
    v_mul_f32 v160, v160, v20
    buffer_load_dwordx4 v[52:55], v10, s[4:7], s90 offen offset:3072 sc1
    v_mul_f32 v161, v161, v20
    v_mul_f32 v156, v156, v20
    v_mul_f32 v157, v157, v20
    v_mul_f32 v158, v158, v20
    s_add_u32 s90, s41, 8192
    v_mul_f32 v159, v159, v20
    v_cvt_pk_bf16_f32 v168, v152, v153
    v_cvt_pk_bf16_f32 v169, v154, v155
    v_cvt_pk_bf16_f32 v170, v160, v161
    buffer_load_dwordx4 v[56:59], v10, s[4:7], s90 offen offset:0 sc1
    v_cvt_pk_bf16_f32 v172, v156, v157
    v_cvt_pk_bf16_f32 v173, v158, v159
    buffer_load_dwordx4 v[60:63], v10, s[4:7], s90 offen offset:1024 sc1
    buffer_load_dwordx4 v[64:67], v10, s[4:7], s90 offen offset:2048 sc1
    buffer_load_dwordx4 v[68:71], v10, s[4:7], s90 offen offset:3072 sc1
    buffer_store_dwordx4 v[164:167], v12, s[4:7], s43 offen offset:0 sc1
    buffer_store_dwordx4 v[168:171], v12, s[4:7], s43 offen offset:1024 sc1
    buffer_store_dwordx4 v[172:175], v12, s[4:7], s43 offen offset:2048 sc1
    s_waitcnt vmcnt(0)
    buffer_store_dword v17, v15, s[4:7], s38 offen sc1
    s_add_u32 s37, s37, 1
    s_branch L_px_loop_s
L_pxl_118:
    v_max_f32 v18, v144, v145
    v_max3_f32 v18, v18, v146, v147
    v_max3_f32 v18, v18, v148, v149
    v_mov_b32 v19, v18
    s_nop 1
    v_permlane16_swap_b32 v18, v19
    v_max_f32 v18, v18, v19
    v_mov_b32 v19, v18
    s_nop 1
    v_permlane32_swap_b32 v18, v19
    v_max_f32 v18, v18, v19
    v_mul_f32 v18, 0xbdd53b95, v18
    v_fma_f32 v144, v144, s44, v18
    v_fma_f32 v145, v145, s44, v18
    v_fma_f32 v146, v146, s44, v18
    v_fma_f32 v147, v147, s44, v18
    v_fma_f32 v148, v148, s44, v18
    v_fma_f32 v149, v149, s44, v18
    v_exp_f32 v144, v144
    v_exp_f32 v145, v145
    v_exp_f32 v146, v146
    v_exp_f32 v147, v147
    v_exp_f32 v148, v148
    v_exp_f32 v149, v149
    v_add_f32 v20, v144, v145
    v_add_f32 v20, v20, v146
    v_add_f32 v20, v20, v147
    v_add_f32 v20, v20, v148
    v_add_f32 v20, v20, v149
    v_mov_b32 v19, v20
    s_nop 1
    v_permlane16_swap_b32 v20, v19
    v_add_f32 v20, v20, v19
    v_mov_b32 v19, v20
    s_nop 1
    v_permlane32_swap_b32 v20, v19
    v_add_f32 v20, v20, v19
    v_rcp_f32 v20, v20
    s_nop 0
    v_mul_f32 v144, v144, v20
    v_mul_f32 v145, v145, v20
    v_mul_f32 v146, v146, v20
    v_mul_f32 v147, v147, v20
    v_mul_f32 v148, v148, v20
    v_mul_f32 v149, v149, v20
    v_cvt_pk_bf16_f32 v164, v144, v145
    v_cvt_pk_bf16_f32 v165, v146, v147
    v_cvt_pk_bf16_f32 v166, v148, v149
    v_max_f32 v18, v152, v153
    v_max3_f32 v18, v18, v154, v155
    v_max3_f32 v18, v18, v160, v161
    v_max3_f32 v18, v18, v156, v157
    v_max3_f32 v18, v18, v158, v159
    v_mov_b32 v19, v18
    s_nop 1
    v_permlane16_swap_b32 v18, v19
    v_max_f32 v18, v18, v19
    v_mov_b32 v19, v18
    s_nop 1
    v_permlane32_swap_b32 v18, v19
    v_max_f32 v18, v18, v19
    v_mul_f32 v18, 0xbdd53b95, v18
    v_fma_f32 v152, v152, s44, v18
    v_fma_f32 v153, v153, s44, v18
    v_fma_f32 v154, v154, s44, v18
    v_fma_f32 v155, v155, s44, v18
    v_fma_f32 v160, v160, s44, v18
    v_fma_f32 v161, v161, s44, v18
    v_fma_f32 v156, v156, s44, v18
    v_fma_f32 v157, v157, s44, v18
    v_fma_f32 v158, v158, s44, v18
    v_fma_f32 v159, v159, s44, v18
    v_exp_f32 v152, v152
    v_exp_f32 v153, v153
    v_exp_f32 v154, v154
    v_exp_f32 v155, v155
    v_exp_f32 v160, v160
    v_exp_f32 v161, v161
    v_exp_f32 v156, v156
    v_exp_f32 v157, v157
    v_exp_f32 v158, v158
    v_exp_f32 v159, v159
    v_add_f32 v20, v152, v153
    v_add_f32 v20, v20, v154
    v_add_f32 v20, v20, v155
    v_add_f32 v20, v20, v160
    v_add_f32 v20, v20, v161
    v_add_f32 v20, v20, v156
    v_add_f32 v20, v20, v157
    v_add_f32 v20, v20, v158
    v_add_f32 v20, v20, v159
    v_mov_b32 v19, v20
    s_nop 1
    v_permlane16_swap_b32 v20, v19
    v_add_f32 v20, v20, v19
    v_mov_b32 v19, v20
    s_nop 1
    v_permlane32_swap_b32 v20, v19
    v_add_f32 v20, v20, v19
    v_rcp_f32 v20, v20
    s_nop 0
    v_mul_f32 v152, v152, v20
    v_mul_f32 v153, v153, v20
    v_mul_f32 v154, v154, v20
    v_mul_f32 v155, v155, v20
    v_mul_f32 v160, v160, v20
    v_mul_f32 v161, v161, v20
    v_mul_f32 v156, v156, v20
    v_mul_f32 v157, v157, v20
    v_mul_f32 v158, v158, v20
    v_mul_f32 v159, v159, v20
    v_cvt_pk_bf16_f32 v168, v152, v153
    v_cvt_pk_bf16_f32 v169, v154, v155
    v_cvt_pk_bf16_f32 v170, v160, v161
    v_cvt_pk_bf16_f32 v172, v156, v157
    v_cvt_pk_bf16_f32 v173, v158, v159
    buffer_store_dwordx4 v[164:167], v12, s[4:7], s43 offen offset:0 sc1
    buffer_store_dwordx4 v[168:171], v12, s[4:7], s43 offen offset:1024 sc1
    buffer_store_dwordx4 v[172:175], v12, s[4:7], s43 offen offset:2048 sc1
    s_waitcnt vmcnt(0)
    buffer_store_dword v17, v15, s[4:7], s38 offen sc1
    s_endpgm
L_pa_s:
    v_mov_b32 v1, 196
L_gw_119:
    buffer_load_dword v2, v1, s[8:11], 0 offen sc1
    s_sub_u32 s36, s36, 1
    s_cbranch_scc1 L_exit
    s_waitcnt vmcnt(0)
    v_readfirstlane_b32 s90, v2
    s_nop 0
    s_cmp_eq_u32 s90, 0
    s_cbranch_scc1 L_gw_119
    s_branch L_pa_body
.section .rodata,"a"
.p2align 6
.amdhsa_kernel concat_heads__sliding_local_dilated__memory_aug_recurrent_mem_tr__prompt_kernel
  .amdhsa_next_free_vgpr 512
  .amdhsa_next_free_sgpr 102
  .amdhsa_accum_offset 256
  .amdhsa_group_segment_fixed_size 0
  .amdhsa_kernarg_size 104
  .amdhsa_user_sgpr_count 2
  .amdhsa_user_sgpr_kernarg_segment_ptr 1
  .amdhsa_system_sgpr_workgroup_id_x 1
  .amdhsa_float_denorm_mode_32 3
.end_amdhsa_kernel
```

```asm
; @launch grid=(256,1,1) block=(256,1,1) lds=163840
.amdgcn_target "amdgcn-amd-amdhsa--gfx950"
.text
.globl concat_heads__sliding_local_dilated__memory_aug_recurrent_mem_tr__prompt_kernel
.p2align 8
.type concat_heads__sliding_local_dilated__memory_aug_recurrent_mem_tr__prompt_kernel,@function
concat_heads__sliding_local_dilated__memory_aug_recurrent_mem_tr__prompt_kernel:
    s_cmp_ge_u32 s2, 256
    s_cbranch_scc1 L_exit
    s_load_dwordx16 s[64:79], s[0:1], 0
    s_load_dwordx8 s[80:87], s[0:1], 64
    s_load_dwordx2 s[88:89], s[0:1], 96
    s_getreg_b32 s33, hwreg(HW_REG_XCC_ID, 0, 4)
    v_lshrrev_b32 v1, 6, v0
    v_and_b32 v0, 63, v0
    v_readfirstlane_b32 s32, v1
    s_mov_b32 s36, 0x40000
    s_mov_b32 s96, 0
    s_mov_b32 s97, 0
    s_and_b32 s90, s33, 4
    s_lshl_b32 s90, s90, 5
    s_and_b32 s91, s33, 3
    s_lshl_b32 s91, s91, 2
    s_add_u32 s90, s90, s91
    s_lshr_b32 s91, s33, 3
    s_lshl_b32 s91, s91, 4
    s_add_u32 s90, s90, s91
    v_mov_b32 v1, s90
    v_mov_b32 v2, 1
    v_mov_b32 v3, 0
    s_waitcnt lgkmcnt(0)
    s_mov_b32 s8, s86
    s_and_b32 s9, s87, 0xffff
    s_mov_b32 s10, 256
    s_mov_b32 s11, 0x20000
    s_mov_b32 s4, s88
    s_and_b32 s5, s89, 0xffff
    s_mov_b32 s6, 33554432
    s_mov_b32 s7, 0x20000
    s_mov_b32 s28, s84
    s_and_b32 s29, s85, 0xffff
    s_mov_b32 s30, 5242880
    s_mov_b32 s31, 0x20000
    s_cmp_lg_u32 s32, 0
    s_cbranch_scc1 L_norank
    s_mov_b64 exec, 1
    buffer_atomic_add v2, v1, s[8:11], 0 offen sc0 sc1
    s_waitcnt vmcnt(0)
    ds_write_b32 v3, v2
    s_mov_b64 exec, -1
    s_waitcnt lgkmcnt(0)
    s_branch L_rank
L_norank:
    s_and_b32 s34, s33, 7
    s_lshr_b32 s93, s2, 3
    s_mul_i32 s93, s93, 3
    s_add_u32 s93, s93, s32
    s_sub_u32 s93, s93, 1
    v_add_u32 v4, 0, v0
    v_cmp_le_u32 vcc, 96, v4
    v_subrev_u32 v5, 96, v4
    s_nop 0
    v_cndmask_b32 v4, v4, v5, vcc
    v_lshlrev_b32 v4, 4, v4
    v_mov_b32 v5, 12288
    v_cndmask_b32 v5, 0, v5, vcc
    s_mul_i32 s90, s34, 1536
    v_add3_u32 v6, v4, v5, s90
    v_add_u32 v4, 64, v0
    v_cmp_le_u32 vcc, 96, v4
    v_subrev_u32 v5, 96, v4
    s_nop 0
    v_cndmask_b32 v4, v4, v5, vcc
    v_lshlrev_b32 v4, 4, v4
    v_mov_b32 v5, 12288
    v_cndmask_b32 v5, 0, v5, vcc
    s_mul_i32 s90, s34, 1536
    v_add3_u32 v7, v4, v5, s90
    v_add_u32 v4, 128, v0
    v_cmp_le_u32 vcc, 96, v4
    v_subrev_u32 v5, 96, v4
    s_nop 0
    v_cndmask_b32 v4, v4, v5, vcc
    v_lshlrev_b32 v4, 4, v4
    v_mov_b32 v5, 12288
    v_cndmask_b32 v5, 0, v5, vcc
    s_mul_i32 s90, s34, 1536
    v_add3_u32 v8, v4, v5, s90
    s_cmp_lt_u32 s93, 64
    s_cselect_b32 s12, s78, s76
    s_cselect_b32 s13, s79, s77
    s_cselect_b32 s91, 2, 0
    s_cmp_lt_u32 s93, 32
    s_cselect_b32 s12, s78, s12
    s_cselect_b32 s13, s79, s13
    s_cselect_b32 s91, 2, s91
    s_and_b32 s13, s13, 0xffff
    s_mov_b32 s14, 7864320
    s_mov_b32 s15, 0x20000
    s_mul_i32 s91, s91, 320
    s_mul_i32 s90, s93, 10
    s_add_u32 s90, s90, s91
    s_sub_u32 s90, s90, 640
    s_mul_i32 s90, s90, 12288
    buffer_load_dwordx4 v[248:251], v6, s[12:15], s90 offen
    buffer_load_dwordx4 v[248:251], v7, s[12:15], s90 offen
    buffer_load_dwordx4 v[248:251], v8, s[12:15], s90 offen
    s_add_u32 s90, s90, 24576
    buffer_load_dwordx4 v[248:251], v6, s[12:15], s90 offen
    buffer_load_dwordx4 v[248:251], v7, s[12:15], s90 offen
    buffer_load_dwordx4 v[248:251], v8, s[12:15], s90 offen
    s_add_u32 s90, s90, 24576
    buffer_load_dwordx4 v[248:251], v6, s[12:15], s90 offen
    buffer_load_dwordx4 v[248:251], v7, s[12:15], s90 offen
    buffer_load_dwordx4 v[248:251], v8, s[12:15], s90 offen
    s_add_u32 s90, s90, 24576
    buffer_load_dwordx4 v[248:251], v6, s[12:15], s90 offen
    buffer_load_dwordx4 v[248:251], v7, s[12:15], s90 offen
    buffer_load_dwordx4 v[248:251], v8, s[12:15], s90 offen
    s_add_u32 s90, s90, 24576
    buffer_load_dwordx4 v[248:251], v6, s[12:15], s90 offen
    buffer_load_dwordx4 v[248:251], v7, s[12:15], s90 offen
    buffer_load_dwordx4 v[248:251], v8, s[12:15], s90 offen
    s_add_u32 s90, s90, 24576
L_rank:
    s_barrier
    ds_read_b32 v2, v3
    s_waitcnt lgkmcnt(0)
    v_readfirstlane_b32 s35, v2
    s_mov_b32 s34, s33
    s_barrier
    s_cmp_ge_u32 s33, 8
    s_cbranch_scc1 L_norole
    s_cmp_ge_u32 s35, 32
    s_cbranch_scc1 L_norole
    s_lshl_b32 s38, s34, 21
    s_add_u32 s38, s38, 8388608
    s_cmp_lt_u32 s35, 28
    s_cbranch_scc1 L_noini_1
    v_mov_b32 v240, -1
    v_mov_b32 v241, -1
    v_mov_b32 v242, -1
    v_mov_b32 v243, -1
    v_mov_b32 v244, 0
    v_lshlrev_b32 v4, 4, v0
    v_lshlrev_b32 v5, 2, v0
    s_sub_u32 s93, s35, 28
    s_lshl_b32 s93, s93, 2
    s_add_u32 s93, s93, s32
    s_lshl_b32 s91, s34, 4
    s_add_u32 s91, s91, s93
    s_lshl_b32 s41, s91, 8
    s_add_u32 s41, s41, 1933312
    s_mul_i32 s91, s91, 5120
    s_lshl_b32 s40, s93, 8
    s_add_u32 s40, s40, s38
    s_add_u32 s40, s40, 458752
    s_lshr_b32 s92, s93, 3
    s_mul_i32 s92, s92, 114688
    s_add_u32 s92, s92, s38
    s_and_b32 s93, s93, 7
    s_mul_i32 s93, s93, 5120
    s_add_u32 s92, s92, s93
    buffer_store_dwordx4 v[240:243], v4, s[4:7], s91 offen offset:0 sc1
    buffer_store_dwordx4 v[240:243], v4, s[4:7], s91 offen offset:1024 sc1
    buffer_store_dwordx4 v[240:243], v4, s[4:7], s91 offen offset:2048 sc1
    buffer_store_dwordx4 v[240:243], v4, s[4:7], s91 offen offset:3072 sc1
    s_add_u32 s91, s91, 4096
    buffer_store_dwordx4 v[240:243], v4, s[4:7], s91 offen offset:0 sc1
    buffer_store_dwordx4 v[240:243], v4, s[4:7], s92 offen offset:0 sc1
    buffer_store_dwordx4 v[240:243], v4, s[4:7], s92 offen offset:1024 sc1
    buffer_store_dwordx4 v[240:243], v4, s[4:7], s92 offen offset:2048 sc1
    buffer_store_dwordx4 v[240:243], v4, s[4:7], s92 offen offset:3072 sc1
    s_add_u32 s92, s92, 4096
    buffer_store_dwordx4 v[240:243], v4, s[4:7], s92 offen offset:0 sc1
    buffer_store_dword v244, v5, s[4:7], s40 offen sc1
    buffer_store_dword v244, v5, s[4:7], s41 offen sc1
    s_waitcnt vmcnt(0)
    s_barrier
    s_cmp_lg_u32 s32, 0
    s_cbranch_scc1 L_ini_2
    v_mov_b32 v1, 64
    v_mov_b32 v2, 1
    s_mov_b64 exec, 1
    buffer_atomic_add v2, v1, s[8:11], 0 offen sc0 sc1
    s_waitcnt vmcnt(0)
    v_readfirstlane_b32 s90, v2
    s_mov_b64 exec, -1
    s_cmp_lg_u32 s90, 31
    s_cbranch_scc1 L_ini_2
    v_mov_b32 v1, 192
    v_mov_b32 v2, 1
    s_mov_b64 exec, 1
    buffer_store_dword v2, v1, s[8:11], 0 offen sc1
    s_mov_b64 exec, -1
L_ini_2:
    s_barrier
    s_cmp_eq_u32 s35, 28
    s_cbranch_scc1 L_px_f
L_noini_1:
    s_sub_u32 s93, s35, 12
    s_cmp_lt_u32 s93, 6
    s_cbranch_scc1 L_v_f
    s_cmp_ge_u32 s35, 12
    s_cselect_b32 s92, 6, 0
    s_sub_u32 s93, s35, s92
    s_cmp_gt_u32 s35, 28
    s_subb_u32 s93, s93, 0
    s_lshl_b32 s93, s93, 2
    s_add_u32 s93, s93, s32
    s_cmp_ge_u32 s93, 96
    s_cbranch_scc1 L_pa_f
    v_add_u32 v4, 0, v0
    v_cmp_le_u32 vcc, 96, v4
    v_subrev_u32 v5, 96, v4
    s_nop 0
    v_cndmask_b32 v4, v4, v5, vcc
    v_lshlrev_b32 v4, 4, v4
    v_mov_b32 v5, 12288
    v_cndmask_b32 v5, 0, v5, vcc
    s_mul_i32 s90, s34, 1536
    v_add3_u32 v6, v4, v5, s90
    v_add_u32 v4, 64, v0
    v_cmp_le_u32 vcc, 96, v4
    v_subrev_u32 v5, 96, v4
    s_nop 0
    v_cndmask_b32 v4, v4, v5, vcc
    v_lshlrev_b32 v4, 4, v4
    v_mov_b32 v5, 12288
    v_cndmask_b32 v5, 0, v5, vcc
    s_mul_i32 s90, s34, 1536
    v_add3_u32 v7, v4, v5, s90
    v_add_u32 v4, 128, v0
    v_cmp_le_u32 vcc, 96, v4
    v_subrev_u32 v5, 96, v4
    s_nop 0
    v_cndmask_b32 v4, v4, v5, vcc
    v_lshlrev_b32 v4, 4, v4
    v_mov_b32 v5, 12288
    v_cndmask_b32 v5, 0, v5, vcc
    s_mul_i32 s90, s34, 1536
    v_add3_u32 v8, v4, v5, s90
    s_cmp_lt_u32 s93, 64
    s_cselect_b32 s12, s76, s74
    s_cselect_b32 s13, s77, s75
    s_cselect_b32 s91, 2, 1
    s_cmp_lt_u32 s93, 32
    s_cselect_b32 s12, s74, s12
    s_cselect_b32 s13, s75, s13
    s_cselect_b32 s91, 2, s91
    s_and_b32 s13, s13, 0xffff
    s_mov_b32 s14, 7864320
    s_mov_b32 s15, 0x20000
    s_mul_i32 s91, s91, 320
    s_mul_i32 s90, s93, 10
    s_add_u32 s90, s90, s91
    s_sub_u32 s90, s90, 640
    s_mul_i32 s90, s90, 12288
    buffer_load_dwordx4 v[248:251], v6, s[12:15], s90 offen
    buffer_load_dwordx4 v[248:251], v7, s[12:15], s90 offen
    buffer_load_dwordx4 v[248:251], v8, s[12:15], s90 offen
    s_add_u32 s90, s90, 24576
    buffer_load_dwordx4 v[248:251], v6, s[12:15], s90 offen
    buffer_load_dwordx4 v[248:251], v7, s[12:15], s90 offen
    buffer_load_dwordx4 v[248:251], v8, s[12:15], s90 offen
    s_add_u32 s90, s90, 24576
    buffer_load_dwordx4 v[248:251], v6, s[12:15], s90 offen
    buffer_load_dwordx4 v[248:251], v7, s[12:15], s90 offen
    buffer_load_dwordx4 v[248:251], v8, s[12:15], s90 offen
    s_add_u32 s90, s90, 24576
    buffer_load_dwordx4 v[248:251], v6, s[12:15], s90 offen
    buffer_load_dwordx4 v[248:251], v7, s[12:15], s90 offen
    buffer_load_dwordx4 v[248:251], v8, s[12:15], s90 offen
    s_add_u32 s90, s90, 24576
    buffer_load_dwordx4 v[248:251], v6, s[12:15], s90 offen
    buffer_load_dwordx4 v[248:251], v7, s[12:15], s90 offen
    buffer_load_dwordx4 v[248:251], v8, s[12:15], s90 offen
    s_add_u32 s90, s90, 24576
    s_waitcnt vmcnt(20)
    s_nop 0
    s_cmp_lt_u32 s35, 12
    s_cbranch_scc1 L_qkv_f
    s_cmp_lt_u32 s35, 18
    s_cbranch_scc1 L_v_f
    s_cmp_lt_u32 s35, 28
    s_cbranch_scc1 L_wo_f
    s_cmp_lt_u32 s35, 29
    s_cbranch_scc1 L_px_f
    s_branch L_pa_f
L_norole:
    v_mov_b32 v1, 192
    v_mov_b32 v2, 2
    s_mov_b64 exec, 1
    buffer_store_dword v2, v1, s[8:11], 0 offen sc1
    s_mov_b64 exec, -1
    s_branch L_slow
L_exit:
    s_endpgm
L_qkv_f:
    s_mov_b32 s12, s74
    s_and_b32 s13, s75, 0xffff
    s_mov_b32 s14, 7864320
    s_mov_b32 s15, 0x20000
    s_mov_b32 s16, s76
    s_and_b32 s17, s77, 0xffff
    s_mov_b32 s18, 7864320
    s_mov_b32 s19, 0x20000
    s_mov_b32 s40, s35
    s_mov_b32 s24, s70
    s_and_b32 s25, s71, 0xffff
    s_mov_b32 s26, 2621440
    s_mov_b32 s27, 0x20000
    v_and_b32 v1, 15, v0
    v_lshrrev_b32 v2, 4, v0
    v_lshrrev_b32 v3, 3, v0
    v_and_b32 v4, 7, v0
    s_lshl_b32 s90, s32, 3
    v_add_u32 v5, s90, v3
    s_and_b32 s91, s32, 1
    s_lshl_b32 s91, s91, 2
    v_and_b32 v6, 2, v3
    v_or_b32 v6, s91, v6
    v_xor_b32 v6, v6, v4
    v_lshlrev_b32 v6, 4, v6
    v_mul_u32_u24 v7, 12288, v5
    s_mul_i32 s92, s34, 1536
    s_lshl_b32 s93, s40, 7
    s_add_u32 s92, s92, s93
    v_add3_u32 v124, v6, v7, s92
    v_lshrrev_b32 v6, 1, v3
    v_or_b32 v6, s91, v6
    v_xor_b32 v6, v6, v4
    v_lshlrev_b32 v6, 4, v6
    v_mul_u32_u24 v7, 1280, v5
    v_add_u32 v10, v6, v7
    s_lshl_b32 s90, s32, 10
    s_add_u32 m0, s90, 81920
    s_mov_b32 s91, 0
    buffer_load_dwordx4 v124, s[16:19], s91 offen nt lds
    s_add_u32 m0, m0, 4096
    s_add_u32 s91, s91, 393216
    buffer_load_dwordx4 v124, s[16:19], s91 offen nt lds
    s_add_u32 m0, m0, 4096
    s_add_u32 s91, s91, 393216
    buffer_load_dwordx4 v124, s[16:19], s91 offen nt lds
    s_add_u32 m0, m0, 4096
    s_add_u32 s91, s91, 393216
    buffer_load_dwordx4 v124, s[16:19], s91 offen nt lds
    s_add_u32 m0, m0, 4096
    s_add_u32 s91, s91, 393216
    buffer_load_dwordx4 v124, s[16:19], s91 offen nt lds
    s_add_u32 m0, m0, 4096
    s_add_u32 s91, s91, 393216
    buffer_load_dwordx4 v124, s[16:19], s91 offen nt lds
    s_add_u32 m0, m0, 4096
    s_add_u32 s91, s91, 393216
    buffer_load_dwordx4 v124, s[16:19], s91 offen nt lds
    s_add_u32 m0, m0, 4096
    s_add_u32 s91, s91, 393216
    buffer_load_dwordx4 v124, s[16:19], s91 offen nt lds
    s_add_u32 m0, m0, 4096
    s_add_u32 s91, s91, 393216
    buffer_load_dwordx4 v124, s[16:19], s91 offen nt lds
    s_add_u32 m0, m0, 4096
    s_add_u32 s91, s91, 393216
    buffer_load_dwordx4 v124, s[16:19], s91 offen nt lds
    s_mul_i32 s60, s40, 86
    s_lshr_b32 s60, s60, 8
    s_mul_i32 s61, s60, 3
    s_sub_u32 s61, s40, s61
    s_add_u32 s90, s40, 1
    s_mul_i32 s62, s90, 86
    s_lshr_b32 s62, s62, 8
    s_mul_i32 s63, s62, 3
    s_sub_u32 s63, s90, s63
    v_lshrrev_b32 v3, 1, v2
    v_and_b32 v5, 1, v2
    s_lshl_b32 s90, s32, 9
    v_lshlrev_b32 v6, 4, v1
    v_lshl_add_u32 v6, v3, 8, v6
    v_add_u32 v6, s90, v6
    s_mul_i32 s90, s60, 12288
    s_lshl_b32 s91, s61, 11
    s_add_u32 s90, s90, s91
    v_mul_u32_u24 v7, 6144, v5
    v_add3_u32 v19, v6, v7, s90
    v_mov_b32 v22, -1
    s_mov_b32 s56, 49152
    v_lshl_add_u32 v137, v5, 11, v6
    v_add_u32 v137, 135168, v137
    s_mul_i32 s90, s40, 1280
    s_add_u32 s90, s90, 10240
    v_lshlrev_b32 v6, 1, v5
    v_or_b32 v7, v6, v3
    v_lshl_add_u32 v7, v7, 4, v1
    v_lshlrev_b32 v7, 2, v7
    v_add_u32 v7, 1024, v7
    v_or_b32 v6, v6, v1
    v_lshl_add_u32 v6, v3, 4, v6
    v_lshlrev_b32 v6, 4, v6
    s_sub_u32 s91, s32, 1
    s_lshl_b32 s91, s91, 9
    v_add_u32 v6, s91, v6
    s_cmp_eq_u32 s32, 0
    s_cselect_b64 vcc, -1, 0
    v_cndmask_b32 v6, v6, v7, vcc
    v_add_u32 v135, s90, v6
    s_lshl_b32 s91, s32, 8
    s_add_u32 s91, s91, s90
    v_lshl_add_u32 v150, v0, 2, s91
    v_and_b32 v4, 2, v1
    v_cmp_eq_u32 vcc, 0, v4
    v_mov_b32 v9, 2146435072
    s_nop 0
    v_cndmask_b32 v135, v9, v135, vcc
    s_lshl_b32 s90, s40, 10
    v_lshrrev_b32 v3, 2, v1
    v_lshlrev_b32 v3, 1, v3
    v_and_b32 v6, 1, v1
    v_or_b32 v3, v3, v6
    v_lshl_add_u32 v3, v2, 3, v3
    v_lshl_add_u32 v136, v3, 4, s90
    v_cmp_ne_u32 vcc, 0, v4
    v_mov_b32 v9, 2146435072
    s_nop 0
    v_cndmask_b32 v136, v9, v136, vcc
    v_and_b32 v6, 9, v1
    v_lshl_or_b32 v6, v4, 1, v6
    v_and_b32 v7, 4, v1
    v_lshrrev_b32 v7, 1, v7
    v_or_b32 v6, v6, v7
    v_lshlrev_b32 v6, 4, v6
    v_lshl_add_u32 v6, v2, 8, v6
    s_cmp_eq_u32 s32, 2
    s_cselect_b32 s90, 2048, 0
    s_add_u32 s90, s90, 135168
    v_add_u32 v138, s90, v6
    s_lshl_b32 s90, s60, 7
    s_lshl_b32 s91, s61, 2
    s_add_u32 s91, s91, s90
    s_add_u32 s91, s91, 459264
    s_cmp_eq_u32 s32, 3
    s_cselect_b32 s91, s91, 2146435072
    s_cselect_b32 s55, -1, 0
    v_mov_b32 v139, s91
    v_cmp_eq_u32 vcc, 0, v0
    v_mov_b32 v9, 2146435072
    s_nop 0
    v_cndmask_b32 v139, v9, v139, vcc
    v_add_u32 v21, 3072, v139
    s_mul_i32 s90, s35, 32768
    s_lshl_b32 s91, s32, 11
    s_add_u32 s90, s90, s91
    s_lshl_b32 s92, s35, 10
    s_lshl_b32 s91, s32, 8
    s_add_u32 s92, s92, s91
    s_cmp_lt_u32 s35, 10
    s_cselect_b32 s90, s90, 2146435072
    s_cselect_b32 s92, s92, 2146435072
    s_lshl_b32 s91, s34, 8
    v_lshlrev_b32 v3, 4, v0
    v_xor_b32 v3, s91, v3
    v_add_u32 v142, s90, v3
    v_xor_b32 v3, 1024, v3
    v_add_u32 v143, s90, v3
    s_min_u32 s90, s35, 9
    s_lshl_b32 s90, s90, 7
    s_add_u32 s90, s90, 460800
    s_add_u32 s90, s90, s38
    v_and_b32 v3, 3, v0
    v_lshl_add_u32 v146, v3, 2, s90
    v_lshl_add_u32 v149, v0, 2, s92
    v_lshl_add_u32 v148, v1, 4, s92
    v_cmp_eq_u32 vcc, 0, v2
    v_mov_b32 v9, 2146435072
    s_nop 0
    v_cndmask_b32 v148, v9, v148, vcc
    v_and_b32 v7, 1, v1
    v_cmp_ne_u32 vcc, 0, v7
    v_mov_b32 v5, 0x3f80
    v_mov_b32 v6, 0x3f800000
    v_cndmask_b32 v5, v5, v6, vcc
    v_bfe_u32 v6, v1, 1, 1
    v_cmp_eq_u32 vcc, 0, v6
    s_nop 1
    v_cndmask_b32 v198, 0, v5, vcc
    v_mov_b32 v196, 0
    v_mov_b32 v200, 0
    v_cmp_eq_u32 vcc, 1, v6
    s_nop 1
    v_cndmask_b32 v199, 0, v5, vcc
    v_mov_b32 v197, 0
    v_mov_b32 v201, 0
    v_lshrrev_b32 v3, 2, v1
    v_and_b32 v4, 3, v1
    v_and_b32 v5, 1, v2
    v_lshl_add_u32 v6, v2, 3, v3
    v_lshlrev_b32 v6, 7, v6
    v_and_b32 v7, 2, v3
    v_lshl_or_b32 v7, v5, 2, v7
    v_lshrrev_b32 v8, 1, v4
    s_lshl_b32 s90, s32, 1
    v_or_b32 v8, s90, v8
    v_xor_b32 v7, v7, v8
    v_lshl_add_u32 v6, v7, 4, v6
    v_and_b32 v7, 1, v4
    v_lshl_add_u32 v6, v7, 3, v6
    v_add_u32 v125, 81920, v6
    v_add_u32 v126, 40960, v6
    v_add_u32 v127, 122880, v6
    s_lshl_b32 s90, s32, 9
    s_add_u32 s90, s90, 133120
    v_xor_b32 v6, 0, v5
    v_lshl_add_u32 v6, v6, 2, v3
    v_lshl_add_u32 v6, v2, 3, v6
    v_lshlrev_b32 v6, 5, v6
    v_lshl_or_b32 v7, v5, 1, 0
    v_xor_b32 v7, v7, v4
    v_lshl_add_u32 v6, v7, 3, v6
    v_add_u32 v24, 133120, v6
    v_xor_b32 v6, 1, v5
    v_lshl_add_u32 v6, v6, 2, v3
    v_lshl_add_u32 v6, v2, 3, v6
    v_lshlrev_b32 v6, 5, v6
    v_lshl_or_b32 v7, v5, 1, 1
    v_xor_b32 v7, v7, v4
    v_lshl_add_u32 v6, v7, 3, v6
    v_add_u32 v134, 133120, v6
    v_lshrrev_b32 v6, 3, v1
    v_lshlrev_b32 v6, 2, v6
    v_xor_b32 v6, v6, v1
    v_lshlrev_b32 v6, 5, v6
    v_xor_b32 v7, v2, v3
    v_lshl_add_u32 v6, v7, 3, v6
    v_add_u32 v23, s90, v6
    v_and_b32 v7, 2, v1
    v_cmp_ne_u32 vcc, 0, v7
    v_mov_b32 v6, 0x4444
    v_mov_b32 v8, 0xeeee
    v_cndmask_b32 v17, v6, v8, vcc
    v_lshlrev_b32 v6, 4, v0
    v_add_u32 v16, 122880, v6
    s_mul_i32 s90, s32, 2560
    v_lshl_add_u32 v13, v0, 4, s90
    v_lshl_add_u32 v14, v0, 2, s90
    s_add_u32 s48, s90, 122880
    v_mul_u32_u24 v6, 40, v0
    v_add_u32 v15, s48, v6
    v_mul_u32_u24 v6, 164, v0
    v_min_u32 v6, 10236, v6
    v_add_u32 v25, 122880, v6
    v_lshrrev_b32 v6, 3, v1
    v_lshlrev_b32 v6, 10, v6
    v_and_b32 v7, 7, v1
    v_lshl_add_u32 v6, v7, 7, v6
    v_lshrrev_b32 v7, 1, v1
    v_xor_b32 v7, v7, v2
    v_lshl_add_u32 v11, v7, 4, v6
    v_xor_b32 v12, 64, v11
    s_and_b32 s91, s34, 1
    s_lshl_b32 s91, s91, 12
    s_lshr_b32 s92, s34, 2
    s_lshl_b32 s92, s92, 13
    s_add_u32 s91, s91, s92
    s_and_b32 s92, s34, 2
    s_lshl_b32 s92, s92, 13
    s_add_u32 s91, s91, s92
    s_add_u32 s91, s91, 1933312
    v_lshrrev_b32 v4, 2, v0
    v_lshl_add_u32 v3, v4, 9, s91
    v_cmp_ne_u32 s[92:93], s34, v4
    v_cmp_gt_u32 vcc, 32, v0
    s_nop 0
    s_and_b64 vcc, vcc, s[92:93]
    s_and_b32 vcc_lo, vcc_lo, s55
    v_cndmask_b32 v146, v146, v3, vcc
    v_cndmask_b32 v152, 0, -1, vcc
    s_lshl_b32 s90, s32, 10
    s_add_u32 m0, s90, 40960
    s_mov_b32 s91, 0
    buffer_load_dwordx4 v124, s[12:15], s91 offen nt lds
    s_add_u32 m0, m0, 4096
    s_add_u32 s91, s91, 393216
    buffer_load_dwordx4 v124, s[12:15], s91 offen nt lds
    s_add_u32 m0, m0, 4096
    s_add_u32 s91, s91, 393216
    buffer_load_dwordx4 v124, s[12:15], s91 offen nt lds
    s_add_u32 m0, m0, 4096
    s_add_u32 s91, s91, 393216
    buffer_load_dwordx4 v124, s[12:15], s91 offen nt lds
    s_add_u32 m0, m0, 4096
    s_add_u32 s91, s91, 393216
    buffer_load_dwordx4 v124, s[12:15], s91 offen nt lds
    s_add_u32 m0, m0, 4096
    s_add_u32 s91, s91, 393216
    buffer_load_dwordx4 v124, s[12:15], s91 offen nt lds
    s_add_u32 m0, m0, 4096
    s_add_u32 s91, s91, 393216
    buffer_load_dwordx4 v124, s[12:15], s91 offen nt lds
    s_add_u32 m0, m0, 4096
    s_add_u32 s91, s91, 393216
    buffer_load_dwordx4 v124, s[12:15], s91 offen nt lds
    s_add_u32 m0, m0, 4096
    s_add_u32 s91, s91, 393216
    buffer_load_dwordx4 v124, s[12:15], s91 offen nt lds
    s_add_u32 m0, m0, 4096
    s_add_u32 s91, s91, 393216
    buffer_load_dwordx4 v124, s[12:15], s91 offen nt lds
    s_lshl_b32 s90, s32, 10
    s_add_u32 m0, s90, 122880
    s_mov_b32 s91, 3932160
    buffer_load_dwordx4 v124, s[16:19], s91 offen nt lds
    s_add_u32 m0, m0, 4096
    s_add_u32 s91, s91, 393216
    buffer_load_dwordx4 v124, s[16:19], s91 offen nt lds
    s_add_u32 m0, m0, 4096
    s_add_u32 s91, s91, 393216
    buffer_load_dwordx4 v124, s[16:19], s91 offen nt lds
    s_add_u32 m0, m0, 4096
    s_add_u32 s91, s91, 393216
    buffer_load_dwordx4 v124, s[16:19], s91 offen nt lds
    s_add_u32 m0, m0, 4096
    s_add_u32 s91, s91, 393216
    buffer_load_dwordx4 v124, s[16:19], s91 offen nt lds
    s_add_u32 m0, m0, 4096
    s_add_u32 s91, s91, 393216
    buffer_load_dwordx4 v124, s[16:19], s91 offen nt lds
    s_add_u32 m0, m0, 4096
    s_add_u32 s91, s91, 393216
    buffer_load_dwordx4 v124, s[16:19], s91 offen nt lds
    s_add_u32 m0, m0, 4096
    s_add_u32 s91, s91, 393216
    buffer_load_dwordx4 v124, s[16:19], s91 offen nt lds
    s_add_u32 m0, m0, 4096
    s_add_u32 s91, s91, 393216
    buffer_load_dwordx4 v124, s[16:19], s91 offen nt lds
    s_add_u32 m0, m0, 4096
    s_add_u32 s91, s91, 393216
    buffer_load_dwordx4 v124, s[16:19], s91 offen nt lds
    s_mov_b32 s46, 0
    s_lshl_b32 s90, s32, 10
    s_add_u32 m0, s90, 0
    s_nop 0
    buffer_load_dwordx4 v10, s[24:27], s46 offen offset:0 lds
    s_add_u32 m0, m0, 3968
    s_nop 0
    buffer_load_dwordx4 v10, s[24:27], s46 offen offset:128 lds
    s_add_u32 m0, m0, 3968
    s_nop 0
    buffer_load_dwordx4 v10, s[24:27], s46 offen offset:256 lds
    s_add_u32 m0, m0, 3968
    s_nop 0
    buffer_load_dwordx4 v10, s[24:27], s46 offen offset:384 lds
    s_add_u32 m0, m0, 3968
    s_nop 0
    buffer_load_dwordx4 v10, s[24:27], s46 offen offset:512 lds
    s_add_u32 m0, m0, 3968
    s_nop 0
    buffer_load_dwordx4 v10, s[24:27], s46 offen offset:640 lds
    s_add_u32 m0, m0, 3968
    s_nop 0
    buffer_load_dwordx4 v10, s[24:27], s46 offen offset:768 lds
    s_add_u32 m0, m0, 3968
    s_nop 0
    buffer_load_dwordx4 v10, s[24:27], s46 offen offset:896 lds
    s_add_u32 m0, m0, 3968
    s_nop 0
    buffer_load_dwordx4 v10, s[24:27], s46 offen offset:1024 lds
    s_add_u32 m0, m0, 3968
    s_nop 0
    buffer_load_dwordx4 v10, s[24:27], s46 offen offset:1152 lds
    s_waitcnt vmcnt(30)
    s_barrier
    ds_read_b64_tr_b16 a[80:81], v125 offset:0
    ds_read_b64_tr_b16 a[82:83], v125 offset:512
    ds_read_b64_tr_b16 a[84:85], v125 offset:4096
    ds_read_b64_tr_b16 a[86:87], v125 offset:4608
    ds_read_b64_tr_b16 a[88:89], v125 offset:8192
    ds_read_b64_tr_b16 a[90:91], v125 offset:8704
    ds_read_b64_tr_b16 a[92:93], v125 offset:12288
    ds_read_b64_tr_b16 a[94:95], v125 offset:12800
    ds_read_b64_tr_b16 a[96:97], v125 offset:16384
    ds_read_b64_tr_b16 a[98:99], v125 offset:16896
    ds_read_b64_tr_b16 a[100:101], v125 offset:20480
    ds_read_b64_tr_b16 a[102:103], v125 offset:20992
    ds_read_b64_tr_b16 a[104:105], v125 offset:24576
    ds_read_b64_tr_b16 a[106:107], v125 offset:25088
    ds_read_b64_tr_b16 a[108:109], v125 offset:28672
    ds_read_b64_tr_b16 a[110:111], v125 offset:29184
    ds_read_b64_tr_b16 a[112:113], v125 offset:32768
    ds_read_b64_tr_b16 a[114:115], v125 offset:33280
    ds_read_b64_tr_b16 a[116:117], v125 offset:36864
    ds_read_b64_tr_b16 a[118:119], v125 offset:37376
    s_waitcnt lgkmcnt(0)
    s_barrier
    s_lshl_b32 s90, s32, 10
    s_add_u32 m0, s90, 81920
    s_mov_b32 s91, 3932160
    buffer_load_dwordx4 v124, s[12:15], s91 offen nt lds
    s_add_u32 m0, m0, 4096
    s_add_u32 s91, s91, 393216
    buffer_load_dwordx4 v124, s[12:15], s91 offen nt lds
    s_add_u32 m0, m0, 4096
    s_add_u32 s91, s91, 393216
    buffer_load_dwordx4 v124, s[12:15], s91 offen nt lds
    s_add_u32 m0, m0, 4096
    s_add_u32 s91, s91, 393216
    buffer_load_dwordx4 v124, s[12:15], s91 offen nt lds
    s_add_u32 m0, m0, 4096
    s_add_u32 s91, s91, 393216
    buffer_load_dwordx4 v124, s[12:15], s91 offen nt lds
    s_add_u32 m0, m0, 4096
    s_add_u32 s91, s91, 393216
    buffer_load_dwordx4 v124, s[12:15], s91 offen nt lds
    s_add_u32 m0, m0, 4096
    s_add_u32 s91, s91, 393216
    buffer_load_dwordx4 v124, s[12:15], s91 offen nt lds
    s_add_u32 m0, m0, 4096
    s_add_u32 s91, s91, 393216
    buffer_load_dwordx4 v124, s[12:15], s91 offen nt lds
    s_add_u32 m0, m0, 4096
    s_add_u32 s91, s91, 393216
    buffer_load_dwordx4 v124, s[12:15], s91 offen nt lds
    s_add_u32 m0, m0, 4096
    s_add_u32 s91, s91, 393216
    buffer_load_dwordx4 v124, s[12:15], s91 offen nt lds
    s_waitcnt vmcnt(30)
    s_barrier
    ds_read_b64_tr_b16 a[0:1], v126 offset:0
    ds_read_b64_tr_b16 a[2:3], v126 offset:512
    ds_read_b64_tr_b16 a[4:5], v126 offset:4096
    ds_read_b64_tr_b16 a[6:7], v126 offset:4608
    ds_read_b64_tr_b16 a[8:9], v126 offset:8192
    ds_read_b64_tr_b16 a[10:11], v126 offset:8704
    ds_read_b64_tr_b16 a[12:13], v126 offset:12288
    ds_read_b64_tr_b16 a[14:15], v126 offset:12800
    ds_read_b64_tr_b16 a[16:17], v126 offset:16384
    ds_read_b64_tr_b16 a[18:19], v126 offset:16896
    ds_read_b64_tr_b16 a[20:21], v126 offset:20480
    ds_read_b64_tr_b16 a[22:23], v126 offset:20992
    ds_read_b64_tr_b16 a[24:25], v126 offset:24576
    ds_read_b64_tr_b16 a[26:27], v126 offset:25088
    ds_read_b64_tr_b16 a[28:29], v126 offset:28672
    ds_read_b64_tr_b16 a[30:31], v126 offset:29184
    ds_read_b64_tr_b16 a[32:33], v126 offset:32768
    ds_read_b64_tr_b16 a[34:35], v126 offset:33280
    ds_read_b64_tr_b16 a[36:37], v126 offset:36864
    ds_read_b64_tr_b16 a[38:39], v126 offset:37376
    s_waitcnt lgkmcnt(0)
    s_barrier
    s_mov_b32 s46, 40960
    s_lshl_b32 s90, s32, 10
    s_add_u32 m0, s90, 40960
    s_nop 0
    buffer_load_dwordx4 v10, s[24:27], s46 offen offset:0 lds
    s_add_u32 m0, m0, 3968
    s_nop 0
    buffer_load_dwordx4 v10, s[24:27], s46 offen offset:128 lds
    s_add_u32 m0, m0, 3968
    s_nop 0
    buffer_load_dwordx4 v10, s[24:27], s46 offen offset:256 lds
    s_add_u32 m0, m0, 3968
    s_nop 0
    buffer_load_dwordx4 v10, s[24:27], s46 offen offset:384 lds
    s_add_u32 m0, m0, 3968
    s_nop 0
    buffer_load_dwordx4 v10, s[24:27], s46 offen offset:512 lds
    s_add_u32 m0, m0, 3968
    s_nop 0
    buffer_load_dwordx4 v10, s[24:27], s46 offen offset:640 lds
    s_add_u32 m0, m0, 3968
    s_nop 0
    buffer_load_dwordx4 v10, s[24:27], s46 offen offset:768 lds
    s_add_u32 m0, m0, 3968
    s_nop 0
    buffer_load_dwordx4 v10, s[24:27], s46 offen offset:896 lds
    s_add_u32 m0, m0, 3968
    s_nop 0
    buffer_load_dwordx4 v10, s[24:27], s46 offen offset:1024 lds
    s_add_u32 m0, m0, 3968
    s_nop 0
    buffer_load_dwordx4 v10, s[24:27], s46 offen offset:1152 lds
    s_waitcnt vmcnt(30)
    s_barrier
    ds_read_b64_tr_b16 a[120:121], v127 offset:0
    ds_read_b64_tr_b16 a[122:123], v127 offset:512
    ds_read_b64_tr_b16 a[124:125], v127 offset:4096
    ds_read_b64_tr_b16 a[126:127], v127 offset:4608
    ds_read_b64_tr_b16 a[128:129], v127 offset:8192
    ds_read_b64_tr_b16 a[130:131], v127 offset:8704
    ds_read_b64_tr_b16 a[132:133], v127 offset:12288
    ds_read_b64_tr_b16 a[134:135], v127 offset:12800
    ds_read_b64_tr_b16 a[136:137], v127 offset:16384
    ds_read_b64_tr_b16 a[138:139], v127 offset:16896
    ds_read_b64_tr_b16 a[140:141], v127 offset:20480
    ds_read_b64_tr_b16 a[142:143], v127 offset:20992
    ds_read_b64_tr_b16 a[144:145], v127 offset:24576
    ds_read_b64_tr_b16 a[146:147], v127 offset:25088
    ds_read_b64_tr_b16 a[148:149], v127 offset:28672
    ds_read_b64_tr_b16 a[150:151], v127 offset:29184
    ds_read_b64_tr_b16 a[152:153], v127 offset:32768
    ds_read_b64_tr_b16 a[154:155], v127 offset:33280
    ds_read_b64_tr_b16 a[156:157], v127 offset:36864
    ds_read_b64_tr_b16 a[158:159], v127 offset:37376
    s_waitcnt lgkmcnt(0)
    s_waitcnt vmcnt(10)
    s_barrier
    ds_read_b64_tr_b16 a[40:41], v125 offset:0
    ds_read_b64_tr_b16 a[42:43], v125 offset:512
    ds_read_b64_tr_b16 a[44:45], v125 offset:4096
    ds_read_b64_tr_b16 a[46:47], v125 offset:4608
    ds_read_b64_tr_b16 a[48:49], v125 offset:8192
    ds_read_b64_tr_b16 a[50:51], v125 offset:8704
    ds_read_b64_tr_b16 a[52:53], v125 offset:12288
    ds_read_b64_tr_b16 a[54:55], v125 offset:12800
    ds_read_b64_tr_b16 a[56:57], v125 offset:16384
    ds_read_b64_tr_b16 a[58:59], v125 offset:16896
    ds_read_b64_tr_b16 a[60:61], v125 offset:20480
    ds_read_b64_tr_b16 a[62:63], v125 offset:20992
    ds_read_b64_tr_b16 a[64:65], v125 offset:24576
    ds_read_b64_tr_b16 a[66:67], v125 offset:25088
    ds_read_b64_tr_b16 a[68:69], v125 offset:28672
    ds_read_b64_tr_b16 a[70:71], v125 offset:29184
    ds_read_b64_tr_b16 a[72:73], v125 offset:32768
    ds_read_b64_tr_b16 a[74:75], v125 offset:33280
    ds_read_b64_tr_b16 a[76:77], v125 offset:36864
    ds_read_b64_tr_b16 a[78:79], v125 offset:37376
    s_waitcnt lgkmcnt(0)
    s_mov_b32 s49, 40960
    s_mov_b32 s47, 40960
    s_mov_b32 s37, -1
    s_add_u32 s44, s38, 475136
    s_add_u32 s45, s44, s56
    s_mov_b32 s46, 40960
    v_add_u32 v140, 0, v137
    v_mov_b32 v1, 192
    buffer_load_dword v2, v1, s[8:11], 0 offen sc1
    ds_read_b128 v[84:87], v11 offset:0
    ds_read_b128 v[88:91], v11 offset:2048
    ds_read_b128 v[92:95], v12 offset:0
    ds_read_b128 v[96:99], v12 offset:2048
    s_waitcnt lgkmcnt(2)
    v_mfma_f32_16x16x32_bf16 v[108:111], a[0:3], v[84:87], 0
    ds_read_b128 v[100:103], v11 offset:4096
    v_mfma_f32_16x16x32_bf16 v[112:115], a[0:3], v[88:91], 0
    ds_read_b128 v[104:107], v11 offset:6144
    v_mfma_f32_16x16x32_bf16 v[116:119], a[80:83], v[84:87], 0
    v_mfma_f32_16x16x32_bf16 v[120:123], a[80:83], v[88:91], 0
    s_waitcnt lgkmcnt(2)
    v_mfma_f32_16x16x32_bf16 v[108:111], a[4:7], v[92:95], v[108:111]
    ds_read_b128 v[84:87], v12 offset:4096
    v_mfma_f32_16x16x32_bf16 v[112:115], a[4:7], v[96:99], v[112:115]
    ds_read_b128 v[88:91], v12 offset:6144
    v_mfma_f32_16x16x32_bf16 v[116:119], a[84:87], v[92:95], v[116:119]
    v_mfma_f32_16x16x32_bf16 v[120:123], a[84:87], v[96:99], v[120:123]
    s_waitcnt lgkmcnt(2)
    v_mfma_f32_16x16x32_bf16 v[108:111], a[8:11], v[100:103], v[108:111]
    ds_read_b128 v[92:95], v11 offset:8192
    v_mfma_f32_16x16x32_bf16 v[112:115], a[8:11], v[104:107], v[112:115]
    ds_read_b128 v[96:99], v11 offset:10240
    v_mfma_f32_16x16x32_bf16 v[116:119], a[88:91], v[100:103], v[116:119]
    v_mfma_f32_16x16x32_bf16 v[120:123], a[88:91], v[104:107], v[120:123]
    s_waitcnt lgkmcnt(2)
    v_mfma_f32_16x16x32_bf16 v[108:111], a[12:15], v[84:87], v[108:111]
    ds_read_b128 v[100:103], v12 offset:8192
    v_mfma_f32_16x16x32_bf16 v[112:115], a[12:15], v[88:91], v[112:115]
    ds_read_b128 v[104:107], v12 offset:10240
    v_mfma_f32_16x16x32_bf16 v[116:119], a[92:95], v[84:87], v[116:119]
    v_mfma_f32_16x16x32_bf16 v[120:123], a[92:95], v[88:91], v[120:123]
    s_waitcnt lgkmcnt(2)
    v_mfma_f32_16x16x32_bf16 v[108:111], a[16:19], v[92:95], v[108:111]
    ds_read_b128 v[84:87], v11 offset:12288
    v_mfma_f32_16x16x32_bf16 v[112:115], a[16:19], v[96:99], v[112:115]
    ds_read_b128 v[88:91], v11 offset:14336
    v_mfma_f32_16x16x32_bf16 v[116:119], a[96:99], v[92:95], v[116:119]
    v_mfma_f32_16x16x32_bf16 v[120:123], a[96:99], v[96:99], v[120:123]
    s_waitcnt lgkmcnt(2)
    v_mfma_f32_16x16x32_bf16 v[108:111], a[20:23], v[100:103], v[108:111]
    ds_read_b128 v[92:95], v12 offset:12288
    v_mfma_f32_16x16x32_bf16 v[112:115], a[20:23], v[104:107], v[112:115]
    ds_read_b128 v[96:99], v12 offset:14336
    v_mfma_f32_16x16x32_bf16 v[116:119], a[100:103], v[100:103], v[116:119]
    v_mfma_f32_16x16x32_bf16 v[120:123], a[100:103], v[104:107], v[120:123]
    s_waitcnt lgkmcnt(2)
    v_mfma_f32_16x16x32_bf16 v[108:111], a[24:27], v[84:87], v[108:111]
    ds_read_b128 v[100:103], v11 offset:16384
    v_mfma_f32_16x16x32_bf16 v[112:115], a[24:27], v[88:91], v[112:115]
    ds_read_b128 v[104:107], v11 offset:18432
    v_mfma_f32_16x16x32_bf16 v[116:119], a[104:107], v[84:87], v[116:119]
    v_mfma_f32_16x16x32_bf16 v[120:123], a[104:107], v[88:91], v[120:123]
    s_waitcnt lgkmcnt(2)
    v_mfma_f32_16x16x32_bf16 v[108:111], a[28:31], v[92:95], v[108:111]
    ds_read_b128 v[84:87], v12 offset:16384
    v_mfma_f32_16x16x32_bf16 v[112:115], a[28:31], v[96:99], v[112:115]
    ds_read_b128 v[88:91], v12 offset:18432
    v_mfma_f32_16x16x32_bf16 v[116:119], a[108:111], v[92:95], v[116:119]
    v_mfma_f32_16x16x32_bf16 v[120:123], a[108:111], v[96:99], v[120:123]
    s_waitcnt lgkmcnt(2)
    v_mfma_f32_16x16x32_bf16 v[108:111], a[32:35], v[100:103], v[108:111]
    ds_read_b128 v[92:95], v11 offset:20480
    v_mfma_f32_16x16x32_bf16 v[112:115], a[32:35], v[104:107], v[112:115]
    ds_read_b128 v[96:99], v11 offset:22528
    v_mfma_f32_16x16x32_bf16 v[116:119], a[112:115], v[100:103], v[116:119]
    v_mfma_f32_16x16x32_bf16 v[120:123], a[112:115], v[104:107], v[120:123]
    s_waitcnt lgkmcnt(2)
    v_mfma_f32_16x16x32_bf16 v[108:111], a[36:39], v[84:87], v[108:111]
    ds_read_b128 v[100:103], v12 offset:20480
    v_mfma_f32_16x16x32_bf16 v[112:115], a[36:39], v[88:91], v[112:115]
    ds_read_b128 v[104:107], v12 offset:22528
    v_mfma_f32_16x16x32_bf16 v[116:119], a[116:119], v[84:87], v[116:119]
    v_mfma_f32_16x16x32_bf16 v[120:123], a[116:119], v[88:91], v[120:123]
    s_waitcnt lgkmcnt(2)
    v_mfma_f32_16x16x32_bf16 v[108:111], a[40:43], v[92:95], v[108:111]
    ds_read_b128 v[84:87], v11 offset:24576
    v_mfma_f32_16x16x32_bf16 v[112:115], a[40:43], v[96:99], v[112:115]
    ds_read_b128 v[88:91], v11 offset:26624
    v_mfma_f32_16x16x32_bf16 v[116:119], a[120:123], v[92:95], v[116:119]
    v_mfma_f32_16x16x32_bf16 v[120:123], a[120:123], v[96:99], v[120:123]
    s_waitcnt lgkmcnt(2)
    v_mfma_f32_16x16x32_bf16 v[108:111], a[44:47], v[100:103], v[108:111]
    ds_read_b128 v[92:95], v12 offset:24576
    v_mfma_f32_16x16x32_bf16 v[112:115], a[44:47], v[104:107], v[112:115]
    ds_read_b128 v[96:99], v12 offset:26624
    v_mfma_f32_16x16x32_bf16 v[116:119], a[124:127], v[100:103], v[116:119]
    v_mfma_f32_16x16x32_bf16 v[120:123], a[124:127], v[104:107], v[120:123]
    s_waitcnt lgkmcnt(2)
    v_mfma_f32_16x16x32_bf16 v[108:111], a[48:51], v[84:87], v[108:111]
    ds_read_b128 v[100:103], v11 offset:28672
    v_mfma_f32_16x16x32_bf16 v[112:115], a[48:51], v[88:91], v[112:115]
    ds_read_b128 v[104:107], v11 offset:30720
    v_mfma_f32_16x16x32_bf16 v[116:119], a[128:131], v[84:87], v[116:119]
    v_mfma_f32_16x16x32_bf16 v[120:123], a[128:131], v[88:91], v[120:123]
    s_waitcnt lgkmcnt(2)
    v_mfma_f32_16x16x32_bf16 v[108:111], a[52:55], v[92:95], v[108:111]
    ds_read_b128 v[84:87], v12 offset:28672
    v_mfma_f32_16x16x32_bf16 v[112:115], a[52:55], v[96:99], v[112:115]
    ds_read_b128 v[88:91], v12 offset:30720
    v_mfma_f32_16x16x32_bf16 v[116:119], a[132:135], v[92:95], v[116:119]
    v_mfma_f32_16x16x32_bf16 v[120:123], a[132:135], v[96:99], v[120:123]
    s_waitcnt lgkmcnt(2)
    v_mfma_f32_16x16x32_bf16 v[108:111], a[56:59], v[100:103], v[108:111]
    ds_read_b128 v[92:95], v11 offset:32768
    v_mfma_f32_16x16x32_bf16 v[112:115], a[56:59], v[104:107], v[112:115]
    ds_read_b128 v[96:99], v11 offset:34816
    v_mfma_f32_16x16x32_bf16 v[116:119], a[136:139], v[100:103], v[116:119]
    v_mfma_f32_16x16x32_bf16 v[120:123], a[136:139], v[104:107], v[120:123]
    s_waitcnt lgkmcnt(2)
    v_mfma_f32_16x16x32_bf16 v[108:111], a[60:63], v[84:87], v[108:111]
    ds_read_b128 v[100:103], v12 offset:32768
    v_mfma_f32_16x16x32_bf16 v[112:115], a[60:63], v[88:91], v[112:115]
    ds_read_b128 v[104:107], v12 offset:34816
    v_mfma_f32_16x16x32_bf16 v[116:119], a[140:143], v[84:87], v[116:119]
    v_mfma_f32_16x16x32_bf16 v[120:123], a[140:143], v[88:91], v[120:123]
    s_waitcnt lgkmcnt(2)
    v_mfma_f32_16x16x32_bf16 v[108:111], a[64:67], v[92:95], v[108:111]
    ds_read_b128 v[84:87], v11 offset:36864
    v_mfma_f32_16x16x32_bf16 v[112:115], a[64:67], v[96:99], v[112:115]
    ds_read_b128 v[88:91], v11 offset:38912
    v_mfma_f32_16x16x32_bf16 v[116:119], a[144:147], v[92:95], v[116:119]
    v_mfma_f32_16x16x32_bf16 v[120:123], a[144:147], v[96:99], v[120:123]
    s_waitcnt lgkmcnt(2)
    v_mfma_f32_16x16x32_bf16 v[108:111], a[68:71], v[100:103], v[108:111]
    ds_read_b128 v[92:95], v12 offset:36864
    v_mfma_f32_16x16x32_bf16 v[112:115], a[68:71], v[104:107], v[112:115]
    ds_read_b128 v[96:99], v12 offset:38912
    v_mfma_f32_16x16x32_bf16 v[116:119], a[148:151], v[100:103], v[116:119]
    v_mfma_f32_16x16x32_bf16 v[120:123], a[148:151], v[104:107], v[120:123]
    s_waitcnt lgkmcnt(0)
    v_mfma_f32_16x16x32_bf16 v[108:111], a[72:75], v[84:87], v[108:111]
    v_add_u32 v11, s49, v11
    v_mfma_f32_16x16x32_bf16 v[112:115], a[72:75], v[88:91], v[112:115]
    v_add_u32 v12, s49, v12
    v_mfma_f32_16x16x32_bf16 v[108:111], a[76:79], v[92:95], v[108:111]
    s_sub_u32 s47, s47, s49
    v_mfma_f32_16x16x32_bf16 v[112:115], a[76:79], v[96:99], v[112:115]
    s_sub_u32 s49, 0, s49
    v_mfma_f32_16x16x32_bf16 v[116:119], a[152:155], v[84:87], v[116:119]
    v_mfma_f32_16x16x32_bf16 v[120:123], a[152:155], v[88:91], v[120:123]
    v_mfma_f32_16x16x32_bf16 v[116:119], a[156:159], v[92:95], v[116:119]
    v_mfma_f32_16x16x32_bf16 v[120:123], a[156:159], v[96:99], v[120:123]
    v_cvt_pk_bf16_f32 v124, v108, v109
    v_cvt_pk_bf16_f32 v125, v110, v111
    v_cvt_pk_bf16_f32 v126, v112, v113
    v_cvt_pk_bf16_f32 v127, v114, v115
    s_nop 0
    v_permlane16_swap_b32 v124, v126
    v_permlane16_swap_b32 v125, v127
    v_cvt_pk_bf16_f32 v128, v116, v117
    v_cvt_pk_bf16_f32 v129, v118, v119
    v_cvt_pk_bf16_f32 v130, v120, v121
    v_cvt_pk_bf16_f32 v131, v122, v123
    s_nop 0
    v_permlane16_swap_b32 v128, v130
    v_permlane16_swap_b32 v129, v131
    ds_write_b128 v140, v[128:131]
    buffer_store_dwordx4 v[124:127], v19, s[4:7], s44 offen
    buffer_store_dwordx4 v[128:131], v19, s[4:7], s45 offen
    s_waitcnt vmcnt(2)
    s_branch L_gw_3c
L_gw_3:
    buffer_load_dword v2, v1, s[8:11], 0 offen sc1
    s_sub_u32 s36, s36, 1
    s_cbranch_scc1 L_exit
    s_waitcnt vmcnt(0)
L_gw_3c:
    v_readfirstlane_b32 s90, v2
    s_nop 0
    s_cmp_eq_u32 s90, 0
    s_cbranch_scc1 L_gw_3
    s_cmp_lg_u32 s90, 1
    s_cbranch_scc1 L_slow
    s_waitcnt vmcnt(2) lgkmcnt(0)
    s_barrier
    s_add_u32 s44, s38, 573440
    s_add_u32 s45, s44, s56
    s_mov_b32 s46, 81920
    v_add_u32 v140, 4096, v137
    ds_read_b128 v[84:87], v11 offset:0
    ds_read_b128 v[88:91], v11 offset:2048
    ds_read_b128 v[92:95], v12 offset:0
    ds_read_b128 v[96:99], v12 offset:2048
    s_lshl_b32 s90, s32, 10
    s_add_u32 m0, s90, s47
    s_waitcnt lgkmcnt(2)
    v_mfma_f32_16x16x32_bf16 v[108:111], a[0:3], v[84:87], 0
    ds_read_b128 v[100:103], v11 offset:4096
    s_and_b32 s50, s37, 3
    v_mfma_f32_16x16x32_bf16 v[112:115], a[0:3], v[88:91], 0
    ds_read_b128 v[104:107], v11 offset:6144
    s_mul_i32 s53, s50, 327680
    v_mfma_f32_16x16x32_bf16 v[116:119], a[80:83], v[84:87], 0
    buffer_load_dwordx4 v10, s[24:27], s46 offen offset:0 lds
    s_add_u32 m0, m0, 3968
    v_mfma_f32_16x16x32_bf16 v[120:123], a[80:83], v[88:91], 0
    s_waitcnt lgkmcnt(2)
    s_add_u32 s51, s37, 2
    v_mfma_f32_16x16x32_bf16 v[108:111], a[4:7], v[92:95], v[108:111]
    ds_read_b128 v[84:87], v12 offset:4096
    s_and_b32 s50, s51, 3
    v_mfma_f32_16x16x32_bf16 v[112:115], a[4:7], v[96:99], v[112:115]
    ds_read_b128 v[88:91], v12 offset:6144
    s_mul_i32 s50, s50, 98304
    v_mfma_f32_16x16x32_bf16 v[116:119], a[84:87], v[92:95], v[116:119]
    buffer_load_dwordx4 v10, s[24:27], s46 offen offset:128 lds
    s_add_u32 m0, m0, 3968
    v_mfma_f32_16x16x32_bf16 v[120:123], a[84:87], v[96:99], v[120:123]
    s_waitcnt lgkmcnt(2)
    s_add_u32 s50, s50, 475136
    v_mfma_f32_16x16x32_bf16 v[108:111], a[8:11], v[100:103], v[108:111]
    ds_read_b128 v[92:95], v11 offset:8192
    s_add_u32 s44, s38, s50
    v_mfma_f32_16x16x32_bf16 v[112:115], a[8:11], v[104:107], v[112:115]
    ds_read_b128 v[96:99], v11 offset:10240
    s_add_u32 s45, s44, s56
    v_mfma_f32_16x16x32_bf16 v[116:119], a[88:91], v[100:103], v[116:119]
    buffer_load_dwordx4 v10, s[24:27], s46 offen offset:256 lds
    s_add_u32 m0, m0, 3968
    v_mfma_f32_16x16x32_bf16 v[120:123], a[88:91], v[104:107], v[120:123]
    s_waitcnt lgkmcnt(2)
    s_and_b32 s50, s51, 3
    v_mfma_f32_16x16x32_bf16 v[108:111], a[12:15], v[84:87], v[108:111]
    ds_read_b128 v[100:103], v12 offset:8192
    s_lshl_b32 s50, s50, 12
    v_mfma_f32_16x16x32_bf16 v[112:115], a[12:15], v[88:91], v[112:115]
    ds_read_b128 v[104:107], v12 offset:10240
    v_add_u32 v140, s50, v137
    v_mfma_f32_16x16x32_bf16 v[116:119], a[92:95], v[84:87], v[116:119]
    buffer_load_dwordx4 v10, s[24:27], s46 offen offset:384 lds
    s_add_u32 m0, m0, 3968
    v_mfma_f32_16x16x32_bf16 v[120:123], a[92:95], v[88:91], v[120:123]
    s_waitcnt lgkmcnt(2)
    s_add_u32 s37, s37, 1
    v_mfma_f32_16x16x32_bf16 v[108:111], a[16:19], v[92:95], v[108:111]
    ds_read_b128 v[84:87], v11 offset:12288
    s_mov_b32 s52, 0
    v_mfma_f32_16x16x32_bf16 v[112:115], a[16:19], v[96:99], v[112:115]
    ds_read_b128 v[88:91], v11 offset:14336
    s_and_b32 s50, s37, 3
    v_mfma_f32_16x16x32_bf16 v[116:119], a[96:99], v[92:95], v[116:119]
    buffer_load_dwordx4 v10, s[24:27], s46 offen offset:512 lds
    s_add_u32 m0, m0, 3968
    v_mfma_f32_16x16x32_bf16 v[120:123], a[96:99], v[96:99], v[120:123]
    s_waitcnt lgkmcnt(2)
    s_mul_i32 s51, s50, 114688
    v_mfma_f32_16x16x32_bf16 v[108:111], a[20:23], v[100:103], v[108:111]
    ds_read_b128 v[92:95], v12 offset:12288
    s_add_u32 s41, s38, s51
    v_mfma_f32_16x16x32_bf16 v[112:115], a[20:23], v[104:107], v[112:115]
    ds_read_b128 v[96:99], v12 offset:14336
    s_and_b32 s54, s37, s55
    v_mfma_f32_16x16x32_bf16 v[116:119], a[100:103], v[100:103], v[116:119]
    buffer_load_dwordx4 v10, s[24:27], s46 offen offset:640 lds
    s_add_u32 m0, m0, 3968
    v_mfma_f32_16x16x32_bf16 v[120:123], a[100:103], v[104:107], v[120:123]
    s_waitcnt lgkmcnt(2)
    s_lshl_b32 s50, s50, 12
    v_mfma_f32_16x16x32_bf16 v[108:111], a[24:27], v[84:87], v[108:111]
    ds_read_b128 v[100:103], v11 offset:16384
    v_add_u32 v141, s50, v138
    v_mfma_f32_16x16x32_bf16 v[112:115], a[24:27], v[88:91], v[112:115]
    ds_read_b128 v[104:107], v11 offset:18432
    s_add_u32 s43, s41, 40960
    v_mfma_f32_16x16x32_bf16 v[116:119], a[104:107], v[84:87], v[116:119]
    buffer_load_dwordx4 v10, s[24:27], s46 offen offset:768 lds
    s_add_u32 m0, m0, 3968
    v_mfma_f32_16x16x32_bf16 v[120:123], a[104:107], v[88:91], v[120:123]
    s_waitcnt lgkmcnt(2)
    v_mfma_f32_16x16x32_bf16 v[108:111], a[28:31], v[92:95], v[108:111]
    ds_read_b128 v[84:87], v12 offset:16384
    v_mfma_f32_16x16x32_bf16 v[112:115], a[28:31], v[96:99], v[112:115]
    ds_read_b128 v[88:91], v12 offset:18432
    v_mfma_f32_16x16x32_bf16 v[116:119], a[108:111], v[92:95], v[116:119]
    buffer_load_dwordx4 v10, s[24:27], s46 offen offset:896 lds
    s_add_u32 m0, m0, 3968
    v_mfma_f32_16x16x32_bf16 v[120:123], a[108:111], v[96:99], v[120:123]
    s_waitcnt lgkmcnt(2)
    v_mfma_f32_16x16x32_bf16 v[108:111], a[32:35], v[100:103], v[108:111]
    ds_read_b128 v[92:95], v11 offset:20480
    v_mfma_f32_16x16x32_bf16 v[112:115], a[32:35], v[104:107], v[112:115]
    ds_read_b128 v[96:99], v11 offset:22528
    v_mfma_f32_16x16x32_bf16 v[116:119], a[112:115], v[100:103], v[116:119]
    buffer_load_dwordx4 v10, s[24:27], s46 offen offset:1024 lds
    s_add_u32 m0, m0, 3968
    v_mfma_f32_16x16x32_bf16 v[120:123], a[112:115], v[104:107], v[120:123]
    s_waitcnt lgkmcnt(2)
    v_mfma_f32_16x16x32_bf16 v[108:111], a[36:39], v[84:87], v[108:111]
    ds_read_b128 v[100:103], v12 offset:20480
    v_mfma_f32_16x16x32_bf16 v[112:115], a[36:39], v[88:91], v[112:115]
    ds_read_b128 v[104:107], v12 offset:22528
    v_mfma_f32_16x16x32_bf16 v[116:119], a[116:119], v[84:87], v[116:119]
    buffer_load_dwordx4 v10, s[24:27], s46 offen offset:1152 lds
    v_mfma_f32_16x16x32_bf16 v[120:123], a[116:119], v[88:91], v[120:123]
    s_waitcnt lgkmcnt(2)
    v_mfma_f32_16x16x32_bf16 v[108:111], a[40:43], v[92:95], v[108:111]
    ds_read_b128 v[84:87], v11 offset:24576
    v_mfma_f32_16x16x32_bf16 v[112:115], a[40:43], v[96:99], v[112:115]
    ds_read_b128 v[88:91], v11 offset:26624
    v_mfma_f32_16x16x32_bf16 v[116:119], a[120:123], v[92:95], v[116:119]
    v_mfma_f32_16x16x32_bf16 v[120:123], a[120:123], v[96:99], v[120:123]
    s_waitcnt lgkmcnt(2)
    v_mfma_f32_16x16x32_bf16 v[108:111], a[44:47], v[100:103], v[108:111]
    ds_read_b128 v[92:95], v12 offset:24576
    v_mfma_f32_16x16x32_bf16 v[112:115], a[44:47], v[104:107], v[112:115]
    ds_read_b128 v[96:99], v12 offset:26624
    v_mfma_f32_16x16x32_bf16 v[116:119], a[124:127], v[100:103], v[116:119]
    v_mfma_f32_16x16x32_bf16 v[120:123], a[124:127], v[104:107], v[120:123]
    s_waitcnt lgkmcnt(2)
    v_mfma_f32_16x16x32_bf16 v[108:111], a[48:51], v[84:87], v[108:111]
    ds_read_b128 v[100:103], v11 offset:28672
    v_mfma_f32_16x16x32_bf16 v[112:115], a[48:51], v[88:91], v[112:115]
    ds_read_b128 v[104:107], v11 offset:30720
    v_mfma_f32_16x16x32_bf16 v[116:119], a[128:131], v[84:87], v[116:119]
    v_mfma_f32_16x16x32_bf16 v[120:123], a[128:131], v[88:91], v[120:123]
    s_waitcnt lgkmcnt(2)
    v_mfma_f32_16x16x32_bf16 v[108:111], a[52:55], v[92:95], v[108:111]
    ds_read_b128 v[84:87], v12 offset:28672
    v_mfma_f32_16x16x32_bf16 v[112:115], a[52:55], v[96:99], v[112:115]
    ds_read_b128 v[88:91], v12 offset:30720
    v_mfma_f32_16x16x32_bf16 v[116:119], a[132:135], v[92:95], v[116:119]
    v_mfma_f32_16x16x32_bf16 v[120:123], a[132:135], v[96:99], v[120:123]
    s_waitcnt lgkmcnt(2)
    v_mfma_f32_16x16x32_bf16 v[108:111], a[56:59], v[100:103], v[108:111]
    ds_read_b128 v[92:95], v11 offset:32768
    v_mfma_f32_16x16x32_bf16 v[112:115], a[56:59], v[104:107], v[112:115]
    ds_read_b128 v[96:99], v11 offset:34816
    v_mfma_f32_16x16x32_bf16 v[116:119], a[136:139], v[100:103], v[116:119]
    v_mfma_f32_16x16x32_bf16 v[120:123], a[136:139], v[104:107], v[120:123]
    s_waitcnt lgkmcnt(2)
    v_mfma_f32_16x16x32_bf16 v[108:111], a[60:63], v[84:87], v[108:111]
    ds_read_b128 v[100:103], v12 offset:32768
    v_mfma_f32_16x16x32_bf16 v[112:115], a[60:63], v[88:91], v[112:115]
    ds_read_b128 v[104:107], v12 offset:34816
    v_mfma_f32_16x16x32_bf16 v[116:119], a[140:143], v[84:87], v[116:119]
    v_mfma_f32_16x16x32_bf16 v[120:123], a[140:143], v[88:91], v[120:123]
    s_waitcnt lgkmcnt(2)
    v_mfma_f32_16x16x32_bf16 v[108:111], a[64:67], v[92:95], v[108:111]
    ds_read_b128 v[84:87], v11 offset:36864
    v_mfma_f32_16x16x32_bf16 v[112:115], a[64:67], v[96:99], v[112:115]
    ds_read_b128 v[88:91], v11 offset:38912
    v_mfma_f32_16x16x32_bf16 v[116:119], a[144:147], v[92:95], v[116:119]
    v_mfma_f32_16x16x32_bf16 v[120:123], a[144:147], v[96:99], v[120:123]
    s_waitcnt lgkmcnt(2)
    v_mfma_f32_16x16x32_bf16 v[108:111], a[68:71], v[100:103], v[108:111]
    ds_read_b128 v[92:95], v12 offset:36864
    v_mfma_f32_16x16x32_bf16 v[112:115], a[68:71], v[104:107], v[112:115]
    ds_read_b128 v[96:99], v12 offset:38912
    v_mfma_f32_16x16x32_bf16 v[116:119], a[148:151], v[100:103], v[116:119]
    v_mfma_f32_16x16x32_bf16 v[120:123], a[148:151], v[104:107], v[120:123]
    s_waitcnt lgkmcnt(0)
    v_mfma_f32_16x16x32_bf16 v[108:111], a[72:75], v[84:87], v[108:111]
    v_add_u32 v11, s49, v11
    v_mfma_f32_16x16x32_bf16 v[112:115], a[72:75], v[88:91], v[112:115]
    v_add_u32 v12, s49, v12
    v_mfma_f32_16x16x32_bf16 v[108:111], a[76:79], v[92:95], v[108:111]
    s_sub_u32 s47, s47, s49
    v_mfma_f32_16x16x32_bf16 v[112:115], a[76:79], v[96:99], v[112:115]
    s_sub_u32 s49, 0, s49
    v_mfma_f32_16x16x32_bf16 v[116:119], a[152:155], v[84:87], v[116:119]
    v_mfma_f32_16x16x32_bf16 v[120:123], a[152:155], v[88:91], v[120:123]
    v_mfma_f32_16x16x32_bf16 v[116:119], a[156:159], v[92:95], v[116:119]
    v_mfma_f32_16x16x32_bf16 v[120:123], a[156:159], v[96:99], v[120:123]
    v_cvt_pk_bf16_f32 v124, v108, v109
    v_cvt_pk_bf16_f32 v125, v110, v111
    v_cvt_pk_bf16_f32 v126, v112, v113
    v_cvt_pk_bf16_f32 v127, v114, v115
    s_nop 0
    v_permlane16_swap_b32 v124, v126
    v_permlane16_swap_b32 v125, v127
    v_cvt_pk_bf16_f32 v128, v116, v117
    v_cvt_pk_bf16_f32 v129, v118, v119
    v_cvt_pk_bf16_f32 v130, v120, v121
    v_cvt_pk_bf16_f32 v131, v122, v123
    s_nop 0
    v_permlane16_swap_b32 v128, v130
    v_permlane16_swap_b32 v129, v131
    ds_write_b128 v140, v[128:131]
    buffer_store_dwordx4 v[124:127], v19, s[4:7], s44 offen
    buffer_store_dwordx4 v[128:131], v19, s[4:7], s45 offen
    s_mov_b32 m0, s48
L_qkv_loop_f:
    s_nop 0
    buffer_load_dwordx4 v13, s[4:7], s41 offen sc1 lds
    buffer_load_dwordx4 v13, s[4:7], s41 offen offset:1024 sc1 lds
    buffer_load_dword v14, s[4:7], s41 offen offset:2048 sc1 lds
    buffer_load_dword v14, s[4:7], s41 offen offset:2304 sc1 lds
    s_add_u32 s50, s37, 2
    s_and_b32 s50, s50, 3
    s_mul_i32 s50, s50, 114688
    s_add_u32 s42, s38, s50
    s_add_u32 s50, s37, 3
    s_min_u32 s50, s50, 63
    s_mul_i32 s46, s50, 40960
    s_add_u32 s51, s37, 1
    v_mov_b32 v20, s51
    s_mov_b32 m0, s48
    v_mov_b32 v68, 0
    v_mov_b32 v69, 0
    v_mov_b32 v70, 0
    v_mov_b32 v71, 0
    v_mov_b32 v72, 0
    v_mov_b32 v73, 0
    v_mov_b32 v74, 0
    v_mov_b32 v75, 0
    ds_read_b128 v[156:159], v141
    ds_read_b128 v[160:163], v141 offset:1024
L_poll_5:
    buffer_load_dwordx4 v13, s[4:7], s41 offen sc1 lds
    buffer_load_dwordx4 v13, s[4:7], s41 offen offset:1024 sc1 lds
    buffer_load_dword v14, s[4:7], s41 offen offset:2048 sc1 lds
    buffer_load_dword v14, s[4:7], s41 offen offset:2304 sc1 lds
    s_sub_u32 s36, s36, 1
    s_cbranch_scc1 L_exit
    s_waitcnt vmcnt(4)
    ds_read_b32 v18, v15
    s_waitcnt lgkmcnt(0)
    v_cmp_eq_u32 vcc, -1, v18
    s_cbranch_vccnz L_poll_5
    s_barrier
    ds_read_b128 v[28:31], v16 offset:0
    ds_read_b128 v[32:35], v16 offset:1024
    ds_read_b128 v[36:39], v16 offset:2048
    ds_read_b128 v[40:43], v16 offset:3072
    s_waitcnt lgkmcnt(3)
    v_smfmac_f32_16x16x64_bf16 v[68:71], v[28:31], a[0:7], v17
    ds_read_b128 v[44:47], v16 offset:4096
    v_smfmac_f32_16x16x64_bf16 v[72:75], v[28:31], a[80:87], v17
    ds_read_b128 v[48:51], v16 offset:5120
    s_waitcnt lgkmcnt(4)
    v_smfmac_f32_16x16x64_bf16 v[68:71], v[32:35], a[8:15], v17
    ds_read_b128 v[52:55], v16 offset:6144
    v_smfmac_f32_16x16x64_bf16 v[72:75], v[32:35], a[88:95], v17
    ds_read_b128 v[56:59], v16 offset:7168
    s_waitcnt lgkmcnt(5)
    v_smfmac_f32_16x16x64_bf16 v[68:71], v[36:39], a[16:23], v17
    ds_read_b128 v[60:63], v16 offset:8192
    s_waitcnt lgkmcnt(5)
    v_smfmac_f32_16x16x64_bf16 v[68:71], v[40:43], a[24:31], v17
    ds_read_b128 v[64:67], v16 offset:9216
    s_waitcnt lgkmcnt(5)
    v_smfmac_f32_16x16x64_bf16 v[68:71], v[44:47], a[32:39], v17
    s_waitcnt lgkmcnt(4)
    v_smfmac_f32_16x16x64_bf16 v[68:71], v[48:51], a[40:47], v17
    s_waitcnt lgkmcnt(3)
    v_smfmac_f32_16x16x64_bf16 v[68:71], v[52:55], a[48:55], v17
    s_waitcnt lgkmcnt(2)
    v_smfmac_f32_16x16x64_bf16 v[68:71], v[56:59], a[56:63], v17
    s_waitcnt lgkmcnt(1)
    v_smfmac_f32_16x16x64_bf16 v[68:71], v[60:63], a[64:71], v17
    buffer_store_dword v20, v21, s[4:7], s38 offen offset:0
    s_waitcnt lgkmcnt(0)
    v_smfmac_f32_16x16x64_bf16 v[68:71], v[64:67], a[72:79], v17
L_redo_4:
    v_smfmac_f32_16x16x64_bf16 v[72:75], v[36:39], a[96:103], v17
    v_smfmac_f32_16x16x64_bf16 v[72:75], v[40:43], a[104:111], v17
    v_smfmac_f32_16x16x64_bf16 v[72:75], v[44:47], a[112:119], v17
    v_add_f32 v68, v68, v70
    v_add_f32 v69, v69, v71
    v_smfmac_f32_16x16x64_bf16 v[72:75], v[48:51], a[120:127], v17
    v_cvt_pk_bf16_f32 v132, v68, v69
    ds_write_b32 v23, v132
    v_smfmac_f32_16x16x64_bf16 v[72:75], v[52:55], a[128:135], v17
    v_cmp_u_f32 vcc, v68, v69
    v_smfmac_f32_16x16x64_bf16 v[72:75], v[56:59], a[136:143], v17
    v_smfmac_f32_16x16x64_bf16 v[72:75], v[60:63], a[144:151], v17
    s_cbranch_vccnz L_nan_6
L_cont_7:
    v_smfmac_f32_16x16x64_bf16 v[72:75], v[64:67], a[152:159], v17
    s_waitcnt lgkmcnt(0)
    s_barrier
    ds_read_b64_tr_b16 v[76:77], v24 offset:0
    ds_read_b64_tr_b16 v[78:79], v134 offset:0
    ds_read_b64_tr_b16 v[80:81], v24 offset:1024
    ds_read_b64_tr_b16 v[82:83], v134 offset:1024
    s_cmp_eq_u32 s32, 0
    s_cbranch_scc1 L_w0_8
    s_cmp_eq_u32 s32, 3
    s_cbranch_scc1 L_w3_9
    v_pk_add_f32 v[72:73], v[72:73], v[74:75]
    v_cvt_pk_bf16_f32 v133, v72, v73
    ds_write_b32 v23, v133 offset:4
    s_waitcnt lgkmcnt(3)
    v_mfma_f32_16x16x32_bf16 v[164:167], v[156:159], v[76:79], 0
    s_waitcnt lgkmcnt(1)
    v_mfma_f32_16x16x32_bf16 v[164:167], v[160:163], v[80:83], v[164:167]
    s_waitcnt lgkmcnt(0)
    s_barrier
    s_nop 5
    buffer_store_dwordx4 v[164:167], v135, s[4:7], s41 offen
    ds_read_b128 v[84:87], v11 offset:0
    ds_read_b128 v[88:91], v11 offset:2048
    ds_read_b128 v[92:95], v12 offset:0
    ds_read_b128 v[96:99], v12 offset:2048
    s_branch L_join_10
L_w0_8:
    v_pk_add_f32 v[72:73], v[72:73], v[74:75]
    v_cvt_pk_bf16_f32 v133, v72, v73
    ds_write_b32 v23, v133 offset:4
    s_waitcnt lgkmcnt(0)
    s_barrier
    ds_read_b64_tr_b16 v[76:77], v24 offset:0
    ds_read_b64_tr_b16 v[78:79], v134 offset:0
    ds_read_b64_tr_b16 v[80:81], v24 offset:1024
    ds_read_b64_tr_b16 v[82:83], v134 offset:1024
    s_waitcnt lgkmcnt(2)
    v_mfma_f32_16x16x32_bf16 v[164:167], v[76:79], v[76:79], 0
    s_waitcnt lgkmcnt(0)
    v_mfma_f32_16x16x32_bf16 v[164:167], v[80:83], v[80:83], v[164:167]
    ds_read_b128 v[84:87], v11 offset:0
    ds_read_b128 v[88:91], v11 offset:2048
    ds_read_b128 v[92:95], v12 offset:0
    ds_read_b128 v[96:99], v12 offset:2048
    s_nop 3
    buffer_store_dword v166, v135, s[4:7], s41 offen
    buffer_store_dword v167, v135, s[4:7], s41 offen offset:8
    s_branch L_join_10
L_w3_9:
    v_pk_add_f32 v[72:73], v[72:73], v[74:75]
    v_cvt_pk_bf16_f32 v133, v72, v73
    ds_write_b32 v23, v133 offset:4
    s_waitcnt lgkmcnt(0)
    s_barrier
    ds_read_b64_tr_b16 v[76:77], v24 offset:0
    ds_read_b64_tr_b16 v[78:79], v134 offset:0
    ds_read_b64_tr_b16 v[80:81], v24 offset:1024
    ds_read_b64_tr_b16 v[82:83], v134 offset:1024
    buffer_store_dword v20, v21, s[4:7], s38 offen offset:32
    s_waitcnt lgkmcnt(0)
    ds_read_b128 v[84:87], v11 offset:0
    ds_read_b128 v[88:91], v11 offset:2048
    ds_read_b128 v[92:95], v12 offset:0
    ds_read_b128 v[96:99], v12 offset:2048
    s_waitcnt lgkmcnt(0)
    buffer_store_dwordx4 v[76:79], v136, s[4:7], s43 offen
    buffer_store_dwordx4 v[80:83], v136, s[4:7], s43 offen offset:512
L_join_10:
    s_cmp_eq_u32 s37, 63
    s_cbranch_scc1 L_end_11
    s_cmp_eq_u32 s37, 0
    s_cbranch_scc1 L_sd_12c
L_sd_12:
    s_lshl_b32 s90, s32, 10
    s_add_u32 m0, s90, s47
    s_waitcnt lgkmcnt(2)
    v_mfma_f32_16x16x32_bf16 v[108:111], a[0:3], v[84:87], 0
    ds_read_b128 v[100:103], v11 offset:4096
    s_and_b32 s50, s37, 3
    v_mfma_f32_16x16x32_bf16 v[112:115], a[0:3], v[88:91], 0
    ds_read_b128 v[104:107], v11 offset:6144
    s_mul_i32 s53, s50, 327680
    v_mfma_f32_16x16x32_bf16 v[116:119], a[80:83], v[84:87], 0
    s_add_u32 s51, s37, 2
    s_and_b32 s50, s51, 3
    v_mfma_f32_16x16x32_bf16 v[120:123], a[80:83], v[88:91], 0
    s_waitcnt lgkmcnt(2)
    s_mul_i32 s50, s50, 98304
    v_mfma_f32_16x16x32_bf16 v[108:111], a[4:7], v[92:95], v[108:111]
    ds_read_b128 v[84:87], v12 offset:4096
    s_add_u32 s50, s50, 475136
    v_mfma_f32_16x16x32_bf16 v[112:115], a[4:7], v[96:99], v[112:115]
    ds_read_b128 v[88:91], v12 offset:6144
    s_add_u32 s44, s38, s50
    v_mfma_f32_16x16x32_bf16 v[116:119], a[84:87], v[92:95], v[116:119]
    s_add_u32 s45, s44, s56
    s_and_b32 s50, s51, 3
    v_mfma_f32_16x16x32_bf16 v[120:123], a[84:87], v[96:99], v[120:123]
    s_waitcnt lgkmcnt(2)
    s_lshl_b32 s50, s50, 12
    v_mfma_f32_16x16x32_bf16 v[108:111], a[8:11], v[100:103], v[108:111]
    ds_read_b128 v[92:95], v11 offset:8192
    v_add_u32 v140, s50, v137
    v_mfma_f32_16x16x32_bf16 v[112:115], a[8:11], v[104:107], v[112:115]
    ds_read_b128 v[96:99], v11 offset:10240
    s_add_u32 s37, s37, 1
    v_mfma_f32_16x16x32_bf16 v[116:119], a[88:91], v[100:103], v[116:119]
    s_mov_b32 s52, 0
    s_and_b32 s50, s37, 3
    v_mfma_f32_16x16x32_bf16 v[120:123], a[88:91], v[104:107], v[120:123]
    s_waitcnt lgkmcnt(2)
    s_mul_i32 s51, s50, 114688
    v_mfma_f32_16x16x32_bf16 v[108:111], a[12:15], v[84:87], v[108:111]
    ds_read_b128 v[100:103], v12 offset:8192
    s_add_u32 s41, s38, s51
    v_mfma_f32_16x16x32_bf16 v[112:115], a[12:15], v[88:91], v[112:115]
    ds_read_b128 v[104:107], v12 offset:10240
    s_and_b32 s54, s37, s55
    v_mfma_f32_16x16x32_bf16 v[116:119], a[92:95], v[84:87], v[116:119]
    buffer_store_dword v22, v150, s[4:7], s42 offen offset:0
    buffer_store_dword v22, v149, s[4:7], s42 offen offset:0
    v_mfma_f32_16x16x32_bf16 v[120:123], a[92:95], v[88:91], v[120:123]
    s_waitcnt lgkmcnt(2)
    s_lshl_b32 s50, s50, 12
    v_mfma_f32_16x16x32_bf16 v[108:111], a[16:19], v[92:95], v[108:111]
    ds_read_b128 v[84:87], v11 offset:12288
    v_add_u32 v141, s50, v138
    v_mfma_f32_16x16x32_bf16 v[112:115], a[16:19], v[96:99], v[112:115]
    ds_read_b128 v[88:91], v11 offset:14336
    s_add_u32 s43, s41, 40960
    v_mfma_f32_16x16x32_bf16 v[116:119], a[96:99], v[92:95], v[116:119]
    buffer_store_dword v22, v150, s[4:7], s42 offen offset:256
    v_mfma_f32_16x16x32_bf16 v[120:123], a[96:99], v[96:99], v[120:123]
    s_waitcnt lgkmcnt(2)
    v_mfma_f32_16x16x32_bf16 v[108:111], a[20:23], v[100:103], v[108:111]
    ds_read_b128 v[92:95], v12 offset:12288
    v_mfma_f32_16x16x32_bf16 v[112:115], a[20:23], v[104:107], v[112:115]
    ds_read_b128 v[96:99], v12 offset:14336
    v_mfma_f32_16x16x32_bf16 v[116:119], a[100:103], v[100:103], v[116:119]
    buffer_load_dwordx4 v10, s[24:27], s46 offen offset:0 lds
    s_add_u32 m0, m0, 3968
    v_mfma_f32_16x16x32_bf16 v[120:123], a[100:103], v[104:107], v[120:123]
    s_waitcnt lgkmcnt(2)
    v_mfma_f32_16x16x32_bf16 v[108:111], a[24:27], v[84:87], v[108:111]
    ds_read_b128 v[100:103], v11 offset:16384
    v_mfma_f32_16x16x32_bf16 v[112:115], a[24:27], v[88:91], v[112:115]
    ds_read_b128 v[104:107], v11 offset:18432
    v_mfma_f32_16x16x32_bf16 v[116:119], a[104:107], v[84:87], v[116:119]
    buffer_load_dwordx4 v10, s[24:27], s46 offen offset:128 lds
    s_add_u32 m0, m0, 3968
    v_mfma_f32_16x16x32_bf16 v[120:123], a[104:107], v[88:91], v[120:123]
    s_waitcnt lgkmcnt(2)
    v_mfma_f32_16x16x32_bf16 v[108:111], a[28:31], v[92:95], v[108:111]
    ds_read_b128 v[84:87], v12 offset:16384
    v_mfma_f32_16x16x32_bf16 v[112:115], a[28:31], v[96:99], v[112:115]
    ds_read_b128 v[88:91], v12 offset:18432
    v_mfma_f32_16x16x32_bf16 v[116:119], a[108:111], v[92:95], v[116:119]
    buffer_load_dwordx4 v10, s[24:27], s46 offen offset:256 lds
    s_add_u32 m0, m0, 3968
    v_mfma_f32_16x16x32_bf16 v[120:123], a[108:111], v[96:99], v[120:123]
    s_waitcnt lgkmcnt(2)
    v_mfma_f32_16x16x32_bf16 v[108:111], a[32:35], v[100:103], v[108:111]
    ds_read_b128 v[92:95], v11 offset:20480
    v_mfma_f32_16x16x32_bf16 v[112:115], a[32:35], v[104:107], v[112:115]
    ds_read_b128 v[96:99], v11 offset:22528
    v_mfma_f32_16x16x32_bf16 v[116:119], a[112:115], v[100:103], v[116:119]
    s_waitcnt vmcnt(6)
    buffer_store_dword v20, v139, s[4:7], s38 offen
    v_mfma_f32_16x16x32_bf16 v[120:123], a[112:115], v[104:107], v[120:123]
    s_waitcnt lgkmcnt(2)
    v_mfma_f32_16x16x32_bf16 v[108:111], a[36:39], v[84:87], v[108:111]
    ds_read_b128 v[100:103], v12 offset:20480
    v_mfma_f32_16x16x32_bf16 v[112:115], a[36:39], v[88:91], v[112:115]
    buffer_load_dword v147, v146, s[4:7], 0 offen sc1
    ds_read_b128 v[104:107], v12 offset:22528
    v_mfma_f32_16x16x32_bf16 v[116:119], a[116:119], v[84:87], v[116:119]
    buffer_load_dwordx4 v10, s[24:27], s46 offen offset:384 lds
    s_add_u32 m0, m0, 3968
    v_mfma_f32_16x16x32_bf16 v[120:123], a[116:119], v[88:91], v[120:123]
    s_waitcnt lgkmcnt(2)
    v_mfma_f32_16x16x32_bf16 v[108:111], a[40:43], v[92:95], v[108:111]
    ds_read_b128 v[84:87], v11 offset:24576
    v_mfma_f32_16x16x32_bf16 v[112:115], a[40:43], v[96:99], v[112:115]
    buffer_load_dword v147, v146, s[4:7], 0 offen sc1
    ds_read_b128 v[88:91], v11 offset:26624
    v_mfma_f32_16x16x32_bf16 v[116:119], a[120:123], v[92:95], v[116:119]
    buffer_load_dwordx4 v10, s[24:27], s46 offen offset:512 lds
    s_add_u32 m0, m0, 3968
    v_mfma_f32_16x16x32_bf16 v[120:123], a[120:123], v[96:99], v[120:123]
    s_waitcnt lgkmcnt(2)
    v_mfma_f32_16x16x32_bf16 v[108:111], a[44:47], v[100:103], v[108:111]
    ds_read_b128 v[92:95], v12 offset:24576
    v_mfma_f32_16x16x32_bf16 v[112:115], a[44:47], v[104:107], v[112:115]
    buffer_load_dword v147, v146, s[4:7], 0 offen sc1
    ds_read_b128 v[96:99], v12 offset:26624
    v_mfma_f32_16x16x32_bf16 v[116:119], a[124:127], v[100:103], v[116:119]
    buffer_load_dwordx4 v10, s[24:27], s46 offen offset:640 lds
    s_add_u32 m0, m0, 3968
    v_mfma_f32_16x16x32_bf16 v[120:123], a[124:127], v[104:107], v[120:123]
    s_waitcnt lgkmcnt(2)
    v_mfma_f32_16x16x32_bf16 v[108:111], a[48:51], v[84:87], v[108:111]
    ds_read_b128 v[100:103], v11 offset:28672
    v_mfma_f32_16x16x32_bf16 v[112:115], a[48:51], v[88:91], v[112:115]
    buffer_load_dword v147, v146, s[4:7], 0 offen sc1
    ds_read_b128 v[104:107], v11 offset:30720
    v_mfma_f32_16x16x32_bf16 v[116:119], a[128:131], v[84:87], v[116:119]
    buffer_load_dwordx4 v10, s[24:27], s46 offen offset:768 lds
    s_add_u32 m0, m0, 3968
    v_mfma_f32_16x16x32_bf16 v[120:123], a[128:131], v[88:91], v[120:123]
    s_waitcnt lgkmcnt(2)
    v_mfma_f32_16x16x32_bf16 v[108:111], a[52:55], v[92:95], v[108:111]
    ds_read_b128 v[84:87], v12 offset:28672
    v_mfma_f32_16x16x32_bf16 v[112:115], a[52:55], v[96:99], v[112:115]
    buffer_load_dword v147, v146, s[4:7], 0 offen sc1
    ds_read_b128 v[88:91], v12 offset:30720
    v_mfma_f32_16x16x32_bf16 v[116:119], a[132:135], v[92:95], v[116:119]
    buffer_load_dwordx4 v10, s[24:27], s46 offen offset:896 lds
    s_add_u32 m0, m0, 3968
    v_mfma_f32_16x16x32_bf16 v[120:123], a[132:135], v[96:99], v[120:123]
    s_waitcnt lgkmcnt(2)
    v_mfma_f32_16x16x32_bf16 v[108:111], a[56:59], v[100:103], v[108:111]
    ds_read_b128 v[92:95], v11 offset:32768
    v_mfma_f32_16x16x32_bf16 v[112:115], a[56:59], v[104:107], v[112:115]
    buffer_load_dword v147, v146, s[4:7], 0 offen sc1
    ds_read_b128 v[96:99], v11 offset:34816
    v_mfma_f32_16x16x32_bf16 v[116:119], a[136:139], v[100:103], v[116:119]
    buffer_load_dwordx4 v10, s[24:27], s46 offen offset:1024 lds
    s_add_u32 m0, m0, 3968
    v_mfma_f32_16x16x32_bf16 v[120:123], a[136:139], v[104:107], v[120:123]
    s_waitcnt lgkmcnt(2)
    v_mfma_f32_16x16x32_bf16 v[108:111], a[60:63], v[84:87], v[108:111]
    ds_read_b128 v[100:103], v12 offset:32768
    v_mfma_f32_16x16x32_bf16 v[112:115], a[60:63], v[88:91], v[112:115]
    buffer_load_dword v147, v146, s[4:7], 0 offen sc1
    ds_read_b128 v[104:107], v12 offset:34816
    v_mfma_f32_16x16x32_bf16 v[116:119], a[140:143], v[84:87], v[116:119]
    buffer_load_dwordx4 v10, s[24:27], s46 offen offset:1152 lds
    v_mfma_f32_16x16x32_bf16 v[120:123], a[140:143], v[88:91], v[120:123]
    s_waitcnt lgkmcnt(2)
    v_mfma_f32_16x16x32_bf16 v[108:111], a[64:67], v[92:95], v[108:111]
    ds_read_b128 v[84:87], v11 offset:36864
    v_mfma_f32_16x16x32_bf16 v[112:115], a[64:67], v[96:99], v[112:115]
L_sp_13:
    s_waitcnt vmcnt(6)
    v_cmp_gt_u32 vcc, s54, v147
    buffer_load_dword v147, v146, s[4:7], 0 offen sc1
    s_sub_u32 s36, s36, 1
    s_cbranch_scc1 L_exit
    s_cbranch_vccz L_sp_13x
    s_waitcnt vmcnt(6)
    v_cmp_gt_u32 vcc, s54, v147
    buffer_load_dword v147, v146, s[4:7], 0 offen sc1
    s_cbranch_vccz L_sp_13x
    s_waitcnt vmcnt(6)
    v_cmp_gt_u32 vcc, s54, v147
    buffer_load_dword v147, v146, s[4:7], 0 offen sc1
    s_cbranch_vccz L_sp_13x
    s_waitcnt vmcnt(6)
    v_cmp_gt_u32 vcc, s54, v147
    buffer_load_dword v147, v146, s[4:7], 0 offen sc1
    s_cbranch_vccnz L_sp_13
L_sp_13x:
    s_barrier
    buffer_load_dwordx4 v[168:171], v142, s[4:7], s53 offen sc1
    ds_read_b128 v[88:91], v11 offset:38912
    v_mfma_f32_16x16x32_bf16 v[116:119], a[144:147], v[92:95], v[116:119]
    v_mfma_f32_16x16x32_bf16 v[120:123], a[144:147], v[96:99], v[120:123]
    s_waitcnt lgkmcnt(2)
    v_mfma_f32_16x16x32_bf16 v[108:111], a[68:71], v[100:103], v[108:111]
    ds_read_b128 v[92:95], v12 offset:36864
    v_mfma_f32_16x16x32_bf16 v[112:115], a[68:71], v[104:107], v[112:115]
    ds_read_b128 v[96:99], v12 offset:38912
    v_mfma_f32_16x16x32_bf16 v[116:119], a[148:151], v[100:103], v[116:119]
    v_mfma_f32_16x16x32_bf16 v[120:123], a[148:151], v[104:107], v[120:123]
    buffer_load_dwordx4 v[172:175], v143, s[4:7], s53 offen sc1
    s_waitcnt lgkmcnt(0)
    v_mfma_f32_16x16x32_bf16 v[108:111], a[72:75], v[84:87], v[108:111]
    v_add_u32 v11, s49, v11
    v_mfma_f32_16x16x32_bf16 v[112:115], a[72:75], v[88:91], v[112:115]
    v_add_u32 v12, s49, v12
    v_mfma_f32_16x16x32_bf16 v[108:111], a[76:79], v[92:95], v[108:111]
    s_sub_u32 s47, s47, s49
    v_mfma_f32_16x16x32_bf16 v[112:115], a[76:79], v[96:99], v[112:115]
    s_sub_u32 s49, 0, s49
    v_mfma_f32_16x16x32_bf16 v[116:119], a[152:155], v[84:87], v[116:119]
    v_mfma_f32_16x16x32_bf16 v[120:123], a[152:155], v[88:91], v[120:123]
    v_mfma_f32_16x16x32_bf16 v[116:119], a[156:159], v[92:95], v[116:119]
    v_mfma_f32_16x16x32_bf16 v[120:123], a[156:159], v[96:99], v[120:123]
    v_cvt_pk_bf16_f32 v124, v108, v109
    v_cvt_pk_bf16_f32 v125, v110, v111
    v_cvt_pk_bf16_f32 v126, v112, v113
    v_cvt_pk_bf16_f32 v127, v114, v115
    s_nop 0
    v_permlane16_swap_b32 v124, v126
    v_permlane16_swap_b32 v125, v127
    v_cvt_pk_bf16_f32 v128, v116, v117
    v_cvt_pk_bf16_f32 v129, v118, v119
    v_cvt_pk_bf16_f32 v130, v120, v121
    v_cvt_pk_bf16_f32 v131, v122, v123
    s_nop 0
    v_permlane16_swap_b32 v128, v130
    v_permlane16_swap_b32 v129, v131
    ds_write_b128 v140, v[128:131]
    buffer_store_dwordx4 v[124:127], v19, s[4:7], s44 offen
    buffer_store_dwordx4 v[128:131], v19, s[4:7], s45 offen
    s_mov_b32 m0, s48
    s_waitcnt vmcnt(3)
    v_mfma_f32_16x16x32_bf16 v[184:187], v[198:201], v[168:171], 0
    v_mfma_f32_16x16x32_bf16 v[188:191], v[196:199], v[168:171], 0
    s_waitcnt vmcnt(2)
    v_mfma_f32_16x16x32_bf16 v[184:187], v[198:201], v[172:175], v[184:187]
    v_mfma_f32_16x16x32_bf16 v[188:191], v[196:199], v[172:175], v[188:191]
    s_nop 4
    v_cmp_u_f32 vcc, v184, v184
    v_cvt_pk_bf16_f32 v192, v184, v185
    v_cvt_pk_bf16_f32 v193, v186, v187
    v_cvt_pk_bf16_f32 v194, v188, v189
    v_cvt_pk_bf16_f32 v195, v190, v191
    s_cbranch_vccnz L_pp_14
L_pc_15:
    buffer_store_dwordx4 v[192:195], v148, s[4:7], s41 offen
    s_barrier
    s_branch L_qkv_loop_f
L_end_11:
    s_waitcnt vmcnt(0) lgkmcnt(0)
    buffer_store_dword v20, v139, s[4:7], s38 offen
    s_endpgm
L_nan_6:
    s_cmp_eq_u32 s52, 1
    s_cbranch_scc1 L_cont_7
    v_lshlrev_b32 v1, 4, v0
L_nan_6r:
    s_mov_b32 s90, s41
    v_mov_b32 v2, 0
    buffer_load_dwordx4 v[28:31], v1, s[4:7], s90 offen sc1
    s_add_u32 s90, s90, 1024
    buffer_load_dwordx4 v[32:35], v1, s[4:7], s90 offen sc1
    s_add_u32 s90, s90, 1024
    buffer_load_dwordx4 v[36:39], v1, s[4:7], s90 offen sc1
    s_add_u32 s90, s90, 1024
    buffer_load_dwordx4 v[40:43], v1, s[4:7], s90 offen sc1
    s_add_u32 s90, s90, 1024
    buffer_load_dwordx4 v[44:47], v1, s[4:7], s90 offen sc1
    s_add_u32 s90, s90, 1024
    buffer_load_dwordx4 v[48:51], v1, s[4:7], s90 offen sc1
    s_add_u32 s90, s90, 1024
    buffer_load_dwordx4 v[52:55], v1, s[4:7], s90 offen sc1
    s_add_u32 s90, s90, 1024
    buffer_load_dwordx4 v[56:59], v1, s[4:7], s90 offen sc1
    s_add_u32 s90, s90, 1024
    buffer_load_dwordx4 v[60:63], v1, s[4:7], s90 offen sc1
    s_add_u32 s90, s90, 1024
    buffer_load_dwordx4 v[64:67], v1, s[4:7], s90 offen sc1
    s_add_u32 s90, s90, 1024
    s_sub_u32 s36, s36, 1
    s_cbranch_scc1 L_exit
    s_waitcnt vmcnt(0) lgkmcnt(0)
    v_max3_u32 v2, v2, v28, v29
    v_max3_u32 v2, v2, v30, v31
    v_max3_u32 v2, v2, v32, v33
    v_max3_u32 v2, v2, v34, v35
    v_max3_u32 v2, v2, v36, v37
    v_max3_u32 v2, v2, v38, v39
    v_max3_u32 v2, v2, v40, v41
    v_max3_u32 v2, v2, v42, v43
    v_max3_u32 v2, v2, v44, v45
    v_max3_u32 v2, v2, v46, v47
    v_max3_u32 v2, v2, v48, v49
    v_max3_u32 v2, v2, v50, v51
    v_max3_u32 v2, v2, v52, v53
    v_max3_u32 v2, v2, v54, v55
    v_max3_u32 v2, v2, v56, v57
    v_max3_u32 v2, v2, v58, v59
    v_max3_u32 v2, v2, v60, v61
    v_max3_u32 v2, v2, v62, v63
    v_max3_u32 v2, v2, v64, v65
    v_max3_u32 v2, v2, v66, v67
    v_cmp_eq_u32 vcc, -1, v2
    s_cbranch_vccnz L_nan_6r
    s_mov_b32 s52, 1
    v_mov_b32 v68, 0
    v_mov_b32 v69, 0
    v_mov_b32 v70, 0
    v_mov_b32 v71, 0
    v_mov_b32 v72, 0
    v_mov_b32 v73, 0
    v_mov_b32 v74, 0
    v_mov_b32 v75, 0
    v_smfmac_f32_16x16x64_bf16 v[68:71], v[28:31], a[0:7], v17
    s_nop 0
    v_smfmac_f32_16x16x64_bf16 v[72:75], v[28:31], a[80:87], v17
    v_smfmac_f32_16x16x64_bf16 v[68:71], v[32:35], a[8:15], v17
    v_smfmac_f32_16x16x64_bf16 v[72:75], v[32:35], a[88:95], v17
    v_smfmac_f32_16x16x64_bf16 v[68:71], v[36:39], a[16:23], v17
    v_smfmac_f32_16x16x64_bf16 v[68:71], v[40:43], a[24:31], v17
    v_smfmac_f32_16x16x64_bf16 v[68:71], v[44:47], a[32:39], v17
    v_smfmac_f32_16x16x64_bf16 v[68:71], v[48:51], a[40:47], v17
    v_smfmac_f32_16x16x64_bf16 v[68:71], v[52:55], a[48:55], v17
    v_smfmac_f32_16x16x64_bf16 v[68:71], v[56:59], a[56:63], v17
    v_smfmac_f32_16x16x64_bf16 v[68:71], v[60:63], a[64:71], v17
    v_smfmac_f32_16x16x64_bf16 v[68:71], v[64:67], a[72:79], v17
    s_nop 3
    s_branch L_redo_4
L_sd_12c:
    v_mov_b32 v5, 460288
L_pf_16:
    buffer_load_dword v6, v5, s[4:7], s38 offen sc1
    v_mov_b32 v3, 200
L_p0_17:
    buffer_load_dword v4, v3, s[8:11], 0 offen sc1
    s_sub_u32 s36, s36, 1
    s_cbranch_scc1 L_exit
    s_waitcnt vmcnt(0)
    v_readfirstlane_b32 s90, v4
    s_nop 0
    s_cmp_eq_u32 s90, 0
    s_cbranch_scc1 L_p0_17
    s_and_b32 s90, s90, 2
    s_lshl_b32 s90, s90, 12
    v_readfirstlane_b32 s91, v6
    s_nop 0
    s_cmp_eq_u32 s91, 0
    s_cbranch_scc1 L_pf_16
    s_and_b32 s91, s91, 2
    s_lshl_b32 s91, s91, 12
    v_add_u32 v142, s91, v142
    v_add_u32 v143, s91, v143
    v_and_b32 v3, s90, v152
    v_xor_b32 v146, v3, v146
    s_branch L_sd_12
L_pp_14:
    buffer_load_dwordx4 v[176:179], v142, s[4:7], s53 offen sc1
    buffer_load_dwordx4 v[180:183], v143, s[4:7], s53 offen sc1
    s_sub_u32 s36, s36, 1
    s_cbranch_scc1 L_exit
    v_max_u32 v151, v168, v169
    v_max3_u32 v151, v151, v170, v171
    v_max3_u32 v151, v151, v172, v173
    v_max3_u32 v151, v151, v174, v175
    v_cmp_eq_u32 vcc, -1, v151
    s_cbranch_vccz L_pc_15
    s_waitcnt vmcnt(1)
    v_mfma_f32_16x16x32_bf16 v[184:187], v[198:201], v[176:179], 0
    v_mfma_f32_16x16x32_bf16 v[188:191], v[196:199], v[176:179], 0
    s_waitcnt vmcnt(0)
    v_mfma_f32_16x16x32_bf16 v[184:187], v[198:201], v[180:183], v[184:187]
    v_mfma_f32_16x16x32_bf16 v[188:191], v[196:199], v[180:183], v[188:191]
    s_nop 4
    v_cmp_u_f32 vcc, v184, v184
    v_cvt_pk_bf16_f32 v192, v184, v185
    v_cvt_pk_bf16_f32 v193, v186, v187
    v_cvt_pk_bf16_f32 v194, v188, v189
    v_cvt_pk_bf16_f32 v195, v190, v191
    s_cbranch_vccnz L_pp_14_1
    s_branch L_pc_15
L_pp_14_1:
    buffer_load_dwordx4 v[168:171], v142, s[4:7], s53 offen sc1
    buffer_load_dwordx4 v[172:175], v143, s[4:7], s53 offen sc1
    s_sub_u32 s36, s36, 1
    s_cbranch_scc1 L_exit
    v_max_u32 v151, v176, v177
    v_max3_u32 v151, v151, v178, v179
    v_max3_u32 v151, v151, v180, v181
    v_max3_u32 v151, v151, v182, v183
    v_cmp_eq_u32 vcc, -1, v151
    s_cbranch_vccz L_pc_15
    s_waitcnt vmcnt(1)
    v_mfma_f32_16x16x32_bf16 v[184:187], v[198:201], v[168:171], 0
    v_mfma_f32_16x16x32_bf16 v[188:191], v[196:199], v[168:171], 0
    s_waitcnt vmcnt(0)
    v_mfma_f32_16x16x32_bf16 v[184:187], v[198:201], v[172:175], v[184:187]
    v_mfma_f32_16x16x32_bf16 v[188:191], v[196:199], v[172:175], v[188:191]
    s_nop 4
    v_cmp_u_f32 vcc, v184, v184
    v_cvt_pk_bf16_f32 v192, v184, v185
    v_cvt_pk_bf16_f32 v193, v186, v187
    v_cvt_pk_bf16_f32 v194, v188, v189
    v_cvt_pk_bf16_f32 v195, v190, v191
    s_cbranch_vccnz L_pp_14
    s_branch L_pc_15
L_v_f:
    s_mov_b32 s12, s78
    s_and_b32 s13, s79, 0xffff
    s_mov_b32 s14, 7864320
    s_mov_b32 s15, 0x20000
    s_sub_u32 s40, s35, 12
    s_lshl_b32 s40, s40, 1
    s_mov_b32 s24, s70
    s_and_b32 s25, s71, 0xffff
    s_mov_b32 s26, 2621440
    s_mov_b32 s27, 0x20000
    v_and_b32 v1, 15, v0
    v_lshrrev_b32 v2, 4, v0
    v_lshrrev_b32 v3, 3, v0
    v_and_b32 v4, 7, v0
    s_lshl_b32 s90, s32, 3
    v_add_u32 v5, s90, v3
    s_and_b32 s91, s32, 1
    s_lshl_b32 s91, s91, 2
    v_and_b32 v6, 2, v3
    v_or_b32 v6, s91, v6
    v_xor_b32 v6, v6, v4
    v_lshlrev_b32 v6, 4, v6
    v_mul_u32_u24 v7, 12288, v5
    s_mul_i32 s92, s34, 1536
    s_lshl_b32 s93, s40, 7
    s_add_u32 s92, s92, s93
    v_add3_u32 v124, v6, v7, s92
    v_lshrrev_b32 v6, 1, v3
    v_or_b32 v6, s91, v6
    v_xor_b32 v6, v6, v4
    v_lshlrev_b32 v6, 4, v6
    v_mul_u32_u24 v7, 1280, v5
    v_add_u32 v10, v6, v7
    s_lshl_b32 s90, s32, 10
    s_add_u32 m0, s90, 81920
    s_mov_b32 s91, 128
    buffer_load_dwordx4 v124, s[12:15], s91 offen nt lds
    s_add_u32 m0, m0, 4096
    s_add_u32 s91, s91, 393216
    buffer_load_dwordx4 v124, s[12:15], s91 offen nt lds
    s_add_u32 m0, m0, 4096
    s_add_u32 s91, s91, 393216
    buffer_load_dwordx4 v124, s[12:15], s91 offen nt lds
    s_add_u32 m0, m0, 4096
    s_add_u32 s91, s91, 393216
    buffer_load_dwordx4 v124, s[12:15], s91 offen nt lds
    s_add_u32 m0, m0, 4096
    s_add_u32 s91, s91, 393216
    buffer_load_dwordx4 v124, s[12:15], s91 offen nt lds
    s_add_u32 m0, m0, 4096
    s_add_u32 s91, s91, 393216
    buffer_load_dwordx4 v124, s[12:15], s91 offen nt lds
    s_add_u32 m0, m0, 4096
    s_add_u32 s91, s91, 393216
    buffer_load_dwordx4 v124, s[12:15], s91 offen nt lds
    s_add_u32 m0, m0, 4096
    s_add_u32 s91, s91, 393216
    buffer_load_dwordx4 v124, s[12:15], s91 offen nt lds
    s_add_u32 m0, m0, 4096
    s_add_u32 s91, s91, 393216
    buffer_load_dwordx4 v124, s[12:15], s91 offen nt lds
    s_add_u32 m0, m0, 4096
    s_add_u32 s91, s91, 393216
    buffer_load_dwordx4 v124, s[12:15], s91 offen nt lds
    s_mul_i32 s60, s40, 86
    s_lshr_b32 s60, s60, 8
    s_mul_i32 s61, s60, 3
    s_sub_u32 s61, s40, s61
    s_add_u32 s90, s40, 1
    s_mul_i32 s62, s90, 86
    s_lshr_b32 s62, s62, 8
    s_mul_i32 s63, s62, 3
    s_sub_u32 s63, s90, s63
    v_lshrrev_b32 v3, 1, v2
    v_and_b32 v5, 1, v2
    s_lshl_b32 s90, s32, 9
    v_lshlrev_b32 v6, 4, v1
    v_lshl_add_u32 v6, v3, 8, v6
    v_add_u32 v6, s90, v6
    s_mul_i32 s90, s60, 12288
    s_lshl_b32 s91, s61, 11
    s_add_u32 s90, s90, s91
    v_mul_u32_u24 v7, 6144, v5
    v_add3_u32 v19, v6, v7, s90
    v_mov_b32 v22, -1
    s_mul_i32 s56, s62, 12288
    s_lshl_b32 s91, s63, 11
    s_add_u32 s56, s56, s91
    s_sub_u32 s56, s56, s90
    s_lshl_b32 s90, s40, 10
    s_lshl_b32 s91, s32, 8
    s_add_u32 s91, s91, s90
    s_add_u32 s91, s91, 25600
    v_lshl_add_u32 v135, v0, 2, s91
    v_and_b32 v6, 60, v0
    v_bfe_u32 v7, v0, 1, 1
    v_or_b32 v6, v6, v7
    v_and_b32 v7, 1, v0
    v_lshl_or_b32 v6, v7, 1, v6
    s_and_b32 s90, s32, 1
    s_lshl_b32 s90, s90, 3
    v_xor_b32 v6, s90, v6
    v_lshl_add_u32 v134, v6, 2, s91
    s_lshl_b32 s90, s60, 5
    s_lshl_b32 s91, s62, 5
    v_mov_b32 v3, s90
    v_mov_b32 v4, s91
    v_mov_b32 v6, s61
    v_mov_b32 v7, s63
    v_cmp_eq_u32 vcc, 0, v0
    s_nop 1
    v_cndmask_b32 v3, v4, v3, vcc
    v_cndmask_b32 v6, v7, v6, vcc
    v_add_u32 v4, v3, v6
    s_cmp_eq_u32 s32, 3
    s_cselect_b32 s91, 0, 2146435072
    s_add_u32 s91, s91, 462348
    v_lshl_add_u32 v21, v4, 2, s91
    v_lshl_add_u32 v4, v6, 2, v3
    s_lshl_b32 s91, s32, 2
    s_add_u32 s91, s91, 458752
    v_lshl_add_u32 v136, v4, 2, s91
    v_cmp_gt_u32 vcc, 2, v0
    v_mov_b32 v9, 2146435072
    s_nop 0
    v_cndmask_b32 v21, v9, v21, vcc
    v_cndmask_b32 v136, v9, v136, vcc
    s_lshl_b32 s90, s40, 1
    s_add_u32 s90, s90, s32
    s_sub_u32 s90, s90, 4
    s_lshl_b32 s90, s90, 11
    s_cmp_eq_u32 s40, 0
    s_cselect_b32 s90, 2146435072, s90
    v_lshl_add_u32 v137, v0, 4, s90
    v_mov_b32 v138, 460800
    v_lshrrev_b32 v3, 2, v1
    v_and_b32 v4, 3, v1
    v_and_b32 v5, 1, v2
    v_lshl_add_u32 v6, v2, 3, v3
    v_lshlrev_b32 v6, 7, v6
    v_and_b32 v7, 2, v3
    v_lshl_or_b32 v7, v5, 2, v7
    v_lshrrev_b32 v8, 1, v4
    s_lshl_b32 s90, s32, 1
    v_or_b32 v8, s90, v8
    v_xor_b32 v7, v7, v8
    v_lshl_add_u32 v6, v7, 4, v6
    v_and_b32 v7, 1, v4
    v_lshl_add_u32 v6, v7, 3, v6
    v_add_u32 v125, 81920, v6
    v_add_u32 v126, 40960, v6
    v_add_u32 v127, 122880, v6
    s_lshl_b32 s90, s32, 9
    s_add_u32 s90, s90, 133120
    v_and_b32 v7, 2, v1
    v_cmp_ne_u32 vcc, 0, v7
    v_mov_b32 v6, 0x4444
    v_mov_b32 v8, 0xeeee
    v_cndmask_b32 v17, v6, v8, vcc
    v_lshlrev_b32 v6, 4, v0
    v_add_u32 v16, 122880, v6
    s_mul_i32 s90, s32, 2560
    v_lshl_add_u32 v13, v0, 4, s90
    v_lshl_add_u32 v14, v0, 2, s90
    s_add_u32 s48, s90, 122880
    v_mul_u32_u24 v6, 40, v0
    v_add_u32 v15, s48, v6
    v_mul_u32_u24 v6, 164, v0
    v_min_u32 v6, 10236, v6
    v_add_u32 v25, 122880, v6
    v_lshrrev_b32 v6, 3, v1
    v_lshlrev_b32 v6, 10, v6
    v_and_b32 v7, 7, v1
    v_lshl_add_u32 v6, v7, 7, v6
    v_lshrrev_b32 v7, 1, v1
    v_xor_b32 v7, v7, v2
    v_lshl_add_u32 v11, v7, 4, v6
    v_xor_b32 v12, 64, v11
    v_and_b32 v3, 1, v0
    v_lshlrev_b32 v3, 12, v3
    v_bfe_u32 v5, v0, 2, 1
    v_lshl_add_u32 v3, v5, 13, v3
    v_bfe_u32 v4, v0, 1, 1
    v_lshl_add_u32 v3, v4, 14, v3
    s_lshl_b32 s91, s34, 9
    s_add_u32 s91, s91, 1933312
    s_xor_b32 s55, s32, 3
    s_or_b32 s55, s55, s40
    s_cselect_b32 s91, 2146435072, s91
    v_add_u32 v140, s91, v3
    v_cmp_gt_u32 vcc, 8, v0
    v_mov_b32 v9, 2146435072
    s_nop 0
    v_cndmask_b32 v140, v9, v140, vcc
    v_cmp_ne_u32 vcc, s34, v0
    v_mov_b32 v9, 2146435072
    s_nop 0
    v_cndmask_b32 v140, v9, v140, vcc
    s_lshr_b32 s91, s34, 2
    v_cmp_eq_u32 vcc, s91, v5
    s_nop 1
    v_cndmask_b32 v141, v9, v140, vcc
    v_cndmask_b32 v140, v140, v9, vcc
    v_and_b32 v3, 7, v0
    v_min_u32 v3, 5, v3
    v_bfe_u32 v4, v0, 3, 2
    v_lshlrev_b32 v4, 7, v4
    v_lshl_add_u32 v3, v3, 2, v4
    v_add_u32 v142, 462368, v3
    s_lshl_b32 s93, s40, 1
    s_add_u32 s93, s93, s32
    s_lshl_b32 s93, s93, 1
    s_sub_u32 s93, s93, 8
    s_nop 0
    s_lshr_b32 s90, s93, 2
    s_lshl_b32 s90, s90, 15
    s_and_b32 s92, s93, 3
    s_lshl_b32 s92, s92, 10
    s_add_u32 s90, s90, s92
    v_mov_b32 v5, s34
    v_and_b32 v6, 7, v1
    v_lshlrev_b32 v6, 4, v6
    v_lshl_add_u32 v6, v5, 7, v6
    v_lshrrev_b32 v7, 3, v1
    v_lshl_add_u32 v6, v7, 12, v6
    v_lshrrev_b32 v5, 1, v2
    v_lshl_add_u32 v6, v5, 13, v6
    v_and_b32 v5, 1, v2
    v_lshl_add_u32 v6, v5, 14, v6
    v_add_u32 v143, s90, v6
    s_and_b32 s91, s34, 1
    s_lshl_b32 s91, s91, 12
    s_add_u32 s90, s90, s91
    s_lshr_b32 s91, s34, 2
    s_lshl_b32 s91, s91, 13
    s_add_u32 s90, s90, s91
    s_and_b32 s91, s34, 2
    s_lshl_b32 s91, s91, 13
    s_add_u32 s90, s90, s91
    v_lshl_add_u32 v144, v0, 4, s90
    s_lshl_b32 s91, s93, 10
    s_add_u32 s91, s91, 884736
    v_lshl_add_u32 v146, v0, 4, s91
    s_lshr_b32 s91, s34, 1
    s_mul_i32 s91, s91, 10240
    s_lshl_b32 s92, s93, 5
    s_add_u32 s91, s91, s92
    s_and_b32 s92, s34, 1
    s_mul_i32 s92, s92, 40960
    s_add_u32 s91, s91, s92
    s_add_u32 s91, s91, 1280
    v_mul_u32_u24 v6, 2560, v2
    v_lshl_add_u32 v6, v1, 1, v6
    v_add_u32 v145, s91, v6
    v_cmp_gt_u32 s[58:59], 8, v1
    v_and_b32 v5, 1, v1
    v_lshrrev_b32 v6, 3, v1
    v_lshl_add_u32 v5, v5, 1, v6
    v_bfe_u32 v6, v1, 2, 1
    v_cmp_ne_u32 vcc, 0, v6
    v_mov_b32 v6, 0x3f80
    v_mov_b32 v7, 0x3f800000
    v_cndmask_b32 v6, v6, v7, vcc
    v_cmp_eq_u32 vcc, 0, v5
    s_nop 1
    v_cndmask_b32 v7, 0, v6, vcc
    v_accvgpr_write_b32 a160, v7
    v_cmp_eq_u32 vcc, 1, v5
    s_nop 1
    v_cndmask_b32 v7, 0, v6, vcc
    v_accvgpr_write_b32 a161, v7
    v_cmp_eq_u32 vcc, 2, v5
    s_nop 1
    v_cndmask_b32 v7, 0, v6, vcc
    v_accvgpr_write_b32 a162, v7
    v_cmp_eq_u32 vcc, 3, v5
    s_nop 1
    v_cndmask_b32 v7, 0, v6, vcc
    v_accvgpr_write_b32 a163, v7
    s_cmp_lg_u32 s40, 0
    s_cselect_b64 vcc, -1, 0
    v_cndmask_b32 v143, v9, v143, vcc
    v_cndmask_b32 v144, v9, v144, vcc
    v_cndmask_b32 v145, v9, v145, vcc
    v_cndmask_b32 v146, v9, v146, vcc
    s_lshl_b32 s90, s32, 10
    s_add_u32 m0, s90, 40960
    s_mov_b32 s91, 0
    buffer_load_dwordx4 v124, s[12:15], s91 offen nt lds
    s_add_u32 m0, m0, 4096
    s_add_u32 s91, s91, 393216
    buffer_load_dwordx4 v124, s[12:15], s91 offen nt lds
    s_add_u32 m0, m0, 4096
    s_add_u32 s91, s91, 393216
    buffer_load_dwordx4 v124, s[12:15], s91 offen nt lds
    s_add_u32 m0, m0, 4096
    s_add_u32 s91, s91, 393216
    buffer_load_dwordx4 v124, s[12:15], s91 offen nt lds
    s_add_u32 m0, m0, 4096
    s_add_u32 s91, s91, 393216
    buffer_load_dwordx4 v124, s[12:15], s91 offen nt lds
    s_add_u32 m0, m0, 4096
    s_add_u32 s91, s91, 393216
    buffer_load_dwordx4 v124, s[12:15], s91 offen nt lds
    s_add_u32 m0, m0, 4096
    s_add_u32 s91, s91, 393216
    buffer_load_dwordx4 v124, s[12:15], s91 offen nt lds
    s_add_u32 m0, m0, 4096
    s_add_u32 s91, s91, 393216
    buffer_load_dwordx4 v124, s[12:15], s91 offen nt lds
    s_add_u32 m0, m0, 4096
    s_add_u32 s91, s91, 393216
    buffer_load_dwordx4 v124, s[12:15], s91 offen nt lds
    s_add_u32 m0, m0, 4096
    s_add_u32 s91, s91, 393216
    buffer_load_dwordx4 v124, s[12:15], s91 offen nt lds
    s_lshl_b32 s90, s32, 10
    s_add_u32 m0, s90, 122880
    s_mov_b32 s91, 3932288
    buffer_load_dwordx4 v124, s[12:15], s91 offen nt lds
    s_add_u32 m0, m0, 4096
    s_add_u32 s91, s91, 393216
    buffer_load_dwordx4 v124, s[12:15], s91 offen nt lds
    s_add_u32 m0, m0, 4096
    s_add_u32 s91, s91, 393216
    buffer_load_dwordx4 v124, s[12:15], s91 offen nt lds
    s_add_u32 m0, m0, 4096
    s_add_u32 s91, s91, 393216
    buffer_load_dwordx4 v124, s[12:15], s91 offen nt lds
    s_add_u32 m0, m0, 4096
    s_add_u32 s91, s91, 393216
    buffer_load_dwordx4 v124, s[12:15], s91 offen nt lds
    s_add_u32 m0, m0, 4096
    s_add_u32 s91, s91, 393216
    buffer_load_dwordx4 v124, s[12:15], s91 offen nt lds
    s_add_u32 m0, m0, 4096
    s_add_u32 s91, s91, 393216
    buffer_load_dwordx4 v124, s[12:15], s91 offen nt lds
    s_add_u32 m0, m0, 4096
    s_add_u32 s91, s91, 393216
    buffer_load_dwordx4 v124, s[12:15], s91 offen nt lds
    s_add_u32 m0, m0, 4096
    s_add_u32 s91, s91, 393216
    buffer_load_dwordx4 v124, s[12:15], s91 offen nt lds
    s_add_u32 m0, m0, 4096
    s_add_u32 s91, s91, 393216
    buffer_load_dwordx4 v124, s[12:15], s91 offen nt lds
    s_mov_b32 s46, 0
    s_lshl_b32 s90, s32, 10
    s_add_u32 m0, s90, 0
    s_nop 0
    buffer_load_dwordx4 v10, s[24:27], s46 offen offset:0 lds
    s_add_u32 m0, m0, 3968
    s_nop 0
    buffer_load_dwordx4 v10, s[24:27], s46 offen offset:128 lds
    s_add_u32 m0, m0, 3968
    s_nop 0
    buffer_load_dwordx4 v10, s[24:27], s46 offen offset:256 lds
    s_add_u32 m0, m0, 3968
    s_nop 0
    buffer_load_dwordx4 v10, s[24:27], s46 offen offset:384 lds
    s_add_u32 m0, m0, 3968
    s_nop 0
    buffer_load_dwordx4 v10, s[24:27], s46 offen offset:512 lds
    s_add_u32 m0, m0, 3968
    s_nop 0
    buffer_load_dwordx4 v10, s[24:27], s46 offen offset:640 lds
    s_add_u32 m0, m0, 3968
    s_nop 0
    buffer_load_dwordx4 v10, s[24:27], s46 offen offset:768 lds
    s_add_u32 m0, m0, 3968
    s_nop 0
    buffer_load_dwordx4 v10, s[24:27], s46 offen offset:896 lds
    s_add_u32 m0, m0, 3968
    s_nop 0
    buffer_load_dwordx4 v10, s[24:27], s46 offen offset:1024 lds
    s_add_u32 m0, m0, 3968
    s_nop 0
    buffer_load_dwordx4 v10, s[24:27], s46 offen offset:1152 lds
    s_waitcnt vmcnt(30)
    s_barrier
    ds_read_b64_tr_b16 a[80:81], v125 offset:0
    ds_read_b64_tr_b16 a[82:83], v125 offset:512
    ds_read_b64_tr_b16 a[84:85], v125 offset:4096
    ds_read_b64_tr_b16 a[86:87], v125 offset:4608
    ds_read_b64_tr_b16 a[88:89], v125 offset:8192
    ds_read_b64_tr_b16 a[90:91], v125 offset:8704
    ds_read_b64_tr_b16 a[92:93], v125 offset:12288
    ds_read_b64_tr_b16 a[94:95], v125 offset:12800
    ds_read_b64_tr_b16 a[96:97], v125 offset:16384
    ds_read_b64_tr_b16 a[98:99], v125 offset:16896
    ds_read_b64_tr_b16 a[100:101], v125 offset:20480
    ds_read_b64_tr_b16 a[102:103], v125 offset:20992
    ds_read_b64_tr_b16 a[104:105], v125 offset:24576
    ds_read_b64_tr_b16 a[106:107], v125 offset:25088
    ds_read_b64_tr_b16 a[108:109], v125 offset:28672
    ds_read_b64_tr_b16 a[110:111], v125 offset:29184
    ds_read_b64_tr_b16 a[112:113], v125 offset:32768
    ds_read_b64_tr_b16 a[114:115], v125 offset:33280
    ds_read_b64_tr_b16 a[116:117], v125 offset:36864
    ds_read_b64_tr_b16 a[118:119], v125 offset:37376
    s_waitcnt lgkmcnt(0)
    s_barrier
    s_lshl_b32 s90, s32, 10
    s_add_u32 m0, s90, 81920
    s_mov_b32 s91, 3932160
    buffer_load_dwordx4 v124, s[12:15], s91 offen nt lds
    s_add_u32 m0, m0, 4096
    s_add_u32 s91, s91, 393216
    buffer_load_dwordx4 v124, s[12:15], s91 offen nt lds
    s_add_u32 m0, m0, 4096
    s_add_u32 s91, s91, 393216
    buffer_load_dwordx4 v124, s[12:15], s91 offen nt lds
    s_add_u32 m0, m0, 4096
    s_add_u32 s91, s91, 393216
    buffer_load_dwordx4 v124, s[12:15], s91 offen nt lds
    s_add_u32 m0, m0, 4096
    s_add_u32 s91, s91, 393216
    buffer_load_dwordx4 v124, s[12:15], s91 offen nt lds
    s_add_u32 m0, m0, 4096
    s_add_u32 s91, s91, 393216
    buffer_load_dwordx4 v124, s[12:15], s91 offen nt lds
    s_add_u32 m0, m0, 4096
    s_add_u32 s91, s91, 393216
    buffer_load_dwordx4 v124, s[12:15], s91 offen nt lds
    s_add_u32 m0, m0, 4096
    s_add_u32 s91, s91, 393216
    buffer_load_dwordx4 v124, s[12:15], s91 offen nt lds
    s_add_u32 m0, m0, 4096
    s_add_u32 s91, s91, 393216
    buffer_load_dwordx4 v124, s[12:15], s91 offen nt lds
    s_add_u32 m0, m0, 4096
    s_add_u32 s91, s91, 393216
    buffer_load_dwordx4 v124, s[12:15], s91 offen nt lds
    s_waitcnt vmcnt(30)
    s_barrier
    ds_read_b64_tr_b16 a[0:1], v126 offset:0
    ds_read_b64_tr_b16 a[2:3], v126 offset:512
    ds_read_b64_tr_b16 a[4:5], v126 offset:4096
    ds_read_b64_tr_b16 a[6:7], v126 offset:4608
    ds_read_b64_tr_b16 a[8:9], v126 offset:8192
    ds_read_b64_tr_b16 a[10:11], v126 offset:8704
    ds_read_b64_tr_b16 a[12:13], v126 offset:12288
    ds_read_b64_tr_b16 a[14:15], v126 offset:12800
    ds_read_b64_tr_b16 a[16:17], v126 offset:16384
    ds_read_b64_tr_b16 a[18:19], v126 offset:16896
    ds_read_b64_tr_b16 a[20:21], v126 offset:20480
    ds_read_b64_tr_b16 a[22:23], v126 offset:20992
    ds_read_b64_tr_b16 a[24:25], v126 offset:24576
    ds_read_b64_tr_b16 a[26:27], v126 offset:25088
    ds_read_b64_tr_b16 a[28:29], v126 offset:28672
    ds_read_b64_tr_b16 a[30:31], v126 offset:29184
    ds_read_b64_tr_b16 a[32:33], v126 offset:32768
    ds_read_b64_tr_b16 a[34:35], v126 offset:33280
    ds_read_b64_tr_b16 a[36:37], v126 offset:36864
    ds_read_b64_tr_b16 a[38:39], v126 offset:37376
    s_waitcnt lgkmcnt(0)
    s_barrier
    s_mov_b32 s46, 40960
    s_lshl_b32 s90, s32, 10
    s_add_u32 m0, s90, 40960
    s_nop 0
    buffer_load_dwordx4 v10, s[24:27], s46 offen offset:0 lds
    s_add_u32 m0, m0, 3968
    s_nop 0
    buffer_load_dwordx4 v10, s[24:27], s46 offen offset:128 lds
    s_add_u32 m0, m0, 3968
    s_nop 0
    buffer_load_dwordx4 v10, s[24:27], s46 offen offset:256 lds
    s_add_u32 m0, m0, 3968
    s_nop 0
    buffer_load_dwordx4 v10, s[24:27], s46 offen offset:384 lds
    s_add_u32 m0, m0, 3968
    s_nop 0
    buffer_load_dwordx4 v10, s[24:27], s46 offen offset:512 lds
    s_add_u32 m0, m0, 3968
    s_nop 0
    buffer_load_dwordx4 v10, s[24:27], s46 offen offset:640 lds
    s_add_u32 m0, m0, 3968
    s_nop 0
    buffer_load_dwordx4 v10, s[24:27], s46 offen offset:768 lds
    s_add_u32 m0, m0, 3968
    s_nop 0
    buffer_load_dwordx4 v10, s[24:27], s46 offen offset:896 lds
    s_add_u32 m0, m0, 3968
    s_nop 0
    buffer_load_dwordx4 v10, s[24:27], s46 offen offset:1024 lds
    s_add_u32 m0, m0, 3968
    s_nop 0
    buffer_load_dwordx4 v10, s[24:27], s46 offen offset:1152 lds
    s_waitcnt vmcnt(30)
    s_barrier
    ds_read_b64_tr_b16 a[120:121], v127 offset:0
    ds_read_b64_tr_b16 a[122:123], v127 offset:512
    ds_read_b64_tr_b16 a[124:125], v127 offset:4096
    ds_read_b64_tr_b16 a[126:127], v127 offset:4608
    ds_read_b64_tr_b16 a[128:129], v127 offset:8192
    ds_read_b64_tr_b16 a[130:131], v127 offset:8704
    ds_read_b64_tr_b16 a[132:133], v127 offset:12288
    ds_read_b64_tr_b16 a[134:135], v127 offset:12800
    ds_read_b64_tr_b16 a[136:137], v127 offset:16384
    ds_read_b64_tr_b16 a[138:139], v127 offset:16896
    ds_read_b64_tr_b16 a[140:141], v127 offset:20480
    ds_read_b64_tr_b16 a[142:143], v127 offset:20992
    ds_read_b64_tr_b16 a[144:145], v127 offset:24576
    ds_read_b64_tr_b16 a[146:147], v127 offset:25088
    ds_read_b64_tr_b16 a[148:149], v127 offset:28672
    ds_read_b64_tr_b16 a[150:151], v127 offset:29184
    ds_read_b64_tr_b16 a[152:153], v127 offset:32768
    ds_read_b64_tr_b16 a[154:155], v127 offset:33280
    ds_read_b64_tr_b16 a[156:157], v127 offset:36864
    ds_read_b64_tr_b16 a[158:159], v127 offset:37376
    s_waitcnt lgkmcnt(0)
    s_waitcnt vmcnt(10)
    s_barrier
    ds_read_b64_tr_b16 a[40:41], v125 offset:0
    ds_read_b64_tr_b16 a[42:43], v125 offset:512
    ds_read_b64_tr_b16 a[44:45], v125 offset:4096
    ds_read_b64_tr_b16 a[46:47], v125 offset:4608
    ds_read_b64_tr_b16 a[48:49], v125 offset:8192
    ds_read_b64_tr_b16 a[50:51], v125 offset:8704
    ds_read_b64_tr_b16 a[52:53], v125 offset:12288
    ds_read_b64_tr_b16 a[54:55], v125 offset:12800
    ds_read_b64_tr_b16 a[56:57], v125 offset:16384
    ds_read_b64_tr_b16 a[58:59], v125 offset:16896
    ds_read_b64_tr_b16 a[60:61], v125 offset:20480
    ds_read_b64_tr_b16 a[62:63], v125 offset:20992
    ds_read_b64_tr_b16 a[64:65], v125 offset:24576
    ds_read_b64_tr_b16 a[66:67], v125 offset:25088
    ds_read_b64_tr_b16 a[68:69], v125 offset:28672
    ds_read_b64_tr_b16 a[70:71], v125 offset:29184
    ds_read_b64_tr_b16 a[72:73], v125 offset:32768
    ds_read_b64_tr_b16 a[74:75], v125 offset:33280
    ds_read_b64_tr_b16 a[76:77], v125 offset:36864
    ds_read_b64_tr_b16 a[78:79], v125 offset:37376
    s_waitcnt lgkmcnt(0)
    s_mov_b32 s49, 40960
    s_mov_b32 s47, 40960
    s_mov_b32 s37, -1
    s_add_u32 s44, s38, 65536
    s_add_u32 s45, s44, s56
    s_mov_b32 s46, 40960
    v_mov_b32 v1, 192
    buffer_load_dword v2, v1, s[8:11], 0 offen sc1
    ds_read_b128 v[84:87], v11 offset:0
    ds_read_b128 v[88:91], v11 offset:2048
    ds_read_b128 v[92:95], v12 offset:0
    ds_read_b128 v[96:99], v12 offset:2048
    s_waitcnt lgkmcnt(2)
    v_mfma_f32_16x16x32_bf16 v[108:111], a[0:3], v[84:87], 0
    ds_read_b128 v[100:103], v11 offset:4096
    v_mfma_f32_16x16x32_bf16 v[112:115], a[0:3], v[88:91], 0
    ds_read_b128 v[104:107], v11 offset:6144
    v_mfma_f32_16x16x32_bf16 v[116:119], a[80:83], v[84:87], 0
    v_mfma_f32_16x16x32_bf16 v[120:123], a[80:83], v[88:91], 0
    s_waitcnt lgkmcnt(2)
    v_mfma_f32_16x16x32_bf16 v[108:111], a[4:7], v[92:95], v[108:111]
    ds_read_b128 v[84:87], v12 offset:4096
    v_mfma_f32_16x16x32_bf16 v[112:115], a[4:7], v[96:99], v[112:115]
    ds_read_b128 v[88:91], v12 offset:6144
    v_mfma_f32_16x16x32_bf16 v[116:119], a[84:87], v[92:95], v[116:119]
    v_mfma_f32_16x16x32_bf16 v[120:123], a[84:87], v[96:99], v[120:123]
    s_waitcnt lgkmcnt(2)
    v_mfma_f32_16x16x32_bf16 v[108:111], a[8:11], v[100:103], v[108:111]
    ds_read_b128 v[92:95], v11 offset:8192
    v_mfma_f32_16x16x32_bf16 v[112:115], a[8:11], v[104:107], v[112:115]
    ds_read_b128 v[96:99], v11 offset:10240
    v_mfma_f32_16x16x32_bf16 v[116:119], a[88:91], v[100:103], v[116:119]
    v_mfma_f32_16x16x32_bf16 v[120:123], a[88:91], v[104:107], v[120:123]
    s_waitcnt lgkmcnt(2)
    v_mfma_f32_16x16x32_bf16 v[108:111], a[12:15], v[84:87], v[108:111]
    ds_read_b128 v[100:103], v12 offset:8192
    v_mfma_f32_16x16x32_bf16 v[112:115], a[12:15], v[88:91], v[112:115]
    ds_read_b128 v[104:107], v12 offset:10240
    v_mfma_f32_16x16x32_bf16 v[116:119], a[92:95], v[84:87], v[116:119]
    v_mfma_f32_16x16x32_bf16 v[120:123], a[92:95], v[88:91], v[120:123]
    s_waitcnt lgkmcnt(2)
    v_mfma_f32_16x16x32_bf16 v[108:111], a[16:19], v[92:95], v[108:111]
    ds_read_b128 v[84:87], v11 offset:12288
    v_mfma_f32_16x16x32_bf16 v[112:115], a[16:19], v[96:99], v[112:115]
    ds_read_b128 v[88:91], v11 offset:14336
    v_mfma_f32_16x16x32_bf16 v[116:119], a[96:99], v[92:95], v[116:119]
    v_mfma_f32_16x16x32_bf16 v[120:123], a[96:99], v[96:99], v[120:123]
    s_waitcnt lgkmcnt(2)
    v_mfma_f32_16x16x32_bf16 v[108:111], a[20:23], v[100:103], v[108:111]
    ds_read_b128 v[92:95], v12 offset:12288
    v_mfma_f32_16x16x32_bf16 v[112:115], a[20:23], v[104:107], v[112:115]
    ds_read_b128 v[96:99], v12 offset:14336
    v_mfma_f32_16x16x32_bf16 v[116:119], a[100:103], v[100:103], v[116:119]
    v_mfma_f32_16x16x32_bf16 v[120:123], a[100:103], v[104:107], v[120:123]
    s_waitcnt lgkmcnt(2)
    v_mfma_f32_16x16x32_bf16 v[108:111], a[24:27], v[84:87], v[108:111]
    ds_read_b128 v[100:103], v11 offset:16384
    v_mfma_f32_16x16x32_bf16 v[112:115], a[24:27], v[88:91], v[112:115]
    ds_read_b128 v[104:107], v11 offset:18432
    v_mfma_f32_16x16x32_bf16 v[116:119], a[104:107], v[84:87], v[116:119]
    v_mfma_f32_16x16x32_bf16 v[120:123], a[104:107], v[88:91], v[120:123]
    s_waitcnt lgkmcnt(2)
    v_mfma_f32_16x16x32_bf16 v[108:111], a[28:31], v[92:95], v[108:111]
    ds_read_b128 v[84:87], v12 offset:16384
    v_mfma_f32_16x16x32_bf16 v[112:115], a[28:31], v[96:99], v[112:115]
    ds_read_b128 v[88:91], v12 offset:18432
    v_mfma_f32_16x16x32_bf16 v[116:119], a[108:111], v[92:95], v[116:119]
    v_mfma_f32_16x16x32_bf16 v[120:123], a[108:111], v[96:99], v[120:123]
    s_waitcnt lgkmcnt(2)
    v_mfma_f32_16x16x32_bf16 v[108:111], a[32:35], v[100:103], v[108:111]
    ds_read_b128 v[92:95], v11 offset:20480
    v_mfma_f32_16x16x32_bf16 v[112:115], a[32:35], v[104:107], v[112:115]
    ds_read_b128 v[96:99], v11 offset:22528
    v_mfma_f32_16x16x32_bf16 v[116:119], a[112:115], v[100:103], v[116:119]
    v_mfma_f32_16x16x32_bf16 v[120:123], a[112:115], v[104:107], v[120:123]
    s_waitcnt lgkmcnt(2)
    v_mfma_f32_16x16x32_bf16 v[108:111], a[36:39], v[84:87], v[108:111]
    ds_read_b128 v[100:103], v12 offset:20480
    v_mfma_f32_16x16x32_bf16 v[112:115], a[36:39], v[88:91], v[112:115]
    ds_read_b128 v[104:107], v12 offset:22528
    v_mfma_f32_16x16x32_bf16 v[116:119], a[116:119], v[84:87], v[116:119]
    v_mfma_f32_16x16x32_bf16 v[120:123], a[116:119], v[88:91], v[120:123]
    s_waitcnt lgkmcnt(2)
    v_mfma_f32_16x16x32_bf16 v[108:111], a[40:43], v[92:95], v[108:111]
    ds_read_b128 v[84:87], v11 offset:24576
    v_mfma_f32_16x16x32_bf16 v[112:115], a[40:43], v[96:99], v[112:115]
    ds_read_b128 v[88:91], v11 offset:26624
    v_mfma_f32_16x16x32_bf16 v[116:119], a[120:123], v[92:95], v[116:119]
    v_mfma_f32_16x16x32_bf16 v[120:123], a[120:123], v[96:99], v[120:123]
    s_waitcnt lgkmcnt(2)
    v_mfma_f32_16x16x32_bf16 v[108:111], a[44:47], v[100:103], v[108:111]
    ds_read_b128 v[92:95], v12 offset:24576
    v_mfma_f32_16x16x32_bf16 v[112:115], a[44:47], v[104:107], v[112:115]
    ds_read_b128 v[96:99], v12 offset:26624
    v_mfma_f32_16x16x32_bf16 v[116:119], a[124:127], v[100:103], v[116:119]
    v_mfma_f32_16x16x32_bf16 v[120:123], a[124:127], v[104:107], v[120:123]
    s_waitcnt lgkmcnt(2)
    v_mfma_f32_16x16x32_bf16 v[108:111], a[48:51], v[84:87], v[108:111]
    ds_read_b128 v[100:103], v11 offset:28672
    v_mfma_f32_16x16x32_bf16 v[112:115], a[48:51], v[88:91], v[112:115]
    ds_read_b128 v[104:107], v11 offset:30720
    v_mfma_f32_16x16x32_bf16 v[116:119], a[128:131], v[84:87], v[116:119]
    v_mfma_f32_16x16x32_bf16 v[120:123], a[128:131], v[88:91], v[120:123]
    s_waitcnt lgkmcnt(2)
    v_mfma_f32_16x16x32_bf16 v[108:111], a[52:55], v[92:95], v[108:111]
    ds_read_b128 v[84:87], v12 offset:28672
    v_mfma_f32_16x16x32_bf16 v[112:115], a[52:55], v[96:99], v[112:115]
    ds_read_b128 v[88:91], v12 offset:30720
    v_mfma_f32_16x16x32_bf16 v[116:119], a[132:135], v[92:95], v[116:119]
    v_mfma_f32_16x16x32_bf16 v[120:123], a[132:135], v[96:99], v[120:123]
    s_waitcnt lgkmcnt(2)
    v_mfma_f32_16x16x32_bf16 v[108:111], a[56:59], v[100:103], v[108:111]
    ds_read_b128 v[92:95], v11 offset:32768
    v_mfma_f32_16x16x32_bf16 v[112:115], a[56:59], v[104:107], v[112:115]
    ds_read_b128 v[96:99], v11 offset:34816
    v_mfma_f32_16x16x32_bf16 v[116:119], a[136:139], v[100:103], v[116:119]
    v_mfma_f32_16x16x32_bf16 v[120:123], a[136:139], v[104:107], v[120:123]
    s_waitcnt lgkmcnt(2)
    v_mfma_f32_16x16x32_bf16 v[108:111], a[60:63], v[84:87], v[108:111]
    ds_read_b128 v[100:103], v12 offset:32768
    v_mfma_f32_16x16x32_bf16 v[112:115], a[60:63], v[88:91], v[112:115]
    ds_read_b128 v[104:107], v12 offset:34816
    v_mfma_f32_16x16x32_bf16 v[116:119], a[140:143], v[84:87], v[116:119]
    v_mfma_f32_16x16x32_bf16 v[120:123], a[140:143], v[88:91], v[120:123]
    s_waitcnt lgkmcnt(2)
    v_mfma_f32_16x16x32_bf16 v[108:111], a[64:67], v[92:95], v[108:111]
    ds_read_b128 v[84:87], v11 offset:36864
    v_mfma_f32_16x16x32_bf16 v[112:115], a[64:67], v[96:99], v[112:115]
    ds_read_b128 v[88:91], v11 offset:38912
    v_mfma_f32_16x16x32_bf16 v[116:119], a[144:147], v[92:95], v[116:119]
    v_mfma_f32_16x16x32_bf16 v[120:123], a[144:147], v[96:99], v[120:123]
    s_waitcnt lgkmcnt(2)
    v_mfma_f32_16x16x32_bf16 v[108:111], a[68:71], v[100:103], v[108:111]
    ds_read_b128 v[92:95], v12 offset:36864
    v_mfma_f32_16x16x32_bf16 v[112:115], a[68:71], v[104:107], v[112:115]
    ds_read_b128 v[96:99], v12 offset:38912
    v_mfma_f32_16x16x32_bf16 v[116:119], a[148:151], v[100:103], v[116:119]
    v_mfma_f32_16x16x32_bf16 v[120:123], a[148:151], v[104:107], v[120:123]
    s_waitcnt lgkmcnt(0)
    v_mfma_f32_16x16x32_bf16 v[108:111], a[72:75], v[84:87], v[108:111]
    v_add_u32 v11, s49, v11
    v_mfma_f32_16x16x32_bf16 v[112:115], a[72:75], v[88:91], v[112:115]
    v_add_u32 v12, s49, v12
    v_mfma_f32_16x16x32_bf16 v[108:111], a[76:79], v[92:95], v[108:111]
    s_sub_u32 s47, s47, s49
    v_mfma_f32_16x16x32_bf16 v[112:115], a[76:79], v[96:99], v[112:115]
    s_sub_u32 s49, 0, s49
    v_mfma_f32_16x16x32_bf16 v[116:119], a[152:155], v[84:87], v[116:119]
    v_mfma_f32_16x16x32_bf16 v[120:123], a[152:155], v[88:91], v[120:123]
    v_mfma_f32_16x16x32_bf16 v[116:119], a[156:159], v[92:95], v[116:119]
    v_mfma_f32_16x16x32_bf16 v[120:123], a[156:159], v[96:99], v[120:123]
    v_cvt_pk_bf16_f32 v124, v108, v109
    v_cvt_pk_bf16_f32 v125, v110, v111
    v_cvt_pk_bf16_f32 v126, v112, v113
    v_cvt_pk_bf16_f32 v127, v114, v115
    s_nop 0
    v_permlane16_swap_b32 v124, v126
    v_permlane16_swap_b32 v125, v127
    v_cvt_pk_bf16_f32 v128, v116, v117
    v_cvt_pk_bf16_f32 v129, v118, v119
    v_cvt_pk_bf16_f32 v130, v120, v121
    v_cvt_pk_bf16_f32 v131, v122, v123
    s_nop 0
    v_permlane16_swap_b32 v128, v130
    v_permlane16_swap_b32 v129, v131
    buffer_store_dwordx4 v[124:127], v19, s[4:7], s44 offen
    buffer_store_dwordx4 v[128:131], v19, s[4:7], s45 offen
    s_waitcnt vmcnt(2)
    s_branch L_gw_18c
L_gw_18:
    buffer_load_dword v2, v1, s[8:11], 0 offen sc1
    s_sub_u32 s36, s36, 1
    s_cbranch_scc1 L_exit
    s_waitcnt vmcnt(0)
L_gw_18c:
    v_readfirstlane_b32 s90, v2
    s_nop 0
    s_cmp_eq_u32 s90, 0
    s_cbranch_scc1 L_gw_18
    s_cmp_lg_u32 s90, 1
    s_cbranch_scc1 L_slow
    s_waitcnt vmcnt(2) lgkmcnt(0)
    s_barrier
    s_add_u32 s44, s38, 180224
    s_add_u32 s45, s44, s56
    s_mov_b32 s46, 81920
    v_mov_b32 v20, 1
    ds_read_b128 v[84:87], v11 offset:0
    ds_read_b128 v[88:91], v11 offset:2048
    ds_read_b128 v[92:95], v12 offset:0
    ds_read_b128 v[96:99], v12 offset:2048
    s_lshl_b32 s90, s32, 10
    s_add_u32 m0, s90, s47
    s_waitcnt lgkmcnt(2)
    v_mfma_f32_16x16x32_bf16 v[108:111], a[0:3], v[84:87], 0
    ds_read_b128 v[100:103], v11 offset:4096
    v_mfma_f32_16x16x32_bf16 v[112:115], a[0:3], v[88:91], 0
    ds_read_b128 v[104:107], v11 offset:6144
    v_mfma_f32_16x16x32_bf16 v[116:119], a[80:83], v[84:87], 0
    buffer_load_dwordx4 v10, s[24:27], s46 offen offset:0 lds
    s_add_u32 m0, m0, 3968
    v_mfma_f32_16x16x32_bf16 v[120:123], a[80:83], v[88:91], 0
    s_waitcnt lgkmcnt(2)
    v_mfma_f32_16x16x32_bf16 v[108:111], a[4:7], v[92:95], v[108:111]
    ds_read_b128 v[84:87], v12 offset:4096
    v_mfma_f32_16x16x32_bf16 v[112:115], a[4:7], v[96:99], v[112:115]
    ds_read_b128 v[88:91], v12 offset:6144
    v_mfma_f32_16x16x32_bf16 v[116:119], a[84:87], v[92:95], v[116:119]
    buffer_load_dwordx4 v10, s[24:27], s46 offen offset:128 lds
    s_add_u32 m0, m0, 3968
    v_mfma_f32_16x16x32_bf16 v[120:123], a[84:87], v[96:99], v[120:123]
    s_waitcnt lgkmcnt(2)
    v_mfma_f32_16x16x32_bf16 v[108:111], a[8:11], v[100:103], v[108:111]
    ds_read_b128 v[92:95], v11 offset:8192
    v_mfma_f32_16x16x32_bf16 v[112:115], a[8:11], v[104:107], v[112:115]
    ds_read_b128 v[96:99], v11 offset:10240
    v_mfma_f32_16x16x32_bf16 v[116:119], a[88:91], v[100:103], v[116:119]
    buffer_load_dwordx4 v10, s[24:27], s46 offen offset:256 lds
    s_add_u32 m0, m0, 3968
    v_mfma_f32_16x16x32_bf16 v[120:123], a[88:91], v[104:107], v[120:123]
    s_waitcnt lgkmcnt(2)
    v_mfma_f32_16x16x32_bf16 v[108:111], a[12:15], v[84:87], v[108:111]
    ds_read_b128 v[100:103], v12 offset:8192
    v_mfma_f32_16x16x32_bf16 v[112:115], a[12:15], v[88:91], v[112:115]
    ds_read_b128 v[104:107], v12 offset:10240
    v_mfma_f32_16x16x32_bf16 v[116:119], a[92:95], v[84:87], v[116:119]
    buffer_load_dwordx4 v10, s[24:27], s46 offen offset:384 lds
    s_add_u32 m0, m0, 3968
    v_mfma_f32_16x16x32_bf16 v[120:123], a[92:95], v[88:91], v[120:123]
    s_waitcnt lgkmcnt(2)
    v_mfma_f32_16x16x32_bf16 v[108:111], a[16:19], v[92:95], v[108:111]
    ds_read_b128 v[84:87], v11 offset:12288
    v_mfma_f32_16x16x32_bf16 v[112:115], a[16:19], v[96:99], v[112:115]
    ds_read_b128 v[88:91], v11 offset:14336
    v_mfma_f32_16x16x32_bf16 v[116:119], a[96:99], v[92:95], v[116:119]
    buffer_load_dwordx4 v10, s[24:27], s46 offen offset:512 lds
    s_add_u32 m0, m0, 3968
    v_mfma_f32_16x16x32_bf16 v[120:123], a[96:99], v[96:99], v[120:123]
    s_waitcnt lgkmcnt(2)
    v_mfma_f32_16x16x32_bf16 v[108:111], a[20:23], v[100:103], v[108:111]
    ds_read_b128 v[92:95], v12 offset:12288
    v_mfma_f32_16x16x32_bf16 v[112:115], a[20:23], v[104:107], v[112:115]
    ds_read_b128 v[96:99], v12 offset:14336
    v_mfma_f32_16x16x32_bf16 v[116:119], a[100:103], v[100:103], v[116:119]
    s_waitcnt vmcnt(5)
    buffer_store_dword v20, v136, s[4:7], s38 offen
    v_mfma_f32_16x16x32_bf16 v[120:123], a[100:103], v[104:107], v[120:123]
    s_waitcnt lgkmcnt(2)
    v_mfma_f32_16x16x32_bf16 v[108:111], a[24:27], v[84:87], v[108:111]
    ds_read_b128 v[100:103], v11 offset:16384
    v_mfma_f32_16x16x32_bf16 v[112:115], a[24:27], v[88:91], v[112:115]
    ds_read_b128 v[104:107], v11 offset:18432
    v_mfma_f32_16x16x32_bf16 v[116:119], a[104:107], v[84:87], v[116:119]
    buffer_load_dwordx4 v10, s[24:27], s46 offen offset:640 lds
    s_add_u32 m0, m0, 3968
    v_mfma_f32_16x16x32_bf16 v[120:123], a[104:107], v[88:91], v[120:123]
    s_waitcnt lgkmcnt(2)
    v_mfma_f32_16x16x32_bf16 v[108:111], a[28:31], v[92:95], v[108:111]
    ds_read_b128 v[84:87], v12 offset:16384
    v_mfma_f32_16x16x32_bf16 v[112:115], a[28:31], v[96:99], v[112:115]
    ds_read_b128 v[88:91], v12 offset:18432
    v_mfma_f32_16x16x32_bf16 v[116:119], a[108:111], v[92:95], v[116:119]
    buffer_load_dwordx4 v10, s[24:27], s46 offen offset:768 lds
    s_add_u32 m0, m0, 3968
    v_mfma_f32_16x16x32_bf16 v[120:123], a[108:111], v[96:99], v[120:123]
    s_waitcnt lgkmcnt(2)
    v_mfma_f32_16x16x32_bf16 v[108:111], a[32:35], v[100:103], v[108:111]
    ds_read_b128 v[92:95], v11 offset:20480
    v_mfma_f32_16x16x32_bf16 v[112:115], a[32:35], v[104:107], v[112:115]
    ds_read_b128 v[96:99], v11 offset:22528
    v_mfma_f32_16x16x32_bf16 v[116:119], a[112:115], v[100:103], v[116:119]
    buffer_load_dwordx4 v10, s[24:27], s46 offen offset:896 lds
    s_add_u32 m0, m0, 3968
    v_mfma_f32_16x16x32_bf16 v[120:123], a[112:115], v[104:107], v[120:123]
    s_waitcnt lgkmcnt(2)
    v_mfma_f32_16x16x32_bf16 v[108:111], a[36:39], v[84:87], v[108:111]
    ds_read_b128 v[100:103], v12 offset:20480
    v_mfma_f32_16x16x32_bf16 v[112:115], a[36:39], v[88:91], v[112:115]
    ds_read_b128 v[104:107], v12 offset:22528
    v_mfma_f32_16x16x32_bf16 v[116:119], a[116:119], v[84:87], v[116:119]
    buffer_load_dwordx4 v10, s[24:27], s46 offen offset:1024 lds
    s_add_u32 m0, m0, 3968
    v_mfma_f32_16x16x32_bf16 v[120:123], a[116:119], v[88:91], v[120:123]
    s_waitcnt lgkmcnt(2)
    v_mfma_f32_16x16x32_bf16 v[108:111], a[40:43], v[92:95], v[108:111]
    ds_read_b128 v[84:87], v11 offset:24576
    v_mfma_f32_16x16x32_bf16 v[112:115], a[40:43], v[96:99], v[112:115]
    ds_read_b128 v[88:91], v11 offset:26624
    v_mfma_f32_16x16x32_bf16 v[116:119], a[120:123], v[92:95], v[116:119]
    buffer_load_dwordx4 v10, s[24:27], s46 offen offset:1152 lds
    v_mfma_f32_16x16x32_bf16 v[120:123], a[120:123], v[96:99], v[120:123]
    s_waitcnt lgkmcnt(2)
    v_mfma_f32_16x16x32_bf16 v[108:111], a[44:47], v[100:103], v[108:111]
    ds_read_b128 v[92:95], v12 offset:24576
    v_mfma_f32_16x16x32_bf16 v[112:115], a[44:47], v[104:107], v[112:115]
    ds_read_b128 v[96:99], v12 offset:26624
    v_mfma_f32_16x16x32_bf16 v[116:119], a[124:127], v[100:103], v[116:119]
    v_mfma_f32_16x16x32_bf16 v[120:123], a[124:127], v[104:107], v[120:123]
    s_waitcnt lgkmcnt(2)
    v_mfma_f32_16x16x32_bf16 v[108:111], a[48:51], v[84:87], v[108:111]
    ds_read_b128 v[100:103], v11 offset:28672
    v_mfma_f32_16x16x32_bf16 v[112:115], a[48:51], v[88:91], v[112:115]
    ds_read_b128 v[104:107], v11 offset:30720
    v_mfma_f32_16x16x32_bf16 v[116:119], a[128:131], v[84:87], v[116:119]
    v_mfma_f32_16x16x32_bf16 v[120:123], a[128:131], v[88:91], v[120:123]
    s_waitcnt lgkmcnt(2)
    v_mfma_f32_16x16x32_bf16 v[108:111], a[52:55], v[92:95], v[108:111]
    ds_read_b128 v[84:87], v12 offset:28672
    v_mfma_f32_16x16x32_bf16 v[112:115], a[52:55], v[96:99], v[112:115]
    ds_read_b128 v[88:91], v12 offset:30720
    v_mfma_f32_16x16x32_bf16 v[116:119], a[132:135], v[92:95], v[116:119]
    v_mfma_f32_16x16x32_bf16 v[120:123], a[132:135], v[96:99], v[120:123]
    s_waitcnt lgkmcnt(2)
    v_mfma_f32_16x16x32_bf16 v[108:111], a[56:59], v[100:103], v[108:111]
    ds_read_b128 v[92:95], v11 offset:32768
    v_mfma_f32_16x16x32_bf16 v[112:115], a[56:59], v[104:107], v[112:115]
    ds_read_b128 v[96:99], v11 offset:34816
    v_mfma_f32_16x16x32_bf16 v[116:119], a[136:139], v[100:103], v[116:119]
    v_mfma_f32_16x16x32_bf16 v[120:123], a[136:139], v[104:107], v[120:123]
    s_waitcnt lgkmcnt(2)
    v_mfma_f32_16x16x32_bf16 v[108:111], a[60:63], v[84:87], v[108:111]
    ds_read_b128 v[100:103], v12 offset:32768
    v_mfma_f32_16x16x32_bf16 v[112:115], a[60:63], v[88:91], v[112:115]
    ds_read_b128 v[104:107], v12 offset:34816
    v_mfma_f32_16x16x32_bf16 v[116:119], a[140:143], v[84:87], v[116:119]
    v_mfma_f32_16x16x32_bf16 v[120:123], a[140:143], v[88:91], v[120:123]
    s_waitcnt lgkmcnt(2)
    v_mfma_f32_16x16x32_bf16 v[108:111], a[64:67], v[92:95], v[108:111]
    ds_read_b128 v[84:87], v11 offset:36864
    v_mfma_f32_16x16x32_bf16 v[112:115], a[64:67], v[96:99], v[112:115]
    ds_read_b128 v[88:91], v11 offset:38912
    v_mfma_f32_16x16x32_bf16 v[116:119], a[144:147], v[92:95], v[116:119]
    v_mfma_f32_16x16x32_bf16 v[120:123], a[144:147], v[96:99], v[120:123]
    s_waitcnt lgkmcnt(2)
    v_mfma_f32_16x16x32_bf16 v[108:111], a[68:71], v[100:103], v[108:111]
    ds_read_b128 v[92:95], v12 offset:36864
    v_mfma_f32_16x16x32_bf16 v[112:115], a[68:71], v[104:107], v[112:115]
    ds_read_b128 v[96:99], v12 offset:38912
    v_mfma_f32_16x16x32_bf16 v[116:119], a[148:151], v[100:103], v[116:119]
    v_mfma_f32_16x16x32_bf16 v[120:123], a[148:151], v[104:107], v[120:123]
    s_waitcnt lgkmcnt(0)
    v_mfma_f32_16x16x32_bf16 v[108:111], a[72:75], v[84:87], v[108:111]
    v_add_u32 v11, s49, v11
    v_mfma_f32_16x16x32_bf16 v[112:115], a[72:75], v[88:91], v[112:115]
    v_add_u32 v12, s49, v12
    v_mfma_f32_16x16x32_bf16 v[108:111], a[76:79], v[92:95], v[108:111]
    s_sub_u32 s47, s47, s49
    v_mfma_f32_16x16x32_bf16 v[112:115], a[76:79], v[96:99], v[112:115]
    s_sub_u32 s49, 0, s49
    v_mfma_f32_16x16x32_bf16 v[116:119], a[152:155], v[84:87], v[116:119]
    v_mfma_f32_16x16x32_bf16 v[120:123], a[152:155], v[88:91], v[120:123]
    v_mfma_f32_16x16x32_bf16 v[116:119], a[156:159], v[92:95], v[116:119]
    v_mfma_f32_16x16x32_bf16 v[120:123], a[156:159], v[96:99], v[120:123]
    v_cvt_pk_bf16_f32 v124, v108, v109
    v_cvt_pk_bf16_f32 v125, v110, v111
    v_cvt_pk_bf16_f32 v126, v112, v113
    v_cvt_pk_bf16_f32 v127, v114, v115
    s_nop 0
    v_permlane16_swap_b32 v124, v126
    v_permlane16_swap_b32 v125, v127
    v_cvt_pk_bf16_f32 v128, v116, v117
    v_cvt_pk_bf16_f32 v129, v118, v119
    v_cvt_pk_bf16_f32 v130, v120, v121
    v_cvt_pk_bf16_f32 v131, v122, v123
    s_nop 0
    v_permlane16_swap_b32 v128, v130
    v_permlane16_swap_b32 v129, v131
    buffer_store_dwordx4 v[124:127], v19, s[4:7], s44 offen
    buffer_store_dwordx4 v[128:131], v19, s[4:7], s45 offen
    s_waitcnt vmcnt(2) lgkmcnt(0)
    s_barrier
    s_add_u32 s44, s38, 294912
    s_add_u32 s45, s44, s56
    s_mov_b32 s46, 122880
    v_mov_b32 v20, 2
    ds_read_b128 v[84:87], v11 offset:0
    ds_read_b128 v[88:91], v11 offset:2048
    ds_read_b128 v[92:95], v12 offset:0
    ds_read_b128 v[96:99], v12 offset:2048
    s_lshl_b32 s90, s32, 10
    s_add_u32 m0, s90, s47
    s_waitcnt lgkmcnt(2)
    v_mfma_f32_16x16x32_bf16 v[108:111], a[0:3], v[84:87], 0
    ds_read_b128 v[100:103], v11 offset:4096
    s_add_u32 s51, s37, 3
    v_mfma_f32_16x16x32_bf16 v[112:115], a[0:3], v[88:91], 0
    ds_read_b128 v[104:107], v11 offset:6144
    s_and_b32 s50, s51, 3
    v_mfma_f32_16x16x32_bf16 v[116:119], a[80:83], v[84:87], 0
    buffer_load_dwordx4 v10, s[24:27], s46 offen offset:0 lds
    s_add_u32 m0, m0, 3968
    v_mfma_f32_16x16x32_bf16 v[120:123], a[80:83], v[88:91], 0
    s_waitcnt lgkmcnt(2)
    s_mul_i32 s50, s50, 114688
    v_mfma_f32_16x16x32_bf16 v[108:111], a[4:7], v[92:95], v[108:111]
    ds_read_b128 v[84:87], v12 offset:4096
    s_add_u32 s50, s50, 65536
    v_mfma_f32_16x16x32_bf16 v[112:115], a[4:7], v[96:99], v[112:115]
    ds_read_b128 v[88:91], v12 offset:6144
    s_add_u32 s44, s38, s50
    v_mfma_f32_16x16x32_bf16 v[116:119], a[84:87], v[92:95], v[116:119]
    buffer_load_dwordx4 v10, s[24:27], s46 offen offset:128 lds
    s_add_u32 m0, m0, 3968
    v_mfma_f32_16x16x32_bf16 v[120:123], a[84:87], v[96:99], v[120:123]
    s_waitcnt lgkmcnt(2)
    s_add_u32 s45, s44, s56
    v_mfma_f32_16x16x32_bf16 v[108:111], a[8:11], v[100:103], v[108:111]
    ds_read_b128 v[92:95], v11 offset:8192
    s_add_u32 s37, s37, 1
    v_mfma_f32_16x16x32_bf16 v[112:115], a[8:11], v[104:107], v[112:115]
    ds_read_b128 v[96:99], v11 offset:10240
    s_mov_b32 s52, 0
    v_mfma_f32_16x16x32_bf16 v[116:119], a[88:91], v[100:103], v[116:119]
    buffer_load_dwordx4 v10, s[24:27], s46 offen offset:256 lds
    s_add_u32 m0, m0, 3968
    v_mfma_f32_16x16x32_bf16 v[120:123], a[88:91], v[104:107], v[120:123]
    s_waitcnt lgkmcnt(2)
    s_and_b32 s50, s37, 3
    v_mfma_f32_16x16x32_bf16 v[108:111], a[12:15], v[84:87], v[108:111]
    ds_read_b128 v[100:103], v12 offset:8192
    s_mul_i32 s51, s50, 114688
    v_mfma_f32_16x16x32_bf16 v[112:115], a[12:15], v[88:91], v[112:115]
    ds_read_b128 v[104:107], v12 offset:10240
    s_add_u32 s41, s38, s51
    v_mfma_f32_16x16x32_bf16 v[116:119], a[92:95], v[84:87], v[116:119]
    buffer_load_dwordx4 v10, s[24:27], s46 offen offset:384 lds
    s_add_u32 m0, m0, 3968
    v_mfma_f32_16x16x32_bf16 v[120:123], a[92:95], v[88:91], v[120:123]
    s_waitcnt lgkmcnt(2)
    v_mfma_f32_16x16x32_bf16 v[108:111], a[16:19], v[92:95], v[108:111]
    ds_read_b128 v[84:87], v11 offset:12288
    v_mfma_f32_16x16x32_bf16 v[112:115], a[16:19], v[96:99], v[112:115]
    ds_read_b128 v[88:91], v11 offset:14336
    v_mfma_f32_16x16x32_bf16 v[116:119], a[96:99], v[92:95], v[116:119]
    buffer_load_dwordx4 v10, s[24:27], s46 offen offset:512 lds
    s_add_u32 m0, m0, 3968
    v_mfma_f32_16x16x32_bf16 v[120:123], a[96:99], v[96:99], v[120:123]
    s_waitcnt lgkmcnt(2)
    v_mfma_f32_16x16x32_bf16 v[108:111], a[20:23], v[100:103], v[108:111]
    ds_read_b128 v[92:95], v12 offset:12288
    v_mfma_f32_16x16x32_bf16 v[112:115], a[20:23], v[104:107], v[112:115]
    ds_read_b128 v[96:99], v12 offset:14336
    v_mfma_f32_16x16x32_bf16 v[116:119], a[100:103], v[100:103], v[116:119]
    s_waitcnt vmcnt(5)
    buffer_store_dword v20, v136, s[4:7], s38 offen
    v_mfma_f32_16x16x32_bf16 v[120:123], a[100:103], v[104:107], v[120:123]
    s_waitcnt lgkmcnt(2)
    v_mfma_f32_16x16x32_bf16 v[108:111], a[24:27], v[84:87], v[108:111]
    ds_read_b128 v[100:103], v11 offset:16384
    v_mfma_f32_16x16x32_bf16 v[112:115], a[24:27], v[88:91], v[112:115]
    ds_read_b128 v[104:107], v11 offset:18432
    v_mfma_f32_16x16x32_bf16 v[116:119], a[104:107], v[84:87], v[116:119]
    buffer_load_dwordx4 v10, s[24:27], s46 offen offset:640 lds
    s_add_u32 m0, m0, 3968
    v_mfma_f32_16x16x32_bf16 v[120:123], a[104:107], v[88:91], v[120:123]
    s_waitcnt lgkmcnt(2)
    v_mfma_f32_16x16x32_bf16 v[108:111], a[28:31], v[92:95], v[108:111]
    ds_read_b128 v[84:87], v12 offset:16384
    v_mfma_f32_16x16x32_bf16 v[112:115], a[28:31], v[96:99], v[112:115]
    ds_read_b128 v[88:91], v12 offset:18432
    v_mfma_f32_16x16x32_bf16 v[116:119], a[108:111], v[92:95], v[116:119]
    buffer_load_dwordx4 v10, s[24:27], s46 offen offset:768 lds
    s_add_u32 m0, m0, 3968
    v_mfma_f32_16x16x32_bf16 v[120:123], a[108:111], v[96:99], v[120:123]
    s_waitcnt lgkmcnt(2)
    v_mfma_f32_16x16x32_bf16 v[108:111], a[32:35], v[100:103], v[108:111]
    ds_read_b128 v[92:95], v11 offset:20480
    v_mfma_f32_16x16x32_bf16 v[112:115], a[32:35], v[104:107], v[112:115]
    ds_read_b128 v[96:99], v11 offset:22528
    v_mfma_f32_16x16x32_bf16 v[116:119], a[112:115], v[100:103], v[116:119]
    buffer_load_dwordx4 v10, s[24:27], s46 offen offset:896 lds
    s_add_u32 m0, m0, 3968
    v_mfma_f32_16x16x32_bf16 v[120:123], a[112:115], v[104:107], v[120:123]
    s_waitcnt lgkmcnt(2)
    v_mfma_f32_16x16x32_bf16 v[108:111], a[36:39], v[84:87], v[108:111]
    ds_read_b128 v[100:103], v12 offset:20480
    v_mfma_f32_16x16x32_bf16 v[112:115], a[36:39], v[88:91], v[112:115]
    ds_read_b128 v[104:107], v12 offset:22528
    v_mfma_f32_16x16x32_bf16 v[116:119], a[116:119], v[84:87], v[116:119]
    buffer_load_dwordx4 v10, s[24:27], s46 offen offset:1024 lds
    s_add_u32 m0, m0, 3968
    v_mfma_f32_16x16x32_bf16 v[120:123], a[116:119], v[88:91], v[120:123]
    s_waitcnt lgkmcnt(2)
    v_mfma_f32_16x16x32_bf16 v[108:111], a[40:43], v[92:95], v[108:111]
    ds_read_b128 v[84:87], v11 offset:24576
    v_mfma_f32_16x16x32_bf16 v[112:115], a[40:43], v[96:99], v[112:115]
    ds_read_b128 v[88:91], v11 offset:26624
    v_mfma_f32_16x16x32_bf16 v[116:119], a[120:123], v[92:95], v[116:119]
    buffer_load_dwordx4 v10, s[24:27], s46 offen offset:1152 lds
    v_mfma_f32_16x16x32_bf16 v[120:123], a[120:123], v[96:99], v[120:123]
    s_waitcnt lgkmcnt(2)
    v_mfma_f32_16x16x32_bf16 v[108:111], a[44:47], v[100:103], v[108:111]
    ds_read_b128 v[92:95], v12 offset:24576
    v_mfma_f32_16x16x32_bf16 v[112:115], a[44:47], v[104:107], v[112:115]
    ds_read_b128 v[96:99], v12 offset:26624
    v_mfma_f32_16x16x32_bf16 v[116:119], a[124:127], v[100:103], v[116:119]
    v_mfma_f32_16x16x32_bf16 v[120:123], a[124:127], v[104:107], v[120:123]
    s_waitcnt lgkmcnt(2)
    v_mfma_f32_16x16x32_bf16 v[108:111], a[48:51], v[84:87], v[108:111]
    ds_read_b128 v[100:103], v11 offset:28672
    v_mfma_f32_16x16x32_bf16 v[112:115], a[48:51], v[88:91], v[112:115]
    ds_read_b128 v[104:107], v11 offset:30720
    v_mfma_f32_16x16x32_bf16 v[116:119], a[128:131], v[84:87], v[116:119]
    v_mfma_f32_16x16x32_bf16 v[120:123], a[128:131], v[88:91], v[120:123]
    s_waitcnt lgkmcnt(2)
    v_mfma_f32_16x16x32_bf16 v[108:111], a[52:55], v[92:95], v[108:111]
    ds_read_b128 v[84:87], v12 offset:28672
    v_mfma_f32_16x16x32_bf16 v[112:115], a[52:55], v[96:99], v[112:115]
    ds_read_b128 v[88:91], v12 offset:30720
    v_mfma_f32_16x16x32_bf16 v[116:119], a[132:135], v[92:95], v[116:119]
    v_mfma_f32_16x16x32_bf16 v[120:123], a[132:135], v[96:99], v[120:123]
    s_waitcnt lgkmcnt(2)
    v_mfma_f32_16x16x32_bf16 v[108:111], a[56:59], v[100:103], v[108:111]
    ds_read_b128 v[92:95], v11 offset:32768
    v_mfma_f32_16x16x32_bf16 v[112:115], a[56:59], v[104:107], v[112:115]
    ds_read_b128 v[96:99], v11 offset:34816
    v_mfma_f32_16x16x32_bf16 v[116:119], a[136:139], v[100:103], v[116:119]
    v_mfma_f32_16x16x32_bf16 v[120:123], a[136:139], v[104:107], v[120:123]
    s_waitcnt lgkmcnt(2)
    v_mfma_f32_16x16x32_bf16 v[108:111], a[60:63], v[84:87], v[108:111]
    ds_read_b128 v[100:103], v12 offset:32768
    v_mfma_f32_16x16x32_bf16 v[112:115], a[60:63], v[88:91], v[112:115]
    ds_read_b128 v[104:107], v12 offset:34816
    v_mfma_f32_16x16x32_bf16 v[116:119], a[140:143], v[84:87], v[116:119]
    v_mfma_f32_16x16x32_bf16 v[120:123], a[140:143], v[88:91], v[120:123]
    s_waitcnt lgkmcnt(2)
    v_mfma_f32_16x16x32_bf16 v[108:111], a[64:67], v[92:95], v[108:111]
    ds_read_b128 v[84:87], v11 offset:36864
    v_mfma_f32_16x16x32_bf16 v[112:115], a[64:67], v[96:99], v[112:115]
    ds_read_b128 v[88:91], v11 offset:38912
    v_mfma_f32_16x16x32_bf16 v[116:119], a[144:147], v[92:95], v[116:119]
    v_mfma_f32_16x16x32_bf16 v[120:123], a[144:147], v[96:99], v[120:123]
    s_waitcnt lgkmcnt(2)
    v_mfma_f32_16x16x32_bf16 v[108:111], a[68:71], v[100:103], v[108:111]
    ds_read_b128 v[92:95], v12 offset:36864
    v_mfma_f32_16x16x32_bf16 v[112:115], a[68:71], v[104:107], v[112:115]
    ds_read_b128 v[96:99], v12 offset:38912
    v_mfma_f32_16x16x32_bf16 v[116:119], a[148:151], v[100:103], v[116:119]
    v_mfma_f32_16x16x32_bf16 v[120:123], a[148:151], v[104:107], v[120:123]
    s_waitcnt lgkmcnt(0)
    v_mfma_f32_16x16x32_bf16 v[108:111], a[72:75], v[84:87], v[108:111]
    v_add_u32 v11, s49, v11
    v_mfma_f32_16x16x32_bf16 v[112:115], a[72:75], v[88:91], v[112:115]
    v_add_u32 v12, s49, v12
    v_mfma_f32_16x16x32_bf16 v[108:111], a[76:79], v[92:95], v[108:111]
    s_sub_u32 s47, s47, s49
    v_mfma_f32_16x16x32_bf16 v[112:115], a[76:79], v[96:99], v[112:115]
    s_sub_u32 s49, 0, s49
    v_mfma_f32_16x16x32_bf16 v[116:119], a[152:155], v[84:87], v[116:119]
    v_mfma_f32_16x16x32_bf16 v[120:123], a[152:155], v[88:91], v[120:123]
    v_mfma_f32_16x16x32_bf16 v[116:119], a[156:159], v[92:95], v[116:119]
    v_mfma_f32_16x16x32_bf16 v[120:123], a[156:159], v[96:99], v[120:123]
    v_cvt_pk_bf16_f32 v124, v108, v109
    v_cvt_pk_bf16_f32 v125, v110, v111
    v_cvt_pk_bf16_f32 v126, v112, v113
    v_cvt_pk_bf16_f32 v127, v114, v115
    s_nop 0
    v_permlane16_swap_b32 v124, v126
    v_permlane16_swap_b32 v125, v127
    v_cvt_pk_bf16_f32 v128, v116, v117
    v_cvt_pk_bf16_f32 v129, v118, v119
    v_cvt_pk_bf16_f32 v130, v120, v121
    v_cvt_pk_bf16_f32 v131, v122, v123
    s_nop 0
    v_permlane16_swap_b32 v128, v130
    v_permlane16_swap_b32 v129, v131
    buffer_store_dwordx4 v[124:127], v19, s[4:7], s44 offen
    buffer_store_dwordx4 v[128:131], v19, s[4:7], s45 offen
    s_add_u32 s50, s37, 2
    s_and_b32 s50, s50, 3
    s_mul_i32 s50, s50, 114688
    s_add_u32 s42, s38, s50
    s_add_u32 s50, s37, 4
    s_min_u32 s50, s50, 63
    s_mul_i32 s46, s50, 40960
    s_add_u32 s51, s37, 1
    v_mov_b32 v20, s51
    s_mov_b32 m0, s48
    v_mov_b32 v68, 0
    v_mov_b32 v69, 0
    v_mov_b32 v70, 0
    v_mov_b32 v71, 0
    v_mov_b32 v72, 0
    v_mov_b32 v73, 0
    v_mov_b32 v74, 0
    v_mov_b32 v75, 0
    s_add_u32 s50, s37, 6
    s_min_u32 s50, s50, 63
    s_mul_i32 s57, s50, 40960
    s_and_b32 s50, s37, 3
    s_mul_i32 s51, s50, 40960
    s_add_u32 s43, s51, s38
    s_mul_i32 s51, s50, 327680
    s_add_u32 s53, s51, 4194304
    s_xor_b32 s50, s50, 2
    s_mul_i32 s51, s50, 327680
    s_add_u32 s54, s51, 4194304
    s_sub_u32 s51, s37, 6
    s_mul_i32 s60, s51, 81920
    s_branch L_v_first_f
L_v_loop_f:
    s_add_u32 s50, s37, 2
    s_and_b32 s50, s50, 3
    s_mul_i32 s50, s50, 114688
    s_add_u32 s42, s38, s50
    s_add_u32 s50, s37, 4
    s_min_u32 s50, s50, 63
    s_mul_i32 s46, s50, 40960
    s_add_u32 s51, s37, 1
    v_mov_b32 v20, s51
    s_mov_b32 m0, s48
    v_mov_b32 v68, 0
    v_mov_b32 v69, 0
    v_mov_b32 v70, 0
    v_mov_b32 v71, 0
    v_mov_b32 v72, 0
    v_mov_b32 v73, 0
    v_mov_b32 v74, 0
    v_mov_b32 v75, 0
    s_add_u32 s50, s37, 6
    s_min_u32 s50, s50, 63
    s_mul_i32 s57, s50, 40960
    s_and_b32 s50, s37, 3
    s_mul_i32 s51, s50, 40960
    s_add_u32 s43, s51, s38
    s_mul_i32 s51, s50, 327680
    s_add_u32 s53, s51, 4194304
    s_xor_b32 s50, s50, 2
    s_mul_i32 s51, s50, 327680
    s_add_u32 s54, s51, 4194304
    s_sub_u32 s51, s37, 6
    s_mul_i32 s60, s51, 81920
L_vg_19:
    buffer_load_dword v139, v138, s[4:7], s38 offen sc1
    s_sub_u32 s36, s36, 1
    s_cbranch_scc1 L_exit
    s_waitcnt vmcnt(0)
    v_cmp_gt_u32 vcc, s37, v139
    s_cbranch_vccnz L_vg_19
L_v_first_f:
    buffer_load_dwordx4 v13, s[4:7], s41 offen sc1 lds
    buffer_load_dwordx4 v13, s[4:7], s41 offen offset:1024 sc1 lds
    buffer_load_dword v14, s[4:7], s41 offen offset:2048 sc1 lds
    buffer_load_dword v14, s[4:7], s41 offen offset:2304 sc1 lds
L_poll_21:
    buffer_load_dwordx4 v13, s[4:7], s41 offen sc1 lds
    buffer_load_dwordx4 v13, s[4:7], s41 offen offset:1024 sc1 lds
    buffer_load_dword v14, s[4:7], s41 offen offset:2048 sc1 lds
    buffer_load_dword v14, s[4:7], s41 offen offset:2304 sc1 lds
    s_sub_u32 s36, s36, 1
    s_cbranch_scc1 L_exit
    s_waitcnt vmcnt(4)
    ds_read_b32 v18, v15
    s_waitcnt lgkmcnt(0)
    v_cmp_eq_u32 vcc, -1, v18
    s_cbranch_vccnz L_poll_21
    s_barrier
    ds_read_b128 v[28:31], v16 offset:0
    ds_read_b128 v[32:35], v16 offset:1024
    ds_read_b128 v[36:39], v16 offset:2048
    ds_read_b128 v[40:43], v16 offset:3072
    s_waitcnt lgkmcnt(3)
    v_smfmac_f32_16x16x64_bf16 v[68:71], v[28:31], a[0:7], v17
    ds_read_b128 v[44:47], v16 offset:4096
    v_smfmac_f32_16x16x64_bf16 v[72:75], v[28:31], a[80:87], v17
    ds_read_b128 v[48:51], v16 offset:5120
    s_waitcnt lgkmcnt(4)
    v_smfmac_f32_16x16x64_bf16 v[68:71], v[32:35], a[8:15], v17
    ds_read_b128 v[52:55], v16 offset:6144
    v_smfmac_f32_16x16x64_bf16 v[72:75], v[32:35], a[88:95], v17
    ds_read_b128 v[56:59], v16 offset:7168
    s_waitcnt lgkmcnt(5)
    v_smfmac_f32_16x16x64_bf16 v[68:71], v[36:39], a[16:23], v17
    ds_read_b128 v[60:63], v16 offset:8192
    v_smfmac_f32_16x16x64_bf16 v[72:75], v[36:39], a[96:103], v17
    ds_read_b128 v[64:67], v16 offset:9216
    s_waitcnt lgkmcnt(6)
    v_smfmac_f32_16x16x64_bf16 v[68:71], v[40:43], a[24:31], v17
    v_smfmac_f32_16x16x64_bf16 v[72:75], v[40:43], a[104:111], v17
    s_waitcnt lgkmcnt(5)
    v_smfmac_f32_16x16x64_bf16 v[68:71], v[44:47], a[32:39], v17
    v_smfmac_f32_16x16x64_bf16 v[72:75], v[44:47], a[112:119], v17
    s_waitcnt lgkmcnt(4)
    v_smfmac_f32_16x16x64_bf16 v[68:71], v[48:51], a[40:47], v17
    s_waitcnt lgkmcnt(3)
    v_smfmac_f32_16x16x64_bf16 v[68:71], v[52:55], a[48:55], v17
    s_waitcnt lgkmcnt(2)
    v_smfmac_f32_16x16x64_bf16 v[68:71], v[56:59], a[56:63], v17
    s_waitcnt lgkmcnt(1)
    v_smfmac_f32_16x16x64_bf16 v[68:71], v[60:63], a[64:71], v17
    s_waitcnt lgkmcnt(0)
    v_smfmac_f32_16x16x64_bf16 v[68:71], v[64:67], a[72:79], v17
L_redo_20:
    v_smfmac_f32_16x16x64_bf16 v[72:75], v[48:51], a[120:127], v17
    v_smfmac_f32_16x16x64_bf16 v[72:75], v[52:55], a[128:135], v17
    buffer_store_dword v20, v21, s[4:7], s38 offen offset:0
    v_smfmac_f32_16x16x64_bf16 v[72:75], v[56:59], a[136:143], v17
    v_add_f32 v68, v68, v70
    v_add_f32 v69, v69, v71
    v_smfmac_f32_16x16x64_bf16 v[72:75], v[60:63], a[144:151], v17
    v_cmp_u_f32 vcc, v68, v69
    v_cvt_pk_bf16_f32 v132, v68, v69
    v_smfmac_f32_16x16x64_bf16 v[72:75], v[64:67], a[152:159], v17
    s_cbranch_vccnz L_nan_22
L_cont_23:
    buffer_store_dword v132, v134, s[4:7], s41 offen offset:0
    s_nop 5
    v_pk_add_f32 v[72:73], v[72:73], v[74:75]
    v_cvt_pk_bf16_f32 v133, v72, v73
    buffer_store_dword v133, v134, s[4:7], s41 offen offset:1024
    buffer_store_dword v20, v21, s[4:7], s38 offen offset:32
    ds_read_b128 v[84:87], v11 offset:0
    ds_read_b128 v[88:91], v11 offset:2048
    ds_read_b128 v[92:95], v12 offset:0
    ds_read_b128 v[96:99], v12 offset:2048
    s_cmp_eq_u32 s37, 63
    s_cbranch_scc1 L_end_24
    s_cmp_eq_u32 s37, 0
    s_cbranch_scc1 L_sd_25c
L_sd_25:
    s_cmp_lg_u32 s55, 0
    s_cbranch_scc1 L_an_26x
    buffer_load_dword v139, v142, s[4:7], s38 offen sc1
    buffer_load_dword v139, v142, s[4:7], s38 offen sc1
    buffer_load_dword v139, v142, s[4:7], s38 offen sc1
    buffer_load_dword v139, v142, s[4:7], s38 offen sc1
    buffer_load_dword v139, v142, s[4:7], s38 offen sc1
    buffer_load_dword v139, v142, s[4:7], s38 offen sc1
L_sp_27:
    s_waitcnt vmcnt(5)
    v_cmp_ge_u32 vcc, s37, v139
    buffer_load_dword v139, v142, s[4:7], s38 offen sc1
    s_sub_u32 s36, s36, 1
    s_cbranch_scc1 L_exit
    s_cbranch_vccz L_sp_27x
    s_waitcnt vmcnt(5)
    v_cmp_ge_u32 vcc, s37, v139
    buffer_load_dword v139, v142, s[4:7], s38 offen sc1
    s_cbranch_vccz L_sp_27x
    s_waitcnt vmcnt(5)
    v_cmp_ge_u32 vcc, s37, v139
    buffer_load_dword v139, v142, s[4:7], s38 offen sc1
    s_cbranch_vccz L_sp_27x
    s_waitcnt vmcnt(5)
    v_cmp_ge_u32 vcc, s37, v139
    buffer_load_dword v139, v142, s[4:7], s38 offen sc1
    s_cbranch_vccnz L_sp_27
L_sp_27x:
L_an_26x:
    s_barrier
    s_lshl_b32 s90, s32, 10
    s_add_u32 m0, s90, s47
    s_waitcnt lgkmcnt(2)
    v_mfma_f32_16x16x32_bf16 v[108:111], a[0:3], v[84:87], 0
    ds_read_b128 v[100:103], v11 offset:4096
    s_add_u32 s51, s37, 3
    v_mfma_f32_16x16x32_bf16 v[112:115], a[0:3], v[88:91], 0
    ds_read_b128 v[104:107], v11 offset:6144
    s_and_b32 s50, s51, 3
    v_mfma_f32_16x16x32_bf16 v[116:119], a[80:83], v[84:87], 0
    buffer_load_dwordx4 v[148:151], v146, s[4:7], s43 offen offset:0 sc1
    buffer_load_dwordx4 v[152:155], v146, s[4:7], s43 offen offset:1024 sc1
    v_mfma_f32_16x16x32_bf16 v[120:123], a[80:83], v[88:91], 0
    s_waitcnt lgkmcnt(2)
    s_mul_i32 s50, s50, 114688
    v_mfma_f32_16x16x32_bf16 v[108:111], a[4:7], v[92:95], v[108:111]
    ds_read_b128 v[84:87], v12 offset:4096
    s_add_u32 s50, s50, 65536
    v_mfma_f32_16x16x32_bf16 v[112:115], a[4:7], v[96:99], v[112:115]
    ds_read_b128 v[88:91], v12 offset:6144
    s_add_u32 s44, s38, s50
    v_mfma_f32_16x16x32_bf16 v[116:119], a[84:87], v[92:95], v[116:119]
    s_cmp_lt_i32 s60, 0
    s_cselect_b32 s54, s38, s54
    buffer_load_dwordx4 v[156:159], v144, s[4:7], s54 offen offset:0 sc1
    buffer_load_dwordx4 v[160:163], v144, s[4:7], s54 offen offset:1024 sc1
    v_mfma_f32_16x16x32_bf16 v[120:123], a[84:87], v[96:99], v[120:123]
    s_waitcnt lgkmcnt(2)
    s_add_u32 s45, s44, s56
    v_mfma_f32_16x16x32_bf16 v[108:111], a[8:11], v[100:103], v[108:111]
    ds_read_b128 v[92:95], v11 offset:8192
    s_add_u32 s37, s37, 1
    v_mfma_f32_16x16x32_bf16 v[112:115], a[8:11], v[104:107], v[112:115]
    ds_read_b128 v[96:99], v11 offset:10240
    s_mov_b32 s52, 0
    v_mfma_f32_16x16x32_bf16 v[116:119], a[88:91], v[100:103], v[116:119]
    s_and_b32 s50, s37, 3
    s_mul_i32 s51, s50, 114688
    v_mfma_f32_16x16x32_bf16 v[120:123], a[88:91], v[104:107], v[120:123]
    s_waitcnt lgkmcnt(2)
    s_add_u32 s41, s38, s51
    v_mfma_f32_16x16x32_bf16 v[108:111], a[12:15], v[84:87], v[108:111]
    ds_read_b128 v[100:103], v12 offset:8192
    v_mfma_f32_16x16x32_bf16 v[112:115], a[12:15], v[88:91], v[112:115]
    ds_read_b128 v[104:107], v12 offset:10240
    v_mfma_f32_16x16x32_bf16 v[116:119], a[92:95], v[84:87], v[116:119]
    buffer_load_dwordx4 v[248:251], v137, s[24:27], s57 offen offset:0
    buffer_load_dwordx4 v[248:251], v137, s[24:27], s57 offen offset:1024
    v_mfma_f32_16x16x32_bf16 v[120:123], a[92:95], v[88:91], v[120:123]
    s_waitcnt lgkmcnt(2)
    v_mfma_f32_16x16x32_bf16 v[108:111], a[16:19], v[92:95], v[108:111]
    ds_read_b128 v[84:87], v11 offset:12288
    v_mfma_f32_16x16x32_bf16 v[112:115], a[16:19], v[96:99], v[112:115]
    ds_read_b128 v[88:91], v11 offset:14336
    v_mfma_f32_16x16x32_bf16 v[116:119], a[96:99], v[92:95], v[116:119]
    buffer_store_dword v20, v140, s[4:7], 0 offen sc1
    v_mfma_f32_16x16x32_bf16 v[120:123], a[96:99], v[96:99], v[120:123]
    s_waitcnt lgkmcnt(2)
    v_mfma_f32_16x16x32_bf16 v[108:111], a[20:23], v[100:103], v[108:111]
    ds_read_b128 v[92:95], v12 offset:12288
    v_mfma_f32_16x16x32_bf16 v[112:115], a[20:23], v[104:107], v[112:115]
    ds_read_b128 v[96:99], v12 offset:14336
    v_mfma_f32_16x16x32_bf16 v[116:119], a[100:103], v[100:103], v[116:119]
    s_waitcnt vmcnt(4)
    s_cmp_lt_i32 s60, -245760
    s_cbranch_scc1 L_fw_28c
L_fw_28:
    buffer_store_dwordx4 v[148:151], v143, s[4:7], s53 offen offset:0 sc1
    buffer_store_dwordx4 v[152:155], v143, s[4:7], s53 offen offset:1024 sc1
    v_mfma_f32_16x16x32_bf16 v[120:123], a[100:103], v[104:107], v[120:123]
    s_waitcnt lgkmcnt(2)
    v_mfma_f32_16x16x32_bf16 v[108:111], a[24:27], v[84:87], v[108:111]
    buffer_store_dword v20, v141, s[4:7], 0 offen sc1
    ds_read_b128 v[100:103], v11 offset:16384
    v_mfma_f32_16x16x32_bf16 v[112:115], a[24:27], v[88:91], v[112:115]
    ds_read_b128 v[104:107], v11 offset:18432
    v_mfma_f32_16x16x32_bf16 v[116:119], a[104:107], v[84:87], v[116:119]
    v_mfma_f32_16x16x32_bf16 v[120:123], a[104:107], v[88:91], v[120:123]
    s_waitcnt lgkmcnt(2)
    v_mfma_f32_16x16x32_bf16 v[108:111], a[28:31], v[92:95], v[108:111]
    ds_read_b128 v[84:87], v12 offset:16384
    v_mfma_f32_16x16x32_bf16 v[112:115], a[28:31], v[96:99], v[112:115]
    ds_read_b128 v[88:91], v12 offset:18432
    v_mfma_f32_16x16x32_bf16 v[116:119], a[108:111], v[92:95], v[116:119]
    buffer_store_dword v22, v135, s[4:7], s42 offen offset:0
    buffer_store_dword v22, v135, s[4:7], s42 offen offset:1024
    v_mfma_f32_16x16x32_bf16 v[120:123], a[108:111], v[96:99], v[120:123]
    s_waitcnt lgkmcnt(2)
    v_mfma_f32_16x16x32_bf16 v[108:111], a[32:35], v[100:103], v[108:111]
    ds_read_b128 v[92:95], v11 offset:20480
    v_mfma_f32_16x16x32_bf16 v[112:115], a[32:35], v[104:107], v[112:115]
    ds_read_b128 v[96:99], v11 offset:22528
    v_mfma_f32_16x16x32_bf16 v[116:119], a[112:115], v[100:103], v[116:119]
    buffer_load_dwordx4 v10, s[24:27], s46 offen offset:0 lds
    s_add_u32 m0, m0, 3968
    v_mfma_f32_16x16x32_bf16 v[120:123], a[112:115], v[104:107], v[120:123]
    s_waitcnt lgkmcnt(2)
    v_mfma_f32_16x16x32_bf16 v[108:111], a[36:39], v[84:87], v[108:111]
    ds_read_b128 v[100:103], v12 offset:20480
    v_mfma_f32_16x16x32_bf16 v[112:115], a[36:39], v[88:91], v[112:115]
    ds_read_b128 v[104:107], v12 offset:22528
    v_mfma_f32_16x16x32_bf16 v[116:119], a[116:119], v[84:87], v[116:119]
    buffer_load_dwordx4 v10, s[24:27], s46 offen offset:128 lds
    s_add_u32 m0, m0, 3968
    v_mfma_f32_16x16x32_bf16 v[120:123], a[116:119], v[88:91], v[120:123]
    s_waitcnt lgkmcnt(2)
    v_mfma_f32_16x16x32_bf16 v[108:111], a[40:43], v[92:95], v[108:111]
    ds_read_b128 v[84:87], v11 offset:24576
    v_mfma_f32_16x16x32_bf16 v[112:115], a[40:43], v[96:99], v[112:115]
    ds_read_b128 v[88:91], v11 offset:26624
    v_mfma_f32_16x16x32_bf16 v[116:119], a[120:123], v[92:95], v[116:119]
    buffer_load_dwordx4 v10, s[24:27], s46 offen offset:256 lds
    s_add_u32 m0, m0, 3968
    v_mfma_f32_16x16x32_bf16 v[120:123], a[120:123], v[96:99], v[120:123]
    s_waitcnt lgkmcnt(2)
    v_mfma_f32_16x16x32_bf16 v[108:111], a[44:47], v[100:103], v[108:111]
    ds_read_b128 v[92:95], v12 offset:24576
    v_mfma_f32_16x16x32_bf16 v[112:115], a[44:47], v[104:107], v[112:115]
    ds_read_b128 v[96:99], v12 offset:26624
    v_mfma_f32_16x16x32_bf16 v[116:119], a[124:127], v[100:103], v[116:119]
    buffer_load_dwordx4 v10, s[24:27], s46 offen offset:384 lds
    s_add_u32 m0, m0, 3968
    v_mfma_f32_16x16x32_bf16 v[120:123], a[124:127], v[104:107], v[120:123]
    s_waitcnt lgkmcnt(2)
    v_mfma_f32_16x16x32_bf16 v[108:111], a[48:51], v[84:87], v[108:111]
    ds_read_b128 v[100:103], v11 offset:28672
    v_mfma_f32_16x16x32_bf16 v[112:115], a[48:51], v[88:91], v[112:115]
    ds_read_b128 v[104:107], v11 offset:30720
    v_mfma_f32_16x16x32_bf16 v[116:119], a[128:131], v[84:87], v[116:119]
    buffer_load_dwordx4 v10, s[24:27], s46 offen offset:512 lds
    s_add_u32 m0, m0, 3968
    v_mfma_f32_16x16x32_bf16 v[120:123], a[128:131], v[88:91], v[120:123]
    s_waitcnt lgkmcnt(2)
    v_mfma_f32_16x16x32_bf16 v[108:111], a[52:55], v[92:95], v[108:111]
    ds_read_b128 v[84:87], v12 offset:28672
    v_mfma_f32_16x16x32_bf16 v[112:115], a[52:55], v[96:99], v[112:115]
    ds_read_b128 v[88:91], v12 offset:30720
    v_mfma_f32_16x16x32_bf16 v[116:119], a[132:135], v[92:95], v[116:119]
    buffer_load_dwordx4 v10, s[24:27], s46 offen offset:640 lds
    s_add_u32 m0, m0, 3968
    v_mfma_f32_16x16x32_bf16 v[120:123], a[132:135], v[96:99], v[120:123]
    s_waitcnt lgkmcnt(2)
    v_mfma_f32_16x16x32_bf16 v[108:111], a[56:59], v[100:103], v[108:111]
    ds_read_b128 v[92:95], v11 offset:32768
    v_mfma_f32_16x16x32_bf16 v[112:115], a[56:59], v[104:107], v[112:115]
    ds_read_b128 v[96:99], v11 offset:34816
    v_mfma_f32_16x16x32_bf16 v[116:119], a[136:139], v[100:103], v[116:119]
    buffer_load_dwordx4 v10, s[24:27], s46 offen offset:768 lds
    s_add_u32 m0, m0, 3968
    v_mfma_f32_16x16x32_bf16 v[120:123], a[136:139], v[104:107], v[120:123]
    s_waitcnt lgkmcnt(2)
    v_mfma_f32_16x16x32_bf16 v[108:111], a[60:63], v[84:87], v[108:111]
    ds_read_b128 v[100:103], v12 offset:32768
    v_mfma_f32_16x16x32_bf16 v[112:115], a[60:63], v[88:91], v[112:115]
    ds_read_b128 v[104:107], v12 offset:34816
    v_mfma_f32_16x16x32_bf16 v[116:119], a[140:143], v[84:87], v[116:119]
    buffer_load_dwordx4 v10, s[24:27], s46 offen offset:896 lds
    s_add_u32 m0, m0, 3968
    v_mfma_f32_16x16x32_bf16 v[120:123], a[140:143], v[88:91], v[120:123]
    s_waitcnt lgkmcnt(2)
    v_mfma_f32_16x16x32_bf16 v[108:111], a[64:67], v[92:95], v[108:111]
    ds_read_b128 v[84:87], v11 offset:36864
    v_mfma_f32_16x16x32_bf16 v[112:115], a[64:67], v[96:99], v[112:115]
    ds_read_b128 v[88:91], v11 offset:38912
    v_mfma_f32_16x16x32_bf16 v[116:119], a[144:147], v[92:95], v[116:119]
    buffer_load_dwordx4 v10, s[24:27], s46 offen offset:1024 lds
    s_add_u32 m0, m0, 3968
    v_mfma_f32_16x16x32_bf16 v[120:123], a[144:147], v[96:99], v[120:123]
    s_waitcnt lgkmcnt(2)
    v_mfma_f32_16x16x32_bf16 v[108:111], a[68:71], v[100:103], v[108:111]
    ds_read_b128 v[92:95], v12 offset:36864
    v_mfma_f32_16x16x32_bf16 v[112:115], a[68:71], v[104:107], v[112:115]
    ds_read_b128 v[96:99], v12 offset:38912
    v_mfma_f32_16x16x32_bf16 v[116:119], a[148:151], v[100:103], v[116:119]
    buffer_load_dwordx4 v10, s[24:27], s46 offen offset:1152 lds
    v_mfma_f32_16x16x32_bf16 v[120:123], a[148:151], v[104:107], v[120:123]
    s_waitcnt lgkmcnt(0)
    v_mfma_f32_16x16x32_bf16 v[108:111], a[72:75], v[84:87], v[108:111]
    v_add_u32 v11, s49, v11
    v_mfma_f32_16x16x32_bf16 v[112:115], a[72:75], v[88:91], v[112:115]
    v_add_u32 v12, s49, v12
    v_mfma_f32_16x16x32_bf16 v[108:111], a[76:79], v[92:95], v[108:111]
    s_sub_u32 s47, s47, s49
    v_mfma_f32_16x16x32_bf16 v[112:115], a[76:79], v[96:99], v[112:115]
    s_sub_u32 s49, 0, s49
    v_mfma_f32_16x16x32_bf16 v[116:119], a[152:155], v[84:87], v[116:119]
    v_mfma_f32_16x16x32_bf16 v[120:123], a[152:155], v[88:91], v[120:123]
    v_mfma_f32_16x16x32_bf16 v[116:119], a[156:159], v[92:95], v[116:119]
    v_mfma_f32_16x16x32_bf16 v[120:123], a[156:159], v[96:99], v[120:123]
    v_cvt_pk_bf16_f32 v124, v108, v109
    v_cvt_pk_bf16_f32 v125, v110, v111
    v_cvt_pk_bf16_f32 v126, v112, v113
    v_cvt_pk_bf16_f32 v127, v114, v115
    s_nop 0
    v_permlane16_swap_b32 v124, v126
    v_permlane16_swap_b32 v125, v127
    v_cvt_pk_bf16_f32 v128, v116, v117
    v_cvt_pk_bf16_f32 v129, v118, v119
    v_cvt_pk_bf16_f32 v130, v120, v121
    v_cvt_pk_bf16_f32 v131, v122, v123
    s_nop 0
    v_permlane16_swap_b32 v128, v130
    v_permlane16_swap_b32 v129, v131
    buffer_store_dwordx4 v[124:127], v19, s[4:7], s44 offen
    buffer_store_dwordx4 v[128:131], v19, s[4:7], s45 offen
    s_waitcnt vmcnt(18)
    s_cmp_lt_i32 s60, 0
    s_cbranch_scc1 L_fin_29
    v_mfma_f32_16x16x32_bf16 v[164:167], a[160:163], v[156:159], 0
    v_mfma_f32_16x16x32_bf16 v[168:171], a[160:163], v[160:163], 0
    s_nop 4
    v_cndmask_b32 v166, v164, v165, s[58:59]
    s_nop 1
    v_cndmask_b32 v170, v168, v169, s[58:59]
    v_cndmask_b32 v167, v165, v164, s[58:59]
    v_cndmask_b32 v171, v169, v168, s[58:59]
    s_nop 0
    v_add_f32_dpp v167, v166, v167 row_ror:8 row_mask:0xf bank_mask:0xf
    v_add_f32_dpp v171, v170, v171 row_ror:8 row_mask:0xf bank_mask:0xf
    v_cvt_pk_bf16_f32 v167, v167, v167
    v_cvt_pk_bf16_f32 v171, v171, v171
    buffer_store_short v167, v145, s[28:31], s60 offen offset:0
    buffer_store_short v171, v145, s[28:31], s60 offen offset:32
L_fin_29:
    s_branch L_v_loop_f
L_end_24:
    s_cmp_lt_i32 s60, 0
    s_cselect_b32 s54, s38, s54
    buffer_load_dwordx4 v[156:159], v144, s[4:7], s54 offen offset:0 sc1
    buffer_load_dwordx4 v[160:163], v144, s[4:7], s54 offen offset:1024 sc1
    s_waitcnt vmcnt(0) lgkmcnt(0)
    s_cmp_lt_i32 s60, 0
    s_cbranch_scc1 L_fin_30
    v_mfma_f32_16x16x32_bf16 v[164:167], a[160:163], v[156:159], 0
    v_mfma_f32_16x16x32_bf16 v[168:171], a[160:163], v[160:163], 0
    s_nop 4
    v_cndmask_b32 v166, v164, v165, s[58:59]
    s_nop 1
    v_cndmask_b32 v170, v168, v169, s[58:59]
    v_cndmask_b32 v167, v165, v164, s[58:59]
    v_cndmask_b32 v171, v169, v168, s[58:59]
    s_nop 0
    v_add_f32_dpp v167, v166, v167 row_ror:8 row_mask:0xf bank_mask:0xf
    v_add_f32_dpp v171, v170, v171 row_ror:8 row_mask:0xf bank_mask:0xf
    v_cvt_pk_bf16_f32 v167, v167, v167
    v_cvt_pk_bf16_f32 v171, v171, v171
    buffer_store_short v167, v145, s[28:31], s60 offen offset:0
    buffer_store_short v171, v145, s[28:31], s60 offen offset:32
L_fin_30:
    s_waitcnt vmcnt(0)
    s_cmp_lg_u32 s55, 0
    s_cbranch_scc1 L_wb_31
    buffer_wbl2 sc1
    s_waitcnt vmcnt(0)
L_wb_31:
    s_endpgm
L_nan_22:
    s_cmp_eq_u32 s52, 1
    s_cbranch_scc1 L_cont_23
    v_lshlrev_b32 v1, 4, v0
L_nan_22r:
    s_mov_b32 s90, s41
    v_mov_b32 v2, 0
    buffer_load_dwordx4 v[28:31], v1, s[4:7], s90 offen sc1
    s_add_u32 s90, s90, 1024
    buffer_load_dwordx4 v[32:35], v1, s[4:7], s90 offen sc1
    s_add_u32 s90, s90, 1024
    buffer_load_dwordx4 v[36:39], v1, s[4:7], s90 offen sc1
    s_add_u32 s90, s90, 1024
    buffer_load_dwordx4 v[40:43], v1, s[4:7], s90 offen sc1
    s_add_u32 s90, s90, 1024
    buffer_load_dwordx4 v[44:47], v1, s[4:7], s90 offen sc1
    s_add_u32 s90, s90, 1024
    buffer_load_dwordx4 v[48:51], v1, s[4:7], s90 offen sc1
    s_add_u32 s90, s90, 1024
    buffer_load_dwordx4 v[52:55], v1, s[4:7], s90 offen sc1
    s_add_u32 s90, s90, 1024
    buffer_load_dwordx4 v[56:59], v1, s[4:7], s90 offen sc1
    s_add_u32 s90, s90, 1024
    buffer_load_dwordx4 v[60:63], v1, s[4:7], s90 offen sc1
    s_add_u32 s90, s90, 1024
    buffer_load_dwordx4 v[64:67], v1, s[4:7], s90 offen sc1
    s_add_u32 s90, s90, 1024
    s_sub_u32 s36, s36, 1
    s_cbranch_scc1 L_exit
    s_waitcnt vmcnt(0) lgkmcnt(0)
    v_max3_u32 v2, v2, v28, v29
    v_max3_u32 v2, v2, v30, v31
    v_max3_u32 v2, v2, v32, v33
    v_max3_u32 v2, v2, v34, v35
    v_max3_u32 v2, v2, v36, v37
    v_max3_u32 v2, v2, v38, v39
    v_max3_u32 v2, v2, v40, v41
    v_max3_u32 v2, v2, v42, v43
    v_max3_u32 v2, v2, v44, v45
    v_max3_u32 v2, v2, v46, v47
    v_max3_u32 v2, v2, v48, v49
    v_max3_u32 v2, v2, v50, v51
    v_max3_u32 v2, v2, v52, v53
    v_max3_u32 v2, v2, v54, v55
    v_max3_u32 v2, v2, v56, v57
    v_max3_u32 v2, v2, v58, v59
    v_max3_u32 v2, v2, v60, v61
    v_max3_u32 v2, v2, v62, v63
    v_max3_u32 v2, v2, v64, v65
    v_max3_u32 v2, v2, v66, v67
    v_cmp_eq_u32 vcc, -1, v2
    s_cbranch_vccnz L_nan_22r
    s_mov_b32 s52, 1
    v_mov_b32 v68, 0
    v_mov_b32 v69, 0
    v_mov_b32 v70, 0
    v_mov_b32 v71, 0
    v_mov_b32 v72, 0
    v_mov_b32 v73, 0
    v_mov_b32 v74, 0
    v_mov_b32 v75, 0
    v_smfmac_f32_16x16x64_bf16 v[68:71], v[28:31], a[0:7], v17
    s_nop 0
    v_smfmac_f32_16x16x64_bf16 v[72:75], v[28:31], a[80:87], v17
    v_smfmac_f32_16x16x64_bf16 v[68:71], v[32:35], a[8:15], v17
    v_smfmac_f32_16x16x64_bf16 v[72:75], v[32:35], a[88:95], v17
    v_smfmac_f32_16x16x64_bf16 v[68:71], v[36:39], a[16:23], v17
    v_smfmac_f32_16x16x64_bf16 v[72:75], v[36:39], a[96:103], v17
    v_smfmac_f32_16x16x64_bf16 v[68:71], v[40:43], a[24:31], v17
    v_smfmac_f32_16x16x64_bf16 v[72:75], v[40:43], a[104:111], v17
    v_smfmac_f32_16x16x64_bf16 v[68:71], v[44:47], a[32:39], v17
    v_smfmac_f32_16x16x64_bf16 v[72:75], v[44:47], a[112:119], v17
    v_smfmac_f32_16x16x64_bf16 v[68:71], v[48:51], a[40:47], v17
    v_smfmac_f32_16x16x64_bf16 v[68:71], v[52:55], a[48:55], v17
    v_smfmac_f32_16x16x64_bf16 v[68:71], v[56:59], a[56:63], v17
    v_smfmac_f32_16x16x64_bf16 v[68:71], v[60:63], a[64:71], v17
    v_smfmac_f32_16x16x64_bf16 v[68:71], v[64:67], a[72:79], v17
    s_nop 2
    s_branch L_redo_20
L_sd_25c:
    v_mov_b32 v3, 200
L_p0_32:
    buffer_load_dword v4, v3, s[8:11], 0 offen sc1
    s_sub_u32 s36, s36, 1
    s_cbranch_scc1 L_exit
    s_waitcnt vmcnt(0)
    v_readfirstlane_b32 s90, v4
    s_nop 0
    s_cmp_eq_u32 s90, 0
    s_cbranch_scc1 L_p0_32
    s_and_b32 s90, s90, 2
    s_lshl_b32 s90, s90, 12
    v_xor_b32 v140, s90, v140
    v_xor_b32 v141, s90, v141
    v_xor_b32 v143, s90, v143
    v_xor_b32 v144, s90, v144
    s_branch L_sd_25
L_fw_28c:
    v_mov_b32 v148, -1
    v_mov_b32 v149, -1
    v_mov_b32 v150, -1
    v_mov_b32 v151, -1
    v_mov_b32 v152, -1
    v_mov_b32 v153, -1
    v_mov_b32 v154, -1
    v_mov_b32 v155, -1
    s_add_u32 s53, s53, 2293760
    buffer_store_dwordx4 v[148:151], v143, s[4:7], s53 offen offset:0 sc1
    buffer_store_dwordx4 v[152:155], v143, s[4:7], s53 offen offset:1024 sc1
    s_sub_u32 s53, s53, 983040
    s_branch L_fw_28
L_wo_f:
    s_mov_b32 s12, s80
    s_and_b32 s13, s81, 0xffff
    s_mov_b32 s14, 7864320
    s_mov_b32 s15, 0x20000
    s_mov_b32 s16, s72
    s_and_b32 s17, s73, 0xffff
    s_mov_b32 s18, 10240
    s_mov_b32 s19, 0x20000
    s_sub_u32 s40, s35, 18
    v_and_b32 v1, 15, v0
    v_lshrrev_b32 v2, 4, v0
    v_lshrrev_b32 v3, 3, v0
    v_and_b32 v4, 7, v0
    v_and_b32 v6, 2, v3
    v_xor_b32 v6, v6, v4
    v_lshlrev_b32 v6, 4, v6
    v_mul_u32_u24 v7, 1280, v3
    s_lshl_b32 s90, s34, 2
    s_add_u32 s90, s90, s32
    s_mul_i32 s90, s90, 245760
    s_lshl_b32 s91, s40, 7
    s_add_u32 s90, s90, s91
    v_add3_u32 v180, v6, v7, s90
    v_xor_b32 v181, 64, v180
    s_mul_i32 s90, s40, 32768
    s_lshl_b32 s91, s32, 11
    s_add_u32 s90, s90, s91
    s_lshr_b32 s91, s32, 1
    s_mul_i32 s91, s91, 0
    s_xor_b32 s91, s91, s34
    v_mul_u32_u24 v7, 0, v2
    v_xor_b32 v7, s91, v7
    v_lshlrev_b32 v6, 4, v1
    v_lshl_add_u32 v7, v7, 8, v6
    v_lshl_add_u32 v7, v2, 13, v7
    v_add_u32 v14, s90, v7
    v_lshlrev_b32 v12, 4, v0
    v_lshlrev_b32 v13, 2, v0
    v_add_u32 v46, s90, v13
    s_xor_b32 s92, s91, 0
    s_lshl_b32 s92, s92, 8
    s_add_u32 s60, s92, 0
    s_xor_b32 s92, s91, 0
    s_lshl_b32 s92, s92, 8
    s_add_u32 s61, s92, 8192
    s_xor_b32 s92, s91, 0
    s_lshl_b32 s92, s92, 8
    s_add_u32 s62, s92, 16384
    s_xor_b32 s92, s91, 0
    s_lshl_b32 s92, s92, 8
    s_add_u32 s63, s92, 24576
    v_cmp_gt_u32 vcc, 2, v2
    v_mov_b32 v9, 2146435072
    s_nop 0
    v_cndmask_b32 v14, v9, v14, vcc
    s_lshl_b32 s92, s40, 7
    s_lshl_b32 s93, s32, 2
    s_add_u32 s92, s92, s93
    s_add_u32 s92, s92, 460800
    v_mov_b32 v244, s92
    v_cmp_eq_u32 vcc, 0, v0
    v_mov_b32 v9, 2146435072
    s_nop 0
    v_cndmask_b32 v244, v9, v244, vcc
    s_lshl_b32 s92, s32, 7
    s_add_u32 s92, s92, 462336
    v_min_u32 v3, 5, v0
    v_lshl_add_u32 v245, v3, 2, s92
    s_lshl_b32 s90, s40, 2
    s_add_u32 s90, s90, s32
    s_lshl_b32 s91, s90, 8
    v_add_u32 v17, s91, v6
    v_cmp_eq_u32 vcc, 0, v2
    v_mov_b32 v9, 2146435072
    s_nop 0
    v_cndmask_b32 v17, v9, v17, vcc
    v_lshrrev_b32 v3, 2, v1
    v_and_b32 v7, 1, v1
    v_lshl_or_b32 v4, v3, 1, v7
    v_mul_u32_u24 v4, 1280, v4
    v_and_b32 v5, 2, v1
    v_lshl_add_u32 v4, v5, 1, v4
    s_lshl_b32 s91, s90, 5
    v_add_u32 v4, s91, v4
    v_lshlrev_b32 v6, 6, v3
    v_lshl_add_u32 v6, v7, 5, v6
    v_lshl_add_u32 v6, v2, 3, v6
    v_lshl_add_u32 v6, v5, 1, v6
    s_mul_i32 s92, s32, 1152
    s_add_u32 s92, s92, 122880
    v_add_u32 v18, s92, v6
    buffer_load_dword v164, v4, s[16:19], 0 offen offset:0
    buffer_load_dword v165, v4, s[16:19], 0 offen offset:8
    buffer_load_dword v166, v4, s[16:19], 0 offen offset:16
    buffer_load_dword v167, v4, s[16:19], 0 offen offset:24
    v_mov_b32 v168, -1
    v_mov_b32 v169, -1
    v_mov_b32 v170, -1
    v_mov_b32 v171, -1
    s_mul_i32 s90, s32, 24576
    s_mov_b32 m0, s90
    s_mov_b32 s91, 0
    buffer_load_dwordx4 v180, s[12:15], s91 offen nt lds
    s_add_u32 m0, m0, 1024
    s_add_u32 s91, s91, 10240
    buffer_load_dwordx4 v181, s[12:15], s91 offen nt lds
    s_add_u32 m0, m0, 1024
    s_add_u32 s91, s91, 10240
    buffer_load_dwordx4 v180, s[12:15], s91 offen nt lds
    s_add_u32 m0, m0, 1024
    s_add_u32 s91, s91, 10240
    buffer_load_dwordx4 v181, s[12:15], s91 offen nt lds
    s_add_u32 m0, m0, 1024
    s_add_u32 s91, s91, 10240
    buffer_load_dwordx4 v180, s[12:15], s91 offen nt lds
    s_add_u32 m0, m0, 1024
    s_add_u32 s91, s91, 10240
    buffer_load_dwordx4 v181, s[12:15], s91 offen nt lds
    s_add_u32 m0, m0, 1024
    s_add_u32 s91, s91, 10240
    buffer_load_dwordx4 v180, s[12:15], s91 offen nt lds
    s_add_u32 m0, m0, 1024
    s_add_u32 s91, s91, 10240
    buffer_load_dwordx4 v181, s[12:15], s91 offen nt lds
    s_add_u32 m0, m0, 1024
    s_add_u32 s91, s91, 10240
    buffer_load_dwordx4 v180, s[12:15], s91 offen nt lds
    s_add_u32 m0, m0, 1024
    s_add_u32 s91, s91, 10240
    buffer_load_dwordx4 v181, s[12:15], s91 offen nt lds
    s_add_u32 m0, m0, 1024
    s_add_u32 s91, s91, 10240
    buffer_load_dwordx4 v180, s[12:15], s91 offen nt lds
    s_add_u32 m0, m0, 1024
    s_add_u32 s91, s91, 10240
    buffer_load_dwordx4 v181, s[12:15], s91 offen nt lds
    s_add_u32 m0, m0, 1024
    s_add_u32 s91, s91, 10240
    buffer_load_dwordx4 v180, s[12:15], s91 offen nt lds
    s_add_u32 m0, m0, 1024
    s_add_u32 s91, s91, 10240
    buffer_load_dwordx4 v181, s[12:15], s91 offen nt lds
    s_add_u32 m0, m0, 1024
    s_add_u32 s91, s91, 10240
    buffer_load_dwordx4 v180, s[12:15], s91 offen nt lds
    s_add_u32 m0, m0, 1024
    s_add_u32 s91, s91, 10240
    buffer_load_dwordx4 v181, s[12:15], s91 offen nt lds
    s_add_u32 m0, m0, 1024
    s_add_u32 s91, s91, 10240
    buffer_load_dwordx4 v180, s[12:15], s91 offen nt lds
    s_add_u32 m0, m0, 1024
    s_add_u32 s91, s91, 10240
    buffer_load_dwordx4 v181, s[12:15], s91 offen nt lds
    s_add_u32 m0, m0, 1024
    s_add_u32 s91, s91, 10240
    buffer_load_dwordx4 v180, s[12:15], s91 offen nt lds
    s_add_u32 m0, m0, 1024
    s_add_u32 s91, s91, 10240
    buffer_load_dwordx4 v181, s[12:15], s91 offen nt lds
    s_add_u32 m0, m0, 1024
    s_add_u32 s91, s91, 10240
    buffer_load_dwordx4 v180, s[12:15], s91 offen nt lds
    s_add_u32 m0, m0, 1024
    s_add_u32 s91, s91, 10240
    buffer_load_dwordx4 v181, s[12:15], s91 offen nt lds
    s_add_u32 m0, m0, 1024
    s_add_u32 s91, s91, 10240
    buffer_load_dwordx4 v180, s[12:15], s91 offen nt lds
    s_add_u32 m0, m0, 1024
    s_add_u32 s91, s91, 10240
    buffer_load_dwordx4 v181, s[12:15], s91 offen nt lds
    s_waitcnt vmcnt(24)
    v_min_u32 v164, -2, v164
    v_min_u32 v165, -2, v165
    v_min_u32 v166, -2, v166
    v_min_u32 v167, -2, v167
    v_and_b32 v7, 2, v1
    v_cmp_ne_u32 vcc, 0, v7
    v_mov_b32 v5, 0x4444
    v_mov_b32 v6, 0xeeee
    v_cndmask_b32 v10, v5, v6, vcc
    v_mov_b32 v5, 0xe484
    v_mov_b32 v6, 0xee9e
    v_cndmask_b32 v7, v5, v6, vcc
    v_mov_b32 v5, 0x84e4
    v_mov_b32 v6, 0x9eee
    v_cndmask_b32 v8, v5, v6, vcc
    v_cmp_gt_u32 vcc, 2, v2
    s_nop 1
    v_cndmask_b32 v11, v8, v7, vcc
    v_mov_b32 v84, 1065369472
    v_mov_b32 v85, 1065369472
    v_mov_b32 v86, 1065369472
    v_mov_b32 v87, 0
    v_mov_b32 v88, 1065369472
    v_mov_b32 v89, 1065369472
    v_mov_b32 v90, 1065369472
    v_mov_b32 v91, 0
    v_mov_b32 v51, 0
    v_mov_b32 v55, 0
    v_mov_b32 v59, 0
    v_mov_b32 v63, 0
    v_mov_b32 v67, 0
    v_mov_b32 v71, 0
    v_mov_b32 v75, 0
    v_mov_b32 v79, 0
    v_mov_b32 v210, 0
    v_mov_b32 v211, 0
    v_mov_b32 v218, 0
    v_mov_b32 v219, 0
    v_and_b32 v7, 1, v1
    v_cmp_ne_u32 vcc, 0, v7
    v_mov_b32 v5, 0x3f80
    v_mov_b32 v6, 0x3f800000
    v_cndmask_b32 v5, v5, v6, vcc
    v_bfe_u32 v6, v1, 1, 1
    v_cmp_eq_u32 vcc, 0, v6
    s_nop 1
    v_cndmask_b32 v110, 0, v5, vcc
    v_mov_b32 v108, 0
    v_mov_b32 v112, 0
    v_cmp_eq_u32 vcc, 1, v6
    s_nop 1
    v_cndmask_b32 v111, 0, v5, vcc
    v_mov_b32 v109, 0
    v_mov_b32 v113, 0
    v_mov_b32 v240, 0x3dd53b95
    v_mov_b32 v241, 0x3dd53b95
    s_lshl_b32 s90, s32, 8
    s_add_u32 s90, s90, 122880
    v_mul_u32_u24 v6, 1152, v2
    v_lshl_add_u32 v6, v1, 3, v6
    v_add_u32 v19, s90, v6
    s_mul_i32 s90, s32, 1536
    v_add_u32 v20, s90, v12
    s_add_u32 s90, s90, 1024
    v_lshl_add_u32 v21, v0, 3, s90
    s_mul_i32 s90, s32, 6144
    v_add_u32 v22, s90, v12
    s_add_u32 s90, s90, 1024
    v_lshl_add_u32 v23, v0, 3, s90
    v_add_u32 v28, 98304, v12
    s_mul_i32 s90, s32, 3072
    v_add_u32 v37, s90, v12
    v_add_u32 v44, 25600, v37
    s_add_u32 s54, s90, 98304
    s_mul_i32 s90, s32, 3840
    s_add_u32 s90, s90, 10240
    v_add_u32 v38, s90, v12
    s_add_u32 s90, s90, 1024
    v_add_u32 v39, s90, v13
    s_mul_i32 s90, s32, 12288
    v_add_u32 v40, s90, v12
    s_lshl_b32 s93, s40, 2
    s_add_u32 s93, s93, s32
    s_nop 0
    s_lshr_b32 s90, s93, 2
    s_lshl_b32 s90, s90, 15
    s_and_b32 s92, s93, 3
    s_lshl_b32 s92, s92, 10
    s_add_u32 s90, s90, s92
    v_mov_b32 v5, s34
    v_and_b32 v6, 7, v1
    v_lshlrev_b32 v6, 4, v6
    v_lshl_add_u32 v6, v5, 7, v6
    v_lshrrev_b32 v7, 3, v1
    v_lshl_add_u32 v6, v7, 12, v6
    v_lshrrev_b32 v5, 1, v2
    v_lshl_add_u32 v6, v5, 13, v6
    v_and_b32 v5, 1, v2
    v_lshl_add_u32 v6, v5, 14, v6
    v_add_u32 v30, s90, v6
    s_and_b32 s91, s34, 1
    s_lshl_b32 s91, s91, 12
    s_add_u32 s90, s90, s91
    s_lshr_b32 s91, s34, 2
    s_lshl_b32 s91, s91, 13
    s_add_u32 s90, s90, s91
    s_and_b32 s91, s34, 2
    s_lshl_b32 s91, s91, 13
    s_add_u32 s90, s90, s91
    v_lshl_add_u32 v31, v0, 4, s90
    s_lshl_b32 s91, s93, 10
    s_add_u32 s91, s91, 884736
    v_lshl_add_u32 v15, v0, 4, s91
    s_lshr_b32 s91, s34, 1
    s_mul_i32 s91, s91, 10240
    s_lshl_b32 s92, s93, 5
    s_add_u32 s91, s91, s92
    s_and_b32 s92, s34, 1
    s_mul_i32 s92, s92, 40960
    s_add_u32 s91, s91, s92
    s_add_u32 s91, s91, 1280
    v_mul_u32_u24 v6, 2560, v2
    v_lshl_add_u32 v6, v1, 1, v6
    v_add_u32 v32, s91, v6
    v_cmp_gt_u32 s[58:59], 8, v1
    v_and_b32 v5, 1, v1
    v_lshrrev_b32 v6, 3, v1
    v_lshl_add_u32 v5, v5, 1, v6
    v_bfe_u32 v6, v1, 2, 1
    v_cmp_ne_u32 vcc, 0, v6
    v_mov_b32 v6, 0x3f80
    v_mov_b32 v7, 0x3f800000
    v_cndmask_b32 v6, v6, v7, vcc
    v_cmp_eq_u32 vcc, 0, v5
    s_nop 1
    v_cndmask_b32 v7, 0, v6, vcc
    v_accvgpr_write_b32 a144, v7
    v_cmp_eq_u32 vcc, 1, v5
    s_nop 1
    v_cndmask_b32 v7, 0, v6, vcc
    v_accvgpr_write_b32 a145, v7
    v_cmp_eq_u32 vcc, 2, v5
    s_nop 1
    v_cndmask_b32 v7, 0, v6, vcc
    v_accvgpr_write_b32 a146, v7
    v_cmp_eq_u32 vcc, 3, v5
    s_nop 1
    v_cndmask_b32 v7, 0, v6, vcc
    v_accvgpr_write_b32 a147, v7
    s_lshl_b32 s90, s32, 7
    v_add_u32 v5, s90, v13
    v_add_u32 v6, 458752, v5
    v_add_u32 v7, 459728, v5
    v_cmp_gt_u32 vcc, 12, v0
    s_nop 1
    v_cndmask_b32 v33, v7, v6, vcc
    v_mov_b32 v5, -2
    v_cndmask_b32 v34, v5, 3, vcc
    v_cmp_gt_u32 vcc, 14, v0
    v_mov_b32 v9, 2146435072
    s_nop 0
    v_cndmask_b32 v33, v9, v33, vcc
    v_mov_b32 v5, -1000
    v_cndmask_b32 v34, v5, v34, vcc
    v_and_b32 v4, 3, v1
    v_lshlrev_b32 v6, 6, v4
    v_lshl_add_u32 v6, v3, 3, v6
    v_lshl_add_u32 v6, v2, 8, v6
    v_and_b32 v5, 1, v2
    v_lshl_add_u32 v6, v5, 5, v6
    s_mul_i32 s90, s32, 3072
    s_add_u32 s53, s90, 131072
    v_add_u32 v16, s53, v6
    v_xor_b32 v13, 32, v16
    v_and_b32 v4, 3, v1
    v_and_b32 v5, 1, v2
    v_lshl_add_u32 v6, v2, 3, v3
    v_lshlrev_b32 v6, 7, v6
    v_and_b32 v7, 2, v3
    v_lshl_or_b32 v7, v5, 2, v7
    v_lshrrev_b32 v8, 1, v4
    v_xor_b32 v7, v7, v8
    v_lshl_add_u32 v6, v7, 4, v6
    v_and_b32 v7, 1, v4
    v_lshl_add_u32 v6, v7, 3, v6
    s_mul_i32 s90, s32, 24576
    v_add_u32 v6, s90, v6
    v_xor_b32 v182, 0, v6
    v_xor_b32 v183, 32, v6
    v_xor_b32 v184, 64, v6
    v_xor_b32 v185, 96, v6
    s_waitcnt vmcnt(0)
    ds_read_b64_tr_b16 a[0:1], v182 offset:0
    ds_read_b64_tr_b16 a[2:3], v182 offset:512
    ds_read_b64_tr_b16 a[4:5], v182 offset:4096
    ds_read_b64_tr_b16 a[6:7], v182 offset:4608
    ds_read_b64_tr_b16 a[8:9], v182 offset:8192
    ds_read_b64_tr_b16 a[10:11], v182 offset:8704
    ds_read_b64_tr_b16 a[12:13], v182 offset:12288
    ds_read_b64_tr_b16 a[14:15], v182 offset:12800
    ds_read_b64_tr_b16 a[16:17], v182 offset:16384
    ds_read_b64_tr_b16 a[18:19], v182 offset:16896
    ds_read_b64_tr_b16 a[20:21], v182 offset:20480
    ds_read_b64_tr_b16 a[22:23], v182 offset:20992
    ds_read_b64_tr_b16 a[24:25], v183 offset:0
    ds_read_b64_tr_b16 a[26:27], v183 offset:512
    ds_read_b64_tr_b16 a[28:29], v183 offset:4096
    ds_read_b64_tr_b16 a[30:31], v183 offset:4608
    ds_read_b64_tr_b16 a[32:33], v183 offset:8192
    ds_read_b64_tr_b16 a[34:35], v183 offset:8704
    ds_read_b64_tr_b16 a[36:37], v183 offset:12288
    ds_read_b64_tr_b16 a[38:39], v183 offset:12800
    ds_read_b64_tr_b16 a[40:41], v183 offset:16384
    ds_read_b64_tr_b16 a[42:43], v183 offset:16896
    ds_read_b64_tr_b16 a[44:45], v183 offset:20480
    ds_read_b64_tr_b16 a[46:47], v183 offset:20992
    ds_read_b64_tr_b16 a[48:49], v184 offset:0
    ds_read_b64_tr_b16 a[50:51], v184 offset:512
    ds_read_b64_tr_b16 a[52:53], v184 offset:4096
    ds_read_b64_tr_b16 a[54:55], v184 offset:4608
    ds_read_b64_tr_b16 a[56:57], v184 offset:8192
    ds_read_b64_tr_b16 a[58:59], v184 offset:8704
    ds_read_b64_tr_b16 a[60:61], v184 offset:12288
    ds_read_b64_tr_b16 a[62:63], v184 offset:12800
    ds_read_b64_tr_b16 a[64:65], v184 offset:16384
    ds_read_b64_tr_b16 a[66:67], v184 offset:16896
    ds_read_b64_tr_b16 a[68:69], v184 offset:20480
    ds_read_b64_tr_b16 a[70:71], v184 offset:20992
    ds_read_b64_tr_b16 a[72:73], v185 offset:0
    ds_read_b64_tr_b16 a[74:75], v185 offset:512
    ds_read_b64_tr_b16 a[76:77], v185 offset:4096
    ds_read_b64_tr_b16 a[78:79], v185 offset:4608
    ds_read_b64_tr_b16 a[80:81], v185 offset:8192
    ds_read_b64_tr_b16 a[82:83], v185 offset:8704
    ds_read_b64_tr_b16 a[84:85], v185 offset:12288
    ds_read_b64_tr_b16 a[86:87], v185 offset:12800
    ds_read_b64_tr_b16 a[88:89], v185 offset:16384
    ds_read_b64_tr_b16 a[90:91], v185 offset:16896
    ds_read_b64_tr_b16 a[92:93], v185 offset:20480
    ds_read_b64_tr_b16 a[94:95], v185 offset:20992
    s_waitcnt lgkmcnt(0)
    s_barrier
    v_mov_b32 v1, 192
L_gw_33:
    buffer_load_dword v2, v1, s[8:11], 0 offen sc1
    s_sub_u32 s36, s36, 1
    s_cbranch_scc1 L_exit
    s_waitcnt vmcnt(0)
L_gw_33c:
    v_readfirstlane_b32 s90, v2
    s_nop 0
    s_cmp_eq_u32 s90, 0
    s_cbranch_scc1 L_gw_33
    s_cmp_lg_u32 s90, 1
    s_cbranch_scc1 L_slow
    buffer_store_dwordx4 v[164:167], v17, s[4:7], s38 offen
    s_mov_b32 s37, -1
    v_add_u32 v35, -2, v34
    s_add_u32 s45, s38, 65536
    s_add_u32 s46, s45, 4096
    s_add_u32 s47, s45, 8192
    v_mov_b32 v24, v20
    v_mov_b32 v25, v21
    buffer_load_dword v36, v33, s[4:7], s38 offen sc1
    s_waitcnt vmcnt(0)
    v_cmp_lt_i32 vcc, v36, v35
    s_cbranch_vccz L_fok_35
L_fw_34:
    buffer_load_dword v36, v33, s[4:7], s38 offen sc1
    s_sub_u32 s36, s36, 1
    s_cbranch_scc1 L_exit
    s_waitcnt vmcnt(0)
    v_cmp_lt_i32 vcc, v36, v35
    s_cbranch_vccnz L_fw_34
L_fok_35:
    buffer_load_dwordx4 a[96:99], v40, s[4:7], s45 offen offset:0 sc1
    buffer_load_dwordx4 a[100:103], v40, s[4:7], s45 offen offset:1024 sc1
    buffer_load_dwordx4 a[104:107], v40, s[4:7], s45 offen offset:2048 sc1
    buffer_load_dwordx4 a[108:111], v40, s[4:7], s45 offen offset:3072 sc1
    buffer_load_dwordx4 a[112:115], v40, s[4:7], s46 offen offset:0 sc1
    buffer_load_dwordx4 a[116:119], v40, s[4:7], s46 offen offset:1024 sc1
    buffer_load_dwordx4 a[120:123], v40, s[4:7], s46 offen offset:2048 sc1
    buffer_load_dwordx4 a[124:127], v40, s[4:7], s46 offen offset:3072 sc1
    buffer_load_dwordx4 a[128:131], v40, s[4:7], s47 offen offset:0 sc1
    buffer_load_dwordx4 a[132:135], v40, s[4:7], s47 offen offset:1024 sc1
    buffer_load_dwordx4 a[136:139], v40, s[4:7], s47 offen offset:2048 sc1
    buffer_load_dwordx4 a[140:143], v40, s[4:7], s47 offen offset:3072 sc1
    s_waitcnt vmcnt(0)
    v_mfma_f32_16x16x32_bf16 v[148:151], a[96:99], a[0:3], 0
    v_mfma_f32_16x16x32_bf16 v[152:155], a[120:123], a[0:3], 0
    v_mfma_f32_16x16x32_bf16 v[156:159], a[96:99], a[24:27], 0
    v_mfma_f32_16x16x32_bf16 v[160:163], a[120:123], a[24:27], 0
    v_mfma_f32_16x16x32_bf16 v[180:183], a[96:99], a[48:51], 0
    v_mfma_f32_16x16x32_bf16 v[184:187], a[120:123], a[48:51], 0
    v_mfma_f32_16x16x32_bf16 v[188:191], a[96:99], a[72:75], 0
    v_mfma_f32_16x16x32_bf16 v[192:195], a[120:123], a[72:75], 0
    v_mfma_f32_16x16x32_bf16 v[148:151], a[100:103], a[4:7], v[148:151]
    v_mfma_f32_16x16x32_bf16 v[152:155], a[124:127], a[4:7], v[152:155]
    v_mfma_f32_16x16x32_bf16 v[156:159], a[100:103], a[28:31], v[156:159]
    v_mfma_f32_16x16x32_bf16 v[160:163], a[124:127], a[28:31], v[160:163]
    v_mfma_f32_16x16x32_bf16 v[180:183], a[100:103], a[52:55], v[180:183]
    v_mfma_f32_16x16x32_bf16 v[184:187], a[124:127], a[52:55], v[184:187]
    v_mfma_f32_16x16x32_bf16 v[188:191], a[100:103], a[76:79], v[188:191]
    v_mfma_f32_16x16x32_bf16 v[192:195], a[124:127], a[76:79], v[192:195]
    v_mfma_f32_16x16x32_bf16 v[148:151], a[104:107], a[8:11], v[148:151]
    v_mfma_f32_16x16x32_bf16 v[152:155], a[128:131], a[8:11], v[152:155]
    v_mfma_f32_16x16x32_bf16 v[156:159], a[104:107], a[32:35], v[156:159]
    v_mfma_f32_16x16x32_bf16 v[160:163], a[128:131], a[32:35], v[160:163]
    v_mfma_f32_16x16x32_bf16 v[180:183], a[104:107], a[56:59], v[180:183]
    v_mfma_f32_16x16x32_bf16 v[184:187], a[128:131], a[56:59], v[184:187]
    v_mfma_f32_16x16x32_bf16 v[188:191], a[104:107], a[80:83], v[188:191]
    v_mfma_f32_16x16x32_bf16 v[192:195], a[128:131], a[80:83], v[192:195]
    v_mfma_f32_16x16x32_bf16 v[148:151], a[108:111], a[12:15], v[148:151]
    v_mfma_f32_16x16x32_bf16 v[152:155], a[132:135], a[12:15], v[152:155]
    v_mfma_f32_16x16x32_bf16 v[156:159], a[108:111], a[36:39], v[156:159]
    v_mfma_f32_16x16x32_bf16 v[160:163], a[132:135], a[36:39], v[160:163]
    v_mfma_f32_16x16x32_bf16 v[180:183], a[108:111], a[60:63], v[180:183]
    v_mfma_f32_16x16x32_bf16 v[184:187], a[132:135], a[60:63], v[184:187]
    v_mfma_f32_16x16x32_bf16 v[188:191], a[108:111], a[84:87], v[188:191]
    v_mfma_f32_16x16x32_bf16 v[192:195], a[132:135], a[84:87], v[192:195]
    v_mfma_f32_16x16x32_bf16 v[148:151], a[112:115], a[16:19], v[148:151]
    v_mfma_f32_16x16x32_bf16 v[152:155], a[136:139], a[16:19], v[152:155]
    v_mfma_f32_16x16x32_bf16 v[156:159], a[112:115], a[40:43], v[156:159]
    v_mfma_f32_16x16x32_bf16 v[160:163], a[136:139], a[40:43], v[160:163]
    v_mfma_f32_16x16x32_bf16 v[180:183], a[112:115], a[64:67], v[180:183]
    v_mfma_f32_16x16x32_bf16 v[184:187], a[136:139], a[64:67], v[184:187]
    v_mfma_f32_16x16x32_bf16 v[188:191], a[112:115], a[88:91], v[188:191]
    v_mfma_f32_16x16x32_bf16 v[192:195], a[136:139], a[88:91], v[192:195]
    v_mfma_f32_16x16x32_bf16 v[148:151], a[116:119], a[20:23], v[148:151]
    v_mfma_f32_16x16x32_bf16 v[152:155], a[140:143], a[20:23], v[152:155]
    v_mfma_f32_16x16x32_bf16 v[156:159], a[116:119], a[44:47], v[156:159]
    v_mfma_f32_16x16x32_bf16 v[160:163], a[140:143], a[44:47], v[160:163]
    v_mfma_f32_16x16x32_bf16 v[180:183], a[116:119], a[68:71], v[180:183]
    v_mfma_f32_16x16x32_bf16 v[184:187], a[140:143], a[68:71], v[184:187]
    v_mfma_f32_16x16x32_bf16 v[188:191], a[116:119], a[92:95], v[188:191]
    v_mfma_f32_16x16x32_bf16 v[192:195], a[140:143], a[92:95], v[192:195]
    v_cvt_pk_bf16_f32 v64, v180, v181
    v_cvt_pk_bf16_f32 v65, v182, v183
    ds_write_b64 v24, v[64:65] offset:12288
    v_cvt_pk_bf16_f32 v68, v184, v185
    v_cvt_pk_bf16_f32 v69, v186, v187
    ds_write_b64 v25, v[68:69] offset:12288
    v_cvt_pk_bf16_f32 v72, v188, v189
    v_cvt_pk_bf16_f32 v73, v190, v191
    ds_write_b64 v24, v[72:73] offset:18432
    v_cvt_pk_bf16_f32 v76, v192, v193
    v_cvt_pk_bf16_f32 v77, v194, v195
    ds_write_b64 v25, v[76:77] offset:18432
    v_cvt_pk_bf16_f32 v48, v148, v149
    v_cvt_pk_bf16_f32 v49, v150, v151
    ds_write_b64 v24, v[48:49] offset:0
    v_cvt_pk_bf16_f32 v52, v152, v153
    v_cvt_pk_bf16_f32 v53, v154, v155
    ds_write_b64 v25, v[52:53] offset:0
    v_cvt_pk_bf16_f32 v56, v156, v157
    v_cvt_pk_bf16_f32 v57, v158, v159
    ds_write_b64 v24, v[56:57] offset:6144
    v_cvt_pk_bf16_f32 v60, v160, v161
    v_cvt_pk_bf16_f32 v61, v162, v163
    ds_write_b64 v25, v[60:61] offset:6144
    s_add_u32 s56, s37, 2
    s_and_b32 s55, s56, 3
    s_mul_i32 s55, s55, 114688
    s_add_u32 s55, s55, 65536
    s_add_u32 s45, s38, s55
    s_add_u32 s46, s45, 4096
    s_add_u32 s47, s45, 8192
    s_add_u32 s56, s37, -1
    s_and_b32 s55, s56, 3
    s_mul_i32 s55, s55, 114688
    s_add_u32 s55, s55, 53248
    s_add_u32 s48, s38, s55
    s_and_b32 s55, s56, 1
    s_add_u32 s56, s56, 1
    v_mov_b32 v35, -16
    v_writelane_b32 v35, s56, 12
    s_mul_i32 s55, s55, 12288
    s_add_u32 m0, s54, s55
    v_add_u32 v35, -1, v34
    buffer_load_dword v36, v33, s[4:7], s38 offen sc1
    s_waitcnt vmcnt(0)
    v_cmp_lt_i32 vcc, v36, v35
    s_cbranch_vccz L_fok_37
L_fw_36:
    buffer_load_dword v36, v33, s[4:7], s38 offen sc1
    s_sub_u32 s36, s36, 1
    s_cbranch_scc1 L_exit
    s_waitcnt vmcnt(0)
    v_cmp_lt_i32 vcc, v36, v35
    s_cbranch_vccnz L_fw_36
L_fok_37:
    buffer_load_dwordx4 a[96:99], v40, s[4:7], s45 offen offset:0 sc1
    buffer_load_dwordx4 a[100:103], v40, s[4:7], s45 offen offset:1024 sc1
    buffer_load_dwordx4 a[104:107], v40, s[4:7], s45 offen offset:2048 sc1
    buffer_load_dwordx4 a[108:111], v40, s[4:7], s45 offen offset:3072 sc1
    buffer_load_dwordx4 a[112:115], v40, s[4:7], s46 offen offset:0 sc1
    buffer_load_dwordx4 a[116:119], v40, s[4:7], s46 offen offset:1024 sc1
    buffer_load_dwordx4 a[120:123], v40, s[4:7], s46 offen offset:2048 sc1
    buffer_load_dwordx4 a[124:127], v40, s[4:7], s46 offen offset:3072 sc1
    buffer_load_dwordx4 a[128:131], v40, s[4:7], s47 offen offset:0 sc1
    buffer_load_dwordx4 a[132:135], v40, s[4:7], s47 offen offset:1024 sc1
    buffer_load_dwordx4 a[136:139], v40, s[4:7], s47 offen offset:2048 sc1
    buffer_load_dwordx4 a[140:143], v40, s[4:7], s47 offen offset:3072 sc1
    s_mov_b32 s50, s42
    s_add_u32 s56, s37, 1
    v_mov_b32 v47, v24
    s_and_b32 s55, s56, 3
    s_mul_i32 s41, s55, 327680
    s_mul_i32 s56, s55, 114688
    s_add_u32 s43, s38, s56
    s_xor_b32 s55, s55, 2
    s_mul_i32 s42, s55, 327680
    s_add_u32 s56, s37, 2
    v_mov_b32 v107, s56
    s_and_b32 s55, s56, 3
    s_mul_i32 s44, s55, 24576
    s_add_u32 s56, s37, -1
    s_and_b32 s55, s56, 3
    s_mul_i32 s55, s55, 40960
    s_add_u32 s49, s55, s38
    s_add_u32 s56, s37, -1
    s_and_b32 s55, s56, 3
    s_mul_i32 s55, s55, 24576
    v_add_u32 v26, s55, v22
    v_add_u32 v27, s55, v23
    s_and_b32 s55, s56, 1
    s_mul_i32 s55, s55, 12288
    v_add_u32 v29, s55, v28
    s_add_u32 s37, s37, 1
    s_mov_b32 m0, s53
    v_add_u32 v24, s44, v20
    v_add_u32 v25, s44, v21
    v_pk_mul_f32 v[148:149], v[210:211], v[210:211]
    v_pk_mul_f32 v[150:151], v[210:211], v[210:211]
    v_pk_mul_f32 v[152:153], v[210:211], v[210:211]
    v_pk_mul_f32 v[154:155], v[210:211], v[210:211]
    v_pk_mul_f32 v[156:157], v[210:211], v[210:211]
    v_pk_mul_f32 v[158:159], v[210:211], v[210:211]
    v_pk_mul_f32 v[160:161], v[210:211], v[210:211]
    v_pk_mul_f32 v[162:163], v[210:211], v[210:211]
    v_mov_b32 v120, 0
    v_mov_b32 v121, 0
    v_mov_b32 v122, 0
    v_mov_b32 v123, 0
    v_mov_b32 v124, 0
    v_mov_b32 v125, 0
    v_mov_b32 v126, 0
    v_mov_b32 v127, 0
    v_mov_b32 v128, 0
    v_mov_b32 v129, 0
    v_mov_b32 v130, 0
    v_mov_b32 v131, 0
    v_mov_b32 v132, 0
    v_mov_b32 v133, 0
    v_mov_b32 v134, 0
    v_mov_b32 v135, 0
    v_mov_b32 v116, 0
    v_mov_b32 v117, 0
    v_mov_b32 v118, 0
    v_mov_b32 v119, 0
L_wo_loop_f:
    buffer_load_dword v41, v245, s[4:7], s38 offen sc1
    buffer_load_dword v41, v245, s[4:7], s38 offen sc1
    buffer_load_dword v41, v245, s[4:7], s38 offen sc1
    buffer_load_dword v41, v245, s[4:7], s38 offen sc1
    buffer_load_dword v41, v245, s[4:7], s38 offen sc1
    buffer_load_dword v41, v245, s[4:7], s38 offen sc1
L_sp_41:
    s_waitcnt vmcnt(5)
    v_cmp_ge_u32 vcc, s37, v41
    buffer_load_dword v41, v245, s[4:7], s38 offen sc1
    s_sub_u32 s36, s36, 1
    s_cbranch_scc1 L_exit
    s_cbranch_vccz L_sp_41x
    s_waitcnt vmcnt(5)
    v_cmp_ge_u32 vcc, s37, v41
    buffer_load_dword v41, v245, s[4:7], s38 offen sc1
    s_cbranch_vccz L_sp_41x
    s_waitcnt vmcnt(5)
    v_cmp_ge_u32 vcc, s37, v41
    buffer_load_dword v41, v245, s[4:7], s38 offen sc1
    s_cbranch_vccz L_sp_41x
    s_waitcnt vmcnt(5)
    v_cmp_ge_u32 vcc, s37, v41
    buffer_load_dword v41, v245, s[4:7], s38 offen sc1
    s_cbranch_vccnz L_sp_41
L_sp_41x:
    buffer_load_dwordx4 v44, s[4:7], s43 offen offset:0 sc1 lds
    buffer_load_dwordx4 v44, s[4:7], s43 offen offset:1024 sc1 lds
    buffer_load_dwordx4 v44, s[4:7], s43 offen offset:2048 sc1 lds
    s_waitcnt vmcnt(2)
    ds_read_b64_tr_b16 v[136:137], v16 offset:0
    ds_read_b64_tr_b16 v[138:139], v13 offset:0
    s_waitcnt vmcnt(1)
    ds_read_b64_tr_b16 v[140:141], v16 offset:1024
    ds_read_b64_tr_b16 v[142:143], v13 offset:1024
    s_waitcnt vmcnt(0)
    ds_read_b64_tr_b16 v[144:145], v16 offset:2048
    ds_read_b64_tr_b16 v[146:147], v13 offset:2048
    buffer_load_dwordx4 v[92:95], v38, s[4:7], s43 offen offset:0 sc1
    buffer_load_dwordx4 v[96:99], v38, s[4:7], s43 offen offset:1280 sc1
    buffer_load_dwordx4 v[100:103], v38, s[4:7], s43 offen offset:2560 sc1
    s_cmp_eq_u32 s37, 63
    s_waitcnt lgkmcnt(4)
    v_smfmac_f32_16x16x64_bf16 v[148:151], v[136:139], a[0:7], v10
    v_smfmac_f32_16x16x64_bf16 v[152:155], v[136:139], a[24:31], v10
    v_smfmac_f32_16x16x64_bf16 v[156:159], v[136:139], a[48:55], v10
    buffer_load_dword v104, v39, s[4:7], s43 offen offset:0 sc1
    v_smfmac_f32_16x16x64_bf16 v[160:163], v[136:139], a[72:79], v10
    buffer_load_dword v105, v39, s[4:7], s43 offen offset:1280 sc1
    s_waitcnt lgkmcnt(2)
    v_smfmac_f32_16x16x64_bf16 v[148:151], v[140:143], a[8:15], v10
    buffer_load_dword v106, v39, s[4:7], s43 offen offset:2560 sc1
    v_smfmac_f32_16x16x64_bf16 v[152:155], v[140:143], a[32:39], v10
    v_smfmac_f32_16x16x64_bf16 v[156:159], v[140:143], a[56:63], v10
    v_smfmac_f32_16x16x64_bf16 v[160:163], v[140:143], a[80:87], v10
    s_waitcnt lgkmcnt(0)
    v_smfmac_f32_16x16x64_bf16 v[148:151], v[144:147], a[16:23], v10
    v_smfmac_f32_16x16x64_bf16 v[152:155], v[144:147], a[40:47], v10
    v_smfmac_f32_16x16x64_bf16 v[156:159], v[144:147], a[64:71], v10
    v_smfmac_f32_16x16x64_bf16 v[160:163], v[144:147], a[88:95], v10
    v_pk_add_f32 v[148:149], v[148:149], v[150:151]
    v_cmp_u_f32 vcc, v148, v149
    v_cvt_pk_bf16_f32 v50, v148, v149
    v_cvt_pk_bf16_f32 v54, v148, v149
    v_pk_add_f32 v[152:153], v[152:153], v[154:155]
    v_cvt_pk_bf16_f32 v58, v152, v153
    v_cvt_pk_bf16_f32 v62, v152, v153
    v_pk_add_f32 v[156:157], v[156:157], v[158:159]
    v_cvt_pk_bf16_f32 v66, v156, v157
    v_cvt_pk_bf16_f32 v70, v156, v157
    v_pk_add_f32 v[160:161], v[160:161], v[162:163]
    v_cvt_pk_bf16_f32 v74, v160, v161
    v_cvt_pk_bf16_f32 v78, v160, v161
    s_cbranch_vccnz L_vm_39
L_u_40:
    s_cbranch_scc1 L_wo_tail_f
L_sc_42:
    s_waitcnt vmcnt(4)
    v_pk_add_f32 v[236:237], v[92:93], v[96:97]
    v_pk_add_f32 v[238:239], v[94:95], v[98:99]
    s_waitcnt vmcnt(3)
    v_pk_add_f32 v[236:237], v[236:237], v[100:101]
    v_pk_add_f32 v[238:239], v[238:239], v[102:103]
    v_max3_f32 v41, v236, v237, v238
    v_pk_add_f32 v[242:243], v[236:237], v[238:239]
    s_waitcnt vmcnt(0)
    v_add_f32 v43, v104, v105
    v_add_f32 v43, v43, v106
    v_max3_f32 v41, v41, v239, v43
    v_add_f32 v242, v242, v43
    s_nop 0
    v_max_f32_dpp v42, v41, v41 quad_perm:[2,3,0,1] row_mask:0xf bank_mask:0xf
    v_max_f32_dpp v41, v41, v41 quad_perm:[2,3,0,1] row_mask:0xf bank_mask:0xf
    v_cmp_u_f32 vcc, v242, v243
    s_nop 0
    v_permlane16_swap_b32 v41, v42
    v_max_f32 v41, v41, v42
    v_mov_b32 v42, v41
    s_cbranch_vccnz L_sp_43
L_sg_44:
    s_nop 0
    v_permlane32_swap_b32 v41, v42
    v_max_f32 v41, v41, v42
    v_mul_f32 v242, 0xbdd53b95, v41
    v_pk_fma_f32 v[236:237], v[236:237], v[240:241], v[242:243] op_sel_hi:[1,1,0]
    v_pk_fma_f32 v[238:239], v[238:239], v[240:241], v[242:243] op_sel_hi:[1,1,0]
    v_fma_f32 v43, v43, v240, v242
    v_exp_f32 v236, v236
    v_exp_f32 v237, v237
    v_exp_f32 v238, v238
    v_exp_f32 v239, v239
    v_exp_f32 v43, v43
    v_cvt_pk_bf16_f32 v80, v236, v237
    v_cvt_pk_bf16_f32 v82, v238, v239
    v_cvt_pk_bf16_f32 v81, v43, 0
    v_cvt_pk_bf16_f32 v83, v43, 0
    s_nop 1
    v_smfmac_f32_16x16x64_bf16 v[116:119], v[80:83], v[84:91], v11
    v_smfmac_f32_16x16x64_bf16 v[120:123], v[80:83], v[48:55], v11
    v_smfmac_f32_16x16x64_bf16 v[124:127], v[80:83], v[56:63], v11
    v_smfmac_f32_16x16x64_bf16 v[128:131], v[80:83], v[64:71], v11
    v_add_f32 v116, v116, v118
    v_add_f32 v117, v117, v119
    v_smfmac_f32_16x16x64_bf16 v[132:135], v[80:83], v[72:79], v11
    v_rcp_f32 v116, v116
    v_rcp_f32 v117, v117
    v_pk_add_f32 v[120:121], v[120:121], v[122:123]
    v_pk_mul_f32 v[120:121], v[120:121], v[116:117]
    v_cvt_pk_bf16_f32 v236, v120, v121
    v_pk_add_f32 v[124:125], v[124:125], v[126:127]
    v_pk_mul_f32 v[124:125], v[124:125], v[116:117]
    v_cvt_pk_bf16_f32 v237, v124, v125
    ds_write2st64_b32 v18, v236, v237 offset0:0 offset1:1
    v_pk_add_f32 v[128:129], v[128:129], v[130:131]
    v_pk_mul_f32 v[128:129], v[128:129], v[116:117]
    v_cvt_pk_bf16_f32 v238, v128, v129
    v_pk_add_f32 v[132:133], v[132:133], v[134:135]
    v_pk_mul_f32 v[132:133], v[132:133], v[116:117]
    v_cvt_pk_bf16_f32 v239, v132, v133
    ds_write2st64_b32 v18, v238, v239 offset0:2 offset1:3
    buffer_store_dword v107, v244, s[4:7], s38 offen
    v_mov_b32 v120, 0
    v_mov_b32 v121, 0
    v_mov_b32 v122, 0
    v_mov_b32 v123, 0
    v_mov_b32 v124, 0
    v_mov_b32 v125, 0
    v_mov_b32 v126, 0
    v_mov_b32 v127, 0
    v_mov_b32 v128, 0
    v_mov_b32 v129, 0
    s_waitcnt lgkmcnt(0)
    s_barrier
    ds_read_b64_tr_b16 v[80:81], v19
    ds_read_b64_tr_b16 v[82:83], v19 offset:128
    v_mov_b32 v130, 0
    v_mov_b32 v131, 0
    v_mov_b32 v132, 0
    v_mov_b32 v133, 0
    v_mov_b32 v134, 0
    v_mov_b32 v135, 0
    v_mov_b32 v116, 0
    v_mov_b32 v117, 0
    v_mov_b32 v118, 0
    v_mov_b32 v119, 0
    s_waitcnt lgkmcnt(0)
    v_mfma_f32_16x16x32_bf16 v[172:175], v[110:113], v[80:83], 0
    v_mfma_f32_16x16x32_bf16 v[176:179], v[108:111], v[80:83], 0
    buffer_load_dword v36, v33, s[4:7], s38 offen sc1
    s_nop 3
    v_cvt_pk_bf16_f32 v236, v172, v173
    v_cvt_pk_bf16_f32 v237, v174, v175
    s_nop 0
    v_cvt_pk_bf16_f32 v238, v176, v177
    v_cvt_pk_bf16_f32 v239, v178, v179
    buffer_store_dwordx4 v[236:239], v14, s[4:7], s41 offen sc1
    ds_write_b32 v47, v50 offset:8
    ds_write_b32 v47, v58 offset:6152
    ds_write_b32 v47, v66 offset:12296
    ds_write_b32 v47, v74 offset:18440
    ds_read_b128 v[204:207], v26 offset:0
    ds_read_b128 v[180:183], v29 offset:0
    ds_read_b128 v[184:187], v29 offset:1024
    ds_read_b64 v[208:209], v27 offset:0
    ds_read_b128 v[188:191], v29 offset:2048
    ds_read_b128 v[212:215], v26 offset:1536
    ds_read_b128 v[192:195], v29 offset:3072
    ds_read_b128 v[196:199], v29 offset:4096
    ds_read_b64 v[216:217], v27 offset:1536
    ds_read_b128 v[200:203], v29 offset:5120
    s_add_u32 s55, s42, s60
    buffer_store_dword v168, v46, s[4:7], s55 offen sc1
    s_add_u32 s55, s42, s61
    buffer_store_dword v168, v46, s[4:7], s55 offen sc1
    s_waitcnt lgkmcnt(5)
    v_mfma_f32_16x16x32_bf16 v[220:223], v[180:183], v[204:207], 0
    v_mfma_f32_16x16x32_bf16 v[224:227], v[184:187], v[204:207], 0
    v_mfma_f32_16x16x32_bf16 v[224:227], v[188:191], v[208:211], v[224:227]
    ds_read_b128 v[204:207], v26 offset:3072
    ds_read_b128 v[180:183], v29 offset:6144
    ds_read_b128 v[184:187], v29 offset:7168
    ds_read_b64 v[208:209], v27 offset:3072
    ds_read_b128 v[188:191], v29 offset:8192
    s_add_u32 s56, s37, 2
    s_and_b32 s55, s56, 3
    s_mul_i32 s55, s55, 114688
    s_add_u32 s55, s55, 65536
    s_add_u32 s45, s38, s55
    s_add_u32 s46, s45, 4096
    s_add_u32 s47, s45, 8192
    s_add_u32 s56, s37, -1
    s_and_b32 s55, s56, 3
    s_mul_i32 s55, s55, 114688
    s_add_u32 s55, s55, 53248
    s_add_u32 s48, s38, s55
    s_and_b32 s55, s56, 1
    s_add_u32 s56, s56, 1
    v_mov_b32 v35, -16
    v_writelane_b32 v35, s56, 12
    s_mul_i32 s55, s55, 12288
    s_add_u32 m0, s54, s55
    s_waitcnt lgkmcnt(5)
    v_mfma_f32_16x16x32_bf16 v[220:223], v[192:195], v[212:215], v[220:223]
    v_mfma_f32_16x16x32_bf16 v[224:227], v[196:199], v[212:215], v[224:227]
    v_mfma_f32_16x16x32_bf16 v[224:227], v[200:203], v[216:219], v[224:227]
    ds_read_b128 v[212:215], v26 offset:4608
    ds_read_b128 v[192:195], v29 offset:9216
    ds_read_b128 v[196:199], v29 offset:10240
    ds_read_b64 v[216:217], v27 offset:4608
    ds_read_b128 v[200:203], v29 offset:11264
    s_waitcnt lgkmcnt(5)
    v_mfma_f32_16x16x32_bf16 v[220:223], v[180:183], v[204:207], v[220:223]
    v_mfma_f32_16x16x32_bf16 v[224:227], v[184:187], v[204:207], v[224:227]
    v_mfma_f32_16x16x32_bf16 v[224:227], v[188:191], v[208:211], v[224:227]
    s_waitcnt lgkmcnt(0)
    v_mfma_f32_16x16x32_bf16 v[220:223], v[192:195], v[212:215], v[220:223]
    v_mfma_f32_16x16x32_bf16 v[224:227], v[196:199], v[212:215], v[224:227]
    v_mfma_f32_16x16x32_bf16 v[224:227], v[200:203], v[216:219], v[224:227]
    s_waitcnt vmcnt(3)
    v_cmp_lt_i32 vcc, v36, v35
    s_cbranch_vccz L_fok_47
L_fw_46:
    buffer_load_dword v36, v33, s[4:7], s38 offen sc1
    s_sub_u32 s36, s36, 1
    s_cbranch_scc1 L_exit
    s_waitcnt vmcnt(0)
    v_cmp_lt_i32 vcc, v36, v35
    s_cbranch_vccnz L_fw_46
L_fok_47:
    buffer_load_dwordx4 v37, s[4:7], s48 offen offset:0 sc1 lds
    buffer_load_dwordx4 v37, s[4:7], s48 offen offset:1024 sc1 lds
    buffer_load_dwordx4 v37, s[4:7], s48 offen offset:2048 sc1 lds
    v_cvt_pk_bf16_f32 v220, v220, v221
    v_cvt_pk_bf16_f32 v221, v222, v223
    v_cvt_pk_bf16_f32 v222, v224, v225
    v_cvt_pk_bf16_f32 v223, v226, v227
    v_mov_b32 v224, v220
    v_mov_b32 v225, v221
    v_mov_b32_dpp v220, v222 row_ror:8 row_mask:0xf bank_mask:0xc
    v_mov_b32_dpp v221, v223 row_ror:8 row_mask:0xf bank_mask:0xc
    v_mov_b32_dpp v222, v224 row_ror:8 row_mask:0xf bank_mask:0x3
    v_mov_b32_dpp v223, v225 row_ror:8 row_mask:0xf bank_mask:0x3
    buffer_store_dwordx4 v[220:223], v15, s[4:7], s49 offen
    v_mfma_f32_16x16x32_bf16 v[148:151], a[96:99], a[0:3], 0
    s_mov_b32 s50, s42
    s_add_u32 s56, s37, 1
    v_mov_b32 v47, v24
    v_mfma_f32_16x16x32_bf16 v[152:155], a[120:123], a[0:3], 0
    s_and_b32 s55, s56, 3
    s_mul_i32 s41, s55, 327680
    s_mul_i32 s56, s55, 114688
    v_mfma_f32_16x16x32_bf16 v[156:159], a[96:99], a[24:27], 0
    s_add_u32 s43, s38, s56
    s_xor_b32 s55, s55, 2
    s_mul_i32 s42, s55, 327680
    v_mfma_f32_16x16x32_bf16 v[160:163], a[120:123], a[24:27], 0
    s_add_u32 s56, s37, 2
    v_mov_b32 v107, s56
    s_and_b32 s55, s56, 3
    v_mfma_f32_16x16x32_bf16 v[180:183], a[96:99], a[48:51], 0
    s_mul_i32 s44, s55, 24576
    s_add_u32 s56, s37, -1
    s_and_b32 s55, s56, 3
    v_mfma_f32_16x16x32_bf16 v[184:187], a[120:123], a[48:51], 0
    s_mul_i32 s55, s55, 40960
    s_add_u32 s49, s55, s38
    s_add_u32 s56, s37, -1
    v_mfma_f32_16x16x32_bf16 v[188:191], a[96:99], a[72:75], 0
    s_and_b32 s55, s56, 3
    s_mul_i32 s55, s55, 24576
    v_add_u32 v26, s55, v22
    v_mfma_f32_16x16x32_bf16 v[192:195], a[120:123], a[72:75], 0
    buffer_load_dwordx4 a[96:99], v40, s[4:7], s45 offen offset:0 sc1
    v_mfma_f32_16x16x32_bf16 v[148:151], a[100:103], a[4:7], v[148:151]
    v_add_u32 v27, s55, v23
    s_and_b32 s55, s56, 1
    s_mul_i32 s55, s55, 12288
    v_mfma_f32_16x16x32_bf16 v[152:155], a[124:127], a[4:7], v[152:155]
    buffer_load_dwordx4 a[120:123], v40, s[4:7], s46 offen offset:2048 sc1
    v_mfma_f32_16x16x32_bf16 v[156:159], a[100:103], a[28:31], v[156:159]
    v_add_u32 v29, s55, v28
    v_mfma_f32_16x16x32_bf16 v[160:163], a[124:127], a[28:31], v[160:163]
    v_mfma_f32_16x16x32_bf16 v[180:183], a[100:103], a[52:55], v[180:183]
    v_mfma_f32_16x16x32_bf16 v[184:187], a[124:127], a[52:55], v[184:187]
    v_mfma_f32_16x16x32_bf16 v[188:191], a[100:103], a[76:79], v[188:191]
    v_mfma_f32_16x16x32_bf16 v[192:195], a[124:127], a[76:79], v[192:195]
    buffer_load_dwordx4 a[100:103], v40, s[4:7], s45 offen offset:1024 sc1
    v_mfma_f32_16x16x32_bf16 v[148:151], a[104:107], a[8:11], v[148:151]
    v_mfma_f32_16x16x32_bf16 v[152:155], a[128:131], a[8:11], v[152:155]
    buffer_load_dwordx4 a[124:127], v40, s[4:7], s46 offen offset:3072 sc1
    v_mfma_f32_16x16x32_bf16 v[156:159], a[104:107], a[32:35], v[156:159]
    v_mfma_f32_16x16x32_bf16 v[160:163], a[128:131], a[32:35], v[160:163]
    v_mfma_f32_16x16x32_bf16 v[180:183], a[104:107], a[56:59], v[180:183]
    v_mfma_f32_16x16x32_bf16 v[184:187], a[128:131], a[56:59], v[184:187]
    v_mfma_f32_16x16x32_bf16 v[188:191], a[104:107], a[80:83], v[188:191]
    v_mfma_f32_16x16x32_bf16 v[192:195], a[128:131], a[80:83], v[192:195]
    buffer_load_dwordx4 a[104:107], v40, s[4:7], s45 offen offset:2048 sc1
    v_mfma_f32_16x16x32_bf16 v[148:151], a[108:111], a[12:15], v[148:151]
    v_mfma_f32_16x16x32_bf16 v[152:155], a[132:135], a[12:15], v[152:155]
    buffer_load_dwordx4 a[128:131], v40, s[4:7], s47 offen offset:0 sc1
    v_mfma_f32_16x16x32_bf16 v[156:159], a[108:111], a[36:39], v[156:159]
    v_mfma_f32_16x16x32_bf16 v[160:163], a[132:135], a[36:39], v[160:163]
    v_mfma_f32_16x16x32_bf16 v[180:183], a[108:111], a[60:63], v[180:183]
    v_mfma_f32_16x16x32_bf16 v[184:187], a[132:135], a[60:63], v[184:187]
    v_mfma_f32_16x16x32_bf16 v[188:191], a[108:111], a[84:87], v[188:191]
    v_mfma_f32_16x16x32_bf16 v[192:195], a[132:135], a[84:87], v[192:195]
    buffer_load_dwordx4 a[108:111], v40, s[4:7], s45 offen offset:3072 sc1
    v_mfma_f32_16x16x32_bf16 v[148:151], a[112:115], a[16:19], v[148:151]
    v_mfma_f32_16x16x32_bf16 v[152:155], a[136:139], a[16:19], v[152:155]
    buffer_load_dwordx4 a[132:135], v40, s[4:7], s47 offen offset:1024 sc1
    v_mfma_f32_16x16x32_bf16 v[156:159], a[112:115], a[40:43], v[156:159]
    v_mfma_f32_16x16x32_bf16 v[160:163], a[136:139], a[40:43], v[160:163]
    v_mfma_f32_16x16x32_bf16 v[180:183], a[112:115], a[64:67], v[180:183]
    v_mfma_f32_16x16x32_bf16 v[184:187], a[136:139], a[64:67], v[184:187]
    v_mfma_f32_16x16x32_bf16 v[188:191], a[112:115], a[88:91], v[188:191]
    v_mfma_f32_16x16x32_bf16 v[192:195], a[136:139], a[88:91], v[192:195]
    v_mfma_f32_16x16x32_bf16 v[148:151], a[116:119], a[20:23], v[148:151]
    v_mfma_f32_16x16x32_bf16 v[152:155], a[140:143], a[20:23], v[152:155]
    v_mfma_f32_16x16x32_bf16 v[156:159], a[116:119], a[44:47], v[156:159]
    v_mfma_f32_16x16x32_bf16 v[160:163], a[140:143], a[44:47], v[160:163]
    v_mfma_f32_16x16x32_bf16 v[180:183], a[116:119], a[68:71], v[180:183]
    v_mfma_f32_16x16x32_bf16 v[184:187], a[140:143], a[68:71], v[184:187]
    v_mfma_f32_16x16x32_bf16 v[188:191], a[116:119], a[92:95], v[188:191]
    v_mfma_f32_16x16x32_bf16 v[192:195], a[140:143], a[92:95], v[192:195]
    v_cvt_pk_bf16_f32 v64, v180, v181
    v_cvt_pk_bf16_f32 v65, v182, v183
    ds_write_b64 v24, v[64:65] offset:12288
    v_cvt_pk_bf16_f32 v68, v184, v185
    v_cvt_pk_bf16_f32 v69, v186, v187
    ds_write_b64 v25, v[68:69] offset:12288
    v_cvt_pk_bf16_f32 v72, v188, v189
    v_cvt_pk_bf16_f32 v73, v190, v191
    ds_write_b64 v24, v[72:73] offset:18432
    v_cvt_pk_bf16_f32 v76, v192, v193
    v_cvt_pk_bf16_f32 v77, v194, v195
    ds_write_b64 v25, v[76:77] offset:18432
    v_cvt_pk_bf16_f32 v48, v148, v149
    v_cvt_pk_bf16_f32 v49, v150, v151
    ds_write_b64 v24, v[48:49] offset:0
    v_cvt_pk_bf16_f32 v52, v152, v153
    v_cvt_pk_bf16_f32 v53, v154, v155
    ds_write_b64 v25, v[52:53] offset:0
    v_cvt_pk_bf16_f32 v56, v156, v157
    v_cvt_pk_bf16_f32 v57, v158, v159
    ds_write_b64 v24, v[56:57] offset:6144
    v_cvt_pk_bf16_f32 v60, v160, v161
    v_cvt_pk_bf16_f32 v61, v162, v163
    ds_write_b64 v25, v[60:61] offset:6144
    s_add_u32 s37, s37, 1
    s_mov_b32 m0, s53
    v_add_u32 v24, s44, v20
    v_add_u32 v25, s44, v21
    v_pk_mul_f32 v[148:149], v[210:211], v[210:211]
    v_pk_mul_f32 v[150:151], v[210:211], v[210:211]
    v_pk_mul_f32 v[152:153], v[210:211], v[210:211]
    v_pk_mul_f32 v[154:155], v[210:211], v[210:211]
    v_pk_mul_f32 v[156:157], v[210:211], v[210:211]
    v_pk_mul_f32 v[158:159], v[210:211], v[210:211]
    v_pk_mul_f32 v[160:161], v[210:211], v[210:211]
    v_pk_mul_f32 v[162:163], v[210:211], v[210:211]
    buffer_load_dwordx4 a[112:115], v40, s[4:7], s46 offen offset:0 sc1
    buffer_load_dwordx4 a[136:139], v40, s[4:7], s47 offen offset:2048 sc1
    buffer_load_dwordx4 a[116:119], v40, s[4:7], s46 offen offset:1024 sc1
    buffer_load_dwordx4 a[140:143], v40, s[4:7], s47 offen offset:3072 sc1
    s_branch L_wo_loop_f
L_wo_tail_f:
    ds_write_b32 v47, v50 offset:8
    ds_write_b32 v47, v58 offset:6152
    ds_write_b32 v47, v66 offset:12296
    ds_write_b32 v47, v74 offset:18440
    s_add_u32 s91, s38, 81920
    buffer_load_dwordx4 v[120:123], v15, s[4:7], s91 offen sc1
    s_add_u32 s91, s38, 122880
    buffer_load_dwordx4 v[124:127], v15, s[4:7], s91 offen sc1
    s_add_u32 s56, s37, -1
    s_and_b32 s55, s56, 3
    s_mul_i32 s55, s55, 114688
    s_add_u32 s55, s55, 53248
    s_add_u32 s48, s38, s55
    s_and_b32 s55, s56, 1
    s_add_u32 s56, s56, 1
    v_mov_b32 v35, -16
    v_writelane_b32 v35, s56, 12
    s_mul_i32 s55, s55, 12288
    s_add_u32 m0, s54, s55
    buffer_load_dword v36, v33, s[4:7], s38 offen sc1
    v_mov_b32 v3, 200
L_p0_48:
    buffer_load_dword v4, v3, s[8:11], 0 offen sc1
    s_sub_u32 s36, s36, 1
    s_cbranch_scc1 L_exit
    s_waitcnt vmcnt(0)
    v_readfirstlane_b32 s90, v4
    s_nop 0
    s_cmp_eq_u32 s90, 0
    s_cbranch_scc1 L_p0_48
    s_and_b32 s90, s90, 2
    s_lshl_b32 s90, s90, 12
    v_xor_b32 v30, s90, v30
    v_xor_b32 v31, s90, v31
    s_waitcnt lgkmcnt(0)
    s_barrier
    v_cmp_lt_i32 vcc, v36, v35
    s_cbranch_vccz L_fok_50
L_fw_49:
    buffer_load_dword v36, v33, s[4:7], s38 offen sc1
    s_sub_u32 s36, s36, 1
    s_cbranch_scc1 L_exit
    s_waitcnt vmcnt(0)
    v_cmp_lt_i32 vcc, v36, v35
    s_cbranch_vccnz L_fw_49
L_fok_50:
    buffer_load_dwordx4 v37, s[4:7], s48 offen offset:0 sc1 lds
    buffer_load_dwordx4 v37, s[4:7], s48 offen offset:1024 sc1 lds
    buffer_load_dwordx4 v37, s[4:7], s48 offen offset:2048 sc1 lds
    v_mov_b32 v128, v220
    v_mov_b32 v129, v221
    v_mov_b32 v130, v222
    v_mov_b32 v131, v223
    s_add_u32 s56, s37, -2
    s_and_b32 s55, s56, 3
    s_mul_i32 s55, s55, 24576
    v_add_u32 v26, s55, v22
    v_add_u32 v27, s55, v23
    s_and_b32 s55, s56, 1
    s_mul_i32 s55, s55, 12288
    v_add_u32 v29, s55, v28
    ds_read_b128 v[204:207], v26 offset:0
    ds_read_b128 v[180:183], v29 offset:0
    ds_read_b128 v[184:187], v29 offset:1024
    ds_read_b64 v[208:209], v27 offset:0
    ds_read_b128 v[188:191], v29 offset:2048
    ds_read_b128 v[212:215], v26 offset:1536
    ds_read_b128 v[192:195], v29 offset:3072
    ds_read_b128 v[196:199], v29 offset:4096
    ds_read_b64 v[216:217], v27 offset:1536
    ds_read_b128 v[200:203], v29 offset:5120
    s_waitcnt lgkmcnt(5)
    v_mfma_f32_16x16x32_bf16 v[220:223], v[180:183], v[204:207], 0
    v_mfma_f32_16x16x32_bf16 v[224:227], v[184:187], v[204:207], 0
    v_mfma_f32_16x16x32_bf16 v[224:227], v[188:191], v[208:211], v[224:227]
    ds_read_b128 v[204:207], v26 offset:3072
    ds_read_b128 v[180:183], v29 offset:6144
    ds_read_b128 v[184:187], v29 offset:7168
    ds_read_b64 v[208:209], v27 offset:3072
    ds_read_b128 v[188:191], v29 offset:8192
    s_waitcnt lgkmcnt(5)
    v_mfma_f32_16x16x32_bf16 v[220:223], v[192:195], v[212:215], v[220:223]
    v_mfma_f32_16x16x32_bf16 v[224:227], v[196:199], v[212:215], v[224:227]
    v_mfma_f32_16x16x32_bf16 v[224:227], v[200:203], v[216:219], v[224:227]
    ds_read_b128 v[212:215], v26 offset:4608
    ds_read_b128 v[192:195], v29 offset:9216
    ds_read_b128 v[196:199], v29 offset:10240
    ds_read_b64 v[216:217], v27 offset:4608
    ds_read_b128 v[200:203], v29 offset:11264
    s_waitcnt lgkmcnt(5)
    v_mfma_f32_16x16x32_bf16 v[220:223], v[180:183], v[204:207], v[220:223]
    v_mfma_f32_16x16x32_bf16 v[224:227], v[184:187], v[204:207], v[224:227]
    v_mfma_f32_16x16x32_bf16 v[224:227], v[188:191], v[208:211], v[224:227]
    s_waitcnt lgkmcnt(0)
    v_mfma_f32_16x16x32_bf16 v[220:223], v[192:195], v[212:215], v[220:223]
    v_mfma_f32_16x16x32_bf16 v[224:227], v[196:199], v[212:215], v[224:227]
    v_mfma_f32_16x16x32_bf16 v[224:227], v[200:203], v[216:219], v[224:227]
    s_nop 0
    v_cvt_pk_bf16_f32 v220, v220, v221
    v_cvt_pk_bf16_f32 v221, v222, v223
    s_nop 4
    v_cvt_pk_bf16_f32 v222, v224, v225
    v_cvt_pk_bf16_f32 v223, v226, v227
    v_mov_b32 v224, v220
    v_mov_b32 v225, v221
    v_mov_b32_dpp v220, v222 row_ror:8 row_mask:0xf bank_mask:0xc
    v_mov_b32_dpp v221, v223 row_ror:8 row_mask:0xf bank_mask:0xc
    v_mov_b32_dpp v222, v224 row_ror:8 row_mask:0xf bank_mask:0x3
    v_mov_b32_dpp v223, v225 row_ror:8 row_mask:0xf bank_mask:0x3
    v_mov_b32 v132, v220
    v_mov_b32 v133, v221
    v_mov_b32 v134, v222
    v_mov_b32 v135, v223
    s_waitcnt vmcnt(0)
    s_barrier
    s_add_u32 s56, s37, -1
    s_and_b32 s55, s56, 3
    s_mul_i32 s55, s55, 24576
    v_add_u32 v26, s55, v22
    v_add_u32 v27, s55, v23
    s_and_b32 s55, s56, 1
    s_mul_i32 s55, s55, 12288
    v_add_u32 v29, s55, v28
    ds_read_b128 v[204:207], v26 offset:0
    ds_read_b128 v[180:183], v29 offset:0
    ds_read_b128 v[184:187], v29 offset:1024
    ds_read_b64 v[208:209], v27 offset:0
    ds_read_b128 v[188:191], v29 offset:2048
    ds_read_b128 v[212:215], v26 offset:1536
    ds_read_b128 v[192:195], v29 offset:3072
    ds_read_b128 v[196:199], v29 offset:4096
    ds_read_b64 v[216:217], v27 offset:1536
    ds_read_b128 v[200:203], v29 offset:5120
    s_waitcnt lgkmcnt(5)
    v_mfma_f32_16x16x32_bf16 v[220:223], v[180:183], v[204:207], 0
    v_mfma_f32_16x16x32_bf16 v[224:227], v[184:187], v[204:207], 0
    v_mfma_f32_16x16x32_bf16 v[224:227], v[188:191], v[208:211], v[224:227]
    ds_read_b128 v[204:207], v26 offset:3072
    ds_read_b128 v[180:183], v29 offset:6144
    ds_read_b128 v[184:187], v29 offset:7168
    ds_read_b64 v[208:209], v27 offset:3072
    ds_read_b128 v[188:191], v29 offset:8192
    s_waitcnt lgkmcnt(5)
    v_mfma_f32_16x16x32_bf16 v[220:223], v[192:195], v[212:215], v[220:223]
    v_mfma_f32_16x16x32_bf16 v[224:227], v[196:199], v[212:215], v[224:227]
    v_mfma_f32_16x16x32_bf16 v[224:227], v[200:203], v[216:219], v[224:227]
    ds_read_b128 v[212:215], v26 offset:4608
    ds_read_b128 v[192:195], v29 offset:9216
    ds_read_b128 v[196:199], v29 offset:10240
    ds_read_b64 v[216:217], v27 offset:4608
    ds_read_b128 v[200:203], v29 offset:11264
    s_waitcnt lgkmcnt(5)
    v_mfma_f32_16x16x32_bf16 v[220:223], v[180:183], v[204:207], v[220:223]
    v_mfma_f32_16x16x32_bf16 v[224:227], v[184:187], v[204:207], v[224:227]
    v_mfma_f32_16x16x32_bf16 v[224:227], v[188:191], v[208:211], v[224:227]
    s_waitcnt lgkmcnt(0)
    v_mfma_f32_16x16x32_bf16 v[220:223], v[192:195], v[212:215], v[220:223]
    v_mfma_f32_16x16x32_bf16 v[224:227], v[196:199], v[212:215], v[224:227]
    v_mfma_f32_16x16x32_bf16 v[224:227], v[200:203], v[216:219], v[224:227]
    s_nop 0
    v_cvt_pk_bf16_f32 v220, v220, v221
    v_cvt_pk_bf16_f32 v221, v222, v223
    s_nop 4
    v_cvt_pk_bf16_f32 v222, v224, v225
    v_cvt_pk_bf16_f32 v223, v226, v227
    v_mov_b32 v224, v220
    v_mov_b32 v225, v221
    v_mov_b32_dpp v220, v222 row_ror:8 row_mask:0xf bank_mask:0xc
    v_mov_b32_dpp v221, v223 row_ror:8 row_mask:0xf bank_mask:0xc
    v_mov_b32_dpp v222, v224 row_ror:8 row_mask:0xf bank_mask:0x3
    v_mov_b32_dpp v223, v225 row_ror:8 row_mask:0xf bank_mask:0x3
    v_mov_b32 v80, v220
    v_mov_b32 v81, v221
    v_mov_b32 v82, v222
    v_mov_b32 v83, v223
    s_add_u32 s56, s37, 0
    s_and_b32 s55, s56, 3
    s_mul_i32 s55, s55, 114688
    s_add_u32 s55, s55, 53248
    s_add_u32 s48, s38, s55
    s_and_b32 s55, s56, 1
    s_add_u32 s56, s56, 1
    v_mov_b32 v35, -16
    v_writelane_b32 v35, s56, 12
    s_mul_i32 s55, s55, 12288
    s_add_u32 m0, s54, s55
    s_add_u32 s56, s37, 0
    s_and_b32 s55, s56, 3
    s_mul_i32 s55, s55, 24576
    v_add_u32 v26, s55, v22
    v_add_u32 v27, s55, v23
    s_and_b32 s55, s56, 1
    s_mul_i32 s55, s55, 12288
    v_add_u32 v29, s55, v28
    buffer_load_dword v36, v33, s[4:7], s38 offen sc1
    buffer_load_dword v36, v33, s[4:7], s38 offen sc1
    buffer_load_dword v36, v33, s[4:7], s38 offen sc1
    buffer_load_dword v36, v33, s[4:7], s38 offen sc1
    buffer_load_dword v36, v33, s[4:7], s38 offen sc1
L_sp_51:
    s_waitcnt vmcnt(4)
    v_cmp_lt_i32 vcc, v36, v35
    buffer_load_dword v36, v33, s[4:7], s38 offen sc1
    s_sub_u32 s36, s36, 1
    s_cbranch_scc1 L_exit
    s_cbranch_vccz L_sp_51x
    s_waitcnt vmcnt(4)
    v_cmp_lt_i32 vcc, v36, v35
    buffer_load_dword v36, v33, s[4:7], s38 offen sc1
    s_cbranch_vccz L_sp_51x
    s_waitcnt vmcnt(4)
    v_cmp_lt_i32 vcc, v36, v35
    buffer_load_dword v36, v33, s[4:7], s38 offen sc1
    s_cbranch_vccz L_sp_51x
    s_waitcnt vmcnt(4)
    v_cmp_lt_i32 vcc, v36, v35
    buffer_load_dword v36, v33, s[4:7], s38 offen sc1
    s_cbranch_vccnz L_sp_51
L_sp_51x:
    buffer_load_dwordx4 v37, s[4:7], s48 offen offset:0 sc1 lds
    buffer_load_dwordx4 v37, s[4:7], s48 offen offset:1024 sc1 lds
    buffer_load_dwordx4 v37, s[4:7], s48 offen offset:2048 sc1 lds
    s_waitcnt vmcnt(0)
    s_barrier
    s_mov_b32 s49, 7143424
    buffer_store_dwordx4 v[120:123], v30, s[4:7], s49 offen sc1
    s_mov_b32 s49, 6815744
    buffer_store_dwordx4 v[124:127], v30, s[4:7], s49 offen sc1
    s_mov_b32 s49, 6488064
    buffer_store_dwordx4 v[128:131], v30, s[4:7], s49 offen sc1
    s_mov_b32 s49, 6160384
    buffer_store_dwordx4 v[132:135], v30, s[4:7], s49 offen sc1
    s_mov_b32 s49, 5832704
    buffer_store_dwordx4 v[80:83], v30, s[4:7], s49 offen sc1
    ds_read_b128 v[204:207], v26 offset:0
    ds_read_b128 v[180:183], v29 offset:0
    ds_read_b128 v[184:187], v29 offset:1024
    ds_read_b64 v[208:209], v27 offset:0
    ds_read_b128 v[188:191], v29 offset:2048
    ds_read_b128 v[212:215], v26 offset:1536
    ds_read_b128 v[192:195], v29 offset:3072
    ds_read_b128 v[196:199], v29 offset:4096
    ds_read_b64 v[216:217], v27 offset:1536
    ds_read_b128 v[200:203], v29 offset:5120
    s_waitcnt lgkmcnt(5)
    v_mfma_f32_16x16x32_bf16 v[220:223], v[180:183], v[204:207], 0
    v_mfma_f32_16x16x32_bf16 v[224:227], v[184:187], v[204:207], 0
    v_mfma_f32_16x16x32_bf16 v[224:227], v[188:191], v[208:211], v[224:227]
    ds_read_b128 v[204:207], v26 offset:3072
    ds_read_b128 v[180:183], v29 offset:6144
    ds_read_b128 v[184:187], v29 offset:7168
    ds_read_b64 v[208:209], v27 offset:3072
    ds_read_b128 v[188:191], v29 offset:8192
    s_waitcnt lgkmcnt(5)
    v_mfma_f32_16x16x32_bf16 v[220:223], v[192:195], v[212:215], v[220:223]
    v_mfma_f32_16x16x32_bf16 v[224:227], v[196:199], v[212:215], v[224:227]
    v_mfma_f32_16x16x32_bf16 v[224:227], v[200:203], v[216:219], v[224:227]
    ds_read_b128 v[212:215], v26 offset:4608
    ds_read_b128 v[192:195], v29 offset:9216
    ds_read_b128 v[196:199], v29 offset:10240
    ds_read_b64 v[216:217], v27 offset:4608
    ds_read_b128 v[200:203], v29 offset:11264
    s_waitcnt lgkmcnt(5)
    v_mfma_f32_16x16x32_bf16 v[220:223], v[180:183], v[204:207], v[220:223]
    v_mfma_f32_16x16x32_bf16 v[224:227], v[184:187], v[204:207], v[224:227]
    v_mfma_f32_16x16x32_bf16 v[224:227], v[188:191], v[208:211], v[224:227]
    s_waitcnt lgkmcnt(0)
    v_mfma_f32_16x16x32_bf16 v[220:223], v[192:195], v[212:215], v[220:223]
    v_mfma_f32_16x16x32_bf16 v[224:227], v[196:199], v[212:215], v[224:227]
    v_mfma_f32_16x16x32_bf16 v[224:227], v[200:203], v[216:219], v[224:227]
    s_nop 0
    v_cvt_pk_bf16_f32 v220, v220, v221
    v_cvt_pk_bf16_f32 v221, v222, v223
    s_nop 4
    v_cvt_pk_bf16_f32 v222, v224, v225
    v_cvt_pk_bf16_f32 v223, v226, v227
    v_mov_b32 v224, v220
    v_mov_b32 v225, v221
    v_mov_b32_dpp v220, v222 row_ror:8 row_mask:0xf bank_mask:0xc
    v_mov_b32_dpp v221, v223 row_ror:8 row_mask:0xf bank_mask:0xc
    v_mov_b32_dpp v222, v224 row_ror:8 row_mask:0xf bank_mask:0x3
    v_mov_b32_dpp v223, v225 row_ror:8 row_mask:0xf bank_mask:0x3
    s_mov_b32 s49, 5505024
    buffer_store_dwordx4 v[220:223], v30, s[4:7], s49 offen sc1
    s_waitcnt vmcnt(0)
L_fp_52:
    s_mov_b32 s51, 5505024
    buffer_load_dwordx4 v[96:99], v31, s[4:7], s51 offen sc1
    s_mov_b32 s51, 7143424
    buffer_load_dwordx4 v[148:151], v31, s[4:7], s51 offen sc1
    s_mov_b32 s51, 6815744
    buffer_load_dwordx4 v[152:155], v31, s[4:7], s51 offen sc1
    s_mov_b32 s51, 6488064
    buffer_load_dwordx4 v[156:159], v31, s[4:7], s51 offen sc1
    s_mov_b32 s51, 6160384
    buffer_load_dwordx4 v[160:163], v31, s[4:7], s51 offen sc1
    s_mov_b32 s51, 5832704
    buffer_load_dwordx4 v[92:95], v31, s[4:7], s51 offen sc1
    s_sub_u32 s36, s36, 1
    s_cbranch_scc1 L_exit
    s_waitcnt vmcnt(0)
L_fp_52c:
    v_mov_b32 v41, 0
    v_max3_u32 v41, v41, v96, v97
    v_max3_u32 v41, v41, v98, v99
    v_max3_u32 v41, v41, v148, v149
    v_max3_u32 v41, v41, v150, v151
    v_max3_u32 v41, v41, v152, v153
    v_max3_u32 v41, v41, v154, v155
    v_max3_u32 v41, v41, v156, v157
    v_max3_u32 v41, v41, v158, v159
    v_max3_u32 v41, v41, v160, v161
    v_max3_u32 v41, v41, v162, v163
    v_max3_u32 v41, v41, v92, v93
    v_max3_u32 v41, v41, v94, v95
    v_cmp_eq_u32 vcc, -1, v41
    s_cbranch_vccnz L_fp_52
    s_mov_b32 s52, 5160960
    v_mfma_f32_16x16x32_bf16 v[232:235], a[144:147], v[96:99], 0
    s_nop 7
    v_cndmask_b32 v234, v232, v233, s[58:59]
    v_cndmask_b32 v235, v233, v232, s[58:59]
    s_nop 1
    v_add_f32_dpp v235, v234, v235 row_ror:8 row_mask:0xf bank_mask:0xf
    v_cvt_pk_bf16_f32 v235, v235, v235
    buffer_store_short v235, v32, s[28:31], s52 offen offset:0
    s_mov_b32 s52, 4751360
    v_mfma_f32_16x16x32_bf16 v[232:235], a[144:147], v[148:151], 0
    s_nop 7
    v_cndmask_b32 v234, v232, v233, s[58:59]
    v_cndmask_b32 v235, v233, v232, s[58:59]
    s_nop 1
    v_add_f32_dpp v235, v234, v235 row_ror:8 row_mask:0xf bank_mask:0xf
    v_cvt_pk_bf16_f32 v235, v235, v235
    buffer_store_short v235, v32, s[28:31], s52 offen offset:0
    s_mov_b32 s52, 4833280
    v_mfma_f32_16x16x32_bf16 v[232:235], a[144:147], v[152:155], 0
    s_nop 7
    v_cndmask_b32 v234, v232, v233, s[58:59]
    v_cndmask_b32 v235, v233, v232, s[58:59]
    s_nop 1
    v_add_f32_dpp v235, v234, v235 row_ror:8 row_mask:0xf bank_mask:0xf
    v_cvt_pk_bf16_f32 v235, v235, v235
    buffer_store_short v235, v32, s[28:31], s52 offen offset:0
    s_mov_b32 s52, 4915200
    v_mfma_f32_16x16x32_bf16 v[232:235], a[144:147], v[156:159], 0
    s_nop 7
    v_cndmask_b32 v234, v232, v233, s[58:59]
    v_cndmask_b32 v235, v233, v232, s[58:59]
    s_nop 1
    v_add_f32_dpp v235, v234, v235 row_ror:8 row_mask:0xf bank_mask:0xf
    v_cvt_pk_bf16_f32 v235, v235, v235
    buffer_store_short v235, v32, s[28:31], s52 offen offset:0
    s_mov_b32 s52, 4997120
    v_mfma_f32_16x16x32_bf16 v[232:235], a[144:147], v[160:163], 0
    s_nop 7
    v_cndmask_b32 v234, v232, v233, s[58:59]
    v_cndmask_b32 v235, v233, v232, s[58:59]
    s_nop 1
    v_add_f32_dpp v235, v234, v235 row_ror:8 row_mask:0xf bank_mask:0xf
    v_cvt_pk_bf16_f32 v235, v235, v235
    buffer_store_short v235, v32, s[28:31], s52 offen offset:0
    s_mov_b32 s52, 5079040
    v_mfma_f32_16x16x32_bf16 v[232:235], a[144:147], v[92:95], 0
    s_nop 7
    v_cndmask_b32 v234, v232, v233, s[58:59]
    v_cndmask_b32 v235, v233, v232, s[58:59]
    s_nop 1
    v_add_f32_dpp v235, v234, v235 row_ror:8 row_mask:0xf bank_mask:0xf
    v_cvt_pk_bf16_f32 v235, v235, v235
    buffer_store_short v235, v32, s[28:31], s52 offen offset:0
    s_endpgm
L_vm_39:
    buffer_load_dwordx4 v44, s[4:7], s43 offen offset:0 sc1 lds
    buffer_load_dwordx4 v44, s[4:7], s43 offen offset:1024 sc1 lds
    buffer_load_dwordx4 v44, s[4:7], s43 offen offset:2048 sc1 lds
    s_sub_u32 s36, s36, 1
    s_cbranch_scc1 L_exit
    v_add_u32 v5, s53, v12
    s_waitcnt vmcnt(0)
    ds_read_b128 v[136:139], v5 offset:0
    ds_read_b128 v[140:143], v5 offset:1024
    ds_read_b128 v[144:147], v5 offset:2048
    s_waitcnt lgkmcnt(0)
    v_max_u32 v4, v136, v137
    v_max3_u32 v4, v4, v138, v139
    v_max3_u32 v4, v4, v140, v141
    v_max3_u32 v4, v4, v142, v143
    v_max3_u32 v4, v4, v144, v145
    v_max3_u32 v4, v4, v146, v147
    v_cmp_eq_u32 vcc, -1, v4
    s_cbranch_vccnz L_vm_39
    buffer_load_dwordx4 v[92:95], v38, s[4:7], s43 offen offset:0 sc1
    buffer_load_dwordx4 v[96:99], v38, s[4:7], s43 offen offset:1280 sc1
    buffer_load_dwordx4 v[100:103], v38, s[4:7], s43 offen offset:2560 sc1
    buffer_load_dword v104, v39, s[4:7], s43 offen offset:0 sc1
    buffer_load_dword v105, v39, s[4:7], s43 offen offset:1280 sc1
    buffer_load_dword v106, v39, s[4:7], s43 offen offset:2560 sc1
    ds_read_b64_tr_b16 v[136:137], v16 offset:0
    ds_read_b64_tr_b16 v[138:139], v13 offset:0
    ds_read_b64_tr_b16 v[140:141], v16 offset:1024
    ds_read_b64_tr_b16 v[142:143], v13 offset:1024
    ds_read_b64_tr_b16 v[144:145], v16 offset:2048
    ds_read_b64_tr_b16 v[146:147], v13 offset:2048
    v_mov_b32 v148, 0
    v_mov_b32 v149, 0
    v_mov_b32 v150, 0
    v_mov_b32 v151, 0
    v_mov_b32 v152, 0
    v_mov_b32 v153, 0
    v_mov_b32 v154, 0
    v_mov_b32 v155, 0
    v_mov_b32 v156, 0
    v_mov_b32 v157, 0
    v_mov_b32 v158, 0
    v_mov_b32 v159, 0
    v_mov_b32 v160, 0
    v_mov_b32 v161, 0
    v_mov_b32 v162, 0
    v_mov_b32 v163, 0
    s_waitcnt lgkmcnt(0)
    v_smfmac_f32_16x16x64_bf16 v[148:151], v[136:139], a[0:7], v10
    v_smfmac_f32_16x16x64_bf16 v[152:155], v[136:139], a[24:31], v10
    v_smfmac_f32_16x16x64_bf16 v[156:159], v[136:139], a[48:55], v10
    v_smfmac_f32_16x16x64_bf16 v[160:163], v[136:139], a[72:79], v10
    v_smfmac_f32_16x16x64_bf16 v[148:151], v[140:143], a[8:15], v10
    v_smfmac_f32_16x16x64_bf16 v[152:155], v[140:143], a[32:39], v10
    v_smfmac_f32_16x16x64_bf16 v[156:159], v[140:143], a[56:63], v10
    v_smfmac_f32_16x16x64_bf16 v[160:163], v[140:143], a[80:87], v10
    v_smfmac_f32_16x16x64_bf16 v[148:151], v[144:147], a[16:23], v10
    v_smfmac_f32_16x16x64_bf16 v[152:155], v[144:147], a[40:47], v10
    v_smfmac_f32_16x16x64_bf16 v[156:159], v[144:147], a[64:71], v10
    v_smfmac_f32_16x16x64_bf16 v[160:163], v[144:147], a[88:95], v10
    v_pk_add_f32 v[148:149], v[148:149], v[150:151]
    v_cmp_u_f32 vcc, v148, v149
    v_cvt_pk_bf16_f32 v50, v148, v149
    v_cvt_pk_bf16_f32 v54, v148, v149
    v_pk_add_f32 v[152:153], v[152:153], v[154:155]
    v_cvt_pk_bf16_f32 v58, v152, v153
    v_cvt_pk_bf16_f32 v62, v152, v153
    v_pk_add_f32 v[156:157], v[156:157], v[158:159]
    v_cvt_pk_bf16_f32 v66, v156, v157
    v_cvt_pk_bf16_f32 v70, v156, v157
    v_pk_add_f32 v[160:161], v[160:161], v[162:163]
    v_cvt_pk_bf16_f32 v74, v160, v161
    v_cvt_pk_bf16_f32 v78, v160, v161
    s_cmp_eq_u32 s37, 63
    s_branch L_u_40
L_sp_43:
    v_max3_u32 v4, v104, v105, v106
    v_max3_u32 v4, v4, v92, v93
    v_max3_u32 v4, v4, v94, v95
    v_max3_u32 v4, v4, v96, v97
    v_max3_u32 v4, v4, v98, v99
    v_max3_u32 v4, v4, v100, v101
    v_max3_u32 v4, v4, v102, v103
    v_cmp_eq_u32 vcc, -1, v4
    s_cbranch_vccz L_sg_44
    buffer_load_dwordx4 v[92:95], v38, s[4:7], s43 offen offset:0 sc1
    buffer_load_dwordx4 v[96:99], v38, s[4:7], s43 offen offset:1280 sc1
    buffer_load_dwordx4 v[100:103], v38, s[4:7], s43 offen offset:2560 sc1
    buffer_load_dword v104, v39, s[4:7], s43 offen offset:0 sc1
    buffer_load_dword v105, v39, s[4:7], s43 offen offset:1280 sc1
    buffer_load_dword v106, v39, s[4:7], s43 offen offset:2560 sc1
    s_sub_u32 s36, s36, 1
    s_cbranch_scc1 L_exit
    s_branch L_sc_42
L_px_f:
    v_and_b32 v1, 15, v0
    v_lshrrev_b32 v2, 4, v0
    s_mul_i32 s90, s32, 12288
    v_lshl_add_u32 v10, v0, 4, s90
    s_mul_i32 s90, s32, 3072
    v_lshl_add_u32 v12, v0, 4, s90
    v_lshrrev_b32 v3, 2, v1
    v_lshlrev_b32 v3, 1, v3
    v_and_b32 v4, 1, v1
    v_or_b32 v3, v3, v4
    v_lshl_add_u32 v3, v2, 3, v3
    v_lshl_add_u32 v11, v3, 4, s90
    s_lshl_b32 s90, s32, 7
    v_min_u32 v3, 11, v0
    v_lshl_add_u32 v3, v3, 2, s90
    v_add_u32 v13, 458752, v3
    v_min_u32 v3, 2, v0
    v_lshl_add_u32 v3, v3, 2, s90
    v_add_u32 v14, 459264, v3
    v_add_u32 v22, 462336, v3
    s_add_u32 s90, s90, 459776
    v_mov_b32 v15, s90
    v_cmp_eq_u32 vcc, 0, v0
    v_mov_b32 v9, 2146435072
    s_nop 0
    v_cndmask_b32 v15, v9, v15, vcc
    s_nop 0
    v_mov_b32 v21, 0xd04e79ff
    s_mov_b32 s44, 0x3dd53b95
    v_lshl_add_u32 v3, v2, 2, 0
    v_cmp_le_u32 s[48:49], v3, v1
    v_lshl_add_u32 v3, v2, 2, 1
    v_cmp_le_u32 s[50:51], v3, v1
    v_lshl_add_u32 v3, v2, 2, 2
    v_cmp_le_u32 s[52:53], v3, v1
    v_lshl_add_u32 v3, v2, 2, 3
    v_cmp_le_u32 s[54:55], v3, v1
    v_mov_b32 v167, 0
    v_mov_b32 v171, 0
    v_mov_b32 v174, 0
    v_mov_b32 v175, 0
    s_mov_b32 s37, 0
    v_mov_b32 v1, 192
L_gw_54:
    buffer_load_dword v2, v1, s[8:11], 0 offen sc1
    s_sub_u32 s36, s36, 1
    s_cbranch_scc1 L_exit
    s_waitcnt vmcnt(0)
L_gw_54c:
    v_readfirstlane_b32 s90, v2
    s_nop 0
    s_cmp_eq_u32 s90, 0
    s_cbranch_scc1 L_gw_54
    s_cmp_lg_u32 s90, 1
    s_cbranch_scc1 L_slow
    s_cmp_lg_u32 s32, 0
    s_cbranch_scc1 L_xg_53
    s_lshl_b32 s92, s34, 14
    s_add_u32 s92, s92, 1966080
    s_add_u32 s93, s92, 8192
    v_lshlrev_b32 v3, 4, v0
    buffer_store_dwordx4 v[24:27], v3, s[4:7], s92 offen offset:0 sc1
    buffer_store_dwordx4 v[24:27], v3, s[4:7], s93 offen offset:0 sc1
    buffer_store_dwordx4 v[24:27], v3, s[4:7], s92 offen offset:1024 sc1
    buffer_store_dwordx4 v[24:27], v3, s[4:7], s93 offen offset:1024 sc1
    buffer_store_dwordx4 v[24:27], v3, s[4:7], s92 offen offset:2048 sc1
    buffer_store_dwordx4 v[24:27], v3, s[4:7], s93 offen offset:2048 sc1
    buffer_store_dwordx4 v[24:27], v3, s[4:7], s92 offen offset:3072 sc1
    buffer_store_dwordx4 v[24:27], v3, s[4:7], s93 offen offset:3072 sc1
    v_mov_b32 v3, 0
    s_mov_b32 s56, -1
    s_mov_b32 s57, -1
    s_mov_b32 s62, 0
    s_mov_b32 s63, 0
    s_waitcnt vmcnt(0)
L_pr_55:
    s_memtime s[58:59]
    s_waitcnt lgkmcnt(0)
    buffer_load_dword v4, v3, s[4:7], s92 offen sc1
    s_waitcnt vmcnt(0)
    s_memtime s[60:61]
    s_waitcnt lgkmcnt(0)
    s_sub_u32 s60, s60, s58
    s_min_u32 s56, s56, s60
    s_memtime s[58:59]
    s_waitcnt lgkmcnt(0)
    buffer_load_dword v4, v3, s[4:7], s93 offen sc1
    s_waitcnt vmcnt(0)
    s_memtime s[60:61]
    s_waitcnt lgkmcnt(0)
    s_sub_u32 s60, s60, s58
    s_min_u32 s57, s57, s60
    buffer_load_dword v4, v13, s[4:7], s38 offen sc1
    v_add_u32 v3, 128, v3
    s_add_u32 s62, s62, 1
    s_waitcnt vmcnt(0)
    v_cmp_eq_u32 vcc, 0, v4
    s_nop 0
    s_cmp_eq_u64 vcc, 0
    s_addc_u32 s63, s63, 0
    s_cmp_ge_u32 s63, 2
    s_cselect_b32 s62, 32, s62
    s_min_u32 s58, s56, s57
    s_max_u32 s59, s56, s57
    s_sub_u32 s59, s59, s58
    s_cmp_ge_u32 s59, 150
    s_cselect_b32 s58, s58, -1
    s_cmp_le_u32 s58, 540
    s_cselect_b32 s62, 32, s62
    s_cmp_lt_u32 s62, 32
    s_cbranch_scc1 L_pr_55
    s_cmp_lt_u32 s57, s56
    s_cselect_b32 s62, 2, 1
    s_nop 0
    v_mov_b32 v3, 460288
    v_mov_b32 v4, s62
    buffer_store_dword v4, v3, s[4:7], s38 offen
    s_cmp_lg_u32 s34, 0
    s_cbranch_scc1 L_xg_53
    v_mov_b32 v3, 200
    buffer_store_dword v4, v3, s[8:11], 0 offen sc1
L_xg_53:
    s_barrier
    s_add_u32 s41, s38, 475136
    buffer_load_dword v16, v22, s[4:7], s38 offen sc1
    buffer_load_dword v16, v22, s[4:7], s38 offen sc1
L_sp_56:
    s_waitcnt vmcnt(1)
    v_cmp_ge_u32 vcc, s37, v16
    buffer_load_dword v16, v22, s[4:7], s38 offen sc1
    s_sub_u32 s36, s36, 1
    s_cbranch_scc1 L_exit
    s_cbranch_vccz L_sp_56x
    s_waitcnt vmcnt(1)
    v_cmp_ge_u32 vcc, s37, v16
    buffer_load_dword v16, v22, s[4:7], s38 offen sc1
    s_cbranch_vccz L_sp_56x
    s_waitcnt vmcnt(1)
    v_cmp_ge_u32 vcc, s37, v16
    buffer_load_dword v16, v22, s[4:7], s38 offen sc1
    s_cbranch_vccz L_sp_56x
    s_waitcnt vmcnt(1)
    v_cmp_ge_u32 vcc, s37, v16
    buffer_load_dword v16, v22, s[4:7], s38 offen sc1
    s_cbranch_vccnz L_sp_56
L_sp_56x:
    s_add_u32 s90, s41, 49152
    buffer_load_dwordx4 v[72:75], v10, s[4:7], s90 offen offset:0 sc1
    buffer_load_dwordx4 v[76:79], v10, s[4:7], s90 offen offset:1024 sc1
    buffer_load_dwordx4 v[80:83], v10, s[4:7], s90 offen offset:2048 sc1
    buffer_load_dwordx4 v[84:87], v10, s[4:7], s90 offen offset:3072 sc1
    s_add_u32 s90, s41, 53248
    buffer_load_dwordx4 v[88:91], v10, s[4:7], s90 offen offset:0 sc1
    buffer_load_dwordx4 v[92:95], v10, s[4:7], s90 offen offset:1024 sc1
    buffer_load_dwordx4 v[96:99], v10, s[4:7], s90 offen offset:2048 sc1
    buffer_load_dwordx4 v[100:103], v10, s[4:7], s90 offen offset:3072 sc1
    s_add_u32 s90, s41, 57344
    buffer_load_dwordx4 v[104:107], v10, s[4:7], s90 offen offset:0 sc1
    buffer_load_dwordx4 v[108:111], v10, s[4:7], s90 offen offset:1024 sc1
    buffer_load_dwordx4 v[112:115], v10, s[4:7], s90 offen offset:2048 sc1
    buffer_load_dwordx4 v[116:119], v10, s[4:7], s90 offen offset:3072 sc1
    s_add_u32 s90, s41, 0
    buffer_load_dwordx4 v[24:27], v10, s[4:7], s90 offen offset:0 sc1
    buffer_load_dwordx4 v[28:31], v10, s[4:7], s90 offen offset:1024 sc1
    buffer_load_dwordx4 v[32:35], v10, s[4:7], s90 offen offset:2048 sc1
    buffer_load_dwordx4 v[36:39], v10, s[4:7], s90 offen offset:3072 sc1
    s_add_u32 s90, s41, 4096
    buffer_load_dwordx4 v[40:43], v10, s[4:7], s90 offen offset:0 sc1
    buffer_load_dwordx4 v[44:47], v10, s[4:7], s90 offen offset:1024 sc1
    buffer_load_dwordx4 v[48:51], v10, s[4:7], s90 offen offset:2048 sc1
    buffer_load_dwordx4 v[52:55], v10, s[4:7], s90 offen offset:3072 sc1
    s_add_u32 s90, s41, 8192
    buffer_load_dwordx4 v[56:59], v10, s[4:7], s90 offen offset:0 sc1
    buffer_load_dwordx4 v[60:63], v10, s[4:7], s90 offen offset:1024 sc1
    buffer_load_dwordx4 v[64:67], v10, s[4:7], s90 offen offset:2048 sc1
    buffer_load_dwordx4 v[68:71], v10, s[4:7], s90 offen offset:3072 sc1
    s_waitcnt vmcnt(0)
L_px_loop_f:
    s_and_b32 s90, s37, 3
    s_mul_i32 s91, s90, 114688
    s_add_u32 s91, s91, s38
    s_add_u32 s42, s91, 40960
    s_add_u32 s43, s91, 53248
    s_add_u32 s90, s37, 1
    v_mov_b32 v17, s90
    s_and_b32 s90, s90, 3
    s_mul_i32 s91, s90, 98304
    s_add_u32 s91, s91, 475136
    s_add_u32 s41, s38, s91
    v_mfma_f32_16x16x32_bf16 v[144:147], v[72:75], v[24:27], 0
    v_mfma_f32_16x16x32_bf16 v[152:155], v[72:75], v[48:51], 0
    v_mfma_f32_16x16x32_bf16 v[156:159], v[96:99], v[48:51], 0
    v_mfma_f32_16x16x32_bf16 v[144:147], v[76:79], v[28:31], v[144:147]
    v_mfma_f32_16x16x32_bf16 v[152:155], v[76:79], v[52:55], v[152:155]
    v_mfma_f32_16x16x32_bf16 v[156:159], v[100:103], v[52:55], v[156:159]
    v_mfma_f32_16x16x32_bf16 v[144:147], v[80:83], v[32:35], v[144:147]
    v_mfma_f32_16x16x32_bf16 v[152:155], v[80:83], v[56:59], v[152:155]
    v_mfma_f32_16x16x32_bf16 v[156:159], v[104:107], v[56:59], v[156:159]
    v_mfma_f32_16x16x32_bf16 v[144:147], v[84:87], v[36:39], v[144:147]
    v_mfma_f32_16x16x32_bf16 v[152:155], v[84:87], v[60:63], v[152:155]
    v_mfma_f32_16x16x32_bf16 v[156:159], v[108:111], v[60:63], v[156:159]
    v_mfma_f32_16x16x32_bf16 v[144:147], v[88:91], v[40:43], v[144:147]
    v_mfma_f32_16x16x32_bf16 v[152:155], v[88:91], v[64:67], v[152:155]
    v_mfma_f32_16x16x32_bf16 v[156:159], v[112:115], v[64:67], v[156:159]
    v_mfma_f32_16x16x32_bf16 v[144:147], v[92:95], v[44:47], v[144:147]
    v_mfma_f32_16x16x32_bf16 v[152:155], v[92:95], v[68:71], v[152:155]
    v_mfma_f32_16x16x32_bf16 v[156:159], v[116:119], v[68:71], v[156:159]
    s_nop 0
    v_cndmask_b32 v144, v21, v144, s[48:49]
    v_cndmask_b32 v145, v21, v145, s[50:51]
    v_cndmask_b32 v146, v21, v146, s[52:53]
    v_cndmask_b32 v147, v21, v147, s[54:55]
    s_nop 2
    v_cndmask_b32 v156, v21, v156, s[48:49]
    v_cndmask_b32 v157, v21, v157, s[50:51]
    v_cndmask_b32 v158, v21, v158, s[52:53]
    v_cndmask_b32 v159, v21, v159, s[54:55]
    buffer_load_dword v16, v14, s[4:7], s38 offen sc1
    buffer_load_dword v16, v14, s[4:7], s38 offen sc1
L_sp_57:
    s_waitcnt vmcnt(1)
    v_cmp_ge_u32 vcc, s37, v16
    buffer_load_dword v16, v14, s[4:7], s38 offen sc1
    s_sub_u32 s36, s36, 1
    s_cbranch_scc1 L_exit
    s_cbranch_vccz L_sp_57x
    s_waitcnt vmcnt(1)
    v_cmp_ge_u32 vcc, s37, v16
    buffer_load_dword v16, v14, s[4:7], s38 offen sc1
    s_cbranch_vccz L_sp_57x
    s_waitcnt vmcnt(1)
    v_cmp_ge_u32 vcc, s37, v16
    buffer_load_dword v16, v14, s[4:7], s38 offen sc1
    s_cbranch_vccz L_sp_57x
    s_waitcnt vmcnt(1)
    v_cmp_ge_u32 vcc, s37, v16
    buffer_load_dword v16, v14, s[4:7], s38 offen sc1
    s_cbranch_vccnz L_sp_57
L_sp_57x:
    buffer_load_dwordx4 v[120:123], v11, s[4:7], s42 offen offset:0 sc1
    buffer_load_dwordx4 v[124:127], v11, s[4:7], s42 offen offset:512 sc1
    buffer_load_dwordx4 v[128:131], v11, s[4:7], s42 offen offset:1024 sc1
    buffer_load_dwordx4 v[132:135], v11, s[4:7], s42 offen offset:1536 sc1
    buffer_load_dwordx4 v[136:139], v11, s[4:7], s42 offen offset:2048 sc1
    buffer_load_dwordx4 v[140:143], v11, s[4:7], s42 offen offset:2560 sc1
    s_waitcnt vmcnt(5)
    v_mfma_f32_16x16x32_bf16 v[148:151], v[120:123], v[24:27], 0
    v_mfma_f32_16x16x32_bf16 v[160:163], v[120:123], v[48:51], 0
    s_waitcnt vmcnt(4)
    v_mfma_f32_16x16x32_bf16 v[148:151], v[124:127], v[28:31], v[148:151]
    v_mfma_f32_16x16x32_bf16 v[160:163], v[124:127], v[52:55], v[160:163]
    s_waitcnt vmcnt(3)
    v_mfma_f32_16x16x32_bf16 v[148:151], v[128:131], v[32:35], v[148:151]
    v_mfma_f32_16x16x32_bf16 v[160:163], v[128:131], v[56:59], v[160:163]
    s_waitcnt vmcnt(2)
    v_mfma_f32_16x16x32_bf16 v[148:151], v[132:135], v[36:39], v[148:151]
    v_mfma_f32_16x16x32_bf16 v[160:163], v[132:135], v[60:63], v[160:163]
    s_waitcnt vmcnt(1)
    v_mfma_f32_16x16x32_bf16 v[148:151], v[136:139], v[40:43], v[148:151]
    v_mfma_f32_16x16x32_bf16 v[160:163], v[136:139], v[64:67], v[160:163]
    s_waitcnt vmcnt(0)
    v_mfma_f32_16x16x32_bf16 v[148:151], v[140:143], v[44:47], v[148:151]
    v_mfma_f32_16x16x32_bf16 v[160:163], v[140:143], v[68:71], v[160:163]
    s_cmp_eq_u32 s37, 63
    s_nop 2
    s_cbranch_scc1 L_pxl_58
    s_add_u32 s90, s41, 49152
    v_max_f32 v18, v144, v145
    v_max3_f32 v18, v18, v146, v147
    v_max3_f32 v18, v18, v148, v149
    v_mov_b32 v19, v18
    buffer_load_dwordx4 v[72:75], v10, s[4:7], s90 offen offset:0 sc1
    s_nop 0
    v_permlane16_swap_b32 v18, v19
    v_max_f32 v18, v18, v19
    v_mov_b32 v19, v18
    s_nop 1
    v_permlane32_swap_b32 v18, v19
    buffer_load_dwordx4 v[76:79], v10, s[4:7], s90 offen offset:1024 sc1
    v_max_f32 v18, v18, v19
    v_mul_f32 v18, 0xbdd53b95, v18
    v_fma_f32 v144, v144, s44, v18
    v_fma_f32 v145, v145, s44, v18
    buffer_load_dwordx4 v[80:83], v10, s[4:7], s90 offen offset:2048 sc1
    v_fma_f32 v146, v146, s44, v18
    v_fma_f32 v147, v147, s44, v18
    v_fma_f32 v148, v148, s44, v18
    v_fma_f32 v149, v149, s44, v18
    buffer_load_dwordx4 v[84:87], v10, s[4:7], s90 offen offset:3072 sc1
    v_exp_f32 v144, v144
    v_exp_f32 v145, v145
    v_exp_f32 v146, v146
    v_exp_f32 v147, v147
    s_add_u32 s90, s41, 53248
    v_exp_f32 v148, v148
    v_exp_f32 v149, v149
    v_add_f32 v20, v144, v145
    v_add_f32 v20, v20, v146
    buffer_load_dwordx4 v[88:91], v10, s[4:7], s90 offen offset:0 sc1
    v_add_f32 v20, v20, v147
    v_add_f32 v20, v20, v148
    v_add_f32 v20, v20, v149
    v_mov_b32 v19, v20
    buffer_load_dwordx4 v[92:95], v10, s[4:7], s90 offen offset:1024 sc1
    s_nop 0
    v_permlane16_swap_b32 v20, v19
    v_add_f32 v20, v20, v19
    v_mov_b32 v19, v20
    s_nop 1
    v_permlane32_swap_b32 v20, v19
    buffer_load_dwordx4 v[96:99], v10, s[4:7], s90 offen offset:2048 sc1
    v_add_f32 v20, v20, v19
    v_rcp_f32 v20, v20
    s_nop 0
    v_mul_f32 v144, v144, v20
    v_mul_f32 v145, v145, v20
    buffer_load_dwordx4 v[100:103], v10, s[4:7], s90 offen offset:3072 sc1
    v_mul_f32 v146, v146, v20
    v_mul_f32 v147, v147, v20
    v_mul_f32 v148, v148, v20
    v_mul_f32 v149, v149, v20
    s_add_u32 s90, s41, 57344
    v_cvt_pk_bf16_f32 v164, v144, v145
    v_cvt_pk_bf16_f32 v165, v146, v147
    v_cvt_pk_bf16_f32 v166, v148, v149
    v_max_f32 v18, v152, v153
    buffer_load_dwordx4 v[104:107], v10, s[4:7], s90 offen offset:0 sc1
    v_max3_f32 v18, v18, v154, v155
    v_max3_f32 v18, v18, v160, v161
    v_max3_f32 v18, v18, v156, v157
    v_max3_f32 v18, v18, v158, v159
    buffer_load_dwordx4 v[108:111], v10, s[4:7], s90 offen offset:1024 sc1
    v_mov_b32 v19, v18
    s_nop 1
    v_permlane16_swap_b32 v18, v19
    v_max_f32 v18, v18, v19
    v_mov_b32 v19, v18
    buffer_load_dwordx4 v[112:115], v10, s[4:7], s90 offen offset:2048 sc1
    s_nop 0
    v_permlane32_swap_b32 v18, v19
    v_max_f32 v18, v18, v19
    v_mul_f32 v18, 0xbdd53b95, v18
    v_fma_f32 v152, v152, s44, v18
    buffer_load_dwordx4 v[116:119], v10, s[4:7], s90 offen offset:3072 sc1
    v_fma_f32 v153, v153, s44, v18
    v_fma_f32 v154, v154, s44, v18
    v_fma_f32 v155, v155, s44, v18
    v_fma_f32 v160, v160, s44, v18
    s_add_u32 s90, s41, 0
    v_fma_f32 v161, v161, s44, v18
    v_fma_f32 v156, v156, s44, v18
    v_fma_f32 v157, v157, s44, v18
    v_fma_f32 v158, v158, s44, v18
    buffer_load_dwordx4 v[24:27], v10, s[4:7], s90 offen offset:0 sc1
    v_fma_f32 v159, v159, s44, v18
    v_exp_f32 v152, v152
    v_exp_f32 v153, v153
    v_exp_f32 v154, v154
    buffer_load_dwordx4 v[28:31], v10, s[4:7], s90 offen offset:1024 sc1
    v_exp_f32 v155, v155
    v_exp_f32 v160, v160
    v_exp_f32 v161, v161
    v_exp_f32 v156, v156
    buffer_load_dwordx4 v[32:35], v10, s[4:7], s90 offen offset:2048 sc1
    v_exp_f32 v157, v157
    v_exp_f32 v158, v158
    v_exp_f32 v159, v159
    v_add_f32 v20, v152, v153
    buffer_load_dwordx4 v[36:39], v10, s[4:7], s90 offen offset:3072 sc1
    v_add_f32 v20, v20, v154
    v_add_f32 v20, v20, v155
    v_add_f32 v20, v20, v160
    v_add_f32 v20, v20, v161
    s_add_u32 s90, s41, 4096
    v_add_f32 v20, v20, v156
    v_add_f32 v20, v20, v157
    v_add_f32 v20, v20, v158
    v_add_f32 v20, v20, v159
    buffer_load_dwordx4 v[40:43], v10, s[4:7], s90 offen offset:0 sc1
    v_mov_b32 v19, v20
    s_nop 1
    v_permlane16_swap_b32 v20, v19
    v_add_f32 v20, v20, v19
    v_mov_b32 v19, v20
    buffer_load_dwordx4 v[44:47], v10, s[4:7], s90 offen offset:1024 sc1
    s_nop 0
    v_permlane32_swap_b32 v20, v19
    v_add_f32 v20, v20, v19
    v_rcp_f32 v20, v20
    s_nop 0
    v_mul_f32 v152, v152, v20
    buffer_load_dwordx4 v[48:51], v10, s[4:7], s90 offen offset:2048 sc1
    v_mul_f32 v153, v153, v20
    v_mul_f32 v154, v154, v20
    v_mul_f32 v155, v155, v20
    v_mul_f32 v160, v160, v20
    buffer_load_dwordx4 v[52:55], v10, s[4:7], s90 offen offset:3072 sc1
    v_mul_f32 v161, v161, v20
    v_mul_f32 v156, v156, v20
    v_mul_f32 v157, v157, v20
    v_mul_f32 v158, v158, v20
    s_add_u32 s90, s41, 8192
    v_mul_f32 v159, v159, v20
    v_cvt_pk_bf16_f32 v168, v152, v153
    v_cvt_pk_bf16_f32 v169, v154, v155
    v_cvt_pk_bf16_f32 v170, v160, v161
    buffer_load_dwordx4 v[56:59], v10, s[4:7], s90 offen offset:0 sc1
    v_cvt_pk_bf16_f32 v172, v156, v157
    v_cvt_pk_bf16_f32 v173, v158, v159
    buffer_load_dwordx4 v[60:63], v10, s[4:7], s90 offen offset:1024 sc1
    buffer_load_dwordx4 v[64:67], v10, s[4:7], s90 offen offset:2048 sc1
    buffer_load_dwordx4 v[68:71], v10, s[4:7], s90 offen offset:3072 sc1
    buffer_store_dwordx4 v[164:167], v12, s[4:7], s43 offen offset:0
    buffer_store_dwordx4 v[168:171], v12, s[4:7], s43 offen offset:1024
    buffer_store_dwordx4 v[172:175], v12, s[4:7], s43 offen offset:2048
    s_waitcnt vmcnt(0)
    buffer_store_dword v17, v15, s[4:7], s38 offen
    s_add_u32 s37, s37, 1
    s_branch L_px_loop_f
L_pxl_58:
    v_max_f32 v18, v144, v145
    v_max3_f32 v18, v18, v146, v147
    v_max3_f32 v18, v18, v148, v149
    v_mov_b32 v19, v18
    s_nop 1
    v_permlane16_swap_b32 v18, v19
    v_max_f32 v18, v18, v19
    v_mov_b32 v19, v18
    s_nop 1
    v_permlane32_swap_b32 v18, v19
    v_max_f32 v18, v18, v19
    v_mul_f32 v18, 0xbdd53b95, v18
    v_fma_f32 v144, v144, s44, v18
    v_fma_f32 v145, v145, s44, v18
    v_fma_f32 v146, v146, s44, v18
    v_fma_f32 v147, v147, s44, v18
    v_fma_f32 v148, v148, s44, v18
    v_fma_f32 v149, v149, s44, v18
    v_exp_f32 v144, v144
    v_exp_f32 v145, v145
    v_exp_f32 v146, v146
    v_exp_f32 v147, v147
    v_exp_f32 v148, v148
    v_exp_f32 v149, v149
    v_add_f32 v20, v144, v145
    v_add_f32 v20, v20, v146
    v_add_f32 v20, v20, v147
    v_add_f32 v20, v20, v148
    v_add_f32 v20, v20, v149
    v_mov_b32 v19, v20
    s_nop 1
    v_permlane16_swap_b32 v20, v19
    v_add_f32 v20, v20, v19
    v_mov_b32 v19, v20
    s_nop 1
    v_permlane32_swap_b32 v20, v19
    v_add_f32 v20, v20, v19
    v_rcp_f32 v20, v20
    s_nop 0
    v_mul_f32 v144, v144, v20
    v_mul_f32 v145, v145, v20
    v_mul_f32 v146, v146, v20
    v_mul_f32 v147, v147, v20
    v_mul_f32 v148, v148, v20
    v_mul_f32 v149, v149, v20
    v_cvt_pk_bf16_f32 v164, v144, v145
    v_cvt_pk_bf16_f32 v165, v146, v147
    v_cvt_pk_bf16_f32 v166, v148, v149
    v_max_f32 v18, v152, v153
    v_max3_f32 v18, v18, v154, v155
    v_max3_f32 v18, v18, v160, v161
    v_max3_f32 v18, v18, v156, v157
    v_max3_f32 v18, v18, v158, v159
    v_mov_b32 v19, v18
    s_nop 1
    v_permlane16_swap_b32 v18, v19
    v_max_f32 v18, v18, v19
    v_mov_b32 v19, v18
    s_nop 1
    v_permlane32_swap_b32 v18, v19
    v_max_f32 v18, v18, v19
    v_mul_f32 v18, 0xbdd53b95, v18
    v_fma_f32 v152, v152, s44, v18
    v_fma_f32 v153, v153, s44, v18
    v_fma_f32 v154, v154, s44, v18
    v_fma_f32 v155, v155, s44, v18
    v_fma_f32 v160, v160, s44, v18
    v_fma_f32 v161, v161, s44, v18
    v_fma_f32 v156, v156, s44, v18
    v_fma_f32 v157, v157, s44, v18
    v_fma_f32 v158, v158, s44, v18
    v_fma_f32 v159, v159, s44, v18
    v_exp_f32 v152, v152
    v_exp_f32 v153, v153
    v_exp_f32 v154, v154
    v_exp_f32 v155, v155
    v_exp_f32 v160, v160
    v_exp_f32 v161, v161
    v_exp_f32 v156, v156
    v_exp_f32 v157, v157
    v_exp_f32 v158, v158
    v_exp_f32 v159, v159
    v_add_f32 v20, v152, v153
    v_add_f32 v20, v20, v154
    v_add_f32 v20, v20, v155
    v_add_f32 v20, v20, v160
    v_add_f32 v20, v20, v161
    v_add_f32 v20, v20, v156
    v_add_f32 v20, v20, v157
    v_add_f32 v20, v20, v158
    v_add_f32 v20, v20, v159
    v_mov_b32 v19, v20
    s_nop 1
    v_permlane16_swap_b32 v20, v19
    v_add_f32 v20, v20, v19
    v_mov_b32 v19, v20
    s_nop 1
    v_permlane32_swap_b32 v20, v19
    v_add_f32 v20, v20, v19
    v_rcp_f32 v20, v20
    s_nop 0
    v_mul_f32 v152, v152, v20
    v_mul_f32 v153, v153, v20
    v_mul_f32 v154, v154, v20
    v_mul_f32 v155, v155, v20
    v_mul_f32 v160, v160, v20
    v_mul_f32 v161, v161, v20
    v_mul_f32 v156, v156, v20
    v_mul_f32 v157, v157, v20
    v_mul_f32 v158, v158, v20
    v_mul_f32 v159, v159, v20
    v_cvt_pk_bf16_f32 v168, v152, v153
    v_cvt_pk_bf16_f32 v169, v154, v155
    v_cvt_pk_bf16_f32 v170, v160, v161
    v_cvt_pk_bf16_f32 v172, v156, v157
    v_cvt_pk_bf16_f32 v173, v158, v159
    buffer_store_dwordx4 v[164:167], v12, s[4:7], s43 offen offset:0
    buffer_store_dwordx4 v[168:171], v12, s[4:7], s43 offen offset:1024
    buffer_store_dwordx4 v[172:175], v12, s[4:7], s43 offen offset:2048
    s_waitcnt vmcnt(0)
    buffer_store_dword v17, v15, s[4:7], s38 offen
    s_endpgm
L_pa_f:
    s_mov_b32 s24, s70
    s_and_b32 s25, s71, 0xffff
    s_mov_b32 s26, 2621440
    s_mov_b32 s27, 0x20000
    s_sub_u32 s93, s35, 29
    s_lshl_b32 s93, s93, 2
    s_add_u32 s93, s93, s32
    s_lshl_b32 s93, s93, 11
    v_lshl_add_u32 v4, v0, 4, s93
    v_mov_b32 v1, 192
L_gw_59:
    buffer_load_dword v2, v1, s[8:11], 0 offen sc1
    s_sub_u32 s36, s36, 1
    s_cbranch_scc1 L_exit
    s_waitcnt vmcnt(0)
L_gw_59c:
    v_readfirstlane_b32 s90, v2
    s_nop 0
    s_cmp_eq_u32 s90, 0
    s_cbranch_scc1 L_gw_59
    s_cmp_lg_u32 s90, 1
    s_cbranch_scc1 L_slow
    s_mov_b32 s92, 0
L_tch_60:
    s_add_u32 s91, s92, s38
    buffer_load_dwordx4 v[248:251], v4, s[4:7], s91 offen
    buffer_load_dwordx4 v[248:251], v4, s[4:7], s91 offen offset:1024
    s_add_u32 s92, s92, 24576
    s_waitcnt vmcnt(24)
    s_cmp_lt_u32 s92, 475136
    s_cbranch_scc1 L_tch_60
    s_mov_b32 s92, 81920
L_tch_61:
    s_add_u32 s91, s92, 0
    buffer_load_dwordx4 v[248:251], v4, s[24:27], s91 offen
    buffer_load_dwordx4 v[248:251], v4, s[24:27], s91 offen offset:1024
    s_add_u32 s92, s92, 24576
    s_waitcnt vmcnt(24)
    s_cmp_lt_u32 s92, 245760
    s_cbranch_scc1 L_tch_61
    s_mov_b32 s92, 475136
L_tch_62:
    s_add_u32 s91, s92, s38
    buffer_load_dwordx4 v[248:251], v4, s[4:7], s91 offen
    buffer_load_dwordx4 v[248:251], v4, s[4:7], s91 offen offset:1024
    s_add_u32 s92, s92, 24576
    s_waitcnt vmcnt(24)
    s_cmp_lt_u32 s92, 1048576
    s_cbranch_scc1 L_tch_62
    s_waitcnt vmcnt(0)
    s_branch L_pa_body
L_pa_body:
    s_sub_u32 s90, s35, 29
    s_cmp_ge_u32 s90, 3
    s_cbranch_scc1 L_pa_end
    s_mul_i32 s52, s90, 3
    s_add_u32 s52, s52, s34
    s_and_b32 s52, s52, 7
    s_cmp_eq_u32 s90, 0
    s_cselect_b32 s91, 0x76543210, 0
    s_cmp_eq_u32 s90, 1
    s_cselect_b32 s91, 0x54c321b0, s91
    s_cmp_eq_u32 s90, 2
    s_cselect_b32 s91, 0xf9ea87d6, s91
    s_lshl_b32 s92, s34, 2
    s_lshr_b32 s91, s91, s92
    s_and_b32 s91, s91, 15
    s_min_u32 s90, s90, 1
    s_lshl_b32 s90, s90, 3
    s_add_u32 s54, s90, s91
    s_mul_i32 s40, s54, 112
    s_lshl_b32 s90, s32, 5
    s_add_u32 s40, s40, s90
    s_sub_u32 s40, s40, 16
    s_mov_b32 s12, s64
    s_and_b32 s13, s65, 0xffff
    s_mov_b32 s14, 2621440
    s_mov_b32 s15, 0x20000
    s_mov_b32 s16, s66
    s_and_b32 s17, s67, 0xffff
    s_mov_b32 s18, 2457600
    s_mov_b32 s19, 0x20000
    s_mov_b32 s20, s68
    s_and_b32 s21, s69, 0xffff
    s_mov_b32 s22, 819200
    s_mov_b32 s23, 0x20000
    v_and_b32 v1, 15, v0
    v_lshrrev_b32 v2, 4, v0
    s_add_u32 s90, s40, 0
    v_add_u32 v3, s90, v1
    v_cmp_gt_u32 vcc, 2048, v3
    v_mul_u32_u24 v3, 1280, v3
    v_lshl_add_u32 v3, v2, 4, v3
    v_mov_b32 v4, 2146435072
    v_cndmask_b32 v3, v4, v3, vcc
    buffer_load_dwordx4 a[0:3], v3, s[12:15], 0 offen offset:0
    buffer_load_dwordx4 a[4:7], v3, s[12:15], 0 offen offset:64
    buffer_load_dwordx4 a[8:11], v3, s[12:15], 0 offen offset:128
    buffer_load_dwordx4 a[12:15], v3, s[12:15], 0 offen offset:192
    buffer_load_dwordx4 a[16:19], v3, s[12:15], 0 offen offset:256
    buffer_load_dwordx4 a[20:23], v3, s[12:15], 0 offen offset:320
    buffer_load_dwordx4 a[24:27], v3, s[12:15], 0 offen offset:384
    buffer_load_dwordx4 a[28:31], v3, s[12:15], 0 offen offset:448
    buffer_load_dwordx4 a[32:35], v3, s[12:15], 0 offen offset:512
    buffer_load_dwordx4 a[36:39], v3, s[12:15], 0 offen offset:576
    buffer_load_dwordx4 a[40:43], v3, s[12:15], 0 offen offset:640
    buffer_load_dwordx4 a[44:47], v3, s[12:15], 0 offen offset:704
    buffer_load_dwordx4 a[48:51], v3, s[12:15], 0 offen offset:768
    buffer_load_dwordx4 a[52:55], v3, s[12:15], 0 offen offset:832
    buffer_load_dwordx4 a[56:59], v3, s[12:15], 0 offen offset:896
    buffer_load_dwordx4 a[60:63], v3, s[12:15], 0 offen offset:960
    buffer_load_dwordx4 a[64:67], v3, s[12:15], 0 offen offset:1024
    buffer_load_dwordx4 a[68:71], v3, s[12:15], 0 offen offset:1088
    buffer_load_dwordx4 a[72:75], v3, s[12:15], 0 offen offset:1152
    buffer_load_dwordx4 a[76:79], v3, s[12:15], 0 offen offset:1216
    s_add_u32 s90, s40, 16
    v_add_u32 v3, s90, v1
    v_cmp_gt_u32 vcc, 2048, v3
    v_mul_u32_u24 v3, 1280, v3
    v_lshl_add_u32 v3, v2, 4, v3
    v_mov_b32 v4, 2146435072
    v_cndmask_b32 v3, v4, v3, vcc
    buffer_load_dwordx4 a[80:83], v3, s[12:15], 0 offen offset:0
    buffer_load_dwordx4 a[84:87], v3, s[12:15], 0 offen offset:64
    buffer_load_dwordx4 a[88:91], v3, s[12:15], 0 offen offset:128
    buffer_load_dwordx4 a[92:95], v3, s[12:15], 0 offen offset:192
    buffer_load_dwordx4 a[96:99], v3, s[12:15], 0 offen offset:256
    buffer_load_dwordx4 a[100:103], v3, s[12:15], 0 offen offset:320
    buffer_load_dwordx4 a[104:107], v3, s[12:15], 0 offen offset:384
    buffer_load_dwordx4 a[108:111], v3, s[12:15], 0 offen offset:448
    buffer_load_dwordx4 a[112:115], v3, s[12:15], 0 offen offset:512
    buffer_load_dwordx4 a[116:119], v3, s[12:15], 0 offen offset:576
    buffer_load_dwordx4 a[120:123], v3, s[12:15], 0 offen offset:640
    buffer_load_dwordx4 a[124:127], v3, s[12:15], 0 offen offset:704
    buffer_load_dwordx4 a[128:131], v3, s[12:15], 0 offen offset:768
    buffer_load_dwordx4 a[132:135], v3, s[12:15], 0 offen offset:832
    buffer_load_dwordx4 a[136:139], v3, s[12:15], 0 offen offset:896
    buffer_load_dwordx4 a[140:143], v3, s[12:15], 0 offen offset:960
    buffer_load_dwordx4 a[144:147], v3, s[12:15], 0 offen offset:1024
    buffer_load_dwordx4 a[148:151], v3, s[12:15], 0 offen offset:1088
    buffer_load_dwordx4 a[152:155], v3, s[12:15], 0 offen offset:1152
    buffer_load_dwordx4 a[156:159], v3, s[12:15], 0 offen offset:1216
    v_add_u32 v3, 0, v0
    v_mul_u32_u24 v4, 6554, v3
    v_lshrrev_b32 v4, 16, v4
    v_mul_u32_u24 v5, 10, v4
    v_sub_u32 v5, v3, v5
    v_and_b32 v6, 19, v4
    v_and_b32 v7, 4, v4
    v_lshl_or_b32 v6, v7, 1, v6
    v_and_b32 v7, 8, v4
    v_lshrrev_b32 v7, 1, v7
    v_or_b32 v6, v6, v7
    s_lshl_b32 s90, s32, 5
    v_add_u32 v6, s90, v6
    v_mul_u32_u24 v6, 3840, v6
    v_lshl_add_u32 v10, v5, 4, v6
    v_add_u32 v3, 64, v0
    v_mul_u32_u24 v4, 6554, v3
    v_lshrrev_b32 v4, 16, v4
    v_mul_u32_u24 v5, 10, v4
    v_sub_u32 v5, v3, v5
    v_and_b32 v6, 19, v4
    v_and_b32 v7, 4, v4
    v_lshl_or_b32 v6, v7, 1, v6
    v_and_b32 v7, 8, v4
    v_lshrrev_b32 v7, 1, v7
    v_or_b32 v6, v6, v7
    s_lshl_b32 s90, s32, 5
    v_add_u32 v6, s90, v6
    v_mul_u32_u24 v6, 3840, v6
    v_lshl_add_u32 v11, v5, 4, v6
    v_add_u32 v3, 128, v0
    v_mul_u32_u24 v4, 6554, v3
    v_lshrrev_b32 v4, 16, v4
    v_mul_u32_u24 v5, 10, v4
    v_sub_u32 v5, v3, v5
    v_and_b32 v6, 19, v4
    v_and_b32 v7, 4, v4
    v_lshl_or_b32 v6, v7, 1, v6
    v_and_b32 v7, 8, v4
    v_lshrrev_b32 v7, 1, v7
    v_or_b32 v6, v6, v7
    s_lshl_b32 s90, s32, 5
    v_add_u32 v6, s90, v6
    v_mul_u32_u24 v6, 3840, v6
    v_lshl_add_u32 v12, v5, 4, v6
    v_add_u32 v3, 192, v0
    v_mul_u32_u24 v4, 6554, v3
    v_lshrrev_b32 v4, 16, v4
    v_mul_u32_u24 v5, 10, v4
    v_sub_u32 v5, v3, v5
    v_and_b32 v6, 19, v4
    v_and_b32 v7, 4, v4
    v_lshl_or_b32 v6, v7, 1, v6
    v_and_b32 v7, 8, v4
    v_lshrrev_b32 v7, 1, v7
    v_or_b32 v6, v6, v7
    s_lshl_b32 s90, s32, 5
    v_add_u32 v6, s90, v6
    v_mul_u32_u24 v6, 3840, v6
    v_lshl_add_u32 v13, v5, 4, v6
    v_add_u32 v3, 256, v0
    v_mul_u32_u24 v4, 6554, v3
    v_lshrrev_b32 v4, 16, v4
    v_mul_u32_u24 v5, 10, v4
    v_sub_u32 v5, v3, v5
    v_and_b32 v6, 19, v4
    v_and_b32 v7, 4, v4
    v_lshl_or_b32 v6, v7, 1, v6
    v_and_b32 v7, 8, v4
    v_lshrrev_b32 v7, 1, v7
    v_or_b32 v6, v6, v7
    s_lshl_b32 s90, s32, 5
    v_add_u32 v6, s90, v6
    v_mul_u32_u24 v6, 3840, v6
    v_lshl_add_u32 v14, v5, 4, v6
    v_lshrrev_b32 v3, 2, v1
    v_and_b32 v4, 3, v1
    v_and_b32 v5, 1, v2
    v_lshl_add_u32 v3, v5, 2, v3
    v_lshrrev_b32 v6, 1, v2
    v_lshl_add_u32 v3, v6, 4, v3
    v_mul_u32_u24 v3, 160, v3
    v_lshl_add_u32 v15, v4, 3, v3
    s_lshl_b32 s90, s32, 5
    v_add_u32 v3, s90, v1
    v_mul_u32_u24 v3, 168, v3
    v_add_u32 v3, 81920, v3
    v_lshl_add_u32 v17, v2, 3, v3
    v_lshl_add_u32 v28, v2, 4, v3
    v_add_u32 v28, -32, v28
    v_lshl_add_u32 v3, v5, 4, v1
    v_add_u32 v4, s90, v3
    v_add_u32 v3, s40, v3
    v_cmp_le_u32 s[92:93], 16, v4
    v_cmp_gt_u32 vcc, 2048, v3
    s_nop 0
    s_and_b64 vcc, vcc, s[92:93]
    v_mul_u32_u24 v3, 2560, v3
    v_lshl_add_u32 v3, v6, 4, v3
    v_mov_b32 v4, 2146435072
    v_cndmask_b32 v19, v4, v3, vcc
    v_and_b32 v3, 31, v0
    v_add_u32 v24, s40, v3
    v_add_u32 v3, s90, v3
    v_mul_u32_u24 v3, 168, v3
    v_lshrrev_b32 v4, 5, v0
    v_mul_u32_u24 v4, 40, v4
    v_add_u32 v3, v3, v4
    v_add_u32 v20, 81920, v3
    v_add_u32 v21, 101072, v3
    v_mov_b32 v27, 0xcf8547b1
    s_mov_b32 s49, 0x3ea52b5c
    s_cmp_lt_u32 s54, 19
    s_cbranch_scc1 L_pa_rows
    s_mov_b32 s24, s70
    s_and_b32 s25, s71, 0xffff
    s_mov_b32 s26, 2621440
    s_mov_b32 s27, 0x20000
    s_sub_u32 s90, s54, 19
    s_lshl_b32 s90, s90, 2
    s_add_u32 s90, s90, s32
    s_lshl_b32 s90, s90, 11
    v_lshl_add_u32 v3, v0, 4, s90
    s_mov_b32 s91, 245760
L_pa_xw:
    buffer_load_dwordx4 v[248:251], v3, s[24:27], s91 offen
    buffer_load_dwordx4 v[248:251], v3, s[24:27], s91 offen offset:1024
    s_add_u32 s91, s91, 40960
    s_waitcnt vmcnt(20)
    s_cmp_lt_u32 s91, 2621440
    s_cbranch_scc1 L_pa_xw
    s_mov_b32 s46, 0
    s_mov_b32 s47, 0
    s_mul_i32 s43, s52, 160
    s_mov_b32 s44, 0
    s_mov_b32 s45, 0
    s_mov_b32 s51, 45
    s_mov_b32 s48, s52
    s_mov_b32 s53, 0
L_pa_pf_63:
    s_mul_i32 s90, s32, 5120
    s_add_u32 m0, s90, s47
    s_mul_i32 s91, s44, 491520
    s_add_u32 s91, s91, s43
    buffer_load_dwordx4 v[248:251], v10, s[16:19], s91 offen
    s_add_u32 s47, s47, 20480
    s_cmp_eq_u32 s47, 81920
    s_cselect_b32 s47, 0, s47
    s_cmp_lg_u32 s51, 0
    s_cselect_b32 s90, 1, 0
    s_sub_u32 s51, s51, s90
    s_add_u32 s44, s44, s90
    s_cmp_eq_u32 s44, 5
    s_cselect_b32 s44, 0, s44
    s_cselect_b32 s90, 1280, 0
    s_addc_u32 s45, s45, 0
    s_add_u32 s43, s43, s90
    s_cmp_eq_u32 s45, 3
    s_cselect_b32 s45, 0, s45
    s_cselect_b32 s90, 3680, 0
    s_cmp_eq_u32 s43, 4960
    s_cselect_b32 s90, s43, s90
    s_sub_u32 s43, s43, s90
    s_add_u32 m0, m0, 1024
    buffer_load_dwordx4 v[248:251], v11, s[16:19], s91 offen
    s_add_u32 m0, m0, 1024
    buffer_load_dwordx4 v[248:251], v12, s[16:19], s91 offen
    s_add_u32 m0, m0, 1024
    buffer_load_dwordx4 v[248:251], v13, s[16:19], s91 offen
    s_add_u32 m0, m0, 1024
    buffer_load_dwordx4 v[248:251], v14, s[16:19], s91 offen
    s_waitcnt vmcnt(20)
    s_cmp_lg_u32 s51, 0
    s_cbranch_scc1 L_pa_pf_63
    v_add_u32 v3, 0, v0
    v_mul_u32_u24 v4, 6554, v3
    v_lshrrev_b32 v4, 16, v4
    v_mul_u32_u24 v5, 10, v4
    v_sub_u32 v5, v3, v5
    v_and_b32 v6, 19, v4
    v_and_b32 v7, 4, v4
    v_lshl_or_b32 v6, v7, 1, v6
    v_and_b32 v7, 8, v4
    v_lshrrev_b32 v7, 1, v7
    v_or_b32 v6, v6, v7
    s_lshl_b32 s90, s32, 5
    v_add_u32 v6, s90, v6
    v_mul_u32_u24 v6, 1280, v6
    v_lshl_add_u32 v10, v5, 4, v6
    v_add_u32 v3, 64, v0
    v_mul_u32_u24 v4, 6554, v3
    v_lshrrev_b32 v4, 16, v4
    v_mul_u32_u24 v5, 10, v4
    v_sub_u32 v5, v3, v5
    v_and_b32 v6, 19, v4
    v_and_b32 v7, 4, v4
    v_lshl_or_b32 v6, v7, 1, v6
    v_and_b32 v7, 8, v4
    v_lshrrev_b32 v7, 1, v7
    v_or_b32 v6, v6, v7
    s_lshl_b32 s90, s32, 5
    v_add_u32 v6, s90, v6
    v_mul_u32_u24 v6, 1280, v6
    v_lshl_add_u32 v11, v5, 4, v6
    v_add_u32 v3, 128, v0
    v_mul_u32_u24 v4, 6554, v3
    v_lshrrev_b32 v4, 16, v4
    v_mul_u32_u24 v5, 10, v4
    v_sub_u32 v5, v3, v5
    v_and_b32 v6, 19, v4
    v_and_b32 v7, 4, v4
    v_lshl_or_b32 v6, v7, 1, v6
    v_and_b32 v7, 8, v4
    v_lshrrev_b32 v7, 1, v7
    v_or_b32 v6, v6, v7
    s_lshl_b32 s90, s32, 5
    v_add_u32 v6, s90, v6
    v_mul_u32_u24 v6, 1280, v6
    v_lshl_add_u32 v12, v5, 4, v6
    v_add_u32 v3, 192, v0
    v_mul_u32_u24 v4, 6554, v3
    v_lshrrev_b32 v4, 16, v4
    v_mul_u32_u24 v5, 10, v4
    v_sub_u32 v5, v3, v5
    v_and_b32 v6, 19, v4
    v_and_b32 v7, 4, v4
    v_lshl_or_b32 v6, v7, 1, v6
    v_and_b32 v7, 8, v4
    v_lshrrev_b32 v7, 1, v7
    v_or_b32 v6, v6, v7
    s_lshl_b32 s90, s32, 5
    v_add_u32 v6, s90, v6
    v_mul_u32_u24 v6, 1280, v6
    v_lshl_add_u32 v13, v5, 4, v6
    v_add_u32 v3, 256, v0
    v_mul_u32_u24 v4, 6554, v3
    v_lshrrev_b32 v4, 16, v4
    v_mul_u32_u24 v5, 10, v4
    v_sub_u32 v5, v3, v5
    v_and_b32 v6, 19, v4
    v_and_b32 v7, 4, v4
    v_lshl_or_b32 v6, v7, 1, v6
    v_and_b32 v7, 8, v4
    v_lshrrev_b32 v7, 1, v7
    v_or_b32 v6, v6, v7
    s_lshl_b32 s90, s32, 5
    v_add_u32 v6, s90, v6
    v_mul_u32_u24 v6, 1280, v6
    v_lshl_add_u32 v14, v5, 4, v6
    s_mov_b32 s46, 0
    s_mov_b32 s47, 0
    s_mul_i32 s43, s52, 160
    s_mov_b32 s44, 0
    s_mov_b32 s45, 0
    s_mov_b32 s51, 40
    s_mov_b32 s48, s52
    s_mov_b32 s53, 0
L_pa_pf_64:
    s_mul_i32 s90, s32, 5120
    s_add_u32 m0, s90, s47
    s_mul_i32 s91, s44, 163840
    s_add_u32 s91, s91, s43
    buffer_load_dwordx4 v[248:251], v10, s[20:23], s91 offen
    s_add_u32 s47, s47, 20480
    s_cmp_eq_u32 s47, 81920
    s_cselect_b32 s47, 0, s47
    s_cmp_lg_u32 s51, 0
    s_cselect_b32 s90, 1, 0
    s_sub_u32 s51, s51, s90
    s_add_u32 s44, s44, s90
    s_cmp_eq_u32 s44, 5
    s_cselect_b32 s44, 0, s44
    s_cselect_b32 s90, 160, 0
    s_add_u32 s43, s43, s90
    s_cmp_eq_u32 s43, 1280
    s_cselect_b32 s43, 0, s43
    s_add_u32 m0, m0, 1024
    buffer_load_dwordx4 v[248:251], v11, s[20:23], s91 offen
    s_add_u32 m0, m0, 1024
    buffer_load_dwordx4 v[248:251], v12, s[20:23], s91 offen
    s_add_u32 m0, m0, 1024
    buffer_load_dwordx4 v[248:251], v13, s[20:23], s91 offen
    s_add_u32 m0, m0, 1024
    buffer_load_dwordx4 v[248:251], v14, s[20:23], s91 offen
    s_waitcnt vmcnt(20)
    s_cmp_lg_u32 s51, 0
    s_cbranch_scc1 L_pa_pf_64
    s_branch L_pa_end
L_pa_rows:
    s_mov_b32 s46, 0
    s_mov_b32 s47, 0
    s_mul_i32 s43, s52, 160
    s_mov_b32 s44, 0
    s_mov_b32 s45, 0
    s_mov_b32 s51, 119
    s_mov_b32 s48, s52
    s_mov_b32 s53, 0
    s_mul_i32 s90, s32, 5120
    s_add_u32 m0, s90, s47
    s_mul_i32 s91, s44, 491520
    s_add_u32 s91, s91, s43
    buffer_load_dwordx4 v10, s[16:19], s91 offen lds
    s_add_u32 s47, s47, 20480
    s_cmp_eq_u32 s47, 81920
    s_cselect_b32 s47, 0, s47
    s_cmp_lg_u32 s51, 0
    s_cselect_b32 s90, 1, 0
    s_sub_u32 s51, s51, s90
    s_add_u32 s44, s44, s90
    s_cmp_eq_u32 s44, 5
    s_cselect_b32 s44, 0, s44
    s_cselect_b32 s90, 1280, 0
    s_addc_u32 s45, s45, 0
    s_add_u32 s43, s43, s90
    s_cmp_eq_u32 s45, 3
    s_cselect_b32 s45, 0, s45
    s_cselect_b32 s90, 3680, 0
    s_cmp_eq_u32 s43, 4960
    s_cselect_b32 s90, s43, s90
    s_sub_u32 s43, s43, s90
    s_add_u32 m0, m0, 1024
    s_nop 0
    buffer_load_dwordx4 v11, s[16:19], s91 offen lds
    s_add_u32 m0, m0, 1024
    s_nop 0
    buffer_load_dwordx4 v12, s[16:19], s91 offen lds
    s_add_u32 m0, m0, 1024
    s_nop 0
    buffer_load_dwordx4 v13, s[16:19], s91 offen lds
    s_add_u32 m0, m0, 1024
    s_nop 0
    buffer_load_dwordx4 v14, s[16:19], s91 offen lds
    s_mul_i32 s90, s32, 5120
    s_add_u32 m0, s90, s47
    s_mul_i32 s91, s44, 491520
    s_add_u32 s91, s91, s43
    buffer_load_dwordx4 v10, s[16:19], s91 offen lds
    s_add_u32 s47, s47, 20480
    s_cmp_eq_u32 s47, 81920
    s_cselect_b32 s47, 0, s47
    s_cmp_lg_u32 s51, 0
    s_cselect_b32 s90, 1, 0
    s_sub_u32 s51, s51, s90
    s_add_u32 s44, s44, s90
    s_cmp_eq_u32 s44, 5
    s_cselect_b32 s44, 0, s44
    s_cselect_b32 s90, 1280, 0
    s_addc_u32 s45, s45, 0
    s_add_u32 s43, s43, s90
    s_cmp_eq_u32 s45, 3
    s_cselect_b32 s45, 0, s45
    s_cselect_b32 s90, 3680, 0
    s_cmp_eq_u32 s43, 4960
    s_cselect_b32 s90, s43, s90
    s_sub_u32 s43, s43, s90
    s_add_u32 m0, m0, 1024
    s_nop 0
    buffer_load_dwordx4 v11, s[16:19], s91 offen lds
    s_add_u32 m0, m0, 1024
    s_nop 0
    buffer_load_dwordx4 v12, s[16:19], s91 offen lds
    s_add_u32 m0, m0, 1024
    s_nop 0
    buffer_load_dwordx4 v13, s[16:19], s91 offen lds
    s_add_u32 m0, m0, 1024
    s_nop 0
    buffer_load_dwordx4 v14, s[16:19], s91 offen lds
    s_mul_i32 s90, s32, 5120
    s_add_u32 m0, s90, s47
    s_mul_i32 s91, s44, 491520
    s_add_u32 s91, s91, s43
    buffer_load_dwordx4 v10, s[16:19], s91 offen lds
    s_add_u32 s47, s47, 20480
    s_cmp_eq_u32 s47, 81920
    s_cselect_b32 s47, 0, s47
    s_cmp_lg_u32 s51, 0
    s_cselect_b32 s90, 1, 0
    s_sub_u32 s51, s51, s90
    s_add_u32 s44, s44, s90
    s_cmp_eq_u32 s44, 5
    s_cselect_b32 s44, 0, s44
    s_cselect_b32 s90, 1280, 0
    s_addc_u32 s45, s45, 0
    s_add_u32 s43, s43, s90
    s_cmp_eq_u32 s45, 3
    s_cselect_b32 s45, 0, s45
    s_cselect_b32 s90, 3680, 0
    s_cmp_eq_u32 s43, 4960
    s_cselect_b32 s90, s43, s90
    s_sub_u32 s43, s43, s90
    s_add_u32 m0, m0, 1024
    s_nop 0
    buffer_load_dwordx4 v11, s[16:19], s91 offen lds
    s_add_u32 m0, m0, 1024
    s_nop 0
    buffer_load_dwordx4 v12, s[16:19], s91 offen lds
    s_add_u32 m0, m0, 1024
    s_nop 0
    buffer_load_dwordx4 v13, s[16:19], s91 offen lds
    s_add_u32 m0, m0, 1024
    s_nop 0
    buffer_load_dwordx4 v14, s[16:19], s91 offen lds
    v_add_u32 v16, s46, v15
    s_waitcnt vmcnt(10) lgkmcnt(0)
    s_barrier
    ds_read_b64_tr_b16 v[96:97], v16 offset:0
    ds_read_b64_tr_b16 v[98:99], v16 offset:1280
    ds_read_b64_tr_b16 v[100:101], v16 offset:32
    ds_read_b64_tr_b16 v[102:103], v16 offset:1312
    ds_read_b64_tr_b16 v[104:105], v16 offset:64
    ds_read_b64_tr_b16 v[106:107], v16 offset:1344
    ds_read_b64_tr_b16 v[108:109], v16 offset:96
    ds_read_b64_tr_b16 v[110:111], v16 offset:1376
    ds_read_b64_tr_b16 v[112:113], v16 offset:128
    ds_read_b64_tr_b16 v[114:115], v16 offset:1408
L_pa_grp:
    s_mov_b32 s41, 0
L_pa_blk:
    s_waitcnt lgkmcnt(8)
    v_mfma_f32_16x16x32_bf16 v[136:139], v[96:99], a[0:3], 0
    ds_read_b64_tr_b16 v[116:117], v16 offset:5120
    s_add_u32 s46, s46, 20480
    s_cmp_eq_u32 s46, 81920
    v_mfma_f32_16x16x32_bf16 v[140:143], v[96:99], a[80:83], 0
    ds_read_b64_tr_b16 v[118:119], v16 offset:6400
    s_cselect_b32 s46, 0, s46
    s_mul_i32 s90, s32, 5120
    s_waitcnt lgkmcnt(8)
    v_mfma_f32_16x16x32_bf16 v[144:147], v[100:103], a[0:3], 0
    ds_read_b64_tr_b16 v[120:121], v16 offset:5152
    s_add_u32 m0, s90, s47
    s_mul_i32 s91, s44, 491520
    v_mfma_f32_16x16x32_bf16 v[148:151], v[100:103], a[80:83], 0
    ds_read_b64_tr_b16 v[122:123], v16 offset:6432
    s_add_u32 s91, s91, s43
    buffer_load_dwordx4 v10, s[16:19], s91 offen lds
    s_waitcnt lgkmcnt(8)
    v_mfma_f32_16x16x32_bf16 v[152:155], v[104:107], a[0:3], 0
    ds_read_b64_tr_b16 v[124:125], v16 offset:5184
    s_add_u32 s47, s47, 20480
    s_cmp_eq_u32 s47, 81920
    v_mfma_f32_16x16x32_bf16 v[156:159], v[104:107], a[80:83], 0
    ds_read_b64_tr_b16 v[126:127], v16 offset:6464
    s_cselect_b32 s47, 0, s47
    s_cmp_lg_u32 s51, 0
    s_waitcnt lgkmcnt(8)
    v_mfma_f32_16x16x32_bf16 v[160:163], v[108:111], a[0:3], 0
    ds_read_b64_tr_b16 v[128:129], v16 offset:5216
    s_cselect_b32 s90, 1, 0
    s_sub_u32 s51, s51, s90
    v_mfma_f32_16x16x32_bf16 v[164:167], v[108:111], a[80:83], 0
    ds_read_b64_tr_b16 v[130:131], v16 offset:6496
    s_add_u32 s44, s44, s90
    s_cmp_eq_u32 s44, 5
    s_waitcnt lgkmcnt(8)
    v_mfma_f32_16x16x32_bf16 v[168:171], v[112:115], a[0:3], 0
    ds_read_b64_tr_b16 v[132:133], v16 offset:5248
    s_cselect_b32 s44, 0, s44
    s_cselect_b32 s90, 1280, 0
    v_mfma_f32_16x16x32_bf16 v[172:175], v[112:115], a[80:83], 0
    ds_read_b64_tr_b16 v[134:135], v16 offset:6528
    s_addc_u32 s45, s45, 0
    s_add_u32 s43, s43, s90
    s_waitcnt lgkmcnt(8)
    v_mfma_f32_16x16x32_bf16 v[136:139], v[116:119], a[4:7], v[136:139]
    ds_read_b64_tr_b16 v[96:97], v16 offset:10240
    s_cmp_eq_u32 s45, 3
    s_cselect_b32 s45, 0, s45
    v_mfma_f32_16x16x32_bf16 v[140:143], v[116:119], a[84:87], v[140:143]
    ds_read_b64_tr_b16 v[98:99], v16 offset:11520
    s_cselect_b32 s90, 3680, 0
    s_cmp_eq_u32 s43, 4960
    s_waitcnt lgkmcnt(8)
    v_mfma_f32_16x16x32_bf16 v[144:147], v[120:123], a[4:7], v[144:147]
    ds_read_b64_tr_b16 v[100:101], v16 offset:10272
    s_cselect_b32 s90, s43, s90
    s_sub_u32 s43, s43, s90
    v_mfma_f32_16x16x32_bf16 v[148:151], v[120:123], a[84:87], v[148:151]
    ds_read_b64_tr_b16 v[102:103], v16 offset:11552
    s_add_u32 m0, m0, 1024
    s_nop 0
    buffer_load_dwordx4 v11, s[16:19], s91 offen lds
    s_waitcnt lgkmcnt(8)
    v_mfma_f32_16x16x32_bf16 v[152:155], v[124:127], a[4:7], v[152:155]
    ds_read_b64_tr_b16 v[104:105], v16 offset:10304
    s_add_u32 m0, m0, 1024
    v_mfma_f32_16x16x32_bf16 v[156:159], v[124:127], a[84:87], v[156:159]
    ds_read_b64_tr_b16 v[106:107], v16 offset:11584
    s_waitcnt lgkmcnt(8)
    v_mfma_f32_16x16x32_bf16 v[160:163], v[128:131], a[4:7], v[160:163]
    ds_read_b64_tr_b16 v[108:109], v16 offset:10336
    v_mfma_f32_16x16x32_bf16 v[164:167], v[128:131], a[84:87], v[164:167]
    ds_read_b64_tr_b16 v[110:111], v16 offset:11616
    s_waitcnt lgkmcnt(8)
    v_mfma_f32_16x16x32_bf16 v[168:171], v[132:135], a[4:7], v[168:171]
    ds_read_b64_tr_b16 v[112:113], v16 offset:10368
    buffer_load_dwordx4 v12, s[16:19], s91 offen lds
    s_add_u32 m0, m0, 1024
    v_mfma_f32_16x16x32_bf16 v[172:175], v[132:135], a[84:87], v[172:175]
    ds_read_b64_tr_b16 v[114:115], v16 offset:11648
    s_waitcnt lgkmcnt(8)
    v_mfma_f32_16x16x32_bf16 v[136:139], v[96:99], a[8:11], v[136:139]
    ds_read_b64_tr_b16 v[116:117], v16 offset:15360
    v_mfma_f32_16x16x32_bf16 v[140:143], v[96:99], a[88:91], v[140:143]
    ds_read_b64_tr_b16 v[118:119], v16 offset:16640
    s_waitcnt lgkmcnt(8)
    v_mfma_f32_16x16x32_bf16 v[144:147], v[100:103], a[8:11], v[144:147]
    ds_read_b64_tr_b16 v[120:121], v16 offset:15392
    v_mfma_f32_16x16x32_bf16 v[148:151], v[100:103], a[88:91], v[148:151]
    ds_read_b64_tr_b16 v[122:123], v16 offset:16672
    buffer_load_dwordx4 v13, s[16:19], s91 offen lds
    s_add_u32 m0, m0, 1024
    s_waitcnt lgkmcnt(8)
    v_mfma_f32_16x16x32_bf16 v[152:155], v[104:107], a[8:11], v[152:155]
    ds_read_b64_tr_b16 v[124:125], v16 offset:15424
    v_mfma_f32_16x16x32_bf16 v[156:159], v[104:107], a[88:91], v[156:159]
    ds_read_b64_tr_b16 v[126:127], v16 offset:16704
    s_waitcnt lgkmcnt(8)
    v_mfma_f32_16x16x32_bf16 v[160:163], v[108:111], a[8:11], v[160:163]
    ds_read_b64_tr_b16 v[128:129], v16 offset:15456
    v_mfma_f32_16x16x32_bf16 v[164:167], v[108:111], a[88:91], v[164:167]
    ds_read_b64_tr_b16 v[130:131], v16 offset:16736
    s_waitcnt lgkmcnt(8)
    v_mfma_f32_16x16x32_bf16 v[168:171], v[112:115], a[8:11], v[168:171]
    ds_read_b64_tr_b16 v[132:133], v16 offset:15488
    buffer_load_dwordx4 v14, s[16:19], s91 offen lds
    v_mfma_f32_16x16x32_bf16 v[172:175], v[112:115], a[88:91], v[172:175]
    ds_read_b64_tr_b16 v[134:135], v16 offset:16768
    s_waitcnt lgkmcnt(8)
    v_mfma_f32_16x16x32_bf16 v[136:139], v[116:119], a[12:15], v[136:139]
    v_mfma_f32_16x16x32_bf16 v[140:143], v[116:119], a[92:95], v[140:143]
    s_waitcnt lgkmcnt(6)
    v_mfma_f32_16x16x32_bf16 v[144:147], v[120:123], a[12:15], v[144:147]
    v_mfma_f32_16x16x32_bf16 v[148:151], v[120:123], a[92:95], v[148:151]
    v_add_u32 v16, s46, v15
    s_waitcnt vmcnt(10) lgkmcnt(0)
    s_barrier
    v_mfma_f32_16x16x32_bf16 v[152:155], v[124:127], a[12:15], v[152:155]
    ds_read_b64_tr_b16 v[96:97], v16 offset:0
    ds_read_b64_tr_b16 v[98:99], v16 offset:1280
    v_mfma_f32_16x16x32_bf16 v[156:159], v[124:127], a[92:95], v[156:159]
    ds_read_b64_tr_b16 v[100:101], v16 offset:32
    ds_read_b64_tr_b16 v[102:103], v16 offset:1312
    v_mfma_f32_16x16x32_bf16 v[160:163], v[128:131], a[12:15], v[160:163]
    ds_read_b64_tr_b16 v[104:105], v16 offset:64
    ds_read_b64_tr_b16 v[106:107], v16 offset:1344
    v_mfma_f32_16x16x32_bf16 v[164:167], v[128:131], a[92:95], v[164:167]
    ds_read_b64_tr_b16 v[108:109], v16 offset:96
    ds_read_b64_tr_b16 v[110:111], v16 offset:1376
    v_mfma_f32_16x16x32_bf16 v[168:171], v[132:135], a[12:15], v[168:171]
    ds_read_b64_tr_b16 v[112:113], v16 offset:128
    ds_read_b64_tr_b16 v[114:115], v16 offset:1408
    v_mfma_f32_16x16x32_bf16 v[172:175], v[132:135], a[92:95], v[172:175]
    s_waitcnt lgkmcnt(8)
    v_mfma_f32_16x16x32_bf16 v[136:139], v[96:99], a[16:19], v[136:139]
    ds_read_b64_tr_b16 v[116:117], v16 offset:5120
    s_add_u32 s46, s46, 20480
    s_cmp_eq_u32 s46, 81920
    v_mfma_f32_16x16x32_bf16 v[140:143], v[96:99], a[96:99], v[140:143]
    ds_read_b64_tr_b16 v[118:119], v16 offset:6400
    s_cselect_b32 s46, 0, s46
    s_mul_i32 s90, s32, 5120
    s_waitcnt lgkmcnt(8)
    v_mfma_f32_16x16x32_bf16 v[144:147], v[100:103], a[16:19], v[144:147]
    ds_read_b64_tr_b16 v[120:121], v16 offset:5152
    s_add_u32 m0, s90, s47
    s_mul_i32 s91, s44, 491520
    v_mfma_f32_16x16x32_bf16 v[148:151], v[100:103], a[96:99], v[148:151]
    ds_read_b64_tr_b16 v[122:123], v16 offset:6432
    s_add_u32 s91, s91, s43
    buffer_load_dwordx4 v10, s[16:19], s91 offen lds
    s_waitcnt lgkmcnt(8)
    v_mfma_f32_16x16x32_bf16 v[152:155], v[104:107], a[16:19], v[152:155]
    ds_read_b64_tr_b16 v[124:125], v16 offset:5184
    s_add_u32 s47, s47, 20480
    s_cmp_eq_u32 s47, 81920
    v_mfma_f32_16x16x32_bf16 v[156:159], v[104:107], a[96:99], v[156:159]
    ds_read_b64_tr_b16 v[126:127], v16 offset:6464
    s_cselect_b32 s47, 0, s47
    s_cmp_lg_u32 s51, 0
    s_waitcnt lgkmcnt(8)
    v_mfma_f32_16x16x32_bf16 v[160:163], v[108:111], a[16:19], v[160:163]
    ds_read_b64_tr_b16 v[128:129], v16 offset:5216
    s_cselect_b32 s90, 1, 0
    s_sub_u32 s51, s51, s90
    v_mfma_f32_16x16x32_bf16 v[164:167], v[108:111], a[96:99], v[164:167]
    ds_read_b64_tr_b16 v[130:131], v16 offset:6496
    s_add_u32 s44, s44, s90
    s_cmp_eq_u32 s44, 5
    s_waitcnt lgkmcnt(8)
    v_mfma_f32_16x16x32_bf16 v[168:171], v[112:115], a[16:19], v[168:171]
    ds_read_b64_tr_b16 v[132:133], v16 offset:5248
    s_cselect_b32 s44, 0, s44
    s_cselect_b32 s90, 1280, 0
    v_mfma_f32_16x16x32_bf16 v[172:175], v[112:115], a[96:99], v[172:175]
    ds_read_b64_tr_b16 v[134:135], v16 offset:6528
    s_addc_u32 s45, s45, 0
    s_add_u32 s43, s43, s90
    s_waitcnt lgkmcnt(8)
    v_mfma_f32_16x16x32_bf16 v[136:139], v[116:119], a[20:23], v[136:139]
    ds_read_b64_tr_b16 v[96:97], v16 offset:10240
    s_cmp_eq_u32 s45, 3
    s_cselect_b32 s45, 0, s45
    v_mfma_f32_16x16x32_bf16 v[140:143], v[116:119], a[100:103], v[140:143]
    ds_read_b64_tr_b16 v[98:99], v16 offset:11520
    s_cselect_b32 s90, 3680, 0
    s_cmp_eq_u32 s43, 4960
    s_waitcnt lgkmcnt(8)
    v_mfma_f32_16x16x32_bf16 v[144:147], v[120:123], a[20:23], v[144:147]
    ds_read_b64_tr_b16 v[100:101], v16 offset:10272
    s_cselect_b32 s90, s43, s90
    s_sub_u32 s43, s43, s90
    v_mfma_f32_16x16x32_bf16 v[148:151], v[120:123], a[100:103], v[148:151]
    ds_read_b64_tr_b16 v[102:103], v16 offset:11552
    s_add_u32 m0, m0, 1024
    s_nop 0
    buffer_load_dwordx4 v11, s[16:19], s91 offen lds
    s_waitcnt lgkmcnt(8)
    v_mfma_f32_16x16x32_bf16 v[152:155], v[124:127], a[20:23], v[152:155]
    ds_read_b64_tr_b16 v[104:105], v16 offset:10304
    s_add_u32 m0, m0, 1024
    v_mfma_f32_16x16x32_bf16 v[156:159], v[124:127], a[100:103], v[156:159]
    ds_read_b64_tr_b16 v[106:107], v16 offset:11584
    s_waitcnt lgkmcnt(8)
    v_mfma_f32_16x16x32_bf16 v[160:163], v[128:131], a[20:23], v[160:163]
    ds_read_b64_tr_b16 v[108:109], v16 offset:10336
    v_mfma_f32_16x16x32_bf16 v[164:167], v[128:131], a[100:103], v[164:167]
    ds_read_b64_tr_b16 v[110:111], v16 offset:11616
    s_waitcnt lgkmcnt(8)
    v_mfma_f32_16x16x32_bf16 v[168:171], v[132:135], a[20:23], v[168:171]
    ds_read_b64_tr_b16 v[112:113], v16 offset:10368
    buffer_load_dwordx4 v12, s[16:19], s91 offen lds
    s_add_u32 m0, m0, 1024
    v_mfma_f32_16x16x32_bf16 v[172:175], v[132:135], a[100:103], v[172:175]
    ds_read_b64_tr_b16 v[114:115], v16 offset:11648
    s_waitcnt lgkmcnt(8)
    v_mfma_f32_16x16x32_bf16 v[136:139], v[96:99], a[24:27], v[136:139]
    ds_read_b64_tr_b16 v[116:117], v16 offset:15360
    v_mfma_f32_16x16x32_bf16 v[140:143], v[96:99], a[104:107], v[140:143]
    ds_read_b64_tr_b16 v[118:119], v16 offset:16640
    s_waitcnt lgkmcnt(8)
    v_mfma_f32_16x16x32_bf16 v[144:147], v[100:103], a[24:27], v[144:147]
    ds_read_b64_tr_b16 v[120:121], v16 offset:15392
    v_mfma_f32_16x16x32_bf16 v[148:151], v[100:103], a[104:107], v[148:151]
    ds_read_b64_tr_b16 v[122:123], v16 offset:16672
    buffer_load_dwordx4 v13, s[16:19], s91 offen lds
    s_add_u32 m0, m0, 1024
    s_waitcnt lgkmcnt(8)
    v_mfma_f32_16x16x32_bf16 v[152:155], v[104:107], a[24:27], v[152:155]
    ds_read_b64_tr_b16 v[124:125], v16 offset:15424
    v_mfma_f32_16x16x32_bf16 v[156:159], v[104:107], a[104:107], v[156:159]
    ds_read_b64_tr_b16 v[126:127], v16 offset:16704
    s_waitcnt lgkmcnt(8)
    v_mfma_f32_16x16x32_bf16 v[160:163], v[108:111], a[24:27], v[160:163]
    ds_read_b64_tr_b16 v[128:129], v16 offset:15456
    v_mfma_f32_16x16x32_bf16 v[164:167], v[108:111], a[104:107], v[164:167]
    ds_read_b64_tr_b16 v[130:131], v16 offset:16736
    s_waitcnt lgkmcnt(8)
    v_mfma_f32_16x16x32_bf16 v[168:171], v[112:115], a[24:27], v[168:171]
    ds_read_b64_tr_b16 v[132:133], v16 offset:15488
    buffer_load_dwordx4 v14, s[16:19], s91 offen lds
    v_mfma_f32_16x16x32_bf16 v[172:175], v[112:115], a[104:107], v[172:175]
    ds_read_b64_tr_b16 v[134:135], v16 offset:16768
    s_waitcnt lgkmcnt(8)
    v_mfma_f32_16x16x32_bf16 v[136:139], v[116:119], a[28:31], v[136:139]
    v_mfma_f32_16x16x32_bf16 v[140:143], v[116:119], a[108:111], v[140:143]
    s_waitcnt lgkmcnt(6)
    v_mfma_f32_16x16x32_bf16 v[144:147], v[120:123], a[28:31], v[144:147]
    v_mfma_f32_16x16x32_bf16 v[148:151], v[120:123], a[108:111], v[148:151]
    v_add_u32 v16, s46, v15
    s_waitcnt vmcnt(10) lgkmcnt(0)
    s_barrier
    v_mfma_f32_16x16x32_bf16 v[152:155], v[124:127], a[28:31], v[152:155]
    ds_read_b64_tr_b16 v[96:97], v16 offset:0
    ds_read_b64_tr_b16 v[98:99], v16 offset:1280
    v_mfma_f32_16x16x32_bf16 v[156:159], v[124:127], a[108:111], v[156:159]
    ds_read_b64_tr_b16 v[100:101], v16 offset:32
    ds_read_b64_tr_b16 v[102:103], v16 offset:1312
    v_mfma_f32_16x16x32_bf16 v[160:163], v[128:131], a[28:31], v[160:163]
    ds_read_b64_tr_b16 v[104:105], v16 offset:64
    ds_read_b64_tr_b16 v[106:107], v16 offset:1344
    v_mfma_f32_16x16x32_bf16 v[164:167], v[128:131], a[108:111], v[164:167]
    ds_read_b64_tr_b16 v[108:109], v16 offset:96
    ds_read_b64_tr_b16 v[110:111], v16 offset:1376
    v_mfma_f32_16x16x32_bf16 v[168:171], v[132:135], a[28:31], v[168:171]
    ds_read_b64_tr_b16 v[112:113], v16 offset:128
    ds_read_b64_tr_b16 v[114:115], v16 offset:1408
    v_mfma_f32_16x16x32_bf16 v[172:175], v[132:135], a[108:111], v[172:175]
    s_waitcnt lgkmcnt(8)
    v_mfma_f32_16x16x32_bf16 v[136:139], v[96:99], a[32:35], v[136:139]
    ds_read_b64_tr_b16 v[116:117], v16 offset:5120
    s_add_u32 s46, s46, 20480
    s_cmp_eq_u32 s46, 81920
    v_mfma_f32_16x16x32_bf16 v[140:143], v[96:99], a[112:115], v[140:143]
    ds_read_b64_tr_b16 v[118:119], v16 offset:6400
    s_cselect_b32 s46, 0, s46
    s_mul_i32 s90, s32, 5120
    s_waitcnt lgkmcnt(8)
    v_mfma_f32_16x16x32_bf16 v[144:147], v[100:103], a[32:35], v[144:147]
    ds_read_b64_tr_b16 v[120:121], v16 offset:5152
    s_add_u32 m0, s90, s47
    s_mul_i32 s91, s44, 491520
    v_mfma_f32_16x16x32_bf16 v[148:151], v[100:103], a[112:115], v[148:151]
    ds_read_b64_tr_b16 v[122:123], v16 offset:6432
    s_add_u32 s91, s91, s43
    buffer_load_dwordx4 v10, s[16:19], s91 offen lds
    s_waitcnt lgkmcnt(8)
    v_mfma_f32_16x16x32_bf16 v[152:155], v[104:107], a[32:35], v[152:155]
    ds_read_b64_tr_b16 v[124:125], v16 offset:5184
    s_add_u32 s47, s47, 20480
    s_cmp_eq_u32 s47, 81920
    v_mfma_f32_16x16x32_bf16 v[156:159], v[104:107], a[112:115], v[156:159]
    ds_read_b64_tr_b16 v[126:127], v16 offset:6464
    s_cselect_b32 s47, 0, s47
    s_cmp_lg_u32 s51, 0
    s_waitcnt lgkmcnt(8)
    v_mfma_f32_16x16x32_bf16 v[160:163], v[108:111], a[32:35], v[160:163]
    ds_read_b64_tr_b16 v[128:129], v16 offset:5216
    s_cselect_b32 s90, 1, 0
    s_sub_u32 s51, s51, s90
    v_mfma_f32_16x16x32_bf16 v[164:167], v[108:111], a[112:115], v[164:167]
    ds_read_b64_tr_b16 v[130:131], v16 offset:6496
    s_add_u32 s44, s44, s90
    s_cmp_eq_u32 s44, 5
    s_waitcnt lgkmcnt(8)
    v_mfma_f32_16x16x32_bf16 v[168:171], v[112:115], a[32:35], v[168:171]
    ds_read_b64_tr_b16 v[132:133], v16 offset:5248
    s_cselect_b32 s44, 0, s44
    s_cselect_b32 s90, 1280, 0
    v_mfma_f32_16x16x32_bf16 v[172:175], v[112:115], a[112:115], v[172:175]
    ds_read_b64_tr_b16 v[134:135], v16 offset:6528
    s_addc_u32 s45, s45, 0
    s_add_u32 s43, s43, s90
    s_waitcnt lgkmcnt(8)
    v_mfma_f32_16x16x32_bf16 v[136:139], v[116:119], a[36:39], v[136:139]
    ds_read_b64_tr_b16 v[96:97], v16 offset:10240
    s_cmp_eq_u32 s45, 3
    s_cselect_b32 s45, 0, s45
    v_mfma_f32_16x16x32_bf16 v[140:143], v[116:119], a[116:119], v[140:143]
    ds_read_b64_tr_b16 v[98:99], v16 offset:11520
    s_cselect_b32 s90, 3680, 0
    s_cmp_eq_u32 s43, 4960
    s_waitcnt lgkmcnt(8)
    v_mfma_f32_16x16x32_bf16 v[144:147], v[120:123], a[36:39], v[144:147]
    ds_read_b64_tr_b16 v[100:101], v16 offset:10272
    s_cselect_b32 s90, s43, s90
    s_sub_u32 s43, s43, s90
    v_mfma_f32_16x16x32_bf16 v[148:151], v[120:123], a[116:119], v[148:151]
    ds_read_b64_tr_b16 v[102:103], v16 offset:11552
    s_add_u32 m0, m0, 1024
    s_nop 0
    buffer_load_dwordx4 v11, s[16:19], s91 offen lds
    s_waitcnt lgkmcnt(8)
    v_mfma_f32_16x16x32_bf16 v[152:155], v[124:127], a[36:39], v[152:155]
    ds_read_b64_tr_b16 v[104:105], v16 offset:10304
    s_add_u32 m0, m0, 1024
    v_mfma_f32_16x16x32_bf16 v[156:159], v[124:127], a[116:119], v[156:159]
    ds_read_b64_tr_b16 v[106:107], v16 offset:11584
    s_waitcnt lgkmcnt(8)
    v_mfma_f32_16x16x32_bf16 v[160:163], v[128:131], a[36:39], v[160:163]
    ds_read_b64_tr_b16 v[108:109], v16 offset:10336
    v_mfma_f32_16x16x32_bf16 v[164:167], v[128:131], a[116:119], v[164:167]
    ds_read_b64_tr_b16 v[110:111], v16 offset:11616
    s_waitcnt lgkmcnt(8)
    v_mfma_f32_16x16x32_bf16 v[168:171], v[132:135], a[36:39], v[168:171]
    ds_read_b64_tr_b16 v[112:113], v16 offset:10368
    buffer_load_dwordx4 v12, s[16:19], s91 offen lds
    s_add_u32 m0, m0, 1024
    v_mfma_f32_16x16x32_bf16 v[172:175], v[132:135], a[116:119], v[172:175]
    ds_read_b64_tr_b16 v[114:115], v16 offset:11648
    s_waitcnt lgkmcnt(8)
    v_mfma_f32_16x16x32_bf16 v[136:139], v[96:99], a[40:43], v[136:139]
    ds_read_b64_tr_b16 v[116:117], v16 offset:15360
    v_mfma_f32_16x16x32_bf16 v[140:143], v[96:99], a[120:123], v[140:143]
    ds_read_b64_tr_b16 v[118:119], v16 offset:16640
    s_waitcnt lgkmcnt(8)
    v_mfma_f32_16x16x32_bf16 v[144:147], v[100:103], a[40:43], v[144:147]
    ds_read_b64_tr_b16 v[120:121], v16 offset:15392
    v_mfma_f32_16x16x32_bf16 v[148:151], v[100:103], a[120:123], v[148:151]
    ds_read_b64_tr_b16 v[122:123], v16 offset:16672
    buffer_load_dwordx4 v13, s[16:19], s91 offen lds
    s_add_u32 m0, m0, 1024
    s_waitcnt lgkmcnt(8)
    v_mfma_f32_16x16x32_bf16 v[152:155], v[104:107], a[40:43], v[152:155]
    ds_read_b64_tr_b16 v[124:125], v16 offset:15424
    v_mfma_f32_16x16x32_bf16 v[156:159], v[104:107], a[120:123], v[156:159]
    ds_read_b64_tr_b16 v[126:127], v16 offset:16704
    s_waitcnt lgkmcnt(8)
    v_mfma_f32_16x16x32_bf16 v[160:163], v[108:111], a[40:43], v[160:163]
    ds_read_b64_tr_b16 v[128:129], v16 offset:15456
    v_mfma_f32_16x16x32_bf16 v[164:167], v[108:111], a[120:123], v[164:167]
    ds_read_b64_tr_b16 v[130:131], v16 offset:16736
    s_waitcnt lgkmcnt(8)
    v_mfma_f32_16x16x32_bf16 v[168:171], v[112:115], a[40:43], v[168:171]
    ds_read_b64_tr_b16 v[132:133], v16 offset:15488
    buffer_load_dwordx4 v14, s[16:19], s91 offen lds
    v_mfma_f32_16x16x32_bf16 v[172:175], v[112:115], a[120:123], v[172:175]
    ds_read_b64_tr_b16 v[134:135], v16 offset:16768
    s_waitcnt lgkmcnt(8)
    v_mfma_f32_16x16x32_bf16 v[136:139], v[116:119], a[44:47], v[136:139]
    v_mfma_f32_16x16x32_bf16 v[140:143], v[116:119], a[124:127], v[140:143]
    s_waitcnt lgkmcnt(6)
    v_mfma_f32_16x16x32_bf16 v[144:147], v[120:123], a[44:47], v[144:147]
    v_mfma_f32_16x16x32_bf16 v[148:151], v[120:123], a[124:127], v[148:151]
    v_add_u32 v16, s46, v15
    s_waitcnt vmcnt(10) lgkmcnt(0)
    s_barrier
    v_mfma_f32_16x16x32_bf16 v[152:155], v[124:127], a[44:47], v[152:155]
    ds_read_b64_tr_b16 v[96:97], v16 offset:0
    ds_read_b64_tr_b16 v[98:99], v16 offset:1280
    v_mfma_f32_16x16x32_bf16 v[156:159], v[124:127], a[124:127], v[156:159]
    ds_read_b64_tr_b16 v[100:101], v16 offset:32
    ds_read_b64_tr_b16 v[102:103], v16 offset:1312
    v_mfma_f32_16x16x32_bf16 v[160:163], v[128:131], a[44:47], v[160:163]
    ds_read_b64_tr_b16 v[104:105], v16 offset:64
    ds_read_b64_tr_b16 v[106:107], v16 offset:1344
    v_mfma_f32_16x16x32_bf16 v[164:167], v[128:131], a[124:127], v[164:167]
    ds_read_b64_tr_b16 v[108:109], v16 offset:96
    ds_read_b64_tr_b16 v[110:111], v16 offset:1376
    v_mfma_f32_16x16x32_bf16 v[168:171], v[132:135], a[44:47], v[168:171]
    ds_read_b64_tr_b16 v[112:113], v16 offset:128
    ds_read_b64_tr_b16 v[114:115], v16 offset:1408
    v_mfma_f32_16x16x32_bf16 v[172:175], v[132:135], a[124:127], v[172:175]
    s_waitcnt lgkmcnt(8)
    v_mfma_f32_16x16x32_bf16 v[136:139], v[96:99], a[48:51], v[136:139]
    ds_read_b64_tr_b16 v[116:117], v16 offset:5120
    s_add_u32 s46, s46, 20480
    s_cmp_eq_u32 s46, 81920
    v_mfma_f32_16x16x32_bf16 v[140:143], v[96:99], a[128:131], v[140:143]
    ds_read_b64_tr_b16 v[118:119], v16 offset:6400
    s_cselect_b32 s46, 0, s46
    s_mul_i32 s90, s32, 5120
    s_waitcnt lgkmcnt(8)
    v_mfma_f32_16x16x32_bf16 v[144:147], v[100:103], a[48:51], v[144:147]
    ds_read_b64_tr_b16 v[120:121], v16 offset:5152
    s_add_u32 m0, s90, s47
    s_mul_i32 s91, s44, 491520
    v_mfma_f32_16x16x32_bf16 v[148:151], v[100:103], a[128:131], v[148:151]
    ds_read_b64_tr_b16 v[122:123], v16 offset:6432
    s_add_u32 s91, s91, s43
    buffer_load_dwordx4 v10, s[16:19], s91 offen lds
    s_waitcnt lgkmcnt(8)
    v_mfma_f32_16x16x32_bf16 v[152:155], v[104:107], a[48:51], v[152:155]
    ds_read_b64_tr_b16 v[124:125], v16 offset:5184
    s_add_u32 s47, s47, 20480
    s_cmp_eq_u32 s47, 81920
    v_mfma_f32_16x16x32_bf16 v[156:159], v[104:107], a[128:131], v[156:159]
    ds_read_b64_tr_b16 v[126:127], v16 offset:6464
    s_cselect_b32 s47, 0, s47
    s_cmp_lg_u32 s51, 0
    s_waitcnt lgkmcnt(8)
    v_mfma_f32_16x16x32_bf16 v[160:163], v[108:111], a[48:51], v[160:163]
    ds_read_b64_tr_b16 v[128:129], v16 offset:5216
    s_cselect_b32 s90, 1, 0
    s_sub_u32 s51, s51, s90
    v_mfma_f32_16x16x32_bf16 v[164:167], v[108:111], a[128:131], v[164:167]
    ds_read_b64_tr_b16 v[130:131], v16 offset:6496
    s_add_u32 s44, s44, s90
    s_cmp_eq_u32 s44, 5
    s_waitcnt lgkmcnt(8)
    v_mfma_f32_16x16x32_bf16 v[168:171], v[112:115], a[48:51], v[168:171]
    ds_read_b64_tr_b16 v[132:133], v16 offset:5248
    s_cselect_b32 s44, 0, s44
    s_cselect_b32 s90, 1280, 0
    v_mfma_f32_16x16x32_bf16 v[172:175], v[112:115], a[128:131], v[172:175]
    ds_read_b64_tr_b16 v[134:135], v16 offset:6528
    s_addc_u32 s45, s45, 0
    s_add_u32 s43, s43, s90
    s_waitcnt lgkmcnt(8)
    v_mfma_f32_16x16x32_bf16 v[136:139], v[116:119], a[52:55], v[136:139]
    ds_read_b64_tr_b16 v[96:97], v16 offset:10240
    s_cmp_eq_u32 s45, 3
    s_cselect_b32 s45, 0, s45
    v_mfma_f32_16x16x32_bf16 v[140:143], v[116:119], a[132:135], v[140:143]
    ds_read_b64_tr_b16 v[98:99], v16 offset:11520
    s_cselect_b32 s90, 3680, 0
    s_cmp_eq_u32 s43, 4960
    s_waitcnt lgkmcnt(8)
    v_mfma_f32_16x16x32_bf16 v[144:147], v[120:123], a[52:55], v[144:147]
    ds_read_b64_tr_b16 v[100:101], v16 offset:10272
    s_cselect_b32 s90, s43, s90
    s_sub_u32 s43, s43, s90
    v_mfma_f32_16x16x32_bf16 v[148:151], v[120:123], a[132:135], v[148:151]
    ds_read_b64_tr_b16 v[102:103], v16 offset:11552
    s_add_u32 m0, m0, 1024
    s_nop 0
    buffer_load_dwordx4 v11, s[16:19], s91 offen lds
    s_waitcnt lgkmcnt(8)
    v_mfma_f32_16x16x32_bf16 v[152:155], v[124:127], a[52:55], v[152:155]
    ds_read_b64_tr_b16 v[104:105], v16 offset:10304
    s_add_u32 m0, m0, 1024
    v_mfma_f32_16x16x32_bf16 v[156:159], v[124:127], a[132:135], v[156:159]
    ds_read_b64_tr_b16 v[106:107], v16 offset:11584
    s_waitcnt lgkmcnt(8)
    v_mfma_f32_16x16x32_bf16 v[160:163], v[128:131], a[52:55], v[160:163]
    ds_read_b64_tr_b16 v[108:109], v16 offset:10336
    v_mfma_f32_16x16x32_bf16 v[164:167], v[128:131], a[132:135], v[164:167]
    ds_read_b64_tr_b16 v[110:111], v16 offset:11616
    s_waitcnt lgkmcnt(8)
    v_mfma_f32_16x16x32_bf16 v[168:171], v[132:135], a[52:55], v[168:171]
    ds_read_b64_tr_b16 v[112:113], v16 offset:10368
    buffer_load_dwordx4 v12, s[16:19], s91 offen lds
    s_add_u32 m0, m0, 1024
    v_mfma_f32_16x16x32_bf16 v[172:175], v[132:135], a[132:135], v[172:175]
    ds_read_b64_tr_b16 v[114:115], v16 offset:11648
    s_waitcnt lgkmcnt(8)
    v_mfma_f32_16x16x32_bf16 v[136:139], v[96:99], a[56:59], v[136:139]
    ds_read_b64_tr_b16 v[116:117], v16 offset:15360
    v_mfma_f32_16x16x32_bf16 v[140:143], v[96:99], a[136:139], v[140:143]
    ds_read_b64_tr_b16 v[118:119], v16 offset:16640
    s_waitcnt lgkmcnt(8)
    v_mfma_f32_16x16x32_bf16 v[144:147], v[100:103], a[56:59], v[144:147]
    ds_read_b64_tr_b16 v[120:121], v16 offset:15392
    v_mfma_f32_16x16x32_bf16 v[148:151], v[100:103], a[136:139], v[148:151]
    ds_read_b64_tr_b16 v[122:123], v16 offset:16672
    buffer_load_dwordx4 v13, s[16:19], s91 offen lds
    s_add_u32 m0, m0, 1024
    s_waitcnt lgkmcnt(8)
    v_mfma_f32_16x16x32_bf16 v[152:155], v[104:107], a[56:59], v[152:155]
    ds_read_b64_tr_b16 v[124:125], v16 offset:15424
    v_mfma_f32_16x16x32_bf16 v[156:159], v[104:107], a[136:139], v[156:159]
    ds_read_b64_tr_b16 v[126:127], v16 offset:16704
    s_waitcnt lgkmcnt(8)
    v_mfma_f32_16x16x32_bf16 v[160:163], v[108:111], a[56:59], v[160:163]
    ds_read_b64_tr_b16 v[128:129], v16 offset:15456
    v_mfma_f32_16x16x32_bf16 v[164:167], v[108:111], a[136:139], v[164:167]
    ds_read_b64_tr_b16 v[130:131], v16 offset:16736
    s_waitcnt lgkmcnt(8)
    v_mfma_f32_16x16x32_bf16 v[168:171], v[112:115], a[56:59], v[168:171]
    ds_read_b64_tr_b16 v[132:133], v16 offset:15488
    buffer_load_dwordx4 v14, s[16:19], s91 offen lds
    v_mfma_f32_16x16x32_bf16 v[172:175], v[112:115], a[136:139], v[172:175]
    ds_read_b64_tr_b16 v[134:135], v16 offset:16768
    s_waitcnt lgkmcnt(8)
    v_mfma_f32_16x16x32_bf16 v[136:139], v[116:119], a[60:63], v[136:139]
    v_mfma_f32_16x16x32_bf16 v[140:143], v[116:119], a[140:143], v[140:143]
    s_waitcnt lgkmcnt(6)
    v_mfma_f32_16x16x32_bf16 v[144:147], v[120:123], a[60:63], v[144:147]
    v_mfma_f32_16x16x32_bf16 v[148:151], v[120:123], a[140:143], v[148:151]
    v_add_u32 v16, s46, v15
    s_waitcnt vmcnt(10) lgkmcnt(0)
    s_barrier
    v_mfma_f32_16x16x32_bf16 v[152:155], v[124:127], a[60:63], v[152:155]
    ds_read_b64_tr_b16 v[96:97], v16 offset:0
    ds_read_b64_tr_b16 v[98:99], v16 offset:1280
    v_mfma_f32_16x16x32_bf16 v[156:159], v[124:127], a[140:143], v[156:159]
    ds_read_b64_tr_b16 v[100:101], v16 offset:32
    ds_read_b64_tr_b16 v[102:103], v16 offset:1312
    v_mfma_f32_16x16x32_bf16 v[160:163], v[128:131], a[60:63], v[160:163]
    ds_read_b64_tr_b16 v[104:105], v16 offset:64
    ds_read_b64_tr_b16 v[106:107], v16 offset:1344
    v_mfma_f32_16x16x32_bf16 v[164:167], v[128:131], a[140:143], v[164:167]
    ds_read_b64_tr_b16 v[108:109], v16 offset:96
    ds_read_b64_tr_b16 v[110:111], v16 offset:1376
    v_mfma_f32_16x16x32_bf16 v[168:171], v[132:135], a[60:63], v[168:171]
    ds_read_b64_tr_b16 v[112:113], v16 offset:128
    ds_read_b64_tr_b16 v[114:115], v16 offset:1408
    v_mfma_f32_16x16x32_bf16 v[172:175], v[132:135], a[140:143], v[172:175]
    s_waitcnt lgkmcnt(8)
    v_mfma_f32_16x16x32_bf16 v[136:139], v[96:99], a[64:67], v[136:139]
    ds_read_b64_tr_b16 v[116:117], v16 offset:5120
    s_add_u32 s46, s46, 20480
    s_cmp_eq_u32 s46, 81920
    v_mfma_f32_16x16x32_bf16 v[140:143], v[96:99], a[144:147], v[140:143]
    ds_read_b64_tr_b16 v[118:119], v16 offset:6400
    s_cselect_b32 s46, 0, s46
    s_mul_i32 s90, s32, 5120
    s_waitcnt lgkmcnt(8)
    v_mfma_f32_16x16x32_bf16 v[144:147], v[100:103], a[64:67], v[144:147]
    ds_read_b64_tr_b16 v[120:121], v16 offset:5152
    s_add_u32 m0, s90, s47
    s_mul_i32 s91, s44, 491520
    v_mfma_f32_16x16x32_bf16 v[148:151], v[100:103], a[144:147], v[148:151]
    ds_read_b64_tr_b16 v[122:123], v16 offset:6432
    s_add_u32 s91, s91, s43
    buffer_load_dwordx4 v10, s[16:19], s91 offen lds
    s_waitcnt lgkmcnt(8)
    v_mfma_f32_16x16x32_bf16 v[152:155], v[104:107], a[64:67], v[152:155]
    ds_read_b64_tr_b16 v[124:125], v16 offset:5184
    s_add_u32 s47, s47, 20480
    s_cmp_eq_u32 s47, 81920
    v_mfma_f32_16x16x32_bf16 v[156:159], v[104:107], a[144:147], v[156:159]
    ds_read_b64_tr_b16 v[126:127], v16 offset:6464
    s_cselect_b32 s47, 0, s47
    s_cmp_lg_u32 s51, 0
    s_waitcnt lgkmcnt(8)
    v_mfma_f32_16x16x32_bf16 v[160:163], v[108:111], a[64:67], v[160:163]
    ds_read_b64_tr_b16 v[128:129], v16 offset:5216
    s_cselect_b32 s90, 1, 0
    s_sub_u32 s51, s51, s90
    v_mfma_f32_16x16x32_bf16 v[164:167], v[108:111], a[144:147], v[164:167]
    ds_read_b64_tr_b16 v[130:131], v16 offset:6496
    s_add_u32 s44, s44, s90
    s_cmp_eq_u32 s44, 5
    s_waitcnt lgkmcnt(8)
    v_mfma_f32_16x16x32_bf16 v[168:171], v[112:115], a[64:67], v[168:171]
    ds_read_b64_tr_b16 v[132:133], v16 offset:5248
    s_cselect_b32 s44, 0, s44
    s_cselect_b32 s90, 1280, 0
    v_mfma_f32_16x16x32_bf16 v[172:175], v[112:115], a[144:147], v[172:175]
    ds_read_b64_tr_b16 v[134:135], v16 offset:6528
    s_addc_u32 s45, s45, 0
    s_add_u32 s43, s43, s90
    s_waitcnt lgkmcnt(8)
    v_mfma_f32_16x16x32_bf16 v[136:139], v[116:119], a[68:71], v[136:139]
    ds_read_b64_tr_b16 v[96:97], v16 offset:10240
    s_cmp_eq_u32 s45, 3
    s_cselect_b32 s45, 0, s45
    v_mfma_f32_16x16x32_bf16 v[140:143], v[116:119], a[148:151], v[140:143]
    ds_read_b64_tr_b16 v[98:99], v16 offset:11520
    s_cselect_b32 s90, 3680, 0
    s_cmp_eq_u32 s43, 4960
    s_waitcnt lgkmcnt(8)
    v_mfma_f32_16x16x32_bf16 v[144:147], v[120:123], a[68:71], v[144:147]
    ds_read_b64_tr_b16 v[100:101], v16 offset:10272
    s_cselect_b32 s90, s43, s90
    s_sub_u32 s43, s43, s90
    v_mfma_f32_16x16x32_bf16 v[148:151], v[120:123], a[148:151], v[148:151]
    ds_read_b64_tr_b16 v[102:103], v16 offset:11552
    s_add_u32 m0, m0, 1024
    s_nop 0
    buffer_load_dwordx4 v11, s[16:19], s91 offen lds
    s_waitcnt lgkmcnt(8)
    v_mfma_f32_16x16x32_bf16 v[152:155], v[124:127], a[68:71], v[152:155]
    ds_read_b64_tr_b16 v[104:105], v16 offset:10304
    s_add_u32 m0, m0, 1024
    v_mfma_f32_16x16x32_bf16 v[156:159], v[124:127], a[148:151], v[156:159]
    ds_read_b64_tr_b16 v[106:107], v16 offset:11584
    s_waitcnt lgkmcnt(8)
    v_mfma_f32_16x16x32_bf16 v[160:163], v[128:131], a[68:71], v[160:163]
    ds_read_b64_tr_b16 v[108:109], v16 offset:10336
    v_mfma_f32_16x16x32_bf16 v[164:167], v[128:131], a[148:151], v[164:167]
    ds_read_b64_tr_b16 v[110:111], v16 offset:11616
    s_waitcnt lgkmcnt(8)
    v_mfma_f32_16x16x32_bf16 v[168:171], v[132:135], a[68:71], v[168:171]
    ds_read_b64_tr_b16 v[112:113], v16 offset:10368
    buffer_load_dwordx4 v12, s[16:19], s91 offen lds
    s_add_u32 m0, m0, 1024
    v_mfma_f32_16x16x32_bf16 v[172:175], v[132:135], a[148:151], v[172:175]
    ds_read_b64_tr_b16 v[114:115], v16 offset:11648
    s_waitcnt lgkmcnt(8)
    v_mfma_f32_16x16x32_bf16 v[136:139], v[96:99], a[72:75], v[136:139]
    ds_read_b64_tr_b16 v[116:117], v16 offset:15360
    v_mfma_f32_16x16x32_bf16 v[140:143], v[96:99], a[152:155], v[140:143]
    ds_read_b64_tr_b16 v[118:119], v16 offset:16640
    s_waitcnt lgkmcnt(8)
    v_mfma_f32_16x16x32_bf16 v[144:147], v[100:103], a[72:75], v[144:147]
    ds_read_b64_tr_b16 v[120:121], v16 offset:15392
    v_mfma_f32_16x16x32_bf16 v[148:151], v[100:103], a[152:155], v[148:151]
    ds_read_b64_tr_b16 v[122:123], v16 offset:16672
    buffer_load_dwordx4 v13, s[16:19], s91 offen lds
    s_add_u32 m0, m0, 1024
    s_waitcnt lgkmcnt(8)
    v_mfma_f32_16x16x32_bf16 v[152:155], v[104:107], a[72:75], v[152:155]
    ds_read_b64_tr_b16 v[124:125], v16 offset:15424
    v_mfma_f32_16x16x32_bf16 v[156:159], v[104:107], a[152:155], v[156:159]
    ds_read_b64_tr_b16 v[126:127], v16 offset:16704
    s_waitcnt lgkmcnt(8)
    v_mfma_f32_16x16x32_bf16 v[160:163], v[108:111], a[72:75], v[160:163]
    ds_read_b64_tr_b16 v[128:129], v16 offset:15456
    v_mfma_f32_16x16x32_bf16 v[164:167], v[108:111], a[152:155], v[164:167]
    ds_read_b64_tr_b16 v[130:131], v16 offset:16736
    s_waitcnt lgkmcnt(8)
    v_mfma_f32_16x16x32_bf16 v[168:171], v[112:115], a[72:75], v[168:171]
    ds_read_b64_tr_b16 v[132:133], v16 offset:15488
    buffer_load_dwordx4 v14, s[16:19], s91 offen lds
    v_mfma_f32_16x16x32_bf16 v[172:175], v[112:115], a[152:155], v[172:175]
    ds_read_b64_tr_b16 v[134:135], v16 offset:16768
    s_waitcnt lgkmcnt(8)
    v_mfma_f32_16x16x32_bf16 v[136:139], v[116:119], a[76:79], v[136:139]
    v_mfma_f32_16x16x32_bf16 v[140:143], v[116:119], a[156:159], v[140:143]
    s_waitcnt lgkmcnt(6)
    v_mfma_f32_16x16x32_bf16 v[144:147], v[120:123], a[76:79], v[144:147]
    v_mfma_f32_16x16x32_bf16 v[148:151], v[120:123], a[156:159], v[148:151]
    v_add_u32 v16, s46, v15
    s_waitcnt vmcnt(10) lgkmcnt(0)
    s_barrier
    v_mfma_f32_16x16x32_bf16 v[152:155], v[124:127], a[76:79], v[152:155]
    ds_read_b64_tr_b16 v[96:97], v16 offset:0
    ds_read_b64_tr_b16 v[98:99], v16 offset:1280
    v_mfma_f32_16x16x32_bf16 v[156:159], v[124:127], a[156:159], v[156:159]
    ds_read_b64_tr_b16 v[100:101], v16 offset:32
    ds_read_b64_tr_b16 v[102:103], v16 offset:1312
    v_mfma_f32_16x16x32_bf16 v[160:163], v[128:131], a[76:79], v[160:163]
    ds_read_b64_tr_b16 v[104:105], v16 offset:64
    ds_read_b64_tr_b16 v[106:107], v16 offset:1344
    v_mfma_f32_16x16x32_bf16 v[164:167], v[128:131], a[156:159], v[164:167]
    ds_read_b64_tr_b16 v[108:109], v16 offset:96
    ds_read_b64_tr_b16 v[110:111], v16 offset:1376
    v_mfma_f32_16x16x32_bf16 v[168:171], v[132:135], a[76:79], v[168:171]
    ds_read_b64_tr_b16 v[112:113], v16 offset:128
    ds_read_b64_tr_b16 v[114:115], v16 offset:1408
    v_mfma_f32_16x16x32_bf16 v[172:175], v[132:135], a[156:159], v[172:175]
    v_add_u32 v18, s41, v17
    v_cvt_pk_bf16_f32 v176, v136, v137
    v_cvt_pk_bf16_f32 v177, v138, v139
    v_cvt_pk_bf16_f32 v178, v140, v141
    v_cvt_pk_bf16_f32 v179, v142, v143
    ds_write_b64 v18, v[176:177] offset:0
    ds_write_b64 v18, v[178:179] offset:2688
    v_cvt_pk_bf16_f32 v176, v144, v145
    v_cvt_pk_bf16_f32 v177, v146, v147
    v_cvt_pk_bf16_f32 v178, v148, v149
    v_cvt_pk_bf16_f32 v179, v150, v151
    ds_write_b64 v18, v[176:177] offset:32
    ds_write_b64 v18, v[178:179] offset:2720
    v_cvt_pk_bf16_f32 v176, v152, v153
    v_cvt_pk_bf16_f32 v177, v154, v155
    v_cvt_pk_bf16_f32 v178, v156, v157
    v_cvt_pk_bf16_f32 v179, v158, v159
    ds_write_b64 v18, v[176:177] offset:64
    ds_write_b64 v18, v[178:179] offset:2752
    v_cvt_pk_bf16_f32 v176, v160, v161
    v_cvt_pk_bf16_f32 v177, v162, v163
    v_cvt_pk_bf16_f32 v178, v164, v165
    v_cvt_pk_bf16_f32 v179, v166, v167
    ds_write_b64 v18, v[176:177] offset:96
    ds_write_b64 v18, v[178:179] offset:2784
    v_cvt_pk_bf16_f32 v176, v168, v169
    v_cvt_pk_bf16_f32 v177, v170, v171
    v_cvt_pk_bf16_f32 v178, v172, v173
    v_cvt_pk_bf16_f32 v179, v174, v175
    ds_write_b64 v18, v[176:177] offset:128
    ds_write_b64 v18, v[178:179] offset:2816
    s_waitcnt lgkmcnt(0)
    s_add_u32 s41, s41, 21504
    s_cmp_lt_u32 s41, 64512
    s_cbranch_scc1 L_pa_blk
    s_barrier
    s_mov_b32 s50, 0
L_pa_att:
    v_add_u32 v23, s50, v21
    v_add_u32 v22, s50, v20
    ds_read_b64 v[116:117], v22 offset:0
    ds_read_b64 v[118:119], v22 offset:8
    ds_read_b64 v[120:121], v22 offset:16
    ds_read_b64 v[122:123], v22 offset:24
    ds_read_b64 v[124:125], v22 offset:32
    ds_read_b64 v[126:127], v23 offset:2352
    ds_read_b64 v[128:129], v23 offset:2360
    ds_read_b64 v[130:131], v23 offset:2368
    ds_read_b64 v[132:133], v23 offset:2376
    ds_read_b64 v[134:135], v23 offset:2384
    ds_read_b64 v[136:137], v23 offset:2016
    ds_read_b64 v[138:139], v23 offset:2024
    ds_read_b64 v[140:141], v23 offset:2032
    ds_read_b64 v[142:143], v23 offset:2040
    ds_read_b64 v[144:145], v23 offset:2048
    s_waitcnt lgkmcnt(5)
    v_dot2_f32_bf16 v146, v116, v126, 0
    v_dot2_f32_bf16 v146, v117, v127, v146
    v_dot2_f32_bf16 v146, v118, v128, v146
    v_dot2_f32_bf16 v146, v119, v129, v146
    v_dot2_f32_bf16 v146, v120, v130, v146
    v_dot2_f32_bf16 v146, v121, v131, v146
    v_dot2_f32_bf16 v146, v122, v132, v146
    v_dot2_f32_bf16 v146, v123, v133, v146
    v_dot2_f32_bf16 v146, v124, v134, v146
    v_dot2_f32_bf16 v146, v125, v135, v146
    ds_read_b64 v[126:127], v23 offset:1680
    ds_read_b64 v[128:129], v23 offset:1688
    ds_read_b64 v[130:131], v23 offset:1696
    ds_read_b64 v[132:133], v23 offset:1704
    ds_read_b64 v[134:135], v23 offset:1712
    s_waitcnt lgkmcnt(5)
    v_dot2_f32_bf16 v147, v116, v136, 0
    v_dot2_f32_bf16 v147, v117, v137, v147
    v_dot2_f32_bf16 v147, v118, v138, v147
    v_dot2_f32_bf16 v147, v119, v139, v147
    v_dot2_f32_bf16 v147, v120, v140, v147
    v_dot2_f32_bf16 v147, v121, v141, v147
    v_dot2_f32_bf16 v147, v122, v142, v147
    v_dot2_f32_bf16 v147, v123, v143, v147
    v_dot2_f32_bf16 v147, v124, v144, v147
    v_dot2_f32_bf16 v147, v125, v145, v147
    ds_read_b64 v[136:137], v23 offset:1344
    ds_read_b64 v[138:139], v23 offset:1352
    ds_read_b64 v[140:141], v23 offset:1360
    ds_read_b64 v[142:143], v23 offset:1368
    ds_read_b64 v[144:145], v23 offset:1376
    s_waitcnt lgkmcnt(5)
    v_dot2_f32_bf16 v148, v116, v126, 0
    v_dot2_f32_bf16 v148, v117, v127, v148
    v_dot2_f32_bf16 v148, v118, v128, v148
    v_dot2_f32_bf16 v148, v119, v129, v148
    v_dot2_f32_bf16 v148, v120, v130, v148
    v_dot2_f32_bf16 v148, v121, v131, v148
    v_dot2_f32_bf16 v148, v122, v132, v148
    v_dot2_f32_bf16 v148, v123, v133, v148
    v_dot2_f32_bf16 v148, v124, v134, v148
    v_dot2_f32_bf16 v148, v125, v135, v148
    ds_read_b64 v[126:127], v23 offset:1008
    ds_read_b64 v[128:129], v23 offset:1016
    ds_read_b64 v[130:131], v23 offset:1024
    ds_read_b64 v[132:133], v23 offset:1032
    ds_read_b64 v[134:135], v23 offset:1040
    s_waitcnt lgkmcnt(5)
    v_dot2_f32_bf16 v149, v116, v136, 0
    v_dot2_f32_bf16 v149, v117, v137, v149
    v_dot2_f32_bf16 v149, v118, v138, v149
    v_dot2_f32_bf16 v149, v119, v139, v149
    v_dot2_f32_bf16 v149, v120, v140, v149
    v_dot2_f32_bf16 v149, v121, v141, v149
    v_dot2_f32_bf16 v149, v122, v142, v149
    v_dot2_f32_bf16 v149, v123, v143, v149
    v_dot2_f32_bf16 v149, v124, v144, v149
    v_dot2_f32_bf16 v149, v125, v145, v149
    ds_read_b64 v[136:137], v23 offset:672
    ds_read_b64 v[138:139], v23 offset:680
    ds_read_b64 v[140:141], v23 offset:688
    ds_read_b64 v[142:143], v23 offset:696
    ds_read_b64 v[144:145], v23 offset:704
    s_waitcnt lgkmcnt(5)
    v_dot2_f32_bf16 v150, v116, v126, 0
    v_dot2_f32_bf16 v150, v117, v127, v150
    v_dot2_f32_bf16 v150, v118, v128, v150
    v_dot2_f32_bf16 v150, v119, v129, v150
    v_dot2_f32_bf16 v150, v120, v130, v150
    v_dot2_f32_bf16 v150, v121, v131, v150
    v_dot2_f32_bf16 v150, v122, v132, v150
    v_dot2_f32_bf16 v150, v123, v133, v150
    v_dot2_f32_bf16 v150, v124, v134, v150
    v_dot2_f32_bf16 v150, v125, v135, v150
    ds_read_b64 v[126:127], v23 offset:336
    ds_read_b64 v[128:129], v23 offset:344
    ds_read_b64 v[130:131], v23 offset:352
    ds_read_b64 v[132:133], v23 offset:360
    ds_read_b64 v[134:135], v23 offset:368
    s_waitcnt lgkmcnt(5)
    v_dot2_f32_bf16 v151, v116, v136, 0
    v_dot2_f32_bf16 v151, v117, v137, v151
    v_dot2_f32_bf16 v151, v118, v138, v151
    v_dot2_f32_bf16 v151, v119, v139, v151
    v_dot2_f32_bf16 v151, v120, v140, v151
    v_dot2_f32_bf16 v151, v121, v141, v151
    v_dot2_f32_bf16 v151, v122, v142, v151
    v_dot2_f32_bf16 v151, v123, v143, v151
    v_dot2_f32_bf16 v151, v124, v144, v151
    v_dot2_f32_bf16 v151, v125, v145, v151
    ds_read_b64 v[136:137], v23 offset:0
    ds_read_b64 v[138:139], v23 offset:8
    ds_read_b64 v[140:141], v23 offset:16
    ds_read_b64 v[142:143], v23 offset:24
    ds_read_b64 v[144:145], v23 offset:32
    s_waitcnt lgkmcnt(5)
    v_dot2_f32_bf16 v152, v116, v126, 0
    v_dot2_f32_bf16 v152, v117, v127, v152
    v_dot2_f32_bf16 v152, v118, v128, v152
    v_dot2_f32_bf16 v152, v119, v129, v152
    v_dot2_f32_bf16 v152, v120, v130, v152
    v_dot2_f32_bf16 v152, v121, v131, v152
    v_dot2_f32_bf16 v152, v122, v132, v152
    v_dot2_f32_bf16 v152, v123, v133, v152
    v_dot2_f32_bf16 v152, v124, v134, v152
    v_dot2_f32_bf16 v152, v125, v135, v152
    ds_read_b64 v[126:127], v23 offset:23856
    ds_read_b64 v[128:129], v23 offset:23864
    ds_read_b64 v[130:131], v23 offset:23872
    ds_read_b64 v[132:133], v23 offset:23880
    ds_read_b64 v[134:135], v23 offset:23888
    s_waitcnt lgkmcnt(5)
    v_dot2_f32_bf16 v153, v116, v136, 0
    v_dot2_f32_bf16 v153, v117, v137, v153
    v_dot2_f32_bf16 v153, v118, v138, v153
    v_dot2_f32_bf16 v153, v119, v139, v153
    v_dot2_f32_bf16 v153, v120, v140, v153
    v_dot2_f32_bf16 v153, v121, v141, v153
    v_dot2_f32_bf16 v153, v122, v142, v153
    v_dot2_f32_bf16 v153, v123, v143, v153
    v_dot2_f32_bf16 v153, v124, v144, v153
    v_dot2_f32_bf16 v153, v125, v145, v153
    v_cmp_le_i32 vcc, 2, v24
    s_nop 1
    v_cndmask_b32 v147, v27, v147, vcc
    v_cmp_le_i32 vcc, 4, v24
    s_nop 1
    v_cndmask_b32 v148, v27, v148, vcc
    v_cmp_le_i32 vcc, 6, v24
    s_nop 1
    v_cndmask_b32 v149, v27, v149, vcc
    v_cmp_le_i32 vcc, 8, v24
    s_nop 1
    v_cndmask_b32 v150, v27, v150, vcc
    v_cmp_le_i32 vcc, 10, v24
    s_nop 1
    v_cndmask_b32 v151, v27, v151, vcc
    v_cmp_le_i32 vcc, 12, v24
    s_nop 1
    v_cndmask_b32 v152, v27, v152, vcc
    v_cmp_le_i32 vcc, 14, v24
    s_nop 1
    v_cndmask_b32 v153, v27, v153, vcc
    v_max_f32 v25, v146, v147
    v_max3_f32 v25, v25, v148, v149
    v_max3_f32 v25, v25, v150, v151
    v_max3_f32 v25, v25, v152, v153
    v_mul_f32 v25, 0xbea52b5c, v25
    v_fma_f32 v146, v146, s49, v25
    v_fma_f32 v147, v147, s49, v25
    v_fma_f32 v148, v148, s49, v25
    v_fma_f32 v149, v149, s49, v25
    v_fma_f32 v150, v150, s49, v25
    v_fma_f32 v151, v151, s49, v25
    v_fma_f32 v152, v152, s49, v25
    v_fma_f32 v153, v153, s49, v25
    v_exp_f32 v146, v146
    v_exp_f32 v147, v147
    v_exp_f32 v148, v148
    v_exp_f32 v149, v149
    v_exp_f32 v150, v150
    v_exp_f32 v151, v151
    v_exp_f32 v152, v152
    v_exp_f32 v153, v153
    v_add_f32 v26, v146, v147
    v_add_f32 v26, v26, v148
    v_add_f32 v26, v26, v149
    v_add_f32 v26, v26, v150
    v_add_f32 v26, v26, v151
    v_add_f32 v26, v26, v152
    v_add_f32 v26, v26, v153
    v_rcp_f32 v26, v26
    s_nop 0
    v_mul_f32 v146, v146, v26
    v_cvt_pk_bf16_f32 v154, v146, 0
    v_cvt_pk_bf16_f32 v155, 0, v146
    v_mul_f32 v147, v147, v26
    v_cvt_pk_bf16_f32 v156, v147, 0
    v_cvt_pk_bf16_f32 v157, 0, v147
    v_mul_f32 v148, v148, v26
    v_cvt_pk_bf16_f32 v158, v148, 0
    v_cvt_pk_bf16_f32 v159, 0, v148
    v_mul_f32 v149, v149, v26
    v_cvt_pk_bf16_f32 v160, v149, 0
    v_cvt_pk_bf16_f32 v161, 0, v149
    v_mul_f32 v150, v150, v26
    v_cvt_pk_bf16_f32 v162, v150, 0
    v_cvt_pk_bf16_f32 v163, 0, v150
    v_mul_f32 v151, v151, v26
    v_cvt_pk_bf16_f32 v164, v151, 0
    v_cvt_pk_bf16_f32 v165, 0, v151
    v_mul_f32 v152, v152, v26
    v_cvt_pk_bf16_f32 v166, v152, 0
    v_cvt_pk_bf16_f32 v167, 0, v152
    v_mul_f32 v153, v153, v26
    v_cvt_pk_bf16_f32 v168, v153, 0
    v_cvt_pk_bf16_f32 v169, 0, v153
    ds_read_b64 v[136:137], v23 offset:23520
    ds_read_b64 v[138:139], v23 offset:23528
    ds_read_b64 v[140:141], v23 offset:23536
    ds_read_b64 v[142:143], v23 offset:23544
    ds_read_b64 v[144:145], v23 offset:23552
    s_waitcnt lgkmcnt(5)
    v_dot2_f32_bf16 v170, v126, v154, 0
    v_dot2_f32_bf16 v171, v126, v155, 0
    v_dot2_f32_bf16 v172, v127, v154, 0
    v_dot2_f32_bf16 v173, v127, v155, 0
    v_dot2_f32_bf16 v174, v128, v154, 0
    v_dot2_f32_bf16 v175, v128, v155, 0
    v_dot2_f32_bf16 v176, v129, v154, 0
    v_dot2_f32_bf16 v177, v129, v155, 0
    v_dot2_f32_bf16 v178, v130, v154, 0
    v_dot2_f32_bf16 v179, v130, v155, 0
    v_dot2_f32_bf16 v180, v131, v154, 0
    v_dot2_f32_bf16 v181, v131, v155, 0
    v_dot2_f32_bf16 v182, v132, v154, 0
    v_dot2_f32_bf16 v183, v132, v155, 0
    v_dot2_f32_bf16 v184, v133, v154, 0
    v_dot2_f32_bf16 v185, v133, v155, 0
    v_dot2_f32_bf16 v186, v134, v154, 0
    v_dot2_f32_bf16 v187, v134, v155, 0
    v_dot2_f32_bf16 v188, v135, v154, 0
    v_dot2_f32_bf16 v189, v135, v155, 0
    ds_read_b64 v[126:127], v23 offset:23184
    ds_read_b64 v[128:129], v23 offset:23192
    ds_read_b64 v[130:131], v23 offset:23200
    ds_read_b64 v[132:133], v23 offset:23208
    ds_read_b64 v[134:135], v23 offset:23216
    s_waitcnt lgkmcnt(5)
    v_dot2_f32_bf16 v170, v136, v156, v170
    v_dot2_f32_bf16 v171, v136, v157, v171
    v_dot2_f32_bf16 v172, v137, v156, v172
    v_dot2_f32_bf16 v173, v137, v157, v173
    v_dot2_f32_bf16 v174, v138, v156, v174
    v_dot2_f32_bf16 v175, v138, v157, v175
    v_dot2_f32_bf16 v176, v139, v156, v176
    v_dot2_f32_bf16 v177, v139, v157, v177
    v_dot2_f32_bf16 v178, v140, v156, v178
    v_dot2_f32_bf16 v179, v140, v157, v179
    v_dot2_f32_bf16 v180, v141, v156, v180
    v_dot2_f32_bf16 v181, v141, v157, v181
    v_dot2_f32_bf16 v182, v142, v156, v182
    v_dot2_f32_bf16 v183, v142, v157, v183
    v_dot2_f32_bf16 v184, v143, v156, v184
    v_dot2_f32_bf16 v185, v143, v157, v185
    v_dot2_f32_bf16 v186, v144, v156, v186
    v_dot2_f32_bf16 v187, v144, v157, v187
    v_dot2_f32_bf16 v188, v145, v156, v188
    v_dot2_f32_bf16 v189, v145, v157, v189
    ds_read_b64 v[136:137], v23 offset:22848
    ds_read_b64 v[138:139], v23 offset:22856
    ds_read_b64 v[140:141], v23 offset:22864
    ds_read_b64 v[142:143], v23 offset:22872
    ds_read_b64 v[144:145], v23 offset:22880
    s_waitcnt lgkmcnt(5)
    v_dot2_f32_bf16 v170, v126, v158, v170
    v_dot2_f32_bf16 v171, v126, v159, v171
    v_dot2_f32_bf16 v172, v127, v158, v172
    v_dot2_f32_bf16 v173, v127, v159, v173
    v_dot2_f32_bf16 v174, v128, v158, v174
    v_dot2_f32_bf16 v175, v128, v159, v175
    v_dot2_f32_bf16 v176, v129, v158, v176
    v_dot2_f32_bf16 v177, v129, v159, v177
    v_dot2_f32_bf16 v178, v130, v158, v178
    v_dot2_f32_bf16 v179, v130, v159, v179
    v_dot2_f32_bf16 v180, v131, v158, v180
    v_dot2_f32_bf16 v181, v131, v159, v181
    v_dot2_f32_bf16 v182, v132, v158, v182
    v_dot2_f32_bf16 v183, v132, v159, v183
    v_dot2_f32_bf16 v184, v133, v158, v184
    v_dot2_f32_bf16 v185, v133, v159, v185
    v_dot2_f32_bf16 v186, v134, v158, v186
    v_dot2_f32_bf16 v187, v134, v159, v187
    v_dot2_f32_bf16 v188, v135, v158, v188
    v_dot2_f32_bf16 v189, v135, v159, v189
    ds_read_b64 v[126:127], v23 offset:22512
    ds_read_b64 v[128:129], v23 offset:22520
    ds_read_b64 v[130:131], v23 offset:22528
    ds_read_b64 v[132:133], v23 offset:22536
    ds_read_b64 v[134:135], v23 offset:22544
    s_waitcnt lgkmcnt(5)
    v_dot2_f32_bf16 v170, v136, v160, v170
    v_dot2_f32_bf16 v171, v136, v161, v171
    v_dot2_f32_bf16 v172, v137, v160, v172
    v_dot2_f32_bf16 v173, v137, v161, v173
    v_dot2_f32_bf16 v174, v138, v160, v174
    v_dot2_f32_bf16 v175, v138, v161, v175
    v_dot2_f32_bf16 v176, v139, v160, v176
    v_dot2_f32_bf16 v177, v139, v161, v177
    v_dot2_f32_bf16 v178, v140, v160, v178
    v_dot2_f32_bf16 v179, v140, v161, v179
    v_dot2_f32_bf16 v180, v141, v160, v180
    v_dot2_f32_bf16 v181, v141, v161, v181
    v_dot2_f32_bf16 v182, v142, v160, v182
    v_dot2_f32_bf16 v183, v142, v161, v183
    v_dot2_f32_bf16 v184, v143, v160, v184
    v_dot2_f32_bf16 v185, v143, v161, v185
    v_dot2_f32_bf16 v186, v144, v160, v186
    v_dot2_f32_bf16 v187, v144, v161, v187
    v_dot2_f32_bf16 v188, v145, v160, v188
    v_dot2_f32_bf16 v189, v145, v161, v189
    ds_read_b64 v[136:137], v23 offset:22176
    ds_read_b64 v[138:139], v23 offset:22184
    ds_read_b64 v[140:141], v23 offset:22192
    ds_read_b64 v[142:143], v23 offset:22200
    ds_read_b64 v[144:145], v23 offset:22208
    s_waitcnt lgkmcnt(5)
    v_dot2_f32_bf16 v170, v126, v162, v170
    v_dot2_f32_bf16 v171, v126, v163, v171
    v_dot2_f32_bf16 v172, v127, v162, v172
    v_dot2_f32_bf16 v173, v127, v163, v173
    v_dot2_f32_bf16 v174, v128, v162, v174
    v_dot2_f32_bf16 v175, v128, v163, v175
    v_dot2_f32_bf16 v176, v129, v162, v176
    v_dot2_f32_bf16 v177, v129, v163, v177
    v_dot2_f32_bf16 v178, v130, v162, v178
    v_dot2_f32_bf16 v179, v130, v163, v179
    v_dot2_f32_bf16 v180, v131, v162, v180
    v_dot2_f32_bf16 v181, v131, v163, v181
    v_dot2_f32_bf16 v182, v132, v162, v182
    v_dot2_f32_bf16 v183, v132, v163, v183
    v_dot2_f32_bf16 v184, v133, v162, v184
    v_dot2_f32_bf16 v185, v133, v163, v185
    v_dot2_f32_bf16 v186, v134, v162, v186
    v_dot2_f32_bf16 v187, v134, v163, v187
    v_dot2_f32_bf16 v188, v135, v162, v188
    v_dot2_f32_bf16 v189, v135, v163, v189
    ds_read_b64 v[126:127], v23 offset:21840
    ds_read_b64 v[128:129], v23 offset:21848
    ds_read_b64 v[130:131], v23 offset:21856
    ds_read_b64 v[132:133], v23 offset:21864
    ds_read_b64 v[134:135], v23 offset:21872
    s_waitcnt lgkmcnt(5)
    v_dot2_f32_bf16 v170, v136, v164, v170
    v_dot2_f32_bf16 v171, v136, v165, v171
    v_dot2_f32_bf16 v172, v137, v164, v172
    v_dot2_f32_bf16 v173, v137, v165, v173
    v_dot2_f32_bf16 v174, v138, v164, v174
    v_dot2_f32_bf16 v175, v138, v165, v175
    v_dot2_f32_bf16 v176, v139, v164, v176
    v_dot2_f32_bf16 v177, v139, v165, v177
    v_dot2_f32_bf16 v178, v140, v164, v178
    v_dot2_f32_bf16 v179, v140, v165, v179
    v_dot2_f32_bf16 v180, v141, v164, v180
    v_dot2_f32_bf16 v181, v141, v165, v181
    v_dot2_f32_bf16 v182, v142, v164, v182
    v_dot2_f32_bf16 v183, v142, v165, v183
    v_dot2_f32_bf16 v184, v143, v164, v184
    v_dot2_f32_bf16 v185, v143, v165, v185
    v_dot2_f32_bf16 v186, v144, v164, v186
    v_dot2_f32_bf16 v187, v144, v165, v187
    v_dot2_f32_bf16 v188, v145, v164, v188
    v_dot2_f32_bf16 v189, v145, v165, v189
    ds_read_b64 v[136:137], v23 offset:21504
    ds_read_b64 v[138:139], v23 offset:21512
    ds_read_b64 v[140:141], v23 offset:21520
    ds_read_b64 v[142:143], v23 offset:21528
    ds_read_b64 v[144:145], v23 offset:21536
    s_waitcnt lgkmcnt(5)
    v_dot2_f32_bf16 v170, v126, v166, v170
    v_dot2_f32_bf16 v171, v126, v167, v171
    v_dot2_f32_bf16 v172, v127, v166, v172
    v_dot2_f32_bf16 v173, v127, v167, v173
    v_dot2_f32_bf16 v174, v128, v166, v174
    v_dot2_f32_bf16 v175, v128, v167, v175
    v_dot2_f32_bf16 v176, v129, v166, v176
    v_dot2_f32_bf16 v177, v129, v167, v177
    v_dot2_f32_bf16 v178, v130, v166, v178
    v_dot2_f32_bf16 v179, v130, v167, v179
    v_dot2_f32_bf16 v180, v131, v166, v180
    v_dot2_f32_bf16 v181, v131, v167, v181
    v_dot2_f32_bf16 v182, v132, v166, v182
    v_dot2_f32_bf16 v183, v132, v167, v183
    v_dot2_f32_bf16 v184, v133, v166, v184
    v_dot2_f32_bf16 v185, v133, v167, v185
    v_dot2_f32_bf16 v186, v134, v166, v186
    v_dot2_f32_bf16 v187, v134, v167, v187
    v_dot2_f32_bf16 v188, v135, v166, v188
    v_dot2_f32_bf16 v189, v135, v167, v189
    s_waitcnt lgkmcnt(0)
    v_dot2_f32_bf16 v170, v136, v168, v170
    v_dot2_f32_bf16 v171, v136, v169, v171
    v_dot2_f32_bf16 v172, v137, v168, v172
    v_dot2_f32_bf16 v173, v137, v169, v173
    v_dot2_f32_bf16 v174, v138, v168, v174
    v_dot2_f32_bf16 v175, v138, v169, v175
    v_dot2_f32_bf16 v176, v139, v168, v176
    v_dot2_f32_bf16 v177, v139, v169, v177
    v_dot2_f32_bf16 v178, v140, v168, v178
    v_dot2_f32_bf16 v179, v140, v169, v179
    v_dot2_f32_bf16 v180, v141, v168, v180
    v_dot2_f32_bf16 v181, v141, v169, v181
    v_dot2_f32_bf16 v182, v142, v168, v182
    v_dot2_f32_bf16 v183, v142, v169, v183
    v_dot2_f32_bf16 v184, v143, v168, v184
    v_dot2_f32_bf16 v185, v143, v169, v185
    v_dot2_f32_bf16 v186, v144, v168, v186
    v_dot2_f32_bf16 v187, v144, v169, v187
    v_dot2_f32_bf16 v188, v145, v168, v188
    v_dot2_f32_bf16 v189, v145, v169, v189
    v_cvt_pk_bf16_f32 v116, v170, v171
    v_cvt_pk_bf16_f32 v117, v172, v173
    v_cvt_pk_bf16_f32 v118, v174, v175
    v_cvt_pk_bf16_f32 v119, v176, v177
    v_cvt_pk_bf16_f32 v120, v178, v179
    v_cvt_pk_bf16_f32 v121, v180, v181
    v_cvt_pk_bf16_f32 v122, v182, v183
    v_cvt_pk_bf16_f32 v123, v184, v185
    v_cvt_pk_bf16_f32 v124, v186, v187
    v_cvt_pk_bf16_f32 v125, v188, v189
    ds_write_b64 v22, v[116:117] offset:0
    ds_write_b64 v22, v[118:119] offset:8
    ds_write_b64 v22, v[120:121] offset:16
    ds_write_b64 v22, v[122:123] offset:24
    ds_write_b64 v22, v[124:125] offset:32
    s_waitcnt lgkmcnt(0)
    s_add_u32 s50, s50, 80
    s_cmp_lt_u32 s50, 160
    s_cbranch_scc1 L_pa_att
    s_cmp_lg_u32 s48, 0
    s_cbranch_scc1 L_pa_o1
    ds_read_b64 a[160:161], v28 offset:32
    ds_read_b64 a[162:163], v28 offset:40
    ds_read_b64 a[240:241], v28 offset:2720
    ds_read_b64 a[242:243], v28 offset:2728
    ds_read_b64 a[164:165], v28 offset:96
    ds_read_b64 a[166:167], v28 offset:104
    ds_read_b64 a[244:245], v28 offset:2784
    ds_read_b64 a[246:247], v28 offset:2792
    s_mov_b32 exec_hi, 0
    ds_read_b64 a[168:169], v28 offset:160
    ds_read_b64 a[170:171], v28 offset:168
    ds_read_b64 a[248:249], v28 offset:2848
    ds_read_b64 a[250:251], v28 offset:2856
    s_mov_b64 exec, -1
    s_branch L_pa_oe
L_pa_o1:
    s_cmp_lg_u32 s48, 1
    s_cbranch_scc1 L_pa_o2
    s_mov_b32 exec_lo, 0
    ds_read_b64 a[168:169], v28 offset:0
    ds_read_b64 a[170:171], v28 offset:8
    ds_read_b64 a[248:249], v28 offset:2688
    ds_read_b64 a[250:251], v28 offset:2696
    s_mov_b64 exec, -1
    ds_read_b64 a[172:173], v28 offset:64
    ds_read_b64 a[174:175], v28 offset:72
    ds_read_b64 a[252:253], v28 offset:2752
    ds_read_b64 a[254:255], v28 offset:2760
    ds_read_b64 a[176:177], v28 offset:128
    ds_read_b64 a[178:179], v28 offset:136
    ds_read_b64 v[32:33], v28 offset:2816
    ds_read_b64 v[34:35], v28 offset:2824
    s_branch L_pa_oe
L_pa_o2:
    s_cmp_lg_u32 s48, 2
    s_cbranch_scc1 L_pa_o3
    ds_read_b64 a[180:181], v28 offset:32
    ds_read_b64 a[182:183], v28 offset:40
    ds_read_b64 v[36:37], v28 offset:2720
    ds_read_b64 v[38:39], v28 offset:2728
    ds_read_b64 a[184:185], v28 offset:96
    ds_read_b64 a[186:187], v28 offset:104
    ds_read_b64 v[40:41], v28 offset:2784
    ds_read_b64 v[42:43], v28 offset:2792
    s_mov_b32 exec_hi, 0
    ds_read_b64 a[188:189], v28 offset:160
    ds_read_b64 a[190:191], v28 offset:168
    ds_read_b64 v[44:45], v28 offset:2848
    ds_read_b64 v[46:47], v28 offset:2856
    s_mov_b64 exec, -1
    s_branch L_pa_oe
L_pa_o3:
    s_cmp_lg_u32 s48, 3
    s_cbranch_scc1 L_pa_o4
    s_mov_b32 exec_lo, 0
    ds_read_b64 a[188:189], v28 offset:0
    ds_read_b64 a[190:191], v28 offset:8
    ds_read_b64 v[44:45], v28 offset:2688
    ds_read_b64 v[46:47], v28 offset:2696
    s_mov_b64 exec, -1
    ds_read_b64 a[192:193], v28 offset:64
    ds_read_b64 a[194:195], v28 offset:72
    ds_read_b64 v[48:49], v28 offset:2752
    ds_read_b64 v[50:51], v28 offset:2760
    ds_read_b64 a[196:197], v28 offset:128
    ds_read_b64 a[198:199], v28 offset:136
    ds_read_b64 v[52:53], v28 offset:2816
    ds_read_b64 v[54:55], v28 offset:2824
    s_branch L_pa_oe
L_pa_o4:
    s_cmp_lg_u32 s48, 4
    s_cbranch_scc1 L_pa_o5
    ds_read_b64 a[200:201], v28 offset:32
    ds_read_b64 a[202:203], v28 offset:40
    ds_read_b64 v[56:57], v28 offset:2720
    ds_read_b64 v[58:59], v28 offset:2728
    ds_read_b64 a[204:205], v28 offset:96
    ds_read_b64 a[206:207], v28 offset:104
    ds_read_b64 v[60:61], v28 offset:2784
    ds_read_b64 v[62:63], v28 offset:2792
    s_mov_b32 exec_hi, 0
    ds_read_b64 a[208:209], v28 offset:160
    ds_read_b64 a[210:211], v28 offset:168
    ds_read_b64 v[64:65], v28 offset:2848
    ds_read_b64 v[66:67], v28 offset:2856
    s_mov_b64 exec, -1
    s_branch L_pa_oe
L_pa_o5:
    s_cmp_lg_u32 s48, 5
    s_cbranch_scc1 L_pa_o6
    s_mov_b32 exec_lo, 0
    ds_read_b64 a[208:209], v28 offset:0
    ds_read_b64 a[210:211], v28 offset:8
    ds_read_b64 v[64:65], v28 offset:2688
    ds_read_b64 v[66:67], v28 offset:2696
    s_mov_b64 exec, -1
    ds_read_b64 a[212:213], v28 offset:64
    ds_read_b64 a[214:215], v28 offset:72
    ds_read_b64 v[68:69], v28 offset:2752
    ds_read_b64 v[70:71], v28 offset:2760
    ds_read_b64 a[216:217], v28 offset:128
    ds_read_b64 a[218:219], v28 offset:136
    ds_read_b64 v[72:73], v28 offset:2816
    ds_read_b64 v[74:75], v28 offset:2824
    s_branch L_pa_oe
L_pa_o6:
    s_cmp_lg_u32 s48, 6
    s_cbranch_scc1 L_pa_o7
    ds_read_b64 a[220:221], v28 offset:32
    ds_read_b64 a[222:223], v28 offset:40
    ds_read_b64 v[76:77], v28 offset:2720
    ds_read_b64 v[78:79], v28 offset:2728
    ds_read_b64 a[224:225], v28 offset:96
    ds_read_b64 a[226:227], v28 offset:104
    ds_read_b64 v[80:81], v28 offset:2784
    ds_read_b64 v[82:83], v28 offset:2792
    s_mov_b32 exec_hi, 0
    ds_read_b64 a[228:229], v28 offset:160
    ds_read_b64 a[230:231], v28 offset:168
    ds_read_b64 v[84:85], v28 offset:2848
    ds_read_b64 v[86:87], v28 offset:2856
    s_mov_b64 exec, -1
    s_branch L_pa_oe
L_pa_o7:
    s_mov_b32 exec_lo, 0
    ds_read_b64 a[228:229], v28 offset:0
    ds_read_b64 a[230:231], v28 offset:8
    ds_read_b64 v[84:85], v28 offset:2688
    ds_read_b64 v[86:87], v28 offset:2696
    s_mov_b64 exec, -1
    ds_read_b64 a[232:233], v28 offset:64
    ds_read_b64 a[234:235], v28 offset:72
    ds_read_b64 v[88:89], v28 offset:2752
    ds_read_b64 v[90:91], v28 offset:2760
    ds_read_b64 a[236:237], v28 offset:128
    ds_read_b64 a[238:239], v28 offset:136
    ds_read_b64 v[92:93], v28 offset:2816
    ds_read_b64 v[94:95], v28 offset:2824
L_pa_oe:
    s_waitcnt lgkmcnt(0)
    s_add_u32 s48, s48, 1
    s_and_b32 s48, s48, 7
    s_cmp_lg_u32 s48, s52
    s_cbranch_scc1 L_pa_grp
    v_add_u32 v3, 0, v0
    v_mul_u32_u24 v4, 6554, v3
    v_lshrrev_b32 v4, 16, v4
    v_mul_u32_u24 v5, 10, v4
    v_sub_u32 v5, v3, v5
    v_and_b32 v6, 19, v4
    v_and_b32 v7, 4, v4
    v_lshl_or_b32 v6, v7, 1, v6
    v_and_b32 v7, 8, v4
    v_lshrrev_b32 v7, 1, v7
    v_or_b32 v6, v6, v7
    s_lshl_b32 s90, s32, 5
    v_add_u32 v6, s90, v6
    v_mul_u32_u24 v6, 1280, v6
    v_lshl_add_u32 v10, v5, 4, v6
    v_add_u32 v3, 64, v0
    v_mul_u32_u24 v4, 6554, v3
    v_lshrrev_b32 v4, 16, v4
    v_mul_u32_u24 v5, 10, v4
    v_sub_u32 v5, v3, v5
    v_and_b32 v6, 19, v4
    v_and_b32 v7, 4, v4
    v_lshl_or_b32 v6, v7, 1, v6
    v_and_b32 v7, 8, v4
    v_lshrrev_b32 v7, 1, v7
    v_or_b32 v6, v6, v7
    s_lshl_b32 s90, s32, 5
    v_add_u32 v6, s90, v6
    v_mul_u32_u24 v6, 1280, v6
    v_lshl_add_u32 v11, v5, 4, v6
    v_add_u32 v3, 128, v0
    v_mul_u32_u24 v4, 6554, v3
    v_lshrrev_b32 v4, 16, v4
    v_mul_u32_u24 v5, 10, v4
    v_sub_u32 v5, v3, v5
    v_and_b32 v6, 19, v4
    v_and_b32 v7, 4, v4
    v_lshl_or_b32 v6, v7, 1, v6
    v_and_b32 v7, 8, v4
    v_lshrrev_b32 v7, 1, v7
    v_or_b32 v6, v6, v7
    s_lshl_b32 s90, s32, 5
    v_add_u32 v6, s90, v6
    v_mul_u32_u24 v6, 1280, v6
    v_lshl_add_u32 v12, v5, 4, v6
    v_add_u32 v3, 192, v0
    v_mul_u32_u24 v4, 6554, v3
    v_lshrrev_b32 v4, 16, v4
    v_mul_u32_u24 v5, 10, v4
    v_sub_u32 v5, v3, v5
    v_and_b32 v6, 19, v4
    v_and_b32 v7, 4, v4
    v_lshl_or_b32 v6, v7, 1, v6
    v_and_b32 v7, 8, v4
    v_lshrrev_b32 v7, 1, v7
    v_or_b32 v6, v6, v7
    s_lshl_b32 s90, s32, 5
    v_add_u32 v6, s90, v6
    v_mul_u32_u24 v6, 1280, v6
    v_lshl_add_u32 v13, v5, 4, v6
    v_add_u32 v3, 256, v0
    v_mul_u32_u24 v4, 6554, v3
    v_lshrrev_b32 v4, 16, v4
    v_mul_u32_u24 v5, 10, v4
    v_sub_u32 v5, v3, v5
    v_and_b32 v6, 19, v4
    v_and_b32 v7, 4, v4
    v_lshl_or_b32 v6, v7, 1, v6
    v_and_b32 v7, 8, v4
    v_lshrrev_b32 v7, 1, v7
    v_or_b32 v6, v6, v7
    s_lshl_b32 s90, s32, 5
    v_add_u32 v6, s90, v6
    v_mul_u32_u24 v6, 1280, v6
    v_lshl_add_u32 v14, v5, 4, v6
    s_waitcnt vmcnt(0) lgkmcnt(0)
    s_barrier
    s_mov_b32 s46, 0
    s_mov_b32 s47, 0
    s_mul_i32 s43, s52, 160
    s_mov_b32 s44, 0
    s_mov_b32 s45, 0
    s_mov_b32 s51, 39
    s_mov_b32 s48, s52
    s_mov_b32 s53, 0
    s_mul_i32 s90, s32, 5120
    s_add_u32 m0, s90, s47
    s_mul_i32 s91, s44, 163840
    s_add_u32 s91, s91, s43
    buffer_load_dwordx4 v10, s[20:23], s91 offen lds
    s_add_u32 s47, s47, 20480
    s_cmp_eq_u32 s47, 81920
    s_cselect_b32 s47, 0, s47
    s_cmp_lg_u32 s51, 0
    s_cselect_b32 s90, 1, 0
    s_sub_u32 s51, s51, s90
    s_add_u32 s44, s44, s90
    s_cmp_eq_u32 s44, 5
    s_cselect_b32 s44, 0, s44
    s_cselect_b32 s90, 160, 0
    s_add_u32 s43, s43, s90
    s_cmp_eq_u32 s43, 1280
    s_cselect_b32 s43, 0, s43
    s_add_u32 m0, m0, 1024
    s_nop 0
    buffer_load_dwordx4 v11, s[20:23], s91 offen lds
    s_add_u32 m0, m0, 1024
    s_nop 0
    buffer_load_dwordx4 v12, s[20:23], s91 offen lds
    s_add_u32 m0, m0, 1024
    s_nop 0
    buffer_load_dwordx4 v13, s[20:23], s91 offen lds
    s_add_u32 m0, m0, 1024
    s_nop 0
    buffer_load_dwordx4 v14, s[20:23], s91 offen lds
    s_mul_i32 s90, s32, 5120
    s_add_u32 m0, s90, s47
    s_mul_i32 s91, s44, 163840
    s_add_u32 s91, s91, s43
    buffer_load_dwordx4 v10, s[20:23], s91 offen lds
    s_add_u32 s47, s47, 20480
    s_cmp_eq_u32 s47, 81920
    s_cselect_b32 s47, 0, s47
    s_cmp_lg_u32 s51, 0
    s_cselect_b32 s90, 1, 0
    s_sub_u32 s51, s51, s90
    s_add_u32 s44, s44, s90
    s_cmp_eq_u32 s44, 5
    s_cselect_b32 s44, 0, s44
    s_cselect_b32 s90, 160, 0
    s_add_u32 s43, s43, s90
    s_cmp_eq_u32 s43, 1280
    s_cselect_b32 s43, 0, s43
    s_add_u32 m0, m0, 1024
    s_nop 0
    buffer_load_dwordx4 v11, s[20:23], s91 offen lds
    s_add_u32 m0, m0, 1024
    s_nop 0
    buffer_load_dwordx4 v12, s[20:23], s91 offen lds
    s_add_u32 m0, m0, 1024
    s_nop 0
    buffer_load_dwordx4 v13, s[20:23], s91 offen lds
    s_add_u32 m0, m0, 1024
    s_nop 0
    buffer_load_dwordx4 v14, s[20:23], s91 offen lds
    s_mul_i32 s90, s32, 5120
    s_add_u32 m0, s90, s47
    s_mul_i32 s91, s44, 163840
    s_add_u32 s91, s91, s43
    buffer_load_dwordx4 v10, s[20:23], s91 offen lds
    s_add_u32 s47, s47, 20480
    s_cmp_eq_u32 s47, 81920
    s_cselect_b32 s47, 0, s47
    s_cmp_lg_u32 s51, 0
    s_cselect_b32 s90, 1, 0
    s_sub_u32 s51, s51, s90
    s_add_u32 s44, s44, s90
    s_cmp_eq_u32 s44, 5
    s_cselect_b32 s44, 0, s44
    s_cselect_b32 s90, 160, 0
    s_add_u32 s43, s43, s90
    s_cmp_eq_u32 s43, 1280
    s_cselect_b32 s43, 0, s43
    s_add_u32 m0, m0, 1024
    s_nop 0
    buffer_load_dwordx4 v11, s[20:23], s91 offen lds
    s_add_u32 m0, m0, 1024
    s_nop 0
    buffer_load_dwordx4 v12, s[20:23], s91 offen lds
    s_add_u32 m0, m0, 1024
    s_nop 0
    buffer_load_dwordx4 v13, s[20:23], s91 offen lds
    s_add_u32 m0, m0, 1024
    s_nop 0
    buffer_load_dwordx4 v14, s[20:23], s91 offen lds
    v_add_u32 v16, s46, v15
    s_waitcnt vmcnt(10) lgkmcnt(0)
    s_barrier
    ds_read_b64_tr_b16 v[96:97], v16 offset:0
    ds_read_b64_tr_b16 v[98:99], v16 offset:1280
    ds_read_b64_tr_b16 v[100:101], v16 offset:32
    ds_read_b64_tr_b16 v[102:103], v16 offset:1312
    ds_read_b64_tr_b16 v[104:105], v16 offset:64
    ds_read_b64_tr_b16 v[106:107], v16 offset:1344
    ds_read_b64_tr_b16 v[108:109], v16 offset:96
    ds_read_b64_tr_b16 v[110:111], v16 offset:1376
    ds_read_b64_tr_b16 v[112:113], v16 offset:128
    ds_read_b64_tr_b16 v[114:115], v16 offset:1408
    s_mul_i32 s42, s52, 160
L_pa_oblk:
    s_waitcnt lgkmcnt(8)
    v_mfma_f32_16x16x32_bf16 v[136:139], v[96:99], a[160:163], 0
    ds_read_b64_tr_b16 v[116:117], v16 offset:5120
    s_add_u32 s46, s46, 20480
    s_cmp_eq_u32 s46, 81920
    v_mfma_f32_16x16x32_bf16 v[140:143], v[96:99], a[240:243], 0
    ds_read_b64_tr_b16 v[118:119], v16 offset:6400
    s_cselect_b32 s46, 0, s46
    s_mul_i32 s90, s32, 5120
    s_waitcnt lgkmcnt(8)
    v_mfma_f32_16x16x32_bf16 v[144:147], v[100:103], a[160:163], 0
    ds_read_b64_tr_b16 v[120:121], v16 offset:5152
    s_add_u32 m0, s90, s47
    s_mul_i32 s91, s44, 163840
    v_mfma_f32_16x16x32_bf16 v[148:151], v[100:103], a[240:243], 0
    ds_read_b64_tr_b16 v[122:123], v16 offset:6432
    s_add_u32 s91, s91, s43
    buffer_load_dwordx4 v10, s[20:23], s91 offen lds
    s_waitcnt lgkmcnt(8)
    v_mfma_f32_16x16x32_bf16 v[152:155], v[104:107], a[160:163], 0
    ds_read_b64_tr_b16 v[124:125], v16 offset:5184
    s_add_u32 s47, s47, 20480
    s_cmp_eq_u32 s47, 81920
    v_mfma_f32_16x16x32_bf16 v[156:159], v[104:107], a[240:243], 0
    ds_read_b64_tr_b16 v[126:127], v16 offset:6464
    s_cselect_b32 s47, 0, s47
    s_cmp_lg_u32 s51, 0
    s_waitcnt lgkmcnt(8)
    v_mfma_f32_16x16x32_bf16 v[160:163], v[108:111], a[160:163], 0
    ds_read_b64_tr_b16 v[128:129], v16 offset:5216
    s_cselect_b32 s90, 1, 0
    s_sub_u32 s51, s51, s90
    v_mfma_f32_16x16x32_bf16 v[164:167], v[108:111], a[240:243], 0
    ds_read_b64_tr_b16 v[130:131], v16 offset:6496
    s_add_u32 s44, s44, s90
    s_cmp_eq_u32 s44, 5
    s_waitcnt lgkmcnt(8)
    v_mfma_f32_16x16x32_bf16 v[168:171], v[112:115], a[160:163], 0
    ds_read_b64_tr_b16 v[132:133], v16 offset:5248
    s_cselect_b32 s44, 0, s44
    s_cselect_b32 s90, 160, 0
    v_mfma_f32_16x16x32_bf16 v[172:175], v[112:115], a[240:243], 0
    ds_read_b64_tr_b16 v[134:135], v16 offset:6528
    s_add_u32 s43, s43, s90
    s_cmp_eq_u32 s43, 1280
    s_waitcnt lgkmcnt(8)
    v_mfma_f32_16x16x32_bf16 v[136:139], v[116:119], a[164:167], v[136:139]
    ds_read_b64_tr_b16 v[96:97], v16 offset:10240
    s_cselect_b32 s43, 0, s43
    s_add_u32 m0, m0, 1024
    v_mfma_f32_16x16x32_bf16 v[140:143], v[116:119], a[244:247], v[140:143]
    ds_read_b64_tr_b16 v[98:99], v16 offset:11520
    buffer_load_dwordx4 v11, s[20:23], s91 offen lds
    s_add_u32 m0, m0, 1024
    s_waitcnt lgkmcnt(8)
    v_mfma_f32_16x16x32_bf16 v[144:147], v[120:123], a[164:167], v[144:147]
    ds_read_b64_tr_b16 v[100:101], v16 offset:10272
    v_mfma_f32_16x16x32_bf16 v[148:151], v[120:123], a[244:247], v[148:151]
    ds_read_b64_tr_b16 v[102:103], v16 offset:11552
    s_waitcnt lgkmcnt(8)
    v_mfma_f32_16x16x32_bf16 v[152:155], v[124:127], a[164:167], v[152:155]
    ds_read_b64_tr_b16 v[104:105], v16 offset:10304
    v_mfma_f32_16x16x32_bf16 v[156:159], v[124:127], a[244:247], v[156:159]
    ds_read_b64_tr_b16 v[106:107], v16 offset:11584
    s_waitcnt lgkmcnt(8)
    v_mfma_f32_16x16x32_bf16 v[160:163], v[128:131], a[164:167], v[160:163]
    ds_read_b64_tr_b16 v[108:109], v16 offset:10336
    buffer_load_dwordx4 v12, s[20:23], s91 offen lds
    s_add_u32 m0, m0, 1024
    v_mfma_f32_16x16x32_bf16 v[164:167], v[128:131], a[244:247], v[164:167]
    ds_read_b64_tr_b16 v[110:111], v16 offset:11616
    s_waitcnt lgkmcnt(8)
    v_mfma_f32_16x16x32_bf16 v[168:171], v[132:135], a[164:167], v[168:171]
    ds_read_b64_tr_b16 v[112:113], v16 offset:10368
    v_mfma_f32_16x16x32_bf16 v[172:175], v[132:135], a[244:247], v[172:175]
    ds_read_b64_tr_b16 v[114:115], v16 offset:11648
    s_waitcnt lgkmcnt(8)
    v_mfma_f32_16x16x32_bf16 v[136:139], v[96:99], a[168:171], v[136:139]
    ds_read_b64_tr_b16 v[116:117], v16 offset:15360
    v_mfma_f32_16x16x32_bf16 v[140:143], v[96:99], a[248:251], v[140:143]
    ds_read_b64_tr_b16 v[118:119], v16 offset:16640
    buffer_load_dwordx4 v13, s[20:23], s91 offen lds
    s_add_u32 m0, m0, 1024
    s_waitcnt lgkmcnt(8)
    v_mfma_f32_16x16x32_bf16 v[144:147], v[100:103], a[168:171], v[144:147]
    ds_read_b64_tr_b16 v[120:121], v16 offset:15392
    v_mfma_f32_16x16x32_bf16 v[148:151], v[100:103], a[248:251], v[148:151]
    ds_read_b64_tr_b16 v[122:123], v16 offset:16672
    s_waitcnt lgkmcnt(8)
    v_mfma_f32_16x16x32_bf16 v[152:155], v[104:107], a[168:171], v[152:155]
    ds_read_b64_tr_b16 v[124:125], v16 offset:15424
    v_mfma_f32_16x16x32_bf16 v[156:159], v[104:107], a[248:251], v[156:159]
    ds_read_b64_tr_b16 v[126:127], v16 offset:16704
    s_waitcnt lgkmcnt(8)
    v_mfma_f32_16x16x32_bf16 v[160:163], v[108:111], a[168:171], v[160:163]
    ds_read_b64_tr_b16 v[128:129], v16 offset:15456
    buffer_load_dwordx4 v14, s[20:23], s91 offen lds
    v_mfma_f32_16x16x32_bf16 v[164:167], v[108:111], a[248:251], v[164:167]
    ds_read_b64_tr_b16 v[130:131], v16 offset:16736
    s_waitcnt lgkmcnt(8)
    v_mfma_f32_16x16x32_bf16 v[168:171], v[112:115], a[168:171], v[168:171]
    ds_read_b64_tr_b16 v[132:133], v16 offset:15488
    v_mfma_f32_16x16x32_bf16 v[172:175], v[112:115], a[248:251], v[172:175]
    ds_read_b64_tr_b16 v[134:135], v16 offset:16768
    s_waitcnt lgkmcnt(8)
    v_mfma_f32_16x16x32_bf16 v[136:139], v[116:119], a[172:175], v[136:139]
    v_mfma_f32_16x16x32_bf16 v[140:143], v[116:119], a[252:255], v[140:143]
    s_waitcnt lgkmcnt(6)
    v_mfma_f32_16x16x32_bf16 v[144:147], v[120:123], a[172:175], v[144:147]
    v_mfma_f32_16x16x32_bf16 v[148:151], v[120:123], a[252:255], v[148:151]
    v_add_u32 v16, s46, v15
    s_waitcnt vmcnt(10) lgkmcnt(0)
    s_barrier
    v_mfma_f32_16x16x32_bf16 v[152:155], v[124:127], a[172:175], v[152:155]
    ds_read_b64_tr_b16 v[96:97], v16 offset:0
    ds_read_b64_tr_b16 v[98:99], v16 offset:1280
    v_mfma_f32_16x16x32_bf16 v[156:159], v[124:127], a[252:255], v[156:159]
    ds_read_b64_tr_b16 v[100:101], v16 offset:32
    ds_read_b64_tr_b16 v[102:103], v16 offset:1312
    v_mfma_f32_16x16x32_bf16 v[160:163], v[128:131], a[172:175], v[160:163]
    ds_read_b64_tr_b16 v[104:105], v16 offset:64
    ds_read_b64_tr_b16 v[106:107], v16 offset:1344
    v_mfma_f32_16x16x32_bf16 v[164:167], v[128:131], a[252:255], v[164:167]
    ds_read_b64_tr_b16 v[108:109], v16 offset:96
    ds_read_b64_tr_b16 v[110:111], v16 offset:1376
    v_mfma_f32_16x16x32_bf16 v[168:171], v[132:135], a[172:175], v[168:171]
    ds_read_b64_tr_b16 v[112:113], v16 offset:128
    ds_read_b64_tr_b16 v[114:115], v16 offset:1408
    v_mfma_f32_16x16x32_bf16 v[172:175], v[132:135], a[252:255], v[172:175]
    s_waitcnt lgkmcnt(8)
    v_mfma_f32_16x16x32_bf16 v[136:139], v[96:99], a[176:179], v[136:139]
    ds_read_b64_tr_b16 v[116:117], v16 offset:5120
    s_add_u32 s46, s46, 20480
    s_cmp_eq_u32 s46, 81920
    v_mfma_f32_16x16x32_bf16 v[140:143], v[96:99], v[32:35], v[140:143]
    ds_read_b64_tr_b16 v[118:119], v16 offset:6400
    s_cselect_b32 s46, 0, s46
    s_mul_i32 s90, s32, 5120
    s_waitcnt lgkmcnt(8)
    v_mfma_f32_16x16x32_bf16 v[144:147], v[100:103], a[176:179], v[144:147]
    ds_read_b64_tr_b16 v[120:121], v16 offset:5152
    s_add_u32 m0, s90, s47
    s_mul_i32 s91, s44, 163840
    v_mfma_f32_16x16x32_bf16 v[148:151], v[100:103], v[32:35], v[148:151]
    ds_read_b64_tr_b16 v[122:123], v16 offset:6432
    s_add_u32 s91, s91, s43
    buffer_load_dwordx4 v10, s[20:23], s91 offen lds
    s_waitcnt lgkmcnt(8)
    v_mfma_f32_16x16x32_bf16 v[152:155], v[104:107], a[176:179], v[152:155]
    ds_read_b64_tr_b16 v[124:125], v16 offset:5184
    s_add_u32 s47, s47, 20480
    s_cmp_eq_u32 s47, 81920
    v_mfma_f32_16x16x32_bf16 v[156:159], v[104:107], v[32:35], v[156:159]
    ds_read_b64_tr_b16 v[126:127], v16 offset:6464
    s_cselect_b32 s47, 0, s47
    s_cmp_lg_u32 s51, 0
    s_waitcnt lgkmcnt(8)
    v_mfma_f32_16x16x32_bf16 v[160:163], v[108:111], a[176:179], v[160:163]
    ds_read_b64_tr_b16 v[128:129], v16 offset:5216
    s_cselect_b32 s90, 1, 0
    s_sub_u32 s51, s51, s90
    v_mfma_f32_16x16x32_bf16 v[164:167], v[108:111], v[32:35], v[164:167]
    ds_read_b64_tr_b16 v[130:131], v16 offset:6496
    s_add_u32 s44, s44, s90
    s_cmp_eq_u32 s44, 5
    s_waitcnt lgkmcnt(8)
    v_mfma_f32_16x16x32_bf16 v[168:171], v[112:115], a[176:179], v[168:171]
    ds_read_b64_tr_b16 v[132:133], v16 offset:5248
    s_cselect_b32 s44, 0, s44
    s_cselect_b32 s90, 160, 0
    v_mfma_f32_16x16x32_bf16 v[172:175], v[112:115], v[32:35], v[172:175]
    ds_read_b64_tr_b16 v[134:135], v16 offset:6528
    s_add_u32 s43, s43, s90
    s_cmp_eq_u32 s43, 1280
    s_waitcnt lgkmcnt(8)
    v_mfma_f32_16x16x32_bf16 v[136:139], v[116:119], a[180:183], v[136:139]
    ds_read_b64_tr_b16 v[96:97], v16 offset:10240
    s_cselect_b32 s43, 0, s43
    s_add_u32 m0, m0, 1024
    v_mfma_f32_16x16x32_bf16 v[140:143], v[116:119], v[36:39], v[140:143]
    ds_read_b64_tr_b16 v[98:99], v16 offset:11520
    buffer_load_dwordx4 v11, s[20:23], s91 offen lds
    s_add_u32 m0, m0, 1024
    s_waitcnt lgkmcnt(8)
    v_mfma_f32_16x16x32_bf16 v[144:147], v[120:123], a[180:183], v[144:147]
    ds_read_b64_tr_b16 v[100:101], v16 offset:10272
    v_mfma_f32_16x16x32_bf16 v[148:151], v[120:123], v[36:39], v[148:151]
    ds_read_b64_tr_b16 v[102:103], v16 offset:11552
    s_waitcnt lgkmcnt(8)
    v_mfma_f32_16x16x32_bf16 v[152:155], v[124:127], a[180:183], v[152:155]
    ds_read_b64_tr_b16 v[104:105], v16 offset:10304
    v_mfma_f32_16x16x32_bf16 v[156:159], v[124:127], v[36:39], v[156:159]
    ds_read_b64_tr_b16 v[106:107], v16 offset:11584
    s_waitcnt lgkmcnt(8)
    v_mfma_f32_16x16x32_bf16 v[160:163], v[128:131], a[180:183], v[160:163]
    ds_read_b64_tr_b16 v[108:109], v16 offset:10336
    buffer_load_dwordx4 v12, s[20:23], s91 offen lds
    s_add_u32 m0, m0, 1024
    v_mfma_f32_16x16x32_bf16 v[164:167], v[128:131], v[36:39], v[164:167]
    ds_read_b64_tr_b16 v[110:111], v16 offset:11616
    s_waitcnt lgkmcnt(8)
    v_mfma_f32_16x16x32_bf16 v[168:171], v[132:135], a[180:183], v[168:171]
    ds_read_b64_tr_b16 v[112:113], v16 offset:10368
    v_mfma_f32_16x16x32_bf16 v[172:175], v[132:135], v[36:39], v[172:175]
    ds_read_b64_tr_b16 v[114:115], v16 offset:11648
    s_waitcnt lgkmcnt(8)
    v_mfma_f32_16x16x32_bf16 v[136:139], v[96:99], a[184:187], v[136:139]
    ds_read_b64_tr_b16 v[116:117], v16 offset:15360
    v_mfma_f32_16x16x32_bf16 v[140:143], v[96:99], v[40:43], v[140:143]
    ds_read_b64_tr_b16 v[118:119], v16 offset:16640
    buffer_load_dwordx4 v13, s[20:23], s91 offen lds
    s_add_u32 m0, m0, 1024
    s_waitcnt lgkmcnt(8)
    v_mfma_f32_16x16x32_bf16 v[144:147], v[100:103], a[184:187], v[144:147]
    ds_read_b64_tr_b16 v[120:121], v16 offset:15392
    v_mfma_f32_16x16x32_bf16 v[148:151], v[100:103], v[40:43], v[148:151]
    ds_read_b64_tr_b16 v[122:123], v16 offset:16672
    s_waitcnt lgkmcnt(8)
    v_mfma_f32_16x16x32_bf16 v[152:155], v[104:107], a[184:187], v[152:155]
    ds_read_b64_tr_b16 v[124:125], v16 offset:15424
    v_mfma_f32_16x16x32_bf16 v[156:159], v[104:107], v[40:43], v[156:159]
    ds_read_b64_tr_b16 v[126:127], v16 offset:16704
    s_waitcnt lgkmcnt(8)
    v_mfma_f32_16x16x32_bf16 v[160:163], v[108:111], a[184:187], v[160:163]
    ds_read_b64_tr_b16 v[128:129], v16 offset:15456
    buffer_load_dwordx4 v14, s[20:23], s91 offen lds
    v_mfma_f32_16x16x32_bf16 v[164:167], v[108:111], v[40:43], v[164:167]
    ds_read_b64_tr_b16 v[130:131], v16 offset:16736
    s_waitcnt lgkmcnt(8)
    v_mfma_f32_16x16x32_bf16 v[168:171], v[112:115], a[184:187], v[168:171]
    ds_read_b64_tr_b16 v[132:133], v16 offset:15488
    v_mfma_f32_16x16x32_bf16 v[172:175], v[112:115], v[40:43], v[172:175]
    ds_read_b64_tr_b16 v[134:135], v16 offset:16768
    s_waitcnt lgkmcnt(8)
    v_mfma_f32_16x16x32_bf16 v[136:139], v[116:119], a[188:191], v[136:139]
    v_mfma_f32_16x16x32_bf16 v[140:143], v[116:119], v[44:47], v[140:143]
    s_waitcnt lgkmcnt(6)
    v_mfma_f32_16x16x32_bf16 v[144:147], v[120:123], a[188:191], v[144:147]
    v_mfma_f32_16x16x32_bf16 v[148:151], v[120:123], v[44:47], v[148:151]
    v_add_u32 v16, s46, v15
    s_waitcnt vmcnt(10) lgkmcnt(0)
    s_barrier
    v_mfma_f32_16x16x32_bf16 v[152:155], v[124:127], a[188:191], v[152:155]
    ds_read_b64_tr_b16 v[96:97], v16 offset:0
    ds_read_b64_tr_b16 v[98:99], v16 offset:1280
    v_mfma_f32_16x16x32_bf16 v[156:159], v[124:127], v[44:47], v[156:159]
    ds_read_b64_tr_b16 v[100:101], v16 offset:32
    ds_read_b64_tr_b16 v[102:103], v16 offset:1312
    v_mfma_f32_16x16x32_bf16 v[160:163], v[128:131], a[188:191], v[160:163]
    ds_read_b64_tr_b16 v[104:105], v16 offset:64
    ds_read_b64_tr_b16 v[106:107], v16 offset:1344
    v_mfma_f32_16x16x32_bf16 v[164:167], v[128:131], v[44:47], v[164:167]
    ds_read_b64_tr_b16 v[108:109], v16 offset:96
    ds_read_b64_tr_b16 v[110:111], v16 offset:1376
    v_mfma_f32_16x16x32_bf16 v[168:171], v[132:135], a[188:191], v[168:171]
    ds_read_b64_tr_b16 v[112:113], v16 offset:128
    ds_read_b64_tr_b16 v[114:115], v16 offset:1408
    v_mfma_f32_16x16x32_bf16 v[172:175], v[132:135], v[44:47], v[172:175]
    s_waitcnt lgkmcnt(8)
    v_mfma_f32_16x16x32_bf16 v[136:139], v[96:99], a[192:195], v[136:139]
    ds_read_b64_tr_b16 v[116:117], v16 offset:5120
    s_add_u32 s46, s46, 20480
    s_cmp_eq_u32 s46, 81920
    v_mfma_f32_16x16x32_bf16 v[140:143], v[96:99], v[48:51], v[140:143]
    ds_read_b64_tr_b16 v[118:119], v16 offset:6400
    s_cselect_b32 s46, 0, s46
    s_mul_i32 s90, s32, 5120
    s_waitcnt lgkmcnt(8)
    v_mfma_f32_16x16x32_bf16 v[144:147], v[100:103], a[192:195], v[144:147]
    ds_read_b64_tr_b16 v[120:121], v16 offset:5152
    s_add_u32 m0, s90, s47
    s_mul_i32 s91, s44, 163840
    v_mfma_f32_16x16x32_bf16 v[148:151], v[100:103], v[48:51], v[148:151]
    ds_read_b64_tr_b16 v[122:123], v16 offset:6432
    s_add_u32 s91, s91, s43
    buffer_load_dwordx4 v10, s[20:23], s91 offen lds
    s_waitcnt lgkmcnt(8)
    v_mfma_f32_16x16x32_bf16 v[152:155], v[104:107], a[192:195], v[152:155]
    ds_read_b64_tr_b16 v[124:125], v16 offset:5184
    s_add_u32 s47, s47, 20480
    s_cmp_eq_u32 s47, 81920
    v_mfma_f32_16x16x32_bf16 v[156:159], v[104:107], v[48:51], v[156:159]
    ds_read_b64_tr_b16 v[126:127], v16 offset:6464
    s_cselect_b32 s47, 0, s47
    s_cmp_lg_u32 s51, 0
    s_waitcnt lgkmcnt(8)
    v_mfma_f32_16x16x32_bf16 v[160:163], v[108:111], a[192:195], v[160:163]
    ds_read_b64_tr_b16 v[128:129], v16 offset:5216
    s_cselect_b32 s90, 1, 0
    s_sub_u32 s51, s51, s90
    v_mfma_f32_16x16x32_bf16 v[164:167], v[108:111], v[48:51], v[164:167]
    ds_read_b64_tr_b16 v[130:131], v16 offset:6496
    s_add_u32 s44, s44, s90
    s_cmp_eq_u32 s44, 5
    s_waitcnt lgkmcnt(8)
    v_mfma_f32_16x16x32_bf16 v[168:171], v[112:115], a[192:195], v[168:171]
    ds_read_b64_tr_b16 v[132:133], v16 offset:5248
    s_cselect_b32 s44, 0, s44
    s_cselect_b32 s90, 160, 0
    v_mfma_f32_16x16x32_bf16 v[172:175], v[112:115], v[48:51], v[172:175]
    ds_read_b64_tr_b16 v[134:135], v16 offset:6528
    s_add_u32 s43, s43, s90
    s_cmp_eq_u32 s43, 1280
    s_waitcnt lgkmcnt(8)
    v_mfma_f32_16x16x32_bf16 v[136:139], v[116:119], a[196:199], v[136:139]
    ds_read_b64_tr_b16 v[96:97], v16 offset:10240
    s_cselect_b32 s43, 0, s43
    s_add_u32 m0, m0, 1024
    v_mfma_f32_16x16x32_bf16 v[140:143], v[116:119], v[52:55], v[140:143]
    ds_read_b64_tr_b16 v[98:99], v16 offset:11520
    buffer_load_dwordx4 v11, s[20:23], s91 offen lds
    s_add_u32 m0, m0, 1024
    s_waitcnt lgkmcnt(8)
    v_mfma_f32_16x16x32_bf16 v[144:147], v[120:123], a[196:199], v[144:147]
    ds_read_b64_tr_b16 v[100:101], v16 offset:10272
    v_mfma_f32_16x16x32_bf16 v[148:151], v[120:123], v[52:55], v[148:151]
    ds_read_b64_tr_b16 v[102:103], v16 offset:11552
    s_waitcnt lgkmcnt(8)
    v_mfma_f32_16x16x32_bf16 v[152:155], v[124:127], a[196:199], v[152:155]
    ds_read_b64_tr_b16 v[104:105], v16 offset:10304
    v_mfma_f32_16x16x32_bf16 v[156:159], v[124:127], v[52:55], v[156:159]
    ds_read_b64_tr_b16 v[106:107], v16 offset:11584
    s_waitcnt lgkmcnt(8)
    v_mfma_f32_16x16x32_bf16 v[160:163], v[128:131], a[196:199], v[160:163]
    ds_read_b64_tr_b16 v[108:109], v16 offset:10336
    buffer_load_dwordx4 v12, s[20:23], s91 offen lds
    s_add_u32 m0, m0, 1024
    v_mfma_f32_16x16x32_bf16 v[164:167], v[128:131], v[52:55], v[164:167]
    ds_read_b64_tr_b16 v[110:111], v16 offset:11616
    s_waitcnt lgkmcnt(8)
    v_mfma_f32_16x16x32_bf16 v[168:171], v[132:135], a[196:199], v[168:171]
    ds_read_b64_tr_b16 v[112:113], v16 offset:10368
    v_mfma_f32_16x16x32_bf16 v[172:175], v[132:135], v[52:55], v[172:175]
    ds_read_b64_tr_b16 v[114:115], v16 offset:11648
    s_waitcnt lgkmcnt(8)
    v_mfma_f32_16x16x32_bf16 v[136:139], v[96:99], a[200:203], v[136:139]
    ds_read_b64_tr_b16 v[116:117], v16 offset:15360
    v_mfma_f32_16x16x32_bf16 v[140:143], v[96:99], v[56:59], v[140:143]
    ds_read_b64_tr_b16 v[118:119], v16 offset:16640
    buffer_load_dwordx4 v13, s[20:23], s91 offen lds
    s_add_u32 m0, m0, 1024
    s_waitcnt lgkmcnt(8)
    v_mfma_f32_16x16x32_bf16 v[144:147], v[100:103], a[200:203], v[144:147]
    ds_read_b64_tr_b16 v[120:121], v16 offset:15392
    v_mfma_f32_16x16x32_bf16 v[148:151], v[100:103], v[56:59], v[148:151]
    ds_read_b64_tr_b16 v[122:123], v16 offset:16672
    s_waitcnt lgkmcnt(8)
    v_mfma_f32_16x16x32_bf16 v[152:155], v[104:107], a[200:203], v[152:155]
    ds_read_b64_tr_b16 v[124:125], v16 offset:15424
    v_mfma_f32_16x16x32_bf16 v[156:159], v[104:107], v[56:59], v[156:159]
    ds_read_b64_tr_b16 v[126:127], v16 offset:16704
    s_waitcnt lgkmcnt(8)
    v_mfma_f32_16x16x32_bf16 v[160:163], v[108:111], a[200:203], v[160:163]
    ds_read_b64_tr_b16 v[128:129], v16 offset:15456
    buffer_load_dwordx4 v14, s[20:23], s91 offen lds
    v_mfma_f32_16x16x32_bf16 v[164:167], v[108:111], v[56:59], v[164:167]
    ds_read_b64_tr_b16 v[130:131], v16 offset:16736
    s_waitcnt lgkmcnt(8)
    v_mfma_f32_16x16x32_bf16 v[168:171], v[112:115], a[200:203], v[168:171]
    ds_read_b64_tr_b16 v[132:133], v16 offset:15488
    v_mfma_f32_16x16x32_bf16 v[172:175], v[112:115], v[56:59], v[172:175]
    ds_read_b64_tr_b16 v[134:135], v16 offset:16768
    s_waitcnt lgkmcnt(8)
    v_mfma_f32_16x16x32_bf16 v[136:139], v[116:119], a[204:207], v[136:139]
    v_mfma_f32_16x16x32_bf16 v[140:143], v[116:119], v[60:63], v[140:143]
    s_waitcnt lgkmcnt(6)
    v_mfma_f32_16x16x32_bf16 v[144:147], v[120:123], a[204:207], v[144:147]
    v_mfma_f32_16x16x32_bf16 v[148:151], v[120:123], v[60:63], v[148:151]
    v_add_u32 v16, s46, v15
    s_waitcnt vmcnt(10) lgkmcnt(0)
    s_barrier
    v_mfma_f32_16x16x32_bf16 v[152:155], v[124:127], a[204:207], v[152:155]
    ds_read_b64_tr_b16 v[96:97], v16 offset:0
    ds_read_b64_tr_b16 v[98:99], v16 offset:1280
    v_mfma_f32_16x16x32_bf16 v[156:159], v[124:127], v[60:63], v[156:159]
    ds_read_b64_tr_b16 v[100:101], v16 offset:32
    ds_read_b64_tr_b16 v[102:103], v16 offset:1312
    v_mfma_f32_16x16x32_bf16 v[160:163], v[128:131], a[204:207], v[160:163]
    ds_read_b64_tr_b16 v[104:105], v16 offset:64
    ds_read_b64_tr_b16 v[106:107], v16 offset:1344
    v_mfma_f32_16x16x32_bf16 v[164:167], v[128:131], v[60:63], v[164:167]
    ds_read_b64_tr_b16 v[108:109], v16 offset:96
    ds_read_b64_tr_b16 v[110:111], v16 offset:1376
    v_mfma_f32_16x16x32_bf16 v[168:171], v[132:135], a[204:207], v[168:171]
    ds_read_b64_tr_b16 v[112:113], v16 offset:128
    ds_read_b64_tr_b16 v[114:115], v16 offset:1408
    v_mfma_f32_16x16x32_bf16 v[172:175], v[132:135], v[60:63], v[172:175]
    s_waitcnt lgkmcnt(8)
    v_mfma_f32_16x16x32_bf16 v[136:139], v[96:99], a[208:211], v[136:139]
    ds_read_b64_tr_b16 v[116:117], v16 offset:5120
    s_add_u32 s46, s46, 20480
    s_cmp_eq_u32 s46, 81920
    v_mfma_f32_16x16x32_bf16 v[140:143], v[96:99], v[64:67], v[140:143]
    ds_read_b64_tr_b16 v[118:119], v16 offset:6400
    s_cselect_b32 s46, 0, s46
    s_mul_i32 s90, s32, 5120
    s_waitcnt lgkmcnt(8)
    v_mfma_f32_16x16x32_bf16 v[144:147], v[100:103], a[208:211], v[144:147]
    ds_read_b64_tr_b16 v[120:121], v16 offset:5152
    s_add_u32 m0, s90, s47
    s_mul_i32 s91, s44, 163840
    v_mfma_f32_16x16x32_bf16 v[148:151], v[100:103], v[64:67], v[148:151]
    ds_read_b64_tr_b16 v[122:123], v16 offset:6432
    s_add_u32 s91, s91, s43
    buffer_load_dwordx4 v10, s[20:23], s91 offen lds
    s_waitcnt lgkmcnt(8)
    v_mfma_f32_16x16x32_bf16 v[152:155], v[104:107], a[208:211], v[152:155]
    ds_read_b64_tr_b16 v[124:125], v16 offset:5184
    s_add_u32 s47, s47, 20480
    s_cmp_eq_u32 s47, 81920
    v_mfma_f32_16x16x32_bf16 v[156:159], v[104:107], v[64:67], v[156:159]
    ds_read_b64_tr_b16 v[126:127], v16 offset:6464
    s_cselect_b32 s47, 0, s47
    s_cmp_lg_u32 s51, 0
    s_waitcnt lgkmcnt(8)
    v_mfma_f32_16x16x32_bf16 v[160:163], v[108:111], a[208:211], v[160:163]
    ds_read_b64_tr_b16 v[128:129], v16 offset:5216
    s_cselect_b32 s90, 1, 0
    s_sub_u32 s51, s51, s90
    v_mfma_f32_16x16x32_bf16 v[164:167], v[108:111], v[64:67], v[164:167]
    ds_read_b64_tr_b16 v[130:131], v16 offset:6496
    s_add_u32 s44, s44, s90
    s_cmp_eq_u32 s44, 5
    s_waitcnt lgkmcnt(8)
    v_mfma_f32_16x16x32_bf16 v[168:171], v[112:115], a[208:211], v[168:171]
    ds_read_b64_tr_b16 v[132:133], v16 offset:5248
    s_cselect_b32 s44, 0, s44
    s_cselect_b32 s90, 160, 0
    v_mfma_f32_16x16x32_bf16 v[172:175], v[112:115], v[64:67], v[172:175]
    ds_read_b64_tr_b16 v[134:135], v16 offset:6528
    s_add_u32 s43, s43, s90
    s_cmp_eq_u32 s43, 1280
    s_waitcnt lgkmcnt(8)
    v_mfma_f32_16x16x32_bf16 v[136:139], v[116:119], a[212:215], v[136:139]
    ds_read_b64_tr_b16 v[96:97], v16 offset:10240
    s_cselect_b32 s43, 0, s43
    s_add_u32 m0, m0, 1024
    v_mfma_f32_16x16x32_bf16 v[140:143], v[116:119], v[68:71], v[140:143]
    ds_read_b64_tr_b16 v[98:99], v16 offset:11520
    buffer_load_dwordx4 v11, s[20:23], s91 offen lds
    s_add_u32 m0, m0, 1024
    s_waitcnt lgkmcnt(8)
    v_mfma_f32_16x16x32_bf16 v[144:147], v[120:123], a[212:215], v[144:147]
    ds_read_b64_tr_b16 v[100:101], v16 offset:10272
    v_mfma_f32_16x16x32_bf16 v[148:151], v[120:123], v[68:71], v[148:151]
    ds_read_b64_tr_b16 v[102:103], v16 offset:11552
    s_waitcnt lgkmcnt(8)
    v_mfma_f32_16x16x32_bf16 v[152:155], v[124:127], a[212:215], v[152:155]
    ds_read_b64_tr_b16 v[104:105], v16 offset:10304
    v_mfma_f32_16x16x32_bf16 v[156:159], v[124:127], v[68:71], v[156:159]
    ds_read_b64_tr_b16 v[106:107], v16 offset:11584
    s_waitcnt lgkmcnt(8)
    v_mfma_f32_16x16x32_bf16 v[160:163], v[128:131], a[212:215], v[160:163]
    ds_read_b64_tr_b16 v[108:109], v16 offset:10336
    buffer_load_dwordx4 v12, s[20:23], s91 offen lds
    s_add_u32 m0, m0, 1024
    v_mfma_f32_16x16x32_bf16 v[164:167], v[128:131], v[68:71], v[164:167]
    ds_read_b64_tr_b16 v[110:111], v16 offset:11616
    s_waitcnt lgkmcnt(8)
    v_mfma_f32_16x16x32_bf16 v[168:171], v[132:135], a[212:215], v[168:171]
    ds_read_b64_tr_b16 v[112:113], v16 offset:10368
    v_mfma_f32_16x16x32_bf16 v[172:175], v[132:135], v[68:71], v[172:175]
    ds_read_b64_tr_b16 v[114:115], v16 offset:11648
    s_waitcnt lgkmcnt(8)
    v_mfma_f32_16x16x32_bf16 v[136:139], v[96:99], a[216:219], v[136:139]
    ds_read_b64_tr_b16 v[116:117], v16 offset:15360
    v_mfma_f32_16x16x32_bf16 v[140:143], v[96:99], v[72:75], v[140:143]
    ds_read_b64_tr_b16 v[118:119], v16 offset:16640
    buffer_load_dwordx4 v13, s[20:23], s91 offen lds
    s_add_u32 m0, m0, 1024
    s_waitcnt lgkmcnt(8)
    v_mfma_f32_16x16x32_bf16 v[144:147], v[100:103], a[216:219], v[144:147]
    ds_read_b64_tr_b16 v[120:121], v16 offset:15392
    v_mfma_f32_16x16x32_bf16 v[148:151], v[100:103], v[72:75], v[148:151]
    ds_read_b64_tr_b16 v[122:123], v16 offset:16672
    s_waitcnt lgkmcnt(8)
    v_mfma_f32_16x16x32_bf16 v[152:155], v[104:107], a[216:219], v[152:155]
    ds_read_b64_tr_b16 v[124:125], v16 offset:15424
    v_mfma_f32_16x16x32_bf16 v[156:159], v[104:107], v[72:75], v[156:159]
    ds_read_b64_tr_b16 v[126:127], v16 offset:16704
    s_waitcnt lgkmcnt(8)
    v_mfma_f32_16x16x32_bf16 v[160:163], v[108:111], a[216:219], v[160:163]
    ds_read_b64_tr_b16 v[128:129], v16 offset:15456
    buffer_load_dwordx4 v14, s[20:23], s91 offen lds
    v_mfma_f32_16x16x32_bf16 v[164:167], v[108:111], v[72:75], v[164:167]
    ds_read_b64_tr_b16 v[130:131], v16 offset:16736
    s_waitcnt lgkmcnt(8)
    v_mfma_f32_16x16x32_bf16 v[168:171], v[112:115], a[216:219], v[168:171]
    ds_read_b64_tr_b16 v[132:133], v16 offset:15488
    v_mfma_f32_16x16x32_bf16 v[172:175], v[112:115], v[72:75], v[172:175]
    ds_read_b64_tr_b16 v[134:135], v16 offset:16768
    s_waitcnt lgkmcnt(8)
    v_mfma_f32_16x16x32_bf16 v[136:139], v[116:119], a[220:223], v[136:139]
    v_mfma_f32_16x16x32_bf16 v[140:143], v[116:119], v[76:79], v[140:143]
    s_waitcnt lgkmcnt(6)
    v_mfma_f32_16x16x32_bf16 v[144:147], v[120:123], a[220:223], v[144:147]
    v_mfma_f32_16x16x32_bf16 v[148:151], v[120:123], v[76:79], v[148:151]
    v_add_u32 v16, s46, v15
    s_waitcnt vmcnt(10) lgkmcnt(0)
    s_barrier
    v_mfma_f32_16x16x32_bf16 v[152:155], v[124:127], a[220:223], v[152:155]
    ds_read_b64_tr_b16 v[96:97], v16 offset:0
    ds_read_b64_tr_b16 v[98:99], v16 offset:1280
    v_mfma_f32_16x16x32_bf16 v[156:159], v[124:127], v[76:79], v[156:159]
    ds_read_b64_tr_b16 v[100:101], v16 offset:32
    ds_read_b64_tr_b16 v[102:103], v16 offset:1312
    v_mfma_f32_16x16x32_bf16 v[160:163], v[128:131], a[220:223], v[160:163]
    ds_read_b64_tr_b16 v[104:105], v16 offset:64
    ds_read_b64_tr_b16 v[106:107], v16 offset:1344
    v_mfma_f32_16x16x32_bf16 v[164:167], v[128:131], v[76:79], v[164:167]
    ds_read_b64_tr_b16 v[108:109], v16 offset:96
    ds_read_b64_tr_b16 v[110:111], v16 offset:1376
    v_mfma_f32_16x16x32_bf16 v[168:171], v[132:135], a[220:223], v[168:171]
    ds_read_b64_tr_b16 v[112:113], v16 offset:128
    ds_read_b64_tr_b16 v[114:115], v16 offset:1408
    v_mfma_f32_16x16x32_bf16 v[172:175], v[132:135], v[76:79], v[172:175]
    s_waitcnt lgkmcnt(8)
    v_mfma_f32_16x16x32_bf16 v[136:139], v[96:99], a[224:227], v[136:139]
    ds_read_b64_tr_b16 v[116:117], v16 offset:5120
    s_add_u32 s46, s46, 20480
    s_cmp_eq_u32 s46, 81920
    v_mfma_f32_16x16x32_bf16 v[140:143], v[96:99], v[80:83], v[140:143]
    ds_read_b64_tr_b16 v[118:119], v16 offset:6400
    s_cselect_b32 s46, 0, s46
    s_mul_i32 s90, s32, 5120
    s_waitcnt lgkmcnt(8)
    v_mfma_f32_16x16x32_bf16 v[144:147], v[100:103], a[224:227], v[144:147]
    ds_read_b64_tr_b16 v[120:121], v16 offset:5152
    s_add_u32 m0, s90, s47
    s_mul_i32 s91, s44, 163840
    v_mfma_f32_16x16x32_bf16 v[148:151], v[100:103], v[80:83], v[148:151]
    ds_read_b64_tr_b16 v[122:123], v16 offset:6432
    s_add_u32 s91, s91, s43
    buffer_load_dwordx4 v10, s[20:23], s91 offen lds
    s_waitcnt lgkmcnt(8)
    v_mfma_f32_16x16x32_bf16 v[152:155], v[104:107], a[224:227], v[152:155]
    ds_read_b64_tr_b16 v[124:125], v16 offset:5184
    s_add_u32 s47, s47, 20480
    s_cmp_eq_u32 s47, 81920
    v_mfma_f32_16x16x32_bf16 v[156:159], v[104:107], v[80:83], v[156:159]
    ds_read_b64_tr_b16 v[126:127], v16 offset:6464
    s_cselect_b32 s47, 0, s47
    s_cmp_lg_u32 s51, 0
    s_waitcnt lgkmcnt(8)
    v_mfma_f32_16x16x32_bf16 v[160:163], v[108:111], a[224:227], v[160:163]
    ds_read_b64_tr_b16 v[128:129], v16 offset:5216
    s_cselect_b32 s90, 1, 0
    s_sub_u32 s51, s51, s90
    v_mfma_f32_16x16x32_bf16 v[164:167], v[108:111], v[80:83], v[164:167]
    ds_read_b64_tr_b16 v[130:131], v16 offset:6496
    s_add_u32 s44, s44, s90
    s_cmp_eq_u32 s44, 5
    s_waitcnt lgkmcnt(8)
    v_mfma_f32_16x16x32_bf16 v[168:171], v[112:115], a[224:227], v[168:171]
    ds_read_b64_tr_b16 v[132:133], v16 offset:5248
    s_cselect_b32 s44, 0, s44
    s_cselect_b32 s90, 160, 0
    v_mfma_f32_16x16x32_bf16 v[172:175], v[112:115], v[80:83], v[172:175]
    ds_read_b64_tr_b16 v[134:135], v16 offset:6528
    s_add_u32 s43, s43, s90
    s_cmp_eq_u32 s43, 1280
    s_waitcnt lgkmcnt(8)
    v_mfma_f32_16x16x32_bf16 v[136:139], v[116:119], a[228:231], v[136:139]
    ds_read_b64_tr_b16 v[96:97], v16 offset:10240
    s_cselect_b32 s43, 0, s43
    s_add_u32 m0, m0, 1024
    v_mfma_f32_16x16x32_bf16 v[140:143], v[116:119], v[84:87], v[140:143]
    ds_read_b64_tr_b16 v[98:99], v16 offset:11520
    buffer_load_dwordx4 v11, s[20:23], s91 offen lds
    s_add_u32 m0, m0, 1024
    s_waitcnt lgkmcnt(8)
    v_mfma_f32_16x16x32_bf16 v[144:147], v[120:123], a[228:231], v[144:147]
    ds_read_b64_tr_b16 v[100:101], v16 offset:10272
    v_mfma_f32_16x16x32_bf16 v[148:151], v[120:123], v[84:87], v[148:151]
    ds_read_b64_tr_b16 v[102:103], v16 offset:11552
    s_waitcnt lgkmcnt(8)
    v_mfma_f32_16x16x32_bf16 v[152:155], v[124:127], a[228:231], v[152:155]
    ds_read_b64_tr_b16 v[104:105], v16 offset:10304
    v_mfma_f32_16x16x32_bf16 v[156:159], v[124:127], v[84:87], v[156:159]
    ds_read_b64_tr_b16 v[106:107], v16 offset:11584
    s_waitcnt lgkmcnt(8)
    v_mfma_f32_16x16x32_bf16 v[160:163], v[128:131], a[228:231], v[160:163]
    ds_read_b64_tr_b16 v[108:109], v16 offset:10336
    buffer_load_dwordx4 v12, s[20:23], s91 offen lds
    s_add_u32 m0, m0, 1024
    v_mfma_f32_16x16x32_bf16 v[164:167], v[128:131], v[84:87], v[164:167]
    ds_read_b64_tr_b16 v[110:111], v16 offset:11616
    s_waitcnt lgkmcnt(8)
    v_mfma_f32_16x16x32_bf16 v[168:171], v[132:135], a[228:231], v[168:171]
    ds_read_b64_tr_b16 v[112:113], v16 offset:10368
    v_mfma_f32_16x16x32_bf16 v[172:175], v[132:135], v[84:87], v[172:175]
    ds_read_b64_tr_b16 v[114:115], v16 offset:11648
    s_waitcnt lgkmcnt(8)
    v_mfma_f32_16x16x32_bf16 v[136:139], v[96:99], a[232:235], v[136:139]
    ds_read_b64_tr_b16 v[116:117], v16 offset:15360
    v_mfma_f32_16x16x32_bf16 v[140:143], v[96:99], v[88:91], v[140:143]
    ds_read_b64_tr_b16 v[118:119], v16 offset:16640
    buffer_load_dwordx4 v13, s[20:23], s91 offen lds
    s_add_u32 m0, m0, 1024
    s_waitcnt lgkmcnt(8)
    v_mfma_f32_16x16x32_bf16 v[144:147], v[100:103], a[232:235], v[144:147]
    ds_read_b64_tr_b16 v[120:121], v16 offset:15392
    v_mfma_f32_16x16x32_bf16 v[148:151], v[100:103], v[88:91], v[148:151]
    ds_read_b64_tr_b16 v[122:123], v16 offset:16672
    s_waitcnt lgkmcnt(8)
    v_mfma_f32_16x16x32_bf16 v[152:155], v[104:107], a[232:235], v[152:155]
    ds_read_b64_tr_b16 v[124:125], v16 offset:15424
    v_mfma_f32_16x16x32_bf16 v[156:159], v[104:107], v[88:91], v[156:159]
    ds_read_b64_tr_b16 v[126:127], v16 offset:16704
    s_waitcnt lgkmcnt(8)
    v_mfma_f32_16x16x32_bf16 v[160:163], v[108:111], a[232:235], v[160:163]
    ds_read_b64_tr_b16 v[128:129], v16 offset:15456
    buffer_load_dwordx4 v14, s[20:23], s91 offen lds
    v_mfma_f32_16x16x32_bf16 v[164:167], v[108:111], v[88:91], v[164:167]
    ds_read_b64_tr_b16 v[130:131], v16 offset:16736
    s_waitcnt lgkmcnt(8)
    v_mfma_f32_16x16x32_bf16 v[168:171], v[112:115], a[232:235], v[168:171]
    ds_read_b64_tr_b16 v[132:133], v16 offset:15488
    v_mfma_f32_16x16x32_bf16 v[172:175], v[112:115], v[88:91], v[172:175]
    ds_read_b64_tr_b16 v[134:135], v16 offset:16768
    s_waitcnt lgkmcnt(8)
    v_mfma_f32_16x16x32_bf16 v[136:139], v[116:119], a[236:239], v[136:139]
    v_mfma_f32_16x16x32_bf16 v[140:143], v[116:119], v[92:95], v[140:143]
    s_waitcnt lgkmcnt(6)
    v_mfma_f32_16x16x32_bf16 v[144:147], v[120:123], a[236:239], v[144:147]
    v_mfma_f32_16x16x32_bf16 v[148:151], v[120:123], v[92:95], v[148:151]
    v_add_u32 v16, s46, v15
    s_waitcnt vmcnt(10) lgkmcnt(0)
    s_barrier
    v_mfma_f32_16x16x32_bf16 v[152:155], v[124:127], a[236:239], v[152:155]
    ds_read_b64_tr_b16 v[96:97], v16 offset:0
    ds_read_b64_tr_b16 v[98:99], v16 offset:1280
    v_mfma_f32_16x16x32_bf16 v[156:159], v[124:127], v[92:95], v[156:159]
    ds_read_b64_tr_b16 v[100:101], v16 offset:32
    ds_read_b64_tr_b16 v[102:103], v16 offset:1312
    v_mfma_f32_16x16x32_bf16 v[160:163], v[128:131], a[236:239], v[160:163]
    ds_read_b64_tr_b16 v[104:105], v16 offset:64
    ds_read_b64_tr_b16 v[106:107], v16 offset:1344
    v_mfma_f32_16x16x32_bf16 v[164:167], v[128:131], v[92:95], v[164:167]
    ds_read_b64_tr_b16 v[108:109], v16 offset:96
    ds_read_b64_tr_b16 v[110:111], v16 offset:1376
    v_mfma_f32_16x16x32_bf16 v[168:171], v[132:135], a[236:239], v[168:171]
    ds_read_b64_tr_b16 v[112:113], v16 offset:128
    ds_read_b64_tr_b16 v[114:115], v16 offset:1408
    v_mfma_f32_16x16x32_bf16 v[172:175], v[132:135], v[92:95], v[172:175]
    v_cvt_pk_bf16_f32 v176, v136, v137
    v_cvt_pk_bf16_f32 v177, v138, v139
    v_cvt_pk_bf16_f32 v178, v140, v141
    v_cvt_pk_bf16_f32 v179, v142, v143
    s_nop 0
    v_permlane16_swap_b32 v176, v178
    v_permlane16_swap_b32 v177, v179
    buffer_store_dwordx4 v[176:179], v19, s[28:31], s42 offen offset:0
    s_nop 1
    v_cvt_pk_bf16_f32 v176, v144, v145
    v_cvt_pk_bf16_f32 v177, v146, v147
    v_cvt_pk_bf16_f32 v178, v148, v149
    v_cvt_pk_bf16_f32 v179, v150, v151
    s_nop 0
    v_permlane16_swap_b32 v176, v178
    v_permlane16_swap_b32 v177, v179
    buffer_store_dwordx4 v[176:179], v19, s[28:31], s42 offen offset:32
    s_nop 1
    v_cvt_pk_bf16_f32 v176, v152, v153
    v_cvt_pk_bf16_f32 v177, v154, v155
    v_cvt_pk_bf16_f32 v178, v156, v157
    v_cvt_pk_bf16_f32 v179, v158, v159
    s_nop 0
    v_permlane16_swap_b32 v176, v178
    v_permlane16_swap_b32 v177, v179
    buffer_store_dwordx4 v[176:179], v19, s[28:31], s42 offen offset:64
    s_nop 1
    v_cvt_pk_bf16_f32 v176, v160, v161
    v_cvt_pk_bf16_f32 v177, v162, v163
    v_cvt_pk_bf16_f32 v178, v164, v165
    v_cvt_pk_bf16_f32 v179, v166, v167
    s_nop 0
    v_permlane16_swap_b32 v176, v178
    v_permlane16_swap_b32 v177, v179
    buffer_store_dwordx4 v[176:179], v19, s[28:31], s42 offen offset:96
    s_nop 1
    v_cvt_pk_bf16_f32 v176, v168, v169
    v_cvt_pk_bf16_f32 v177, v170, v171
    v_cvt_pk_bf16_f32 v178, v172, v173
    v_cvt_pk_bf16_f32 v179, v174, v175
    s_nop 0
    v_permlane16_swap_b32 v176, v178
    v_permlane16_swap_b32 v177, v179
    buffer_store_dwordx4 v[176:179], v19, s[28:31], s42 offen offset:128
    s_add_u32 s42, s42, 160
    s_cmp_eq_u32 s42, 1280
    s_cselect_b32 s42, 0, s42
    s_add_u32 s53, s53, 1
    s_cmp_lt_u32 s53, 8
    s_cbranch_scc1 L_pa_oblk
L_pa_end:
    s_waitcnt vmcnt(0)
    s_endpgm
L_slow:
    s_waitcnt vmcnt(0) lgkmcnt(0)
    s_barrier
    s_and_b32 s34, s2, 7
    s_lshr_b32 s35, s2, 3
    s_add_u32 s4, s88, 33554432
    s_addc_u32 s5, s89, 0
    s_and_b32 s5, s5, 0xffff
    s_lshl_b32 s38, s34, 21
    s_add_u32 s38, s38, 8388608
    s_cmp_lt_u32 s35, 28
    s_cbranch_scc1 L_noini_65
    v_mov_b32 v240, -1
    v_mov_b32 v241, -1
    v_mov_b32 v242, -1
    v_mov_b32 v243, -1
    v_mov_b32 v244, 0
    v_lshlrev_b32 v4, 4, v0
    v_lshlrev_b32 v5, 2, v0
    s_sub_u32 s93, s35, 28
    s_lshl_b32 s93, s93, 2
    s_add_u32 s93, s93, s32
    s_lshl_b32 s91, s34, 4
    s_add_u32 s91, s91, s93
    s_lshl_b32 s41, s91, 8
    s_add_u32 s41, s41, 1933312
    s_mul_i32 s91, s91, 5120
    s_lshl_b32 s40, s93, 8
    s_add_u32 s40, s40, s38
    s_add_u32 s40, s40, 458752
    s_lshr_b32 s92, s93, 3
    s_mul_i32 s92, s92, 114688
    s_add_u32 s92, s92, s38
    s_and_b32 s93, s93, 7
    s_mul_i32 s93, s93, 5120
    s_add_u32 s92, s92, s93
    buffer_store_dwordx4 v[240:243], v4, s[4:7], s91 offen offset:0 sc1
    buffer_store_dwordx4 v[240:243], v4, s[4:7], s91 offen offset:1024 sc1
    buffer_store_dwordx4 v[240:243], v4, s[4:7], s91 offen offset:2048 sc1
    buffer_store_dwordx4 v[240:243], v4, s[4:7], s91 offen offset:3072 sc1
    s_add_u32 s91, s91, 4096
    buffer_store_dwordx4 v[240:243], v4, s[4:7], s91 offen offset:0 sc1
    buffer_store_dwordx4 v[240:243], v4, s[4:7], s92 offen offset:0 sc1
    buffer_store_dwordx4 v[240:243], v4, s[4:7], s92 offen offset:1024 sc1
    buffer_store_dwordx4 v[240:243], v4, s[4:7], s92 offen offset:2048 sc1
    buffer_store_dwordx4 v[240:243], v4, s[4:7], s92 offen offset:3072 sc1
    s_add_u32 s92, s92, 4096
    buffer_store_dwordx4 v[240:243], v4, s[4:7], s92 offen offset:0 sc1
    buffer_store_dword v244, v5, s[4:7], s40 offen sc1
    buffer_store_dword v244, v5, s[4:7], s41 offen sc1
    s_waitcnt vmcnt(0)
    s_barrier
    s_cmp_lg_u32 s32, 0
    s_cbranch_scc1 L_ini_66
    v_mov_b32 v1, 68
    v_mov_b32 v2, 1
    s_mov_b64 exec, 1
    buffer_atomic_add v2, v1, s[8:11], 0 offen sc0 sc1
    s_waitcnt vmcnt(0)
    v_readfirstlane_b32 s90, v2
    s_mov_b64 exec, -1
    s_cmp_lg_u32 s90, 31
    s_cbranch_scc1 L_ini_66
    v_mov_b32 v1, 196
    v_mov_b32 v2, 1
    s_mov_b64 exec, 1
    buffer_store_dword v2, v1, s[8:11], 0 offen sc1
    s_mov_b64 exec, -1
L_ini_66:
    s_barrier
    s_cmp_eq_u32 s35, 28
    s_cbranch_scc1 L_px_s
L_noini_65:
    s_nop 0
    s_cmp_lt_u32 s35, 12
    s_cbranch_scc1 L_qkv_s
    s_cmp_lt_u32 s35, 18
    s_cbranch_scc1 L_v_s
    s_cmp_lt_u32 s35, 28
    s_cbranch_scc1 L_wo_s
    s_cmp_lt_u32 s35, 29
    s_cbranch_scc1 L_px_s
    s_branch L_pa_s
L_qkv_s:
    s_mov_b32 s12, s74
    s_and_b32 s13, s75, 0xffff
    s_mov_b32 s14, 7864320
    s_mov_b32 s15, 0x20000
    s_mov_b32 s16, s76
    s_and_b32 s17, s77, 0xffff
    s_mov_b32 s18, 7864320
    s_mov_b32 s19, 0x20000
    s_mov_b32 s40, s35
    s_mov_b32 s24, s70
    s_and_b32 s25, s71, 0xffff
    s_mov_b32 s26, 2621440
    s_mov_b32 s27, 0x20000
    v_and_b32 v1, 15, v0
    v_lshrrev_b32 v2, 4, v0
    v_lshrrev_b32 v3, 3, v0
    v_and_b32 v4, 7, v0
    s_lshl_b32 s90, s32, 3
    v_add_u32 v5, s90, v3
    s_and_b32 s91, s32, 1
    s_lshl_b32 s91, s91, 2
    v_and_b32 v6, 2, v3
    v_or_b32 v6, s91, v6
    v_xor_b32 v6, v6, v4
    v_lshlrev_b32 v6, 4, v6
    v_mul_u32_u24 v7, 12288, v5
    s_mul_i32 s92, s34, 1536
    s_lshl_b32 s93, s40, 7
    s_add_u32 s92, s92, s93
    v_add3_u32 v124, v6, v7, s92
    v_lshrrev_b32 v6, 1, v3
    v_or_b32 v6, s91, v6
    v_xor_b32 v6, v6, v4
    v_lshlrev_b32 v6, 4, v6
    v_mul_u32_u24 v7, 1280, v5
    v_add_u32 v10, v6, v7
    s_lshl_b32 s90, s32, 10
    s_add_u32 m0, s90, 81920
    s_mov_b32 s91, 0
    buffer_load_dwordx4 v124, s[16:19], s91 offen nt lds
    s_add_u32 m0, m0, 4096
    s_add_u32 s91, s91, 393216
    buffer_load_dwordx4 v124, s[16:19], s91 offen nt lds
    s_add_u32 m0, m0, 4096
    s_add_u32 s91, s91, 393216
    buffer_load_dwordx4 v124, s[16:19], s91 offen nt lds
    s_add_u32 m0, m0, 4096
    s_add_u32 s91, s91, 393216
    buffer_load_dwordx4 v124, s[16:19], s91 offen nt lds
    s_add_u32 m0, m0, 4096
    s_add_u32 s91, s91, 393216
    buffer_load_dwordx4 v124, s[16:19], s91 offen nt lds
    s_add_u32 m0, m0, 4096
    s_add_u32 s91, s91, 393216
    buffer_load_dwordx4 v124, s[16:19], s91 offen nt lds
    s_add_u32 m0, m0, 4096
    s_add_u32 s91, s91, 393216
    buffer_load_dwordx4 v124, s[16:19], s91 offen nt lds
    s_add_u32 m0, m0, 4096
    s_add_u32 s91, s91, 393216
    buffer_load_dwordx4 v124, s[16:19], s91 offen nt lds
    s_add_u32 m0, m0, 4096
    s_add_u32 s91, s91, 393216
    buffer_load_dwordx4 v124, s[16:19], s91 offen nt lds
    s_add_u32 m0, m0, 4096
    s_add_u32 s91, s91, 393216
    buffer_load_dwordx4 v124, s[16:19], s91 offen nt lds
    s_mul_i32 s60, s40, 86
    s_lshr_b32 s60, s60, 8
    s_mul_i32 s61, s60, 3
    s_sub_u32 s61, s40, s61
    s_add_u32 s90, s40, 1
    s_mul_i32 s62, s90, 86
    s_lshr_b32 s62, s62, 8
    s_mul_i32 s63, s62, 3
    s_sub_u32 s63, s90, s63
    v_lshrrev_b32 v3, 1, v2
    v_and_b32 v5, 1, v2
    s_lshl_b32 s90, s32, 9
    v_lshlrev_b32 v6, 4, v1
    v_lshl_add_u32 v6, v3, 8, v6
    v_add_u32 v6, s90, v6
    s_mul_i32 s90, s60, 12288
    s_lshl_b32 s91, s61, 11
    s_add_u32 s90, s90, s91
    v_mul_u32_u24 v7, 6144, v5
    v_add3_u32 v19, v6, v7, s90
    v_mov_b32 v22, -1
    s_mov_b32 s56, 49152
    v_lshl_add_u32 v137, v5, 11, v6
    v_add_u32 v137, 135168, v137
    s_mul_i32 s90, s40, 1280
    s_add_u32 s90, s90, 10240
    v_lshlrev_b32 v6, 1, v5
    v_or_b32 v7, v6, v3
    v_lshl_add_u32 v7, v7, 4, v1
    v_lshlrev_b32 v7, 2, v7
    v_add_u32 v7, 1024, v7
    v_or_b32 v6, v6, v1
    v_lshl_add_u32 v6, v3, 4, v6
    v_lshlrev_b32 v6, 4, v6
    s_sub_u32 s91, s32, 1
    s_lshl_b32 s91, s91, 9
    v_add_u32 v6, s91, v6
    s_cmp_eq_u32 s32, 0
    s_cselect_b64 vcc, -1, 0
    v_cndmask_b32 v6, v6, v7, vcc
    v_add_u32 v135, s90, v6
    s_lshl_b32 s91, s32, 8
    s_add_u32 s91, s91, s90
    v_lshl_add_u32 v150, v0, 2, s91
    v_and_b32 v4, 2, v1
    v_cmp_eq_u32 vcc, 0, v4
    v_mov_b32 v9, 2146435072
    s_nop 0
    v_cndmask_b32 v135, v9, v135, vcc
    s_lshl_b32 s90, s40, 10
    v_lshrrev_b32 v3, 2, v1
    v_lshlrev_b32 v3, 1, v3
    v_and_b32 v6, 1, v1
    v_or_b32 v3, v3, v6
    v_lshl_add_u32 v3, v2, 3, v3
    v_lshl_add_u32 v136, v3, 4, s90
    v_cmp_ne_u32 vcc, 0, v4
    v_mov_b32 v9, 2146435072
    s_nop 0
    v_cndmask_b32 v136, v9, v136, vcc
    v_and_b32 v6, 9, v1
    v_lshl_or_b32 v6, v4, 1, v6
    v_and_b32 v7, 4, v1
    v_lshrrev_b32 v7, 1, v7
    v_or_b32 v6, v6, v7
    v_lshlrev_b32 v6, 4, v6
    v_lshl_add_u32 v6, v2, 8, v6
    s_cmp_eq_u32 s32, 2
    s_cselect_b32 s90, 2048, 0
    s_add_u32 s90, s90, 135168
    v_add_u32 v138, s90, v6
    s_lshl_b32 s90, s60, 7
    s_lshl_b32 s91, s61, 2
    s_add_u32 s91, s91, s90
    s_add_u32 s91, s91, 459264
    s_cmp_eq_u32 s32, 3
    s_cselect_b32 s91, s91, 2146435072
    s_cselect_b32 s55, -1, 0
    v_mov_b32 v139, s91
    v_cmp_eq_u32 vcc, 0, v0
    v_mov_b32 v9, 2146435072
    s_nop 0
    v_cndmask_b32 v139, v9, v139, vcc
    v_add_u32 v21, 3072, v139
    s_mul_i32 s90, s35, 32768
    s_lshl_b32 s91, s32, 11
    s_add_u32 s90, s90, s91
    s_lshl_b32 s92, s35, 10
    s_lshl_b32 s91, s32, 8
    s_add_u32 s92, s92, s91
    s_cmp_lt_u32 s35, 10
    s_cselect_b32 s90, s90, 2146435072
    s_cselect_b32 s92, s92, 2146435072
    s_lshl_b32 s91, s34, 8
    v_lshlrev_b32 v3, 4, v0
    v_xor_b32 v3, s91, v3
    v_add_u32 v142, s90, v3
    v_xor_b32 v3, 1024, v3
    v_add_u32 v143, s90, v3
    s_min_u32 s90, s35, 9
    s_lshl_b32 s90, s90, 7
    s_add_u32 s90, s90, 460800
    s_add_u32 s90, s90, s38
    v_and_b32 v3, 3, v0
    v_lshl_add_u32 v146, v3, 2, s90
    v_lshl_add_u32 v149, v0, 2, s92
    v_lshl_add_u32 v148, v1, 4, s92
    v_cmp_eq_u32 vcc, 0, v2
    v_mov_b32 v9, 2146435072
    s_nop 0
    v_cndmask_b32 v148, v9, v148, vcc
    v_and_b32 v7, 1, v1
    v_cmp_ne_u32 vcc, 0, v7
    v_mov_b32 v5, 0x3f80
    v_mov_b32 v6, 0x3f800000
    v_cndmask_b32 v5, v5, v6, vcc
    v_bfe_u32 v6, v1, 1, 1
    v_cmp_eq_u32 vcc, 0, v6
    s_nop 1
    v_cndmask_b32 v198, 0, v5, vcc
    v_mov_b32 v196, 0
    v_mov_b32 v200, 0
    v_cmp_eq_u32 vcc, 1, v6
    s_nop 1
    v_cndmask_b32 v199, 0, v5, vcc
    v_mov_b32 v197, 0
    v_mov_b32 v201, 0
    v_lshrrev_b32 v3, 2, v1
    v_and_b32 v4, 3, v1
    v_and_b32 v5, 1, v2
    v_lshl_add_u32 v6, v2, 3, v3
    v_lshlrev_b32 v6, 7, v6
    v_and_b32 v7, 2, v3
    v_lshl_or_b32 v7, v5, 2, v7
    v_lshrrev_b32 v8, 1, v4
    s_lshl_b32 s90, s32, 1
    v_or_b32 v8, s90, v8
    v_xor_b32 v7, v7, v8
    v_lshl_add_u32 v6, v7, 4, v6
    v_and_b32 v7, 1, v4
    v_lshl_add_u32 v6, v7, 3, v6
    v_add_u32 v125, 81920, v6
    v_add_u32 v126, 40960, v6
    v_add_u32 v127, 122880, v6
    s_lshl_b32 s90, s32, 9
    s_add_u32 s90, s90, 133120
    v_xor_b32 v6, 0, v5
    v_lshl_add_u32 v6, v6, 2, v3
    v_lshl_add_u32 v6, v2, 3, v6
    v_lshlrev_b32 v6, 5, v6
    v_lshl_or_b32 v7, v5, 1, 0
    v_xor_b32 v7, v7, v4
    v_lshl_add_u32 v6, v7, 3, v6
    v_add_u32 v24, 133120, v6
    v_xor_b32 v6, 1, v5
    v_lshl_add_u32 v6, v6, 2, v3
    v_lshl_add_u32 v6, v2, 3, v6
    v_lshlrev_b32 v6, 5, v6
    v_lshl_or_b32 v7, v5, 1, 1
    v_xor_b32 v7, v7, v4
    v_lshl_add_u32 v6, v7, 3, v6
    v_add_u32 v134, 133120, v6
    v_lshrrev_b32 v6, 3, v1
    v_lshlrev_b32 v6, 2, v6
    v_xor_b32 v6, v6, v1
    v_lshlrev_b32 v6, 5, v6
    v_xor_b32 v7, v2, v3
    v_lshl_add_u32 v6, v7, 3, v6
    v_add_u32 v23, s90, v6
    v_and_b32 v7, 2, v1
    v_cmp_ne_u32 vcc, 0, v7
    v_mov_b32 v6, 0x4444
    v_mov_b32 v8, 0xeeee
    v_cndmask_b32 v17, v6, v8, vcc
    v_lshlrev_b32 v6, 4, v0
    v_add_u32 v16, 122880, v6
    s_mul_i32 s90, s32, 2560
    v_lshl_add_u32 v13, v0, 4, s90
    v_lshl_add_u32 v14, v0, 2, s90
    s_add_u32 s48, s90, 122880
    v_mul_u32_u24 v6, 40, v0
    v_add_u32 v15, s48, v6
    v_mul_u32_u24 v6, 164, v0
    v_min_u32 v6, 10236, v6
    v_add_u32 v25, 122880, v6
    v_lshrrev_b32 v6, 3, v1
    v_lshlrev_b32 v6, 10, v6
    v_and_b32 v7, 7, v1
    v_lshl_add_u32 v6, v7, 7, v6
    v_lshrrev_b32 v7, 1, v1
    v_xor_b32 v7, v7, v2
    v_lshl_add_u32 v11, v7, 4, v6
    v_xor_b32 v12, 64, v11
    s_and_b32 s91, s34, 1
    s_lshl_b32 s91, s91, 12
    s_lshr_b32 s92, s34, 2
    s_lshl_b32 s92, s92, 13
    s_add_u32 s91, s91, s92
    s_and_b32 s92, s34, 2
    s_lshl_b32 s92, s92, 13
    s_add_u32 s91, s91, s92
    s_add_u32 s91, s91, 1933312
    v_lshrrev_b32 v4, 2, v0
    v_lshl_add_u32 v3, v4, 9, s91
    v_cmp_ne_u32 s[92:93], s34, v4
    v_cmp_gt_u32 vcc, 32, v0
    s_nop 0
    s_and_b64 vcc, vcc, s[92:93]
    s_and_b32 vcc_lo, vcc_lo, s55
    v_cndmask_b32 v146, v146, v3, vcc
    v_cndmask_b32 v152, 0, -1, vcc
    s_lshl_b32 s90, s32, 10
    s_add_u32 m0, s90, 40960
    s_mov_b32 s91, 0
    buffer_load_dwordx4 v124, s[12:15], s91 offen nt lds
    s_add_u32 m0, m0, 4096
    s_add_u32 s91, s91, 393216
    buffer_load_dwordx4 v124, s[12:15], s91 offen nt lds
    s_add_u32 m0, m0, 4096
    s_add_u32 s91, s91, 393216
    buffer_load_dwordx4 v124, s[12:15], s91 offen nt lds
    s_add_u32 m0, m0, 4096
    s_add_u32 s91, s91, 393216
    buffer_load_dwordx4 v124, s[12:15], s91 offen nt lds
    s_add_u32 m0, m0, 4096
    s_add_u32 s91, s91, 393216
    buffer_load_dwordx4 v124, s[12:15], s91 offen nt lds
    s_add_u32 m0, m0, 4096
    s_add_u32 s91, s91, 393216
    buffer_load_dwordx4 v124, s[12:15], s91 offen nt lds
    s_add_u32 m0, m0, 4096
    s_add_u32 s91, s91, 393216
    buffer_load_dwordx4 v124, s[12:15], s91 offen nt lds
    s_add_u32 m0, m0, 4096
    s_add_u32 s91, s91, 393216
    buffer_load_dwordx4 v124, s[12:15], s91 offen nt lds
    s_add_u32 m0, m0, 4096
    s_add_u32 s91, s91, 393216
    buffer_load_dwordx4 v124, s[12:15], s91 offen nt lds
    s_add_u32 m0, m0, 4096
    s_add_u32 s91, s91, 393216
    buffer_load_dwordx4 v124, s[12:15], s91 offen nt lds
    s_lshl_b32 s90, s32, 10
    s_add_u32 m0, s90, 122880
    s_mov_b32 s91, 3932160
    buffer_load_dwordx4 v124, s[16:19], s91 offen nt lds
    s_add_u32 m0, m0, 4096
    s_add_u32 s91, s91, 393216
    buffer_load_dwordx4 v124, s[16:19], s91 offen nt lds
    s_add_u32 m0, m0, 4096
    s_add_u32 s91, s91, 393216
    buffer_load_dwordx4 v124, s[16:19], s91 offen nt lds
    s_add_u32 m0, m0, 4096
    s_add_u32 s91, s91, 393216
    buffer_load_dwordx4 v124, s[16:19], s91 offen nt lds
    s_add_u32 m0, m0, 4096
    s_add_u32 s91, s91, 393216
    buffer_load_dwordx4 v124, s[16:19], s91 offen nt lds
    s_add_u32 m0, m0, 4096
    s_add_u32 s91, s91, 393216
    buffer_load_dwordx4 v124, s[16:19], s91 offen nt lds
    s_add_u32 m0, m0, 4096
    s_add_u32 s91, s91, 393216
    buffer_load_dwordx4 v124, s[16:19], s91 offen nt lds
    s_add_u32 m0, m0, 4096
    s_add_u32 s91, s91, 393216
    buffer_load_dwordx4 v124, s[16:19], s91 offen nt lds
    s_add_u32 m0, m0, 4096
    s_add_u32 s91, s91, 393216
    buffer_load_dwordx4 v124, s[16:19], s91 offen nt lds
    s_add_u32 m0, m0, 4096
    s_add_u32 s91, s91, 393216
    buffer_load_dwordx4 v124, s[16:19], s91 offen nt lds
    s_mov_b32 s46, 0
    s_lshl_b32 s90, s32, 10
    s_add_u32 m0, s90, 0
    s_nop 0
    buffer_load_dwordx4 v10, s[24:27], s46 offen offset:0 lds
    s_add_u32 m0, m0, 3968
    s_nop 0
    buffer_load_dwordx4 v10, s[24:27], s46 offen offset:128 lds
    s_add_u32 m0, m0, 3968
    s_nop 0
    buffer_load_dwordx4 v10, s[24:27], s46 offen offset:256 lds
    s_add_u32 m0, m0, 3968
    s_nop 0
    buffer_load_dwordx4 v10, s[24:27], s46 offen offset:384 lds
    s_add_u32 m0, m0, 3968
    s_nop 0
    buffer_load_dwordx4 v10, s[24:27], s46 offen offset:512 lds
    s_add_u32 m0, m0, 3968
    s_nop 0
    buffer_load_dwordx4 v10, s[24:27], s46 offen offset:640 lds
    s_add_u32 m0, m0, 3968
    s_nop 0
    buffer_load_dwordx4 v10, s[24:27], s46 offen offset:768 lds
    s_add_u32 m0, m0, 3968
    s_nop 0
    buffer_load_dwordx4 v10, s[24:27], s46 offen offset:896 lds
    s_add_u32 m0, m0, 3968
    s_nop 0
    buffer_load_dwordx4 v10, s[24:27], s46 offen offset:1024 lds
    s_add_u32 m0, m0, 3968
    s_nop 0
    buffer_load_dwordx4 v10, s[24:27], s46 offen offset:1152 lds
    s_waitcnt vmcnt(30)
    s_barrier
    ds_read_b64_tr_b16 a[80:81], v125 offset:0
    ds_read_b64_tr_b16 a[82:83], v125 offset:512
    ds_read_b64_tr_b16 a[84:85], v125 offset:4096
    ds_read_b64_tr_b16 a[86:87], v125 offset:4608
    ds_read_b64_tr_b16 a[88:89], v125 offset:8192
    ds_read_b64_tr_b16 a[90:91], v125 offset:8704
    ds_read_b64_tr_b16 a[92:93], v125 offset:12288
    ds_read_b64_tr_b16 a[94:95], v125 offset:12800
    ds_read_b64_tr_b16 a[96:97], v125 offset:16384
    ds_read_b64_tr_b16 a[98:99], v125 offset:16896
    ds_read_b64_tr_b16 a[100:101], v125 offset:20480
    ds_read_b64_tr_b16 a[102:103], v125 offset:20992
    ds_read_b64_tr_b16 a[104:105], v125 offset:24576
    ds_read_b64_tr_b16 a[106:107], v125 offset:25088
    ds_read_b64_tr_b16 a[108:109], v125 offset:28672
    ds_read_b64_tr_b16 a[110:111], v125 offset:29184
    ds_read_b64_tr_b16 a[112:113], v125 offset:32768
    ds_read_b64_tr_b16 a[114:115], v125 offset:33280
    ds_read_b64_tr_b16 a[116:117], v125 offset:36864
    ds_read_b64_tr_b16 a[118:119], v125 offset:37376
    s_waitcnt lgkmcnt(0)
    s_barrier
    s_lshl_b32 s90, s32, 10
    s_add_u32 m0, s90, 81920
    s_mov_b32 s91, 3932160
    buffer_load_dwordx4 v124, s[12:15], s91 offen nt lds
    s_add_u32 m0, m0, 4096
    s_add_u32 s91, s91, 393216
    buffer_load_dwordx4 v124, s[12:15], s91 offen nt lds
    s_add_u32 m0, m0, 4096
    s_add_u32 s91, s91, 393216
    buffer_load_dwordx4 v124, s[12:15], s91 offen nt lds
    s_add_u32 m0, m0, 4096
    s_add_u32 s91, s91, 393216
    buffer_load_dwordx4 v124, s[12:15], s91 offen nt lds
    s_add_u32 m0, m0, 4096
    s_add_u32 s91, s91, 393216
    buffer_load_dwordx4 v124, s[12:15], s91 offen nt lds
    s_add_u32 m0, m0, 4096
    s_add_u32 s91, s91, 393216
    buffer_load_dwordx4 v124, s[12:15], s91 offen nt lds
    s_add_u32 m0, m0, 4096
    s_add_u32 s91, s91, 393216
    buffer_load_dwordx4 v124, s[12:15], s91 offen nt lds
    s_add_u32 m0, m0, 4096
    s_add_u32 s91, s91, 393216
    buffer_load_dwordx4 v124, s[12:15], s91 offen nt lds
    s_add_u32 m0, m0, 4096
    s_add_u32 s91, s91, 393216
    buffer_load_dwordx4 v124, s[12:15], s91 offen nt lds
    s_add_u32 m0, m0, 4096
    s_add_u32 s91, s91, 393216
    buffer_load_dwordx4 v124, s[12:15], s91 offen nt lds
    s_waitcnt vmcnt(30)
    s_barrier
    ds_read_b64_tr_b16 a[0:1], v126 offset:0
    ds_read_b64_tr_b16 a[2:3], v126 offset:512
    ds_read_b64_tr_b16 a[4:5], v126 offset:4096
    ds_read_b64_tr_b16 a[6:7], v126 offset:4608
    ds_read_b64_tr_b16 a[8:9], v126 offset:8192
    ds_read_b64_tr_b16 a[10:11], v126 offset:8704
    ds_read_b64_tr_b16 a[12:13], v126 offset:12288
    ds_read_b64_tr_b16 a[14:15], v126 offset:12800
    ds_read_b64_tr_b16 a[16:17], v126 offset:16384
    ds_read_b64_tr_b16 a[18:19], v126 offset:16896
    ds_read_b64_tr_b16 a[20:21], v126 offset:20480
    ds_read_b64_tr_b16 a[22:23], v126 offset:20992
    ds_read_b64_tr_b16 a[24:25], v126 offset:24576
    ds_read_b64_tr_b16 a[26:27], v126 offset:25088
    ds_read_b64_tr_b16 a[28:29], v126 offset:28672
    ds_read_b64_tr_b16 a[30:31], v126 offset:29184
    ds_read_b64_tr_b16 a[32:33], v126 offset:32768
    ds_read_b64_tr_b16 a[34:35], v126 offset:33280
    ds_read_b64_tr_b16 a[36:37], v126 offset:36864
    ds_read_b64_tr_b16 a[38:39], v126 offset:37376
    s_waitcnt lgkmcnt(0)
    s_barrier
    s_mov_b32 s46, 40960
    s_lshl_b32 s90, s32, 10
    s_add_u32 m0, s90, 40960
    s_nop 0
    buffer_load_dwordx4 v10, s[24:27], s46 offen offset:0 lds
    s_add_u32 m0, m0, 3968
    s_nop 0
    buffer_load_dwordx4 v10, s[24:27], s46 offen offset:128 lds
    s_add_u32 m0, m0, 3968
    s_nop 0
    buffer_load_dwordx4 v10, s[24:27], s46 offen offset:256 lds
    s_add_u32 m0, m0, 3968
    s_nop 0
    buffer_load_dwordx4 v10, s[24:27], s46 offen offset:384 lds
    s_add_u32 m0, m0, 3968
    s_nop 0
    buffer_load_dwordx4 v10, s[24:27], s46 offen offset:512 lds
    s_add_u32 m0, m0, 3968
    s_nop 0
    buffer_load_dwordx4 v10, s[24:27], s46 offen offset:640 lds
    s_add_u32 m0, m0, 3968
    s_nop 0
    buffer_load_dwordx4 v10, s[24:27], s46 offen offset:768 lds
    s_add_u32 m0, m0, 3968
    s_nop 0
    buffer_load_dwordx4 v10, s[24:27], s46 offen offset:896 lds
    s_add_u32 m0, m0, 3968
    s_nop 0
    buffer_load_dwordx4 v10, s[24:27], s46 offen offset:1024 lds
    s_add_u32 m0, m0, 3968
    s_nop 0
    buffer_load_dwordx4 v10, s[24:27], s46 offen offset:1152 lds
    s_waitcnt vmcnt(30)
    s_barrier
    ds_read_b64_tr_b16 a[120:121], v127 offset:0
    ds_read_b64_tr_b16 a[122:123], v127 offset:512
    ds_read_b64_tr_b16 a[124:125], v127 offset:4096
    ds_read_b64_tr_b16 a[126:127], v127 offset:4608
    ds_read_b64_tr_b16 a[128:129], v127 offset:8192
    ds_read_b64_tr_b16 a[130:131], v127 offset:8704
    ds_read_b64_tr_b16 a[132:133], v127 offset:12288
    ds_read_b64_tr_b16 a[134:135], v127 offset:12800
    ds_read_b64_tr_b16 a[136:137], v127 offset:16384
    ds_read_b64_tr_b16 a[138:139], v127 offset:16896
    ds_read_b64_tr_b16 a[140:141], v127 offset:20480
    ds_read_b64_tr_b16 a[142:143], v127 offset:20992
    ds_read_b64_tr_b16 a[144:145], v127 offset:24576
    ds_read_b64_tr_b16 a[146:147], v127 offset:25088
    ds_read_b64_tr_b16 a[148:149], v127 offset:28672
    ds_read_b64_tr_b16 a[150:151], v127 offset:29184
    ds_read_b64_tr_b16 a[152:153], v127 offset:32768
    ds_read_b64_tr_b16 a[154:155], v127 offset:33280
    ds_read_b64_tr_b16 a[156:157], v127 offset:36864
    ds_read_b64_tr_b16 a[158:159], v127 offset:37376
    s_waitcnt lgkmcnt(0)
    s_waitcnt vmcnt(10)
    s_barrier
    ds_read_b64_tr_b16 a[40:41], v125 offset:0
    ds_read_b64_tr_b16 a[42:43], v125 offset:512
    ds_read_b64_tr_b16 a[44:45], v125 offset:4096
    ds_read_b64_tr_b16 a[46:47], v125 offset:4608
    ds_read_b64_tr_b16 a[48:49], v125 offset:8192
    ds_read_b64_tr_b16 a[50:51], v125 offset:8704
    ds_read_b64_tr_b16 a[52:53], v125 offset:12288
    ds_read_b64_tr_b16 a[54:55], v125 offset:12800
    ds_read_b64_tr_b16 a[56:57], v125 offset:16384
    ds_read_b64_tr_b16 a[58:59], v125 offset:16896
    ds_read_b64_tr_b16 a[60:61], v125 offset:20480
    ds_read_b64_tr_b16 a[62:63], v125 offset:20992
    ds_read_b64_tr_b16 a[64:65], v125 offset:24576
    ds_read_b64_tr_b16 a[66:67], v125 offset:25088
    ds_read_b64_tr_b16 a[68:69], v125 offset:28672
    ds_read_b64_tr_b16 a[70:71], v125 offset:29184
    ds_read_b64_tr_b16 a[72:73], v125 offset:32768
    ds_read_b64_tr_b16 a[74:75], v125 offset:33280
    ds_read_b64_tr_b16 a[76:77], v125 offset:36864
    ds_read_b64_tr_b16 a[78:79], v125 offset:37376
    s_waitcnt lgkmcnt(0)
    s_mov_b32 s49, 40960
    s_mov_b32 s47, 40960
    s_mov_b32 s37, -1
    s_add_u32 s44, s38, 475136
    s_add_u32 s45, s44, s56
    s_mov_b32 s46, 40960
    v_add_u32 v140, 0, v137
    v_mov_b32 v1, 196
    buffer_load_dword v2, v1, s[8:11], 0 offen sc1
    ds_read_b128 v[84:87], v11 offset:0
    ds_read_b128 v[88:91], v11 offset:2048
    ds_read_b128 v[92:95], v12 offset:0
    ds_read_b128 v[96:99], v12 offset:2048
    s_waitcnt lgkmcnt(2)
    v_mfma_f32_16x16x32_bf16 v[108:111], a[0:3], v[84:87], 0
    ds_read_b128 v[100:103], v11 offset:4096
    v_mfma_f32_16x16x32_bf16 v[112:115], a[0:3], v[88:91], 0
    ds_read_b128 v[104:107], v11 offset:6144
    v_mfma_f32_16x16x32_bf16 v[116:119], a[80:83], v[84:87], 0
    v_mfma_f32_16x16x32_bf16 v[120:123], a[80:83], v[88:91], 0
    s_waitcnt lgkmcnt(2)
    v_mfma_f32_16x16x32_bf16 v[108:111], a[4:7], v[92:95], v[108:111]
    ds_read_b128 v[84:87], v12 offset:4096
    v_mfma_f32_16x16x32_bf16 v[112:115], a[4:7], v[96:99], v[112:115]
    ds_read_b128 v[88:91], v12 offset:6144
    v_mfma_f32_16x16x32_bf16 v[116:119], a[84:87], v[92:95], v[116:119]
    v_mfma_f32_16x16x32_bf16 v[120:123], a[84:87], v[96:99], v[120:123]
    s_waitcnt lgkmcnt(2)
    v_mfma_f32_16x16x32_bf16 v[108:111], a[8:11], v[100:103], v[108:111]
    ds_read_b128 v[92:95], v11 offset:8192
    v_mfma_f32_16x16x32_bf16 v[112:115], a[8:11], v[104:107], v[112:115]
    ds_read_b128 v[96:99], v11 offset:10240
    v_mfma_f32_16x16x32_bf16 v[116:119], a[88:91], v[100:103], v[116:119]
    v_mfma_f32_16x16x32_bf16 v[120:123], a[88:91], v[104:107], v[120:123]
    s_waitcnt lgkmcnt(2)
    v_mfma_f32_16x16x32_bf16 v[108:111], a[12:15], v[84:87], v[108:111]
    ds_read_b128 v[100:103], v12 offset:8192
    v_mfma_f32_16x16x32_bf16 v[112:115], a[12:15], v[88:91], v[112:115]
    ds_read_b128 v[104:107], v12 offset:10240
    v_mfma_f32_16x16x32_bf16 v[116:119], a[92:95], v[84:87], v[116:119]
    v_mfma_f32_16x16x32_bf16 v[120:123], a[92:95], v[88:91], v[120:123]
    s_waitcnt lgkmcnt(2)
    v_mfma_f32_16x16x32_bf16 v[108:111], a[16:19], v[92:95], v[108:111]
    ds_read_b128 v[84:87], v11 offset:12288
    v_mfma_f32_16x16x32_bf16 v[112:115], a[16:19], v[96:99], v[112:115]
    ds_read_b128 v[88:91], v11 offset:14336
    v_mfma_f32_16x16x32_bf16 v[116:119], a[96:99], v[92:95], v[116:119]
    v_mfma_f32_16x16x32_bf16 v[120:123], a[96:99], v[96:99], v[120:123]
    s_waitcnt lgkmcnt(2)
    v_mfma_f32_16x16x32_bf16 v[108:111], a[20:23], v[100:103], v[108:111]
    ds_read_b128 v[92:95], v12 offset:12288
    v_mfma_f32_16x16x32_bf16 v[112:115], a[20:23], v[104:107], v[112:115]
    ds_read_b128 v[96:99], v12 offset:14336
    v_mfma_f32_16x16x32_bf16 v[116:119], a[100:103], v[100:103], v[116:119]
    v_mfma_f32_16x16x32_bf16 v[120:123], a[100:103], v[104:107], v[120:123]
    s_waitcnt lgkmcnt(2)
    v_mfma_f32_16x16x32_bf16 v[108:111], a[24:27], v[84:87], v[108:111]
    ds_read_b128 v[100:103], v11 offset:16384
    v_mfma_f32_16x16x32_bf16 v[112:115], a[24:27], v[88:91], v[112:115]
    ds_read_b128 v[104:107], v11 offset:18432
    v_mfma_f32_16x16x32_bf16 v[116:119], a[104:107], v[84:87], v[116:119]
    v_mfma_f32_16x16x32_bf16 v[120:123], a[104:107], v[88:91], v[120:123]
    s_waitcnt lgkmcnt(2)
    v_mfma_f32_16x16x32_bf16 v[108:111], a[28:31], v[92:95], v[108:111]
    ds_read_b128 v[84:87], v12 offset:16384
    v_mfma_f32_16x16x32_bf16 v[112:115], a[28:31], v[96:99], v[112:115]
    ds_read_b128 v[88:91], v12 offset:18432
    v_mfma_f32_16x16x32_bf16 v[116:119], a[108:111], v[92:95], v[116:119]
    v_mfma_f32_16x16x32_bf16 v[120:123], a[108:111], v[96:99], v[120:123]
    s_waitcnt lgkmcnt(2)
    v_mfma_f32_16x16x32_bf16 v[108:111], a[32:35], v[100:103], v[108:111]
    ds_read_b128 v[92:95], v11 offset:20480
    v_mfma_f32_16x16x32_bf16 v[112:115], a[32:35], v[104:107], v[112:115]
    ds_read_b128 v[96:99], v11 offset:22528
    v_mfma_f32_16x16x32_bf16 v[116:119], a[112:115], v[100:103], v[116:119]
    v_mfma_f32_16x16x32_bf16 v[120:123], a[112:115], v[104:107], v[120:123]
    s_waitcnt lgkmcnt(2)
    v_mfma_f32_16x16x32_bf16 v[108:111], a[36:39], v[84:87], v[108:111]
    ds_read_b128 v[100:103], v12 offset:20480
    v_mfma_f32_16x16x32_bf16 v[112:115], a[36:39], v[88:91], v[112:115]
    ds_read_b128 v[104:107], v12 offset:22528
    v_mfma_f32_16x16x32_bf16 v[116:119], a[116:119], v[84:87], v[116:119]
    v_mfma_f32_16x16x32_bf16 v[120:123], a[116:119], v[88:91], v[120:123]
    s_waitcnt lgkmcnt(2)
    v_mfma_f32_16x16x32_bf16 v[108:111], a[40:43], v[92:95], v[108:111]
    ds_read_b128 v[84:87], v11 offset:24576
    v_mfma_f32_16x16x32_bf16 v[112:115], a[40:43], v[96:99], v[112:115]
    ds_read_b128 v[88:91], v11 offset:26624
    v_mfma_f32_16x16x32_bf16 v[116:119], a[120:123], v[92:95], v[116:119]
    v_mfma_f32_16x16x32_bf16 v[120:123], a[120:123], v[96:99], v[120:123]
    s_waitcnt lgkmcnt(2)
    v_mfma_f32_16x16x32_bf16 v[108:111], a[44:47], v[100:103], v[108:111]
    ds_read_b128 v[92:95], v12 offset:24576
    v_mfma_f32_16x16x32_bf16 v[112:115], a[44:47], v[104:107], v[112:115]
    ds_read_b128 v[96:99], v12 offset:26624
    v_mfma_f32_16x16x32_bf16 v[116:119], a[124:127], v[100:103], v[116:119]
    v_mfma_f32_16x16x32_bf16 v[120:123], a[124:127], v[104:107], v[120:123]
    s_waitcnt lgkmcnt(2)
    v_mfma_f32_16x16x32_bf16 v[108:111], a[48:51], v[84:87], v[108:111]
    ds_read_b128 v[100:103], v11 offset:28672
    v_mfma_f32_16x16x32_bf16 v[112:115], a[48:51], v[88:91], v[112:115]
    ds_read_b128 v[104:107], v11 offset:30720
    v_mfma_f32_16x16x32_bf16 v[116:119], a[128:131], v[84:87], v[116:119]
    v_mfma_f32_16x16x32_bf16 v[120:123], a[128:131], v[88:91], v[120:123]
    s_waitcnt lgkmcnt(2)
    v_mfma_f32_16x16x32_bf16 v[108:111], a[52:55], v[92:95], v[108:111]
    ds_read_b128 v[84:87], v12 offset:28672
    v_mfma_f32_16x16x32_bf16 v[112:115], a[52:55], v[96:99], v[112:115]
    ds_read_b128 v[88:91], v12 offset:30720
    v_mfma_f32_16x16x32_bf16 v[116:119], a[132:135], v[92:95], v[116:119]
    v_mfma_f32_16x16x32_bf16 v[120:123], a[132:135], v[96:99], v[120:123]
    s_waitcnt lgkmcnt(2)
    v_mfma_f32_16x16x32_bf16 v[108:111], a[56:59], v[100:103], v[108:111]
    ds_read_b128 v[92:95], v11 offset:32768
    v_mfma_f32_16x16x32_bf16 v[112:115], a[56:59], v[104:107], v[112:115]
    ds_read_b128 v[96:99], v11 offset:34816
    v_mfma_f32_16x16x32_bf16 v[116:119], a[136:139], v[100:103], v[116:119]
    v_mfma_f32_16x16x32_bf16 v[120:123], a[136:139], v[104:107], v[120:123]
    s_waitcnt lgkmcnt(2)
    v_mfma_f32_16x16x32_bf16 v[108:111], a[60:63], v[84:87], v[108:111]
    ds_read_b128 v[100:103], v12 offset:32768
    v_mfma_f32_16x16x32_bf16 v[112:115], a[60:63], v[88:91], v[112:115]
    ds_read_b128 v[104:107], v12 offset:34816
    v_mfma_f32_16x16x32_bf16 v[116:119], a[140:143], v[84:87], v[116:119]
    v_mfma_f32_16x16x32_bf16 v[120:123], a[140:143], v[88:91], v[120:123]
    s_waitcnt lgkmcnt(2)
    v_mfma_f32_16x16x32_bf16 v[108:111], a[64:67], v[92:95], v[108:111]
    ds_read_b128 v[84:87], v11 offset:36864
    v_mfma_f32_16x16x32_bf16 v[112:115], a[64:67], v[96:99], v[112:115]
    ds_read_b128 v[88:91], v11 offset:38912
    v_mfma_f32_16x16x32_bf16 v[116:119], a[144:147], v[92:95], v[116:119]
    v_mfma_f32_16x16x32_bf16 v[120:123], a[144:147], v[96:99], v[120:123]
    s_waitcnt lgkmcnt(2)
    v_mfma_f32_16x16x32_bf16 v[108:111], a[68:71], v[100:103], v[108:111]
    ds_read_b128 v[92:95], v12 offset:36864
    v_mfma_f32_16x16x32_bf16 v[112:115], a[68:71], v[104:107], v[112:115]
    ds_read_b128 v[96:99], v12 offset:38912
    v_mfma_f32_16x16x32_bf16 v[116:119], a[148:151], v[100:103], v[116:119]
    v_mfma_f32_16x16x32_bf16 v[120:123], a[148:151], v[104:107], v[120:123]
    s_waitcnt lgkmcnt(0)
    v_mfma_f32_16x16x32_bf16 v[108:111], a[72:75], v[84:87], v[108:111]
    v_add_u32 v11, s49, v11
    v_mfma_f32_16x16x32_bf16 v[112:115], a[72:75], v[88:91], v[112:115]
    v_add_u32 v12, s49, v12
    v_mfma_f32_16x16x32_bf16 v[108:111], a[76:79], v[92:95], v[108:111]
    s_sub_u32 s47, s47, s49
    v_mfma_f32_16x16x32_bf16 v[112:115], a[76:79], v[96:99], v[112:115]
    s_sub_u32 s49, 0, s49
    v_mfma_f32_16x16x32_bf16 v[116:119], a[152:155], v[84:87], v[116:119]
    v_mfma_f32_16x16x32_bf16 v[120:123], a[152:155], v[88:91], v[120:123]
    v_mfma_f32_16x16x32_bf16 v[116:119], a[156:159], v[92:95], v[116:119]
    v_mfma_f32_16x16x32_bf16 v[120:123], a[156:159], v[96:99], v[120:123]
    v_cvt_pk_bf16_f32 v124, v108, v109
    v_cvt_pk_bf16_f32 v125, v110, v111
    v_cvt_pk_bf16_f32 v126, v112, v113
    v_cvt_pk_bf16_f32 v127, v114, v115
    s_nop 0
    v_permlane16_swap_b32 v124, v126
    v_permlane16_swap_b32 v125, v127
    v_cvt_pk_bf16_f32 v128, v116, v117
    v_cvt_pk_bf16_f32 v129, v118, v119
    v_cvt_pk_bf16_f32 v130, v120, v121
    v_cvt_pk_bf16_f32 v131, v122, v123
    s_nop 0
    v_permlane16_swap_b32 v128, v130
    v_permlane16_swap_b32 v129, v131
    ds_write_b128 v140, v[128:131]
    buffer_store_dwordx4 v[124:127], v19, s[4:7], s44 offen sc1
    buffer_store_dwordx4 v[128:131], v19, s[4:7], s45 offen sc1
    s_waitcnt vmcnt(2)
    s_branch L_gw_67c
L_gw_67:
    buffer_load_dword v2, v1, s[8:11], 0 offen sc1
    s_sub_u32 s36, s36, 1
    s_cbranch_scc1 L_exit
    s_waitcnt vmcnt(0)
L_gw_67c:
    v_readfirstlane_b32 s90, v2
    s_nop 0
    s_cmp_eq_u32 s90, 0
    s_cbranch_scc1 L_gw_67
    s_waitcnt vmcnt(2) lgkmcnt(0)
    s_barrier
    s_add_u32 s44, s38, 573440
    s_add_u32 s45, s44, s56
    s_mov_b32 s46, 81920
    v_add_u32 v140, 4096, v137
    ds_read_b128 v[84:87], v11 offset:0
    ds_read_b128 v[88:91], v11 offset:2048
    ds_read_b128 v[92:95], v12 offset:0
    ds_read_b128 v[96:99], v12 offset:2048
    s_lshl_b32 s90, s32, 10
    s_add_u32 m0, s90, s47
    s_waitcnt lgkmcnt(2)
    v_mfma_f32_16x16x32_bf16 v[108:111], a[0:3], v[84:87], 0
    ds_read_b128 v[100:103], v11 offset:4096
    s_and_b32 s50, s37, 3
    v_mfma_f32_16x16x32_bf16 v[112:115], a[0:3], v[88:91], 0
    ds_read_b128 v[104:107], v11 offset:6144
    s_mul_i32 s53, s50, 327680
    v_mfma_f32_16x16x32_bf16 v[116:119], a[80:83], v[84:87], 0
    buffer_load_dwordx4 v10, s[24:27], s46 offen offset:0 lds
    s_add_u32 m0, m0, 3968
    v_mfma_f32_16x16x32_bf16 v[120:123], a[80:83], v[88:91], 0
    s_waitcnt lgkmcnt(2)
    s_add_u32 s51, s37, 2
    v_mfma_f32_16x16x32_bf16 v[108:111], a[4:7], v[92:95], v[108:111]
    ds_read_b128 v[84:87], v12 offset:4096
    s_and_b32 s50, s51, 3
    v_mfma_f32_16x16x32_bf16 v[112:115], a[4:7], v[96:99], v[112:115]
    ds_read_b128 v[88:91], v12 offset:6144
    s_mul_i32 s50, s50, 98304
    v_mfma_f32_16x16x32_bf16 v[116:119], a[84:87], v[92:95], v[116:119]
    buffer_load_dwordx4 v10, s[24:27], s46 offen offset:128 lds
    s_add_u32 m0, m0, 3968
    v_mfma_f32_16x16x32_bf16 v[120:123], a[84:87], v[96:99], v[120:123]
    s_waitcnt lgkmcnt(2)
    s_add_u32 s50, s50, 475136
    v_mfma_f32_16x16x32_bf16 v[108:111], a[8:11], v[100:103], v[108:111]
    ds_read_b128 v[92:95], v11 offset:8192
    s_add_u32 s44, s38, s50
    v_mfma_f32_16x16x32_bf16 v[112:115], a[8:11], v[104:107], v[112:115]
    ds_read_b128 v[96:99], v11 offset:10240
    s_add_u32 s45, s44, s56
    v_mfma_f32_16x16x32_bf16 v[116:119], a[88:91], v[100:103], v[116:119]
    buffer_load_dwordx4 v10, s[24:27], s46 offen offset:256 lds
    s_add_u32 m0, m0, 3968
    v_mfma_f32_16x16x32_bf16 v[120:123], a[88:91], v[104:107], v[120:123]
    s_waitcnt lgkmcnt(2)
    s_and_b32 s50, s51, 3
    v_mfma_f32_16x16x32_bf16 v[108:111], a[12:15], v[84:87], v[108:111]
    ds_read_b128 v[100:103], v12 offset:8192
    s_lshl_b32 s50, s50, 12
    v_mfma_f32_16x16x32_bf16 v[112:115], a[12:15], v[88:91], v[112:115]
    ds_read_b128 v[104:107], v12 offset:10240
    v_add_u32 v140, s50, v137
    v_mfma_f32_16x16x32_bf16 v[116:119], a[92:95], v[84:87], v[116:119]
    buffer_load_dwordx4 v10, s[24:27], s46 offen offset:384 lds
    s_add_u32 m0, m0, 3968
    v_mfma_f32_16x16x32_bf16 v[120:123], a[92:95], v[88:91], v[120:123]
    s_waitcnt lgkmcnt(2)
    s_add_u32 s37, s37, 1
    v_mfma_f32_16x16x32_bf16 v[108:111], a[16:19], v[92:95], v[108:111]
    ds_read_b128 v[84:87], v11 offset:12288
    s_mov_b32 s52, 0
    v_mfma_f32_16x16x32_bf16 v[112:115], a[16:19], v[96:99], v[112:115]
    ds_read_b128 v[88:91], v11 offset:14336
    s_and_b32 s50, s37, 3
    v_mfma_f32_16x16x32_bf16 v[116:119], a[96:99], v[92:95], v[116:119]
    buffer_load_dwordx4 v10, s[24:27], s46 offen offset:512 lds
    s_add_u32 m0, m0, 3968
    v_mfma_f32_16x16x32_bf16 v[120:123], a[96:99], v[96:99], v[120:123]
    s_waitcnt lgkmcnt(2)
    s_mul_i32 s51, s50, 114688
    v_mfma_f32_16x16x32_bf16 v[108:111], a[20:23], v[100:103], v[108:111]
    ds_read_b128 v[92:95], v12 offset:12288
    s_add_u32 s41, s38, s51
    v_mfma_f32_16x16x32_bf16 v[112:115], a[20:23], v[104:107], v[112:115]
    ds_read_b128 v[96:99], v12 offset:14336
    s_and_b32 s54, s37, s55
    v_mfma_f32_16x16x32_bf16 v[116:119], a[100:103], v[100:103], v[116:119]
    buffer_load_dwordx4 v10, s[24:27], s46 offen offset:640 lds
    s_add_u32 m0, m0, 3968
    v_mfma_f32_16x16x32_bf16 v[120:123], a[100:103], v[104:107], v[120:123]
    s_waitcnt lgkmcnt(2)
    s_lshl_b32 s50, s50, 12
    v_mfma_f32_16x16x32_bf16 v[108:111], a[24:27], v[84:87], v[108:111]
    ds_read_b128 v[100:103], v11 offset:16384
    v_add_u32 v141, s50, v138
    v_mfma_f32_16x16x32_bf16 v[112:115], a[24:27], v[88:91], v[112:115]
    ds_read_b128 v[104:107], v11 offset:18432
    s_add_u32 s43, s41, 40960
    v_mfma_f32_16x16x32_bf16 v[116:119], a[104:107], v[84:87], v[116:119]
    buffer_load_dwordx4 v10, s[24:27], s46 offen offset:768 lds
    s_add_u32 m0, m0, 3968
    v_mfma_f32_16x16x32_bf16 v[120:123], a[104:107], v[88:91], v[120:123]
    s_waitcnt lgkmcnt(2)
    v_mfma_f32_16x16x32_bf16 v[108:111], a[28:31], v[92:95], v[108:111]
    ds_read_b128 v[84:87], v12 offset:16384
    v_mfma_f32_16x16x32_bf16 v[112:115], a[28:31], v[96:99], v[112:115]
    ds_read_b128 v[88:91], v12 offset:18432
    v_mfma_f32_16x16x32_bf16 v[116:119], a[108:111], v[92:95], v[116:119]
    buffer_load_dwordx4 v10, s[24:27], s46 offen offset:896 lds
    s_add_u32 m0, m0, 3968
    v_mfma_f32_16x16x32_bf16 v[120:123], a[108:111], v[96:99], v[120:123]
    s_waitcnt lgkmcnt(2)
    v_mfma_f32_16x16x32_bf16 v[108:111], a[32:35], v[100:103], v[108:111]
    ds_read_b128 v[92:95], v11 offset:20480
    v_mfma_f32_16x16x32_bf16 v[112:115], a[32:35], v[104:107], v[112:115]
    ds_read_b128 v[96:99], v11 offset:22528
    v_mfma_f32_16x16x32_bf16 v[116:119], a[112:115], v[100:103], v[116:119]
    buffer_load_dwordx4 v10, s[24:27], s46 offen offset:1024 lds
    s_add_u32 m0, m0, 3968
    v_mfma_f32_16x16x32_bf16 v[120:123], a[112:115], v[104:107], v[120:123]
    s_waitcnt lgkmcnt(2)
    v_mfma_f32_16x16x32_bf16 v[108:111], a[36:39], v[84:87], v[108:111]
    ds_read_b128 v[100:103], v12 offset:20480
    v_mfma_f32_16x16x32_bf16 v[112:115], a[36:39], v[88:91], v[112:115]
    ds_read_b128 v[104:107], v12 offset:22528
    v_mfma_f32_16x16x32_bf16 v[116:119], a[116:119], v[84:87], v[116:119]
    buffer_load_dwordx4 v10, s[24:27], s46 offen offset:1152 lds
    v_mfma_f32_16x16x32_bf16 v[120:123], a[116:119], v[88:91], v[120:123]
    s_waitcnt lgkmcnt(2)
    v_mfma_f32_16x16x32_bf16 v[108:111], a[40:43], v[92:95], v[108:111]
    ds_read_b128 v[84:87], v11 offset:24576
    v_mfma_f32_16x16x32_bf16 v[112:115], a[40:43], v[96:99], v[112:115]
    ds_read_b128 v[88:91], v11 offset:26624
    v_mfma_f32_16x16x32_bf16 v[116:119], a[120:123], v[92:95], v[116:119]
    v_mfma_f32_16x16x32_bf16 v[120:123], a[120:123], v[96:99], v[120:123]
    s_waitcnt lgkmcnt(2)
    v_mfma_f32_16x16x32_bf16 v[108:111], a[44:47], v[100:103], v[108:111]
    ds_read_b128 v[92:95], v12 offset:24576
    v_mfma_f32_16x16x32_bf16 v[112:115], a[44:47], v[104:107], v[112:115]
    ds_read_b128 v[96:99], v12 offset:26624
    v_mfma_f32_16x16x32_bf16 v[116:119], a[124:127], v[100:103], v[116:119]
    v_mfma_f32_16x16x32_bf16 v[120:123], a[124:127], v[104:107], v[120:123]
    s_waitcnt lgkmcnt(2)
    v_mfma_f32_16x16x32_bf16 v[108:111], a[48:51], v[84:87], v[108:111]
    ds_read_b128 v[100:103], v11 offset:28672
    v_mfma_f32_16x16x32_bf16 v[112:115], a[48:51], v[88:91], v[112:115]
    ds_read_b128 v[104:107], v11 offset:30720
    v_mfma_f32_16x16x32_bf16 v[116:119], a[128:131], v[84:87], v[116:119]
    v_mfma_f32_16x16x32_bf16 v[120:123], a[128:131], v[88:91], v[120:123]
    s_waitcnt lgkmcnt(2)
    v_mfma_f32_16x16x32_bf16 v[108:111], a[52:55], v[92:95], v[108:111]
    ds_read_b128 v[84:87], v12 offset:28672
    v_mfma_f32_16x16x32_bf16 v[112:115], a[52:55], v[96:99], v[112:115]
    ds_read_b128 v[88:91], v12 offset:30720
    v_mfma_f32_16x16x32_bf16 v[116:119], a[132:135], v[92:95], v[116:119]
    v_mfma_f32_16x16x32_bf16 v[120:123], a[132:135], v[96:99], v[120:123]
    s_waitcnt lgkmcnt(2)
    v_mfma_f32_16x16x32_bf16 v[108:111], a[56:59], v[100:103], v[108:111]
    ds_read_b128 v[92:95], v11 offset:32768
    v_mfma_f32_16x16x32_bf16 v[112:115], a[56:59], v[104:107], v[112:115]
    ds_read_b128 v[96:99], v11 offset:34816
    v_mfma_f32_16x16x32_bf16 v[116:119], a[136:139], v[100:103], v[116:119]
    v_mfma_f32_16x16x32_bf16 v[120:123], a[136:139], v[104:107], v[120:123]
    s_waitcnt lgkmcnt(2)
    v_mfma_f32_16x16x32_bf16 v[108:111], a[60:63], v[84:87], v[108:111]
    ds_read_b128 v[100:103], v12 offset:32768
    v_mfma_f32_16x16x32_bf16 v[112:115], a[60:63], v[88:91], v[112:115]
    ds_read_b128 v[104:107], v12 offset:34816
    v_mfma_f32_16x16x32_bf16 v[116:119], a[140:143], v[84:87], v[116:119]
    v_mfma_f32_16x16x32_bf16 v[120:123], a[140:143], v[88:91], v[120:123]
    s_waitcnt lgkmcnt(2)
    v_mfma_f32_16x16x32_bf16 v[108:111], a[64:67], v[92:95], v[108:111]
    ds_read_b128 v[84:87], v11 offset:36864
    v_mfma_f32_16x16x32_bf16 v[112:115], a[64:67], v[96:99], v[112:115]
    ds_read_b128 v[88:91], v11 offset:38912
    v_mfma_f32_16x16x32_bf16 v[116:119], a[144:147], v[92:95], v[116:119]
    v_mfma_f32_16x16x32_bf16 v[120:123], a[144:147], v[96:99], v[120:123]
    s_waitcnt lgkmcnt(2)
    v_mfma_f32_16x16x32_bf16 v[108:111], a[68:71], v[100:103], v[108:111]
    ds_read_b128 v[92:95], v12 offset:36864
    v_mfma_f32_16x16x32_bf16 v[112:115], a[68:71], v[104:107], v[112:115]
    ds_read_b128 v[96:99], v12 offset:38912
    v_mfma_f32_16x16x32_bf16 v[116:119], a[148:151], v[100:103], v[116:119]
    v_mfma_f32_16x16x32_bf16 v[120:123], a[148:151], v[104:107], v[120:123]
    s_waitcnt lgkmcnt(0)
    v_mfma_f32_16x16x32_bf16 v[108:111], a[72:75], v[84:87], v[108:111]
    v_add_u32 v11, s49, v11
    v_mfma_f32_16x16x32_bf16 v[112:115], a[72:75], v[88:91], v[112:115]
    v_add_u32 v12, s49, v12
    v_mfma_f32_16x16x32_bf16 v[108:111], a[76:79], v[92:95], v[108:111]
    s_sub_u32 s47, s47, s49
    v_mfma_f32_16x16x32_bf16 v[112:115], a[76:79], v[96:99], v[112:115]
    s_sub_u32 s49, 0, s49
    v_mfma_f32_16x16x32_bf16 v[116:119], a[152:155], v[84:87], v[116:119]
    v_mfma_f32_16x16x32_bf16 v[120:123], a[152:155], v[88:91], v[120:123]
    v_mfma_f32_16x16x32_bf16 v[116:119], a[156:159], v[92:95], v[116:119]
    v_mfma_f32_16x16x32_bf16 v[120:123], a[156:159], v[96:99], v[120:123]
    v_cvt_pk_bf16_f32 v124, v108, v109
    v_cvt_pk_bf16_f32 v125, v110, v111
    v_cvt_pk_bf16_f32 v126, v112, v113
    v_cvt_pk_bf16_f32 v127, v114, v115
    s_nop 0
    v_permlane16_swap_b32 v124, v126
    v_permlane16_swap_b32 v125, v127
    v_cvt_pk_bf16_f32 v128, v116, v117
    v_cvt_pk_bf16_f32 v129, v118, v119
    v_cvt_pk_bf16_f32 v130, v120, v121
    v_cvt_pk_bf16_f32 v131, v122, v123
    s_nop 0
    v_permlane16_swap_b32 v128, v130
    v_permlane16_swap_b32 v129, v131
    ds_write_b128 v140, v[128:131]
    buffer_store_dwordx4 v[124:127], v19, s[4:7], s44 offen sc1
    buffer_store_dwordx4 v[128:131], v19, s[4:7], s45 offen sc1
    s_mov_b32 m0, s48
L_qkv_loop_s:
    s_nop 0
    buffer_load_dwordx4 v13, s[4:7], s41 offen sc1 lds
    buffer_load_dwordx4 v13, s[4:7], s41 offen offset:1024 sc1 lds
    buffer_load_dword v14, s[4:7], s41 offen offset:2048 sc1 lds
    buffer_load_dword v14, s[4:7], s41 offen offset:2304 sc1 lds
    s_add_u32 s50, s37, 2
    s_and_b32 s50, s50, 3
    s_mul_i32 s50, s50, 114688
    s_add_u32 s42, s38, s50
    s_add_u32 s50, s37, 3
    s_min_u32 s50, s50, 63
    s_mul_i32 s46, s50, 40960
    s_add_u32 s51, s37, 1
    v_mov_b32 v20, s51
    s_mov_b32 m0, s48
    v_mov_b32 v68, 0
    v_mov_b32 v69, 0
    v_mov_b32 v70, 0
    v_mov_b32 v71, 0
    v_mov_b32 v72, 0
    v_mov_b32 v73, 0
    v_mov_b32 v74, 0
    v_mov_b32 v75, 0
    ds_read_b128 v[156:159], v141
    ds_read_b128 v[160:163], v141 offset:1024
L_poll_69:
    buffer_load_dwordx4 v13, s[4:7], s41 offen sc1 lds
    buffer_load_dwordx4 v13, s[4:7], s41 offen offset:1024 sc1 lds
    buffer_load_dword v14, s[4:7], s41 offen offset:2048 sc1 lds
    buffer_load_dword v14, s[4:7], s41 offen offset:2304 sc1 lds
    s_sub_u32 s36, s36, 1
    s_cbranch_scc1 L_exit
    s_waitcnt vmcnt(4)
    ds_read_b32 v18, v15
    s_waitcnt lgkmcnt(0)
    v_cmp_eq_u32 vcc, -1, v18
    s_cbranch_vccnz L_poll_69
    s_barrier
    ds_read_b128 v[28:31], v16 offset:0
    ds_read_b128 v[32:35], v16 offset:1024
    ds_read_b128 v[36:39], v16 offset:2048
    ds_read_b128 v[40:43], v16 offset:3072
    s_waitcnt lgkmcnt(3)
    v_smfmac_f32_16x16x64_bf16 v[68:71], v[28:31], a[0:7], v17
    ds_read_b128 v[44:47], v16 offset:4096
    v_smfmac_f32_16x16x64_bf16 v[72:75], v[28:31], a[80:87], v17
    ds_read_b128 v[48:51], v16 offset:5120
    s_waitcnt lgkmcnt(4)
    v_smfmac_f32_16x16x64_bf16 v[68:71], v[32:35], a[8:15], v17
    ds_read_b128 v[52:55], v16 offset:6144
    v_smfmac_f32_16x16x64_bf16 v[72:75], v[32:35], a[88:95], v17
    ds_read_b128 v[56:59], v16 offset:7168
    s_waitcnt lgkmcnt(5)
    v_smfmac_f32_16x16x64_bf16 v[68:71], v[36:39], a[16:23], v17
    ds_read_b128 v[60:63], v16 offset:8192
    s_waitcnt lgkmcnt(5)
    v_smfmac_f32_16x16x64_bf16 v[68:71], v[40:43], a[24:31], v17
    ds_read_b128 v[64:67], v16 offset:9216
    s_waitcnt lgkmcnt(5)
    v_smfmac_f32_16x16x64_bf16 v[68:71], v[44:47], a[32:39], v17
    s_waitcnt lgkmcnt(4)
    v_smfmac_f32_16x16x64_bf16 v[68:71], v[48:51], a[40:47], v17
    s_waitcnt lgkmcnt(3)
    v_smfmac_f32_16x16x64_bf16 v[68:71], v[52:55], a[48:55], v17
    s_waitcnt lgkmcnt(2)
    v_smfmac_f32_16x16x64_bf16 v[68:71], v[56:59], a[56:63], v17
    s_waitcnt lgkmcnt(1)
    v_smfmac_f32_16x16x64_bf16 v[68:71], v[60:63], a[64:71], v17
    buffer_store_dword v20, v21, s[4:7], s38 offen offset:0 sc1
    s_waitcnt lgkmcnt(0)
    v_smfmac_f32_16x16x64_bf16 v[68:71], v[64:67], a[72:79], v17
L_redo_68:
    v_smfmac_f32_16x16x64_bf16 v[72:75], v[36:39], a[96:103], v17
    v_smfmac_f32_16x16x64_bf16 v[72:75], v[40:43], a[104:111], v17
    v_smfmac_f32_16x16x64_bf16 v[72:75], v[44:47], a[112:119], v17
    v_add_f32 v68, v68, v70
    v_add_f32 v69, v69, v71
    v_smfmac_f32_16x16x64_bf16 v[72:75], v[48:51], a[120:127], v17
    v_cvt_pk_bf16_f32 v132, v68, v69
    ds_write_b32 v23, v132
    v_smfmac_f32_16x16x64_bf16 v[72:75], v[52:55], a[128:135], v17
    v_cmp_u_f32 vcc, v68, v69
    v_smfmac_f32_16x16x64_bf16 v[72:75], v[56:59], a[136:143], v17
    v_smfmac_f32_16x16x64_bf16 v[72:75], v[60:63], a[144:151], v17
    s_cbranch_vccnz L_nan_70
L_cont_71:
    v_smfmac_f32_16x16x64_bf16 v[72:75], v[64:67], a[152:159], v17
    s_waitcnt lgkmcnt(0)
    s_barrier
    ds_read_b64_tr_b16 v[76:77], v24 offset:0
    ds_read_b64_tr_b16 v[78:79], v134 offset:0
    ds_read_b64_tr_b16 v[80:81], v24 offset:1024
    ds_read_b64_tr_b16 v[82:83], v134 offset:1024
    s_cmp_eq_u32 s32, 0
    s_cbranch_scc1 L_w0_72
    s_cmp_eq_u32 s32, 3
    s_cbranch_scc1 L_w3_73
    v_pk_add_f32 v[72:73], v[72:73], v[74:75]
    v_cvt_pk_bf16_f32 v133, v72, v73
    ds_write_b32 v23, v133 offset:4
    s_waitcnt lgkmcnt(3)
    v_mfma_f32_16x16x32_bf16 v[164:167], v[156:159], v[76:79], 0
    s_waitcnt lgkmcnt(1)
    v_mfma_f32_16x16x32_bf16 v[164:167], v[160:163], v[80:83], v[164:167]
    s_waitcnt lgkmcnt(0)
    s_barrier
    s_nop 5
    buffer_store_dwordx4 v[164:167], v135, s[4:7], s41 offen sc1
    ds_read_b128 v[84:87], v11 offset:0
    ds_read_b128 v[88:91], v11 offset:2048
    ds_read_b128 v[92:95], v12 offset:0
    ds_read_b128 v[96:99], v12 offset:2048
    s_branch L_join_74
L_w0_72:
    v_pk_add_f32 v[72:73], v[72:73], v[74:75]
    v_cvt_pk_bf16_f32 v133, v72, v73
    ds_write_b32 v23, v133 offset:4
    s_waitcnt lgkmcnt(0)
    s_barrier
    ds_read_b64_tr_b16 v[76:77], v24 offset:0
    ds_read_b64_tr_b16 v[78:79], v134 offset:0
    ds_read_b64_tr_b16 v[80:81], v24 offset:1024
    ds_read_b64_tr_b16 v[82:83], v134 offset:1024
    s_waitcnt lgkmcnt(2)
    v_mfma_f32_16x16x32_bf16 v[164:167], v[76:79], v[76:79], 0
    s_waitcnt lgkmcnt(0)
    v_mfma_f32_16x16x32_bf16 v[164:167], v[80:83], v[80:83], v[164:167]
    ds_read_b128 v[84:87], v11 offset:0
    ds_read_b128 v[88:91], v11 offset:2048
    ds_read_b128 v[92:95], v12 offset:0
    ds_read_b128 v[96:99], v12 offset:2048
    s_nop 3
    buffer_store_dword v166, v135, s[4:7], s41 offen sc1
    buffer_store_dword v167, v135, s[4:7], s41 offen offset:8 sc1
    s_branch L_join_74
L_w3_73:
    v_pk_add_f32 v[72:73], v[72:73], v[74:75]
    v_cvt_pk_bf16_f32 v133, v72, v73
    ds_write_b32 v23, v133 offset:4
    s_waitcnt lgkmcnt(0)
    s_barrier
    ds_read_b64_tr_b16 v[76:77], v24 offset:0
    ds_read_b64_tr_b16 v[78:79], v134 offset:0
    ds_read_b64_tr_b16 v[80:81], v24 offset:1024
    ds_read_b64_tr_b16 v[82:83], v134 offset:1024
    buffer_store_dword v20, v21, s[4:7], s38 offen offset:32 sc1
    s_waitcnt lgkmcnt(0)
    ds_read_b128 v[84:87], v11 offset:0
    ds_read_b128 v[88:91], v11 offset:2048
    ds_read_b128 v[92:95], v12 offset:0
    ds_read_b128 v[96:99], v12 offset:2048
    s_waitcnt lgkmcnt(0)
    buffer_store_dwordx4 v[76:79], v136, s[4:7], s43 offen sc1
    buffer_store_dwordx4 v[80:83], v136, s[4:7], s43 offen offset:512 sc1
L_join_74:
    s_cmp_eq_u32 s37, 63
    s_cbranch_scc1 L_end_75
    s_cmp_eq_u32 s37, 0
    s_cbranch_scc1 L_sd_76c
L_sd_76:
    s_lshl_b32 s90, s32, 10
    s_add_u32 m0, s90, s47
    s_waitcnt lgkmcnt(2)
    v_mfma_f32_16x16x32_bf16 v[108:111], a[0:3], v[84:87], 0
    ds_read_b128 v[100:103], v11 offset:4096
    s_and_b32 s50, s37, 3
    v_mfma_f32_16x16x32_bf16 v[112:115], a[0:3], v[88:91], 0
    ds_read_b128 v[104:107], v11 offset:6144
    s_mul_i32 s53, s50, 327680
    v_mfma_f32_16x16x32_bf16 v[116:119], a[80:83], v[84:87], 0
    s_add_u32 s51, s37, 2
    s_and_b32 s50, s51, 3
    v_mfma_f32_16x16x32_bf16 v[120:123], a[80:83], v[88:91], 0
    s_waitcnt lgkmcnt(2)
    s_mul_i32 s50, s50, 98304
    v_mfma_f32_16x16x32_bf16 v[108:111], a[4:7], v[92:95], v[108:111]
    ds_read_b128 v[84:87], v12 offset:4096
    s_add_u32 s50, s50, 475136
    v_mfma_f32_16x16x32_bf16 v[112:115], a[4:7], v[96:99], v[112:115]
    ds_read_b128 v[88:91], v12 offset:6144
    s_add_u32 s44, s38, s50
    v_mfma_f32_16x16x32_bf16 v[116:119], a[84:87], v[92:95], v[116:119]
    s_add_u32 s45, s44, s56
    s_and_b32 s50, s51, 3
    v_mfma_f32_16x16x32_bf16 v[120:123], a[84:87], v[96:99], v[120:123]
    s_waitcnt lgkmcnt(2)
    s_lshl_b32 s50, s50, 12
    v_mfma_f32_16x16x32_bf16 v[108:111], a[8:11], v[100:103], v[108:111]
    ds_read_b128 v[92:95], v11 offset:8192
    v_add_u32 v140, s50, v137
    v_mfma_f32_16x16x32_bf16 v[112:115], a[8:11], v[104:107], v[112:115]
    ds_read_b128 v[96:99], v11 offset:10240
    s_add_u32 s37, s37, 1
    v_mfma_f32_16x16x32_bf16 v[116:119], a[88:91], v[100:103], v[116:119]
    s_mov_b32 s52, 0
    s_and_b32 s50, s37, 3
    v_mfma_f32_16x16x32_bf16 v[120:123], a[88:91], v[104:107], v[120:123]
    s_waitcnt lgkmcnt(2)
    s_mul_i32 s51, s50, 114688
    v_mfma_f32_16x16x32_bf16 v[108:111], a[12:15], v[84:87], v[108:111]
    ds_read_b128 v[100:103], v12 offset:8192
    s_add_u32 s41, s38, s51
    v_mfma_f32_16x16x32_bf16 v[112:115], a[12:15], v[88:91], v[112:115]
    ds_read_b128 v[104:107], v12 offset:10240
    s_and_b32 s54, s37, s55
    v_mfma_f32_16x16x32_bf16 v[116:119], a[92:95], v[84:87], v[116:119]
    buffer_store_dword v22, v150, s[4:7], s42 offen offset:0 sc1
    buffer_store_dword v22, v149, s[4:7], s42 offen offset:0 sc1
    v_mfma_f32_16x16x32_bf16 v[120:123], a[92:95], v[88:91], v[120:123]
    s_waitcnt lgkmcnt(2)
    s_lshl_b32 s50, s50, 12
    v_mfma_f32_16x16x32_bf16 v[108:111], a[16:19], v[92:95], v[108:111]
    ds_read_b128 v[84:87], v11 offset:12288
    v_add_u32 v141, s50, v138
    v_mfma_f32_16x16x32_bf16 v[112:115], a[16:19], v[96:99], v[112:115]
    ds_read_b128 v[88:91], v11 offset:14336
    s_add_u32 s43, s41, 40960
    v_mfma_f32_16x16x32_bf16 v[116:119], a[96:99], v[92:95], v[116:119]
    buffer_store_dword v22, v150, s[4:7], s42 offen offset:256 sc1
    v_mfma_f32_16x16x32_bf16 v[120:123], a[96:99], v[96:99], v[120:123]
    s_waitcnt lgkmcnt(2)
    v_mfma_f32_16x16x32_bf16 v[108:111], a[20:23], v[100:103], v[108:111]
    ds_read_b128 v[92:95], v12 offset:12288
    v_mfma_f32_16x16x32_bf16 v[112:115], a[20:23], v[104:107], v[112:115]
    ds_read_b128 v[96:99], v12 offset:14336
    v_mfma_f32_16x16x32_bf16 v[116:119], a[100:103], v[100:103], v[116:119]
    buffer_load_dwordx4 v10, s[24:27], s46 offen offset:0 lds
    s_add_u32 m0, m0, 3968
    v_mfma_f32_16x16x32_bf16 v[120:123], a[100:103], v[104:107], v[120:123]
    s_waitcnt lgkmcnt(2)
    v_mfma_f32_16x16x32_bf16 v[108:111], a[24:27], v[84:87], v[108:111]
    ds_read_b128 v[100:103], v11 offset:16384
    v_mfma_f32_16x16x32_bf16 v[112:115], a[24:27], v[88:91], v[112:115]
    ds_read_b128 v[104:107], v11 offset:18432
    v_mfma_f32_16x16x32_bf16 v[116:119], a[104:107], v[84:87], v[116:119]
    buffer_load_dwordx4 v10, s[24:27], s46 offen offset:128 lds
    s_add_u32 m0, m0, 3968
    v_mfma_f32_16x16x32_bf16 v[120:123], a[104:107], v[88:91], v[120:123]
    s_waitcnt lgkmcnt(2)
    v_mfma_f32_16x16x32_bf16 v[108:111], a[28:31], v[92:95], v[108:111]
    ds_read_b128 v[84:87], v12 offset:16384
    v_mfma_f32_16x16x32_bf16 v[112:115], a[28:31], v[96:99], v[112:115]
    ds_read_b128 v[88:91], v12 offset:18432
    v_mfma_f32_16x16x32_bf16 v[116:119], a[108:111], v[92:95], v[116:119]
    buffer_load_dwordx4 v10, s[24:27], s46 offen offset:256 lds
    s_add_u32 m0, m0, 3968
    v_mfma_f32_16x16x32_bf16 v[120:123], a[108:111], v[96:99], v[120:123]
    s_waitcnt lgkmcnt(2)
    v_mfma_f32_16x16x32_bf16 v[108:111], a[32:35], v[100:103], v[108:111]
    ds_read_b128 v[92:95], v11 offset:20480
    v_mfma_f32_16x16x32_bf16 v[112:115], a[32:35], v[104:107], v[112:115]
    ds_read_b128 v[96:99], v11 offset:22528
    v_mfma_f32_16x16x32_bf16 v[116:119], a[112:115], v[100:103], v[116:119]
    s_waitcnt vmcnt(6)
    buffer_store_dword v20, v139, s[4:7], s38 offen sc1
    v_mfma_f32_16x16x32_bf16 v[120:123], a[112:115], v[104:107], v[120:123]
    s_waitcnt lgkmcnt(2)
    v_mfma_f32_16x16x32_bf16 v[108:111], a[36:39], v[84:87], v[108:111]
    ds_read_b128 v[100:103], v12 offset:20480
    v_mfma_f32_16x16x32_bf16 v[112:115], a[36:39], v[88:91], v[112:115]
    buffer_load_dword v147, v146, s[4:7], 0 offen sc1
    ds_read_b128 v[104:107], v12 offset:22528
    v_mfma_f32_16x16x32_bf16 v[116:119], a[116:119], v[84:87], v[116:119]
    buffer_load_dwordx4 v10, s[24:27], s46 offen offset:384 lds
    s_add_u32 m0, m0, 3968
    v_mfma_f32_16x16x32_bf16 v[120:123], a[116:119], v[88:91], v[120:123]
    s_waitcnt lgkmcnt(2)
    v_mfma_f32_16x16x32_bf16 v[108:111], a[40:43], v[92:95], v[108:111]
    ds_read_b128 v[84:87], v11 offset:24576
    v_mfma_f32_16x16x32_bf16 v[112:115], a[40:43], v[96:99], v[112:115]
    buffer_load_dword v147, v146, s[4:7], 0 offen sc1
    ds_read_b128 v[88:91], v11 offset:26624
    v_mfma_f32_16x16x32_bf16 v[116:119], a[120:123], v[92:95], v[116:119]
    buffer_load_dwordx4 v10, s[24:27], s46 offen offset:512 lds
    s_add_u32 m0, m0, 3968
    v_mfma_f32_16x16x32_bf16 v[120:123], a[120:123], v[96:99], v[120:123]
    s_waitcnt lgkmcnt(2)
    v_mfma_f32_16x16x32_bf16 v[108:111], a[44:47], v[100:103], v[108:111]
    ds_read_b128 v[92:95], v12 offset:24576
    v_mfma_f32_16x16x32_bf16 v[112:115], a[44:47], v[104:107], v[112:115]
    buffer_load_dword v147, v146, s[4:7], 0 offen sc1
    ds_read_b128 v[96:99], v12 offset:26624
    v_mfma_f32_16x16x32_bf16 v[116:119], a[124:127], v[100:103], v[116:119]
    buffer_load_dwordx4 v10, s[24:27], s46 offen offset:640 lds
    s_add_u32 m0, m0, 3968
    v_mfma_f32_16x16x32_bf16 v[120:123], a[124:127], v[104:107], v[120:123]
    s_waitcnt lgkmcnt(2)
    v_mfma_f32_16x16x32_bf16 v[108:111], a[48:51], v[84:87], v[108:111]
    ds_read_b128 v[100:103], v11 offset:28672
    v_mfma_f32_16x16x32_bf16 v[112:115], a[48:51], v[88:91], v[112:115]
    buffer_load_dword v147, v146, s[4:7], 0 offen sc1
    ds_read_b128 v[104:107], v11 offset:30720
    v_mfma_f32_16x16x32_bf16 v[116:119], a[128:131], v[84:87], v[116:119]
    buffer_load_dwordx4 v10, s[24:27], s46 offen offset:768 lds
    s_add_u32 m0, m0, 3968
    v_mfma_f32_16x16x32_bf16 v[120:123], a[128:131], v[88:91], v[120:123]
    s_waitcnt lgkmcnt(2)
    v_mfma_f32_16x16x32_bf16 v[108:111], a[52:55], v[92:95], v[108:111]
    ds_read_b128 v[84:87], v12 offset:28672
    v_mfma_f32_16x16x32_bf16 v[112:115], a[52:55], v[96:99], v[112:115]
    buffer_load_dword v147, v146, s[4:7], 0 offen sc1
    ds_read_b128 v[88:91], v12 offset:30720
    v_mfma_f32_16x16x32_bf16 v[116:119], a[132:135], v[92:95], v[116:119]
    buffer_load_dwordx4 v10, s[24:27], s46 offen offset:896 lds
    s_add_u32 m0, m0, 3968
    v_mfma_f32_16x16x32_bf16 v[120:123], a[132:135], v[96:99], v[120:123]
    s_waitcnt lgkmcnt(2)
    v_mfma_f32_16x16x32_bf16 v[108:111], a[56:59], v[100:103], v[108:111]
    ds_read_b128 v[92:95], v11 offset:32768
    v_mfma_f32_16x16x32_bf16 v[112:115], a[56:59], v[104:107], v[112:115]
    buffer_load_dword v147, v146, s[4:7], 0 offen sc1
    ds_read_b128 v[96:99], v11 offset:34816
    v_mfma_f32_16x16x32_bf16 v[116:119], a[136:139], v[100:103], v[116:119]
    buffer_load_dwordx4 v10, s[24:27], s46 offen offset:1024 lds
    s_add_u32 m0, m0, 3968
    v_mfma_f32_16x16x32_bf16 v[120:123], a[136:139], v[104:107], v[120:123]
    s_waitcnt lgkmcnt(2)
    v_mfma_f32_16x16x32_bf16 v[108:111], a[60:63], v[84:87], v[108:111]
    ds_read_b128 v[100:103], v12 offset:32768
    v_mfma_f32_16x16x32_bf16 v[112:115], a[60:63], v[88:91], v[112:115]
    buffer_load_dword v147, v146, s[4:7], 0 offen sc1
    ds_read_b128 v[104:107], v12 offset:34816
    v_mfma_f32_16x16x32_bf16 v[116:119], a[140:143], v[84:87], v[116:119]
    buffer_load_dwordx4 v10, s[24:27], s46 offen offset:1152 lds
    v_mfma_f32_16x16x32_bf16 v[120:123], a[140:143], v[88:91], v[120:123]
    s_waitcnt lgkmcnt(2)
    v_mfma_f32_16x16x32_bf16 v[108:111], a[64:67], v[92:95], v[108:111]
    ds_read_b128 v[84:87], v11 offset:36864
    v_mfma_f32_16x16x32_bf16 v[112:115], a[64:67], v[96:99], v[112:115]
L_sp_77:
    s_waitcnt vmcnt(6)
    v_cmp_gt_u32 vcc, s54, v147
    buffer_load_dword v147, v146, s[4:7], 0 offen sc1
    s_sub_u32 s36, s36, 1
    s_cbranch_scc1 L_exit
    s_cbranch_vccz L_sp_77x
    s_waitcnt vmcnt(6)
    v_cmp_gt_u32 vcc, s54, v147
    buffer_load_dword v147, v146, s[4:7], 0 offen sc1
    s_cbranch_vccz L_sp_77x
    s_waitcnt vmcnt(6)
    v_cmp_gt_u32 vcc, s54, v147
    buffer_load_dword v147, v146, s[4:7], 0 offen sc1
    s_cbranch_vccz L_sp_77x
    s_waitcnt vmcnt(6)
    v_cmp_gt_u32 vcc, s54, v147
    buffer_load_dword v147, v146, s[4:7], 0 offen sc1
    s_cbranch_vccnz L_sp_77
L_sp_77x:
    s_barrier
    buffer_load_dwordx4 v[168:171], v142, s[4:7], s53 offen sc1
    ds_read_b128 v[88:91], v11 offset:38912
    v_mfma_f32_16x16x32_bf16 v[116:119], a[144:147], v[92:95], v[116:119]
    v_mfma_f32_16x16x32_bf16 v[120:123], a[144:147], v[96:99], v[120:123]
    s_waitcnt lgkmcnt(2)
    v_mfma_f32_16x16x32_bf16 v[108:111], a[68:71], v[100:103], v[108:111]
    ds_read_b128 v[92:95], v12 offset:36864
    v_mfma_f32_16x16x32_bf16 v[112:115], a[68:71], v[104:107], v[112:115]
    ds_read_b128 v[96:99], v12 offset:38912
    v_mfma_f32_16x16x32_bf16 v[116:119], a[148:151], v[100:103], v[116:119]
    v_mfma_f32_16x16x32_bf16 v[120:123], a[148:151], v[104:107], v[120:123]
    buffer_load_dwordx4 v[172:175], v143, s[4:7], s53 offen sc1
    s_waitcnt lgkmcnt(0)
    v_mfma_f32_16x16x32_bf16 v[108:111], a[72:75], v[84:87], v[108:111]
    v_add_u32 v11, s49, v11
    v_mfma_f32_16x16x32_bf16 v[112:115], a[72:75], v[88:91], v[112:115]
    v_add_u32 v12, s49, v12
    v_mfma_f32_16x16x32_bf16 v[108:111], a[76:79], v[92:95], v[108:111]
    s_sub_u32 s47, s47, s49
    v_mfma_f32_16x16x32_bf16 v[112:115], a[76:79], v[96:99], v[112:115]
    s_sub_u32 s49, 0, s49
    v_mfma_f32_16x16x32_bf16 v[116:119], a[152:155], v[84:87], v[116:119]
    v_mfma_f32_16x16x32_bf16 v[120:123], a[152:155], v[88:91], v[120:123]
    v_mfma_f32_16x16x32_bf16 v[116:119], a[156:159], v[92:95], v[116:119]
    v_mfma_f32_16x16x32_bf16 v[120:123], a[156:159], v[96:99], v[120:123]
    v_cvt_pk_bf16_f32 v124, v108, v109
    v_cvt_pk_bf16_f32 v125, v110, v111
    v_cvt_pk_bf16_f32 v126, v112, v113
    v_cvt_pk_bf16_f32 v127, v114, v115
    s_nop 0
    v_permlane16_swap_b32 v124, v126
    v_permlane16_swap_b32 v125, v127
    v_cvt_pk_bf16_f32 v128, v116, v117
    v_cvt_pk_bf16_f32 v129, v118, v119
    v_cvt_pk_bf16_f32 v130, v120, v121
    v_cvt_pk_bf16_f32 v131, v122, v123
    s_nop 0
    v_permlane16_swap_b32 v128, v130
    v_permlane16_swap_b32 v129, v131
    ds_write_b128 v140, v[128:131]
    buffer_store_dwordx4 v[124:127], v19, s[4:7], s44 offen sc1
    buffer_store_dwordx4 v[128:131], v19, s[4:7], s45 offen sc1
    s_mov_b32 m0, s48
    s_waitcnt vmcnt(3)
    v_mfma_f32_16x16x32_bf16 v[184:187], v[198:201], v[168:171], 0
    v_mfma_f32_16x16x32_bf16 v[188:191], v[196:199], v[168:171], 0
    s_waitcnt vmcnt(2)
    v_mfma_f32_16x16x32_bf16 v[184:187], v[198:201], v[172:175], v[184:187]
    v_mfma_f32_16x16x32_bf16 v[188:191], v[196:199], v[172:175], v[188:191]
    s_nop 4
    v_cmp_u_f32 vcc, v184, v184
    v_cvt_pk_bf16_f32 v192, v184, v185
    v_cvt_pk_bf16_f32 v193, v186, v187
    v_cvt_pk_bf16_f32 v194, v188, v189
    v_cvt_pk_bf16_f32 v195, v190, v191
    s_cbranch_vccnz L_pp_78
L_pc_79:
    buffer_store_dwordx4 v[192:195], v148, s[4:7], s41 offen sc1
    s_barrier
    s_branch L_qkv_loop_s
L_end_75:
    s_waitcnt vmcnt(0) lgkmcnt(0)
    buffer_store_dword v20, v139, s[4:7], s38 offen sc1
    s_endpgm
L_nan_70:
    s_cmp_eq_u32 s52, 1
    s_cbranch_scc1 L_cont_71
    v_lshlrev_b32 v1, 4, v0
L_nan_70r:
    s_mov_b32 s90, s41
    v_mov_b32 v2, 0
    buffer_load_dwordx4 v[28:31], v1, s[4:7], s90 offen sc1
    s_add_u32 s90, s90, 1024
    buffer_load_dwordx4 v[32:35], v1, s[4:7], s90 offen sc1
    s_add_u32 s90, s90, 1024
    buffer_load_dwordx4 v[36:39], v1, s[4:7], s90 offen sc1
    s_add_u32 s90, s90, 1024
    buffer_load_dwordx4 v[40:43], v1, s[4:7], s90 offen sc1
    s_add_u32 s90, s90, 1024
    buffer_load_dwordx4 v[44:47], v1, s[4:7], s90 offen sc1
    s_add_u32 s90, s90, 1024
    buffer_load_dwordx4 v[48:51], v1, s[4:7], s90 offen sc1
    s_add_u32 s90, s90, 1024
    buffer_load_dwordx4 v[52:55], v1, s[4:7], s90 offen sc1
    s_add_u32 s90, s90, 1024
    buffer_load_dwordx4 v[56:59], v1, s[4:7], s90 offen sc1
    s_add_u32 s90, s90, 1024
    buffer_load_dwordx4 v[60:63], v1, s[4:7], s90 offen sc1
    s_add_u32 s90, s90, 1024
    buffer_load_dwordx4 v[64:67], v1, s[4:7], s90 offen sc1
    s_add_u32 s90, s90, 1024
    s_sub_u32 s36, s36, 1
    s_cbranch_scc1 L_exit
    s_waitcnt vmcnt(0) lgkmcnt(0)
    v_max3_u32 v2, v2, v28, v29
    v_max3_u32 v2, v2, v30, v31
    v_max3_u32 v2, v2, v32, v33
    v_max3_u32 v2, v2, v34, v35
    v_max3_u32 v2, v2, v36, v37
    v_max3_u32 v2, v2, v38, v39
    v_max3_u32 v2, v2, v40, v41
    v_max3_u32 v2, v2, v42, v43
    v_max3_u32 v2, v2, v44, v45
    v_max3_u32 v2, v2, v46, v47
    v_max3_u32 v2, v2, v48, v49
    v_max3_u32 v2, v2, v50, v51
    v_max3_u32 v2, v2, v52, v53
    v_max3_u32 v2, v2, v54, v55
    v_max3_u32 v2, v2, v56, v57
    v_max3_u32 v2, v2, v58, v59
    v_max3_u32 v2, v2, v60, v61
    v_max3_u32 v2, v2, v62, v63
    v_max3_u32 v2, v2, v64, v65
    v_max3_u32 v2, v2, v66, v67
    v_cmp_eq_u32 vcc, -1, v2
    s_cbranch_vccnz L_nan_70r
    s_mov_b32 s52, 1
    v_mov_b32 v68, 0
    v_mov_b32 v69, 0
    v_mov_b32 v70, 0
    v_mov_b32 v71, 0
    v_mov_b32 v72, 0
    v_mov_b32 v73, 0
    v_mov_b32 v74, 0
    v_mov_b32 v75, 0
    v_smfmac_f32_16x16x64_bf16 v[68:71], v[28:31], a[0:7], v17
    s_nop 0
    v_smfmac_f32_16x16x64_bf16 v[72:75], v[28:31], a[80:87], v17
    v_smfmac_f32_16x16x64_bf16 v[68:71], v[32:35], a[8:15], v17
    v_smfmac_f32_16x16x64_bf16 v[72:75], v[32:35], a[88:95], v17
    v_smfmac_f32_16x16x64_bf16 v[68:71], v[36:39], a[16:23], v17
    v_smfmac_f32_16x16x64_bf16 v[68:71], v[40:43], a[24:31], v17
    v_smfmac_f32_16x16x64_bf16 v[68:71], v[44:47], a[32:39], v17
    v_smfmac_f32_16x16x64_bf16 v[68:71], v[48:51], a[40:47], v17
    v_smfmac_f32_16x16x64_bf16 v[68:71], v[52:55], a[48:55], v17
    v_smfmac_f32_16x16x64_bf16 v[68:71], v[56:59], a[56:63], v17
    v_smfmac_f32_16x16x64_bf16 v[68:71], v[60:63], a[64:71], v17
    v_smfmac_f32_16x16x64_bf16 v[68:71], v[64:67], a[72:79], v17
    s_nop 3
    s_branch L_redo_68
L_sd_76c:
    v_mov_b32 v5, 460288
L_pf_80:
    buffer_load_dword v6, v5, s[4:7], s38 offen sc1
    v_mov_b32 v3, 204
L_p0_81:
    buffer_load_dword v4, v3, s[8:11], 0 offen sc1
    s_sub_u32 s36, s36, 1
    s_cbranch_scc1 L_exit
    s_waitcnt vmcnt(0)
    v_readfirstlane_b32 s90, v4
    s_nop 0
    s_cmp_eq_u32 s90, 0
    s_cbranch_scc1 L_p0_81
    s_and_b32 s90, s90, 2
    s_lshl_b32 s90, s90, 12
    v_readfirstlane_b32 s91, v6
    s_nop 0
    s_cmp_eq_u32 s91, 0
    s_cbranch_scc1 L_pf_80
    s_and_b32 s91, s91, 2
    s_lshl_b32 s91, s91, 12
    v_add_u32 v142, s91, v142
    v_add_u32 v143, s91, v143
    v_and_b32 v3, s90, v152
    v_xor_b32 v146, v3, v146
    s_branch L_sd_76
L_pp_78:
    buffer_load_dwordx4 v[176:179], v142, s[4:7], s53 offen sc1
    buffer_load_dwordx4 v[180:183], v143, s[4:7], s53 offen sc1
    s_sub_u32 s36, s36, 1
    s_cbranch_scc1 L_exit
    v_max_u32 v151, v168, v169
    v_max3_u32 v151, v151, v170, v171
    v_max3_u32 v151, v151, v172, v173
    v_max3_u32 v151, v151, v174, v175
    v_cmp_eq_u32 vcc, -1, v151
    s_cbranch_vccz L_pc_79
    s_waitcnt vmcnt(1)
    v_mfma_f32_16x16x32_bf16 v[184:187], v[198:201], v[176:179], 0
    v_mfma_f32_16x16x32_bf16 v[188:191], v[196:199], v[176:179], 0
    s_waitcnt vmcnt(0)
    v_mfma_f32_16x16x32_bf16 v[184:187], v[198:201], v[180:183], v[184:187]
    v_mfma_f32_16x16x32_bf16 v[188:191], v[196:199], v[180:183], v[188:191]
    s_nop 4
    v_cmp_u_f32 vcc, v184, v184
    v_cvt_pk_bf16_f32 v192, v184, v185
    v_cvt_pk_bf16_f32 v193, v186, v187
    v_cvt_pk_bf16_f32 v194, v188, v189
    v_cvt_pk_bf16_f32 v195, v190, v191
    s_cbranch_vccnz L_pp_78_1
    s_branch L_pc_79
L_pp_78_1:
    buffer_load_dwordx4 v[168:171], v142, s[4:7], s53 offen sc1
    buffer_load_dwordx4 v[172:175], v143, s[4:7], s53 offen sc1
    s_sub_u32 s36, s36, 1
    s_cbranch_scc1 L_exit
    v_max_u32 v151, v176, v177
    v_max3_u32 v151, v151, v178, v179
    v_max3_u32 v151, v151, v180, v181
    v_max3_u32 v151, v151, v182, v183
    v_cmp_eq_u32 vcc, -1, v151
    s_cbranch_vccz L_pc_79
    s_waitcnt vmcnt(1)
    v_mfma_f32_16x16x32_bf16 v[184:187], v[198:201], v[168:171], 0
    v_mfma_f32_16x16x32_bf16 v[188:191], v[196:199], v[168:171], 0
    s_waitcnt vmcnt(0)
    v_mfma_f32_16x16x32_bf16 v[184:187], v[198:201], v[172:175], v[184:187]
    v_mfma_f32_16x16x32_bf16 v[188:191], v[196:199], v[172:175], v[188:191]
    s_nop 4
    v_cmp_u_f32 vcc, v184, v184
    v_cvt_pk_bf16_f32 v192, v184, v185
    v_cvt_pk_bf16_f32 v193, v186, v187
    v_cvt_pk_bf16_f32 v194, v188, v189
    v_cvt_pk_bf16_f32 v195, v190, v191
    s_cbranch_vccnz L_pp_78
    s_branch L_pc_79
L_v_s:
    s_mov_b32 s12, s78
    s_and_b32 s13, s79, 0xffff
    s_mov_b32 s14, 7864320
    s_mov_b32 s15, 0x20000
    s_sub_u32 s40, s35, 12
    s_lshl_b32 s40, s40, 1
    s_mov_b32 s24, s70
    s_and_b32 s25, s71, 0xffff
    s_mov_b32 s26, 2621440
    s_mov_b32 s27, 0x20000
    v_and_b32 v1, 15, v0
    v_lshrrev_b32 v2, 4, v0
    v_lshrrev_b32 v3, 3, v0
    v_and_b32 v4, 7, v0
    s_lshl_b32 s90, s32, 3
    v_add_u32 v5, s90, v3
    s_and_b32 s91, s32, 1
    s_lshl_b32 s91, s91, 2
    v_and_b32 v6, 2, v3
    v_or_b32 v6, s91, v6
    v_xor_b32 v6, v6, v4
    v_lshlrev_b32 v6, 4, v6
    v_mul_u32_u24 v7, 12288, v5
    s_mul_i32 s92, s34, 1536
    s_lshl_b32 s93, s40, 7
    s_add_u32 s92, s92, s93
    v_add3_u32 v124, v6, v7, s92
    v_lshrrev_b32 v6, 1, v3
    v_or_b32 v6, s91, v6
    v_xor_b32 v6, v6, v4
    v_lshlrev_b32 v6, 4, v6
    v_mul_u32_u24 v7, 1280, v5
    v_add_u32 v10, v6, v7
    s_lshl_b32 s90, s32, 10
    s_add_u32 m0, s90, 81920
    s_mov_b32 s91, 128
    buffer_load_dwordx4 v124, s[12:15], s91 offen nt lds
    s_add_u32 m0, m0, 4096
    s_add_u32 s91, s91, 393216
    buffer_load_dwordx4 v124, s[12:15], s91 offen nt lds
    s_add_u32 m0, m0, 4096
    s_add_u32 s91, s91, 393216
    buffer_load_dwordx4 v124, s[12:15], s91 offen nt lds
    s_add_u32 m0, m0, 4096
    s_add_u32 s91, s91, 393216
    buffer_load_dwordx4 v124, s[12:15], s91 offen nt lds
    s_add_u32 m0, m0, 4096
    s_add_u32 s91, s91, 393216
    buffer_load_dwordx4 v124, s[12:15], s91 offen nt lds
    s_add_u32 m0, m0, 4096
    s_add_u32 s91, s91, 393216
    buffer_load_dwordx4 v124, s[12:15], s91 offen nt lds
    s_add_u32 m0, m0, 4096
    s_add_u32 s91, s91, 393216
    buffer_load_dwordx4 v124, s[12:15], s91 offen nt lds
    s_add_u32 m0, m0, 4096
    s_add_u32 s91, s91, 393216
    buffer_load_dwordx4 v124, s[12:15], s91 offen nt lds
    s_add_u32 m0, m0, 4096
    s_add_u32 s91, s91, 393216
    buffer_load_dwordx4 v124, s[12:15], s91 offen nt lds
    s_add_u32 m0, m0, 4096
    s_add_u32 s91, s91, 393216
    buffer_load_dwordx4 v124, s[12:15], s91 offen nt lds
    s_mul_i32 s60, s40, 86
    s_lshr_b32 s60, s60, 8
    s_mul_i32 s61, s60, 3
    s_sub_u32 s61, s40, s61
    s_add_u32 s90, s40, 1
    s_mul_i32 s62, s90, 86
    s_lshr_b32 s62, s62, 8
    s_mul_i32 s63, s62, 3
    s_sub_u32 s63, s90, s63
    v_lshrrev_b32 v3, 1, v2
    v_and_b32 v5, 1, v2
    s_lshl_b32 s90, s32, 9
    v_lshlrev_b32 v6, 4, v1
    v_lshl_add_u32 v6, v3, 8, v6
    v_add_u32 v6, s90, v6
    s_mul_i32 s90, s60, 12288
    s_lshl_b32 s91, s61, 11
    s_add_u32 s90, s90, s91
    v_mul_u32_u24 v7, 6144, v5
    v_add3_u32 v19, v6, v7, s90
    v_mov_b32 v22, -1
    s_mul_i32 s56, s62, 12288
    s_lshl_b32 s91, s63, 11
    s_add_u32 s56, s56, s91
    s_sub_u32 s56, s56, s90
    s_lshl_b32 s90, s40, 10
    s_lshl_b32 s91, s32, 8
    s_add_u32 s91, s91, s90
    s_add_u32 s91, s91, 25600
    v_lshl_add_u32 v135, v0, 2, s91
    v_and_b32 v6, 60, v0
    v_bfe_u32 v7, v0, 1, 1
    v_or_b32 v6, v6, v7
    v_and_b32 v7, 1, v0
    v_lshl_or_b32 v6, v7, 1, v6
    s_and_b32 s90, s32, 1
    s_lshl_b32 s90, s90, 3
    v_xor_b32 v6, s90, v6
    v_lshl_add_u32 v134, v6, 2, s91
    s_lshl_b32 s90, s60, 5
    s_lshl_b32 s91, s62, 5
    v_mov_b32 v3, s90
    v_mov_b32 v4, s91
    v_mov_b32 v6, s61
    v_mov_b32 v7, s63
    v_cmp_eq_u32 vcc, 0, v0
    s_nop 1
    v_cndmask_b32 v3, v4, v3, vcc
    v_cndmask_b32 v6, v7, v6, vcc
    v_add_u32 v4, v3, v6
    s_cmp_eq_u32 s32, 3
    s_cselect_b32 s91, 0, 2146435072
    s_add_u32 s91, s91, 462348
    v_lshl_add_u32 v21, v4, 2, s91
    v_lshl_add_u32 v4, v6, 2, v3
    s_lshl_b32 s91, s32, 2
    s_add_u32 s91, s91, 458752
    v_lshl_add_u32 v136, v4, 2, s91
    v_cmp_gt_u32 vcc, 2, v0
    v_mov_b32 v9, 2146435072
    s_nop 0
    v_cndmask_b32 v21, v9, v21, vcc
    v_cndmask_b32 v136, v9, v136, vcc
    s_lshl_b32 s90, s40, 1
    s_add_u32 s90, s90, s32
    s_sub_u32 s90, s90, 4
    s_lshl_b32 s90, s90, 11
    s_cmp_eq_u32 s40, 0
    s_cselect_b32 s90, 2146435072, s90
    v_lshl_add_u32 v137, v0, 4, s90
    v_mov_b32 v138, 460800
    v_lshrrev_b32 v3, 2, v1
    v_and_b32 v4, 3, v1
    v_and_b32 v5, 1, v2
    v_lshl_add_u32 v6, v2, 3, v3
    v_lshlrev_b32 v6, 7, v6
    v_and_b32 v7, 2, v3
    v_lshl_or_b32 v7, v5, 2, v7
    v_lshrrev_b32 v8, 1, v4
    s_lshl_b32 s90, s32, 1
    v_or_b32 v8, s90, v8
    v_xor_b32 v7, v7, v8
    v_lshl_add_u32 v6, v7, 4, v6
    v_and_b32 v7, 1, v4
    v_lshl_add_u32 v6, v7, 3, v6
    v_add_u32 v125, 81920, v6
    v_add_u32 v126, 40960, v6
    v_add_u32 v127, 122880, v6
    s_lshl_b32 s90, s32, 9
    s_add_u32 s90, s90, 133120
    v_and_b32 v7, 2, v1
    v_cmp_ne_u32 vcc, 0, v7
    v_mov_b32 v6, 0x4444
    v_mov_b32 v8, 0xeeee
    v_cndmask_b32 v17, v6, v8, vcc
    v_lshlrev_b32 v6, 4, v0
    v_add_u32 v16, 122880, v6
    s_mul_i32 s90, s32, 2560
    v_lshl_add_u32 v13, v0, 4, s90
    v_lshl_add_u32 v14, v0, 2, s90
    s_add_u32 s48, s90, 122880
    v_mul_u32_u24 v6, 40, v0
    v_add_u32 v15, s48, v6
    v_mul_u32_u24 v6, 164, v0
    v_min_u32 v6, 10236, v6
    v_add_u32 v25, 122880, v6
    v_lshrrev_b32 v6, 3, v1
    v_lshlrev_b32 v6, 10, v6
    v_and_b32 v7, 7, v1
    v_lshl_add_u32 v6, v7, 7, v6
    v_lshrrev_b32 v7, 1, v1
    v_xor_b32 v7, v7, v2
    v_lshl_add_u32 v11, v7, 4, v6
    v_xor_b32 v12, 64, v11
    v_and_b32 v3, 1, v0
    v_lshlrev_b32 v3, 12, v3
    v_bfe_u32 v5, v0, 2, 1
    v_lshl_add_u32 v3, v5, 13, v3
    v_bfe_u32 v4, v0, 1, 1
    v_lshl_add_u32 v3, v4, 14, v3
    s_lshl_b32 s91, s34, 9
    s_add_u32 s91, s91, 1933312
    s_xor_b32 s55, s32, 3
    s_or_b32 s55, s55, s40
    s_cselect_b32 s91, 2146435072, s91
    v_add_u32 v140, s91, v3
    v_cmp_gt_u32 vcc, 8, v0
    v_mov_b32 v9, 2146435072
    s_nop 0
    v_cndmask_b32 v140, v9, v140, vcc
    v_cmp_ne_u32 vcc, s34, v0
    v_mov_b32 v9, 2146435072
    s_nop 0
    v_cndmask_b32 v140, v9, v140, vcc
    s_lshr_b32 s91, s34, 2
    v_cmp_eq_u32 vcc, s91, v5
    s_nop 1
    v_cndmask_b32 v141, v9, v140, vcc
    v_cndmask_b32 v140, v140, v9, vcc
    v_and_b32 v3, 7, v0
    v_min_u32 v3, 5, v3
    v_bfe_u32 v4, v0, 3, 2
    v_lshlrev_b32 v4, 7, v4
    v_lshl_add_u32 v3, v3, 2, v4
    v_add_u32 v142, 462368, v3
    s_lshl_b32 s93, s40, 1
    s_add_u32 s93, s93, s32
    s_lshl_b32 s93, s93, 1
    s_sub_u32 s93, s93, 8
    s_nop 0
    s_lshr_b32 s90, s93, 2
    s_lshl_b32 s90, s90, 15
    s_and_b32 s92, s93, 3
    s_lshl_b32 s92, s92, 10
    s_add_u32 s90, s90, s92
    v_mov_b32 v5, s34
    v_and_b32 v6, 7, v1
    v_lshlrev_b32 v6, 4, v6
    v_lshl_add_u32 v6, v5, 7, v6
    v_lshrrev_b32 v7, 3, v1
    v_lshl_add_u32 v6, v7, 12, v6
    v_lshrrev_b32 v5, 1, v2
    v_lshl_add_u32 v6, v5, 13, v6
    v_and_b32 v5, 1, v2
    v_lshl_add_u32 v6, v5, 14, v6
    v_add_u32 v143, s90, v6
    s_and_b32 s91, s34, 1
    s_lshl_b32 s91, s91, 12
    s_add_u32 s90, s90, s91
    s_lshr_b32 s91, s34, 2
    s_lshl_b32 s91, s91, 13
    s_add_u32 s90, s90, s91
    s_and_b32 s91, s34, 2
    s_lshl_b32 s91, s91, 13
    s_add_u32 s90, s90, s91
    v_lshl_add_u32 v144, v0, 4, s90
    s_lshl_b32 s91, s93, 10
    s_add_u32 s91, s91, 884736
    v_lshl_add_u32 v146, v0, 4, s91
    s_lshr_b32 s91, s34, 1
    s_mul_i32 s91, s91, 10240
    s_lshl_b32 s92, s93, 5
    s_add_u32 s91, s91, s92
    s_and_b32 s92, s34, 1
    s_mul_i32 s92, s92, 40960
    s_add_u32 s91, s91, s92
    s_add_u32 s91, s91, 1280
    v_mul_u32_u24 v6, 2560, v2
    v_lshl_add_u32 v6, v1, 1, v6
    v_add_u32 v145, s91, v6
    v_cmp_gt_u32 s[58:59], 8, v1
    v_and_b32 v5, 1, v1
    v_lshrrev_b32 v6, 3, v1
    v_lshl_add_u32 v5, v5, 1, v6
    v_bfe_u32 v6, v1, 2, 1
    v_cmp_ne_u32 vcc, 0, v6
    v_mov_b32 v6, 0x3f80
    v_mov_b32 v7, 0x3f800000
    v_cndmask_b32 v6, v6, v7, vcc
    v_cmp_eq_u32 vcc, 0, v5
    s_nop 1
    v_cndmask_b32 v7, 0, v6, vcc
    v_accvgpr_write_b32 a160, v7
    v_cmp_eq_u32 vcc, 1, v5
    s_nop 1
    v_cndmask_b32 v7, 0, v6, vcc
    v_accvgpr_write_b32 a161, v7
    v_cmp_eq_u32 vcc, 2, v5
    s_nop 1
    v_cndmask_b32 v7, 0, v6, vcc
    v_accvgpr_write_b32 a162, v7
    v_cmp_eq_u32 vcc, 3, v5
    s_nop 1
    v_cndmask_b32 v7, 0, v6, vcc
    v_accvgpr_write_b32 a163, v7
    s_cmp_lg_u32 s40, 0
    s_cselect_b64 vcc, -1, 0
    v_cndmask_b32 v143, v9, v143, vcc
    v_cndmask_b32 v144, v9, v144, vcc
    v_cndmask_b32 v145, v9, v145, vcc
    v_cndmask_b32 v146, v9, v146, vcc
    s_lshl_b32 s90, s32, 10
    s_add_u32 m0, s90, 40960
    s_mov_b32 s91, 0
    buffer_load_dwordx4 v124, s[12:15], s91 offen nt lds
    s_add_u32 m0, m0, 4096
    s_add_u32 s91, s91, 393216
    buffer_load_dwordx4 v124, s[12:15], s91 offen nt lds
    s_add_u32 m0, m0, 4096
    s_add_u32 s91, s91, 393216
    buffer_load_dwordx4 v124, s[12:15], s91 offen nt lds
    s_add_u32 m0, m0, 4096
    s_add_u32 s91, s91, 393216
    buffer_load_dwordx4 v124, s[12:15], s91 offen nt lds
    s_add_u32 m0, m0, 4096
    s_add_u32 s91, s91, 393216
    buffer_load_dwordx4 v124, s[12:15], s91 offen nt lds
    s_add_u32 m0, m0, 4096
    s_add_u32 s91, s91, 393216
    buffer_load_dwordx4 v124, s[12:15], s91 offen nt lds
    s_add_u32 m0, m0, 4096
    s_add_u32 s91, s91, 393216
    buffer_load_dwordx4 v124, s[12:15], s91 offen nt lds
    s_add_u32 m0, m0, 4096
    s_add_u32 s91, s91, 393216
    buffer_load_dwordx4 v124, s[12:15], s91 offen nt lds
    s_add_u32 m0, m0, 4096
    s_add_u32 s91, s91, 393216
    buffer_load_dwordx4 v124, s[12:15], s91 offen nt lds
    s_add_u32 m0, m0, 4096
    s_add_u32 s91, s91, 393216
    buffer_load_dwordx4 v124, s[12:15], s91 offen nt lds
    s_lshl_b32 s90, s32, 10
    s_add_u32 m0, s90, 122880
    s_mov_b32 s91, 3932288
    buffer_load_dwordx4 v124, s[12:15], s91 offen nt lds
    s_add_u32 m0, m0, 4096
    s_add_u32 s91, s91, 393216
    buffer_load_dwordx4 v124, s[12:15], s91 offen nt lds
    s_add_u32 m0, m0, 4096
    s_add_u32 s91, s91, 393216
    buffer_load_dwordx4 v124, s[12:15], s91 offen nt lds
    s_add_u32 m0, m0, 4096
    s_add_u32 s91, s91, 393216
    buffer_load_dwordx4 v124, s[12:15], s91 offen nt lds
    s_add_u32 m0, m0, 4096
    s_add_u32 s91, s91, 393216
    buffer_load_dwordx4 v124, s[12:15], s91 offen nt lds
    s_add_u32 m0, m0, 4096
    s_add_u32 s91, s91, 393216
    buffer_load_dwordx4 v124, s[12:15], s91 offen nt lds
    s_add_u32 m0, m0, 4096
    s_add_u32 s91, s91, 393216
    buffer_load_dwordx4 v124, s[12:15], s91 offen nt lds
    s_add_u32 m0, m0, 4096
    s_add_u32 s91, s91, 393216
    buffer_load_dwordx4 v124, s[12:15], s91 offen nt lds
    s_add_u32 m0, m0, 4096
    s_add_u32 s91, s91, 393216
    buffer_load_dwordx4 v124, s[12:15], s91 offen nt lds
    s_add_u32 m0, m0, 4096
    s_add_u32 s91, s91, 393216
    buffer_load_dwordx4 v124, s[12:15], s91 offen nt lds
    s_mov_b32 s46, 0
    s_lshl_b32 s90, s32, 10
    s_add_u32 m0, s90, 0
    s_nop 0
    buffer_load_dwordx4 v10, s[24:27], s46 offen offset:0 lds
    s_add_u32 m0, m0, 3968
    s_nop 0
    buffer_load_dwordx4 v10, s[24:27], s46 offen offset:128 lds
    s_add_u32 m0, m0, 3968
    s_nop 0
    buffer_load_dwordx4 v10, s[24:27], s46 offen offset:256 lds
    s_add_u32 m0, m0, 3968
    s_nop 0
    buffer_load_dwordx4 v10, s[24:27], s46 offen offset:384 lds
    s_add_u32 m0, m0, 3968
    s_nop 0
    buffer_load_dwordx4 v10, s[24:27], s46 offen offset:512 lds
    s_add_u32 m0, m0, 3968
    s_nop 0
    buffer_load_dwordx4 v10, s[24:27], s46 offen offset:640 lds
    s_add_u32 m0, m0, 3968
    s_nop 0
    buffer_load_dwordx4 v10, s[24:27], s46 offen offset:768 lds
    s_add_u32 m0, m0, 3968
    s_nop 0
    buffer_load_dwordx4 v10, s[24:27], s46 offen offset:896 lds
    s_add_u32 m0, m0, 3968
    s_nop 0
    buffer_load_dwordx4 v10, s[24:27], s46 offen offset:1024 lds
    s_add_u32 m0, m0, 3968
    s_nop 0
    buffer_load_dwordx4 v10, s[24:27], s46 offen offset:1152 lds
    s_waitcnt vmcnt(30)
    s_barrier
    ds_read_b64_tr_b16 a[80:81], v125 offset:0
    ds_read_b64_tr_b16 a[82:83], v125 offset:512
    ds_read_b64_tr_b16 a[84:85], v125 offset:4096
    ds_read_b64_tr_b16 a[86:87], v125 offset:4608
    ds_read_b64_tr_b16 a[88:89], v125 offset:8192
    ds_read_b64_tr_b16 a[90:91], v125 offset:8704
    ds_read_b64_tr_b16 a[92:93], v125 offset:12288
    ds_read_b64_tr_b16 a[94:95], v125 offset:12800
    ds_read_b64_tr_b16 a[96:97], v125 offset:16384
    ds_read_b64_tr_b16 a[98:99], v125 offset:16896
    ds_read_b64_tr_b16 a[100:101], v125 offset:20480
    ds_read_b64_tr_b16 a[102:103], v125 offset:20992
    ds_read_b64_tr_b16 a[104:105], v125 offset:24576
    ds_read_b64_tr_b16 a[106:107], v125 offset:25088
    ds_read_b64_tr_b16 a[108:109], v125 offset:28672
    ds_read_b64_tr_b16 a[110:111], v125 offset:29184
    ds_read_b64_tr_b16 a[112:113], v125 offset:32768
    ds_read_b64_tr_b16 a[114:115], v125 offset:33280
    ds_read_b64_tr_b16 a[116:117], v125 offset:36864
    ds_read_b64_tr_b16 a[118:119], v125 offset:37376
    s_waitcnt lgkmcnt(0)
    s_barrier
    s_lshl_b32 s90, s32, 10
    s_add_u32 m0, s90, 81920
    s_mov_b32 s91, 3932160
    buffer_load_dwordx4 v124, s[12:15], s91 offen nt lds
    s_add_u32 m0, m0, 4096
    s_add_u32 s91, s91, 393216
    buffer_load_dwordx4 v124, s[12:15], s91 offen nt lds
    s_add_u32 m0, m0, 4096
    s_add_u32 s91, s91, 393216
    buffer_load_dwordx4 v124, s[12:15], s91 offen nt lds
    s_add_u32 m0, m0, 4096
    s_add_u32 s91, s91, 393216
    buffer_load_dwordx4 v124, s[12:15], s91 offen nt lds
    s_add_u32 m0, m0, 4096
    s_add_u32 s91, s91, 393216
    buffer_load_dwordx4 v124, s[12:15], s91 offen nt lds
    s_add_u32 m0, m0, 4096
    s_add_u32 s91, s91, 393216
    buffer_load_dwordx4 v124, s[12:15], s91 offen nt lds
    s_add_u32 m0, m0, 4096
    s_add_u32 s91, s91, 393216
    buffer_load_dwordx4 v124, s[12:15], s91 offen nt lds
    s_add_u32 m0, m0, 4096
    s_add_u32 s91, s91, 393216
    buffer_load_dwordx4 v124, s[12:15], s91 offen nt lds
    s_add_u32 m0, m0, 4096
    s_add_u32 s91, s91, 393216
    buffer_load_dwordx4 v124, s[12:15], s91 offen nt lds
    s_add_u32 m0, m0, 4096
    s_add_u32 s91, s91, 393216
    buffer_load_dwordx4 v124, s[12:15], s91 offen nt lds
    s_waitcnt vmcnt(30)
    s_barrier
    ds_read_b64_tr_b16 a[0:1], v126 offset:0
    ds_read_b64_tr_b16 a[2:3], v126 offset:512
    ds_read_b64_tr_b16 a[4:5], v126 offset:4096
    ds_read_b64_tr_b16 a[6:7], v126 offset:4608
    ds_read_b64_tr_b16 a[8:9], v126 offset:8192
    ds_read_b64_tr_b16 a[10:11], v126 offset:8704
    ds_read_b64_tr_b16 a[12:13], v126 offset:12288
    ds_read_b64_tr_b16 a[14:15], v126 offset:12800
    ds_read_b64_tr_b16 a[16:17], v126 offset:16384
    ds_read_b64_tr_b16 a[18:19], v126 offset:16896
    ds_read_b64_tr_b16 a[20:21], v126 offset:20480
    ds_read_b64_tr_b16 a[22:23], v126 offset:20992
    ds_read_b64_tr_b16 a[24:25], v126 offset:24576
    ds_read_b64_tr_b16 a[26:27], v126 offset:25088
    ds_read_b64_tr_b16 a[28:29], v126 offset:28672
    ds_read_b64_tr_b16 a[30:31], v126 offset:29184
    ds_read_b64_tr_b16 a[32:33], v126 offset:32768
    ds_read_b64_tr_b16 a[34:35], v126 offset:33280
    ds_read_b64_tr_b16 a[36:37], v126 offset:36864
    ds_read_b64_tr_b16 a[38:39], v126 offset:37376
    s_waitcnt lgkmcnt(0)
    s_barrier
    s_mov_b32 s46, 40960
    s_lshl_b32 s90, s32, 10
    s_add_u32 m0, s90, 40960
    s_nop 0
    buffer_load_dwordx4 v10, s[24:27], s46 offen offset:0 lds
    s_add_u32 m0, m0, 3968
    s_nop 0
    buffer_load_dwordx4 v10, s[24:27], s46 offen offset:128 lds
    s_add_u32 m0, m0, 3968
    s_nop 0
    buffer_load_dwordx4 v10, s[24:27], s46 offen offset:256 lds
    s_add_u32 m0, m0, 3968
    s_nop 0
    buffer_load_dwordx4 v10, s[24:27], s46 offen offset:384 lds
    s_add_u32 m0, m0, 3968
    s_nop 0
    buffer_load_dwordx4 v10, s[24:27], s46 offen offset:512 lds
    s_add_u32 m0, m0, 3968
    s_nop 0
    buffer_load_dwordx4 v10, s[24:27], s46 offen offset:640 lds
    s_add_u32 m0, m0, 3968
    s_nop 0
    buffer_load_dwordx4 v10, s[24:27], s46 offen offset:768 lds
    s_add_u32 m0, m0, 3968
    s_nop 0
    buffer_load_dwordx4 v10, s[24:27], s46 offen offset:896 lds
    s_add_u32 m0, m0, 3968
    s_nop 0
    buffer_load_dwordx4 v10, s[24:27], s46 offen offset:1024 lds
    s_add_u32 m0, m0, 3968
    s_nop 0
    buffer_load_dwordx4 v10, s[24:27], s46 offen offset:1152 lds
    s_waitcnt vmcnt(30)
    s_barrier
    ds_read_b64_tr_b16 a[120:121], v127 offset:0
    ds_read_b64_tr_b16 a[122:123], v127 offset:512
    ds_read_b64_tr_b16 a[124:125], v127 offset:4096
    ds_read_b64_tr_b16 a[126:127], v127 offset:4608
    ds_read_b64_tr_b16 a[128:129], v127 offset:8192
    ds_read_b64_tr_b16 a[130:131], v127 offset:8704
    ds_read_b64_tr_b16 a[132:133], v127 offset:12288
    ds_read_b64_tr_b16 a[134:135], v127 offset:12800
    ds_read_b64_tr_b16 a[136:137], v127 offset:16384
    ds_read_b64_tr_b16 a[138:139], v127 offset:16896
    ds_read_b64_tr_b16 a[140:141], v127 offset:20480
    ds_read_b64_tr_b16 a[142:143], v127 offset:20992
    ds_read_b64_tr_b16 a[144:145], v127 offset:24576
    ds_read_b64_tr_b16 a[146:147], v127 offset:25088
    ds_read_b64_tr_b16 a[148:149], v127 offset:28672
    ds_read_b64_tr_b16 a[150:151], v127 offset:29184
    ds_read_b64_tr_b16 a[152:153], v127 offset:32768
    ds_read_b64_tr_b16 a[154:155], v127 offset:33280
    ds_read_b64_tr_b16 a[156:157], v127 offset:36864
    ds_read_b64_tr_b16 a[158:159], v127 offset:37376
    s_waitcnt lgkmcnt(0)
    s_waitcnt vmcnt(10)
    s_barrier
    ds_read_b64_tr_b16 a[40:41], v125 offset:0
    ds_read_b64_tr_b16 a[42:43], v125 offset:512
    ds_read_b64_tr_b16 a[44:45], v125 offset:4096
    ds_read_b64_tr_b16 a[46:47], v125 offset:4608
    ds_read_b64_tr_b16 a[48:49], v125 offset:8192
    ds_read_b64_tr_b16 a[50:51], v125 offset:8704
    ds_read_b64_tr_b16 a[52:53], v125 offset:12288
    ds_read_b64_tr_b16 a[54:55], v125 offset:12800
    ds_read_b64_tr_b16 a[56:57], v125 offset:16384
    ds_read_b64_tr_b16 a[58:59], v125 offset:16896
    ds_read_b64_tr_b16 a[60:61], v125 offset:20480
    ds_read_b64_tr_b16 a[62:63], v125 offset:20992
    ds_read_b64_tr_b16 a[64:65], v125 offset:24576
    ds_read_b64_tr_b16 a[66:67], v125 offset:25088
    ds_read_b64_tr_b16 a[68:69], v125 offset:28672
    ds_read_b64_tr_b16 a[70:71], v125 offset:29184
    ds_read_b64_tr_b16 a[72:73], v125 offset:32768
    ds_read_b64_tr_b16 a[74:75], v125 offset:33280
    ds_read_b64_tr_b16 a[76:77], v125 offset:36864
    ds_read_b64_tr_b16 a[78:79], v125 offset:37376
    s_waitcnt lgkmcnt(0)
    s_mov_b32 s49, 40960
    s_mov_b32 s47, 40960
    s_mov_b32 s37, -1
    s_add_u32 s44, s38, 65536
    s_add_u32 s45, s44, s56
    s_mov_b32 s46, 40960
    v_mov_b32 v1, 196
    buffer_load_dword v2, v1, s[8:11], 0 offen sc1
    ds_read_b128 v[84:87], v11 offset:0
    ds_read_b128 v[88:91], v11 offset:2048
    ds_read_b128 v[92:95], v12 offset:0
    ds_read_b128 v[96:99], v12 offset:2048
    s_waitcnt lgkmcnt(2)
    v_mfma_f32_16x16x32_bf16 v[108:111], a[0:3], v[84:87], 0
    ds_read_b128 v[100:103], v11 offset:4096
    v_mfma_f32_16x16x32_bf16 v[112:115], a[0:3], v[88:91], 0
    ds_read_b128 v[104:107], v11 offset:6144
    v_mfma_f32_16x16x32_bf16 v[116:119], a[80:83], v[84:87], 0
    v_mfma_f32_16x16x32_bf16 v[120:123], a[80:83], v[88:91], 0
    s_waitcnt lgkmcnt(2)
    v_mfma_f32_16x16x32_bf16 v[108:111], a[4:7], v[92:95], v[108:111]
    ds_read_b128 v[84:87], v12 offset:4096
    v_mfma_f32_16x16x32_bf16 v[112:115], a[4:7], v[96:99], v[112:115]
    ds_read_b128 v[88:91], v12 offset:6144
    v_mfma_f32_16x16x32_bf16 v[116:119], a[84:87], v[92:95], v[116:119]
    v_mfma_f32_16x16x32_bf16 v[120:123], a[84:87], v[96:99], v[120:123]
    s_waitcnt lgkmcnt(2)
    v_mfma_f32_16x16x32_bf16 v[108:111], a[8:11], v[100:103], v[108:111]
    ds_read_b128 v[92:95], v11 offset:8192
    v_mfma_f32_16x16x32_bf16 v[112:115], a[8:11], v[104:107], v[112:115]
    ds_read_b128 v[96:99], v11 offset:10240
    v_mfma_f32_16x16x32_bf16 v[116:119], a[88:91], v[100:103], v[116:119]
    v_mfma_f32_16x16x32_bf16 v[120:123], a[88:91], v[104:107], v[120:123]
    s_waitcnt lgkmcnt(2)
    v_mfma_f32_16x16x32_bf16 v[108:111], a[12:15], v[84:87], v[108:111]
    ds_read_b128 v[100:103], v12 offset:8192
    v_mfma_f32_16x16x32_bf16 v[112:115], a[12:15], v[88:91], v[112:115]
    ds_read_b128 v[104:107], v12 offset:10240
    v_mfma_f32_16x16x32_bf16 v[116:119], a[92:95], v[84:87], v[116:119]
    v_mfma_f32_16x16x32_bf16 v[120:123], a[92:95], v[88:91], v[120:123]
    s_waitcnt lgkmcnt(2)
    v_mfma_f32_16x16x32_bf16 v[108:111], a[16:19], v[92:95], v[108:111]
    ds_read_b128 v[84:87], v11 offset:12288
    v_mfma_f32_16x16x32_bf16 v[112:115], a[16:19], v[96:99], v[112:115]
    ds_read_b128 v[88:91], v11 offset:14336
    v_mfma_f32_16x16x32_bf16 v[116:119], a[96:99], v[92:95], v[116:119]
    v_mfma_f32_16x16x32_bf16 v[120:123], a[96:99], v[96:99], v[120:123]
    s_waitcnt lgkmcnt(2)
    v_mfma_f32_16x16x32_bf16 v[108:111], a[20:23], v[100:103], v[108:111]
    ds_read_b128 v[92:95], v12 offset:12288
    v_mfma_f32_16x16x32_bf16 v[112:115], a[20:23], v[104:107], v[112:115]
    ds_read_b128 v[96:99], v12 offset:14336
    v_mfma_f32_16x16x32_bf16 v[116:119], a[100:103], v[100:103], v[116:119]
    v_mfma_f32_16x16x32_bf16 v[120:123], a[100:103], v[104:107], v[120:123]
    s_waitcnt lgkmcnt(2)
    v_mfma_f32_16x16x32_bf16 v[108:111], a[24:27], v[84:87], v[108:111]
    ds_read_b128 v[100:103], v11 offset:16384
    v_mfma_f32_16x16x32_bf16 v[112:115], a[24:27], v[88:91], v[112:115]
    ds_read_b128 v[104:107], v11 offset:18432
    v_mfma_f32_16x16x32_bf16 v[116:119], a[104:107], v[84:87], v[116:119]
    v_mfma_f32_16x16x32_bf16 v[120:123], a[104:107], v[88:91], v[120:123]
    s_waitcnt lgkmcnt(2)
    v_mfma_f32_16x16x32_bf16 v[108:111], a[28:31], v[92:95], v[108:111]
    ds_read_b128 v[84:87], v12 offset:16384
    v_mfma_f32_16x16x32_bf16 v[112:115], a[28:31], v[96:99], v[112:115]
    ds_read_b128 v[88:91], v12 offset:18432
    v_mfma_f32_16x16x32_bf16 v[116:119], a[108:111], v[92:95], v[116:119]
    v_mfma_f32_16x16x32_bf16 v[120:123], a[108:111], v[96:99], v[120:123]
    s_waitcnt lgkmcnt(2)
    v_mfma_f32_16x16x32_bf16 v[108:111], a[32:35], v[100:103], v[108:111]
    ds_read_b128 v[92:95], v11 offset:20480
    v_mfma_f32_16x16x32_bf16 v[112:115], a[32:35], v[104:107], v[112:115]
    ds_read_b128 v[96:99], v11 offset:22528
    v_mfma_f32_16x16x32_bf16 v[116:119], a[112:115], v[100:103], v[116:119]
    v_mfma_f32_16x16x32_bf16 v[120:123], a[112:115], v[104:107], v[120:123]
    s_waitcnt lgkmcnt(2)
    v_mfma_f32_16x16x32_bf16 v[108:111], a[36:39], v[84:87], v[108:111]
    ds_read_b128 v[100:103], v12 offset:20480
    v_mfma_f32_16x16x32_bf16 v[112:115], a[36:39], v[88:91], v[112:115]
    ds_read_b128 v[104:107], v12 offset:22528
    v_mfma_f32_16x16x32_bf16 v[116:119], a[116:119], v[84:87], v[116:119]
    v_mfma_f32_16x16x32_bf16 v[120:123], a[116:119], v[88:91], v[120:123]
    s_waitcnt lgkmcnt(2)
    v_mfma_f32_16x16x32_bf16 v[108:111], a[40:43], v[92:95], v[108:111]
    ds_read_b128 v[84:87], v11 offset:24576
    v_mfma_f32_16x16x32_bf16 v[112:115], a[40:43], v[96:99], v[112:115]
    ds_read_b128 v[88:91], v11 offset:26624
    v_mfma_f32_16x16x32_bf16 v[116:119], a[120:123], v[92:95], v[116:119]
    v_mfma_f32_16x16x32_bf16 v[120:123], a[120:123], v[96:99], v[120:123]
    s_waitcnt lgkmcnt(2)
    v_mfma_f32_16x16x32_bf16 v[108:111], a[44:47], v[100:103], v[108:111]
    ds_read_b128 v[92:95], v12 offset:24576
    v_mfma_f32_16x16x32_bf16 v[112:115], a[44:47], v[104:107], v[112:115]
    ds_read_b128 v[96:99], v12 offset:26624
    v_mfma_f32_16x16x32_bf16 v[116:119], a[124:127], v[100:103], v[116:119]
    v_mfma_f32_16x16x32_bf16 v[120:123], a[124:127], v[104:107], v[120:123]
    s_waitcnt lgkmcnt(2)
    v_mfma_f32_16x16x32_bf16 v[108:111], a[48:51], v[84:87], v[108:111]
    ds_read_b128 v[100:103], v11 offset:28672
    v_mfma_f32_16x16x32_bf16 v[112:115], a[48:51], v[88:91], v[112:115]
    ds_read_b128 v[104:107], v11 offset:30720
    v_mfma_f32_16x16x32_bf16 v[116:119], a[128:131], v[84:87], v[116:119]
    v_mfma_f32_16x16x32_bf16 v[120:123], a[128:131], v[88:91], v[120:123]
    s_waitcnt lgkmcnt(2)
    v_mfma_f32_16x16x32_bf16 v[108:111], a[52:55], v[92:95], v[108:111]
    ds_read_b128 v[84:87], v12 offset:28672
    v_mfma_f32_16x16x32_bf16 v[112:115], a[52:55], v[96:99], v[112:115]
    ds_read_b128 v[88:91], v12 offset:30720
    v_mfma_f32_16x16x32_bf16 v[116:119], a[132:135], v[92:95], v[116:119]
    v_mfma_f32_16x16x32_bf16 v[120:123], a[132:135], v[96:99], v[120:123]
    s_waitcnt lgkmcnt(2)
    v_mfma_f32_16x16x32_bf16 v[108:111], a[56:59], v[100:103], v[108:111]
    ds_read_b128 v[92:95], v11 offset:32768
    v_mfma_f32_16x16x32_bf16 v[112:115], a[56:59], v[104:107], v[112:115]
    ds_read_b128 v[96:99], v11 offset:34816
    v_mfma_f32_16x16x32_bf16 v[116:119], a[136:139], v[100:103], v[116:119]
    v_mfma_f32_16x16x32_bf16 v[120:123], a[136:139], v[104:107], v[120:123]
    s_waitcnt lgkmcnt(2)
    v_mfma_f32_16x16x32_bf16 v[108:111], a[60:63], v[84:87], v[108:111]
    ds_read_b128 v[100:103], v12 offset:32768
    v_mfma_f32_16x16x32_bf16 v[112:115], a[60:63], v[88:91], v[112:115]
    ds_read_b128 v[104:107], v12 offset:34816
    v_mfma_f32_16x16x32_bf16 v[116:119], a[140:143], v[84:87], v[116:119]
    v_mfma_f32_16x16x32_bf16 v[120:123], a[140:143], v[88:91], v[120:123]
    s_waitcnt lgkmcnt(2)
    v_mfma_f32_16x16x32_bf16 v[108:111], a[64:67], v[92:95], v[108:111]
    ds_read_b128 v[84:87], v11 offset:36864
    v_mfma_f32_16x16x32_bf16 v[112:115], a[64:67], v[96:99], v[112:115]
    ds_read_b128 v[88:91], v11 offset:38912
    v_mfma_f32_16x16x32_bf16 v[116:119], a[144:147], v[92:95], v[116:119]
    v_mfma_f32_16x16x32_bf16 v[120:123], a[144:147], v[96:99], v[120:123]
    s_waitcnt lgkmcnt(2)
    v_mfma_f32_16x16x32_bf16 v[108:111], a[68:71], v[100:103], v[108:111]
    ds_read_b128 v[92:95], v12 offset:36864
    v_mfma_f32_16x16x32_bf16 v[112:115], a[68:71], v[104:107], v[112:115]
    ds_read_b128 v[96:99], v12 offset:38912
    v_mfma_f32_16x16x32_bf16 v[116:119], a[148:151], v[100:103], v[116:119]
    v_mfma_f32_16x16x32_bf16 v[120:123], a[148:151], v[104:107], v[120:123]
    s_waitcnt lgkmcnt(0)
    v_mfma_f32_16x16x32_bf16 v[108:111], a[72:75], v[84:87], v[108:111]
    v_add_u32 v11, s49, v11
    v_mfma_f32_16x16x32_bf16 v[112:115], a[72:75], v[88:91], v[112:115]
    v_add_u32 v12, s49, v12
    v_mfma_f32_16x16x32_bf16 v[108:111], a[76:79], v[92:95], v[108:111]
    s_sub_u32 s47, s47, s49
    v_mfma_f32_16x16x32_bf16 v[112:115], a[76:79], v[96:99], v[112:115]
    s_sub_u32 s49, 0, s49
    v_mfma_f32_16x16x32_bf16 v[116:119], a[152:155], v[84:87], v[116:119]
    v_mfma_f32_16x16x32_bf16 v[120:123], a[152:155], v[88:91], v[120:123]
    v_mfma_f32_16x16x32_bf16 v[116:119], a[156:159], v[92:95], v[116:119]
    v_mfma_f32_16x16x32_bf16 v[120:123], a[156:159], v[96:99], v[120:123]
    v_cvt_pk_bf16_f32 v124, v108, v109
    v_cvt_pk_bf16_f32 v125, v110, v111
    v_cvt_pk_bf16_f32 v126, v112, v113
    v_cvt_pk_bf16_f32 v127, v114, v115
    s_nop 0
    v_permlane16_swap_b32 v124, v126
    v_permlane16_swap_b32 v125, v127
    v_cvt_pk_bf16_f32 v128, v116, v117
    v_cvt_pk_bf16_f32 v129, v118, v119
    v_cvt_pk_bf16_f32 v130, v120, v121
    v_cvt_pk_bf16_f32 v131, v122, v123
    s_nop 0
    v_permlane16_swap_b32 v128, v130
    v_permlane16_swap_b32 v129, v131
    buffer_store_dwordx4 v[124:127], v19, s[4:7], s44 offen sc1
    buffer_store_dwordx4 v[128:131], v19, s[4:7], s45 offen sc1
    s_waitcnt vmcnt(2)
    s_branch L_gw_82c
L_gw_82:
    buffer_load_dword v2, v1, s[8:11], 0 offen sc1
    s_sub_u32 s36, s36, 1
    s_cbranch_scc1 L_exit
    s_waitcnt vmcnt(0)
L_gw_82c:
    v_readfirstlane_b32 s90, v2
    s_nop 0
    s_cmp_eq_u32 s90, 0
    s_cbranch_scc1 L_gw_82
    s_waitcnt vmcnt(2) lgkmcnt(0)
    s_barrier
    s_add_u32 s44, s38, 180224
    s_add_u32 s45, s44, s56
    s_mov_b32 s46, 81920
    v_mov_b32 v20, 1
    ds_read_b128 v[84:87], v11 offset:0
    ds_read_b128 v[88:91], v11 offset:2048
    ds_read_b128 v[92:95], v12 offset:0
    ds_read_b128 v[96:99], v12 offset:2048
    s_lshl_b32 s90, s32, 10
    s_add_u32 m0, s90, s47
    s_waitcnt lgkmcnt(2)
    v_mfma_f32_16x16x32_bf16 v[108:111], a[0:3], v[84:87], 0
    ds_read_b128 v[100:103], v11 offset:4096
    v_mfma_f32_16x16x32_bf16 v[112:115], a[0:3], v[88:91], 0
    ds_read_b128 v[104:107], v11 offset:6144
    v_mfma_f32_16x16x32_bf16 v[116:119], a[80:83], v[84:87], 0
    buffer_load_dwordx4 v10, s[24:27], s46 offen offset:0 lds
    s_add_u32 m0, m0, 3968
    v_mfma_f32_16x16x32_bf16 v[120:123], a[80:83], v[88:91], 0
    s_waitcnt lgkmcnt(2)
    v_mfma_f32_16x16x32_bf16 v[108:111], a[4:7], v[92:95], v[108:111]
    ds_read_b128 v[84:87], v12 offset:4096
    v_mfma_f32_16x16x32_bf16 v[112:115], a[4:7], v[96:99], v[112:115]
    ds_read_b128 v[88:91], v12 offset:6144
    v_mfma_f32_16x16x32_bf16 v[116:119], a[84:87], v[92:95], v[116:119]
    buffer_load_dwordx4 v10, s[24:27], s46 offen offset:128 lds
    s_add_u32 m0, m0, 3968
    v_mfma_f32_16x16x32_bf16 v[120:123], a[84:87], v[96:99], v[120:123]
    s_waitcnt lgkmcnt(2)
    v_mfma_f32_16x16x32_bf16 v[108:111], a[8:11], v[100:103], v[108:111]
    ds_read_b128 v[92:95], v11 offset:8192
    v_mfma_f32_16x16x32_bf16 v[112:115], a[8:11], v[104:107], v[112:115]
    ds_read_b128 v[96:99], v11 offset:10240
    v_mfma_f32_16x16x32_bf16 v[116:119], a[88:91], v[100:103], v[116:119]
    buffer_load_dwordx4 v10, s[24:27], s46 offen offset:256 lds
    s_add_u32 m0, m0, 3968
    v_mfma_f32_16x16x32_bf16 v[120:123], a[88:91], v[104:107], v[120:123]
    s_waitcnt lgkmcnt(2)
    v_mfma_f32_16x16x32_bf16 v[108:111], a[12:15], v[84:87], v[108:111]
    ds_read_b128 v[100:103], v12 offset:8192
    v_mfma_f32_16x16x32_bf16 v[112:115], a[12:15], v[88:91], v[112:115]
    ds_read_b128 v[104:107], v12 offset:10240
    v_mfma_f32_16x16x32_bf16 v[116:119], a[92:95], v[84:87], v[116:119]
    buffer_load_dwordx4 v10, s[24:27], s46 offen offset:384 lds
    s_add_u32 m0, m0, 3968
    v_mfma_f32_16x16x32_bf16 v[120:123], a[92:95], v[88:91], v[120:123]
    s_waitcnt lgkmcnt(2)
    v_mfma_f32_16x16x32_bf16 v[108:111], a[16:19], v[92:95], v[108:111]
    ds_read_b128 v[84:87], v11 offset:12288
    v_mfma_f32_16x16x32_bf16 v[112:115], a[16:19], v[96:99], v[112:115]
    ds_read_b128 v[88:91], v11 offset:14336
    v_mfma_f32_16x16x32_bf16 v[116:119], a[96:99], v[92:95], v[116:119]
    buffer_load_dwordx4 v10, s[24:27], s46 offen offset:512 lds
    s_add_u32 m0, m0, 3968
    v_mfma_f32_16x16x32_bf16 v[120:123], a[96:99], v[96:99], v[120:123]
    s_waitcnt lgkmcnt(2)
    v_mfma_f32_16x16x32_bf16 v[108:111], a[20:23], v[100:103], v[108:111]
    ds_read_b128 v[92:95], v12 offset:12288
    v_mfma_f32_16x16x32_bf16 v[112:115], a[20:23], v[104:107], v[112:115]
    ds_read_b128 v[96:99], v12 offset:14336
    v_mfma_f32_16x16x32_bf16 v[116:119], a[100:103], v[100:103], v[116:119]
    s_waitcnt vmcnt(5)
    buffer_store_dword v20, v136, s[4:7], s38 offen sc1
    v_mfma_f32_16x16x32_bf16 v[120:123], a[100:103], v[104:107], v[120:123]
    s_waitcnt lgkmcnt(2)
    v_mfma_f32_16x16x32_bf16 v[108:111], a[24:27], v[84:87], v[108:111]
    ds_read_b128 v[100:103], v11 offset:16384
    v_mfma_f32_16x16x32_bf16 v[112:115], a[24:27], v[88:91], v[112:115]
    ds_read_b128 v[104:107], v11 offset:18432
    v_mfma_f32_16x16x32_bf16 v[116:119], a[104:107], v[84:87], v[116:119]
    buffer_load_dwordx4 v10, s[24:27], s46 offen offset:640 lds
    s_add_u32 m0, m0, 3968
    v_mfma_f32_16x16x32_bf16 v[120:123], a[104:107], v[88:91], v[120:123]
    s_waitcnt lgkmcnt(2)
    v_mfma_f32_16x16x32_bf16 v[108:111], a[28:31], v[92:95], v[108:111]
    ds_read_b128 v[84:87], v12 offset:16384
    v_mfma_f32_16x16x32_bf16 v[112:115], a[28:31], v[96:99], v[112:115]
    ds_read_b128 v[88:91], v12 offset:18432
    v_mfma_f32_16x16x32_bf16 v[116:119], a[108:111], v[92:95], v[116:119]
    buffer_load_dwordx4 v10, s[24:27], s46 offen offset:768 lds
    s_add_u32 m0, m0, 3968
    v_mfma_f32_16x16x32_bf16 v[120:123], a[108:111], v[96:99], v[120:123]
    s_waitcnt lgkmcnt(2)
    v_mfma_f32_16x16x32_bf16 v[108:111], a[32:35], v[100:103], v[108:111]
    ds_read_b128 v[92:95], v11 offset:20480
    v_mfma_f32_16x16x32_bf16 v[112:115], a[32:35], v[104:107], v[112:115]
    ds_read_b128 v[96:99], v11 offset:22528
    v_mfma_f32_16x16x32_bf16 v[116:119], a[112:115], v[100:103], v[116:119]
    buffer_load_dwordx4 v10, s[24:27], s46 offen offset:896 lds
    s_add_u32 m0, m0, 3968
    v_mfma_f32_16x16x32_bf16 v[120:123], a[112:115], v[104:107], v[120:123]
    s_waitcnt lgkmcnt(2)
    v_mfma_f32_16x16x32_bf16 v[108:111], a[36:39], v[84:87], v[108:111]
    ds_read_b128 v[100:103], v12 offset:20480
    v_mfma_f32_16x16x32_bf16 v[112:115], a[36:39], v[88:91], v[112:115]
    ds_read_b128 v[104:107], v12 offset:22528
    v_mfma_f32_16x16x32_bf16 v[116:119], a[116:119], v[84:87], v[116:119]
    buffer_load_dwordx4 v10, s[24:27], s46 offen offset:1024 lds
    s_add_u32 m0, m0, 3968
    v_mfma_f32_16x16x32_bf16 v[120:123], a[116:119], v[88:91], v[120:123]
    s_waitcnt lgkmcnt(2)
    v_mfma_f32_16x16x32_bf16 v[108:111], a[40:43], v[92:95], v[108:111]
    ds_read_b128 v[84:87], v11 offset:24576
    v_mfma_f32_16x16x32_bf16 v[112:115], a[40:43], v[96:99], v[112:115]
    ds_read_b128 v[88:91], v11 offset:26624
    v_mfma_f32_16x16x32_bf16 v[116:119], a[120:123], v[92:95], v[116:119]
    buffer_load_dwordx4 v10, s[24:27], s46 offen offset:1152 lds
    v_mfma_f32_16x16x32_bf16 v[120:123], a[120:123], v[96:99], v[120:123]
    s_waitcnt lgkmcnt(2)
    v_mfma_f32_16x16x32_bf16 v[108:111], a[44:47], v[100:103], v[108:111]
    ds_read_b128 v[92:95], v12 offset:24576
    v_mfma_f32_16x16x32_bf16 v[112:115], a[44:47], v[104:107], v[112:115]
    ds_read_b128 v[96:99], v12 offset:26624
    v_mfma_f32_16x16x32_bf16 v[116:119], a[124:127], v[100:103], v[116:119]
    v_mfma_f32_16x16x32_bf16 v[120:123], a[124:127], v[104:107], v[120:123]
    s_waitcnt lgkmcnt(2)
    v_mfma_f32_16x16x32_bf16 v[108:111], a[48:51], v[84:87], v[108:111]
    ds_read_b128 v[100:103], v11 offset:28672
    v_mfma_f32_16x16x32_bf16 v[112:115], a[48:51], v[88:91], v[112:115]
    ds_read_b128 v[104:107], v11 offset:30720
    v_mfma_f32_16x16x32_bf16 v[116:119], a[128:131], v[84:87], v[116:119]
    v_mfma_f32_16x16x32_bf16 v[120:123], a[128:131], v[88:91], v[120:123]
    s_waitcnt lgkmcnt(2)
    v_mfma_f32_16x16x32_bf16 v[108:111], a[52:55], v[92:95], v[108:111]
    ds_read_b128 v[84:87], v12 offset:28672
    v_mfma_f32_16x16x32_bf16 v[112:115], a[52:55], v[96:99], v[112:115]
    ds_read_b128 v[88:91], v12 offset:30720
    v_mfma_f32_16x16x32_bf16 v[116:119], a[132:135], v[92:95], v[116:119]
    v_mfma_f32_16x16x32_bf16 v[120:123], a[132:135], v[96:99], v[120:123]
    s_waitcnt lgkmcnt(2)
    v_mfma_f32_16x16x32_bf16 v[108:111], a[56:59], v[100:103], v[108:111]
    ds_read_b128 v[92:95], v11 offset:32768
    v_mfma_f32_16x16x32_bf16 v[112:115], a[56:59], v[104:107], v[112:115]
    ds_read_b128 v[96:99], v11 offset:34816
    v_mfma_f32_16x16x32_bf16 v[116:119], a[136:139], v[100:103], v[116:119]
    v_mfma_f32_16x16x32_bf16 v[120:123], a[136:139], v[104:107], v[120:123]
    s_waitcnt lgkmcnt(2)
    v_mfma_f32_16x16x32_bf16 v[108:111], a[60:63], v[84:87], v[108:111]
    ds_read_b128 v[100:103], v12 offset:32768
    v_mfma_f32_16x16x32_bf16 v[112:115], a[60:63], v[88:91], v[112:115]
    ds_read_b128 v[104:107], v12 offset:34816
    v_mfma_f32_16x16x32_bf16 v[116:119], a[140:143], v[84:87], v[116:119]
    v_mfma_f32_16x16x32_bf16 v[120:123], a[140:143], v[88:91], v[120:123]
    s_waitcnt lgkmcnt(2)
    v_mfma_f32_16x16x32_bf16 v[108:111], a[64:67], v[92:95], v[108:111]
    ds_read_b128 v[84:87], v11 offset:36864
    v_mfma_f32_16x16x32_bf16 v[112:115], a[64:67], v[96:99], v[112:115]
    ds_read_b128 v[88:91], v11 offset:38912
    v_mfma_f32_16x16x32_bf16 v[116:119], a[144:147], v[92:95], v[116:119]
    v_mfma_f32_16x16x32_bf16 v[120:123], a[144:147], v[96:99], v[120:123]
    s_waitcnt lgkmcnt(2)
    v_mfma_f32_16x16x32_bf16 v[108:111], a[68:71], v[100:103], v[108:111]
    ds_read_b128 v[92:95], v12 offset:36864
    v_mfma_f32_16x16x32_bf16 v[112:115], a[68:71], v[104:107], v[112:115]
    ds_read_b128 v[96:99], v12 offset:38912
    v_mfma_f32_16x16x32_bf16 v[116:119], a[148:151], v[100:103], v[116:119]
    v_mfma_f32_16x16x32_bf16 v[120:123], a[148:151], v[104:107], v[120:123]
    s_waitcnt lgkmcnt(0)
    v_mfma_f32_16x16x32_bf16 v[108:111], a[72:75], v[84:87], v[108:111]
    v_add_u32 v11, s49, v11
    v_mfma_f32_16x16x32_bf16 v[112:115], a[72:75], v[88:91], v[112:115]
    v_add_u32 v12, s49, v12
    v_mfma_f32_16x16x32_bf16 v[108:111], a[76:79], v[92:95], v[108:111]
    s_sub_u32 s47, s47, s49
    v_mfma_f32_16x16x32_bf16 v[112:115], a[76:79], v[96:99], v[112:115]
    s_sub_u32 s49, 0, s49
    v_mfma_f32_16x16x32_bf16 v[116:119], a[152:155], v[84:87], v[116:119]
    v_mfma_f32_16x16x32_bf16 v[120:123], a[152:155], v[88:91], v[120:123]
    v_mfma_f32_16x16x32_bf16 v[116:119], a[156:159], v[92:95], v[116:119]
    v_mfma_f32_16x16x32_bf16 v[120:123], a[156:159], v[96:99], v[120:123]
    v_cvt_pk_bf16_f32 v124, v108, v109
    v_cvt_pk_bf16_f32 v125, v110, v111
    v_cvt_pk_bf16_f32 v126, v112, v113
    v_cvt_pk_bf16_f32 v127, v114, v115
    s_nop 0
    v_permlane16_swap_b32 v124, v126
    v_permlane16_swap_b32 v125, v127
    v_cvt_pk_bf16_f32 v128, v116, v117
    v_cvt_pk_bf16_f32 v129, v118, v119
    v_cvt_pk_bf16_f32 v130, v120, v121
    v_cvt_pk_bf16_f32 v131, v122, v123
    s_nop 0
    v_permlane16_swap_b32 v128, v130
    v_permlane16_swap_b32 v129, v131
    buffer_store_dwordx4 v[124:127], v19, s[4:7], s44 offen sc1
    buffer_store_dwordx4 v[128:131], v19, s[4:7], s45 offen sc1
    s_waitcnt vmcnt(2) lgkmcnt(0)
    s_barrier
    s_add_u32 s44, s38, 294912
    s_add_u32 s45, s44, s56
    s_mov_b32 s46, 122880
    v_mov_b32 v20, 2
    ds_read_b128 v[84:87], v11 offset:0
    ds_read_b128 v[88:91], v11 offset:2048
    ds_read_b128 v[92:95], v12 offset:0
    ds_read_b128 v[96:99], v12 offset:2048
    s_lshl_b32 s90, s32, 10
    s_add_u32 m0, s90, s47
    s_waitcnt lgkmcnt(2)
    v_mfma_f32_16x16x32_bf16 v[108:111], a[0:3], v[84:87], 0
    ds_read_b128 v[100:103], v11 offset:4096
    s_add_u32 s51, s37, 3
    v_mfma_f32_16x16x32_bf16 v[112:115], a[0:3], v[88:91], 0
    ds_read_b128 v[104:107], v11 offset:6144
    s_and_b32 s50, s51, 3
    v_mfma_f32_16x16x32_bf16 v[116:119], a[80:83], v[84:87], 0
    buffer_load_dwordx4 v10, s[24:27], s46 offen offset:0 lds
    s_add_u32 m0, m0, 3968
    v_mfma_f32_16x16x32_bf16 v[120:123], a[80:83], v[88:91], 0
    s_waitcnt lgkmcnt(2)
    s_mul_i32 s50, s50, 114688
    v_mfma_f32_16x16x32_bf16 v[108:111], a[4:7], v[92:95], v[108:111]
    ds_read_b128 v[84:87], v12 offset:4096
    s_add_u32 s50, s50, 65536
    v_mfma_f32_16x16x32_bf16 v[112:115], a[4:7], v[96:99], v[112:115]
    ds_read_b128 v[88:91], v12 offset:6144
    s_add_u32 s44, s38, s50
    v_mfma_f32_16x16x32_bf16 v[116:119], a[84:87], v[92:95], v[116:119]
    buffer_load_dwordx4 v10, s[24:27], s46 offen offset:128 lds
    s_add_u32 m0, m0, 3968
    v_mfma_f32_16x16x32_bf16 v[120:123], a[84:87], v[96:99], v[120:123]
    s_waitcnt lgkmcnt(2)
    s_add_u32 s45, s44, s56
    v_mfma_f32_16x16x32_bf16 v[108:111], a[8:11], v[100:103], v[108:111]
    ds_read_b128 v[92:95], v11 offset:8192
    s_add_u32 s37, s37, 1
    v_mfma_f32_16x16x32_bf16 v[112:115], a[8:11], v[104:107], v[112:115]
    ds_read_b128 v[96:99], v11 offset:10240
    s_mov_b32 s52, 0
    v_mfma_f32_16x16x32_bf16 v[116:119], a[88:91], v[100:103], v[116:119]
    buffer_load_dwordx4 v10, s[24:27], s46 offen offset:256 lds
    s_add_u32 m0, m0, 3968
    v_mfma_f32_16x16x32_bf16 v[120:123], a[88:91], v[104:107], v[120:123]
    s_waitcnt lgkmcnt(2)
    s_and_b32 s50, s37, 3
    v_mfma_f32_16x16x32_bf16 v[108:111], a[12:15], v[84:87], v[108:111]
    ds_read_b128 v[100:103], v12 offset:8192
    s_mul_i32 s51, s50, 114688
    v_mfma_f32_16x16x32_bf16 v[112:115], a[12:15], v[88:91], v[112:115]
    ds_read_b128 v[104:107], v12 offset:10240
    s_add_u32 s41, s38, s51
    v_mfma_f32_16x16x32_bf16 v[116:119], a[92:95], v[84:87], v[116:119]
    buffer_load_dwordx4 v10, s[24:27], s46 offen offset:384 lds
    s_add_u32 m0, m0, 3968
    v_mfma_f32_16x16x32_bf16 v[120:123], a[92:95], v[88:91], v[120:123]
    s_waitcnt lgkmcnt(2)
    v_mfma_f32_16x16x32_bf16 v[108:111], a[16:19], v[92:95], v[108:111]
    ds_read_b128 v[84:87], v11 offset:12288
    v_mfma_f32_16x16x32_bf16 v[112:115], a[16:19], v[96:99], v[112:115]
    ds_read_b128 v[88:91], v11 offset:14336
    v_mfma_f32_16x16x32_bf16 v[116:119], a[96:99], v[92:95], v[116:119]
    buffer_load_dwordx4 v10, s[24:27], s46 offen offset:512 lds
    s_add_u32 m0, m0, 3968
    v_mfma_f32_16x16x32_bf16 v[120:123], a[96:99], v[96:99], v[120:123]
    s_waitcnt lgkmcnt(2)
    v_mfma_f32_16x16x32_bf16 v[108:111], a[20:23], v[100:103], v[108:111]
    ds_read_b128 v[92:95], v12 offset:12288
    v_mfma_f32_16x16x32_bf16 v[112:115], a[20:23], v[104:107], v[112:115]
    ds_read_b128 v[96:99], v12 offset:14336
    v_mfma_f32_16x16x32_bf16 v[116:119], a[100:103], v[100:103], v[116:119]
    s_waitcnt vmcnt(5)
    buffer_store_dword v20, v136, s[4:7], s38 offen sc1
    v_mfma_f32_16x16x32_bf16 v[120:123], a[100:103], v[104:107], v[120:123]
    s_waitcnt lgkmcnt(2)
    v_mfma_f32_16x16x32_bf16 v[108:111], a[24:27], v[84:87], v[108:111]
    ds_read_b128 v[100:103], v11 offset:16384
    v_mfma_f32_16x16x32_bf16 v[112:115], a[24:27], v[88:91], v[112:115]
    ds_read_b128 v[104:107], v11 offset:18432
    v_mfma_f32_16x16x32_bf16 v[116:119], a[104:107], v[84:87], v[116:119]
    buffer_load_dwordx4 v10, s[24:27], s46 offen offset:640 lds
    s_add_u32 m0, m0, 3968
    v_mfma_f32_16x16x32_bf16 v[120:123], a[104:107], v[88:91], v[120:123]
    s_waitcnt lgkmcnt(2)
    v_mfma_f32_16x16x32_bf16 v[108:111], a[28:31], v[92:95], v[108:111]
    ds_read_b128 v[84:87], v12 offset:16384
    v_mfma_f32_16x16x32_bf16 v[112:115], a[28:31], v[96:99], v[112:115]
    ds_read_b128 v[88:91], v12 offset:18432
    v_mfma_f32_16x16x32_bf16 v[116:119], a[108:111], v[92:95], v[116:119]
    buffer_load_dwordx4 v10, s[24:27], s46 offen offset:768 lds
    s_add_u32 m0, m0, 3968
    v_mfma_f32_16x16x32_bf16 v[120:123], a[108:111], v[96:99], v[120:123]
    s_waitcnt lgkmcnt(2)
    v_mfma_f32_16x16x32_bf16 v[108:111], a[32:35], v[100:103], v[108:111]
    ds_read_b128 v[92:95], v11 offset:20480
    v_mfma_f32_16x16x32_bf16 v[112:115], a[32:35], v[104:107], v[112:115]
    ds_read_b128 v[96:99], v11 offset:22528
    v_mfma_f32_16x16x32_bf16 v[116:119], a[112:115], v[100:103], v[116:119]
    buffer_load_dwordx4 v10, s[24:27], s46 offen offset:896 lds
    s_add_u32 m0, m0, 3968
    v_mfma_f32_16x16x32_bf16 v[120:123], a[112:115], v[104:107], v[120:123]
    s_waitcnt lgkmcnt(2)
    v_mfma_f32_16x16x32_bf16 v[108:111], a[36:39], v[84:87], v[108:111]
    ds_read_b128 v[100:103], v12 offset:20480
    v_mfma_f32_16x16x32_bf16 v[112:115], a[36:39], v[88:91], v[112:115]
    ds_read_b128 v[104:107], v12 offset:22528
    v_mfma_f32_16x16x32_bf16 v[116:119], a[116:119], v[84:87], v[116:119]
    buffer_load_dwordx4 v10, s[24:27], s46 offen offset:1024 lds
    s_add_u32 m0, m0, 3968
    v_mfma_f32_16x16x32_bf16 v[120:123], a[116:119], v[88:91], v[120:123]
    s_waitcnt lgkmcnt(2)
    v_mfma_f32_16x16x32_bf16 v[108:111], a[40:43], v[92:95], v[108:111]
    ds_read_b128 v[84:87], v11 offset:24576
    v_mfma_f32_16x16x32_bf16 v[112:115], a[40:43], v[96:99], v[112:115]
    ds_read_b128 v[88:91], v11 offset:26624
    v_mfma_f32_16x16x32_bf16 v[116:119], a[120:123], v[92:95], v[116:119]
    buffer_load_dwordx4 v10, s[24:27], s46 offen offset:1152 lds
    v_mfma_f32_16x16x32_bf16 v[120:123], a[120:123], v[96:99], v[120:123]
    s_waitcnt lgkmcnt(2)
    v_mfma_f32_16x16x32_bf16 v[108:111], a[44:47], v[100:103], v[108:111]
    ds_read_b128 v[92:95], v12 offset:24576
    v_mfma_f32_16x16x32_bf16 v[112:115], a[44:47], v[104:107], v[112:115]
    ds_read_b128 v[96:99], v12 offset:26624
    v_mfma_f32_16x16x32_bf16 v[116:119], a[124:127], v[100:103], v[116:119]
    v_mfma_f32_16x16x32_bf16 v[120:123], a[124:127], v[104:107], v[120:123]
    s_waitcnt lgkmcnt(2)
    v_mfma_f32_16x16x32_bf16 v[108:111], a[48:51], v[84:87], v[108:111]
    ds_read_b128 v[100:103], v11 offset:28672
    v_mfma_f32_16x16x32_bf16 v[112:115], a[48:51], v[88:91], v[112:115]
    ds_read_b128 v[104:107], v11 offset:30720
    v_mfma_f32_16x16x32_bf16 v[116:119], a[128:131], v[84:87], v[116:119]
    v_mfma_f32_16x16x32_bf16 v[120:123], a[128:131], v[88:91], v[120:123]
    s_waitcnt lgkmcnt(2)
    v_mfma_f32_16x16x32_bf16 v[108:111], a[52:55], v[92:95], v[108:111]
    ds_read_b128 v[84:87], v12 offset:28672
    v_mfma_f32_16x16x32_bf16 v[112:115], a[52:55], v[96:99], v[112:115]
    ds_read_b128 v[88:91], v12 offset:30720
    v_mfma_f32_16x16x32_bf16 v[116:119], a[132:135], v[92:95], v[116:119]
    v_mfma_f32_16x16x32_bf16 v[120:123], a[132:135], v[96:99], v[120:123]
    s_waitcnt lgkmcnt(2)
    v_mfma_f32_16x16x32_bf16 v[108:111], a[56:59], v[100:103], v[108:111]
    ds_read_b128 v[92:95], v11 offset:32768
    v_mfma_f32_16x16x32_bf16 v[112:115], a[56:59], v[104:107], v[112:115]
    ds_read_b128 v[96:99], v11 offset:34816
    v_mfma_f32_16x16x32_bf16 v[116:119], a[136:139], v[100:103], v[116:119]
    v_mfma_f32_16x16x32_bf16 v[120:123], a[136:139], v[104:107], v[120:123]
    s_waitcnt lgkmcnt(2)
    v_mfma_f32_16x16x32_bf16 v[108:111], a[60:63], v[84:87], v[108:111]
    ds_read_b128 v[100:103], v12 offset:32768
    v_mfma_f32_16x16x32_bf16 v[112:115], a[60:63], v[88:91], v[112:115]
    ds_read_b128 v[104:107], v12 offset:34816
    v_mfma_f32_16x16x32_bf16 v[116:119], a[140:143], v[84:87], v[116:119]
    v_mfma_f32_16x16x32_bf16 v[120:123], a[140:143], v[88:91], v[120:123]
    s_waitcnt lgkmcnt(2)
    v_mfma_f32_16x16x32_bf16 v[108:111], a[64:67], v[92:95], v[108:111]
    ds_read_b128 v[84:87], v11 offset:36864
    v_mfma_f32_16x16x32_bf16 v[112:115], a[64:67], v[96:99], v[112:115]
    ds_read_b128 v[88:91], v11 offset:38912
    v_mfma_f32_16x16x32_bf16 v[116:119], a[144:147], v[92:95], v[116:119]
    v_mfma_f32_16x16x32_bf16 v[120:123], a[144:147], v[96:99], v[120:123]
    s_waitcnt lgkmcnt(2)
    v_mfma_f32_16x16x32_bf16 v[108:111], a[68:71], v[100:103], v[108:111]
    ds_read_b128 v[92:95], v12 offset:36864
    v_mfma_f32_16x16x32_bf16 v[112:115], a[68:71], v[104:107], v[112:115]
    ds_read_b128 v[96:99], v12 offset:38912
    v_mfma_f32_16x16x32_bf16 v[116:119], a[148:151], v[100:103], v[116:119]
    v_mfma_f32_16x16x32_bf16 v[120:123], a[148:151], v[104:107], v[120:123]
    s_waitcnt lgkmcnt(0)
    v_mfma_f32_16x16x32_bf16 v[108:111], a[72:75], v[84:87], v[108:111]
    v_add_u32 v11, s49, v11
    v_mfma_f32_16x16x32_bf16 v[112:115], a[72:75], v[88:91], v[112:115]
    v_add_u32 v12, s49, v12
    v_mfma_f32_16x16x32_bf16 v[108:111], a[76:79], v[92:95], v[108:111]
    s_sub_u32 s47, s47, s49
    v_mfma_f32_16x16x32_bf16 v[112:115], a[76:79], v[96:99], v[112:115]
    s_sub_u32 s49, 0, s49
    v_mfma_f32_16x16x32_bf16 v[116:119], a[152:155], v[84:87], v[116:119]
    v_mfma_f32_16x16x32_bf16 v[120:123], a[152:155], v[88:91], v[120:123]
    v_mfma_f32_16x16x32_bf16 v[116:119], a[156:159], v[92:95], v[116:119]
    v_mfma_f32_16x16x32_bf16 v[120:123], a[156:159], v[96:99], v[120:123]
    v_cvt_pk_bf16_f32 v124, v108, v109
    v_cvt_pk_bf16_f32 v125, v110, v111
    v_cvt_pk_bf16_f32 v126, v112, v113
    v_cvt_pk_bf16_f32 v127, v114, v115
    s_nop 0
    v_permlane16_swap_b32 v124, v126
    v_permlane16_swap_b32 v125, v127
    v_cvt_pk_bf16_f32 v128, v116, v117
    v_cvt_pk_bf16_f32 v129, v118, v119
    v_cvt_pk_bf16_f32 v130, v120, v121
    v_cvt_pk_bf16_f32 v131, v122, v123
    s_nop 0
    v_permlane16_swap_b32 v128, v130
    v_permlane16_swap_b32 v129, v131
    buffer_store_dwordx4 v[124:127], v19, s[4:7], s44 offen sc1
    buffer_store_dwordx4 v[128:131], v19, s[4:7], s45 offen sc1
    s_add_u32 s50, s37, 2
    s_and_b32 s50, s50, 3
    s_mul_i32 s50, s50, 114688
    s_add_u32 s42, s38, s50
    s_add_u32 s50, s37, 4
    s_min_u32 s50, s50, 63
    s_mul_i32 s46, s50, 40960
    s_add_u32 s51, s37, 1
    v_mov_b32 v20, s51
    s_mov_b32 m0, s48
    v_mov_b32 v68, 0
    v_mov_b32 v69, 0
    v_mov_b32 v70, 0
    v_mov_b32 v71, 0
    v_mov_b32 v72, 0
    v_mov_b32 v73, 0
    v_mov_b32 v74, 0
    v_mov_b32 v75, 0
    s_add_u32 s50, s37, 6
    s_min_u32 s50, s50, 63
    s_mul_i32 s57, s50, 40960
    s_and_b32 s50, s37, 3
    s_mul_i32 s51, s50, 40960
    s_add_u32 s43, s51, s38
    s_mul_i32 s51, s50, 327680
    s_add_u32 s53, s51, 4194304
    s_xor_b32 s50, s50, 2
    s_mul_i32 s51, s50, 327680
    s_add_u32 s54, s51, 4194304
    s_sub_u32 s51, s37, 6
    s_mul_i32 s60, s51, 81920
    s_branch L_v_first_s
L_v_loop_s:
    s_add_u32 s50, s37, 2
    s_and_b32 s50, s50, 3
    s_mul_i32 s50, s50, 114688
    s_add_u32 s42, s38, s50
    s_add_u32 s50, s37, 4
    s_min_u32 s50, s50, 63
    s_mul_i32 s46, s50, 40960
    s_add_u32 s51, s37, 1
    v_mov_b32 v20, s51
    s_mov_b32 m0, s48
    v_mov_b32 v68, 0
    v_mov_b32 v69, 0
    v_mov_b32 v70, 0
    v_mov_b32 v71, 0
    v_mov_b32 v72, 0
    v_mov_b32 v73, 0
    v_mov_b32 v74, 0
    v_mov_b32 v75, 0
    s_add_u32 s50, s37, 6
    s_min_u32 s50, s50, 63
    s_mul_i32 s57, s50, 40960
    s_and_b32 s50, s37, 3
    s_mul_i32 s51, s50, 40960
    s_add_u32 s43, s51, s38
    s_mul_i32 s51, s50, 327680
    s_add_u32 s53, s51, 4194304
    s_xor_b32 s50, s50, 2
    s_mul_i32 s51, s50, 327680
    s_add_u32 s54, s51, 4194304
    s_sub_u32 s51, s37, 6
    s_mul_i32 s60, s51, 81920
L_vg_83:
    buffer_load_dword v139, v138, s[4:7], s38 offen sc1
    s_sub_u32 s36, s36, 1
    s_cbranch_scc1 L_exit
    s_waitcnt vmcnt(0)
    v_cmp_gt_u32 vcc, s37, v139
    s_cbranch_vccnz L_vg_83
L_v_first_s:
    buffer_load_dwordx4 v13, s[4:7], s41 offen sc1 lds
    buffer_load_dwordx4 v13, s[4:7], s41 offen offset:1024 sc1 lds
    buffer_load_dword v14, s[4:7], s41 offen offset:2048 sc1 lds
    buffer_load_dword v14, s[4:7], s41 offen offset:2304 sc1 lds
L_poll_85:
    buffer_load_dwordx4 v13, s[4:7], s41 offen sc1 lds
    buffer_load_dwordx4 v13, s[4:7], s41 offen offset:1024 sc1 lds
    buffer_load_dword v14, s[4:7], s41 offen offset:2048 sc1 lds
    buffer_load_dword v14, s[4:7], s41 offen offset:2304 sc1 lds
    s_sub_u32 s36, s36, 1
    s_cbranch_scc1 L_exit
    s_waitcnt vmcnt(4)
    ds_read_b32 v18, v15
    s_waitcnt lgkmcnt(0)
    v_cmp_eq_u32 vcc, -1, v18
    s_cbranch_vccnz L_poll_85
    s_barrier
    ds_read_b128 v[28:31], v16 offset:0
    ds_read_b128 v[32:35], v16 offset:1024
    ds_read_b128 v[36:39], v16 offset:2048
    ds_read_b128 v[40:43], v16 offset:3072
    s_waitcnt lgkmcnt(3)
    v_smfmac_f32_16x16x64_bf16 v[68:71], v[28:31], a[0:7], v17
    ds_read_b128 v[44:47], v16 offset:4096
    v_smfmac_f32_16x16x64_bf16 v[72:75], v[28:31], a[80:87], v17
    ds_read_b128 v[48:51], v16 offset:5120
    s_waitcnt lgkmcnt(4)
    v_smfmac_f32_16x16x64_bf16 v[68:71], v[32:35], a[8:15], v17
    ds_read_b128 v[52:55], v16 offset:6144
    v_smfmac_f32_16x16x64_bf16 v[72:75], v[32:35], a[88:95], v17
    ds_read_b128 v[56:59], v16 offset:7168
    s_waitcnt lgkmcnt(5)
    v_smfmac_f32_16x16x64_bf16 v[68:71], v[36:39], a[16:23], v17
    ds_read_b128 v[60:63], v16 offset:8192
    v_smfmac_f32_16x16x64_bf16 v[72:75], v[36:39], a[96:103], v17
    ds_read_b128 v[64:67], v16 offset:9216
    s_waitcnt lgkmcnt(6)
    v_smfmac_f32_16x16x64_bf16 v[68:71], v[40:43], a[24:31], v17
    v_smfmac_f32_16x16x64_bf16 v[72:75], v[40:43], a[104:111], v17
    s_waitcnt lgkmcnt(5)
    v_smfmac_f32_16x16x64_bf16 v[68:71], v[44:47], a[32:39], v17
    v_smfmac_f32_16x16x64_bf16 v[72:75], v[44:47], a[112:119], v17
    s_waitcnt lgkmcnt(4)
    v_smfmac_f32_16x16x64_bf16 v[68:71], v[48:51], a[40:47], v17
    s_waitcnt lgkmcnt(3)
    v_smfmac_f32_16x16x64_bf16 v[68:71], v[52:55], a[48:55], v17
    s_waitcnt lgkmcnt(2)
    v_smfmac_f32_16x16x64_bf16 v[68:71], v[56:59], a[56:63], v17
    s_waitcnt lgkmcnt(1)
    v_smfmac_f32_16x16x64_bf16 v[68:71], v[60:63], a[64:71], v17
    s_waitcnt lgkmcnt(0)
    v_smfmac_f32_16x16x64_bf16 v[68:71], v[64:67], a[72:79], v17
L_redo_84:
    v_smfmac_f32_16x16x64_bf16 v[72:75], v[48:51], a[120:127], v17
    v_smfmac_f32_16x16x64_bf16 v[72:75], v[52:55], a[128:135], v17
    buffer_store_dword v20, v21, s[4:7], s38 offen offset:0 sc1
    v_smfmac_f32_16x16x64_bf16 v[72:75], v[56:59], a[136:143], v17
    v_add_f32 v68, v68, v70
    v_add_f32 v69, v69, v71
    v_smfmac_f32_16x16x64_bf16 v[72:75], v[60:63], a[144:151], v17
    v_cmp_u_f32 vcc, v68, v69
    v_cvt_pk_bf16_f32 v132, v68, v69
    v_smfmac_f32_16x16x64_bf16 v[72:75], v[64:67], a[152:159], v17
    s_cbranch_vccnz L_nan_86
L_cont_87:
    buffer_store_dword v132, v134, s[4:7], s41 offen offset:0 sc1
    s_nop 5
    v_pk_add_f32 v[72:73], v[72:73], v[74:75]
    v_cvt_pk_bf16_f32 v133, v72, v73
    buffer_store_dword v133, v134, s[4:7], s41 offen offset:1024 sc1
    buffer_store_dword v20, v21, s[4:7], s38 offen offset:32 sc1
    ds_read_b128 v[84:87], v11 offset:0
    ds_read_b128 v[88:91], v11 offset:2048
    ds_read_b128 v[92:95], v12 offset:0
    ds_read_b128 v[96:99], v12 offset:2048
    s_cmp_eq_u32 s37, 63
    s_cbranch_scc1 L_end_88
    s_cmp_eq_u32 s37, 0
    s_cbranch_scc1 L_sd_89c
L_sd_89:
    s_cmp_lg_u32 s55, 0
    s_cbranch_scc1 L_an_90x
    buffer_load_dword v139, v142, s[4:7], s38 offen sc1
    buffer_load_dword v139, v142, s[4:7], s38 offen sc1
    buffer_load_dword v139, v142, s[4:7], s38 offen sc1
    buffer_load_dword v139, v142, s[4:7], s38 offen sc1
    buffer_load_dword v139, v142, s[4:7], s38 offen sc1
    buffer_load_dword v139, v142, s[4:7], s38 offen sc1
L_sp_91:
    s_waitcnt vmcnt(5)
    v_cmp_ge_u32 vcc, s37, v139
    buffer_load_dword v139, v142, s[4:7], s38 offen sc1
    s_sub_u32 s36, s36, 1
    s_cbranch_scc1 L_exit
    s_cbranch_vccz L_sp_91x
    s_waitcnt vmcnt(5)
    v_cmp_ge_u32 vcc, s37, v139
    buffer_load_dword v139, v142, s[4:7], s38 offen sc1
    s_cbranch_vccz L_sp_91x
    s_waitcnt vmcnt(5)
    v_cmp_ge_u32 vcc, s37, v139
    buffer_load_dword v139, v142, s[4:7], s38 offen sc1
    s_cbranch_vccz L_sp_91x
    s_waitcnt vmcnt(5)
    v_cmp_ge_u32 vcc, s37, v139
    buffer_load_dword v139, v142, s[4:7], s38 offen sc1
    s_cbranch_vccnz L_sp_91
L_sp_91x:
L_an_90x:
    s_barrier
    s_lshl_b32 s90, s32, 10
    s_add_u32 m0, s90, s47
    s_waitcnt lgkmcnt(2)
    v_mfma_f32_16x16x32_bf16 v[108:111], a[0:3], v[84:87], 0
    ds_read_b128 v[100:103], v11 offset:4096
    s_add_u32 s51, s37, 3
    v_mfma_f32_16x16x32_bf16 v[112:115], a[0:3], v[88:91], 0
    ds_read_b128 v[104:107], v11 offset:6144
    s_and_b32 s50, s51, 3
    v_mfma_f32_16x16x32_bf16 v[116:119], a[80:83], v[84:87], 0
    buffer_load_dwordx4 v[148:151], v146, s[4:7], s43 offen offset:0 sc1
    buffer_load_dwordx4 v[152:155], v146, s[4:7], s43 offen offset:1024 sc1
    v_mfma_f32_16x16x32_bf16 v[120:123], a[80:83], v[88:91], 0
    s_waitcnt lgkmcnt(2)
    s_mul_i32 s50, s50, 114688
    v_mfma_f32_16x16x32_bf16 v[108:111], a[4:7], v[92:95], v[108:111]
    ds_read_b128 v[84:87], v12 offset:4096
    s_add_u32 s50, s50, 65536
    v_mfma_f32_16x16x32_bf16 v[112:115], a[4:7], v[96:99], v[112:115]
    ds_read_b128 v[88:91], v12 offset:6144
    s_add_u32 s44, s38, s50
    v_mfma_f32_16x16x32_bf16 v[116:119], a[84:87], v[92:95], v[116:119]
    s_cmp_lt_i32 s60, 0
    s_cselect_b32 s54, s38, s54
    buffer_load_dwordx4 v[156:159], v144, s[4:7], s54 offen offset:0 sc1
    buffer_load_dwordx4 v[160:163], v144, s[4:7], s54 offen offset:1024 sc1
    v_mfma_f32_16x16x32_bf16 v[120:123], a[84:87], v[96:99], v[120:123]
    s_waitcnt lgkmcnt(2)
    s_add_u32 s45, s44, s56
    v_mfma_f32_16x16x32_bf16 v[108:111], a[8:11], v[100:103], v[108:111]
    ds_read_b128 v[92:95], v11 offset:8192
    s_add_u32 s37, s37, 1
    v_mfma_f32_16x16x32_bf16 v[112:115], a[8:11], v[104:107], v[112:115]
    ds_read_b128 v[96:99], v11 offset:10240
    s_mov_b32 s52, 0
    v_mfma_f32_16x16x32_bf16 v[116:119], a[88:91], v[100:103], v[116:119]
    s_and_b32 s50, s37, 3
    s_mul_i32 s51, s50, 114688
    v_mfma_f32_16x16x32_bf16 v[120:123], a[88:91], v[104:107], v[120:123]
    s_waitcnt lgkmcnt(2)
    s_add_u32 s41, s38, s51
    v_mfma_f32_16x16x32_bf16 v[108:111], a[12:15], v[84:87], v[108:111]
    ds_read_b128 v[100:103], v12 offset:8192
    v_mfma_f32_16x16x32_bf16 v[112:115], a[12:15], v[88:91], v[112:115]
    ds_read_b128 v[104:107], v12 offset:10240
    v_mfma_f32_16x16x32_bf16 v[116:119], a[92:95], v[84:87], v[116:119]
    buffer_load_dwordx4 v[248:251], v137, s[24:27], s57 offen offset:0
    buffer_load_dwordx4 v[248:251], v137, s[24:27], s57 offen offset:1024
    v_mfma_f32_16x16x32_bf16 v[120:123], a[92:95], v[88:91], v[120:123]
    s_waitcnt lgkmcnt(2)
    v_mfma_f32_16x16x32_bf16 v[108:111], a[16:19], v[92:95], v[108:111]
    ds_read_b128 v[84:87], v11 offset:12288
    v_mfma_f32_16x16x32_bf16 v[112:115], a[16:19], v[96:99], v[112:115]
    ds_read_b128 v[88:91], v11 offset:14336
    v_mfma_f32_16x16x32_bf16 v[116:119], a[96:99], v[92:95], v[116:119]
    buffer_store_dword v20, v140, s[4:7], 0 offen sc1
    v_mfma_f32_16x16x32_bf16 v[120:123], a[96:99], v[96:99], v[120:123]
    s_waitcnt lgkmcnt(2)
    v_mfma_f32_16x16x32_bf16 v[108:111], a[20:23], v[100:103], v[108:111]
    ds_read_b128 v[92:95], v12 offset:12288
    v_mfma_f32_16x16x32_bf16 v[112:115], a[20:23], v[104:107], v[112:115]
    ds_read_b128 v[96:99], v12 offset:14336
    v_mfma_f32_16x16x32_bf16 v[116:119], a[100:103], v[100:103], v[116:119]
    s_waitcnt vmcnt(4)
    s_cmp_lt_i32 s60, -245760
    s_cbranch_scc1 L_fw_92c
L_fw_92:
    buffer_store_dwordx4 v[148:151], v143, s[4:7], s53 offen offset:0 sc1
    buffer_store_dwordx4 v[152:155], v143, s[4:7], s53 offen offset:1024 sc1
    v_mfma_f32_16x16x32_bf16 v[120:123], a[100:103], v[104:107], v[120:123]
    s_waitcnt lgkmcnt(2)
    v_mfma_f32_16x16x32_bf16 v[108:111], a[24:27], v[84:87], v[108:111]
    buffer_store_dword v20, v141, s[4:7], 0 offen sc1
    ds_read_b128 v[100:103], v11 offset:16384
    v_mfma_f32_16x16x32_bf16 v[112:115], a[24:27], v[88:91], v[112:115]
    ds_read_b128 v[104:107], v11 offset:18432
    v_mfma_f32_16x16x32_bf16 v[116:119], a[104:107], v[84:87], v[116:119]
    v_mfma_f32_16x16x32_bf16 v[120:123], a[104:107], v[88:91], v[120:123]
    s_waitcnt lgkmcnt(2)
    v_mfma_f32_16x16x32_bf16 v[108:111], a[28:31], v[92:95], v[108:111]
    ds_read_b128 v[84:87], v12 offset:16384
    v_mfma_f32_16x16x32_bf16 v[112:115], a[28:31], v[96:99], v[112:115]
    ds_read_b128 v[88:91], v12 offset:18432
    v_mfma_f32_16x16x32_bf16 v[116:119], a[108:111], v[92:95], v[116:119]
    buffer_store_dword v22, v135, s[4:7], s42 offen offset:0 sc1
    buffer_store_dword v22, v135, s[4:7], s42 offen offset:1024 sc1
    v_mfma_f32_16x16x32_bf16 v[120:123], a[108:111], v[96:99], v[120:123]
    s_waitcnt lgkmcnt(2)
    v_mfma_f32_16x16x32_bf16 v[108:111], a[32:35], v[100:103], v[108:111]
    ds_read_b128 v[92:95], v11 offset:20480
    v_mfma_f32_16x16x32_bf16 v[112:115], a[32:35], v[104:107], v[112:115]
    ds_read_b128 v[96:99], v11 offset:22528
    v_mfma_f32_16x16x32_bf16 v[116:119], a[112:115], v[100:103], v[116:119]
    buffer_load_dwordx4 v10, s[24:27], s46 offen offset:0 lds
    s_add_u32 m0, m0, 3968
    v_mfma_f32_16x16x32_bf16 v[120:123], a[112:115], v[104:107], v[120:123]
    s_waitcnt lgkmcnt(2)
    v_mfma_f32_16x16x32_bf16 v[108:111], a[36:39], v[84:87], v[108:111]
    ds_read_b128 v[100:103], v12 offset:20480
    v_mfma_f32_16x16x32_bf16 v[112:115], a[36:39], v[88:91], v[112:115]
    ds_read_b128 v[104:107], v12 offset:22528
    v_mfma_f32_16x16x32_bf16 v[116:119], a[116:119], v[84:87], v[116:119]
    buffer_load_dwordx4 v10, s[24:27], s46 offen offset:128 lds
    s_add_u32 m0, m0, 3968
    v_mfma_f32_16x16x32_bf16 v[120:123], a[116:119], v[88:91], v[120:123]
    s_waitcnt lgkmcnt(2)
    v_mfma_f32_16x16x32_bf16 v[108:111], a[40:43], v[92:95], v[108:111]
    ds_read_b128 v[84:87], v11 offset:24576
    v_mfma_f32_16x16x32_bf16 v[112:115], a[40:43], v[96:99], v[112:115]
    ds_read_b128 v[88:91], v11 offset:26624
    v_mfma_f32_16x16x32_bf16 v[116:119], a[120:123], v[92:95], v[116:119]
    buffer_load_dwordx4 v10, s[24:27], s46 offen offset:256 lds
    s_add_u32 m0, m0, 3968
    v_mfma_f32_16x16x32_bf16 v[120:123], a[120:123], v[96:99], v[120:123]
    s_waitcnt lgkmcnt(2)
    v_mfma_f32_16x16x32_bf16 v[108:111], a[44:47], v[100:103], v[108:111]
    ds_read_b128 v[92:95], v12 offset:24576
    v_mfma_f32_16x16x32_bf16 v[112:115], a[44:47], v[104:107], v[112:115]
    ds_read_b128 v[96:99], v12 offset:26624
    v_mfma_f32_16x16x32_bf16 v[116:119], a[124:127], v[100:103], v[116:119]
    buffer_load_dwordx4 v10, s[24:27], s46 offen offset:384 lds
    s_add_u32 m0, m0, 3968
    v_mfma_f32_16x16x32_bf16 v[120:123], a[124:127], v[104:107], v[120:123]
    s_waitcnt lgkmcnt(2)
    v_mfma_f32_16x16x32_bf16 v[108:111], a[48:51], v[84:87], v[108:111]
    ds_read_b128 v[100:103], v11 offset:28672
    v_mfma_f32_16x16x32_bf16 v[112:115], a[48:51], v[88:91], v[112:115]
    ds_read_b128 v[104:107], v11 offset:30720
    v_mfma_f32_16x16x32_bf16 v[116:119], a[128:131], v[84:87], v[116:119]
    buffer_load_dwordx4 v10, s[24:27], s46 offen offset:512 lds
    s_add_u32 m0, m0, 3968
    v_mfma_f32_16x16x32_bf16 v[120:123], a[128:131], v[88:91], v[120:123]
    s_waitcnt lgkmcnt(2)
    v_mfma_f32_16x16x32_bf16 v[108:111], a[52:55], v[92:95], v[108:111]
    ds_read_b128 v[84:87], v12 offset:28672
    v_mfma_f32_16x16x32_bf16 v[112:115], a[52:55], v[96:99], v[112:115]
    ds_read_b128 v[88:91], v12 offset:30720
    v_mfma_f32_16x16x32_bf16 v[116:119], a[132:135], v[92:95], v[116:119]
    buffer_load_dwordx4 v10, s[24:27], s46 offen offset:640 lds
    s_add_u32 m0, m0, 3968
    v_mfma_f32_16x16x32_bf16 v[120:123], a[132:135], v[96:99], v[120:123]
    s_waitcnt lgkmcnt(2)
    v_mfma_f32_16x16x32_bf16 v[108:111], a[56:59], v[100:103], v[108:111]
    ds_read_b128 v[92:95], v11 offset:32768
    v_mfma_f32_16x16x32_bf16 v[112:115], a[56:59], v[104:107], v[112:115]
    ds_read_b128 v[96:99], v11 offset:34816
    v_mfma_f32_16x16x32_bf16 v[116:119], a[136:139], v[100:103], v[116:119]
    buffer_load_dwordx4 v10, s[24:27], s46 offen offset:768 lds
    s_add_u32 m0, m0, 3968
    v_mfma_f32_16x16x32_bf16 v[120:123], a[136:139], v[104:107], v[120:123]
    s_waitcnt lgkmcnt(2)
    v_mfma_f32_16x16x32_bf16 v[108:111], a[60:63], v[84:87], v[108:111]
    ds_read_b128 v[100:103], v12 offset:32768
    v_mfma_f32_16x16x32_bf16 v[112:115], a[60:63], v[88:91], v[112:115]
    ds_read_b128 v[104:107], v12 offset:34816
    v_mfma_f32_16x16x32_bf16 v[116:119], a[140:143], v[84:87], v[116:119]
    buffer_load_dwordx4 v10, s[24:27], s46 offen offset:896 lds
    s_add_u32 m0, m0, 3968
    v_mfma_f32_16x16x32_bf16 v[120:123], a[140:143], v[88:91], v[120:123]
    s_waitcnt lgkmcnt(2)
    v_mfma_f32_16x16x32_bf16 v[108:111], a[64:67], v[92:95], v[108:111]
    ds_read_b128 v[84:87], v11 offset:36864
    v_mfma_f32_16x16x32_bf16 v[112:115], a[64:67], v[96:99], v[112:115]
    ds_read_b128 v[88:91], v11 offset:38912
    v_mfma_f32_16x16x32_bf16 v[116:119], a[144:147], v[92:95], v[116:119]
    buffer_load_dwordx4 v10, s[24:27], s46 offen offset:1024 lds
    s_add_u32 m0, m0, 3968
    v_mfma_f32_16x16x32_bf16 v[120:123], a[144:147], v[96:99], v[120:123]
    s_waitcnt lgkmcnt(2)
    v_mfma_f32_16x16x32_bf16 v[108:111], a[68:71], v[100:103], v[108:111]
    ds_read_b128 v[92:95], v12 offset:36864
    v_mfma_f32_16x16x32_bf16 v[112:115], a[68:71], v[104:107], v[112:115]
    ds_read_b128 v[96:99], v12 offset:38912
    v_mfma_f32_16x16x32_bf16 v[116:119], a[148:151], v[100:103], v[116:119]
    buffer_load_dwordx4 v10, s[24:27], s46 offen offset:1152 lds
    v_mfma_f32_16x16x32_bf16 v[120:123], a[148:151], v[104:107], v[120:123]
    s_waitcnt lgkmcnt(0)
    v_mfma_f32_16x16x32_bf16 v[108:111], a[72:75], v[84:87], v[108:111]
    v_add_u32 v11, s49, v11
    v_mfma_f32_16x16x32_bf16 v[112:115], a[72:75], v[88:91], v[112:115]
    v_add_u32 v12, s49, v12
    v_mfma_f32_16x16x32_bf16 v[108:111], a[76:79], v[92:95], v[108:111]
    s_sub_u32 s47, s47, s49
    v_mfma_f32_16x16x32_bf16 v[112:115], a[76:79], v[96:99], v[112:115]
    s_sub_u32 s49, 0, s49
    v_mfma_f32_16x16x32_bf16 v[116:119], a[152:155], v[84:87], v[116:119]
    v_mfma_f32_16x16x32_bf16 v[120:123], a[152:155], v[88:91], v[120:123]
    v_mfma_f32_16x16x32_bf16 v[116:119], a[156:159], v[92:95], v[116:119]
    v_mfma_f32_16x16x32_bf16 v[120:123], a[156:159], v[96:99], v[120:123]
    v_cvt_pk_bf16_f32 v124, v108, v109
    v_cvt_pk_bf16_f32 v125, v110, v111
    v_cvt_pk_bf16_f32 v126, v112, v113
    v_cvt_pk_bf16_f32 v127, v114, v115
    s_nop 0
    v_permlane16_swap_b32 v124, v126
    v_permlane16_swap_b32 v125, v127
    v_cvt_pk_bf16_f32 v128, v116, v117
    v_cvt_pk_bf16_f32 v129, v118, v119
    v_cvt_pk_bf16_f32 v130, v120, v121
    v_cvt_pk_bf16_f32 v131, v122, v123
    s_nop 0
    v_permlane16_swap_b32 v128, v130
    v_permlane16_swap_b32 v129, v131
    buffer_store_dwordx4 v[124:127], v19, s[4:7], s44 offen sc1
    buffer_store_dwordx4 v[128:131], v19, s[4:7], s45 offen sc1
    s_waitcnt vmcnt(18)
    s_cmp_lt_i32 s60, 0
    s_cbranch_scc1 L_fin_93
    v_mfma_f32_16x16x32_bf16 v[164:167], a[160:163], v[156:159], 0
    v_mfma_f32_16x16x32_bf16 v[168:171], a[160:163], v[160:163], 0
    s_nop 4
    v_cndmask_b32 v166, v164, v165, s[58:59]
    s_nop 1
    v_cndmask_b32 v170, v168, v169, s[58:59]
    v_cndmask_b32 v167, v165, v164, s[58:59]
    v_cndmask_b32 v171, v169, v168, s[58:59]
    s_nop 0
    v_add_f32_dpp v167, v166, v167 row_ror:8 row_mask:0xf bank_mask:0xf
    v_add_f32_dpp v171, v170, v171 row_ror:8 row_mask:0xf bank_mask:0xf
    v_cvt_pk_bf16_f32 v167, v167, v167
    v_cvt_pk_bf16_f32 v171, v171, v171
    buffer_store_short v167, v145, s[28:31], s60 offen offset:0
    buffer_store_short v171, v145, s[28:31], s60 offen offset:32
L_fin_93:
    s_branch L_v_loop_s
L_end_88:
    s_cmp_lt_i32 s60, 0
    s_cselect_b32 s54, s38, s54
    buffer_load_dwordx4 v[156:159], v144, s[4:7], s54 offen offset:0 sc1
    buffer_load_dwordx4 v[160:163], v144, s[4:7], s54 offen offset:1024 sc1
    s_waitcnt vmcnt(0) lgkmcnt(0)
    s_cmp_lt_i32 s60, 0
    s_cbranch_scc1 L_fin_94
    v_mfma_f32_16x16x32_bf16 v[164:167], a[160:163], v[156:159], 0
    v_mfma_f32_16x16x32_bf16 v[168:171], a[160:163], v[160:163], 0
    s_nop 4
    v_cndmask_b32 v166, v164, v165, s[58:59]
    s_nop 1
    v_cndmask_b32 v170, v168, v169, s[58:59]
    v_cndmask_b32 v167, v165, v164, s[58:59]
    v_cndmask_b32 v171, v169, v168, s[58:59]
    s_nop 0
    v_add_f32_dpp v167, v166, v167 row_ror:8 row_mask:0xf bank_mask:0xf
    v_add_f32_dpp v171, v170, v171 row_ror:8 row_mask:0xf bank_mask:0xf
    v_cvt_pk_bf16_f32 v167, v167, v167
    v_cvt_pk_bf16_f32 v171, v171, v171
    buffer_store_short v167, v145, s[28:31], s60 offen offset:0
    buffer_store_short v171, v145, s[28:31], s60 offen offset:32
L_fin_94:
    s_waitcnt vmcnt(0)
    s_cmp_lg_u32 s55, 0
    s_cbranch_scc1 L_wb_95
    buffer_wbl2 sc1
    s_waitcnt vmcnt(0)
L_wb_95:
    s_endpgm
L_nan_86:
    s_cmp_eq_u32 s52, 1
    s_cbranch_scc1 L_cont_87
    v_lshlrev_b32 v1, 4, v0
L_nan_86r:
    s_mov_b32 s90, s41
    v_mov_b32 v2, 0
    buffer_load_dwordx4 v[28:31], v1, s[4:7], s90 offen sc1
    s_add_u32 s90, s90, 1024
    buffer_load_dwordx4 v[32:35], v1, s[4:7], s90 offen sc1
    s_add_u32 s90, s90, 1024
    buffer_load_dwordx4 v[36:39], v1, s[4:7], s90 offen sc1
    s_add_u32 s90, s90, 1024
    buffer_load_dwordx4 v[40:43], v1, s[4:7], s90 offen sc1
    s_add_u32 s90, s90, 1024
    buffer_load_dwordx4 v[44:47], v1, s[4:7], s90 offen sc1
    s_add_u32 s90, s90, 1024
    buffer_load_dwordx4 v[48:51], v1, s[4:7], s90 offen sc1
    s_add_u32 s90, s90, 1024
    buffer_load_dwordx4 v[52:55], v1, s[4:7], s90 offen sc1
    s_add_u32 s90, s90, 1024
    buffer_load_dwordx4 v[56:59], v1, s[4:7], s90 offen sc1
    s_add_u32 s90, s90, 1024
    buffer_load_dwordx4 v[60:63], v1, s[4:7], s90 offen sc1
    s_add_u32 s90, s90, 1024
    buffer_load_dwordx4 v[64:67], v1, s[4:7], s90 offen sc1
    s_add_u32 s90, s90, 1024
    s_sub_u32 s36, s36, 1
    s_cbranch_scc1 L_exit
    s_waitcnt vmcnt(0) lgkmcnt(0)
    v_max3_u32 v2, v2, v28, v29
    v_max3_u32 v2, v2, v30, v31
    v_max3_u32 v2, v2, v32, v33
    v_max3_u32 v2, v2, v34, v35
    v_max3_u32 v2, v2, v36, v37
    v_max3_u32 v2, v2, v38, v39
    v_max3_u32 v2, v2, v40, v41
    v_max3_u32 v2, v2, v42, v43
    v_max3_u32 v2, v2, v44, v45
    v_max3_u32 v2, v2, v46, v47
    v_max3_u32 v2, v2, v48, v49
    v_max3_u32 v2, v2, v50, v51
    v_max3_u32 v2, v2, v52, v53
    v_max3_u32 v2, v2, v54, v55
    v_max3_u32 v2, v2, v56, v57
    v_max3_u32 v2, v2, v58, v59
    v_max3_u32 v2, v2, v60, v61
    v_max3_u32 v2, v2, v62, v63
    v_max3_u32 v2, v2, v64, v65
    v_max3_u32 v2, v2, v66, v67
    v_cmp_eq_u32 vcc, -1, v2
    s_cbranch_vccnz L_nan_86r
    s_mov_b32 s52, 1
    v_mov_b32 v68, 0
    v_mov_b32 v69, 0
    v_mov_b32 v70, 0
    v_mov_b32 v71, 0
    v_mov_b32 v72, 0
    v_mov_b32 v73, 0
    v_mov_b32 v74, 0
    v_mov_b32 v75, 0
    v_smfmac_f32_16x16x64_bf16 v[68:71], v[28:31], a[0:7], v17
    s_nop 0
    v_smfmac_f32_16x16x64_bf16 v[72:75], v[28:31], a[80:87], v17
    v_smfmac_f32_16x16x64_bf16 v[68:71], v[32:35], a[8:15], v17
    v_smfmac_f32_16x16x64_bf16 v[72:75], v[32:35], a[88:95], v17
    v_smfmac_f32_16x16x64_bf16 v[68:71], v[36:39], a[16:23], v17
    v_smfmac_f32_16x16x64_bf16 v[72:75], v[36:39], a[96:103], v17
    v_smfmac_f32_16x16x64_bf16 v[68:71], v[40:43], a[24:31], v17
    v_smfmac_f32_16x16x64_bf16 v[72:75], v[40:43], a[104:111], v17
    v_smfmac_f32_16x16x64_bf16 v[68:71], v[44:47], a[32:39], v17
    v_smfmac_f32_16x16x64_bf16 v[72:75], v[44:47], a[112:119], v17
    v_smfmac_f32_16x16x64_bf16 v[68:71], v[48:51], a[40:47], v17
    v_smfmac_f32_16x16x64_bf16 v[68:71], v[52:55], a[48:55], v17
    v_smfmac_f32_16x16x64_bf16 v[68:71], v[56:59], a[56:63], v17
    v_smfmac_f32_16x16x64_bf16 v[68:71], v[60:63], a[64:71], v17
    v_smfmac_f32_16x16x64_bf16 v[68:71], v[64:67], a[72:79], v17
    s_nop 2
    s_branch L_redo_84
L_wo_s:
    s_mov_b32 s12, s80
    s_and_b32 s13, s81, 0xffff
    s_mov_b32 s14, 7864320
    s_mov_b32 s15, 0x20000
    s_mov_b32 s16, s72
    s_and_b32 s17, s73, 0xffff
    s_mov_b32 s18, 10240
    s_mov_b32 s19, 0x20000
    s_sub_u32 s40, s35, 18
    v_and_b32 v1, 15, v0
    v_lshrrev_b32 v2, 4, v0
    v_lshrrev_b32 v3, 3, v0
    v_and_b32 v4, 7, v0
    v_and_b32 v6, 2, v3
    v_xor_b32 v6, v6, v4
    v_lshlrev_b32 v6, 4, v6
    v_mul_u32_u24 v7, 1280, v3
    s_lshl_b32 s90, s34, 2
    s_add_u32 s90, s90, s32
    s_mul_i32 s90, s90, 245760
    s_lshl_b32 s91, s40, 7
    s_add_u32 s90, s90, s91
    v_add3_u32 v180, v6, v7, s90
    v_xor_b32 v181, 64, v180
    s_mul_i32 s90, s40, 32768
    s_lshl_b32 s91, s32, 11
    s_add_u32 s90, s90, s91
    s_lshr_b32 s91, s32, 1
    s_mul_i32 s91, s91, 0
    s_xor_b32 s91, s91, s34
    v_mul_u32_u24 v7, 0, v2
    v_xor_b32 v7, s91, v7
    v_lshlrev_b32 v6, 4, v1
    v_lshl_add_u32 v7, v7, 8, v6
    v_lshl_add_u32 v7, v2, 13, v7
    v_add_u32 v14, s90, v7
    v_lshlrev_b32 v12, 4, v0
    v_lshlrev_b32 v13, 2, v0
    v_add_u32 v46, s90, v13
    s_xor_b32 s92, s91, 0
    s_lshl_b32 s92, s92, 8
    s_add_u32 s60, s92, 0
    s_xor_b32 s92, s91, 0
    s_lshl_b32 s92, s92, 8
    s_add_u32 s61, s92, 8192
    s_xor_b32 s92, s91, 0
    s_lshl_b32 s92, s92, 8
    s_add_u32 s62, s92, 16384
    s_xor_b32 s92, s91, 0
    s_lshl_b32 s92, s92, 8
    s_add_u32 s63, s92, 24576
    v_cmp_gt_u32 vcc, 2, v2
    v_mov_b32 v9, 2146435072
    s_nop 0
    v_cndmask_b32 v14, v9, v14, vcc
    s_lshl_b32 s92, s40, 7
    s_lshl_b32 s93, s32, 2
    s_add_u32 s92, s92, s93
    s_add_u32 s92, s92, 460800
    v_mov_b32 v244, s92
    v_cmp_eq_u32 vcc, 0, v0
    v_mov_b32 v9, 2146435072
    s_nop 0
    v_cndmask_b32 v244, v9, v244, vcc
    s_lshl_b32 s92, s32, 7
    s_add_u32 s92, s92, 462336
    v_min_u32 v3, 5, v0
    v_lshl_add_u32 v245, v3, 2, s92
    s_lshl_b32 s90, s40, 2
    s_add_u32 s90, s90, s32
    s_lshl_b32 s91, s90, 8
    v_add_u32 v17, s91, v6
    v_cmp_eq_u32 vcc, 0, v2
    v_mov_b32 v9, 2146435072
    s_nop 0
    v_cndmask_b32 v17, v9, v17, vcc
    v_lshrrev_b32 v3, 2, v1
    v_and_b32 v7, 1, v1
    v_lshl_or_b32 v4, v3, 1, v7
    v_mul_u32_u24 v4, 1280, v4
    v_and_b32 v5, 2, v1
    v_lshl_add_u32 v4, v5, 1, v4
    s_lshl_b32 s91, s90, 5
    v_add_u32 v4, s91, v4
    v_lshlrev_b32 v6, 6, v3
    v_lshl_add_u32 v6, v7, 5, v6
    v_lshl_add_u32 v6, v2, 3, v6
    v_lshl_add_u32 v6, v5, 1, v6
    s_mul_i32 s92, s32, 1152
    s_add_u32 s92, s92, 122880
    v_add_u32 v18, s92, v6
    buffer_load_dword v164, v4, s[16:19], 0 offen offset:0
    buffer_load_dword v165, v4, s[16:19], 0 offen offset:8
    buffer_load_dword v166, v4, s[16:19], 0 offen offset:16
    buffer_load_dword v167, v4, s[16:19], 0 offen offset:24
    v_mov_b32 v168, -1
    v_mov_b32 v169, -1
    v_mov_b32 v170, -1
    v_mov_b32 v171, -1
    s_mul_i32 s90, s32, 24576
    s_mov_b32 m0, s90
    s_mov_b32 s91, 0
    buffer_load_dwordx4 v180, s[12:15], s91 offen nt lds
    s_add_u32 m0, m0, 1024
    s_add_u32 s91, s91, 10240
    buffer_load_dwordx4 v181, s[12:15], s91 offen nt lds
    s_add_u32 m0, m0, 1024
    s_add_u32 s91, s91, 10240
    buffer_load_dwordx4 v180, s[12:15], s91 offen nt lds
    s_add_u32 m0, m0, 1024
    s_add_u32 s91, s91, 10240
    buffer_load_dwordx4 v181, s[12:15], s91 offen nt lds
    s_add_u32 m0, m0, 1024
    s_add_u32 s91, s91, 10240
    buffer_load_dwordx4 v180, s[12:15], s91 offen nt lds
    s_add_u32 m0, m0, 1024
    s_add_u32 s91, s91, 10240
    buffer_load_dwordx4 v181, s[12:15], s91 offen nt lds
    s_add_u32 m0, m0, 1024
    s_add_u32 s91, s91, 10240
    buffer_load_dwordx4 v180, s[12:15], s91 offen nt lds
    s_add_u32 m0, m0, 1024
    s_add_u32 s91, s91, 10240
    buffer_load_dwordx4 v181, s[12:15], s91 offen nt lds
    s_add_u32 m0, m0, 1024
    s_add_u32 s91, s91, 10240
    buffer_load_dwordx4 v180, s[12:15], s91 offen nt lds
    s_add_u32 m0, m0, 1024
    s_add_u32 s91, s91, 10240
    buffer_load_dwordx4 v181, s[12:15], s91 offen nt lds
    s_add_u32 m0, m0, 1024
    s_add_u32 s91, s91, 10240
    buffer_load_dwordx4 v180, s[12:15], s91 offen nt lds
    s_add_u32 m0, m0, 1024
    s_add_u32 s91, s91, 10240
    buffer_load_dwordx4 v181, s[12:15], s91 offen nt lds
    s_add_u32 m0, m0, 1024
    s_add_u32 s91, s91, 10240
    buffer_load_dwordx4 v180, s[12:15], s91 offen nt lds
    s_add_u32 m0, m0, 1024
    s_add_u32 s91, s91, 10240
    buffer_load_dwordx4 v181, s[12:15], s91 offen nt lds
    s_add_u32 m0, m0, 1024
    s_add_u32 s91, s91, 10240
    buffer_load_dwordx4 v180, s[12:15], s91 offen nt lds
    s_add_u32 m0, m0, 1024
    s_add_u32 s91, s91, 10240
    buffer_load_dwordx4 v181, s[12:15], s91 offen nt lds
    s_add_u32 m0, m0, 1024
    s_add_u32 s91, s91, 10240
    buffer_load_dwordx4 v180, s[12:15], s91 offen nt lds
    s_add_u32 m0, m0, 1024
    s_add_u32 s91, s91, 10240
    buffer_load_dwordx4 v181, s[12:15], s91 offen nt lds
    s_add_u32 m0, m0, 1024
    s_add_u32 s91, s91, 10240
    buffer_load_dwordx4 v180, s[12:15], s91 offen nt lds
    s_add_u32 m0, m0, 1024
    s_add_u32 s91, s91, 10240
    buffer_load_dwordx4 v181, s[12:15], s91 offen nt lds
    s_add_u32 m0, m0, 1024
    s_add_u32 s91, s91, 10240
    buffer_load_dwordx4 v180, s[12:15], s91 offen nt lds
    s_add_u32 m0, m0, 1024
    s_add_u32 s91, s91, 10240
    buffer_load_dwordx4 v181, s[12:15], s91 offen nt lds
    s_add_u32 m0, m0, 1024
    s_add_u32 s91, s91, 10240
    buffer_load_dwordx4 v180, s[12:15], s91 offen nt lds
    s_add_u32 m0, m0, 1024
    s_add_u32 s91, s91, 10240
    buffer_load_dwordx4 v181, s[12:15], s91 offen nt lds
    s_waitcnt vmcnt(24)
    v_min_u32 v164, -2, v164
    v_min_u32 v165, -2, v165
    v_min_u32 v166, -2, v166
    v_min_u32 v167, -2, v167
    v_and_b32 v7, 2, v1
    v_cmp_ne_u32 vcc, 0, v7
    v_mov_b32 v5, 0x4444
    v_mov_b32 v6, 0xeeee
    v_cndmask_b32 v10, v5, v6, vcc
    v_mov_b32 v5, 0xe484
    v_mov_b32 v6, 0xee9e
    v_cndmask_b32 v7, v5, v6, vcc
    v_mov_b32 v5, 0x84e4
    v_mov_b32 v6, 0x9eee
    v_cndmask_b32 v8, v5, v6, vcc
    v_cmp_gt_u32 vcc, 2, v2
    s_nop 1
    v_cndmask_b32 v11, v8, v7, vcc
    v_mov_b32 v84, 1065369472
    v_mov_b32 v85, 1065369472
    v_mov_b32 v86, 1065369472
    v_mov_b32 v87, 0
    v_mov_b32 v88, 1065369472
    v_mov_b32 v89, 1065369472
    v_mov_b32 v90, 1065369472
    v_mov_b32 v91, 0
    v_mov_b32 v51, 0
    v_mov_b32 v55, 0
    v_mov_b32 v59, 0
    v_mov_b32 v63, 0
    v_mov_b32 v67, 0
    v_mov_b32 v71, 0
    v_mov_b32 v75, 0
    v_mov_b32 v79, 0
    v_mov_b32 v210, 0
    v_mov_b32 v211, 0
    v_mov_b32 v218, 0
    v_mov_b32 v219, 0
    v_and_b32 v7, 1, v1
    v_cmp_ne_u32 vcc, 0, v7
    v_mov_b32 v5, 0x3f80
    v_mov_b32 v6, 0x3f800000
    v_cndmask_b32 v5, v5, v6, vcc
    v_bfe_u32 v6, v1, 1, 1
    v_cmp_eq_u32 vcc, 0, v6
    s_nop 1
    v_cndmask_b32 v110, 0, v5, vcc
    v_mov_b32 v108, 0
    v_mov_b32 v112, 0
    v_cmp_eq_u32 vcc, 1, v6
    s_nop 1
    v_cndmask_b32 v111, 0, v5, vcc
    v_mov_b32 v109, 0
    v_mov_b32 v113, 0
    v_mov_b32 v240, 0x3dd53b95
    v_mov_b32 v241, 0x3dd53b95
    s_lshl_b32 s90, s32, 8
    s_add_u32 s90, s90, 122880
    v_mul_u32_u24 v6, 1152, v2
    v_lshl_add_u32 v6, v1, 3, v6
    v_add_u32 v19, s90, v6
    s_mul_i32 s90, s32, 1536
    v_add_u32 v20, s90, v12
    s_add_u32 s90, s90, 1024
    v_lshl_add_u32 v21, v0, 3, s90
    s_mul_i32 s90, s32, 6144
    v_add_u32 v22, s90, v12
    s_add_u32 s90, s90, 1024
    v_lshl_add_u32 v23, v0, 3, s90
    v_add_u32 v28, 98304, v12
    s_mul_i32 s90, s32, 3072
    v_add_u32 v37, s90, v12
    v_add_u32 v44, 25600, v37
    s_add_u32 s54, s90, 98304
    s_mul_i32 s90, s32, 3840
    s_add_u32 s90, s90, 10240
    v_add_u32 v38, s90, v12
    s_add_u32 s90, s90, 1024
    v_add_u32 v39, s90, v13
    s_mul_i32 s90, s32, 12288
    v_add_u32 v40, s90, v12
    s_lshl_b32 s93, s40, 2
    s_add_u32 s93, s93, s32
    s_nop 0
    s_lshr_b32 s90, s93, 2
    s_lshl_b32 s90, s90, 15
    s_and_b32 s92, s93, 3
    s_lshl_b32 s92, s92, 10
    s_add_u32 s90, s90, s92
    v_mov_b32 v5, s34
    v_and_b32 v6, 7, v1
    v_lshlrev_b32 v6, 4, v6
    v_lshl_add_u32 v6, v5, 7, v6
    v_lshrrev_b32 v7, 3, v1
    v_lshl_add_u32 v6, v7, 12, v6
    v_lshrrev_b32 v5, 1, v2
    v_lshl_add_u32 v6, v5, 13, v6
    v_and_b32 v5, 1, v2
    v_lshl_add_u32 v6, v5, 14, v6
    v_add_u32 v30, s90, v6
    s_and_b32 s91, s34, 1
    s_lshl_b32 s91, s91, 12
    s_add_u32 s90, s90, s91
    s_lshr_b32 s91, s34, 2
    s_lshl_b32 s91, s91, 13
    s_add_u32 s90, s90, s91
    s_and_b32 s91, s34, 2
    s_lshl_b32 s91, s91, 13
    s_add_u32 s90, s90, s91
    v_lshl_add_u32 v31, v0, 4, s90
    s_lshl_b32 s91, s93, 10
    s_add_u32 s91, s91, 884736
    v_lshl_add_u32 v15, v0, 4, s91
    s_lshr_b32 s91, s34, 1
    s_mul_i32 s91, s91, 10240
    s_lshl_b32 s92, s93, 5
    s_add_u32 s91, s91, s92
    s_and_b32 s92, s34, 1
    s_mul_i32 s92, s92, 40960
    s_add_u32 s91, s91, s92
    s_add_u32 s91, s91, 1280
    v_mul_u32_u24 v6, 2560, v2
    v_lshl_add_u32 v6, v1, 1, v6
    v_add_u32 v32, s91, v6
    v_cmp_gt_u32 s[58:59], 8, v1
    v_and_b32 v5, 1, v1
    v_lshrrev_b32 v6, 3, v1
    v_lshl_add_u32 v5, v5, 1, v6
    v_bfe_u32 v6, v1, 2, 1
    v_cmp_ne_u32 vcc, 0, v6
    v_mov_b32 v6, 0x3f80
    v_mov_b32 v7, 0x3f800000
    v_cndmask_b32 v6, v6, v7, vcc
    v_cmp_eq_u32 vcc, 0, v5
    s_nop 1
    v_cndmask_b32 v7, 0, v6, vcc
    v_accvgpr_write_b32 a144, v7
    v_cmp_eq_u32 vcc, 1, v5
    s_nop 1
    v_cndmask_b32 v7, 0, v6, vcc
    v_accvgpr_write_b32 a145, v7
    v_cmp_eq_u32 vcc, 2, v5
    s_nop 1
    v_cndmask_b32 v7, 0, v6, vcc
    v_accvgpr_write_b32 a146, v7
    v_cmp_eq_u32 vcc, 3, v5
    s_nop 1
    v_cndmask_b32 v7, 0, v6, vcc
    v_accvgpr_write_b32 a147, v7
    s_lshl_b32 s90, s32, 7
    v_add_u32 v5, s90, v13
    v_add_u32 v6, 458752, v5
    v_add_u32 v7, 459728, v5
    v_cmp_gt_u32 vcc, 12, v0
    s_nop 1
    v_cndmask_b32 v33, v7, v6, vcc
    v_mov_b32 v5, -2
    v_cndmask_b32 v34, v5, 3, vcc
    v_cmp_gt_u32 vcc, 14, v0
    v_mov_b32 v9, 2146435072
    s_nop 0
    v_cndmask_b32 v33, v9, v33, vcc
    v_mov_b32 v5, -1000
    v_cndmask_b32 v34, v5, v34, vcc
    v_and_b32 v4, 3, v1
    v_lshlrev_b32 v6, 6, v4
    v_lshl_add_u32 v6, v3, 3, v6
    v_lshl_add_u32 v6, v2, 8, v6
    v_and_b32 v5, 1, v2
    v_lshl_add_u32 v6, v5, 5, v6
    s_mul_i32 s90, s32, 3072
    s_add_u32 s53, s90, 131072
    v_add_u32 v16, s53, v6
    v_xor_b32 v13, 32, v16
    v_and_b32 v4, 3, v1
    v_and_b32 v5, 1, v2
    v_lshl_add_u32 v6, v2, 3, v3
    v_lshlrev_b32 v6, 7, v6
    v_and_b32 v7, 2, v3
    v_lshl_or_b32 v7, v5, 2, v7
    v_lshrrev_b32 v8, 1, v4
    v_xor_b32 v7, v7, v8
    v_lshl_add_u32 v6, v7, 4, v6
    v_and_b32 v7, 1, v4
    v_lshl_add_u32 v6, v7, 3, v6
    s_mul_i32 s90, s32, 24576
    v_add_u32 v6, s90, v6
    v_xor_b32 v182, 0, v6
    v_xor_b32 v183, 32, v6
    v_xor_b32 v184, 64, v6
    v_xor_b32 v185, 96, v6
    s_waitcnt vmcnt(0)
    ds_read_b64_tr_b16 a[0:1], v182 offset:0
    ds_read_b64_tr_b16 a[2:3], v182 offset:512
    ds_read_b64_tr_b16 a[4:5], v182 offset:4096
    ds_read_b64_tr_b16 a[6:7], v182 offset:4608
    ds_read_b64_tr_b16 a[8:9], v182 offset:8192
    ds_read_b64_tr_b16 a[10:11], v182 offset:8704
    ds_read_b64_tr_b16 a[12:13], v182 offset:12288
    ds_read_b64_tr_b16 a[14:15], v182 offset:12800
    ds_read_b64_tr_b16 a[16:17], v182 offset:16384
    ds_read_b64_tr_b16 a[18:19], v182 offset:16896
    ds_read_b64_tr_b16 a[20:21], v182 offset:20480
    ds_read_b64_tr_b16 a[22:23], v182 offset:20992
    ds_read_b64_tr_b16 a[24:25], v183 offset:0
    ds_read_b64_tr_b16 a[26:27], v183 offset:512
    ds_read_b64_tr_b16 a[28:29], v183 offset:4096
    ds_read_b64_tr_b16 a[30:31], v183 offset:4608
    ds_read_b64_tr_b16 a[32:33], v183 offset:8192
    ds_read_b64_tr_b16 a[34:35], v183 offset:8704
    ds_read_b64_tr_b16 a[36:37], v183 offset:12288
    ds_read_b64_tr_b16 a[38:39], v183 offset:12800
    ds_read_b64_tr_b16 a[40:41], v183 offset:16384
    ds_read_b64_tr_b16 a[42:43], v183 offset:16896
    ds_read_b64_tr_b16 a[44:45], v183 offset:20480
    ds_read_b64_tr_b16 a[46:47], v183 offset:20992
    ds_read_b64_tr_b16 a[48:49], v184 offset:0
    ds_read_b64_tr_b16 a[50:51], v184 offset:512
    ds_read_b64_tr_b16 a[52:53], v184 offset:4096
    ds_read_b64_tr_b16 a[54:55], v184 offset:4608
    ds_read_b64_tr_b16 a[56:57], v184 offset:8192
    ds_read_b64_tr_b16 a[58:59], v184 offset:8704
    ds_read_b64_tr_b16 a[60:61], v184 offset:12288
    ds_read_b64_tr_b16 a[62:63], v184 offset:12800
    ds_read_b64_tr_b16 a[64:65], v184 offset:16384
    ds_read_b64_tr_b16 a[66:67], v184 offset:16896
    ds_read_b64_tr_b16 a[68:69], v184 offset:20480
    ds_read_b64_tr_b16 a[70:71], v184 offset:20992
    ds_read_b64_tr_b16 a[72:73], v185 offset:0
    ds_read_b64_tr_b16 a[74:75], v185 offset:512
    ds_read_b64_tr_b16 a[76:77], v185 offset:4096
    ds_read_b64_tr_b16 a[78:79], v185 offset:4608
    ds_read_b64_tr_b16 a[80:81], v185 offset:8192
    ds_read_b64_tr_b16 a[82:83], v185 offset:8704
    ds_read_b64_tr_b16 a[84:85], v185 offset:12288
    ds_read_b64_tr_b16 a[86:87], v185 offset:12800
    ds_read_b64_tr_b16 a[88:89], v185 offset:16384
    ds_read_b64_tr_b16 a[90:91], v185 offset:16896
    ds_read_b64_tr_b16 a[92:93], v185 offset:20480
    ds_read_b64_tr_b16 a[94:95], v185 offset:20992
    s_waitcnt lgkmcnt(0)
    s_barrier
    v_mov_b32 v1, 196
L_gw_96:
    buffer_load_dword v2, v1, s[8:11], 0 offen sc1
    s_sub_u32 s36, s36, 1
    s_cbranch_scc1 L_exit
    s_waitcnt vmcnt(0)
L_gw_96c:
    v_readfirstlane_b32 s90, v2
    s_nop 0
    s_cmp_eq_u32 s90, 0
    s_cbranch_scc1 L_gw_96
    buffer_store_dwordx4 v[164:167], v17, s[4:7], s38 offen sc1
    s_mov_b32 s37, -1
    v_add_u32 v35, -2, v34
    s_add_u32 s45, s38, 65536
    s_add_u32 s46, s45, 4096
    s_add_u32 s47, s45, 8192
    v_mov_b32 v24, v20
    v_mov_b32 v25, v21
    buffer_load_dword v36, v33, s[4:7], s38 offen sc1
    s_waitcnt vmcnt(0)
    v_cmp_lt_i32 vcc, v36, v35
    s_cbranch_vccz L_fok_98
L_fw_97:
    buffer_load_dword v36, v33, s[4:7], s38 offen sc1
    s_sub_u32 s36, s36, 1
    s_cbranch_scc1 L_exit
    s_waitcnt vmcnt(0)
    v_cmp_lt_i32 vcc, v36, v35
    s_cbranch_vccnz L_fw_97
L_fok_98:
    buffer_load_dwordx4 a[96:99], v40, s[4:7], s45 offen offset:0 sc1
    buffer_load_dwordx4 a[100:103], v40, s[4:7], s45 offen offset:1024 sc1
    buffer_load_dwordx4 a[104:107], v40, s[4:7], s45 offen offset:2048 sc1
    buffer_load_dwordx4 a[108:111], v40, s[4:7], s45 offen offset:3072 sc1
    buffer_load_dwordx4 a[112:115], v40, s[4:7], s46 offen offset:0 sc1
    buffer_load_dwordx4 a[116:119], v40, s[4:7], s46 offen offset:1024 sc1
    buffer_load_dwordx4 a[120:123], v40, s[4:7], s46 offen offset:2048 sc1
    buffer_load_dwordx4 a[124:127], v40, s[4:7], s46 offen offset:3072 sc1
    buffer_load_dwordx4 a[128:131], v40, s[4:7], s47 offen offset:0 sc1
    buffer_load_dwordx4 a[132:135], v40, s[4:7], s47 offen offset:1024 sc1
    buffer_load_dwordx4 a[136:139], v40, s[4:7], s47 offen offset:2048 sc1
    buffer_load_dwordx4 a[140:143], v40, s[4:7], s47 offen offset:3072 sc1
    s_waitcnt vmcnt(0)
    v_mfma_f32_16x16x32_bf16 v[148:151], a[96:99], a[0:3], 0
    v_mfma_f32_16x16x32_bf16 v[152:155], a[120:123], a[0:3], 0
    v_mfma_f32_16x16x32_bf16 v[156:159], a[96:99], a[24:27], 0
    v_mfma_f32_16x16x32_bf16 v[160:163], a[120:123], a[24:27], 0
    v_mfma_f32_16x16x32_bf16 v[180:183], a[96:99], a[48:51], 0
    v_mfma_f32_16x16x32_bf16 v[184:187], a[120:123], a[48:51], 0
    v_mfma_f32_16x16x32_bf16 v[188:191], a[96:99], a[72:75], 0
    v_mfma_f32_16x16x32_bf16 v[192:195], a[120:123], a[72:75], 0
    v_mfma_f32_16x16x32_bf16 v[148:151], a[100:103], a[4:7], v[148:151]
    v_mfma_f32_16x16x32_bf16 v[152:155], a[124:127], a[4:7], v[152:155]
    v_mfma_f32_16x16x32_bf16 v[156:159], a[100:103], a[28:31], v[156:159]
    v_mfma_f32_16x16x32_bf16 v[160:163], a[124:127], a[28:31], v[160:163]
    v_mfma_f32_16x16x32_bf16 v[180:183], a[100:103], a[52:55], v[180:183]
    v_mfma_f32_16x16x32_bf16 v[184:187], a[124:127], a[52:55], v[184:187]
    v_mfma_f32_16x16x32_bf16 v[188:191], a[100:103], a[76:79], v[188:191]
    v_mfma_f32_16x16x32_bf16 v[192:195], a[124:127], a[76:79], v[192:195]
    v_mfma_f32_16x16x32_bf16 v[148:151], a[104:107], a[8:11], v[148:151]
    v_mfma_f32_16x16x32_bf16 v[152:155], a[128:131], a[8:11], v[152:155]
    v_mfma_f32_16x16x32_bf16 v[156:159], a[104:107], a[32:35], v[156:159]
    v_mfma_f32_16x16x32_bf16 v[160:163], a[128:131], a[32:35], v[160:163]
    v_mfma_f32_16x16x32_bf16 v[180:183], a[104:107], a[56:59], v[180:183]
    v_mfma_f32_16x16x32_bf16 v[184:187], a[128:131], a[56:59], v[184:187]
    v_mfma_f32_16x16x32_bf16 v[188:191], a[104:107], a[80:83], v[188:191]
    v_mfma_f32_16x16x32_bf16 v[192:195], a[128:131], a[80:83], v[192:195]
    v_mfma_f32_16x16x32_bf16 v[148:151], a[108:111], a[12:15], v[148:151]
    v_mfma_f32_16x16x32_bf16 v[152:155], a[132:135], a[12:15], v[152:155]
    v_mfma_f32_16x16x32_bf16 v[156:159], a[108:111], a[36:39], v[156:159]
    v_mfma_f32_16x16x32_bf16 v[160:163], a[132:135], a[36:39], v[160:163]
    v_mfma_f32_16x16x32_bf16 v[180:183], a[108:111], a[60:63], v[180:183]
    v_mfma_f32_16x16x32_bf16 v[184:187], a[132:135], a[60:63], v[184:187]
    v_mfma_f32_16x16x32_bf16 v[188:191], a[108:111], a[84:87], v[188:191]
    v_mfma_f32_16x16x32_bf16 v[192:195], a[132:135], a[84:87], v[192:195]
    v_mfma_f32_16x16x32_bf16 v[148:151], a[112:115], a[16:19], v[148:151]
    v_mfma_f32_16x16x32_bf16 v[152:155], a[136:139], a[16:19], v[152:155]
    v_mfma_f32_16x16x32_bf16 v[156:159], a[112:115], a[40:43], v[156:159]
    v_mfma_f32_16x16x32_bf16 v[160:163], a[136:139], a[40:43], v[160:163]
    v_mfma_f32_16x16x32_bf16 v[180:183], a[112:115], a[64:67], v[180:183]
    v_mfma_f32_16x16x32_bf16 v[184:187], a[136:139], a[64:67], v[184:187]
    v_mfma_f32_16x16x32_bf16 v[188:191], a[112:115], a[88:91], v[188:191]
    v_mfma_f32_16x16x32_bf16 v[192:195], a[136:139], a[88:91], v[192:195]
    v_mfma_f32_16x16x32_bf16 v[148:151], a[116:119], a[20:23], v[148:151]
    v_mfma_f32_16x16x32_bf16 v[152:155], a[140:143], a[20:23], v[152:155]
    v_mfma_f32_16x16x32_bf16 v[156:159], a[116:119], a[44:47], v[156:159]
    v_mfma_f32_16x16x32_bf16 v[160:163], a[140:143], a[44:47], v[160:163]
    v_mfma_f32_16x16x32_bf16 v[180:183], a[116:119], a[68:71], v[180:183]
    v_mfma_f32_16x16x32_bf16 v[184:187], a[140:143], a[68:71], v[184:187]
    v_mfma_f32_16x16x32_bf16 v[188:191], a[116:119], a[92:95], v[188:191]
    v_mfma_f32_16x16x32_bf16 v[192:195], a[140:143], a[92:95], v[192:195]
    v_cvt_pk_bf16_f32 v64, v180, v181
    v_cvt_pk_bf16_f32 v65, v182, v183
    ds_write_b64 v24, v[64:65] offset:12288
    v_cvt_pk_bf16_f32 v68, v184, v185
    v_cvt_pk_bf16_f32 v69, v186, v187
    ds_write_b64 v25, v[68:69] offset:12288
    v_cvt_pk_bf16_f32 v72, v188, v189
    v_cvt_pk_bf16_f32 v73, v190, v191
    ds_write_b64 v24, v[72:73] offset:18432
    v_cvt_pk_bf16_f32 v76, v192, v193
    v_cvt_pk_bf16_f32 v77, v194, v195
    ds_write_b64 v25, v[76:77] offset:18432
    v_cvt_pk_bf16_f32 v48, v148, v149
    v_cvt_pk_bf16_f32 v49, v150, v151
    ds_write_b64 v24, v[48:49] offset:0
    v_cvt_pk_bf16_f32 v52, v152, v153
    v_cvt_pk_bf16_f32 v53, v154, v155
    ds_write_b64 v25, v[52:53] offset:0
    v_cvt_pk_bf16_f32 v56, v156, v157
    v_cvt_pk_bf16_f32 v57, v158, v159
    ds_write_b64 v24, v[56:57] offset:6144
    v_cvt_pk_bf16_f32 v60, v160, v161
    v_cvt_pk_bf16_f32 v61, v162, v163
    ds_write_b64 v25, v[60:61] offset:6144
    s_add_u32 s56, s37, 2
    s_and_b32 s55, s56, 3
    s_mul_i32 s55, s55, 114688
    s_add_u32 s55, s55, 65536
    s_add_u32 s45, s38, s55
    s_add_u32 s46, s45, 4096
    s_add_u32 s47, s45, 8192
    s_add_u32 s56, s37, -1
    s_and_b32 s55, s56, 3
    s_mul_i32 s55, s55, 114688
    s_add_u32 s55, s55, 53248
    s_add_u32 s48, s38, s55
    s_and_b32 s55, s56, 1
    s_add_u32 s56, s56, 1
    v_mov_b32 v35, -16
    v_writelane_b32 v35, s56, 12
    s_mul_i32 s55, s55, 12288
    s_add_u32 m0, s54, s55
    v_add_u32 v35, -1, v34
    buffer_load_dword v36, v33, s[4:7], s38 offen sc1
    s_waitcnt vmcnt(0)
    v_cmp_lt_i32 vcc, v36, v35
    s_cbranch_vccz L_fok_100
L_fw_99:
    buffer_load_dword v36, v33, s[4:7], s38 offen sc1
    s_sub_u32 s36, s36, 1
    s_cbranch_scc1 L_exit
    s_waitcnt vmcnt(0)
    v_cmp_lt_i32 vcc, v36, v35
    s_cbranch_vccnz L_fw_99
L_fok_100:
    buffer_load_dwordx4 a[96:99], v40, s[4:7], s45 offen offset:0 sc1
    buffer_load_dwordx4 a[100:103], v40, s[4:7], s45 offen offset:1024 sc1
    buffer_load_dwordx4 a[104:107], v40, s[4:7], s45 offen offset:2048 sc1
    buffer_load_dwordx4 a[108:111], v40, s[4:7], s45 offen offset:3072 sc1
    buffer_load_dwordx4 a[112:115], v40, s[4:7], s46 offen offset:0 sc1
    buffer_load_dwordx4 a[116:119], v40, s[4:7], s46 offen offset:1024 sc1
    buffer_load_dwordx4 a[120:123], v40, s[4:7], s46 offen offset:2048 sc1
    buffer_load_dwordx4 a[124:127], v40, s[4:7], s46 offen offset:3072 sc1
    buffer_load_dwordx4 a[128:131], v40, s[4:7], s47 offen offset:0 sc1
    buffer_load_dwordx4 a[132:135], v40, s[4:7], s47 offen offset:1024 sc1
    buffer_load_dwordx4 a[136:139], v40, s[4:7], s47 offen offset:2048 sc1
    buffer_load_dwordx4 a[140:143], v40, s[4:7], s47 offen offset:3072 sc1
    s_mov_b32 s50, s42
    s_add_u32 s56, s37, 1
    v_mov_b32 v47, v24
    s_and_b32 s55, s56, 3
    s_mul_i32 s41, s55, 327680
    s_mul_i32 s56, s55, 114688
    s_add_u32 s43, s38, s56
    s_xor_b32 s55, s55, 2
    s_mul_i32 s42, s55, 327680
    s_add_u32 s56, s37, 2
    v_mov_b32 v107, s56
    s_and_b32 s55, s56, 3
    s_mul_i32 s44, s55, 24576
    s_add_u32 s56, s37, -1
    s_and_b32 s55, s56, 3
    s_mul_i32 s55, s55, 40960
    s_add_u32 s49, s55, s38
    s_add_u32 s56, s37, -1
    s_and_b32 s55, s56, 3
    s_mul_i32 s55, s55, 24576
    v_add_u32 v26, s55, v22
    v_add_u32 v27, s55, v23
    s_and_b32 s55, s56, 1
    s_mul_i32 s55, s55, 12288
    v_add_u32 v29, s55, v28
    s_add_u32 s37, s37, 1
    s_mov_b32 m0, s53
    v_add_u32 v24, s44, v20
    v_add_u32 v25, s44, v21
    v_pk_mul_f32 v[148:149], v[210:211], v[210:211]
    v_pk_mul_f32 v[150:151], v[210:211], v[210:211]
    v_pk_mul_f32 v[152:153], v[210:211], v[210:211]
    v_pk_mul_f32 v[154:155], v[210:211], v[210:211]
    v_pk_mul_f32 v[156:157], v[210:211], v[210:211]
    v_pk_mul_f32 v[158:159], v[210:211], v[210:211]
    v_pk_mul_f32 v[160:161], v[210:211], v[210:211]
    v_pk_mul_f32 v[162:163], v[210:211], v[210:211]
    v_mov_b32 v120, 0
    v_mov_b32 v121, 0
    v_mov_b32 v122, 0
    v_mov_b32 v123, 0
    v_mov_b32 v124, 0
    v_mov_b32 v125, 0
    v_mov_b32 v126, 0
    v_mov_b32 v127, 0
    v_mov_b32 v128, 0
    v_mov_b32 v129, 0
    v_mov_b32 v130, 0
    v_mov_b32 v131, 0
    v_mov_b32 v132, 0
    v_mov_b32 v133, 0
    v_mov_b32 v134, 0
    v_mov_b32 v135, 0
    v_mov_b32 v116, 0
    v_mov_b32 v117, 0
    v_mov_b32 v118, 0
    v_mov_b32 v119, 0
L_wo_loop_s:
    buffer_load_dword v41, v245, s[4:7], s38 offen sc1
    buffer_load_dword v41, v245, s[4:7], s38 offen sc1
    buffer_load_dword v41, v245, s[4:7], s38 offen sc1
    buffer_load_dword v41, v245, s[4:7], s38 offen sc1
    buffer_load_dword v41, v245, s[4:7], s38 offen sc1
    buffer_load_dword v41, v245, s[4:7], s38 offen sc1
L_sp_104:
    s_waitcnt vmcnt(5)
    v_cmp_ge_u32 vcc, s37, v41
    buffer_load_dword v41, v245, s[4:7], s38 offen sc1
    s_sub_u32 s36, s36, 1
    s_cbranch_scc1 L_exit
    s_cbranch_vccz L_sp_104x
    s_waitcnt vmcnt(5)
    v_cmp_ge_u32 vcc, s37, v41
    buffer_load_dword v41, v245, s[4:7], s38 offen sc1
    s_cbranch_vccz L_sp_104x
    s_waitcnt vmcnt(5)
    v_cmp_ge_u32 vcc, s37, v41
    buffer_load_dword v41, v245, s[4:7], s38 offen sc1
    s_cbranch_vccz L_sp_104x
    s_waitcnt vmcnt(5)
    v_cmp_ge_u32 vcc, s37, v41
    buffer_load_dword v41, v245, s[4:7], s38 offen sc1
    s_cbranch_vccnz L_sp_104
L_sp_104x:
    buffer_load_dwordx4 v44, s[4:7], s43 offen offset:0 sc1 lds
    buffer_load_dwordx4 v44, s[4:7], s43 offen offset:1024 sc1 lds
    buffer_load_dwordx4 v44, s[4:7], s43 offen offset:2048 sc1 lds
    s_waitcnt vmcnt(2)
    ds_read_b64_tr_b16 v[136:137], v16 offset:0
    ds_read_b64_tr_b16 v[138:139], v13 offset:0
    s_waitcnt vmcnt(1)
    ds_read_b64_tr_b16 v[140:141], v16 offset:1024
    ds_read_b64_tr_b16 v[142:143], v13 offset:1024
    s_waitcnt vmcnt(0)
    ds_read_b64_tr_b16 v[144:145], v16 offset:2048
    ds_read_b64_tr_b16 v[146:147], v13 offset:2048
    buffer_load_dwordx4 v[92:95], v38, s[4:7], s43 offen offset:0 sc1
    buffer_load_dwordx4 v[96:99], v38, s[4:7], s43 offen offset:1280 sc1
    buffer_load_dwordx4 v[100:103], v38, s[4:7], s43 offen offset:2560 sc1
    s_cmp_eq_u32 s37, 63
    s_waitcnt lgkmcnt(4)
    v_smfmac_f32_16x16x64_bf16 v[148:151], v[136:139], a[0:7], v10
    v_smfmac_f32_16x16x64_bf16 v[152:155], v[136:139], a[24:31], v10
    v_smfmac_f32_16x16x64_bf16 v[156:159], v[136:139], a[48:55], v10
    buffer_load_dword v104, v39, s[4:7], s43 offen offset:0 sc1
    v_smfmac_f32_16x16x64_bf16 v[160:163], v[136:139], a[72:79], v10
    buffer_load_dword v105, v39, s[4:7], s43 offen offset:1280 sc1
    s_waitcnt lgkmcnt(2)
    v_smfmac_f32_16x16x64_bf16 v[148:151], v[140:143], a[8:15], v10
    buffer_load_dword v106, v39, s[4:7], s43 offen offset:2560 sc1
    v_smfmac_f32_16x16x64_bf16 v[152:155], v[140:143], a[32:39], v10
    v_smfmac_f32_16x16x64_bf16 v[156:159], v[140:143], a[56:63], v10
    v_smfmac_f32_16x16x64_bf16 v[160:163], v[140:143], a[80:87], v10
    s_waitcnt lgkmcnt(0)
    v_smfmac_f32_16x16x64_bf16 v[148:151], v[144:147], a[16:23], v10
    v_smfmac_f32_16x16x64_bf16 v[152:155], v[144:147], a[40:47], v10
    v_smfmac_f32_16x16x64_bf16 v[156:159], v[144:147], a[64:71], v10
    v_smfmac_f32_16x16x64_bf16 v[160:163], v[144:147], a[88:95], v10
    v_pk_add_f32 v[148:149], v[148:149], v[150:151]
    v_cmp_u_f32 vcc, v148, v149
    v_cvt_pk_bf16_f32 v50, v148, v149
    v_cvt_pk_bf16_f32 v54, v148, v149
    v_pk_add_f32 v[152:153], v[152:153], v[154:155]
    v_cvt_pk_bf16_f32 v58, v152, v153
    v_cvt_pk_bf16_f32 v62, v152, v153
    v_pk_add_f32 v[156:157], v[156:157], v[158:159]
    v_cvt_pk_bf16_f32 v66, v156, v157
    v_cvt_pk_bf16_f32 v70, v156, v157
    v_pk_add_f32 v[160:161], v[160:161], v[162:163]
    v_cvt_pk_bf16_f32 v74, v160, v161
    v_cvt_pk_bf16_f32 v78, v160, v161
    s_cbranch_vccnz L_vm_102
L_u_103:
    s_cbranch_scc1 L_wo_tail_s
L_sc_105:
    s_waitcnt vmcnt(4)
    v_pk_add_f32 v[236:237], v[92:93], v[96:97]
    v_pk_add_f32 v[238:239], v[94:95], v[98:99]
    s_waitcnt vmcnt(3)
    v_pk_add_f32 v[236:237], v[236:237], v[100:101]
    v_pk_add_f32 v[238:239], v[238:239], v[102:103]
    v_max3_f32 v41, v236, v237, v238
    v_pk_add_f32 v[242:243], v[236:237], v[238:239]
    s_waitcnt vmcnt(0)
    v_add_f32 v43, v104, v105
    v_add_f32 v43, v43, v106
    v_max3_f32 v41, v41, v239, v43
    v_add_f32 v242, v242, v43
    s_nop 0
    v_max_f32_dpp v42, v41, v41 quad_perm:[2,3,0,1] row_mask:0xf bank_mask:0xf
    v_max_f32_dpp v41, v41, v41 quad_perm:[2,3,0,1] row_mask:0xf bank_mask:0xf
    v_cmp_u_f32 vcc, v242, v243
    s_nop 0
    v_permlane16_swap_b32 v41, v42
    v_max_f32 v41, v41, v42
    v_mov_b32 v42, v41
    s_cbranch_vccnz L_sp_106
L_sg_107:
    s_nop 0
    v_permlane32_swap_b32 v41, v42
    v_max_f32 v41, v41, v42
    v_mul_f32 v242, 0xbdd53b95, v41
    v_pk_fma_f32 v[236:237], v[236:237], v[240:241], v[242:243] op_sel_hi:[1,1,0]
    v_pk_fma_f32 v[238:239], v[238:239], v[240:241], v[242:243] op_sel_hi:[1,1,0]
    v_fma_f32 v43, v43, v240, v242
    v_exp_f32 v236, v236
    v_exp_f32 v237, v237
    v_exp_f32 v238, v238
    v_exp_f32 v239, v239
    v_exp_f32 v43, v43
    v_cvt_pk_bf16_f32 v80, v236, v237
    v_cvt_pk_bf16_f32 v82, v238, v239
    v_cvt_pk_bf16_f32 v81, v43, 0
    v_cvt_pk_bf16_f32 v83, v43, 0
    s_nop 1
    v_smfmac_f32_16x16x64_bf16 v[116:119], v[80:83], v[84:91], v11
    v_smfmac_f32_16x16x64_bf16 v[120:123], v[80:83], v[48:55], v11
    v_smfmac_f32_16x16x64_bf16 v[124:127], v[80:83], v[56:63], v11
    v_smfmac_f32_16x16x64_bf16 v[128:131], v[80:83], v[64:71], v11
    v_add_f32 v116, v116, v118
    v_add_f32 v117, v117, v119
    v_smfmac_f32_16x16x64_bf16 v[132:135], v[80:83], v[72:79], v11
    v_rcp_f32 v116, v116
    v_rcp_f32 v117, v117
    v_pk_add_f32 v[120:121], v[120:121], v[122:123]
    v_pk_mul_f32 v[120:121], v[120:121], v[116:117]
    v_cvt_pk_bf16_f32 v236, v120, v121
    v_pk_add_f32 v[124:125], v[124:125], v[126:127]
    v_pk_mul_f32 v[124:125], v[124:125], v[116:117]
    v_cvt_pk_bf16_f32 v237, v124, v125
    ds_write2st64_b32 v18, v236, v237 offset0:0 offset1:1
    v_pk_add_f32 v[128:129], v[128:129], v[130:131]
    v_pk_mul_f32 v[128:129], v[128:129], v[116:117]
    v_cvt_pk_bf16_f32 v238, v128, v129
    v_pk_add_f32 v[132:133], v[132:133], v[134:135]
    v_pk_mul_f32 v[132:133], v[132:133], v[116:117]
    v_cvt_pk_bf16_f32 v239, v132, v133
    ds_write2st64_b32 v18, v238, v239 offset0:2 offset1:3
    buffer_store_dword v107, v244, s[4:7], s38 offen sc1
    v_mov_b32 v120, 0
    v_mov_b32 v121, 0
    v_mov_b32 v122, 0
    v_mov_b32 v123, 0
    v_mov_b32 v124, 0
    v_mov_b32 v125, 0
    v_mov_b32 v126, 0
    v_mov_b32 v127, 0
    v_mov_b32 v128, 0
    v_mov_b32 v129, 0
    s_waitcnt lgkmcnt(0)
    s_barrier
    ds_read_b64_tr_b16 v[80:81], v19
    ds_read_b64_tr_b16 v[82:83], v19 offset:128
    v_mov_b32 v130, 0
    v_mov_b32 v131, 0
    v_mov_b32 v132, 0
    v_mov_b32 v133, 0
    v_mov_b32 v134, 0
    v_mov_b32 v135, 0
    v_mov_b32 v116, 0
    v_mov_b32 v117, 0
    v_mov_b32 v118, 0
    v_mov_b32 v119, 0
    s_waitcnt lgkmcnt(0)
    v_mfma_f32_16x16x32_bf16 v[172:175], v[110:113], v[80:83], 0
    v_mfma_f32_16x16x32_bf16 v[176:179], v[108:111], v[80:83], 0
    buffer_load_dword v36, v33, s[4:7], s38 offen sc1
    s_nop 3
    v_cvt_pk_bf16_f32 v236, v172, v173
    v_cvt_pk_bf16_f32 v237, v174, v175
    s_nop 0
    v_cvt_pk_bf16_f32 v238, v176, v177
    v_cvt_pk_bf16_f32 v239, v178, v179
    buffer_store_dwordx4 v[236:239], v14, s[4:7], s41 offen sc1
    ds_write_b32 v47, v50 offset:8
    ds_write_b32 v47, v58 offset:6152
    ds_write_b32 v47, v66 offset:12296
    ds_write_b32 v47, v74 offset:18440
    ds_read_b128 v[204:207], v26 offset:0
    ds_read_b128 v[180:183], v29 offset:0
    ds_read_b128 v[184:187], v29 offset:1024
    ds_read_b64 v[208:209], v27 offset:0
    ds_read_b128 v[188:191], v29 offset:2048
    ds_read_b128 v[212:215], v26 offset:1536
    ds_read_b128 v[192:195], v29 offset:3072
    ds_read_b128 v[196:199], v29 offset:4096
    ds_read_b64 v[216:217], v27 offset:1536
    ds_read_b128 v[200:203], v29 offset:5120
    s_add_u32 s55, s42, s60
    buffer_store_dword v168, v46, s[4:7], s55 offen sc1
    s_add_u32 s55, s42, s61
    buffer_store_dword v168, v46, s[4:7], s55 offen sc1
    s_waitcnt lgkmcnt(5)
    v_mfma_f32_16x16x32_bf16 v[220:223], v[180:183], v[204:207], 0
    v_mfma_f32_16x16x32_bf16 v[224:227], v[184:187], v[204:207], 0
    v_mfma_f32_16x16x32_bf16 v[224:227], v[188:191], v[208:211], v[224:227]
    ds_read_b128 v[204:207], v26 offset:3072
    ds_read_b128 v[180:183], v29 offset:6144
    ds_read_b128 v[184:187], v29 offset:7168
    ds_read_b64 v[208:209], v27 offset:3072
    ds_read_b128 v[188:191], v29 offset:8192
    s_add_u32 s56, s37, 2
    s_and_b32 s55, s56, 3
    s_mul_i32 s55, s55, 114688
    s_add_u32 s55, s55, 65536
    s_add_u32 s45, s38, s55
    s_add_u32 s46, s45, 4096
    s_add_u32 s47, s45, 8192
    s_add_u32 s56, s37, -1
    s_and_b32 s55, s56, 3
    s_mul_i32 s55, s55, 114688
    s_add_u32 s55, s55, 53248
    s_add_u32 s48, s38, s55
    s_and_b32 s55, s56, 1
    s_add_u32 s56, s56, 1
    v_mov_b32 v35, -16
    v_writelane_b32 v35, s56, 12
    s_mul_i32 s55, s55, 12288
    s_add_u32 m0, s54, s55
    s_waitcnt lgkmcnt(5)
    v_mfma_f32_16x16x32_bf16 v[220:223], v[192:195], v[212:215], v[220:223]
    v_mfma_f32_16x16x32_bf16 v[224:227], v[196:199], v[212:215], v[224:227]
    v_mfma_f32_16x16x32_bf16 v[224:227], v[200:203], v[216:219], v[224:227]
    ds_read_b128 v[212:215], v26 offset:4608
    ds_read_b128 v[192:195], v29 offset:9216
    ds_read_b128 v[196:199], v29 offset:10240
    ds_read_b64 v[216:217], v27 offset:4608
    ds_read_b128 v[200:203], v29 offset:11264
    s_waitcnt lgkmcnt(5)
    v_mfma_f32_16x16x32_bf16 v[220:223], v[180:183], v[204:207], v[220:223]
    v_mfma_f32_16x16x32_bf16 v[224:227], v[184:187], v[204:207], v[224:227]
    v_mfma_f32_16x16x32_bf16 v[224:227], v[188:191], v[208:211], v[224:227]
    s_waitcnt lgkmcnt(0)
    v_mfma_f32_16x16x32_bf16 v[220:223], v[192:195], v[212:215], v[220:223]
    v_mfma_f32_16x16x32_bf16 v[224:227], v[196:199], v[212:215], v[224:227]
    v_mfma_f32_16x16x32_bf16 v[224:227], v[200:203], v[216:219], v[224:227]
    s_waitcnt vmcnt(3)
    v_cmp_lt_i32 vcc, v36, v35
    s_cbranch_vccz L_fok_110
L_fw_109:
    buffer_load_dword v36, v33, s[4:7], s38 offen sc1
    s_sub_u32 s36, s36, 1
    s_cbranch_scc1 L_exit
    s_waitcnt vmcnt(0)
    v_cmp_lt_i32 vcc, v36, v35
    s_cbranch_vccnz L_fw_109
L_fok_110:
    buffer_load_dwordx4 v37, s[4:7], s48 offen offset:0 sc1 lds
    buffer_load_dwordx4 v37, s[4:7], s48 offen offset:1024 sc1 lds
    buffer_load_dwordx4 v37, s[4:7], s48 offen offset:2048 sc1 lds
    v_cvt_pk_bf16_f32 v220, v220, v221
    v_cvt_pk_bf16_f32 v221, v222, v223
    v_cvt_pk_bf16_f32 v222, v224, v225
    v_cvt_pk_bf16_f32 v223, v226, v227
    v_mov_b32 v224, v220
    v_mov_b32 v225, v221
    v_mov_b32_dpp v220, v222 row_ror:8 row_mask:0xf bank_mask:0xc
    v_mov_b32_dpp v221, v223 row_ror:8 row_mask:0xf bank_mask:0xc
    v_mov_b32_dpp v222, v224 row_ror:8 row_mask:0xf bank_mask:0x3
    v_mov_b32_dpp v223, v225 row_ror:8 row_mask:0xf bank_mask:0x3
    buffer_store_dwordx4 v[220:223], v15, s[4:7], s49 offen sc1
    v_mfma_f32_16x16x32_bf16 v[148:151], a[96:99], a[0:3], 0
    s_mov_b32 s50, s42
    s_add_u32 s56, s37, 1
    v_mov_b32 v47, v24
    v_mfma_f32_16x16x32_bf16 v[152:155], a[120:123], a[0:3], 0
    s_and_b32 s55, s56, 3
    s_mul_i32 s41, s55, 327680
    s_mul_i32 s56, s55, 114688
    v_mfma_f32_16x16x32_bf16 v[156:159], a[96:99], a[24:27], 0
    s_add_u32 s43, s38, s56
    s_xor_b32 s55, s55, 2
    s_mul_i32 s42, s55, 327680
    v_mfma_f32_16x16x32_bf16 v[160:163], a[120:123], a[24:27], 0
    s_add_u32 s56, s37, 2
    v_mov_b32 v107, s56
    s_and_b32 s55, s56, 3
    v_mfma_f32_16x16x32_bf16 v[180:183], a[96:99], a[48:51], 0
    s_mul_i32 s44, s55, 24576
    s_add_u32 s56, s37, -1
    s_and_b32 s55, s56, 3
    v_mfma_f32_16x16x32_bf16 v[184:187], a[120:123], a[48:51], 0
    s_mul_i32 s55, s55, 40960
    s_add_u32 s49, s55, s38
    s_add_u32 s56, s37, -1
    v_mfma_f32_16x16x32_bf16 v[188:191], a[96:99], a[72:75], 0
    s_and_b32 s55, s56, 3
    s_mul_i32 s55, s55, 24576
    v_add_u32 v26, s55, v22
    v_mfma_f32_16x16x32_bf16 v[192:195], a[120:123], a[72:75], 0
    buffer_load_dwordx4 a[96:99], v40, s[4:7], s45 offen offset:0 sc1
    v_mfma_f32_16x16x32_bf16 v[148:151], a[100:103], a[4:7], v[148:151]
    v_add_u32 v27, s55, v23
    s_and_b32 s55, s56, 1
    s_mul_i32 s55, s55, 12288
    v_mfma_f32_16x16x32_bf16 v[152:155], a[124:127], a[4:7], v[152:155]
    buffer_load_dwordx4 a[120:123], v40, s[4:7], s46 offen offset:2048 sc1
    v_mfma_f32_16x16x32_bf16 v[156:159], a[100:103], a[28:31], v[156:159]
    v_add_u32 v29, s55, v28
    v_mfma_f32_16x16x32_bf16 v[160:163], a[124:127], a[28:31], v[160:163]
    v_mfma_f32_16x16x32_bf16 v[180:183], a[100:103], a[52:55], v[180:183]
    v_mfma_f32_16x16x32_bf16 v[184:187], a[124:127], a[52:55], v[184:187]
    v_mfma_f32_16x16x32_bf16 v[188:191], a[100:103], a[76:79], v[188:191]
    v_mfma_f32_16x16x32_bf16 v[192:195], a[124:127], a[76:79], v[192:195]
    buffer_load_dwordx4 a[100:103], v40, s[4:7], s45 offen offset:1024 sc1
    v_mfma_f32_16x16x32_bf16 v[148:151], a[104:107], a[8:11], v[148:151]
    v_mfma_f32_16x16x32_bf16 v[152:155], a[128:131], a[8:11], v[152:155]
    buffer_load_dwordx4 a[124:127], v40, s[4:7], s46 offen offset:3072 sc1
    v_mfma_f32_16x16x32_bf16 v[156:159], a[104:107], a[32:35], v[156:159]
    v_mfma_f32_16x16x32_bf16 v[160:163], a[128:131], a[32:35], v[160:163]
    v_mfma_f32_16x16x32_bf16 v[180:183], a[104:107], a[56:59], v[180:183]
    v_mfma_f32_16x16x32_bf16 v[184:187], a[128:131], a[56:59], v[184:187]
    v_mfma_f32_16x16x32_bf16 v[188:191], a[104:107], a[80:83], v[188:191]
    v_mfma_f32_16x16x32_bf16 v[192:195], a[128:131], a[80:83], v[192:195]
    buffer_load_dwordx4 a[104:107], v40, s[4:7], s45 offen offset:2048 sc1
    v_mfma_f32_16x16x32_bf16 v[148:151], a[108:111], a[12:15], v[148:151]
    v_mfma_f32_16x16x32_bf16 v[152:155], a[132:135], a[12:15], v[152:155]
    buffer_load_dwordx4 a[128:131], v40, s[4:7], s47 offen offset:0 sc1
    v_mfma_f32_16x16x32_bf16 v[156:159], a[108:111], a[36:39], v[156:159]
    v_mfma_f32_16x16x32_bf16 v[160:163], a[132:135], a[36:39], v[160:163]
    v_mfma_f32_16x16x32_bf16 v[180:183], a[108:111], a[60:63], v[180:183]
    v_mfma_f32_16x16x32_bf16 v[184:187], a[132:135], a[60:63], v[184:187]
    v_mfma_f32_16x16x32_bf16 v[188:191], a[108:111], a[84:87], v[188:191]
    v_mfma_f32_16x16x32_bf16 v[192:195], a[132:135], a[84:87], v[192:195]
    buffer_load_dwordx4 a[108:111], v40, s[4:7], s45 offen offset:3072 sc1
    v_mfma_f32_16x16x32_bf16 v[148:151], a[112:115], a[16:19], v[148:151]
    v_mfma_f32_16x16x32_bf16 v[152:155], a[136:139], a[16:19], v[152:155]
    buffer_load_dwordx4 a[132:135], v40, s[4:7], s47 offen offset:1024 sc1
    v_mfma_f32_16x16x32_bf16 v[156:159], a[112:115], a[40:43], v[156:159]
    v_mfma_f32_16x16x32_bf16 v[160:163], a[136:139], a[40:43], v[160:163]
    v_mfma_f32_16x16x32_bf16 v[180:183], a[112:115], a[64:67], v[180:183]
    v_mfma_f32_16x16x32_bf16 v[184:187], a[136:139], a[64:67], v[184:187]
    v_mfma_f32_16x16x32_bf16 v[188:191], a[112:115], a[88:91], v[188:191]
    v_mfma_f32_16x16x32_bf16 v[192:195], a[136:139], a[88:91], v[192:195]
    v_mfma_f32_16x16x32_bf16 v[148:151], a[116:119], a[20:23], v[148:151]
    v_mfma_f32_16x16x32_bf16 v[152:155], a[140:143], a[20:23], v[152:155]
    v_mfma_f32_16x16x32_bf16 v[156:159], a[116:119], a[44:47], v[156:159]
    v_mfma_f32_16x16x32_bf16 v[160:163], a[140:143], a[44:47], v[160:163]
    v_mfma_f32_16x16x32_bf16 v[180:183], a[116:119], a[68:71], v[180:183]
    v_mfma_f32_16x16x32_bf16 v[184:187], a[140:143], a[68:71], v[184:187]
    v_mfma_f32_16x16x32_bf16 v[188:191], a[116:119], a[92:95], v[188:191]
    v_mfma_f32_16x16x32_bf16 v[192:195], a[140:143], a[92:95], v[192:195]
    v_cvt_pk_bf16_f32 v64, v180, v181
    v_cvt_pk_bf16_f32 v65, v182, v183
    ds_write_b64 v24, v[64:65] offset:12288
    v_cvt_pk_bf16_f32 v68, v184, v185
    v_cvt_pk_bf16_f32 v69, v186, v187
    ds_write_b64 v25, v[68:69] offset:12288
    v_cvt_pk_bf16_f32 v72, v188, v189
    v_cvt_pk_bf16_f32 v73, v190, v191
    ds_write_b64 v24, v[72:73] offset:18432
    v_cvt_pk_bf16_f32 v76, v192, v193
    v_cvt_pk_bf16_f32 v77, v194, v195
    ds_write_b64 v25, v[76:77] offset:18432
    v_cvt_pk_bf16_f32 v48, v148, v149
    v_cvt_pk_bf16_f32 v49, v150, v151
    ds_write_b64 v24, v[48:49] offset:0
    v_cvt_pk_bf16_f32 v52, v152, v153
    v_cvt_pk_bf16_f32 v53, v154, v155
    ds_write_b64 v25, v[52:53] offset:0
    v_cvt_pk_bf16_f32 v56, v156, v157
    v_cvt_pk_bf16_f32 v57, v158, v159
    ds_write_b64 v24, v[56:57] offset:6144
    v_cvt_pk_bf16_f32 v60, v160, v161
    v_cvt_pk_bf16_f32 v61, v162, v163
    ds_write_b64 v25, v[60:61] offset:6144
    s_add_u32 s37, s37, 1
    s_mov_b32 m0, s53
    v_add_u32 v24, s44, v20
    v_add_u32 v25, s44, v21
    v_pk_mul_f32 v[148:149], v[210:211], v[210:211]
    v_pk_mul_f32 v[150:151], v[210:211], v[210:211]
    v_pk_mul_f32 v[152:153], v[210:211], v[210:211]
    v_pk_mul_f32 v[154:155], v[210:211], v[210:211]
    v_pk_mul_f32 v[156:157], v[210:211], v[210:211]
    v_pk_mul_f32 v[158:159], v[210:211], v[210:211]
    v_pk_mul_f32 v[160:161], v[210:211], v[210:211]
    v_pk_mul_f32 v[162:163], v[210:211], v[210:211]
    buffer_load_dwordx4 a[112:115], v40, s[4:7], s46 offen offset:0 sc1
    buffer_load_dwordx4 a[136:139], v40, s[4:7], s47 offen offset:2048 sc1
    buffer_load_dwordx4 a[116:119], v40, s[4:7], s46 offen offset:1024 sc1
    buffer_load_dwordx4 a[140:143], v40, s[4:7], s47 offen offset:3072 sc1
    s_branch L_wo_loop_s
L_wo_tail_s:
    ds_write_b32 v47, v50 offset:8
    ds_write_b32 v47, v58 offset:6152
    ds_write_b32 v47, v66 offset:12296
    ds_write_b32 v47, v74 offset:18440
    s_add_u32 s91, s38, 81920
    buffer_load_dwordx4 v[120:123], v15, s[4:7], s91 offen sc1
    s_add_u32 s91, s38, 122880
    buffer_load_dwordx4 v[124:127], v15, s[4:7], s91 offen sc1
    s_add_u32 s56, s37, -1
    s_and_b32 s55, s56, 3
    s_mul_i32 s55, s55, 114688
    s_add_u32 s55, s55, 53248
    s_add_u32 s48, s38, s55
    s_and_b32 s55, s56, 1
    s_add_u32 s56, s56, 1
    v_mov_b32 v35, -16
    v_writelane_b32 v35, s56, 12
    s_mul_i32 s55, s55, 12288
    s_add_u32 m0, s54, s55
    buffer_load_dword v36, v33, s[4:7], s38 offen sc1
    v_mov_b32 v3, 204
L_p0_111:
    buffer_load_dword v4, v3, s[8:11], 0 offen sc1
    s_sub_u32 s36, s36, 1
    s_cbranch_scc1 L_exit
    s_waitcnt vmcnt(0)
    v_readfirstlane_b32 s90, v4
    s_nop 0
    s_cmp_eq_u32 s90, 0
    s_cbranch_scc1 L_p0_111
    s_and_b32 s90, s90, 2
    s_lshl_b32 s90, s90, 12
    v_xor_b32 v30, s90, v30
    v_xor_b32 v31, s90, v31
    s_waitcnt lgkmcnt(0)
    s_barrier
    v_cmp_lt_i32 vcc, v36, v35
    s_cbranch_vccz L_fok_113
L_fw_112:
    buffer_load_dword v36, v33, s[4:7], s38 offen sc1
    s_sub_u32 s36, s36, 1
    s_cbranch_scc1 L_exit
    s_waitcnt vmcnt(0)
    v_cmp_lt_i32 vcc, v36, v35
    s_cbranch_vccnz L_fw_112
L_fok_113:
    buffer_load_dwordx4 v37, s[4:7], s48 offen offset:0 sc1 lds
    buffer_load_dwordx4 v37, s[4:7], s48 offen offset:1024 sc1 lds
    buffer_load_dwordx4 v37, s[4:7], s48 offen offset:2048 sc1 lds
    v_mov_b32 v128, v220
    v_mov_b32 v129, v221
    v_mov_b32 v130, v222
    v_mov_b32 v131, v223
    s_add_u32 s56, s37, -2
    s_and_b32 s55, s56, 3
    s_mul_i32 s55, s55, 24576
    v_add_u32 v26, s55, v22
    v_add_u32 v27, s55, v23
    s_and_b32 s55, s56, 1
    s_mul_i32 s55, s55, 12288
    v_add_u32 v29, s55, v28
    ds_read_b128 v[204:207], v26 offset:0
    ds_read_b128 v[180:183], v29 offset:0
    ds_read_b128 v[184:187], v29 offset:1024
    ds_read_b64 v[208:209], v27 offset:0
    ds_read_b128 v[188:191], v29 offset:2048
    ds_read_b128 v[212:215], v26 offset:1536
    ds_read_b128 v[192:195], v29 offset:3072
    ds_read_b128 v[196:199], v29 offset:4096
    ds_read_b64 v[216:217], v27 offset:1536
    ds_read_b128 v[200:203], v29 offset:5120
    s_waitcnt lgkmcnt(5)
    v_mfma_f32_16x16x32_bf16 v[220:223], v[180:183], v[204:207], 0
    v_mfma_f32_16x16x32_bf16 v[224:227], v[184:187], v[204:207], 0
    v_mfma_f32_16x16x32_bf16 v[224:227], v[188:191], v[208:211], v[224:227]
    ds_read_b128 v[204:207], v26 offset:3072
    ds_read_b128 v[180:183], v29 offset:6144
    ds_read_b128 v[184:187], v29 offset:7168
    ds_read_b64 v[208:209], v27 offset:3072
    ds_read_b128 v[188:191], v29 offset:8192
    s_waitcnt lgkmcnt(5)
    v_mfma_f32_16x16x32_bf16 v[220:223], v[192:195], v[212:215], v[220:223]
    v_mfma_f32_16x16x32_bf16 v[224:227], v[196:199], v[212:215], v[224:227]
    v_mfma_f32_16x16x32_bf16 v[224:227], v[200:203], v[216:219], v[224:227]
    ds_read_b128 v[212:215], v26 offset:4608
    ds_read_b128 v[192:195], v29 offset:9216
    ds_read_b128 v[196:199], v29 offset:10240
    ds_read_b64 v[216:217], v27 offset:4608
    ds_read_b128 v[200:203], v29 offset:11264
    s_waitcnt lgkmcnt(5)
    v_mfma_f32_16x16x32_bf16 v[220:223], v[180:183], v[204:207], v[220:223]
    v_mfma_f32_16x16x32_bf16 v[224:227], v[184:187], v[204:207], v[224:227]
    v_mfma_f32_16x16x32_bf16 v[224:227], v[188:191], v[208:211], v[224:227]
    s_waitcnt lgkmcnt(0)
    v_mfma_f32_16x16x32_bf16 v[220:223], v[192:195], v[212:215], v[220:223]
    v_mfma_f32_16x16x32_bf16 v[224:227], v[196:199], v[212:215], v[224:227]
    v_mfma_f32_16x16x32_bf16 v[224:227], v[200:203], v[216:219], v[224:227]
    s_nop 0
    v_cvt_pk_bf16_f32 v220, v220, v221
    v_cvt_pk_bf16_f32 v221, v222, v223
    s_nop 4
    v_cvt_pk_bf16_f32 v222, v224, v225
    v_cvt_pk_bf16_f32 v223, v226, v227
    v_mov_b32 v224, v220
    v_mov_b32 v225, v221
    v_mov_b32_dpp v220, v222 row_ror:8 row_mask:0xf bank_mask:0xc
    v_mov_b32_dpp v221, v223 row_ror:8 row_mask:0xf bank_mask:0xc
    v_mov_b32_dpp v222, v224 row_ror:8 row_mask:0xf bank_mask:0x3
    v_mov_b32_dpp v223, v225 row_ror:8 row_mask:0xf bank_mask:0x3
    v_mov_b32 v132, v220
    v_mov_b32 v133, v221
    v_mov_b32 v134, v222
    v_mov_b32 v135, v223
    s_waitcnt vmcnt(0)
    s_barrier
    s_add_u32 s56, s37, -1
    s_and_b32 s55, s56, 3
    s_mul_i32 s55, s55, 24576
    v_add_u32 v26, s55, v22
    v_add_u32 v27, s55, v23
    s_and_b32 s55, s56, 1
    s_mul_i32 s55, s55, 12288
    v_add_u32 v29, s55, v28
    ds_read_b128 v[204:207], v26 offset:0
    ds_read_b128 v[180:183], v29 offset:0
    ds_read_b128 v[184:187], v29 offset:1024
    ds_read_b64 v[208:209], v27 offset:0
    ds_read_b128 v[188:191], v29 offset:2048
    ds_read_b128 v[212:215], v26 offset:1536
    ds_read_b128 v[192:195], v29 offset:3072
    ds_read_b128 v[196:199], v29 offset:4096
    ds_read_b64 v[216:217], v27 offset:1536
    ds_read_b128 v[200:203], v29 offset:5120
    s_waitcnt lgkmcnt(5)
    v_mfma_f32_16x16x32_bf16 v[220:223], v[180:183], v[204:207], 0
    v_mfma_f32_16x16x32_bf16 v[224:227], v[184:187], v[204:207], 0
    v_mfma_f32_16x16x32_bf16 v[224:227], v[188:191], v[208:211], v[224:227]
    ds_read_b128 v[204:207], v26 offset:3072
    ds_read_b128 v[180:183], v29 offset:6144
    ds_read_b128 v[184:187], v29 offset:7168
    ds_read_b64 v[208:209], v27 offset:3072
    ds_read_b128 v[188:191], v29 offset:8192
    s_waitcnt lgkmcnt(5)
    v_mfma_f32_16x16x32_bf16 v[220:223], v[192:195], v[212:215], v[220:223]
    v_mfma_f32_16x16x32_bf16 v[224:227], v[196:199], v[212:215], v[224:227]
    v_mfma_f32_16x16x32_bf16 v[224:227], v[200:203], v[216:219], v[224:227]
    ds_read_b128 v[212:215], v26 offset:4608
    ds_read_b128 v[192:195], v29 offset:9216
    ds_read_b128 v[196:199], v29 offset:10240
    ds_read_b64 v[216:217], v27 offset:4608
    ds_read_b128 v[200:203], v29 offset:11264
    s_waitcnt lgkmcnt(5)
    v_mfma_f32_16x16x32_bf16 v[220:223], v[180:183], v[204:207], v[220:223]
    v_mfma_f32_16x16x32_bf16 v[224:227], v[184:187], v[204:207], v[224:227]
    v_mfma_f32_16x16x32_bf16 v[224:227], v[188:191], v[208:211], v[224:227]
    s_waitcnt lgkmcnt(0)
    v_mfma_f32_16x16x32_bf16 v[220:223], v[192:195], v[212:215], v[220:223]
    v_mfma_f32_16x16x32_bf16 v[224:227], v[196:199], v[212:215], v[224:227]
    v_mfma_f32_16x16x32_bf16 v[224:227], v[200:203], v[216:219], v[224:227]
    s_nop 0
    v_cvt_pk_bf16_f32 v220, v220, v221
    v_cvt_pk_bf16_f32 v221, v222, v223
    s_nop 4
    v_cvt_pk_bf16_f32 v222, v224, v225
    v_cvt_pk_bf16_f32 v223, v226, v227
    v_mov_b32 v224, v220
    v_mov_b32 v225, v221
    v_mov_b32_dpp v220, v222 row_ror:8 row_mask:0xf bank_mask:0xc
    v_mov_b32_dpp v221, v223 row_ror:8 row_mask:0xf bank_mask:0xc
    v_mov_b32_dpp v222, v224 row_ror:8 row_mask:0xf bank_mask:0x3
    v_mov_b32_dpp v223, v225 row_ror:8 row_mask:0xf bank_mask:0x3
    v_mov_b32 v80, v220
    v_mov_b32 v81, v221
    v_mov_b32 v82, v222
    v_mov_b32 v83, v223
    s_add_u32 s56, s37, 0
    s_and_b32 s55, s56, 3
    s_mul_i32 s55, s55, 114688
    s_add_u32 s55, s55, 53248
    s_add_u32 s48, s38, s55
    s_and_b32 s55, s56, 1
    s_add_u32 s56, s56, 1
    v_mov_b32 v35, -16
    v_writelane_b32 v35, s56, 12
    s_mul_i32 s55, s55, 12288
    s_add_u32 m0, s54, s55
    s_add_u32 s56, s37, 0
    s_and_b32 s55, s56, 3
    s_mul_i32 s55, s55, 24576
    v_add_u32 v26, s55, v22
    v_add_u32 v27, s55, v23
    s_and_b32 s55, s56, 1
    s_mul_i32 s55, s55, 12288
    v_add_u32 v29, s55, v28
    buffer_load_dword v36, v33, s[4:7], s38 offen sc1
    buffer_load_dword v36, v33, s[4:7], s38 offen sc1
    buffer_load_dword v36, v33, s[4:7], s38 offen sc1
    buffer_load_dword v36, v33, s[4:7], s38 offen sc1
    buffer_load_dword v36, v33, s[4:7], s38 offen sc1
L_sp_114:
    s_waitcnt vmcnt(4)
    v_cmp_lt_i32 vcc, v36, v35
    buffer_load_dword v36, v33, s[4:7], s38 offen sc1
    s_sub_u32 s36, s36, 1
    s_cbranch_scc1 L_exit
    s_cbranch_vccz L_sp_114x
    s_waitcnt vmcnt(4)
    v_cmp_lt_i32 vcc, v36, v35
    buffer_load_dword v36, v33, s[4:7], s38 offen sc1
    s_cbranch_vccz L_sp_114x
    s_waitcnt vmcnt(4)
    v_cmp_lt_i32 vcc, v36, v35
    buffer_load_dword v36, v33, s[4:7], s38 offen sc1
    s_cbranch_vccz L_sp_114x
    s_waitcnt vmcnt(4)
    v_cmp_lt_i32 vcc, v36, v35
    buffer_load_dword v36, v33, s[4:7], s38 offen sc1
    s_cbranch_vccnz L_sp_114
L_sp_114x:
    buffer_load_dwordx4 v37, s[4:7], s48 offen offset:0 sc1 lds
    buffer_load_dwordx4 v37, s[4:7], s48 offen offset:1024 sc1 lds
    buffer_load_dwordx4 v37, s[4:7], s48 offen offset:2048 sc1 lds
    s_waitcnt vmcnt(0)
    s_barrier
    s_mov_b32 s49, 7143424
    buffer_store_dwordx4 v[120:123], v30, s[4:7], s49 offen sc1
    s_mov_b32 s49, 6815744
    buffer_store_dwordx4 v[124:127], v30, s[4:7], s49 offen sc1
    s_mov_b32 s49, 6488064
    buffer_store_dwordx4 v[128:131], v30, s[4:7], s49 offen sc1
    s_mov_b32 s49, 6160384
    buffer_store_dwordx4 v[132:135], v30, s[4:7], s49 offen sc1
    s_mov_b32 s49, 5832704
    buffer_store_dwordx4 v[80:83], v30, s[4:7], s49 offen sc1
    ds_read_b128 v[204:207], v26 offset:0
    ds_read_b128 v[180:183], v29 offset:0
    ds_read_b128 v[184:187], v29 offset:1024
    ds_read_b64 v[208:209], v27 offset:0
    ds_read_b128 v[188:191], v29 offset:2048
    ds_read_b128 v[212:215], v26 offset:1536
    ds_read_b128 v[192:195], v29 offset:3072
    ds_read_b128 v[196:199], v29 offset:4096
    ds_read_b64 v[216:217], v27 offset:1536
    ds_read_b128 v[200:203], v29 offset:5120
    s_waitcnt lgkmcnt(5)
    v_mfma_f32_16x16x32_bf16 v[220:223], v[180:183], v[204:207], 0
    v_mfma_f32_16x16x32_bf16 v[224:227], v[184:187], v[204:207], 0
    v_mfma_f32_16x16x32_bf16 v[224:227], v[188:191], v[208:211], v[224:227]
    ds_read_b128 v[204:207], v26 offset:3072
    ds_read_b128 v[180:183], v29 offset:6144
    ds_read_b128 v[184:187], v29 offset:7168
    ds_read_b64 v[208:209], v27 offset:3072
    ds_read_b128 v[188:191], v29 offset:8192
    s_waitcnt lgkmcnt(5)
    v_mfma_f32_16x16x32_bf16 v[220:223], v[192:195], v[212:215], v[220:223]
    v_mfma_f32_16x16x32_bf16 v[224:227], v[196:199], v[212:215], v[224:227]
    v_mfma_f32_16x16x32_bf16 v[224:227], v[200:203], v[216:219], v[224:227]
    ds_read_b128 v[212:215], v26 offset:4608
    ds_read_b128 v[192:195], v29 offset:9216
    ds_read_b128 v[196:199], v29 offset:10240
    ds_read_b64 v[216:217], v27 offset:4608
    ds_read_b128 v[200:203], v29 offset:11264
    s_waitcnt lgkmcnt(5)
    v_mfma_f32_16x16x32_bf16 v[220:223], v[180:183], v[204:207], v[220:223]
    v_mfma_f32_16x16x32_bf16 v[224:227], v[184:187], v[204:207], v[224:227]
    v_mfma_f32_16x16x32_bf16 v[224:227], v[188:191], v[208:211], v[224:227]
    s_waitcnt lgkmcnt(0)
    v_mfma_f32_16x16x32_bf16 v[220:223], v[192:195], v[212:215], v[220:223]
    v_mfma_f32_16x16x32_bf16 v[224:227], v[196:199], v[212:215], v[224:227]
    v_mfma_f32_16x16x32_bf16 v[224:227], v[200:203], v[216:219], v[224:227]
    s_nop 0
    v_cvt_pk_bf16_f32 v220, v220, v221
    v_cvt_pk_bf16_f32 v221, v222, v223
    s_nop 4
    v_cvt_pk_bf16_f32 v222, v224, v225
    v_cvt_pk_bf16_f32 v223, v226, v227
    v_mov_b32 v224, v220
    v_mov_b32 v225, v221
    v_mov_b32_dpp v220, v222 row_ror:8 row_mask:0xf bank_mask:0xc
    v_mov_b32_dpp v221, v223 row_ror:8 row_mask:0xf bank_mask:0xc
    v_mov_b32_dpp v222, v224 row_ror:8 row_mask:0xf bank_mask:0x3
    v_mov_b32_dpp v223, v225 row_ror:8 row_mask:0xf bank_mask:0x3
    s_mov_b32 s49, 5505024
    buffer_store_dwordx4 v[220:223], v30, s[4:7], s49 offen sc1
    s_waitcnt vmcnt(0)
L_fp_115:
    s_mov_b32 s51, 5505024
    buffer_load_dwordx4 v[96:99], v31, s[4:7], s51 offen sc1
    s_mov_b32 s51, 7143424
    buffer_load_dwordx4 v[148:151], v31, s[4:7], s51 offen sc1
    s_mov_b32 s51, 6815744
    buffer_load_dwordx4 v[152:155], v31, s[4:7], s51 offen sc1
    s_mov_b32 s51, 6488064
    buffer_load_dwordx4 v[156:159], v31, s[4:7], s51 offen sc1
    s_mov_b32 s51, 6160384
    buffer_load_dwordx4 v[160:163], v31, s[4:7], s51 offen sc1
    s_mov_b32 s51, 5832704
    buffer_load_dwordx4 v[92:95], v31, s[4:7], s51 offen sc1
    s_sub_u32 s36, s36, 1
    s_cbranch_scc1 L_exit
    s_waitcnt vmcnt(0)
L_fp_115c:
    v_mov_b32 v41, 0
    v_max3_u32 v41, v41, v96, v97
    v_max3_u32 v41, v41, v98, v99
    v_max3_u32 v41, v41, v148, v149
    v_max3_u32 v41, v41, v150, v151
    v_max3_u32 v41, v41, v152, v153
    v_max3_u32 v41, v41, v154, v155
    v_max3_u32 v41, v41, v156, v157
    v_max3_u32 v41, v41, v158, v159
    v_max3_u32 v41, v41, v160, v161
    v_max3_u32 v41, v41, v162, v163
    v_max3_u32 v41, v41, v92, v93
    v_max3_u32 v41, v41, v94, v95
    v_cmp_eq_u32 vcc, -1, v41
    s_cbranch_vccnz L_fp_115
    s_mov_b32 s52, 5160960
    v_mfma_f32_16x16x32_bf16 v[232:235], a[144:147], v[96:99], 0
    s_nop 7
    v_cndmask_b32 v234, v232, v233, s[58:59]
    v_cndmask_b32 v235, v233, v232, s[58:59]
    s_nop 1
    v_add_f32_dpp v235, v234, v235 row_ror:8 row_mask:0xf bank_mask:0xf
    v_cvt_pk_bf16_f32 v235, v235, v235
    buffer_store_short v235, v32, s[28:31], s52 offen offset:0
    s_mov_b32 s52, 4751360
    v_mfma_f32_16x16x32_bf16 v[232:235], a[144:147], v[148:151], 0
    s_nop 7
    v_cndmask_b32 v234, v232, v233, s[58:59]
    v_cndmask_b32 v235, v233, v232, s[58:59]
    s_nop 1
    v_add_f32_dpp v235, v234, v235 row_ror:8 row_mask:0xf bank_mask:0xf
    v_cvt_pk_bf16_f32 v235, v235, v235
    buffer_store_short v235, v32, s[28:31], s52 offen offset:0
    s_mov_b32 s52, 4833280
    v_mfma_f32_16x16x32_bf16 v[232:235], a[144:147], v[152:155], 0
    s_nop 7
    v_cndmask_b32 v234, v232, v233, s[58:59]
    v_cndmask_b32 v235, v233, v232, s[58:59]
    s_nop 1
    v_add_f32_dpp v235, v234, v235 row_ror:8 row_mask:0xf bank_mask:0xf
    v_cvt_pk_bf16_f32 v235, v235, v235
    buffer_store_short v235, v32, s[28:31], s52 offen offset:0
    s_mov_b32 s52, 4915200
    v_mfma_f32_16x16x32_bf16 v[232:235], a[144:147], v[156:159], 0
    s_nop 7
    v_cndmask_b32 v234, v232, v233, s[58:59]
    v_cndmask_b32 v235, v233, v232, s[58:59]
    s_nop 1
    v_add_f32_dpp v235, v234, v235 row_ror:8 row_mask:0xf bank_mask:0xf
    v_cvt_pk_bf16_f32 v235, v235, v235
    buffer_store_short v235, v32, s[28:31], s52 offen offset:0
    s_mov_b32 s52, 4997120
    v_mfma_f32_16x16x32_bf16 v[232:235], a[144:147], v[160:163], 0
    s_nop 7
    v_cndmask_b32 v234, v232, v233, s[58:59]
    v_cndmask_b32 v235, v233, v232, s[58:59]
    s_nop 1
    v_add_f32_dpp v235, v234, v235 row_ror:8 row_mask:0xf bank_mask:0xf
    v_cvt_pk_bf16_f32 v235, v235, v235
    buffer_store_short v235, v32, s[28:31], s52 offen offset:0
    s_mov_b32 s52, 5079040
    v_mfma_f32_16x16x32_bf16 v[232:235], a[144:147], v[92:95], 0
    s_nop 7
    v_cndmask_b32 v234, v232, v233, s[58:59]
    v_cndmask_b32 v235, v233, v232, s[58:59]
    s_nop 1
    v_add_f32_dpp v235, v234, v235 row_ror:8 row_mask:0xf bank_mask:0xf
    v_cvt_pk_bf16_f32 v235, v235, v235
    buffer_store_short v235, v32, s[28:31], s52 offen offset:0
    s_endpgm
L_sd_89c:
    v_mov_b32 v3, 204
L_p0_116:
    buffer_load_dword v4, v3, s[8:11], 0 offen sc1
    s_sub_u32 s36, s36, 1
    s_cbranch_scc1 L_exit
    s_waitcnt vmcnt(0)
    v_readfirstlane_b32 s90, v4
    s_nop 0
    s_cmp_eq_u32 s90, 0
    s_cbranch_scc1 L_p0_116
    s_and_b32 s90, s90, 2
    s_lshl_b32 s90, s90, 12
    v_xor_b32 v140, s90, v140
    v_xor_b32 v141, s90, v141
    v_xor_b32 v143, s90, v143
    v_xor_b32 v144, s90, v144
    s_branch L_sd_89
L_fw_92c:
    v_mov_b32 v148, -1
    v_mov_b32 v149, -1
    v_mov_b32 v150, -1
    v_mov_b32 v151, -1
    v_mov_b32 v152, -1
    v_mov_b32 v153, -1
    v_mov_b32 v154, -1
    v_mov_b32 v155, -1
    s_add_u32 s53, s53, 2293760
    buffer_store_dwordx4 v[148:151], v143, s[4:7], s53 offen offset:0 sc1
    buffer_store_dwordx4 v[152:155], v143, s[4:7], s53 offen offset:1024 sc1
    s_sub_u32 s53, s53, 983040
    s_branch L_fw_92
L_vm_102:
    buffer_load_dwordx4 v44, s[4:7], s43 offen offset:0 sc1 lds
    buffer_load_dwordx4 v44, s[4:7], s43 offen offset:1024 sc1 lds
    buffer_load_dwordx4 v44, s[4:7], s43 offen offset:2048 sc1 lds
    s_sub_u32 s36, s36, 1
    s_cbranch_scc1 L_exit
    v_add_u32 v5, s53, v12
    s_waitcnt vmcnt(0)
    ds_read_b128 v[136:139], v5 offset:0
    ds_read_b128 v[140:143], v5 offset:1024
    ds_read_b128 v[144:147], v5 offset:2048
    s_waitcnt lgkmcnt(0)
    v_max_u32 v4, v136, v137
    v_max3_u32 v4, v4, v138, v139
    v_max3_u32 v4, v4, v140, v141
    v_max3_u32 v4, v4, v142, v143
    v_max3_u32 v4, v4, v144, v145
    v_max3_u32 v4, v4, v146, v147
    v_cmp_eq_u32 vcc, -1, v4
    s_cbranch_vccnz L_vm_102
    buffer_load_dwordx4 v[92:95], v38, s[4:7], s43 offen offset:0 sc1
    buffer_load_dwordx4 v[96:99], v38, s[4:7], s43 offen offset:1280 sc1
    buffer_load_dwordx4 v[100:103], v38, s[4:7], s43 offen offset:2560 sc1
    buffer_load_dword v104, v39, s[4:7], s43 offen offset:0 sc1
    buffer_load_dword v105, v39, s[4:7], s43 offen offset:1280 sc1
    buffer_load_dword v106, v39, s[4:7], s43 offen offset:2560 sc1
    ds_read_b64_tr_b16 v[136:137], v16 offset:0
    ds_read_b64_tr_b16 v[138:139], v13 offset:0
    ds_read_b64_tr_b16 v[140:141], v16 offset:1024
    ds_read_b64_tr_b16 v[142:143], v13 offset:1024
    ds_read_b64_tr_b16 v[144:145], v16 offset:2048
    ds_read_b64_tr_b16 v[146:147], v13 offset:2048
    v_mov_b32 v148, 0
    v_mov_b32 v149, 0
    v_mov_b32 v150, 0
    v_mov_b32 v151, 0
    v_mov_b32 v152, 0
    v_mov_b32 v153, 0
    v_mov_b32 v154, 0
    v_mov_b32 v155, 0
    v_mov_b32 v156, 0
    v_mov_b32 v157, 0
    v_mov_b32 v158, 0
    v_mov_b32 v159, 0
    v_mov_b32 v160, 0
    v_mov_b32 v161, 0
    v_mov_b32 v162, 0
    v_mov_b32 v163, 0
    s_waitcnt lgkmcnt(0)
    v_smfmac_f32_16x16x64_bf16 v[148:151], v[136:139], a[0:7], v10
    v_smfmac_f32_16x16x64_bf16 v[152:155], v[136:139], a[24:31], v10
    v_smfmac_f32_16x16x64_bf16 v[156:159], v[136:139], a[48:55], v10
    v_smfmac_f32_16x16x64_bf16 v[160:163], v[136:139], a[72:79], v10
    v_smfmac_f32_16x16x64_bf16 v[148:151], v[140:143], a[8:15], v10
    v_smfmac_f32_16x16x64_bf16 v[152:155], v[140:143], a[32:39], v10
    v_smfmac_f32_16x16x64_bf16 v[156:159], v[140:143], a[56:63], v10
    v_smfmac_f32_16x16x64_bf16 v[160:163], v[140:143], a[80:87], v10
    v_smfmac_f32_16x16x64_bf16 v[148:151], v[144:147], a[16:23], v10
    v_smfmac_f32_16x16x64_bf16 v[152:155], v[144:147], a[40:47], v10
    v_smfmac_f32_16x16x64_bf16 v[156:159], v[144:147], a[64:71], v10
    v_smfmac_f32_16x16x64_bf16 v[160:163], v[144:147], a[88:95], v10
    v_pk_add_f32 v[148:149], v[148:149], v[150:151]
    v_cmp_u_f32 vcc, v148, v149
    v_cvt_pk_bf16_f32 v50, v148, v149
    v_cvt_pk_bf16_f32 v54, v148, v149
    v_pk_add_f32 v[152:153], v[152:153], v[154:155]
    v_cvt_pk_bf16_f32 v58, v152, v153
    v_cvt_pk_bf16_f32 v62, v152, v153
    v_pk_add_f32 v[156:157], v[156:157], v[158:159]
    v_cvt_pk_bf16_f32 v66, v156, v157
    v_cvt_pk_bf16_f32 v70, v156, v157
    v_pk_add_f32 v[160:161], v[160:161], v[162:163]
    v_cvt_pk_bf16_f32 v74, v160, v161
    v_cvt_pk_bf16_f32 v78, v160, v161
    s_cmp_eq_u32 s37, 63
    s_branch L_u_103
L_sp_106:
    v_max3_u32 v4, v104, v105, v106
    v_max3_u32 v4, v4, v92, v93
    v_max3_u32 v4, v4, v94, v95
    v_max3_u32 v4, v4, v96, v97
    v_max3_u32 v4, v4, v98, v99
    v_max3_u32 v4, v4, v100, v101
    v_max3_u32 v4, v4, v102, v103
    v_cmp_eq_u32 vcc, -1, v4
    s_cbranch_vccz L_sg_107
    buffer_load_dwordx4 v[92:95], v38, s[4:7], s43 offen offset:0 sc1
    buffer_load_dwordx4 v[96:99], v38, s[4:7], s43 offen offset:1280 sc1
    buffer_load_dwordx4 v[100:103], v38, s[4:7], s43 offen offset:2560 sc1
    buffer_load_dword v104, v39, s[4:7], s43 offen offset:0 sc1
    buffer_load_dword v105, v39, s[4:7], s43 offen offset:1280 sc1
    buffer_load_dword v106, v39, s[4:7], s43 offen offset:2560 sc1
    s_sub_u32 s36, s36, 1
    s_cbranch_scc1 L_exit
    s_branch L_sc_105
L_px_s:
    v_and_b32 v1, 15, v0
    v_lshrrev_b32 v2, 4, v0
    s_mul_i32 s90, s32, 12288
    v_lshl_add_u32 v10, v0, 4, s90
    s_mul_i32 s90, s32, 3072
    v_lshl_add_u32 v12, v0, 4, s90
    v_lshrrev_b32 v3, 2, v1
    v_lshlrev_b32 v3, 1, v3
    v_and_b32 v4, 1, v1
    v_or_b32 v3, v3, v4
    v_lshl_add_u32 v3, v2, 3, v3
    v_lshl_add_u32 v11, v3, 4, s90
    s_lshl_b32 s90, s32, 7
    v_min_u32 v3, 11, v0
    v_lshl_add_u32 v3, v3, 2, s90
    v_add_u32 v13, 458752, v3
    v_min_u32 v3, 2, v0
    v_lshl_add_u32 v3, v3, 2, s90
    v_add_u32 v14, 459264, v3
    v_add_u32 v22, 462336, v3
    s_add_u32 s90, s90, 459776
    v_mov_b32 v15, s90
    v_cmp_eq_u32 vcc, 0, v0
    v_mov_b32 v9, 2146435072
    s_nop 0
    v_cndmask_b32 v15, v9, v15, vcc
    s_nop 0
    v_mov_b32 v21, 0xd04e79ff
    s_mov_b32 s44, 0x3dd53b95
    v_lshl_add_u32 v3, v2, 2, 0
    v_cmp_le_u32 s[48:49], v3, v1
    v_lshl_add_u32 v3, v2, 2, 1
    v_cmp_le_u32 s[50:51], v3, v1
    v_lshl_add_u32 v3, v2, 2, 2
    v_cmp_le_u32 s[52:53], v3, v1
    v_lshl_add_u32 v3, v2, 2, 3
    v_cmp_le_u32 s[54:55], v3, v1
    v_mov_b32 v167, 0
    v_mov_b32 v171, 0
    v_mov_b32 v174, 0
    v_mov_b32 v175, 0
    s_mov_b32 s37, 0
    v_mov_b32 v1, 196
L_gw_118:
    buffer_load_dword v2, v1, s[8:11], 0 offen sc1
    s_sub_u32 s36, s36, 1
    s_cbranch_scc1 L_exit
    s_waitcnt vmcnt(0)
L_gw_118c:
    v_readfirstlane_b32 s90, v2
    s_nop 0
    s_cmp_eq_u32 s90, 0
    s_cbranch_scc1 L_gw_118
    s_cmp_lg_u32 s32, 0
    s_cbranch_scc1 L_xg_117
    s_lshl_b32 s92, s34, 14
    s_add_u32 s92, s92, 1966080
    s_add_u32 s93, s92, 8192
    v_lshlrev_b32 v3, 4, v0
    buffer_store_dwordx4 v[24:27], v3, s[4:7], s92 offen offset:0 sc1
    buffer_store_dwordx4 v[24:27], v3, s[4:7], s93 offen offset:0 sc1
    buffer_store_dwordx4 v[24:27], v3, s[4:7], s92 offen offset:1024 sc1
    buffer_store_dwordx4 v[24:27], v3, s[4:7], s93 offen offset:1024 sc1
    buffer_store_dwordx4 v[24:27], v3, s[4:7], s92 offen offset:2048 sc1
    buffer_store_dwordx4 v[24:27], v3, s[4:7], s93 offen offset:2048 sc1
    buffer_store_dwordx4 v[24:27], v3, s[4:7], s92 offen offset:3072 sc1
    buffer_store_dwordx4 v[24:27], v3, s[4:7], s93 offen offset:3072 sc1
    v_mov_b32 v3, 0
    s_mov_b32 s56, -1
    s_mov_b32 s57, -1
    s_mov_b32 s62, 0
    s_mov_b32 s63, 0
    s_waitcnt vmcnt(0)
L_pr_119:
    s_memtime s[58:59]
    s_waitcnt lgkmcnt(0)
    buffer_load_dword v4, v3, s[4:7], s92 offen sc1
    s_waitcnt vmcnt(0)
    s_memtime s[60:61]
    s_waitcnt lgkmcnt(0)
    s_sub_u32 s60, s60, s58
    s_min_u32 s56, s56, s60
    s_memtime s[58:59]
    s_waitcnt lgkmcnt(0)
    buffer_load_dword v4, v3, s[4:7], s93 offen sc1
    s_waitcnt vmcnt(0)
    s_memtime s[60:61]
    s_waitcnt lgkmcnt(0)
    s_sub_u32 s60, s60, s58
    s_min_u32 s57, s57, s60
    buffer_load_dword v4, v13, s[4:7], s38 offen sc1
    v_add_u32 v3, 128, v3
    s_add_u32 s62, s62, 1
    s_waitcnt vmcnt(0)
    v_cmp_eq_u32 vcc, 0, v4
    s_nop 0
    s_cmp_eq_u64 vcc, 0
    s_addc_u32 s63, s63, 0
    s_cmp_ge_u32 s63, 2
    s_cselect_b32 s62, 32, s62
    s_min_u32 s58, s56, s57
    s_max_u32 s59, s56, s57
    s_sub_u32 s59, s59, s58
    s_cmp_ge_u32 s59, 150
    s_cselect_b32 s58, s58, -1
    s_cmp_le_u32 s58, 540
    s_cselect_b32 s62, 32, s62
    s_cmp_lt_u32 s62, 32
    s_cbranch_scc1 L_pr_119
    s_cmp_lt_u32 s57, s56
    s_cselect_b32 s62, 2, 1
    s_nop 0
    v_mov_b32 v3, 460288
    v_mov_b32 v4, s62
    buffer_store_dword v4, v3, s[4:7], s38 offen sc1
    s_cmp_lg_u32 s34, 0
    s_cbranch_scc1 L_xg_117
    v_mov_b32 v3, 204
    buffer_store_dword v4, v3, s[8:11], 0 offen sc1
L_xg_117:
    s_barrier
    s_add_u32 s41, s38, 475136
    buffer_load_dword v16, v22, s[4:7], s38 offen sc1
    buffer_load_dword v16, v22, s[4:7], s38 offen sc1
L_sp_120:
    s_waitcnt vmcnt(1)
    v_cmp_ge_u32 vcc, s37, v16
    buffer_load_dword v16, v22, s[4:7], s38 offen sc1
    s_sub_u32 s36, s36, 1
    s_cbranch_scc1 L_exit
    s_cbranch_vccz L_sp_120x
    s_waitcnt vmcnt(1)
    v_cmp_ge_u32 vcc, s37, v16
    buffer_load_dword v16, v22, s[4:7], s38 offen sc1
    s_cbranch_vccz L_sp_120x
    s_waitcnt vmcnt(1)
    v_cmp_ge_u32 vcc, s37, v16
    buffer_load_dword v16, v22, s[4:7], s38 offen sc1
    s_cbranch_vccz L_sp_120x
    s_waitcnt vmcnt(1)
    v_cmp_ge_u32 vcc, s37, v16
    buffer_load_dword v16, v22, s[4:7], s38 offen sc1
    s_cbranch_vccnz L_sp_120
L_sp_120x:
    s_add_u32 s90, s41, 49152
    buffer_load_dwordx4 v[72:75], v10, s[4:7], s90 offen offset:0 sc1
    buffer_load_dwordx4 v[76:79], v10, s[4:7], s90 offen offset:1024 sc1
    buffer_load_dwordx4 v[80:83], v10, s[4:7], s90 offen offset:2048 sc1
    buffer_load_dwordx4 v[84:87], v10, s[4:7], s90 offen offset:3072 sc1
    s_add_u32 s90, s41, 53248
    buffer_load_dwordx4 v[88:91], v10, s[4:7], s90 offen offset:0 sc1
    buffer_load_dwordx4 v[92:95], v10, s[4:7], s90 offen offset:1024 sc1
    buffer_load_dwordx4 v[96:99], v10, s[4:7], s90 offen offset:2048 sc1
    buffer_load_dwordx4 v[100:103], v10, s[4:7], s90 offen offset:3072 sc1
    s_add_u32 s90, s41, 57344
    buffer_load_dwordx4 v[104:107], v10, s[4:7], s90 offen offset:0 sc1
    buffer_load_dwordx4 v[108:111], v10, s[4:7], s90 offen offset:1024 sc1
    buffer_load_dwordx4 v[112:115], v10, s[4:7], s90 offen offset:2048 sc1
    buffer_load_dwordx4 v[116:119], v10, s[4:7], s90 offen offset:3072 sc1
    s_add_u32 s90, s41, 0
    buffer_load_dwordx4 v[24:27], v10, s[4:7], s90 offen offset:0 sc1
    buffer_load_dwordx4 v[28:31], v10, s[4:7], s90 offen offset:1024 sc1
    buffer_load_dwordx4 v[32:35], v10, s[4:7], s90 offen offset:2048 sc1
    buffer_load_dwordx4 v[36:39], v10, s[4:7], s90 offen offset:3072 sc1
    s_add_u32 s90, s41, 4096
    buffer_load_dwordx4 v[40:43], v10, s[4:7], s90 offen offset:0 sc1
    buffer_load_dwordx4 v[44:47], v10, s[4:7], s90 offen offset:1024 sc1
    buffer_load_dwordx4 v[48:51], v10, s[4:7], s90 offen offset:2048 sc1
    buffer_load_dwordx4 v[52:55], v10, s[4:7], s90 offen offset:3072 sc1
    s_add_u32 s90, s41, 8192
    buffer_load_dwordx4 v[56:59], v10, s[4:7], s90 offen offset:0 sc1
    buffer_load_dwordx4 v[60:63], v10, s[4:7], s90 offen offset:1024 sc1
    buffer_load_dwordx4 v[64:67], v10, s[4:7], s90 offen offset:2048 sc1
    buffer_load_dwordx4 v[68:71], v10, s[4:7], s90 offen offset:3072 sc1
    s_waitcnt vmcnt(0)
L_px_loop_s:
    s_and_b32 s90, s37, 3
    s_mul_i32 s91, s90, 114688
    s_add_u32 s91, s91, s38
    s_add_u32 s42, s91, 40960
    s_add_u32 s43, s91, 53248
    s_add_u32 s90, s37, 1
    v_mov_b32 v17, s90
    s_and_b32 s90, s90, 3
    s_mul_i32 s91, s90, 98304
    s_add_u32 s91, s91, 475136
    s_add_u32 s41, s38, s91
    v_mfma_f32_16x16x32_bf16 v[144:147], v[72:75], v[24:27], 0
    v_mfma_f32_16x16x32_bf16 v[152:155], v[72:75], v[48:51], 0
    v_mfma_f32_16x16x32_bf16 v[156:159], v[96:99], v[48:51], 0
    v_mfma_f32_16x16x32_bf16 v[144:147], v[76:79], v[28:31], v[144:147]
    v_mfma_f32_16x16x32_bf16 v[152:155], v[76:79], v[52:55], v[152:155]
    v_mfma_f32_16x16x32_bf16 v[156:159], v[100:103], v[52:55], v[156:159]
    v_mfma_f32_16x16x32_bf16 v[144:147], v[80:83], v[32:35], v[144:147]
    v_mfma_f32_16x16x32_bf16 v[152:155], v[80:83], v[56:59], v[152:155]
    v_mfma_f32_16x16x32_bf16 v[156:159], v[104:107], v[56:59], v[156:159]
    v_mfma_f32_16x16x32_bf16 v[144:147], v[84:87], v[36:39], v[144:147]
    v_mfma_f32_16x16x32_bf16 v[152:155], v[84:87], v[60:63], v[152:155]
    v_mfma_f32_16x16x32_bf16 v[156:159], v[108:111], v[60:63], v[156:159]
    v_mfma_f32_16x16x32_bf16 v[144:147], v[88:91], v[40:43], v[144:147]
    v_mfma_f32_16x16x32_bf16 v[152:155], v[88:91], v[64:67], v[152:155]
    v_mfma_f32_16x16x32_bf16 v[156:159], v[112:115], v[64:67], v[156:159]
    v_mfma_f32_16x16x32_bf16 v[144:147], v[92:95], v[44:47], v[144:147]
    v_mfma_f32_16x16x32_bf16 v[152:155], v[92:95], v[68:71], v[152:155]
    v_mfma_f32_16x16x32_bf16 v[156:159], v[116:119], v[68:71], v[156:159]
    s_nop 0
    v_cndmask_b32 v144, v21, v144, s[48:49]
    v_cndmask_b32 v145, v21, v145, s[50:51]
    v_cndmask_b32 v146, v21, v146, s[52:53]
    v_cndmask_b32 v147, v21, v147, s[54:55]
    s_nop 2
    v_cndmask_b32 v156, v21, v156, s[48:49]
    v_cndmask_b32 v157, v21, v157, s[50:51]
    v_cndmask_b32 v158, v21, v158, s[52:53]
    v_cndmask_b32 v159, v21, v159, s[54:55]
    buffer_load_dword v16, v14, s[4:7], s38 offen sc1
    buffer_load_dword v16, v14, s[4:7], s38 offen sc1
L_sp_121:
    s_waitcnt vmcnt(1)
    v_cmp_ge_u32 vcc, s37, v16
    buffer_load_dword v16, v14, s[4:7], s38 offen sc1
    s_sub_u32 s36, s36, 1
    s_cbranch_scc1 L_exit
    s_cbranch_vccz L_sp_121x
    s_waitcnt vmcnt(1)
    v_cmp_ge_u32 vcc, s37, v16
    buffer_load_dword v16, v14, s[4:7], s38 offen sc1
    s_cbranch_vccz L_sp_121x
    s_waitcnt vmcnt(1)
    v_cmp_ge_u32 vcc, s37, v16
    buffer_load_dword v16, v14, s[4:7], s38 offen sc1
    s_cbranch_vccz L_sp_121x
    s_waitcnt vmcnt(1)
    v_cmp_ge_u32 vcc, s37, v16
    buffer_load_dword v16, v14, s[4:7], s38 offen sc1
    s_cbranch_vccnz L_sp_121
L_sp_121x:
    buffer_load_dwordx4 v[120:123], v11, s[4:7], s42 offen offset:0 sc1
    buffer_load_dwordx4 v[124:127], v11, s[4:7], s42 offen offset:512 sc1
    buffer_load_dwordx4 v[128:131], v11, s[4:7], s42 offen offset:1024 sc1
    buffer_load_dwordx4 v[132:135], v11, s[4:7], s42 offen offset:1536 sc1
    buffer_load_dwordx4 v[136:139], v11, s[4:7], s42 offen offset:2048 sc1
    buffer_load_dwordx4 v[140:143], v11, s[4:7], s42 offen offset:2560 sc1
    s_waitcnt vmcnt(5)
    v_mfma_f32_16x16x32_bf16 v[148:151], v[120:123], v[24:27], 0
    v_mfma_f32_16x16x32_bf16 v[160:163], v[120:123], v[48:51], 0
    s_waitcnt vmcnt(4)
    v_mfma_f32_16x16x32_bf16 v[148:151], v[124:127], v[28:31], v[148:151]
    v_mfma_f32_16x16x32_bf16 v[160:163], v[124:127], v[52:55], v[160:163]
    s_waitcnt vmcnt(3)
    v_mfma_f32_16x16x32_bf16 v[148:151], v[128:131], v[32:35], v[148:151]
    v_mfma_f32_16x16x32_bf16 v[160:163], v[128:131], v[56:59], v[160:163]
    s_waitcnt vmcnt(2)
    v_mfma_f32_16x16x32_bf16 v[148:151], v[132:135], v[36:39], v[148:151]
    v_mfma_f32_16x16x32_bf16 v[160:163], v[132:135], v[60:63], v[160:163]
    s_waitcnt vmcnt(1)
    v_mfma_f32_16x16x32_bf16 v[148:151], v[136:139], v[40:43], v[148:151]
    v_mfma_f32_16x16x32_bf16 v[160:163], v[136:139], v[64:67], v[160:163]
    s_waitcnt vmcnt(0)
    v_mfma_f32_16x16x32_bf16 v[148:151], v[140:143], v[44:47], v[148:151]
    v_mfma_f32_16x16x32_bf16 v[160:163], v[140:143], v[68:71], v[160:163]
    s_cmp_eq_u32 s37, 63
    s_nop 2
    s_cbranch_scc1 L_pxl_122
    s_add_u32 s90, s41, 49152
    v_max_f32 v18, v144, v145
    v_max3_f32 v18, v18, v146, v147
    v_max3_f32 v18, v18, v148, v149
    v_mov_b32 v19, v18
    buffer_load_dwordx4 v[72:75], v10, s[4:7], s90 offen offset:0 sc1
    s_nop 0
    v_permlane16_swap_b32 v18, v19
    v_max_f32 v18, v18, v19
    v_mov_b32 v19, v18
    s_nop 1
    v_permlane32_swap_b32 v18, v19
    buffer_load_dwordx4 v[76:79], v10, s[4:7], s90 offen offset:1024 sc1
    v_max_f32 v18, v18, v19
    v_mul_f32 v18, 0xbdd53b95, v18
    v_fma_f32 v144, v144, s44, v18
    v_fma_f32 v145, v145, s44, v18
    buffer_load_dwordx4 v[80:83], v10, s[4:7], s90 offen offset:2048 sc1
    v_fma_f32 v146, v146, s44, v18
    v_fma_f32 v147, v147, s44, v18
    v_fma_f32 v148, v148, s44, v18
    v_fma_f32 v149, v149, s44, v18
    buffer_load_dwordx4 v[84:87], v10, s[4:7], s90 offen offset:3072 sc1
    v_exp_f32 v144, v144
    v_exp_f32 v145, v145
    v_exp_f32 v146, v146
    v_exp_f32 v147, v147
    s_add_u32 s90, s41, 53248
    v_exp_f32 v148, v148
    v_exp_f32 v149, v149
    v_add_f32 v20, v144, v145
    v_add_f32 v20, v20, v146
    buffer_load_dwordx4 v[88:91], v10, s[4:7], s90 offen offset:0 sc1
    v_add_f32 v20, v20, v147
    v_add_f32 v20, v20, v148
    v_add_f32 v20, v20, v149
    v_mov_b32 v19, v20
    buffer_load_dwordx4 v[92:95], v10, s[4:7], s90 offen offset:1024 sc1
    s_nop 0
    v_permlane16_swap_b32 v20, v19
    v_add_f32 v20, v20, v19
    v_mov_b32 v19, v20
    s_nop 1
    v_permlane32_swap_b32 v20, v19
    buffer_load_dwordx4 v[96:99], v10, s[4:7], s90 offen offset:2048 sc1
    v_add_f32 v20, v20, v19
    v_rcp_f32 v20, v20
    s_nop 0
    v_mul_f32 v144, v144, v20
    v_mul_f32 v145, v145, v20
    buffer_load_dwordx4 v[100:103], v10, s[4:7], s90 offen offset:3072 sc1
    v_mul_f32 v146, v146, v20
    v_mul_f32 v147, v147, v20
    v_mul_f32 v148, v148, v20
    v_mul_f32 v149, v149, v20
    s_add_u32 s90, s41, 57344
    v_cvt_pk_bf16_f32 v164, v144, v145
    v_cvt_pk_bf16_f32 v165, v146, v147
    v_cvt_pk_bf16_f32 v166, v148, v149
    v_max_f32 v18, v152, v153
    buffer_load_dwordx4 v[104:107], v10, s[4:7], s90 offen offset:0 sc1
    v_max3_f32 v18, v18, v154, v155
    v_max3_f32 v18, v18, v160, v161
    v_max3_f32 v18, v18, v156, v157
    v_max3_f32 v18, v18, v158, v159
    buffer_load_dwordx4 v[108:111], v10, s[4:7], s90 offen offset:1024 sc1
    v_mov_b32 v19, v18
    s_nop 1
    v_permlane16_swap_b32 v18, v19
    v_max_f32 v18, v18, v19
    v_mov_b32 v19, v18
    buffer_load_dwordx4 v[112:115], v10, s[4:7], s90 offen offset:2048 sc1
    s_nop 0
    v_permlane32_swap_b32 v18, v19
    v_max_f32 v18, v18, v19
    v_mul_f32 v18, 0xbdd53b95, v18
    v_fma_f32 v152, v152, s44, v18
    buffer_load_dwordx4 v[116:119], v10, s[4:7], s90 offen offset:3072 sc1
    v_fma_f32 v153, v153, s44, v18
    v_fma_f32 v154, v154, s44, v18
    v_fma_f32 v155, v155, s44, v18
    v_fma_f32 v160, v160, s44, v18
    s_add_u32 s90, s41, 0
    v_fma_f32 v161, v161, s44, v18
    v_fma_f32 v156, v156, s44, v18
    v_fma_f32 v157, v157, s44, v18
    v_fma_f32 v158, v158, s44, v18
    buffer_load_dwordx4 v[24:27], v10, s[4:7], s90 offen offset:0 sc1
    v_fma_f32 v159, v159, s44, v18
    v_exp_f32 v152, v152
    v_exp_f32 v153, v153
    v_exp_f32 v154, v154
    buffer_load_dwordx4 v[28:31], v10, s[4:7], s90 offen offset:1024 sc1
    v_exp_f32 v155, v155
    v_exp_f32 v160, v160
    v_exp_f32 v161, v161
    v_exp_f32 v156, v156
    buffer_load_dwordx4 v[32:35], v10, s[4:7], s90 offen offset:2048 sc1
    v_exp_f32 v157, v157
    v_exp_f32 v158, v158
    v_exp_f32 v159, v159
    v_add_f32 v20, v152, v153
    buffer_load_dwordx4 v[36:39], v10, s[4:7], s90 offen offset:3072 sc1
    v_add_f32 v20, v20, v154
    v_add_f32 v20, v20, v155
    v_add_f32 v20, v20, v160
    v_add_f32 v20, v20, v161
    s_add_u32 s90, s41, 4096
    v_add_f32 v20, v20, v156
    v_add_f32 v20, v20, v157
    v_add_f32 v20, v20, v158
    v_add_f32 v20, v20, v159
    buffer_load_dwordx4 v[40:43], v10, s[4:7], s90 offen offset:0 sc1
    v_mov_b32 v19, v20
    s_nop 1
    v_permlane16_swap_b32 v20, v19
    v_add_f32 v20, v20, v19
    v_mov_b32 v19, v20
    buffer_load_dwordx4 v[44:47], v10, s[4:7], s90 offen offset:1024 sc1
    s_nop 0
    v_permlane32_swap_b32 v20, v19
    v_add_f32 v20, v20, v19
    v_rcp_f32 v20, v20
    s_nop 0
    v_mul_f32 v152, v152, v20
    buffer_load_dwordx4 v[48:51], v10, s[4:7], s90 offen offset:2048 sc1
    v_mul_f32 v153, v153, v20
    v_mul_f32 v154, v154, v20
    v_mul_f32 v155, v155, v20
    v_mul_f32 v160, v160, v20
    buffer_load_dwordx4 v[52:55], v10, s[4:7], s90 offen offset:3072 sc1
    v_mul_f32 v161, v161, v20
    v_mul_f32 v156, v156, v20
    v_mul_f32 v157, v157, v20
    v_mul_f32 v158, v158, v20
    s_add_u32 s90, s41, 8192
    v_mul_f32 v159, v159, v20
    v_cvt_pk_bf16_f32 v168, v152, v153
    v_cvt_pk_bf16_f32 v169, v154, v155
    v_cvt_pk_bf16_f32 v170, v160, v161
    buffer_load_dwordx4 v[56:59], v10, s[4:7], s90 offen offset:0 sc1
    v_cvt_pk_bf16_f32 v172, v156, v157
    v_cvt_pk_bf16_f32 v173, v158, v159
    buffer_load_dwordx4 v[60:63], v10, s[4:7], s90 offen offset:1024 sc1
    buffer_load_dwordx4 v[64:67], v10, s[4:7], s90 offen offset:2048 sc1
    buffer_load_dwordx4 v[68:71], v10, s[4:7], s90 offen offset:3072 sc1
    buffer_store_dwordx4 v[164:167], v12, s[4:7], s43 offen offset:0 sc1
    buffer_store_dwordx4 v[168:171], v12, s[4:7], s43 offen offset:1024 sc1
    buffer_store_dwordx4 v[172:175], v12, s[4:7], s43 offen offset:2048 sc1
    s_waitcnt vmcnt(0)
    buffer_store_dword v17, v15, s[4:7], s38 offen sc1
    s_add_u32 s37, s37, 1
    s_branch L_px_loop_s
L_pxl_122:
    v_max_f32 v18, v144, v145
    v_max3_f32 v18, v18, v146, v147
    v_max3_f32 v18, v18, v148, v149
    v_mov_b32 v19, v18
    s_nop 1
    v_permlane16_swap_b32 v18, v19
    v_max_f32 v18, v18, v19
    v_mov_b32 v19, v18
    s_nop 1
    v_permlane32_swap_b32 v18, v19
    v_max_f32 v18, v18, v19
    v_mul_f32 v18, 0xbdd53b95, v18
    v_fma_f32 v144, v144, s44, v18
    v_fma_f32 v145, v145, s44, v18
    v_fma_f32 v146, v146, s44, v18
    v_fma_f32 v147, v147, s44, v18
    v_fma_f32 v148, v148, s44, v18
    v_fma_f32 v149, v149, s44, v18
    v_exp_f32 v144, v144
    v_exp_f32 v145, v145
    v_exp_f32 v146, v146
    v_exp_f32 v147, v147
    v_exp_f32 v148, v148
    v_exp_f32 v149, v149
    v_add_f32 v20, v144, v145
    v_add_f32 v20, v20, v146
    v_add_f32 v20, v20, v147
    v_add_f32 v20, v20, v148
    v_add_f32 v20, v20, v149
    v_mov_b32 v19, v20
    s_nop 1
    v_permlane16_swap_b32 v20, v19
    v_add_f32 v20, v20, v19
    v_mov_b32 v19, v20
    s_nop 1
    v_permlane32_swap_b32 v20, v19
    v_add_f32 v20, v20, v19
    v_rcp_f32 v20, v20
    s_nop 0
    v_mul_f32 v144, v144, v20
    v_mul_f32 v145, v145, v20
    v_mul_f32 v146, v146, v20
    v_mul_f32 v147, v147, v20
    v_mul_f32 v148, v148, v20
    v_mul_f32 v149, v149, v20
    v_cvt_pk_bf16_f32 v164, v144, v145
    v_cvt_pk_bf16_f32 v165, v146, v147
    v_cvt_pk_bf16_f32 v166, v148, v149
    v_max_f32 v18, v152, v153
    v_max3_f32 v18, v18, v154, v155
    v_max3_f32 v18, v18, v160, v161
    v_max3_f32 v18, v18, v156, v157
    v_max3_f32 v18, v18, v158, v159
    v_mov_b32 v19, v18
    s_nop 1
    v_permlane16_swap_b32 v18, v19
    v_max_f32 v18, v18, v19
    v_mov_b32 v19, v18
    s_nop 1
    v_permlane32_swap_b32 v18, v19
    v_max_f32 v18, v18, v19
    v_mul_f32 v18, 0xbdd53b95, v18
    v_fma_f32 v152, v152, s44, v18
    v_fma_f32 v153, v153, s44, v18
    v_fma_f32 v154, v154, s44, v18
    v_fma_f32 v155, v155, s44, v18
    v_fma_f32 v160, v160, s44, v18
    v_fma_f32 v161, v161, s44, v18
    v_fma_f32 v156, v156, s44, v18
    v_fma_f32 v157, v157, s44, v18
    v_fma_f32 v158, v158, s44, v18
    v_fma_f32 v159, v159, s44, v18
    v_exp_f32 v152, v152
    v_exp_f32 v153, v153
    v_exp_f32 v154, v154
    v_exp_f32 v155, v155
    v_exp_f32 v160, v160
    v_exp_f32 v161, v161
    v_exp_f32 v156, v156
    v_exp_f32 v157, v157
    v_exp_f32 v158, v158
    v_exp_f32 v159, v159
    v_add_f32 v20, v152, v153
    v_add_f32 v20, v20, v154
    v_add_f32 v20, v20, v155
    v_add_f32 v20, v20, v160
    v_add_f32 v20, v20, v161
    v_add_f32 v20, v20, v156
    v_add_f32 v20, v20, v157
    v_add_f32 v20, v20, v158
    v_add_f32 v20, v20, v159
    v_mov_b32 v19, v20
    s_nop 1
    v_permlane16_swap_b32 v20, v19
    v_add_f32 v20, v20, v19
    v_mov_b32 v19, v20
    s_nop 1
    v_permlane32_swap_b32 v20, v19
    v_add_f32 v20, v20, v19
    v_rcp_f32 v20, v20
    s_nop 0
    v_mul_f32 v152, v152, v20
    v_mul_f32 v153, v153, v20
    v_mul_f32 v154, v154, v20
    v_mul_f32 v155, v155, v20
    v_mul_f32 v160, v160, v20
    v_mul_f32 v161, v161, v20
    v_mul_f32 v156, v156, v20
    v_mul_f32 v157, v157, v20
    v_mul_f32 v158, v158, v20
    v_mul_f32 v159, v159, v20
    v_cvt_pk_bf16_f32 v168, v152, v153
    v_cvt_pk_bf16_f32 v169, v154, v155
    v_cvt_pk_bf16_f32 v170, v160, v161
    v_cvt_pk_bf16_f32 v172, v156, v157
    v_cvt_pk_bf16_f32 v173, v158, v159
    buffer_store_dwordx4 v[164:167], v12, s[4:7], s43 offen offset:0 sc1
    buffer_store_dwordx4 v[168:171], v12, s[4:7], s43 offen offset:1024 sc1
    buffer_store_dwordx4 v[172:175], v12, s[4:7], s43 offen offset:2048 sc1
    s_waitcnt vmcnt(0)
    buffer_store_dword v17, v15, s[4:7], s38 offen sc1
    s_endpgm
L_pa_s:
    v_mov_b32 v1, 196
L_gw_123:
    buffer_load_dword v2, v1, s[8:11], 0 offen sc1
    s_sub_u32 s36, s36, 1
    s_cbranch_scc1 L_exit
    s_waitcnt vmcnt(0)
L_gw_123c:
    v_readfirstlane_b32 s90, v2
    s_nop 0
    s_cmp_eq_u32 s90, 0
    s_cbranch_scc1 L_gw_123
    s_branch L_pa_body
.section .rodata,"a"
.p2align 6
.amdhsa_kernel concat_heads__sliding_local_dilated__memory_aug_recurrent_mem_tr__prompt_kernel
  .amdhsa_next_free_vgpr 512
  .amdhsa_next_free_sgpr 102
  .amdhsa_accum_offset 256
  .amdhsa_group_segment_fixed_size 0
  .amdhsa_kernarg_size 104
  .amdhsa_user_sgpr_count 2
  .amdhsa_user_sgpr_kernarg_segment_ptr 1
  .amdhsa_system_sgpr_workgroup_id_x 1
  .amdhsa_float_denorm_mode_32 3
.end_amdhsa_kernel
```

```asm
; @launch grid=(256,1,1) block=(256,1,1) lds=163840
.amdgcn_target "amdgcn-amd-amdhsa--gfx950"
.text
.globl concat_heads__sliding_local_dilated__memory_aug_recurrent_mem_tr__prompt_kernel
.p2align 8
.type concat_heads__sliding_local_dilated__memory_aug_recurrent_mem_tr__prompt_kernel,@function
concat_heads__sliding_local_dilated__memory_aug_recurrent_mem_tr__prompt_kernel:
    s_cmp_ge_u32 s2, 256
    s_cbranch_scc1 L_exit
    s_load_dwordx16 s[64:79], s[0:1], 0
    s_load_dwordx8 s[80:87], s[0:1], 64
    s_load_dwordx2 s[88:89], s[0:1], 96
    s_getreg_b32 s33, hwreg(HW_REG_XCC_ID, 0, 4)
    v_lshrrev_b32 v1, 6, v0
    v_and_b32 v0, 63, v0
    v_readfirstlane_b32 s32, v1
    s_mov_b32 s36, 0x40000
    s_mov_b32 s96, 0
    s_mov_b32 s97, 0
    s_and_b32 s90, s33, 4
    s_lshl_b32 s90, s90, 5
    s_and_b32 s91, s33, 3
    s_lshl_b32 s91, s91, 2
    s_add_u32 s90, s90, s91
    s_lshr_b32 s91, s33, 3
    s_lshl_b32 s91, s91, 4
    s_add_u32 s90, s90, s91
    v_mov_b32 v1, s90
    v_mov_b32 v2, 1
    v_mov_b32 v3, 0
    s_waitcnt lgkmcnt(0)
    s_mov_b32 s8, s86
    s_and_b32 s9, s87, 0xffff
    s_mov_b32 s10, 256
    s_mov_b32 s11, 0x20000
    s_mov_b32 s4, s88
    s_and_b32 s5, s89, 0xffff
    s_mov_b32 s6, 33554432
    s_mov_b32 s7, 0x20000
    s_mov_b32 s28, s84
    s_and_b32 s29, s85, 0xffff
    s_mov_b32 s30, 5242880
    s_mov_b32 s31, 0x20000
    s_cmp_lg_u32 s32, 0
    s_cbranch_scc1 L_norank
    s_mov_b64 exec, 1
    buffer_atomic_add v2, v1, s[8:11], 0 offen sc0 sc1
    s_waitcnt vmcnt(0)
    ds_write_b32 v3, v2
    s_mov_b64 exec, -1
    s_waitcnt lgkmcnt(0)
    s_branch L_rank
L_norank:
    s_and_b32 s34, s33, 7
    s_lshr_b32 s93, s2, 3
    s_mul_i32 s93, s93, 3
    s_add_u32 s93, s93, s32
    s_sub_u32 s93, s93, 1
    v_add_u32 v4, 0, v0
    v_cmp_le_u32 vcc, 96, v4
    v_subrev_u32 v5, 96, v4
    s_nop 0
    v_cndmask_b32 v4, v4, v5, vcc
    v_lshlrev_b32 v4, 4, v4
    v_mov_b32 v5, 12288
    v_cndmask_b32 v5, 0, v5, vcc
    s_mul_i32 s90, s34, 1536
    v_add3_u32 v6, v4, v5, s90
    v_add_u32 v4, 64, v0
    v_cmp_le_u32 vcc, 96, v4
    v_subrev_u32 v5, 96, v4
    s_nop 0
    v_cndmask_b32 v4, v4, v5, vcc
    v_lshlrev_b32 v4, 4, v4
    v_mov_b32 v5, 12288
    v_cndmask_b32 v5, 0, v5, vcc
    s_mul_i32 s90, s34, 1536
    v_add3_u32 v7, v4, v5, s90
    v_add_u32 v4, 128, v0
    v_cmp_le_u32 vcc, 96, v4
    v_subrev_u32 v5, 96, v4
    s_nop 0
    v_cndmask_b32 v4, v4, v5, vcc
    v_lshlrev_b32 v4, 4, v4
    v_mov_b32 v5, 12288
    v_cndmask_b32 v5, 0, v5, vcc
    s_mul_i32 s90, s34, 1536
    v_add3_u32 v8, v4, v5, s90
    s_cmp_lt_u32 s93, 64
    s_cselect_b32 s12, s78, s76
    s_cselect_b32 s13, s79, s77
    s_cselect_b32 s91, 2, 0
    s_cmp_lt_u32 s93, 32
    s_cselect_b32 s12, s78, s12
    s_cselect_b32 s13, s79, s13
    s_cselect_b32 s91, 2, s91
    s_and_b32 s13, s13, 0xffff
    s_mov_b32 s14, 7864320
    s_mov_b32 s15, 0x20000
    s_mul_i32 s91, s91, 320
    s_mul_i32 s90, s93, 10
    s_add_u32 s90, s90, s91
    s_sub_u32 s90, s90, 640
    s_mul_i32 s90, s90, 12288
    buffer_load_dwordx4 v[248:251], v6, s[12:15], s90 offen
    buffer_load_dwordx4 v[248:251], v7, s[12:15], s90 offen
    buffer_load_dwordx4 v[248:251], v8, s[12:15], s90 offen
    s_add_u32 s90, s90, 24576
    buffer_load_dwordx4 v[248:251], v6, s[12:15], s90 offen
    buffer_load_dwordx4 v[248:251], v7, s[12:15], s90 offen
    buffer_load_dwordx4 v[248:251], v8, s[12:15], s90 offen
    s_add_u32 s90, s90, 24576
    buffer_load_dwordx4 v[248:251], v6, s[12:15], s90 offen
    buffer_load_dwordx4 v[248:251], v7, s[12:15], s90 offen
    buffer_load_dwordx4 v[248:251], v8, s[12:15], s90 offen
    s_add_u32 s90, s90, 24576
    buffer_load_dwordx4 v[248:251], v6, s[12:15], s90 offen
    buffer_load_dwordx4 v[248:251], v7, s[12:15], s90 offen
    buffer_load_dwordx4 v[248:251], v8, s[12:15], s90 offen
    s_add_u32 s90, s90, 24576
    buffer_load_dwordx4 v[248:251], v6, s[12:15], s90 offen
    buffer_load_dwordx4 v[248:251], v7, s[12:15], s90 offen
    buffer_load_dwordx4 v[248:251], v8, s[12:15], s90 offen
    s_add_u32 s90, s90, 24576
L_rank:
    s_barrier
    ds_read_b32 v2, v3
    s_waitcnt lgkmcnt(0)
    v_readfirstlane_b32 s35, v2
    s_mov_b32 s34, s33
    s_barrier
    s_cmp_ge_u32 s33, 8
    s_cbranch_scc1 L_norole
    s_cmp_ge_u32 s35, 32
    s_cbranch_scc1 L_norole
    s_lshl_b32 s38, s34, 21
    s_add_u32 s38, s38, 8388608
    s_cmp_lt_u32 s35, 28
    s_cbranch_scc1 L_noini_1
    v_mov_b32 v240, -1
    v_mov_b32 v241, -1
    v_mov_b32 v242, -1
    v_mov_b32 v243, -1
    v_mov_b32 v244, 0
    v_lshlrev_b32 v4, 4, v0
    v_lshlrev_b32 v5, 2, v0
    s_sub_u32 s93, s35, 28
    s_lshl_b32 s93, s93, 2
    s_add_u32 s93, s93, s32
    s_lshl_b32 s91, s34, 4
    s_add_u32 s91, s91, s93
    s_lshl_b32 s41, s91, 8
    s_add_u32 s41, s41, 1933312
    s_mul_i32 s91, s91, 5120
    s_lshl_b32 s40, s93, 8
    s_add_u32 s40, s40, s38
    s_add_u32 s40, s40, 458752
    s_lshr_b32 s92, s93, 3
    s_mul_i32 s92, s92, 114688
    s_add_u32 s92, s92, s38
    s_and_b32 s93, s93, 7
    s_mul_i32 s93, s93, 5120
    s_add_u32 s92, s92, s93
    buffer_store_dwordx4 v[240:243], v4, s[4:7], s91 offen offset:0 sc1
    buffer_store_dwordx4 v[240:243], v4, s[4:7], s91 offen offset:1024 sc1
    buffer_store_dwordx4 v[240:243], v4, s[4:7], s91 offen offset:2048 sc1
    buffer_store_dwordx4 v[240:243], v4, s[4:7], s91 offen offset:3072 sc1
    s_add_u32 s91, s91, 4096
    buffer_store_dwordx4 v[240:243], v4, s[4:7], s91 offen offset:0 sc1
    buffer_store_dwordx4 v[240:243], v4, s[4:7], s92 offen offset:0 sc1
    buffer_store_dwordx4 v[240:243], v4, s[4:7], s92 offen offset:1024 sc1
    buffer_store_dwordx4 v[240:243], v4, s[4:7], s92 offen offset:2048 sc1
    buffer_store_dwordx4 v[240:243], v4, s[4:7], s92 offen offset:3072 sc1
    s_add_u32 s92, s92, 4096
    buffer_store_dwordx4 v[240:243], v4, s[4:7], s92 offen offset:0 sc1
    buffer_store_dword v244, v5, s[4:7], s40 offen sc1
    buffer_store_dword v244, v5, s[4:7], s41 offen sc1
    s_waitcnt vmcnt(0)
    s_barrier
    s_cmp_lg_u32 s32, 0
    s_cbranch_scc1 L_ini_2
    v_mov_b32 v1, 64
    v_mov_b32 v2, 1
    s_mov_b64 exec, 1
    buffer_atomic_add v2, v1, s[8:11], 0 offen sc0 sc1
    s_waitcnt vmcnt(0)
    v_readfirstlane_b32 s90, v2
    s_mov_b64 exec, -1
    s_cmp_lg_u32 s90, 31
    s_cbranch_scc1 L_ini_2
    v_mov_b32 v1, 192
    v_mov_b32 v2, 1
    s_mov_b64 exec, 1
    buffer_store_dword v2, v1, s[8:11], 0 offen sc1
    s_mov_b64 exec, -1
L_ini_2:
    s_barrier
    s_cmp_eq_u32 s35, 28
    s_cbranch_scc1 L_px_f
L_noini_1:
    s_sub_u32 s93, s35, 12
    s_cmp_lt_u32 s93, 6
    s_cbranch_scc1 L_v_f
    s_cmp_ge_u32 s35, 12
    s_cselect_b32 s92, 6, 0
    s_sub_u32 s93, s35, s92
    s_cmp_gt_u32 s35, 28
    s_subb_u32 s93, s93, 0
    s_lshl_b32 s93, s93, 2
    s_add_u32 s93, s93, s32
    s_cmp_ge_u32 s93, 96
    s_cbranch_scc1 L_pa_f
    v_add_u32 v4, 0, v0
    v_cmp_le_u32 vcc, 96, v4
    v_subrev_u32 v5, 96, v4
    s_nop 0
    v_cndmask_b32 v4, v4, v5, vcc
    v_lshlrev_b32 v4, 4, v4
    v_mov_b32 v5, 12288
    v_cndmask_b32 v5, 0, v5, vcc
    s_mul_i32 s90, s34, 1536
    v_add3_u32 v6, v4, v5, s90
    v_add_u32 v4, 64, v0
    v_cmp_le_u32 vcc, 96, v4
    v_subrev_u32 v5, 96, v4
    s_nop 0
    v_cndmask_b32 v4, v4, v5, vcc
    v_lshlrev_b32 v4, 4, v4
    v_mov_b32 v5, 12288
    v_cndmask_b32 v5, 0, v5, vcc
    s_mul_i32 s90, s34, 1536
    v_add3_u32 v7, v4, v5, s90
    v_add_u32 v4, 128, v0
    v_cmp_le_u32 vcc, 96, v4
    v_subrev_u32 v5, 96, v4
    s_nop 0
    v_cndmask_b32 v4, v4, v5, vcc
    v_lshlrev_b32 v4, 4, v4
    v_mov_b32 v5, 12288
    v_cndmask_b32 v5, 0, v5, vcc
    s_mul_i32 s90, s34, 1536
    v_add3_u32 v8, v4, v5, s90
    s_cmp_lt_u32 s93, 64
    s_cselect_b32 s12, s76, s74
    s_cselect_b32 s13, s77, s75
    s_cselect_b32 s91, 2, 1
    s_cmp_lt_u32 s93, 32
    s_cselect_b32 s12, s74, s12
    s_cselect_b32 s13, s75, s13
    s_cselect_b32 s91, 2, s91
    s_and_b32 s13, s13, 0xffff
    s_mov_b32 s14, 7864320
    s_mov_b32 s15, 0x20000
    s_mul_i32 s91, s91, 320
    s_mul_i32 s90, s93, 10
    s_add_u32 s90, s90, s91
    s_sub_u32 s90, s90, 640
    s_mul_i32 s90, s90, 12288
    buffer_load_dwordx4 v[248:251], v6, s[12:15], s90 offen
    buffer_load_dwordx4 v[248:251], v7, s[12:15], s90 offen
    buffer_load_dwordx4 v[248:251], v8, s[12:15], s90 offen
    s_add_u32 s90, s90, 24576
    buffer_load_dwordx4 v[248:251], v6, s[12:15], s90 offen
    buffer_load_dwordx4 v[248:251], v7, s[12:15], s90 offen
    buffer_load_dwordx4 v[248:251], v8, s[12:15], s90 offen
    s_add_u32 s90, s90, 24576
    buffer_load_dwordx4 v[248:251], v6, s[12:15], s90 offen
    buffer_load_dwordx4 v[248:251], v7, s[12:15], s90 offen
    buffer_load_dwordx4 v[248:251], v8, s[12:15], s90 offen
    s_add_u32 s90, s90, 24576
    buffer_load_dwordx4 v[248:251], v6, s[12:15], s90 offen
    buffer_load_dwordx4 v[248:251], v7, s[12:15], s90 offen
    buffer_load_dwordx4 v[248:251], v8, s[12:15], s90 offen
    s_add_u32 s90, s90, 24576
    buffer_load_dwordx4 v[248:251], v6, s[12:15], s90 offen
    buffer_load_dwordx4 v[248:251], v7, s[12:15], s90 offen
    buffer_load_dwordx4 v[248:251], v8, s[12:15], s90 offen
    s_add_u32 s90, s90, 24576
    s_waitcnt vmcnt(20)
    s_nop 0
    s_cmp_lt_u32 s35, 12
    s_cbranch_scc1 L_qkv_f
    s_cmp_lt_u32 s35, 18
    s_cbranch_scc1 L_v_f
    s_cmp_lt_u32 s35, 28
    s_cbranch_scc1 L_wo_f
    s_cmp_lt_u32 s35, 29
    s_cbranch_scc1 L_px_f
    s_branch L_pa_f
L_norole:
    v_mov_b32 v1, 192
    v_mov_b32 v2, 2
    s_mov_b64 exec, 1
    buffer_store_dword v2, v1, s[8:11], 0 offen sc1
    s_mov_b64 exec, -1
    s_branch L_slow
L_exit:
    s_endpgm
L_qkv_f:
    s_mov_b32 s12, s74
    s_and_b32 s13, s75, 0xffff
    s_mov_b32 s14, 7864320
    s_mov_b32 s15, 0x20000
    s_mov_b32 s16, s76
    s_and_b32 s17, s77, 0xffff
    s_mov_b32 s18, 7864320
    s_mov_b32 s19, 0x20000
    s_mov_b32 s40, s35
    s_mov_b32 s24, s70
    s_and_b32 s25, s71, 0xffff
    s_mov_b32 s26, 2621440
    s_mov_b32 s27, 0x20000
    v_and_b32 v1, 15, v0
    v_lshrrev_b32 v2, 4, v0
    v_lshrrev_b32 v3, 3, v0
    v_and_b32 v4, 7, v0
    s_lshl_b32 s90, s32, 3
    v_add_u32 v5, s90, v3
    s_and_b32 s91, s32, 1
    s_lshl_b32 s91, s91, 2
    v_and_b32 v6, 2, v3
    v_or_b32 v6, s91, v6
    v_xor_b32 v6, v6, v4
    v_lshlrev_b32 v6, 4, v6
    v_mul_u32_u24 v7, 12288, v5
    s_mul_i32 s92, s34, 1536
    s_lshl_b32 s93, s40, 7
    s_add_u32 s92, s92, s93
    v_add3_u32 v124, v6, v7, s92
    v_lshrrev_b32 v6, 1, v3
    v_or_b32 v6, s91, v6
    v_xor_b32 v6, v6, v4
    v_lshlrev_b32 v6, 4, v6
    v_mul_u32_u24 v7, 1280, v5
    v_add_u32 v10, v6, v7
    s_lshl_b32 s90, s32, 10
    s_add_u32 m0, s90, 81920
    s_mov_b32 s91, 0
    buffer_load_dwordx4 v124, s[16:19], s91 offen nt lds
    s_add_u32 m0, m0, 4096
    s_add_u32 s91, s91, 393216
    buffer_load_dwordx4 v124, s[16:19], s91 offen nt lds
    s_add_u32 m0, m0, 4096
    s_add_u32 s91, s91, 393216
    buffer_load_dwordx4 v124, s[16:19], s91 offen nt lds
    s_add_u32 m0, m0, 4096
    s_add_u32 s91, s91, 393216
    buffer_load_dwordx4 v124, s[16:19], s91 offen nt lds
    s_add_u32 m0, m0, 4096
    s_add_u32 s91, s91, 393216
    buffer_load_dwordx4 v124, s[16:19], s91 offen nt lds
    s_add_u32 m0, m0, 4096
    s_add_u32 s91, s91, 393216
    buffer_load_dwordx4 v124, s[16:19], s91 offen nt lds
    s_add_u32 m0, m0, 4096
    s_add_u32 s91, s91, 393216
    buffer_load_dwordx4 v124, s[16:19], s91 offen nt lds
    s_add_u32 m0, m0, 4096
    s_add_u32 s91, s91, 393216
    buffer_load_dwordx4 v124, s[16:19], s91 offen nt lds
    s_add_u32 m0, m0, 4096
    s_add_u32 s91, s91, 393216
    buffer_load_dwordx4 v124, s[16:19], s91 offen nt lds
    s_add_u32 m0, m0, 4096
    s_add_u32 s91, s91, 393216
    buffer_load_dwordx4 v124, s[16:19], s91 offen nt lds
    s_mul_i32 s60, s40, 86
    s_lshr_b32 s60, s60, 8
    s_mul_i32 s61, s60, 3
    s_sub_u32 s61, s40, s61
    s_add_u32 s90, s40, 1
    s_mul_i32 s62, s90, 86
    s_lshr_b32 s62, s62, 8
    s_mul_i32 s63, s62, 3
    s_sub_u32 s63, s90, s63
    v_lshrrev_b32 v3, 1, v2
    v_and_b32 v5, 1, v2
    s_lshl_b32 s90, s32, 9
    v_lshlrev_b32 v6, 4, v1
    v_lshl_add_u32 v6, v3, 8, v6
    v_add_u32 v6, s90, v6
    s_mul_i32 s90, s60, 12288
    s_lshl_b32 s91, s61, 11
    s_add_u32 s90, s90, s91
    v_mul_u32_u24 v7, 6144, v5
    v_add3_u32 v19, v6, v7, s90
    v_mov_b32 v22, -1
    s_mov_b32 s56, 49152
    v_lshl_add_u32 v137, v5, 11, v6
    v_add_u32 v137, 135168, v137
    s_mul_i32 s90, s40, 1280
    s_add_u32 s90, s90, 10240
    v_lshlrev_b32 v6, 1, v5
    v_or_b32 v7, v6, v3
    v_lshl_add_u32 v7, v7, 4, v1
    v_lshlrev_b32 v7, 2, v7
    v_add_u32 v7, 1024, v7
    v_or_b32 v6, v6, v1
    v_lshl_add_u32 v6, v3, 4, v6
    v_lshlrev_b32 v6, 4, v6
    s_sub_u32 s91, s32, 1
    s_lshl_b32 s91, s91, 9
    v_add_u32 v6, s91, v6
    s_cmp_eq_u32 s32, 0
    s_cselect_b64 vcc, -1, 0
    v_cndmask_b32 v6, v6, v7, vcc
    v_add_u32 v135, s90, v6
    s_lshl_b32 s91, s32, 8
    s_add_u32 s91, s91, s90
    v_lshl_add_u32 v150, v0, 2, s91
    v_and_b32 v4, 2, v1
    v_cmp_eq_u32 vcc, 0, v4
    v_mov_b32 v9, 2146435072
    s_nop 0
    v_cndmask_b32 v135, v9, v135, vcc
    s_lshl_b32 s90, s40, 10
    v_lshrrev_b32 v3, 2, v1
    v_lshlrev_b32 v3, 1, v3
    v_and_b32 v6, 1, v1
    v_or_b32 v3, v3, v6
    v_lshl_add_u32 v3, v2, 3, v3
    v_lshl_add_u32 v136, v3, 4, s90
    v_cmp_ne_u32 vcc, 0, v4
    v_mov_b32 v9, 2146435072
    s_nop 0
    v_cndmask_b32 v136, v9, v136, vcc
    v_and_b32 v6, 9, v1
    v_lshl_or_b32 v6, v4, 1, v6
    v_and_b32 v7, 4, v1
    v_lshrrev_b32 v7, 1, v7
    v_or_b32 v6, v6, v7
    v_lshlrev_b32 v6, 4, v6
    v_lshl_add_u32 v6, v2, 8, v6
    s_cmp_eq_u32 s32, 2
    s_cselect_b32 s90, 2048, 0
    s_add_u32 s90, s90, 135168
    v_add_u32 v138, s90, v6
    s_lshl_b32 s90, s60, 7
    s_lshl_b32 s91, s61, 2
    s_add_u32 s91, s91, s90
    s_add_u32 s91, s91, 459264
    s_cmp_eq_u32 s32, 3
    s_cselect_b32 s91, s91, 2146435072
    s_cselect_b32 s55, -1, 0
    v_mov_b32 v139, s91
    v_cmp_eq_u32 vcc, 0, v0
    v_mov_b32 v9, 2146435072
    s_nop 0
    v_cndmask_b32 v139, v9, v139, vcc
    v_add_u32 v21, 3072, v139
    s_mul_i32 s90, s35, 32768
    s_lshl_b32 s91, s32, 11
    s_add_u32 s90, s90, s91
    s_lshl_b32 s92, s35, 10
    s_lshl_b32 s91, s32, 8
    s_add_u32 s92, s92, s91
    s_cmp_lt_u32 s35, 10
    s_cselect_b32 s90, s90, 2146435072
    s_cselect_b32 s92, s92, 2146435072
    s_lshl_b32 s91, s34, 8
    v_lshlrev_b32 v3, 4, v0
    v_xor_b32 v3, s91, v3
    v_add_u32 v142, s90, v3
    v_xor_b32 v3, 1024, v3
    v_add_u32 v143, s90, v3
    s_min_u32 s90, s35, 9
    s_lshl_b32 s90, s90, 7
    s_add_u32 s90, s90, 460800
    s_add_u32 s90, s90, s38
    v_and_b32 v3, 3, v0
    v_lshl_add_u32 v146, v3, 2, s90
    v_lshl_add_u32 v149, v0, 2, s92
    v_lshl_add_u32 v148, v1, 4, s92
    v_cmp_eq_u32 vcc, 0, v2
    v_mov_b32 v9, 2146435072
    s_nop 0
    v_cndmask_b32 v148, v9, v148, vcc
    v_and_b32 v7, 1, v1
    v_cmp_ne_u32 vcc, 0, v7
    v_mov_b32 v5, 0x3f80
    v_mov_b32 v6, 0x3f800000
    v_cndmask_b32 v5, v5, v6, vcc
    v_bfe_u32 v6, v1, 1, 1
    v_cmp_eq_u32 vcc, 0, v6
    s_nop 1
    v_cndmask_b32 v198, 0, v5, vcc
    v_mov_b32 v196, 0
    v_mov_b32 v200, 0
    v_cmp_eq_u32 vcc, 1, v6
    s_nop 1
    v_cndmask_b32 v199, 0, v5, vcc
    v_mov_b32 v197, 0
    v_mov_b32 v201, 0
    v_lshrrev_b32 v3, 2, v1
    v_and_b32 v4, 3, v1
    v_and_b32 v5, 1, v2
    v_lshl_add_u32 v6, v2, 3, v3
    v_lshlrev_b32 v6, 7, v6
    v_and_b32 v7, 2, v3
    v_lshl_or_b32 v7, v5, 2, v7
    v_lshrrev_b32 v8, 1, v4
    s_lshl_b32 s90, s32, 1
    v_or_b32 v8, s90, v8
    v_xor_b32 v7, v7, v8
    v_lshl_add_u32 v6, v7, 4, v6
    v_and_b32 v7, 1, v4
    v_lshl_add_u32 v6, v7, 3, v6
    v_add_u32 v125, 81920, v6
    v_add_u32 v126, 40960, v6
    v_add_u32 v127, 122880, v6
    s_lshl_b32 s90, s32, 9
    s_add_u32 s90, s90, 133120
    v_xor_b32 v6, 0, v5
    v_lshl_add_u32 v6, v6, 2, v3
    v_lshl_add_u32 v6, v2, 3, v6
    v_lshlrev_b32 v6, 5, v6
    v_lshl_or_b32 v7, v5, 1, 0
    v_xor_b32 v7, v7, v4
    v_lshl_add_u32 v6, v7, 3, v6
    v_add_u32 v24, 133120, v6
    v_xor_b32 v6, 1, v5
    v_lshl_add_u32 v6, v6, 2, v3
    v_lshl_add_u32 v6, v2, 3, v6
    v_lshlrev_b32 v6, 5, v6
    v_lshl_or_b32 v7, v5, 1, 1
    v_xor_b32 v7, v7, v4
    v_lshl_add_u32 v6, v7, 3, v6
    v_add_u32 v134, 133120, v6
    v_lshrrev_b32 v6, 3, v1
    v_lshlrev_b32 v6, 2, v6
    v_xor_b32 v6, v6, v1
    v_lshlrev_b32 v6, 5, v6
    v_xor_b32 v7, v2, v3
    v_lshl_add_u32 v6, v7, 3, v6
    v_add_u32 v23, s90, v6
    v_and_b32 v7, 2, v1
    v_cmp_ne_u32 vcc, 0, v7
    v_mov_b32 v6, 0x4444
    v_mov_b32 v8, 0xeeee
    v_cndmask_b32 v17, v6, v8, vcc
    v_lshlrev_b32 v6, 4, v0
    v_add_u32 v16, 122880, v6
    s_mul_i32 s90, s32, 2560
    v_lshl_add_u32 v13, v0, 4, s90
    v_lshl_add_u32 v14, v0, 2, s90
    s_add_u32 s48, s90, 122880
    v_mul_u32_u24 v6, 40, v0
    v_add_u32 v15, s48, v6
    v_mul_u32_u24 v6, 164, v0
    v_min_u32 v6, 10236, v6
    v_add_u32 v25, 122880, v6
    v_lshrrev_b32 v6, 3, v1
    v_lshlrev_b32 v6, 10, v6
    v_and_b32 v7, 7, v1
    v_lshl_add_u32 v6, v7, 7, v6
    v_lshrrev_b32 v7, 1, v1
    v_xor_b32 v7, v7, v2
    v_lshl_add_u32 v11, v7, 4, v6
    v_xor_b32 v12, 64, v11
    s_and_b32 s91, s34, 1
    s_lshl_b32 s91, s91, 12
    s_lshr_b32 s92, s34, 2
    s_lshl_b32 s92, s92, 13
    s_add_u32 s91, s91, s92
    s_and_b32 s92, s34, 2
    s_lshl_b32 s92, s92, 13
    s_add_u32 s91, s91, s92
    s_add_u32 s91, s91, 1933312
    v_lshrrev_b32 v4, 2, v0
    v_lshl_add_u32 v3, v4, 9, s91
    v_cmp_ne_u32 s[92:93], s34, v4
    v_cmp_gt_u32 vcc, 32, v0
    s_nop 0
    s_and_b64 vcc, vcc, s[92:93]
    s_and_b32 vcc_lo, vcc_lo, s55
    v_cndmask_b32 v146, v146, v3, vcc
    v_cndmask_b32 v152, 0, -1, vcc
    s_lshl_b32 s90, s32, 10
    s_add_u32 m0, s90, 40960
    s_mov_b32 s91, 0
    buffer_load_dwordx4 v124, s[12:15], s91 offen nt lds
    s_add_u32 m0, m0, 4096
    s_add_u32 s91, s91, 393216
    buffer_load_dwordx4 v124, s[12:15], s91 offen nt lds
    s_add_u32 m0, m0, 4096
    s_add_u32 s91, s91, 393216
    buffer_load_dwordx4 v124, s[12:15], s91 offen nt lds
    s_add_u32 m0, m0, 4096
    s_add_u32 s91, s91, 393216
    buffer_load_dwordx4 v124, s[12:15], s91 offen nt lds
    s_add_u32 m0, m0, 4096
    s_add_u32 s91, s91, 393216
    buffer_load_dwordx4 v124, s[12:15], s91 offen nt lds
    s_add_u32 m0, m0, 4096
    s_add_u32 s91, s91, 393216
    buffer_load_dwordx4 v124, s[12:15], s91 offen nt lds
    s_add_u32 m0, m0, 4096
    s_add_u32 s91, s91, 393216
    buffer_load_dwordx4 v124, s[12:15], s91 offen nt lds
    s_add_u32 m0, m0, 4096
    s_add_u32 s91, s91, 393216
    buffer_load_dwordx4 v124, s[12:15], s91 offen nt lds
    s_add_u32 m0, m0, 4096
    s_add_u32 s91, s91, 393216
    buffer_load_dwordx4 v124, s[12:15], s91 offen nt lds
    s_add_u32 m0, m0, 4096
    s_add_u32 s91, s91, 393216
    buffer_load_dwordx4 v124, s[12:15], s91 offen nt lds
    s_lshl_b32 s90, s32, 10
    s_add_u32 m0, s90, 122880
    s_mov_b32 s91, 3932160
    buffer_load_dwordx4 v124, s[16:19], s91 offen nt lds
    s_add_u32 m0, m0, 4096
    s_add_u32 s91, s91, 393216
    buffer_load_dwordx4 v124, s[16:19], s91 offen nt lds
    s_add_u32 m0, m0, 4096
    s_add_u32 s91, s91, 393216
    buffer_load_dwordx4 v124, s[16:19], s91 offen nt lds
    s_add_u32 m0, m0, 4096
    s_add_u32 s91, s91, 393216
    buffer_load_dwordx4 v124, s[16:19], s91 offen nt lds
    s_add_u32 m0, m0, 4096
    s_add_u32 s91, s91, 393216
    buffer_load_dwordx4 v124, s[16:19], s91 offen nt lds
    s_add_u32 m0, m0, 4096
    s_add_u32 s91, s91, 393216
    buffer_load_dwordx4 v124, s[16:19], s91 offen nt lds
    s_add_u32 m0, m0, 4096
    s_add_u32 s91, s91, 393216
    buffer_load_dwordx4 v124, s[16:19], s91 offen nt lds
    s_add_u32 m0, m0, 4096
    s_add_u32 s91, s91, 393216
    buffer_load_dwordx4 v124, s[16:19], s91 offen nt lds
    s_add_u32 m0, m0, 4096
    s_add_u32 s91, s91, 393216
    buffer_load_dwordx4 v124, s[16:19], s91 offen nt lds
    s_add_u32 m0, m0, 4096
    s_add_u32 s91, s91, 393216
    buffer_load_dwordx4 v124, s[16:19], s91 offen nt lds
    s_mov_b32 s46, 0
    s_lshl_b32 s90, s32, 10
    s_add_u32 m0, s90, 0
    s_nop 0
    buffer_load_dwordx4 v10, s[24:27], s46 offen offset:0 lds
    s_add_u32 m0, m0, 3968
    s_nop 0
    buffer_load_dwordx4 v10, s[24:27], s46 offen offset:128 lds
    s_add_u32 m0, m0, 3968
    s_nop 0
    buffer_load_dwordx4 v10, s[24:27], s46 offen offset:256 lds
    s_add_u32 m0, m0, 3968
    s_nop 0
    buffer_load_dwordx4 v10, s[24:27], s46 offen offset:384 lds
    s_add_u32 m0, m0, 3968
    s_nop 0
    buffer_load_dwordx4 v10, s[24:27], s46 offen offset:512 lds
    s_add_u32 m0, m0, 3968
    s_nop 0
    buffer_load_dwordx4 v10, s[24:27], s46 offen offset:640 lds
    s_add_u32 m0, m0, 3968
    s_nop 0
    buffer_load_dwordx4 v10, s[24:27], s46 offen offset:768 lds
    s_add_u32 m0, m0, 3968
    s_nop 0
    buffer_load_dwordx4 v10, s[24:27], s46 offen offset:896 lds
    s_add_u32 m0, m0, 3968
    s_nop 0
    buffer_load_dwordx4 v10, s[24:27], s46 offen offset:1024 lds
    s_add_u32 m0, m0, 3968
    s_nop 0
    buffer_load_dwordx4 v10, s[24:27], s46 offen offset:1152 lds
    s_waitcnt vmcnt(30)
    s_barrier
    ds_read_b64_tr_b16 a[80:81], v125 offset:0
    ds_read_b64_tr_b16 a[82:83], v125 offset:512
    ds_read_b64_tr_b16 a[84:85], v125 offset:4096
    ds_read_b64_tr_b16 a[86:87], v125 offset:4608
    ds_read_b64_tr_b16 a[88:89], v125 offset:8192
    ds_read_b64_tr_b16 a[90:91], v125 offset:8704
    ds_read_b64_tr_b16 a[92:93], v125 offset:12288
    ds_read_b64_tr_b16 a[94:95], v125 offset:12800
    ds_read_b64_tr_b16 a[96:97], v125 offset:16384
    ds_read_b64_tr_b16 a[98:99], v125 offset:16896
    ds_read_b64_tr_b16 a[100:101], v125 offset:20480
    ds_read_b64_tr_b16 a[102:103], v125 offset:20992
    ds_read_b64_tr_b16 a[104:105], v125 offset:24576
    ds_read_b64_tr_b16 a[106:107], v125 offset:25088
    ds_read_b64_tr_b16 a[108:109], v125 offset:28672
    ds_read_b64_tr_b16 a[110:111], v125 offset:29184
    ds_read_b64_tr_b16 a[112:113], v125 offset:32768
    ds_read_b64_tr_b16 a[114:115], v125 offset:33280
    ds_read_b64_tr_b16 a[116:117], v125 offset:36864
    ds_read_b64_tr_b16 a[118:119], v125 offset:37376
    s_waitcnt lgkmcnt(0)
    s_barrier
    s_lshl_b32 s90, s32, 10
    s_add_u32 m0, s90, 81920
    s_mov_b32 s91, 3932160
    buffer_load_dwordx4 v124, s[12:15], s91 offen nt lds
    s_add_u32 m0, m0, 4096
    s_add_u32 s91, s91, 393216
    buffer_load_dwordx4 v124, s[12:15], s91 offen nt lds
    s_add_u32 m0, m0, 4096
    s_add_u32 s91, s91, 393216
    buffer_load_dwordx4 v124, s[12:15], s91 offen nt lds
    s_add_u32 m0, m0, 4096
    s_add_u32 s91, s91, 393216
    buffer_load_dwordx4 v124, s[12:15], s91 offen nt lds
    s_add_u32 m0, m0, 4096
    s_add_u32 s91, s91, 393216
    buffer_load_dwordx4 v124, s[12:15], s91 offen nt lds
    s_add_u32 m0, m0, 4096
    s_add_u32 s91, s91, 393216
    buffer_load_dwordx4 v124, s[12:15], s91 offen nt lds
    s_add_u32 m0, m0, 4096
    s_add_u32 s91, s91, 393216
    buffer_load_dwordx4 v124, s[12:15], s91 offen nt lds
    s_add_u32 m0, m0, 4096
    s_add_u32 s91, s91, 393216
    buffer_load_dwordx4 v124, s[12:15], s91 offen nt lds
    s_add_u32 m0, m0, 4096
    s_add_u32 s91, s91, 393216
    buffer_load_dwordx4 v124, s[12:15], s91 offen nt lds
    s_add_u32 m0, m0, 4096
    s_add_u32 s91, s91, 393216
    buffer_load_dwordx4 v124, s[12:15], s91 offen nt lds
    s_waitcnt vmcnt(30)
    s_barrier
    ds_read_b64_tr_b16 a[0:1], v126 offset:0
    ds_read_b64_tr_b16 a[2:3], v126 offset:512
    ds_read_b64_tr_b16 a[4:5], v126 offset:4096
    ds_read_b64_tr_b16 a[6:7], v126 offset:4608
    ds_read_b64_tr_b16 a[8:9], v126 offset:8192
    ds_read_b64_tr_b16 a[10:11], v126 offset:8704
    ds_read_b64_tr_b16 a[12:13], v126 offset:12288
    ds_read_b64_tr_b16 a[14:15], v126 offset:12800
    ds_read_b64_tr_b16 a[16:17], v126 offset:16384
    ds_read_b64_tr_b16 a[18:19], v126 offset:16896
    ds_read_b64_tr_b16 a[20:21], v126 offset:20480
    ds_read_b64_tr_b16 a[22:23], v126 offset:20992
    ds_read_b64_tr_b16 a[24:25], v126 offset:24576
    ds_read_b64_tr_b16 a[26:27], v126 offset:25088
    ds_read_b64_tr_b16 a[28:29], v126 offset:28672
    ds_read_b64_tr_b16 a[30:31], v126 offset:29184
    ds_read_b64_tr_b16 a[32:33], v126 offset:32768
    ds_read_b64_tr_b16 a[34:35], v126 offset:33280
    ds_read_b64_tr_b16 a[36:37], v126 offset:36864
    ds_read_b64_tr_b16 a[38:39], v126 offset:37376
    s_waitcnt lgkmcnt(0)
    s_barrier
    s_mov_b32 s46, 40960
    s_lshl_b32 s90, s32, 10
    s_add_u32 m0, s90, 40960
    s_nop 0
    buffer_load_dwordx4 v10, s[24:27], s46 offen offset:0 lds
    s_add_u32 m0, m0, 3968
    s_nop 0
    buffer_load_dwordx4 v10, s[24:27], s46 offen offset:128 lds
    s_add_u32 m0, m0, 3968
    s_nop 0
    buffer_load_dwordx4 v10, s[24:27], s46 offen offset:256 lds
    s_add_u32 m0, m0, 3968
    s_nop 0
    buffer_load_dwordx4 v10, s[24:27], s46 offen offset:384 lds
    s_add_u32 m0, m0, 3968
    s_nop 0
    buffer_load_dwordx4 v10, s[24:27], s46 offen offset:512 lds
    s_add_u32 m0, m0, 3968
    s_nop 0
    buffer_load_dwordx4 v10, s[24:27], s46 offen offset:640 lds
    s_add_u32 m0, m0, 3968
    s_nop 0
    buffer_load_dwordx4 v10, s[24:27], s46 offen offset:768 lds
    s_add_u32 m0, m0, 3968
    s_nop 0
    buffer_load_dwordx4 v10, s[24:27], s46 offen offset:896 lds
    s_add_u32 m0, m0, 3968
    s_nop 0
    buffer_load_dwordx4 v10, s[24:27], s46 offen offset:1024 lds
    s_add_u32 m0, m0, 3968
    s_nop 0
    buffer_load_dwordx4 v10, s[24:27], s46 offen offset:1152 lds
    s_waitcnt vmcnt(30)
    s_barrier
    ds_read_b64_tr_b16 a[120:121], v127 offset:0
    ds_read_b64_tr_b16 a[122:123], v127 offset:512
    ds_read_b64_tr_b16 a[124:125], v127 offset:4096
    ds_read_b64_tr_b16 a[126:127], v127 offset:4608
    ds_read_b64_tr_b16 a[128:129], v127 offset:8192
    ds_read_b64_tr_b16 a[130:131], v127 offset:8704
    ds_read_b64_tr_b16 a[132:133], v127 offset:12288
    ds_read_b64_tr_b16 a[134:135], v127 offset:12800
    ds_read_b64_tr_b16 a[136:137], v127 offset:16384
    ds_read_b64_tr_b16 a[138:139], v127 offset:16896
    ds_read_b64_tr_b16 a[140:141], v127 offset:20480
    ds_read_b64_tr_b16 a[142:143], v127 offset:20992
    ds_read_b64_tr_b16 a[144:145], v127 offset:24576
    ds_read_b64_tr_b16 a[146:147], v127 offset:25088
    ds_read_b64_tr_b16 a[148:149], v127 offset:28672
    ds_read_b64_tr_b16 a[150:151], v127 offset:29184
    ds_read_b64_tr_b16 a[152:153], v127 offset:32768
    ds_read_b64_tr_b16 a[154:155], v127 offset:33280
    ds_read_b64_tr_b16 a[156:157], v127 offset:36864
    ds_read_b64_tr_b16 a[158:159], v127 offset:37376
    s_waitcnt lgkmcnt(0)
    s_waitcnt vmcnt(10)
    s_barrier
    ds_read_b64_tr_b16 a[40:41], v125 offset:0
    ds_read_b64_tr_b16 a[42:43], v125 offset:512
    ds_read_b64_tr_b16 a[44:45], v125 offset:4096
    ds_read_b64_tr_b16 a[46:47], v125 offset:4608
    ds_read_b64_tr_b16 a[48:49], v125 offset:8192
    ds_read_b64_tr_b16 a[50:51], v125 offset:8704
    ds_read_b64_tr_b16 a[52:53], v125 offset:12288
    ds_read_b64_tr_b16 a[54:55], v125 offset:12800
    ds_read_b64_tr_b16 a[56:57], v125 offset:16384
    ds_read_b64_tr_b16 a[58:59], v125 offset:16896
    ds_read_b64_tr_b16 a[60:61], v125 offset:20480
    ds_read_b64_tr_b16 a[62:63], v125 offset:20992
    ds_read_b64_tr_b16 a[64:65], v125 offset:24576
    ds_read_b64_tr_b16 a[66:67], v125 offset:25088
    ds_read_b64_tr_b16 a[68:69], v125 offset:28672
    ds_read_b64_tr_b16 a[70:71], v125 offset:29184
    ds_read_b64_tr_b16 a[72:73], v125 offset:32768
    ds_read_b64_tr_b16 a[74:75], v125 offset:33280
    ds_read_b64_tr_b16 a[76:77], v125 offset:36864
    ds_read_b64_tr_b16 a[78:79], v125 offset:37376
    s_waitcnt lgkmcnt(0)
    s_mov_b32 s49, 40960
    s_mov_b32 s47, 40960
    s_mov_b32 s37, -1
    s_add_u32 s44, s38, 475136
    s_add_u32 s45, s44, s56
    s_mov_b32 s46, 40960
    v_add_u32 v140, 0, v137
    v_mov_b32 v1, 192
    buffer_load_dword v2, v1, s[8:11], 0 offen sc1
    ds_read_b128 v[84:87], v11 offset:0
    ds_read_b128 v[88:91], v11 offset:2048
    ds_read_b128 v[92:95], v12 offset:0
    ds_read_b128 v[96:99], v12 offset:2048
    s_waitcnt lgkmcnt(2)
    v_mfma_f32_16x16x32_bf16 v[108:111], a[0:3], v[84:87], 0
    ds_read_b128 v[100:103], v11 offset:4096
    v_mfma_f32_16x16x32_bf16 v[112:115], a[0:3], v[88:91], 0
    ds_read_b128 v[104:107], v11 offset:6144
    v_mfma_f32_16x16x32_bf16 v[116:119], a[80:83], v[84:87], 0
    v_mfma_f32_16x16x32_bf16 v[120:123], a[80:83], v[88:91], 0
    s_waitcnt lgkmcnt(2)
    v_mfma_f32_16x16x32_bf16 v[108:111], a[4:7], v[92:95], v[108:111]
    ds_read_b128 v[84:87], v12 offset:4096
    v_mfma_f32_16x16x32_bf16 v[112:115], a[4:7], v[96:99], v[112:115]
    ds_read_b128 v[88:91], v12 offset:6144
    v_mfma_f32_16x16x32_bf16 v[116:119], a[84:87], v[92:95], v[116:119]
    v_mfma_f32_16x16x32_bf16 v[120:123], a[84:87], v[96:99], v[120:123]
    s_waitcnt lgkmcnt(2)
    v_mfma_f32_16x16x32_bf16 v[108:111], a[8:11], v[100:103], v[108:111]
    ds_read_b128 v[92:95], v11 offset:8192
    v_mfma_f32_16x16x32_bf16 v[112:115], a[8:11], v[104:107], v[112:115]
    ds_read_b128 v[96:99], v11 offset:10240
    v_mfma_f32_16x16x32_bf16 v[116:119], a[88:91], v[100:103], v[116:119]
    v_mfma_f32_16x16x32_bf16 v[120:123], a[88:91], v[104:107], v[120:123]
    s_waitcnt lgkmcnt(2)
    v_mfma_f32_16x16x32_bf16 v[108:111], a[12:15], v[84:87], v[108:111]
    ds_read_b128 v[100:103], v12 offset:8192
    v_mfma_f32_16x16x32_bf16 v[112:115], a[12:15], v[88:91], v[112:115]
    ds_read_b128 v[104:107], v12 offset:10240
    v_mfma_f32_16x16x32_bf16 v[116:119], a[92:95], v[84:87], v[116:119]
    v_mfma_f32_16x16x32_bf16 v[120:123], a[92:95], v[88:91], v[120:123]
    s_waitcnt lgkmcnt(2)
    v_mfma_f32_16x16x32_bf16 v[108:111], a[16:19], v[92:95], v[108:111]
    ds_read_b128 v[84:87], v11 offset:12288
    v_mfma_f32_16x16x32_bf16 v[112:115], a[16:19], v[96:99], v[112:115]
    ds_read_b128 v[88:91], v11 offset:14336
    v_mfma_f32_16x16x32_bf16 v[116:119], a[96:99], v[92:95], v[116:119]
    v_mfma_f32_16x16x32_bf16 v[120:123], a[96:99], v[96:99], v[120:123]
    s_waitcnt lgkmcnt(2)
    v_mfma_f32_16x16x32_bf16 v[108:111], a[20:23], v[100:103], v[108:111]
    ds_read_b128 v[92:95], v12 offset:12288
    v_mfma_f32_16x16x32_bf16 v[112:115], a[20:23], v[104:107], v[112:115]
    ds_read_b128 v[96:99], v12 offset:14336
    v_mfma_f32_16x16x32_bf16 v[116:119], a[100:103], v[100:103], v[116:119]
    v_mfma_f32_16x16x32_bf16 v[120:123], a[100:103], v[104:107], v[120:123]
    s_waitcnt lgkmcnt(2)
    v_mfma_f32_16x16x32_bf16 v[108:111], a[24:27], v[84:87], v[108:111]
    ds_read_b128 v[100:103], v11 offset:16384
    v_mfma_f32_16x16x32_bf16 v[112:115], a[24:27], v[88:91], v[112:115]
    ds_read_b128 v[104:107], v11 offset:18432
    v_mfma_f32_16x16x32_bf16 v[116:119], a[104:107], v[84:87], v[116:119]
    v_mfma_f32_16x16x32_bf16 v[120:123], a[104:107], v[88:91], v[120:123]
    s_waitcnt lgkmcnt(2)
    v_mfma_f32_16x16x32_bf16 v[108:111], a[28:31], v[92:95], v[108:111]
    ds_read_b128 v[84:87], v12 offset:16384
    v_mfma_f32_16x16x32_bf16 v[112:115], a[28:31], v[96:99], v[112:115]
    ds_read_b128 v[88:91], v12 offset:18432
    v_mfma_f32_16x16x32_bf16 v[116:119], a[108:111], v[92:95], v[116:119]
    v_mfma_f32_16x16x32_bf16 v[120:123], a[108:111], v[96:99], v[120:123]
    s_waitcnt lgkmcnt(2)
    v_mfma_f32_16x16x32_bf16 v[108:111], a[32:35], v[100:103], v[108:111]
    ds_read_b128 v[92:95], v11 offset:20480
    v_mfma_f32_16x16x32_bf16 v[112:115], a[32:35], v[104:107], v[112:115]
    ds_read_b128 v[96:99], v11 offset:22528
    v_mfma_f32_16x16x32_bf16 v[116:119], a[112:115], v[100:103], v[116:119]
    v_mfma_f32_16x16x32_bf16 v[120:123], a[112:115], v[104:107], v[120:123]
    s_waitcnt lgkmcnt(2)
    v_mfma_f32_16x16x32_bf16 v[108:111], a[36:39], v[84:87], v[108:111]
    ds_read_b128 v[100:103], v12 offset:20480
    v_mfma_f32_16x16x32_bf16 v[112:115], a[36:39], v[88:91], v[112:115]
    ds_read_b128 v[104:107], v12 offset:22528
    v_mfma_f32_16x16x32_bf16 v[116:119], a[116:119], v[84:87], v[116:119]
    v_mfma_f32_16x16x32_bf16 v[120:123], a[116:119], v[88:91], v[120:123]
    s_waitcnt lgkmcnt(2)
    v_mfma_f32_16x16x32_bf16 v[108:111], a[40:43], v[92:95], v[108:111]
    ds_read_b128 v[84:87], v11 offset:24576
    v_mfma_f32_16x16x32_bf16 v[112:115], a[40:43], v[96:99], v[112:115]
    ds_read_b128 v[88:91], v11 offset:26624
    v_mfma_f32_16x16x32_bf16 v[116:119], a[120:123], v[92:95], v[116:119]
    v_mfma_f32_16x16x32_bf16 v[120:123], a[120:123], v[96:99], v[120:123]
    s_waitcnt lgkmcnt(2)
    v_mfma_f32_16x16x32_bf16 v[108:111], a[44:47], v[100:103], v[108:111]
    ds_read_b128 v[92:95], v12 offset:24576
    v_mfma_f32_16x16x32_bf16 v[112:115], a[44:47], v[104:107], v[112:115]
    ds_read_b128 v[96:99], v12 offset:26624
    v_mfma_f32_16x16x32_bf16 v[116:119], a[124:127], v[100:103], v[116:119]
    v_mfma_f32_16x16x32_bf16 v[120:123], a[124:127], v[104:107], v[120:123]
    s_waitcnt lgkmcnt(2)
    v_mfma_f32_16x16x32_bf16 v[108:111], a[48:51], v[84:87], v[108:111]
    ds_read_b128 v[100:103], v11 offset:28672
    v_mfma_f32_16x16x32_bf16 v[112:115], a[48:51], v[88:91], v[112:115]
    ds_read_b128 v[104:107], v11 offset:30720
    v_mfma_f32_16x16x32_bf16 v[116:119], a[128:131], v[84:87], v[116:119]
    v_mfma_f32_16x16x32_bf16 v[120:123], a[128:131], v[88:91], v[120:123]
    s_waitcnt lgkmcnt(2)
    v_mfma_f32_16x16x32_bf16 v[108:111], a[52:55], v[92:95], v[108:111]
    ds_read_b128 v[84:87], v12 offset:28672
    v_mfma_f32_16x16x32_bf16 v[112:115], a[52:55], v[96:99], v[112:115]
    ds_read_b128 v[88:91], v12 offset:30720
    v_mfma_f32_16x16x32_bf16 v[116:119], a[132:135], v[92:95], v[116:119]
    v_mfma_f32_16x16x32_bf16 v[120:123], a[132:135], v[96:99], v[120:123]
    s_waitcnt lgkmcnt(2)
    v_mfma_f32_16x16x32_bf16 v[108:111], a[56:59], v[100:103], v[108:111]
    ds_read_b128 v[92:95], v11 offset:32768
    v_mfma_f32_16x16x32_bf16 v[112:115], a[56:59], v[104:107], v[112:115]
    ds_read_b128 v[96:99], v11 offset:34816
    v_mfma_f32_16x16x32_bf16 v[116:119], a[136:139], v[100:103], v[116:119]
    v_mfma_f32_16x16x32_bf16 v[120:123], a[136:139], v[104:107], v[120:123]
    s_waitcnt lgkmcnt(2)
    v_mfma_f32_16x16x32_bf16 v[108:111], a[60:63], v[84:87], v[108:111]
    ds_read_b128 v[100:103], v12 offset:32768
    v_mfma_f32_16x16x32_bf16 v[112:115], a[60:63], v[88:91], v[112:115]
    ds_read_b128 v[104:107], v12 offset:34816
    v_mfma_f32_16x16x32_bf16 v[116:119], a[140:143], v[84:87], v[116:119]
    v_mfma_f32_16x16x32_bf16 v[120:123], a[140:143], v[88:91], v[120:123]
    s_waitcnt lgkmcnt(2)
    v_mfma_f32_16x16x32_bf16 v[108:111], a[64:67], v[92:95], v[108:111]
    ds_read_b128 v[84:87], v11 offset:36864
    v_mfma_f32_16x16x32_bf16 v[112:115], a[64:67], v[96:99], v[112:115]
    ds_read_b128 v[88:91], v11 offset:38912
    v_mfma_f32_16x16x32_bf16 v[116:119], a[144:147], v[92:95], v[116:119]
    v_mfma_f32_16x16x32_bf16 v[120:123], a[144:147], v[96:99], v[120:123]
    s_waitcnt lgkmcnt(2)
    v_mfma_f32_16x16x32_bf16 v[108:111], a[68:71], v[100:103], v[108:111]
    ds_read_b128 v[92:95], v12 offset:36864
    v_mfma_f32_16x16x32_bf16 v[112:115], a[68:71], v[104:107], v[112:115]
    ds_read_b128 v[96:99], v12 offset:38912
    v_mfma_f32_16x16x32_bf16 v[116:119], a[148:151], v[100:103], v[116:119]
    v_mfma_f32_16x16x32_bf16 v[120:123], a[148:151], v[104:107], v[120:123]
    s_waitcnt lgkmcnt(0)
    v_mfma_f32_16x16x32_bf16 v[108:111], a[72:75], v[84:87], v[108:111]
    v_add_u32 v11, s49, v11
    v_mfma_f32_16x16x32_bf16 v[112:115], a[72:75], v[88:91], v[112:115]
    v_add_u32 v12, s49, v12
    v_mfma_f32_16x16x32_bf16 v[108:111], a[76:79], v[92:95], v[108:111]
    s_sub_u32 s47, s47, s49
    v_mfma_f32_16x16x32_bf16 v[112:115], a[76:79], v[96:99], v[112:115]
    s_sub_u32 s49, 0, s49
    v_mfma_f32_16x16x32_bf16 v[116:119], a[152:155], v[84:87], v[116:119]
    v_mfma_f32_16x16x32_bf16 v[120:123], a[152:155], v[88:91], v[120:123]
    v_mfma_f32_16x16x32_bf16 v[116:119], a[156:159], v[92:95], v[116:119]
    v_mfma_f32_16x16x32_bf16 v[120:123], a[156:159], v[96:99], v[120:123]
    v_cvt_pk_bf16_f32 v124, v108, v109
    v_cvt_pk_bf16_f32 v125, v110, v111
    v_cvt_pk_bf16_f32 v126, v112, v113
    v_cvt_pk_bf16_f32 v127, v114, v115
    s_nop 0
    v_permlane16_swap_b32 v124, v126
    v_permlane16_swap_b32 v125, v127
    v_cvt_pk_bf16_f32 v128, v116, v117
    v_cvt_pk_bf16_f32 v129, v118, v119
    v_cvt_pk_bf16_f32 v130, v120, v121
    v_cvt_pk_bf16_f32 v131, v122, v123
    s_nop 0
    v_permlane16_swap_b32 v128, v130
    v_permlane16_swap_b32 v129, v131
    ds_write_b128 v140, v[128:131]
    buffer_store_dwordx4 v[124:127], v19, s[4:7], s44 offen
    buffer_store_dwordx4 v[128:131], v19, s[4:7], s45 offen
    s_waitcnt vmcnt(2)
    s_branch L_gw_3c
L_gw_3:
    buffer_load_dword v2, v1, s[8:11], 0 offen sc1
    s_sub_u32 s36, s36, 1
    s_cbranch_scc1 L_exit
    s_waitcnt vmcnt(0)
L_gw_3c:
    v_readfirstlane_b32 s90, v2
    s_nop 0
    s_cmp_eq_u32 s90, 0
    s_cbranch_scc1 L_gw_3
    s_cmp_lg_u32 s90, 1
    s_cbranch_scc1 L_slow
    s_waitcnt vmcnt(2) lgkmcnt(0)
    s_barrier
    s_add_u32 s44, s38, 573440
    s_add_u32 s45, s44, s56
    s_mov_b32 s46, 81920
    v_add_u32 v140, 4096, v137
    ds_read_b128 v[84:87], v11 offset:0
    ds_read_b128 v[88:91], v11 offset:2048
    ds_read_b128 v[92:95], v12 offset:0
    ds_read_b128 v[96:99], v12 offset:2048
    s_lshl_b32 s90, s32, 10
    s_add_u32 m0, s90, s47
    s_waitcnt lgkmcnt(2)
    v_mfma_f32_16x16x32_bf16 v[108:111], a[0:3], v[84:87], 0
    ds_read_b128 v[100:103], v11 offset:4096
    s_and_b32 s50, s37, 3
    v_mfma_f32_16x16x32_bf16 v[112:115], a[0:3], v[88:91], 0
    ds_read_b128 v[104:107], v11 offset:6144
    s_mul_i32 s53, s50, 327680
    v_mfma_f32_16x16x32_bf16 v[116:119], a[80:83], v[84:87], 0
    buffer_load_dwordx4 v10, s[24:27], s46 offen offset:0 lds
    s_add_u32 m0, m0, 3968
    v_mfma_f32_16x16x32_bf16 v[120:123], a[80:83], v[88:91], 0
    s_waitcnt lgkmcnt(2)
    s_add_u32 s51, s37, 2
    v_mfma_f32_16x16x32_bf16 v[108:111], a[4:7], v[92:95], v[108:111]
    ds_read_b128 v[84:87], v12 offset:4096
    s_and_b32 s50, s51, 3
    v_mfma_f32_16x16x32_bf16 v[112:115], a[4:7], v[96:99], v[112:115]
    ds_read_b128 v[88:91], v12 offset:6144
    s_mul_i32 s50, s50, 98304
    v_mfma_f32_16x16x32_bf16 v[116:119], a[84:87], v[92:95], v[116:119]
    buffer_load_dwordx4 v10, s[24:27], s46 offen offset:128 lds
    s_add_u32 m0, m0, 3968
    v_mfma_f32_16x16x32_bf16 v[120:123], a[84:87], v[96:99], v[120:123]
    s_waitcnt lgkmcnt(2)
    s_add_u32 s50, s50, 475136
    v_mfma_f32_16x16x32_bf16 v[108:111], a[8:11], v[100:103], v[108:111]
    ds_read_b128 v[92:95], v11 offset:8192
    s_add_u32 s44, s38, s50
    v_mfma_f32_16x16x32_bf16 v[112:115], a[8:11], v[104:107], v[112:115]
    ds_read_b128 v[96:99], v11 offset:10240
    s_add_u32 s45, s44, s56
    v_mfma_f32_16x16x32_bf16 v[116:119], a[88:91], v[100:103], v[116:119]
    buffer_load_dwordx4 v10, s[24:27], s46 offen offset:256 lds
    s_add_u32 m0, m0, 3968
    v_mfma_f32_16x16x32_bf16 v[120:123], a[88:91], v[104:107], v[120:123]
    s_waitcnt lgkmcnt(2)
    s_and_b32 s50, s51, 3
    v_mfma_f32_16x16x32_bf16 v[108:111], a[12:15], v[84:87], v[108:111]
    ds_read_b128 v[100:103], v12 offset:8192
    s_lshl_b32 s50, s50, 12
    v_mfma_f32_16x16x32_bf16 v[112:115], a[12:15], v[88:91], v[112:115]
    ds_read_b128 v[104:107], v12 offset:10240
    v_add_u32 v140, s50, v137
    v_mfma_f32_16x16x32_bf16 v[116:119], a[92:95], v[84:87], v[116:119]
    buffer_load_dwordx4 v10, s[24:27], s46 offen offset:384 lds
    s_add_u32 m0, m0, 3968
    v_mfma_f32_16x16x32_bf16 v[120:123], a[92:95], v[88:91], v[120:123]
    s_waitcnt lgkmcnt(2)
    s_add_u32 s37, s37, 1
    v_mfma_f32_16x16x32_bf16 v[108:111], a[16:19], v[92:95], v[108:111]
    ds_read_b128 v[84:87], v11 offset:12288
    s_mov_b32 s52, 0
    v_mfma_f32_16x16x32_bf16 v[112:115], a[16:19], v[96:99], v[112:115]
    ds_read_b128 v[88:91], v11 offset:14336
    s_and_b32 s50, s37, 3
    v_mfma_f32_16x16x32_bf16 v[116:119], a[96:99], v[92:95], v[116:119]
    buffer_load_dwordx4 v10, s[24:27], s46 offen offset:512 lds
    s_add_u32 m0, m0, 3968
    v_mfma_f32_16x16x32_bf16 v[120:123], a[96:99], v[96:99], v[120:123]
    s_waitcnt lgkmcnt(2)
    s_mul_i32 s51, s50, 114688
    v_mfma_f32_16x16x32_bf16 v[108:111], a[20:23], v[100:103], v[108:111]
    ds_read_b128 v[92:95], v12 offset:12288
    s_add_u32 s41, s38, s51
    v_mfma_f32_16x16x32_bf16 v[112:115], a[20:23], v[104:107], v[112:115]
    ds_read_b128 v[96:99], v12 offset:14336
    s_and_b32 s54, s37, s55
    v_mfma_f32_16x16x32_bf16 v[116:119], a[100:103], v[100:103], v[116:119]
    buffer_load_dwordx4 v10, s[24:27], s46 offen offset:640 lds
    s_add_u32 m0, m0, 3968
    v_mfma_f32_16x16x32_bf16 v[120:123], a[100:103], v[104:107], v[120:123]
    s_waitcnt lgkmcnt(2)
    s_lshl_b32 s50, s50, 12
    v_mfma_f32_16x16x32_bf16 v[108:111], a[24:27], v[84:87], v[108:111]
    ds_read_b128 v[100:103], v11 offset:16384
    v_add_u32 v141, s50, v138
    v_mfma_f32_16x16x32_bf16 v[112:115], a[24:27], v[88:91], v[112:115]
    ds_read_b128 v[104:107], v11 offset:18432
    s_add_u32 s43, s41, 40960
    v_mfma_f32_16x16x32_bf16 v[116:119], a[104:107], v[84:87], v[116:119]
    buffer_load_dwordx4 v10, s[24:27], s46 offen offset:768 lds
    s_add_u32 m0, m0, 3968
    v_mfma_f32_16x16x32_bf16 v[120:123], a[104:107], v[88:91], v[120:123]
    s_waitcnt lgkmcnt(2)
    v_mfma_f32_16x16x32_bf16 v[108:111], a[28:31], v[92:95], v[108:111]
    ds_read_b128 v[84:87], v12 offset:16384
    v_mfma_f32_16x16x32_bf16 v[112:115], a[28:31], v[96:99], v[112:115]
    ds_read_b128 v[88:91], v12 offset:18432
    v_mfma_f32_16x16x32_bf16 v[116:119], a[108:111], v[92:95], v[116:119]
    buffer_load_dwordx4 v10, s[24:27], s46 offen offset:896 lds
    s_add_u32 m0, m0, 3968
    v_mfma_f32_16x16x32_bf16 v[120:123], a[108:111], v[96:99], v[120:123]
    s_waitcnt lgkmcnt(2)
    v_mfma_f32_16x16x32_bf16 v[108:111], a[32:35], v[100:103], v[108:111]
    ds_read_b128 v[92:95], v11 offset:20480
    v_mfma_f32_16x16x32_bf16 v[112:115], a[32:35], v[104:107], v[112:115]
    ds_read_b128 v[96:99], v11 offset:22528
    v_mfma_f32_16x16x32_bf16 v[116:119], a[112:115], v[100:103], v[116:119]
    buffer_load_dwordx4 v10, s[24:27], s46 offen offset:1024 lds
    s_add_u32 m0, m0, 3968
    v_mfma_f32_16x16x32_bf16 v[120:123], a[112:115], v[104:107], v[120:123]
    s_waitcnt lgkmcnt(2)
    v_mfma_f32_16x16x32_bf16 v[108:111], a[36:39], v[84:87], v[108:111]
    ds_read_b128 v[100:103], v12 offset:20480
    v_mfma_f32_16x16x32_bf16 v[112:115], a[36:39], v[88:91], v[112:115]
    ds_read_b128 v[104:107], v12 offset:22528
    v_mfma_f32_16x16x32_bf16 v[116:119], a[116:119], v[84:87], v[116:119]
    buffer_load_dwordx4 v10, s[24:27], s46 offen offset:1152 lds
    v_mfma_f32_16x16x32_bf16 v[120:123], a[116:119], v[88:91], v[120:123]
    s_waitcnt lgkmcnt(2)
    v_mfma_f32_16x16x32_bf16 v[108:111], a[40:43], v[92:95], v[108:111]
    ds_read_b128 v[84:87], v11 offset:24576
    v_mfma_f32_16x16x32_bf16 v[112:115], a[40:43], v[96:99], v[112:115]
    ds_read_b128 v[88:91], v11 offset:26624
    v_mfma_f32_16x16x32_bf16 v[116:119], a[120:123], v[92:95], v[116:119]
    v_mfma_f32_16x16x32_bf16 v[120:123], a[120:123], v[96:99], v[120:123]
    s_waitcnt lgkmcnt(2)
    v_mfma_f32_16x16x32_bf16 v[108:111], a[44:47], v[100:103], v[108:111]
    ds_read_b128 v[92:95], v12 offset:24576
    v_mfma_f32_16x16x32_bf16 v[112:115], a[44:47], v[104:107], v[112:115]
    ds_read_b128 v[96:99], v12 offset:26624
    v_mfma_f32_16x16x32_bf16 v[116:119], a[124:127], v[100:103], v[116:119]
    v_mfma_f32_16x16x32_bf16 v[120:123], a[124:127], v[104:107], v[120:123]
    s_waitcnt lgkmcnt(2)
    v_mfma_f32_16x16x32_bf16 v[108:111], a[48:51], v[84:87], v[108:111]
    ds_read_b128 v[100:103], v11 offset:28672
    v_mfma_f32_16x16x32_bf16 v[112:115], a[48:51], v[88:91], v[112:115]
    ds_read_b128 v[104:107], v11 offset:30720
    v_mfma_f32_16x16x32_bf16 v[116:119], a[128:131], v[84:87], v[116:119]
    v_mfma_f32_16x16x32_bf16 v[120:123], a[128:131], v[88:91], v[120:123]
    s_waitcnt lgkmcnt(2)
    v_mfma_f32_16x16x32_bf16 v[108:111], a[52:55], v[92:95], v[108:111]
    ds_read_b128 v[84:87], v12 offset:28672
    v_mfma_f32_16x16x32_bf16 v[112:115], a[52:55], v[96:99], v[112:115]
    ds_read_b128 v[88:91], v12 offset:30720
    v_mfma_f32_16x16x32_bf16 v[116:119], a[132:135], v[92:95], v[116:119]
    v_mfma_f32_16x16x32_bf16 v[120:123], a[132:135], v[96:99], v[120:123]
    s_waitcnt lgkmcnt(2)
    v_mfma_f32_16x16x32_bf16 v[108:111], a[56:59], v[100:103], v[108:111]
    ds_read_b128 v[92:95], v11 offset:32768
    v_mfma_f32_16x16x32_bf16 v[112:115], a[56:59], v[104:107], v[112:115]
    ds_read_b128 v[96:99], v11 offset:34816
    v_mfma_f32_16x16x32_bf16 v[116:119], a[136:139], v[100:103], v[116:119]
    v_mfma_f32_16x16x32_bf16 v[120:123], a[136:139], v[104:107], v[120:123]
    s_waitcnt lgkmcnt(2)
    v_mfma_f32_16x16x32_bf16 v[108:111], a[60:63], v[84:87], v[108:111]
    ds_read_b128 v[100:103], v12 offset:32768
    v_mfma_f32_16x16x32_bf16 v[112:115], a[60:63], v[88:91], v[112:115]
    ds_read_b128 v[104:107], v12 offset:34816
    v_mfma_f32_16x16x32_bf16 v[116:119], a[140:143], v[84:87], v[116:119]
    v_mfma_f32_16x16x32_bf16 v[120:123], a[140:143], v[88:91], v[120:123]
    s_waitcnt lgkmcnt(2)
    v_mfma_f32_16x16x32_bf16 v[108:111], a[64:67], v[92:95], v[108:111]
    ds_read_b128 v[84:87], v11 offset:36864
    v_mfma_f32_16x16x32_bf16 v[112:115], a[64:67], v[96:99], v[112:115]
    ds_read_b128 v[88:91], v11 offset:38912
    v_mfma_f32_16x16x32_bf16 v[116:119], a[144:147], v[92:95], v[116:119]
    v_mfma_f32_16x16x32_bf16 v[120:123], a[144:147], v[96:99], v[120:123]
    s_waitcnt lgkmcnt(2)
    v_mfma_f32_16x16x32_bf16 v[108:111], a[68:71], v[100:103], v[108:111]
    ds_read_b128 v[92:95], v12 offset:36864
    v_mfma_f32_16x16x32_bf16 v[112:115], a[68:71], v[104:107], v[112:115]
    ds_read_b128 v[96:99], v12 offset:38912
    v_mfma_f32_16x16x32_bf16 v[116:119], a[148:151], v[100:103], v[116:119]
    v_mfma_f32_16x16x32_bf16 v[120:123], a[148:151], v[104:107], v[120:123]
    s_waitcnt lgkmcnt(0)
    v_mfma_f32_16x16x32_bf16 v[108:111], a[72:75], v[84:87], v[108:111]
    v_add_u32 v11, s49, v11
    v_mfma_f32_16x16x32_bf16 v[112:115], a[72:75], v[88:91], v[112:115]
    v_add_u32 v12, s49, v12
    v_mfma_f32_16x16x32_bf16 v[108:111], a[76:79], v[92:95], v[108:111]
    s_sub_u32 s47, s47, s49
    v_mfma_f32_16x16x32_bf16 v[112:115], a[76:79], v[96:99], v[112:115]
    s_sub_u32 s49, 0, s49
    v_mfma_f32_16x16x32_bf16 v[116:119], a[152:155], v[84:87], v[116:119]
    v_mfma_f32_16x16x32_bf16 v[120:123], a[152:155], v[88:91], v[120:123]
    v_mfma_f32_16x16x32_bf16 v[116:119], a[156:159], v[92:95], v[116:119]
    v_mfma_f32_16x16x32_bf16 v[120:123], a[156:159], v[96:99], v[120:123]
    v_cvt_pk_bf16_f32 v124, v108, v109
    v_cvt_pk_bf16_f32 v125, v110, v111
    v_cvt_pk_bf16_f32 v126, v112, v113
    v_cvt_pk_bf16_f32 v127, v114, v115
    s_nop 0
    v_permlane16_swap_b32 v124, v126
    v_permlane16_swap_b32 v125, v127
    v_cvt_pk_bf16_f32 v128, v116, v117
    v_cvt_pk_bf16_f32 v129, v118, v119
    v_cvt_pk_bf16_f32 v130, v120, v121
    v_cvt_pk_bf16_f32 v131, v122, v123
    s_nop 0
    v_permlane16_swap_b32 v128, v130
    v_permlane16_swap_b32 v129, v131
    ds_write_b128 v140, v[128:131]
    buffer_store_dwordx4 v[124:127], v19, s[4:7], s44 offen
    buffer_store_dwordx4 v[128:131], v19, s[4:7], s45 offen
    s_mov_b32 m0, s48
L_qkv_loop_f:
    s_add_u32 s50, s37, 2
    s_and_b32 s50, s50, 3
    s_mul_i32 s50, s50, 114688
    s_add_u32 s42, s38, s50
    s_add_u32 s50, s37, 3
    s_min_u32 s50, s50, 63
    s_mul_i32 s46, s50, 40960
    s_add_u32 s51, s37, 1
    v_mov_b32 v20, s51
    s_mov_b32 m0, s48
    v_mov_b32 v68, 0
    v_mov_b32 v69, 0
    v_mov_b32 v70, 0
    v_mov_b32 v71, 0
    v_mov_b32 v72, 0
    v_mov_b32 v73, 0
    v_mov_b32 v74, 0
    v_mov_b32 v75, 0
    ds_read_b128 v[156:159], v141
    ds_read_b128 v[160:163], v141 offset:1024
    buffer_load_dwordx4 v13, s[4:7], s41 offen sc1 lds
    buffer_load_dwordx4 v13, s[4:7], s41 offen offset:1024 sc1 lds
    buffer_load_dword v14, s[4:7], s41 offen offset:2048 sc1 lds
    buffer_load_dword v14, s[4:7], s41 offen offset:2304 sc1 lds
L_poll_5:
    buffer_load_dwordx4 v13, s[4:7], s41 offen sc1 lds
    buffer_load_dwordx4 v13, s[4:7], s41 offen offset:1024 sc1 lds
    buffer_load_dword v14, s[4:7], s41 offen offset:2048 sc1 lds
    buffer_load_dword v14, s[4:7], s41 offen offset:2304 sc1 lds
    s_sub_u32 s36, s36, 1
    s_cbranch_scc1 L_exit
    s_waitcnt vmcnt(4)
    ds_read_b32 v18, v15
    s_waitcnt lgkmcnt(0)
    v_cmp_eq_u32 vcc, -1, v18
    s_cbranch_vccnz L_poll_5
    s_barrier
    ds_read_b128 v[28:31], v16 offset:0
    ds_read_b128 v[32:35], v16 offset:1024
    ds_read_b128 v[36:39], v16 offset:2048
    ds_read_b128 v[40:43], v16 offset:3072
    s_waitcnt lgkmcnt(3)
    v_smfmac_f32_16x16x64_bf16 v[68:71], v[28:31], a[0:7], v17
    ds_read_b128 v[44:47], v16 offset:4096
    v_smfmac_f32_16x16x64_bf16 v[72:75], v[28:31], a[80:87], v17
    ds_read_b128 v[48:51], v16 offset:5120
    s_waitcnt lgkmcnt(4)
    v_smfmac_f32_16x16x64_bf16 v[68:71], v[32:35], a[8:15], v17
    ds_read_b128 v[52:55], v16 offset:6144
    v_smfmac_f32_16x16x64_bf16 v[72:75], v[32:35], a[88:95], v17
    ds_read_b128 v[56:59], v16 offset:7168
    s_waitcnt lgkmcnt(5)
    v_smfmac_f32_16x16x64_bf16 v[68:71], v[36:39], a[16:23], v17
    ds_read_b128 v[60:63], v16 offset:8192
    s_waitcnt lgkmcnt(5)
    v_smfmac_f32_16x16x64_bf16 v[68:71], v[40:43], a[24:31], v17
    ds_read_b128 v[64:67], v16 offset:9216
    s_waitcnt lgkmcnt(5)
    v_smfmac_f32_16x16x64_bf16 v[68:71], v[44:47], a[32:39], v17
    s_waitcnt lgkmcnt(4)
    v_smfmac_f32_16x16x64_bf16 v[68:71], v[48:51], a[40:47], v17
    s_waitcnt lgkmcnt(3)
    v_smfmac_f32_16x16x64_bf16 v[68:71], v[52:55], a[48:55], v17
    s_waitcnt lgkmcnt(2)
    v_smfmac_f32_16x16x64_bf16 v[68:71], v[56:59], a[56:63], v17
    s_waitcnt lgkmcnt(1)
    v_smfmac_f32_16x16x64_bf16 v[68:71], v[60:63], a[64:71], v17
    buffer_store_dword v20, v21, s[4:7], s38 offen offset:0
    s_waitcnt lgkmcnt(0)
    v_smfmac_f32_16x16x64_bf16 v[68:71], v[64:67], a[72:79], v17
L_redo_4:
    v_smfmac_f32_16x16x64_bf16 v[72:75], v[36:39], a[96:103], v17
    v_smfmac_f32_16x16x64_bf16 v[72:75], v[40:43], a[104:111], v17
    v_smfmac_f32_16x16x64_bf16 v[72:75], v[44:47], a[112:119], v17
    v_add_f32 v68, v68, v70
    v_add_f32 v69, v69, v71
    v_smfmac_f32_16x16x64_bf16 v[72:75], v[48:51], a[120:127], v17
    v_cvt_pk_bf16_f32 v132, v68, v69
    ds_write_b32 v23, v132
    v_smfmac_f32_16x16x64_bf16 v[72:75], v[52:55], a[128:135], v17
    v_cmp_u_f32 vcc, v68, v69
    v_smfmac_f32_16x16x64_bf16 v[72:75], v[56:59], a[136:143], v17
    v_smfmac_f32_16x16x64_bf16 v[72:75], v[60:63], a[144:151], v17
    s_cbranch_vccnz L_nan_6
L_cont_7:
    v_smfmac_f32_16x16x64_bf16 v[72:75], v[64:67], a[152:159], v17
    s_waitcnt lgkmcnt(0)
    s_barrier
    ds_read_b64_tr_b16 v[76:77], v24 offset:0
    ds_read_b64_tr_b16 v[78:79], v134 offset:0
    ds_read_b64_tr_b16 v[80:81], v24 offset:1024
    ds_read_b64_tr_b16 v[82:83], v134 offset:1024
    s_cmp_eq_u32 s32, 0
    s_cbranch_scc1 L_w0_8
    s_cmp_eq_u32 s32, 3
    s_cbranch_scc1 L_w3_9
    v_pk_add_f32 v[72:73], v[72:73], v[74:75]
    v_cvt_pk_bf16_f32 v133, v72, v73
    ds_write_b32 v23, v133 offset:4
    s_waitcnt lgkmcnt(3)
    v_mfma_f32_16x16x32_bf16 v[164:167], v[156:159], v[76:79], 0
    s_waitcnt lgkmcnt(1)
    v_mfma_f32_16x16x32_bf16 v[164:167], v[160:163], v[80:83], v[164:167]
    s_waitcnt lgkmcnt(0)
    s_barrier
    s_nop 5
    buffer_store_dwordx4 v[164:167], v135, s[4:7], s41 offen
    ds_read_b128 v[84:87], v11 offset:0
    ds_read_b128 v[88:91], v11 offset:2048
    ds_read_b128 v[92:95], v12 offset:0
    ds_read_b128 v[96:99], v12 offset:2048
    s_branch L_join_10
L_w0_8:
    v_pk_add_f32 v[72:73], v[72:73], v[74:75]
    v_cvt_pk_bf16_f32 v133, v72, v73
    ds_write_b32 v23, v133 offset:4
    s_waitcnt lgkmcnt(0)
    s_barrier
    ds_read_b64_tr_b16 v[76:77], v24 offset:0
    ds_read_b64_tr_b16 v[78:79], v134 offset:0
    ds_read_b64_tr_b16 v[80:81], v24 offset:1024
    ds_read_b64_tr_b16 v[82:83], v134 offset:1024
    s_waitcnt lgkmcnt(2)
    v_mfma_f32_16x16x32_bf16 v[164:167], v[76:79], v[76:79], 0
    s_waitcnt lgkmcnt(0)
    v_mfma_f32_16x16x32_bf16 v[164:167], v[80:83], v[80:83], v[164:167]
    ds_read_b128 v[84:87], v11 offset:0
    ds_read_b128 v[88:91], v11 offset:2048
    ds_read_b128 v[92:95], v12 offset:0
    ds_read_b128 v[96:99], v12 offset:2048
    s_nop 3
    buffer_store_dword v166, v135, s[4:7], s41 offen
    buffer_store_dword v167, v135, s[4:7], s41 offen offset:8
    s_branch L_join_10
L_w3_9:
    v_pk_add_f32 v[72:73], v[72:73], v[74:75]
    v_cvt_pk_bf16_f32 v133, v72, v73
    ds_write_b32 v23, v133 offset:4
    s_waitcnt lgkmcnt(0)
    s_barrier
    ds_read_b64_tr_b16 v[76:77], v24 offset:0
    ds_read_b64_tr_b16 v[78:79], v134 offset:0
    ds_read_b64_tr_b16 v[80:81], v24 offset:1024
    ds_read_b64_tr_b16 v[82:83], v134 offset:1024
    s_waitcnt lgkmcnt(0)
    ds_read_b128 v[84:87], v11 offset:0
    ds_read_b128 v[88:91], v11 offset:2048
    ds_read_b128 v[92:95], v12 offset:0
    ds_read_b128 v[96:99], v12 offset:2048
    s_waitcnt lgkmcnt(0)
    buffer_store_dwordx4 v[76:79], v136, s[4:7], s43 offen
    buffer_store_dwordx4 v[80:83], v136, s[4:7], s43 offen offset:512
L_join_10:
    s_cmp_eq_u32 s37, 63
    s_cbranch_scc1 L_end_11
    s_cmp_eq_u32 s37, 0
    s_cbranch_scc1 L_sd_12c
L_sd_12:
    s_lshl_b32 s90, s32, 10
    s_add_u32 m0, s90, s47
    s_waitcnt lgkmcnt(2)
    v_mfma_f32_16x16x32_bf16 v[108:111], a[0:3], v[84:87], 0
    ds_read_b128 v[100:103], v11 offset:4096
    s_and_b32 s50, s37, 3
    v_mfma_f32_16x16x32_bf16 v[112:115], a[0:3], v[88:91], 0
    ds_read_b128 v[104:107], v11 offset:6144
    s_mul_i32 s53, s50, 327680
    v_mfma_f32_16x16x32_bf16 v[116:119], a[80:83], v[84:87], 0
    s_add_u32 s51, s37, 2
    s_and_b32 s50, s51, 3
    v_mfma_f32_16x16x32_bf16 v[120:123], a[80:83], v[88:91], 0
    s_waitcnt lgkmcnt(2)
    s_mul_i32 s50, s50, 98304
    v_mfma_f32_16x16x32_bf16 v[108:111], a[4:7], v[92:95], v[108:111]
    ds_read_b128 v[84:87], v12 offset:4096
    s_add_u32 s50, s50, 475136
    v_mfma_f32_16x16x32_bf16 v[112:115], a[4:7], v[96:99], v[112:115]
    ds_read_b128 v[88:91], v12 offset:6144
    s_add_u32 s44, s38, s50
    v_mfma_f32_16x16x32_bf16 v[116:119], a[84:87], v[92:95], v[116:119]
    s_add_u32 s45, s44, s56
    s_and_b32 s50, s51, 3
    v_mfma_f32_16x16x32_bf16 v[120:123], a[84:87], v[96:99], v[120:123]
    s_waitcnt lgkmcnt(2)
    s_lshl_b32 s50, s50, 12
    v_mfma_f32_16x16x32_bf16 v[108:111], a[8:11], v[100:103], v[108:111]
    ds_read_b128 v[92:95], v11 offset:8192
    v_add_u32 v140, s50, v137
    v_mfma_f32_16x16x32_bf16 v[112:115], a[8:11], v[104:107], v[112:115]
    ds_read_b128 v[96:99], v11 offset:10240
    s_add_u32 s37, s37, 1
    v_mfma_f32_16x16x32_bf16 v[116:119], a[88:91], v[100:103], v[116:119]
    s_mov_b32 s52, 0
    s_and_b32 s50, s37, 3
    v_mfma_f32_16x16x32_bf16 v[120:123], a[88:91], v[104:107], v[120:123]
    s_waitcnt lgkmcnt(2)
    s_mul_i32 s51, s50, 114688
    v_mfma_f32_16x16x32_bf16 v[108:111], a[12:15], v[84:87], v[108:111]
    ds_read_b128 v[100:103], v12 offset:8192
    s_add_u32 s41, s38, s51
    v_mfma_f32_16x16x32_bf16 v[112:115], a[12:15], v[88:91], v[112:115]
    ds_read_b128 v[104:107], v12 offset:10240
    s_and_b32 s54, s37, s55
    v_mfma_f32_16x16x32_bf16 v[116:119], a[92:95], v[84:87], v[116:119]
    buffer_store_dword v22, v150, s[4:7], s42 offen offset:0
    buffer_store_dword v22, v149, s[4:7], s42 offen offset:0
    v_mfma_f32_16x16x32_bf16 v[120:123], a[92:95], v[88:91], v[120:123]
    s_waitcnt lgkmcnt(2)
    s_lshl_b32 s50, s50, 12
    v_mfma_f32_16x16x32_bf16 v[108:111], a[16:19], v[92:95], v[108:111]
    ds_read_b128 v[84:87], v11 offset:12288
    v_add_u32 v141, s50, v138
    v_mfma_f32_16x16x32_bf16 v[112:115], a[16:19], v[96:99], v[112:115]
    ds_read_b128 v[88:91], v11 offset:14336
    s_add_u32 s43, s41, 40960
    v_mfma_f32_16x16x32_bf16 v[116:119], a[96:99], v[92:95], v[116:119]
    buffer_store_dword v22, v150, s[4:7], s42 offen offset:256
    v_mfma_f32_16x16x32_bf16 v[120:123], a[96:99], v[96:99], v[120:123]
    s_waitcnt lgkmcnt(2)
    v_mfma_f32_16x16x32_bf16 v[108:111], a[20:23], v[100:103], v[108:111]
    ds_read_b128 v[92:95], v12 offset:12288
    v_mfma_f32_16x16x32_bf16 v[112:115], a[20:23], v[104:107], v[112:115]
    ds_read_b128 v[96:99], v12 offset:14336
    v_mfma_f32_16x16x32_bf16 v[116:119], a[100:103], v[100:103], v[116:119]
    buffer_load_dwordx4 v10, s[24:27], s46 offen offset:0 lds
    s_add_u32 m0, m0, 3968
    v_mfma_f32_16x16x32_bf16 v[120:123], a[100:103], v[104:107], v[120:123]
    s_waitcnt lgkmcnt(2)
    v_mfma_f32_16x16x32_bf16 v[108:111], a[24:27], v[84:87], v[108:111]
    ds_read_b128 v[100:103], v11 offset:16384
    v_mfma_f32_16x16x32_bf16 v[112:115], a[24:27], v[88:91], v[112:115]
    ds_read_b128 v[104:107], v11 offset:18432
    v_mfma_f32_16x16x32_bf16 v[116:119], a[104:107], v[84:87], v[116:119]
    buffer_load_dwordx4 v10, s[24:27], s46 offen offset:128 lds
    s_add_u32 m0, m0, 3968
    v_mfma_f32_16x16x32_bf16 v[120:123], a[104:107], v[88:91], v[120:123]
    s_waitcnt lgkmcnt(2)
    v_mfma_f32_16x16x32_bf16 v[108:111], a[28:31], v[92:95], v[108:111]
    ds_read_b128 v[84:87], v12 offset:16384
    v_mfma_f32_16x16x32_bf16 v[112:115], a[28:31], v[96:99], v[112:115]
    ds_read_b128 v[88:91], v12 offset:18432
    v_mfma_f32_16x16x32_bf16 v[116:119], a[108:111], v[92:95], v[116:119]
    buffer_load_dwordx4 v10, s[24:27], s46 offen offset:256 lds
    s_add_u32 m0, m0, 3968
    v_mfma_f32_16x16x32_bf16 v[120:123], a[108:111], v[96:99], v[120:123]
    s_waitcnt lgkmcnt(2)
    v_mfma_f32_16x16x32_bf16 v[108:111], a[32:35], v[100:103], v[108:111]
    ds_read_b128 v[92:95], v11 offset:20480
    v_mfma_f32_16x16x32_bf16 v[112:115], a[32:35], v[104:107], v[112:115]
    ds_read_b128 v[96:99], v11 offset:22528
    v_mfma_f32_16x16x32_bf16 v[116:119], a[112:115], v[100:103], v[116:119]
    s_waitcnt vmcnt(6)
    buffer_store_dword v20, v139, s[4:7], s38 offen
    v_mfma_f32_16x16x32_bf16 v[120:123], a[112:115], v[104:107], v[120:123]
    s_waitcnt lgkmcnt(2)
    v_mfma_f32_16x16x32_bf16 v[108:111], a[36:39], v[84:87], v[108:111]
    ds_read_b128 v[100:103], v12 offset:20480
    v_mfma_f32_16x16x32_bf16 v[112:115], a[36:39], v[88:91], v[112:115]
    buffer_load_dword v147, v146, s[4:7], 0 offen sc1
    ds_read_b128 v[104:107], v12 offset:22528
    v_mfma_f32_16x16x32_bf16 v[116:119], a[116:119], v[84:87], v[116:119]
    buffer_load_dwordx4 v10, s[24:27], s46 offen offset:384 lds
    s_add_u32 m0, m0, 3968
    v_mfma_f32_16x16x32_bf16 v[120:123], a[116:119], v[88:91], v[120:123]
    s_waitcnt lgkmcnt(2)
    v_mfma_f32_16x16x32_bf16 v[108:111], a[40:43], v[92:95], v[108:111]
    ds_read_b128 v[84:87], v11 offset:24576
    v_mfma_f32_16x16x32_bf16 v[112:115], a[40:43], v[96:99], v[112:115]
    buffer_load_dword v147, v146, s[4:7], 0 offen sc1
    ds_read_b128 v[88:91], v11 offset:26624
    v_mfma_f32_16x16x32_bf16 v[116:119], a[120:123], v[92:95], v[116:119]
    buffer_load_dwordx4 v10, s[24:27], s46 offen offset:512 lds
    s_add_u32 m0, m0, 3968
    v_mfma_f32_16x16x32_bf16 v[120:123], a[120:123], v[96:99], v[120:123]
    s_waitcnt lgkmcnt(2)
    v_mfma_f32_16x16x32_bf16 v[108:111], a[44:47], v[100:103], v[108:111]
    ds_read_b128 v[92:95], v12 offset:24576
    v_mfma_f32_16x16x32_bf16 v[112:115], a[44:47], v[104:107], v[112:115]
    buffer_load_dword v147, v146, s[4:7], 0 offen sc1
    ds_read_b128 v[96:99], v12 offset:26624
    v_mfma_f32_16x16x32_bf16 v[116:119], a[124:127], v[100:103], v[116:119]
    buffer_load_dwordx4 v10, s[24:27], s46 offen offset:640 lds
    s_add_u32 m0, m0, 3968
    v_mfma_f32_16x16x32_bf16 v[120:123], a[124:127], v[104:107], v[120:123]
    s_waitcnt lgkmcnt(2)
    v_mfma_f32_16x16x32_bf16 v[108:111], a[48:51], v[84:87], v[108:111]
    ds_read_b128 v[100:103], v11 offset:28672
    v_mfma_f32_16x16x32_bf16 v[112:115], a[48:51], v[88:91], v[112:115]
    buffer_load_dword v147, v146, s[4:7], 0 offen sc1
    ds_read_b128 v[104:107], v11 offset:30720
    v_mfma_f32_16x16x32_bf16 v[116:119], a[128:131], v[84:87], v[116:119]
    buffer_load_dwordx4 v10, s[24:27], s46 offen offset:768 lds
    s_add_u32 m0, m0, 3968
    v_mfma_f32_16x16x32_bf16 v[120:123], a[128:131], v[88:91], v[120:123]
    s_waitcnt lgkmcnt(2)
    v_mfma_f32_16x16x32_bf16 v[108:111], a[52:55], v[92:95], v[108:111]
    ds_read_b128 v[84:87], v12 offset:28672
    v_mfma_f32_16x16x32_bf16 v[112:115], a[52:55], v[96:99], v[112:115]
    buffer_load_dword v147, v146, s[4:7], 0 offen sc1
    ds_read_b128 v[88:91], v12 offset:30720
    v_mfma_f32_16x16x32_bf16 v[116:119], a[132:135], v[92:95], v[116:119]
    buffer_load_dwordx4 v10, s[24:27], s46 offen offset:896 lds
    s_add_u32 m0, m0, 3968
    v_mfma_f32_16x16x32_bf16 v[120:123], a[132:135], v[96:99], v[120:123]
    s_waitcnt lgkmcnt(2)
    v_mfma_f32_16x16x32_bf16 v[108:111], a[56:59], v[100:103], v[108:111]
    ds_read_b128 v[92:95], v11 offset:32768
    v_mfma_f32_16x16x32_bf16 v[112:115], a[56:59], v[104:107], v[112:115]
    buffer_load_dword v147, v146, s[4:7], 0 offen sc1
    ds_read_b128 v[96:99], v11 offset:34816
    v_mfma_f32_16x16x32_bf16 v[116:119], a[136:139], v[100:103], v[116:119]
    buffer_load_dwordx4 v10, s[24:27], s46 offen offset:1024 lds
    s_add_u32 m0, m0, 3968
    v_mfma_f32_16x16x32_bf16 v[120:123], a[136:139], v[104:107], v[120:123]
    s_waitcnt lgkmcnt(2)
    v_mfma_f32_16x16x32_bf16 v[108:111], a[60:63], v[84:87], v[108:111]
    ds_read_b128 v[100:103], v12 offset:32768
    v_mfma_f32_16x16x32_bf16 v[112:115], a[60:63], v[88:91], v[112:115]
    buffer_load_dword v147, v146, s[4:7], 0 offen sc1
    ds_read_b128 v[104:107], v12 offset:34816
    v_mfma_f32_16x16x32_bf16 v[116:119], a[140:143], v[84:87], v[116:119]
    buffer_load_dwordx4 v10, s[24:27], s46 offen offset:1152 lds
    v_mfma_f32_16x16x32_bf16 v[120:123], a[140:143], v[88:91], v[120:123]
    s_waitcnt lgkmcnt(2)
    v_mfma_f32_16x16x32_bf16 v[108:111], a[64:67], v[92:95], v[108:111]
    ds_read_b128 v[84:87], v11 offset:36864
    v_mfma_f32_16x16x32_bf16 v[112:115], a[64:67], v[96:99], v[112:115]
L_sp_13:
    s_waitcnt vmcnt(6)
    v_cmp_gt_u32 vcc, s54, v147
    buffer_load_dword v147, v146, s[4:7], 0 offen sc1
    s_sub_u32 s36, s36, 1
    s_cbranch_scc1 L_exit
    s_cbranch_vccz L_sp_13x
    s_waitcnt vmcnt(6)
    v_cmp_gt_u32 vcc, s54, v147
    buffer_load_dword v147, v146, s[4:7], 0 offen sc1
    s_cbranch_vccz L_sp_13x
    s_waitcnt vmcnt(6)
    v_cmp_gt_u32 vcc, s54, v147
    buffer_load_dword v147, v146, s[4:7], 0 offen sc1
    s_cbranch_vccz L_sp_13x
    s_waitcnt vmcnt(6)
    v_cmp_gt_u32 vcc, s54, v147
    buffer_load_dword v147, v146, s[4:7], 0 offen sc1
    s_cbranch_vccnz L_sp_13
L_sp_13x:
    s_barrier
    buffer_load_dwordx4 v[168:171], v142, s[4:7], s53 offen sc1
    ds_read_b128 v[88:91], v11 offset:38912
    v_mfma_f32_16x16x32_bf16 v[116:119], a[144:147], v[92:95], v[116:119]
    v_mfma_f32_16x16x32_bf16 v[120:123], a[144:147], v[96:99], v[120:123]
    s_waitcnt lgkmcnt(2)
    v_mfma_f32_16x16x32_bf16 v[108:111], a[68:71], v[100:103], v[108:111]
    ds_read_b128 v[92:95], v12 offset:36864
    v_mfma_f32_16x16x32_bf16 v[112:115], a[68:71], v[104:107], v[112:115]
    ds_read_b128 v[96:99], v12 offset:38912
    v_mfma_f32_16x16x32_bf16 v[116:119], a[148:151], v[100:103], v[116:119]
    v_mfma_f32_16x16x32_bf16 v[120:123], a[148:151], v[104:107], v[120:123]
    buffer_load_dwordx4 v[172:175], v143, s[4:7], s53 offen sc1
    s_waitcnt lgkmcnt(0)
    v_mfma_f32_16x16x32_bf16 v[108:111], a[72:75], v[84:87], v[108:111]
    v_add_u32 v11, s49, v11
    v_mfma_f32_16x16x32_bf16 v[112:115], a[72:75], v[88:91], v[112:115]
    v_add_u32 v12, s49, v12
    v_mfma_f32_16x16x32_bf16 v[108:111], a[76:79], v[92:95], v[108:111]
    s_sub_u32 s47, s47, s49
    v_mfma_f32_16x16x32_bf16 v[112:115], a[76:79], v[96:99], v[112:115]
    s_sub_u32 s49, 0, s49
    v_mfma_f32_16x16x32_bf16 v[116:119], a[152:155], v[84:87], v[116:119]
    v_mfma_f32_16x16x32_bf16 v[120:123], a[152:155], v[88:91], v[120:123]
    v_mfma_f32_16x16x32_bf16 v[116:119], a[156:159], v[92:95], v[116:119]
    v_mfma_f32_16x16x32_bf16 v[120:123], a[156:159], v[96:99], v[120:123]
    v_cvt_pk_bf16_f32 v124, v108, v109
    v_cvt_pk_bf16_f32 v125, v110, v111
    v_cvt_pk_bf16_f32 v126, v112, v113
    v_cvt_pk_bf16_f32 v127, v114, v115
    s_nop 0
    v_permlane16_swap_b32 v124, v126
    v_permlane16_swap_b32 v125, v127
    v_cvt_pk_bf16_f32 v128, v116, v117
    v_cvt_pk_bf16_f32 v129, v118, v119
    v_cvt_pk_bf16_f32 v130, v120, v121
    v_cvt_pk_bf16_f32 v131, v122, v123
    s_nop 0
    v_permlane16_swap_b32 v128, v130
    v_permlane16_swap_b32 v129, v131
    ds_write_b128 v140, v[128:131]
    buffer_store_dwordx4 v[124:127], v19, s[4:7], s44 offen
    buffer_store_dwordx4 v[128:131], v19, s[4:7], s45 offen
    s_mov_b32 m0, s48
    s_waitcnt vmcnt(3)
    v_mfma_f32_16x16x32_bf16 v[184:187], v[198:201], v[168:171], 0
    v_mfma_f32_16x16x32_bf16 v[188:191], v[196:199], v[168:171], 0
    s_waitcnt vmcnt(2)
    v_mfma_f32_16x16x32_bf16 v[184:187], v[198:201], v[172:175], v[184:187]
    v_mfma_f32_16x16x32_bf16 v[188:191], v[196:199], v[172:175], v[188:191]
    s_nop 4
    v_cmp_u_f32 vcc, v184, v184
    v_cvt_pk_bf16_f32 v192, v184, v185
    v_cvt_pk_bf16_f32 v193, v186, v187
    v_cvt_pk_bf16_f32 v194, v188, v189
    v_cvt_pk_bf16_f32 v195, v190, v191
    s_cbranch_vccnz L_pp_14
L_pc_15:
    buffer_store_dwordx4 v[192:195], v148, s[4:7], s41 offen
    s_barrier
    s_branch L_qkv_loop_f
L_end_11:
    s_waitcnt vmcnt(0) lgkmcnt(0)
    buffer_store_dword v20, v139, s[4:7], s38 offen
    s_endpgm
L_nan_6:
    s_cmp_eq_u32 s52, 1
    s_cbranch_scc1 L_cont_7
    v_lshlrev_b32 v1, 4, v0
L_nan_6r:
    s_mov_b32 s90, s41
    v_mov_b32 v2, 0
    buffer_load_dwordx4 v[28:31], v1, s[4:7], s90 offen sc1
    s_add_u32 s90, s90, 1024
    buffer_load_dwordx4 v[32:35], v1, s[4:7], s90 offen sc1
    s_add_u32 s90, s90, 1024
    buffer_load_dwordx4 v[36:39], v1, s[4:7], s90 offen sc1
    s_add_u32 s90, s90, 1024
    buffer_load_dwordx4 v[40:43], v1, s[4:7], s90 offen sc1
    s_add_u32 s90, s90, 1024
    buffer_load_dwordx4 v[44:47], v1, s[4:7], s90 offen sc1
    s_add_u32 s90, s90, 1024
    buffer_load_dwordx4 v[48:51], v1, s[4:7], s90 offen sc1
    s_add_u32 s90, s90, 1024
    buffer_load_dwordx4 v[52:55], v1, s[4:7], s90 offen sc1
    s_add_u32 s90, s90, 1024
    buffer_load_dwordx4 v[56:59], v1, s[4:7], s90 offen sc1
    s_add_u32 s90, s90, 1024
    buffer_load_dwordx4 v[60:63], v1, s[4:7], s90 offen sc1
    s_add_u32 s90, s90, 1024
    buffer_load_dwordx4 v[64:67], v1, s[4:7], s90 offen sc1
    s_add_u32 s90, s90, 1024
    s_sub_u32 s36, s36, 1
    s_cbranch_scc1 L_exit
    s_waitcnt vmcnt(0) lgkmcnt(0)
    v_max3_u32 v2, v2, v28, v29
    v_max3_u32 v2, v2, v30, v31
    v_max3_u32 v2, v2, v32, v33
    v_max3_u32 v2, v2, v34, v35
    v_max3_u32 v2, v2, v36, v37
    v_max3_u32 v2, v2, v38, v39
    v_max3_u32 v2, v2, v40, v41
    v_max3_u32 v2, v2, v42, v43
    v_max3_u32 v2, v2, v44, v45
    v_max3_u32 v2, v2, v46, v47
    v_max3_u32 v2, v2, v48, v49
    v_max3_u32 v2, v2, v50, v51
    v_max3_u32 v2, v2, v52, v53
    v_max3_u32 v2, v2, v54, v55
    v_max3_u32 v2, v2, v56, v57
    v_max3_u32 v2, v2, v58, v59
    v_max3_u32 v2, v2, v60, v61
    v_max3_u32 v2, v2, v62, v63
    v_max3_u32 v2, v2, v64, v65
    v_max3_u32 v2, v2, v66, v67
    v_cmp_eq_u32 vcc, -1, v2
    s_cbranch_vccnz L_nan_6r
    s_mov_b32 s52, 1
    v_mov_b32 v68, 0
    v_mov_b32 v69, 0
    v_mov_b32 v70, 0
    v_mov_b32 v71, 0
    v_mov_b32 v72, 0
    v_mov_b32 v73, 0
    v_mov_b32 v74, 0
    v_mov_b32 v75, 0
    v_smfmac_f32_16x16x64_bf16 v[68:71], v[28:31], a[0:7], v17
    s_nop 0
    v_smfmac_f32_16x16x64_bf16 v[72:75], v[28:31], a[80:87], v17
    v_smfmac_f32_16x16x64_bf16 v[68:71], v[32:35], a[8:15], v17
    v_smfmac_f32_16x16x64_bf16 v[72:75], v[32:35], a[88:95], v17
    v_smfmac_f32_16x16x64_bf16 v[68:71], v[36:39], a[16:23], v17
    v_smfmac_f32_16x16x64_bf16 v[68:71], v[40:43], a[24:31], v17
    v_smfmac_f32_16x16x64_bf16 v[68:71], v[44:47], a[32:39], v17
    v_smfmac_f32_16x16x64_bf16 v[68:71], v[48:51], a[40:47], v17
    v_smfmac_f32_16x16x64_bf16 v[68:71], v[52:55], a[48:55], v17
    v_smfmac_f32_16x16x64_bf16 v[68:71], v[56:59], a[56:63], v17
    v_smfmac_f32_16x16x64_bf16 v[68:71], v[60:63], a[64:71], v17
    v_smfmac_f32_16x16x64_bf16 v[68:71], v[64:67], a[72:79], v17
    s_nop 3
    s_branch L_redo_4
L_sd_12c:
    v_mov_b32 v5, 460288
L_pf_16:
    buffer_load_dword v6, v5, s[4:7], s38 offen sc1
    v_mov_b32 v3, 200
L_p0_17:
    buffer_load_dword v4, v3, s[8:11], 0 offen sc1
    s_sub_u32 s36, s36, 1
    s_cbranch_scc1 L_exit
    s_waitcnt vmcnt(0)
    v_readfirstlane_b32 s90, v4
    s_nop 0
    s_cmp_eq_u32 s90, 0
    s_cbranch_scc1 L_p0_17
    s_and_b32 s90, s90, 2
    s_lshl_b32 s90, s90, 12
    v_readfirstlane_b32 s91, v6
    s_nop 0
    s_cmp_eq_u32 s91, 0
    s_cbranch_scc1 L_pf_16
    s_and_b32 s91, s91, 2
    s_lshl_b32 s91, s91, 12
    v_add_u32 v142, s91, v142
    v_add_u32 v143, s91, v143
    v_and_b32 v3, s90, v152
    v_xor_b32 v146, v3, v146
    s_branch L_sd_12
L_pp_14:
    buffer_load_dwordx4 v[176:179], v142, s[4:7], s53 offen sc1
    buffer_load_dwordx4 v[180:183], v143, s[4:7], s53 offen sc1
    s_sub_u32 s36, s36, 1
    s_cbranch_scc1 L_exit
    v_max_u32 v151, v168, v169
    v_max3_u32 v151, v151, v170, v171
    v_max3_u32 v151, v151, v172, v173
    v_max3_u32 v151, v151, v174, v175
    v_cmp_eq_u32 vcc, -1, v151
    s_cbranch_vccz L_pc_15
    s_waitcnt vmcnt(1)
    v_mfma_f32_16x16x32_bf16 v[184:187], v[198:201], v[176:179], 0
    v_mfma_f32_16x16x32_bf16 v[188:191], v[196:199], v[176:179], 0
    s_waitcnt vmcnt(0)
    v_mfma_f32_16x16x32_bf16 v[184:187], v[198:201], v[180:183], v[184:187]
    v_mfma_f32_16x16x32_bf16 v[188:191], v[196:199], v[180:183], v[188:191]
    s_nop 4
    v_cmp_u_f32 vcc, v184, v184
    v_cvt_pk_bf16_f32 v192, v184, v185
    v_cvt_pk_bf16_f32 v193, v186, v187
    v_cvt_pk_bf16_f32 v194, v188, v189
    v_cvt_pk_bf16_f32 v195, v190, v191
    s_cbranch_vccnz L_pp_14_1
    s_branch L_pc_15
L_pp_14_1:
    buffer_load_dwordx4 v[168:171], v142, s[4:7], s53 offen sc1
    buffer_load_dwordx4 v[172:175], v143, s[4:7], s53 offen sc1
    s_sub_u32 s36, s36, 1
    s_cbranch_scc1 L_exit
    v_max_u32 v151, v176, v177
    v_max3_u32 v151, v151, v178, v179
    v_max3_u32 v151, v151, v180, v181
    v_max3_u32 v151, v151, v182, v183
    v_cmp_eq_u32 vcc, -1, v151
    s_cbranch_vccz L_pc_15
    s_waitcnt vmcnt(1)
    v_mfma_f32_16x16x32_bf16 v[184:187], v[198:201], v[168:171], 0
    v_mfma_f32_16x16x32_bf16 v[188:191], v[196:199], v[168:171], 0
    s_waitcnt vmcnt(0)
    v_mfma_f32_16x16x32_bf16 v[184:187], v[198:201], v[172:175], v[184:187]
    v_mfma_f32_16x16x32_bf16 v[188:191], v[196:199], v[172:175], v[188:191]
    s_nop 4
    v_cmp_u_f32 vcc, v184, v184
    v_cvt_pk_bf16_f32 v192, v184, v185
    v_cvt_pk_bf16_f32 v193, v186, v187
    v_cvt_pk_bf16_f32 v194, v188, v189
    v_cvt_pk_bf16_f32 v195, v190, v191
    s_cbranch_vccnz L_pp_14
    s_branch L_pc_15
L_v_f:
    s_mov_b32 s12, s78
    s_and_b32 s13, s79, 0xffff
    s_mov_b32 s14, 7864320
    s_mov_b32 s15, 0x20000
    s_sub_u32 s40, s35, 12
    s_lshl_b32 s40, s40, 1
    s_mov_b32 s24, s70
    s_and_b32 s25, s71, 0xffff
    s_mov_b32 s26, 2621440
    s_mov_b32 s27, 0x20000
    v_and_b32 v1, 15, v0
    v_lshrrev_b32 v2, 4, v0
    v_lshrrev_b32 v3, 3, v0
    v_and_b32 v4, 7, v0
    s_lshl_b32 s90, s32, 3
    v_add_u32 v5, s90, v3
    s_and_b32 s91, s32, 1
    s_lshl_b32 s91, s91, 2
    v_and_b32 v6, 2, v3
    v_or_b32 v6, s91, v6
    v_xor_b32 v6, v6, v4
    v_lshlrev_b32 v6, 4, v6
    v_mul_u32_u24 v7, 12288, v5
    s_mul_i32 s92, s34, 1536
    s_lshl_b32 s93, s40, 7
    s_add_u32 s92, s92, s93
    v_add3_u32 v124, v6, v7, s92
    v_lshrrev_b32 v6, 1, v3
    v_or_b32 v6, s91, v6
    v_xor_b32 v6, v6, v4
    v_lshlrev_b32 v6, 4, v6
    v_mul_u32_u24 v7, 1280, v5
    v_add_u32 v10, v6, v7
    s_lshl_b32 s90, s32, 10
    s_add_u32 m0, s90, 81920
    s_mov_b32 s91, 128
    buffer_load_dwordx4 v124, s[12:15], s91 offen nt lds
    s_add_u32 m0, m0, 4096
    s_add_u32 s91, s91, 393216
    buffer_load_dwordx4 v124, s[12:15], s91 offen nt lds
    s_add_u32 m0, m0, 4096
    s_add_u32 s91, s91, 393216
    buffer_load_dwordx4 v124, s[12:15], s91 offen nt lds
    s_add_u32 m0, m0, 4096
    s_add_u32 s91, s91, 393216
    buffer_load_dwordx4 v124, s[12:15], s91 offen nt lds
    s_add_u32 m0, m0, 4096
    s_add_u32 s91, s91, 393216
    buffer_load_dwordx4 v124, s[12:15], s91 offen nt lds
    s_add_u32 m0, m0, 4096
    s_add_u32 s91, s91, 393216
    buffer_load_dwordx4 v124, s[12:15], s91 offen nt lds
    s_add_u32 m0, m0, 4096
    s_add_u32 s91, s91, 393216
    buffer_load_dwordx4 v124, s[12:15], s91 offen nt lds
    s_add_u32 m0, m0, 4096
    s_add_u32 s91, s91, 393216
    buffer_load_dwordx4 v124, s[12:15], s91 offen nt lds
    s_add_u32 m0, m0, 4096
    s_add_u32 s91, s91, 393216
    buffer_load_dwordx4 v124, s[12:15], s91 offen nt lds
    s_add_u32 m0, m0, 4096
    s_add_u32 s91, s91, 393216
    buffer_load_dwordx4 v124, s[12:15], s91 offen nt lds
    s_mul_i32 s60, s40, 86
    s_lshr_b32 s60, s60, 8
    s_mul_i32 s61, s60, 3
    s_sub_u32 s61, s40, s61
    s_add_u32 s90, s40, 1
    s_mul_i32 s62, s90, 86
    s_lshr_b32 s62, s62, 8
    s_mul_i32 s63, s62, 3
    s_sub_u32 s63, s90, s63
    v_lshrrev_b32 v3, 1, v2
    v_and_b32 v5, 1, v2
    s_lshl_b32 s90, s32, 9
    v_lshlrev_b32 v6, 4, v1
    v_lshl_add_u32 v6, v3, 8, v6
    v_add_u32 v6, s90, v6
    s_mul_i32 s90, s60, 12288
    s_lshl_b32 s91, s61, 11
    s_add_u32 s90, s90, s91
    v_mul_u32_u24 v7, 6144, v5
    v_add3_u32 v19, v6, v7, s90
    v_mov_b32 v22, -1
    s_mul_i32 s56, s62, 12288
    s_lshl_b32 s91, s63, 11
    s_add_u32 s56, s56, s91
    s_sub_u32 s56, s56, s90
    s_lshl_b32 s90, s40, 10
    s_lshl_b32 s91, s32, 8
    s_add_u32 s91, s91, s90
    s_add_u32 s91, s91, 25600
    v_lshl_add_u32 v135, v0, 2, s91
    v_and_b32 v6, 60, v0
    v_bfe_u32 v7, v0, 1, 1
    v_or_b32 v6, v6, v7
    v_and_b32 v7, 1, v0
    v_lshl_or_b32 v6, v7, 1, v6
    s_and_b32 s90, s32, 1
    s_lshl_b32 s90, s90, 3
    v_xor_b32 v6, s90, v6
    v_lshl_add_u32 v134, v6, 2, s91
    s_lshl_b32 s90, s60, 5
    s_lshl_b32 s91, s62, 5
    v_mov_b32 v3, s90
    v_mov_b32 v4, s91
    v_mov_b32 v6, s61
    v_mov_b32 v7, s63
    v_cmp_eq_u32 vcc, 0, v0
    s_nop 1
    v_cndmask_b32 v3, v4, v3, vcc
    v_cndmask_b32 v6, v7, v6, vcc
    v_add_u32 v4, v3, v6
    s_cmp_eq_u32 s32, 3
    s_cselect_b32 s91, 0, 2146435072
    s_add_u32 s91, s91, 462348
    v_lshl_add_u32 v21, v4, 2, s91
    v_lshl_add_u32 v4, v6, 2, v3
    s_lshl_b32 s91, s32, 2
    s_add_u32 s91, s91, 458752
    v_lshl_add_u32 v136, v4, 2, s91
    v_cmp_gt_u32 vcc, 2, v0
    v_mov_b32 v9, 2146435072
    s_nop 0
    v_cndmask_b32 v21, v9, v21, vcc
    v_cndmask_b32 v136, v9, v136, vcc
    s_lshl_b32 s90, s40, 1
    s_add_u32 s90, s90, s32
    s_sub_u32 s90, s90, 4
    s_lshl_b32 s90, s90, 11
    s_cmp_eq_u32 s40, 0
    s_cselect_b32 s90, 2146435072, s90
    v_lshl_add_u32 v137, v0, 4, s90
    v_mov_b32 v138, 460800
    v_lshrrev_b32 v3, 2, v1
    v_and_b32 v4, 3, v1
    v_and_b32 v5, 1, v2
    v_lshl_add_u32 v6, v2, 3, v3
    v_lshlrev_b32 v6, 7, v6
    v_and_b32 v7, 2, v3
    v_lshl_or_b32 v7, v5, 2, v7
    v_lshrrev_b32 v8, 1, v4
    s_lshl_b32 s90, s32, 1
    v_or_b32 v8, s90, v8
    v_xor_b32 v7, v7, v8
    v_lshl_add_u32 v6, v7, 4, v6
    v_and_b32 v7, 1, v4
    v_lshl_add_u32 v6, v7, 3, v6
    v_add_u32 v125, 81920, v6
    v_add_u32 v126, 40960, v6
    v_add_u32 v127, 122880, v6
    s_lshl_b32 s90, s32, 9
    s_add_u32 s90, s90, 133120
    v_and_b32 v7, 2, v1
    v_cmp_ne_u32 vcc, 0, v7
    v_mov_b32 v6, 0x4444
    v_mov_b32 v8, 0xeeee
    v_cndmask_b32 v17, v6, v8, vcc
    v_lshlrev_b32 v6, 4, v0
    v_add_u32 v16, 122880, v6
    s_mul_i32 s90, s32, 2560
    v_lshl_add_u32 v13, v0, 4, s90
    v_lshl_add_u32 v14, v0, 2, s90
    s_add_u32 s48, s90, 122880
    v_mul_u32_u24 v6, 40, v0
    v_add_u32 v15, s48, v6
    v_mul_u32_u24 v6, 164, v0
    v_min_u32 v6, 10236, v6
    v_add_u32 v25, 122880, v6
    v_lshrrev_b32 v6, 3, v1
    v_lshlrev_b32 v6, 10, v6
    v_and_b32 v7, 7, v1
    v_lshl_add_u32 v6, v7, 7, v6
    v_lshrrev_b32 v7, 1, v1
    v_xor_b32 v7, v7, v2
    v_lshl_add_u32 v11, v7, 4, v6
    v_xor_b32 v12, 64, v11
    v_and_b32 v3, 1, v0
    v_lshlrev_b32 v3, 12, v3
    v_bfe_u32 v5, v0, 2, 1
    v_lshl_add_u32 v3, v5, 13, v3
    v_bfe_u32 v4, v0, 1, 1
    v_lshl_add_u32 v3, v4, 14, v3
    s_lshl_b32 s91, s34, 9
    s_add_u32 s91, s91, 1933312
    s_xor_b32 s55, s32, 3
    s_or_b32 s55, s55, s40
    s_cselect_b32 s91, 2146435072, s91
    v_add_u32 v140, s91, v3
    v_cmp_gt_u32 vcc, 8, v0
    v_mov_b32 v9, 2146435072
    s_nop 0
    v_cndmask_b32 v140, v9, v140, vcc
    v_cmp_ne_u32 vcc, s34, v0
    v_mov_b32 v9, 2146435072
    s_nop 0
    v_cndmask_b32 v140, v9, v140, vcc
    s_lshr_b32 s91, s34, 2
    v_cmp_eq_u32 vcc, s91, v5
    s_nop 1
    v_cndmask_b32 v141, v9, v140, vcc
    v_cndmask_b32 v140, v140, v9, vcc
    v_and_b32 v3, 7, v0
    v_min_u32 v3, 5, v3
    v_bfe_u32 v4, v0, 3, 2
    v_lshlrev_b32 v4, 7, v4
    v_lshl_add_u32 v3, v3, 2, v4
    v_add_u32 v142, 462368, v3
    v_min_u32 v3, 39, v0
    v_lshlrev_b32 v3, 2, v3
    v_add_u32 v142, 460544, v3
    s_lshl_b32 s93, s40, 1
    s_add_u32 s93, s93, s32
    s_lshl_b32 s93, s93, 1
    s_sub_u32 s93, s93, 8
    s_nop 0
    s_lshr_b32 s90, s93, 2
    s_lshl_b32 s90, s90, 15
    s_and_b32 s92, s93, 3
    s_lshl_b32 s92, s92, 10
    s_add_u32 s90, s90, s92
    v_mov_b32 v5, s34
    v_and_b32 v6, 7, v1
    v_lshlrev_b32 v6, 4, v6
    v_lshl_add_u32 v6, v5, 7, v6
    v_lshrrev_b32 v7, 3, v1
    v_lshl_add_u32 v6, v7, 12, v6
    v_lshrrev_b32 v5, 1, v2
    v_lshl_add_u32 v6, v5, 13, v6
    v_and_b32 v5, 1, v2
    v_lshl_add_u32 v6, v5, 14, v6
    v_add_u32 v143, s90, v6
    s_and_b32 s91, s34, 1
    s_lshl_b32 s91, s91, 12
    s_add_u32 s90, s90, s91
    s_lshr_b32 s91, s34, 2
    s_lshl_b32 s91, s91, 13
    s_add_u32 s90, s90, s91
    s_and_b32 s91, s34, 2
    s_lshl_b32 s91, s91, 13
    s_add_u32 s90, s90, s91
    v_lshl_add_u32 v144, v0, 4, s90
    s_lshl_b32 s91, s93, 10
    s_add_u32 s91, s91, 884736
    v_lshl_add_u32 v146, v0, 4, s91
    s_lshr_b32 s91, s34, 1
    s_mul_i32 s91, s91, 10240
    s_lshl_b32 s92, s93, 5
    s_add_u32 s91, s91, s92
    s_and_b32 s92, s34, 1
    s_mul_i32 s92, s92, 40960
    s_add_u32 s91, s91, s92
    s_add_u32 s91, s91, 1280
    v_mul_u32_u24 v6, 2560, v2
    v_lshl_add_u32 v6, v1, 1, v6
    v_add_u32 v145, s91, v6
    v_cmp_gt_u32 s[58:59], 8, v1
    v_and_b32 v5, 1, v1
    v_lshrrev_b32 v6, 3, v1
    v_lshl_add_u32 v5, v5, 1, v6
    v_bfe_u32 v6, v1, 2, 1
    v_cmp_ne_u32 vcc, 0, v6
    v_mov_b32 v6, 0x3f80
    v_mov_b32 v7, 0x3f800000
    v_cndmask_b32 v6, v6, v7, vcc
    v_cmp_eq_u32 vcc, 0, v5
    s_nop 1
    v_cndmask_b32 v7, 0, v6, vcc
    v_accvgpr_write_b32 a160, v7
    v_cmp_eq_u32 vcc, 1, v5
    s_nop 1
    v_cndmask_b32 v7, 0, v6, vcc
    v_accvgpr_write_b32 a161, v7
    v_cmp_eq_u32 vcc, 2, v5
    s_nop 1
    v_cndmask_b32 v7, 0, v6, vcc
    v_accvgpr_write_b32 a162, v7
    v_cmp_eq_u32 vcc, 3, v5
    s_nop 1
    v_cndmask_b32 v7, 0, v6, vcc
    v_accvgpr_write_b32 a163, v7
    s_cmp_lg_u32 s40, 0
    s_cselect_b64 vcc, -1, 0
    v_cndmask_b32 v143, v9, v143, vcc
    v_cndmask_b32 v144, v9, v144, vcc
    v_cndmask_b32 v145, v9, v145, vcc
    v_cndmask_b32 v146, v9, v146, vcc
    s_lshl_b32 s90, s32, 10
    s_add_u32 m0, s90, 40960
    s_mov_b32 s91, 0
    buffer_load_dwordx4 v124, s[12:15], s91 offen nt lds
    s_add_u32 m0, m0, 4096
    s_add_u32 s91, s91, 393216
    buffer_load_dwordx4 v124, s[12:15], s91 offen nt lds
    s_add_u32 m0, m0, 4096
    s_add_u32 s91, s91, 393216
    buffer_load_dwordx4 v124, s[12:15], s91 offen nt lds
    s_add_u32 m0, m0, 4096
    s_add_u32 s91, s91, 393216
    buffer_load_dwordx4 v124, s[12:15], s91 offen nt lds
    s_add_u32 m0, m0, 4096
    s_add_u32 s91, s91, 393216
    buffer_load_dwordx4 v124, s[12:15], s91 offen nt lds
    s_add_u32 m0, m0, 4096
    s_add_u32 s91, s91, 393216
    buffer_load_dwordx4 v124, s[12:15], s91 offen nt lds
    s_add_u32 m0, m0, 4096
    s_add_u32 s91, s91, 393216
    buffer_load_dwordx4 v124, s[12:15], s91 offen nt lds
    s_add_u32 m0, m0, 4096
    s_add_u32 s91, s91, 393216
    buffer_load_dwordx4 v124, s[12:15], s91 offen nt lds
    s_add_u32 m0, m0, 4096
    s_add_u32 s91, s91, 393216
    buffer_load_dwordx4 v124, s[12:15], s91 offen nt lds
    s_add_u32 m0, m0, 4096
    s_add_u32 s91, s91, 393216
    buffer_load_dwordx4 v124, s[12:15], s91 offen nt lds
    s_lshl_b32 s90, s32, 10
    s_add_u32 m0, s90, 122880
    s_mov_b32 s91, 3932288
    buffer_load_dwordx4 v124, s[12:15], s91 offen nt lds
    s_add_u32 m0, m0, 4096
    s_add_u32 s91, s91, 393216
    buffer_load_dwordx4 v124, s[12:15], s91 offen nt lds
    s_add_u32 m0, m0, 4096
    s_add_u32 s91, s91, 393216
    buffer_load_dwordx4 v124, s[12:15], s91 offen nt lds
    s_add_u32 m0, m0, 4096
    s_add_u32 s91, s91, 393216
    buffer_load_dwordx4 v124, s[12:15], s91 offen nt lds
    s_add_u32 m0, m0, 4096
    s_add_u32 s91, s91, 393216
    buffer_load_dwordx4 v124, s[12:15], s91 offen nt lds
    s_add_u32 m0, m0, 4096
    s_add_u32 s91, s91, 393216
    buffer_load_dwordx4 v124, s[12:15], s91 offen nt lds
    s_add_u32 m0, m0, 4096
    s_add_u32 s91, s91, 393216
    buffer_load_dwordx4 v124, s[12:15], s91 offen nt lds
    s_add_u32 m0, m0, 4096
    s_add_u32 s91, s91, 393216
    buffer_load_dwordx4 v124, s[12:15], s91 offen nt lds
    s_add_u32 m0, m0, 4096
    s_add_u32 s91, s91, 393216
    buffer_load_dwordx4 v124, s[12:15], s91 offen nt lds
    s_add_u32 m0, m0, 4096
    s_add_u32 s91, s91, 393216
    buffer_load_dwordx4 v124, s[12:15], s91 offen nt lds
    s_mov_b32 s46, 0
    s_lshl_b32 s90, s32, 10
    s_add_u32 m0, s90, 0
    s_nop 0
    buffer_load_dwordx4 v10, s[24:27], s46 offen offset:0 lds
    s_add_u32 m0, m0, 3968
    s_nop 0
    buffer_load_dwordx4 v10, s[24:27], s46 offen offset:128 lds
    s_add_u32 m0, m0, 3968
    s_nop 0
    buffer_load_dwordx4 v10, s[24:27], s46 offen offset:256 lds
    s_add_u32 m0, m0, 3968
    s_nop 0
    buffer_load_dwordx4 v10, s[24:27], s46 offen offset:384 lds
    s_add_u32 m0, m0, 3968
    s_nop 0
    buffer_load_dwordx4 v10, s[24:27], s46 offen offset:512 lds
    s_add_u32 m0, m0, 3968
    s_nop 0
    buffer_load_dwordx4 v10, s[24:27], s46 offen offset:640 lds
    s_add_u32 m0, m0, 3968
    s_nop 0
    buffer_load_dwordx4 v10, s[24:27], s46 offen offset:768 lds
    s_add_u32 m0, m0, 3968
    s_nop 0
    buffer_load_dwordx4 v10, s[24:27], s46 offen offset:896 lds
    s_add_u32 m0, m0, 3968
    s_nop 0
    buffer_load_dwordx4 v10, s[24:27], s46 offen offset:1024 lds
    s_add_u32 m0, m0, 3968
    s_nop 0
    buffer_load_dwordx4 v10, s[24:27], s46 offen offset:1152 lds
    s_waitcnt vmcnt(30)
    s_barrier
    ds_read_b64_tr_b16 a[80:81], v125 offset:0
    ds_read_b64_tr_b16 a[82:83], v125 offset:512
    ds_read_b64_tr_b16 a[84:85], v125 offset:4096
    ds_read_b64_tr_b16 a[86:87], v125 offset:4608
    ds_read_b64_tr_b16 a[88:89], v125 offset:8192
    ds_read_b64_tr_b16 a[90:91], v125 offset:8704
    ds_read_b64_tr_b16 a[92:93], v125 offset:12288
    ds_read_b64_tr_b16 a[94:95], v125 offset:12800
    ds_read_b64_tr_b16 a[96:97], v125 offset:16384
    ds_read_b64_tr_b16 a[98:99], v125 offset:16896
    ds_read_b64_tr_b16 a[100:101], v125 offset:20480
    ds_read_b64_tr_b16 a[102:103], v125 offset:20992
    ds_read_b64_tr_b16 a[104:105], v125 offset:24576
    ds_read_b64_tr_b16 a[106:107], v125 offset:25088
    ds_read_b64_tr_b16 a[108:109], v125 offset:28672
    ds_read_b64_tr_b16 a[110:111], v125 offset:29184
    ds_read_b64_tr_b16 a[112:113], v125 offset:32768
    ds_read_b64_tr_b16 a[114:115], v125 offset:33280
    ds_read_b64_tr_b16 a[116:117], v125 offset:36864
    ds_read_b64_tr_b16 a[118:119], v125 offset:37376
    s_waitcnt lgkmcnt(0)
    s_barrier
    s_lshl_b32 s90, s32, 10
    s_add_u32 m0, s90, 81920
    s_mov_b32 s91, 3932160
    buffer_load_dwordx4 v124, s[12:15], s91 offen nt lds
    s_add_u32 m0, m0, 4096
    s_add_u32 s91, s91, 393216
    buffer_load_dwordx4 v124, s[12:15], s91 offen nt lds
    s_add_u32 m0, m0, 4096
    s_add_u32 s91, s91, 393216
    buffer_load_dwordx4 v124, s[12:15], s91 offen nt lds
    s_add_u32 m0, m0, 4096
    s_add_u32 s91, s91, 393216
    buffer_load_dwordx4 v124, s[12:15], s91 offen nt lds
    s_add_u32 m0, m0, 4096
    s_add_u32 s91, s91, 393216
    buffer_load_dwordx4 v124, s[12:15], s91 offen nt lds
    s_add_u32 m0, m0, 4096
    s_add_u32 s91, s91, 393216
    buffer_load_dwordx4 v124, s[12:15], s91 offen nt lds
    s_add_u32 m0, m0, 4096
    s_add_u32 s91, s91, 393216
    buffer_load_dwordx4 v124, s[12:15], s91 offen nt lds
    s_add_u32 m0, m0, 4096
    s_add_u32 s91, s91, 393216
    buffer_load_dwordx4 v124, s[12:15], s91 offen nt lds
    s_add_u32 m0, m0, 4096
    s_add_u32 s91, s91, 393216
    buffer_load_dwordx4 v124, s[12:15], s91 offen nt lds
    s_add_u32 m0, m0, 4096
    s_add_u32 s91, s91, 393216
    buffer_load_dwordx4 v124, s[12:15], s91 offen nt lds
    s_waitcnt vmcnt(30)
    s_barrier
    ds_read_b64_tr_b16 a[0:1], v126 offset:0
    ds_read_b64_tr_b16 a[2:3], v126 offset:512
    ds_read_b64_tr_b16 a[4:5], v126 offset:4096
    ds_read_b64_tr_b16 a[6:7], v126 offset:4608
    ds_read_b64_tr_b16 a[8:9], v126 offset:8192
    ds_read_b64_tr_b16 a[10:11], v126 offset:8704
    ds_read_b64_tr_b16 a[12:13], v126 offset:12288
    ds_read_b64_tr_b16 a[14:15], v126 offset:12800
    ds_read_b64_tr_b16 a[16:17], v126 offset:16384
    ds_read_b64_tr_b16 a[18:19], v126 offset:16896
    ds_read_b64_tr_b16 a[20:21], v126 offset:20480
    ds_read_b64_tr_b16 a[22:23], v126 offset:20992
    ds_read_b64_tr_b16 a[24:25], v126 offset:24576
    ds_read_b64_tr_b16 a[26:27], v126 offset:25088
    ds_read_b64_tr_b16 a[28:29], v126 offset:28672
    ds_read_b64_tr_b16 a[30:31], v126 offset:29184
    ds_read_b64_tr_b16 a[32:33], v126 offset:32768
    ds_read_b64_tr_b16 a[34:35], v126 offset:33280
    ds_read_b64_tr_b16 a[36:37], v126 offset:36864
    ds_read_b64_tr_b16 a[38:39], v126 offset:37376
    s_waitcnt lgkmcnt(0)
    s_barrier
    s_mov_b32 s46, 40960
    s_lshl_b32 s90, s32, 10
    s_add_u32 m0, s90, 40960
    s_nop 0
    buffer_load_dwordx4 v10, s[24:27], s46 offen offset:0 lds
    s_add_u32 m0, m0, 3968
    s_nop 0
    buffer_load_dwordx4 v10, s[24:27], s46 offen offset:128 lds
    s_add_u32 m0, m0, 3968
    s_nop 0
    buffer_load_dwordx4 v10, s[24:27], s46 offen offset:256 lds
    s_add_u32 m0, m0, 3968
    s_nop 0
    buffer_load_dwordx4 v10, s[24:27], s46 offen offset:384 lds
    s_add_u32 m0, m0, 3968
    s_nop 0
    buffer_load_dwordx4 v10, s[24:27], s46 offen offset:512 lds
    s_add_u32 m0, m0, 3968
    s_nop 0
    buffer_load_dwordx4 v10, s[24:27], s46 offen offset:640 lds
    s_add_u32 m0, m0, 3968
    s_nop 0
    buffer_load_dwordx4 v10, s[24:27], s46 offen offset:768 lds
    s_add_u32 m0, m0, 3968
    s_nop 0
    buffer_load_dwordx4 v10, s[24:27], s46 offen offset:896 lds
    s_add_u32 m0, m0, 3968
    s_nop 0
    buffer_load_dwordx4 v10, s[24:27], s46 offen offset:1024 lds
    s_add_u32 m0, m0, 3968
    s_nop 0
    buffer_load_dwordx4 v10, s[24:27], s46 offen offset:1152 lds
    s_waitcnt vmcnt(30)
    s_barrier
    ds_read_b64_tr_b16 a[120:121], v127 offset:0
    ds_read_b64_tr_b16 a[122:123], v127 offset:512
    ds_read_b64_tr_b16 a[124:125], v127 offset:4096
    ds_read_b64_tr_b16 a[126:127], v127 offset:4608
    ds_read_b64_tr_b16 a[128:129], v127 offset:8192
    ds_read_b64_tr_b16 a[130:131], v127 offset:8704
    ds_read_b64_tr_b16 a[132:133], v127 offset:12288
    ds_read_b64_tr_b16 a[134:135], v127 offset:12800
    ds_read_b64_tr_b16 a[136:137], v127 offset:16384
    ds_read_b64_tr_b16 a[138:139], v127 offset:16896
    ds_read_b64_tr_b16 a[140:141], v127 offset:20480
    ds_read_b64_tr_b16 a[142:143], v127 offset:20992
    ds_read_b64_tr_b16 a[144:145], v127 offset:24576
    ds_read_b64_tr_b16 a[146:147], v127 offset:25088
    ds_read_b64_tr_b16 a[148:149], v127 offset:28672
    ds_read_b64_tr_b16 a[150:151], v127 offset:29184
    ds_read_b64_tr_b16 a[152:153], v127 offset:32768
    ds_read_b64_tr_b16 a[154:155], v127 offset:33280
    ds_read_b64_tr_b16 a[156:157], v127 offset:36864
    ds_read_b64_tr_b16 a[158:159], v127 offset:37376
    s_waitcnt lgkmcnt(0)
    s_waitcnt vmcnt(10)
    s_barrier
    ds_read_b64_tr_b16 a[40:41], v125 offset:0
    ds_read_b64_tr_b16 a[42:43], v125 offset:512
    ds_read_b64_tr_b16 a[44:45], v125 offset:4096
    ds_read_b64_tr_b16 a[46:47], v125 offset:4608
    ds_read_b64_tr_b16 a[48:49], v125 offset:8192
    ds_read_b64_tr_b16 a[50:51], v125 offset:8704
    ds_read_b64_tr_b16 a[52:53], v125 offset:12288
    ds_read_b64_tr_b16 a[54:55], v125 offset:12800
    ds_read_b64_tr_b16 a[56:57], v125 offset:16384
    ds_read_b64_tr_b16 a[58:59], v125 offset:16896
    ds_read_b64_tr_b16 a[60:61], v125 offset:20480
    ds_read_b64_tr_b16 a[62:63], v125 offset:20992
    ds_read_b64_tr_b16 a[64:65], v125 offset:24576
    ds_read_b64_tr_b16 a[66:67], v125 offset:25088
    ds_read_b64_tr_b16 a[68:69], v125 offset:28672
    ds_read_b64_tr_b16 a[70:71], v125 offset:29184
    ds_read_b64_tr_b16 a[72:73], v125 offset:32768
    ds_read_b64_tr_b16 a[74:75], v125 offset:33280
    ds_read_b64_tr_b16 a[76:77], v125 offset:36864
    ds_read_b64_tr_b16 a[78:79], v125 offset:37376
    s_waitcnt lgkmcnt(0)
    s_mov_b32 s49, 40960
    s_mov_b32 s47, 40960
    s_mov_b32 s37, -1
    s_add_u32 s44, s38, 65536
    s_add_u32 s45, s44, s56
    s_mov_b32 s46, 40960
    v_mov_b32 v1, 192
    buffer_load_dword v2, v1, s[8:11], 0 offen sc1
    ds_read_b128 v[84:87], v11 offset:0
    ds_read_b128 v[88:91], v11 offset:2048
    ds_read_b128 v[92:95], v12 offset:0
    ds_read_b128 v[96:99], v12 offset:2048
    s_waitcnt lgkmcnt(2)
    v_mfma_f32_16x16x32_bf16 v[108:111], a[0:3], v[84:87], 0
    ds_read_b128 v[100:103], v11 offset:4096
    v_mfma_f32_16x16x32_bf16 v[112:115], a[0:3], v[88:91], 0
    ds_read_b128 v[104:107], v11 offset:6144
    v_mfma_f32_16x16x32_bf16 v[116:119], a[80:83], v[84:87], 0
    v_mfma_f32_16x16x32_bf16 v[120:123], a[80:83], v[88:91], 0
    s_waitcnt lgkmcnt(2)
    v_mfma_f32_16x16x32_bf16 v[108:111], a[4:7], v[92:95], v[108:111]
    ds_read_b128 v[84:87], v12 offset:4096
    v_mfma_f32_16x16x32_bf16 v[112:115], a[4:7], v[96:99], v[112:115]
    ds_read_b128 v[88:91], v12 offset:6144
    v_mfma_f32_16x16x32_bf16 v[116:119], a[84:87], v[92:95], v[116:119]
    v_mfma_f32_16x16x32_bf16 v[120:123], a[84:87], v[96:99], v[120:123]
    s_waitcnt lgkmcnt(2)
    v_mfma_f32_16x16x32_bf16 v[108:111], a[8:11], v[100:103], v[108:111]
    ds_read_b128 v[92:95], v11 offset:8192
    v_mfma_f32_16x16x32_bf16 v[112:115], a[8:11], v[104:107], v[112:115]
    ds_read_b128 v[96:99], v11 offset:10240
    v_mfma_f32_16x16x32_bf16 v[116:119], a[88:91], v[100:103], v[116:119]
    v_mfma_f32_16x16x32_bf16 v[120:123], a[88:91], v[104:107], v[120:123]
    s_waitcnt lgkmcnt(2)
    v_mfma_f32_16x16x32_bf16 v[108:111], a[12:15], v[84:87], v[108:111]
    ds_read_b128 v[100:103], v12 offset:8192
    v_mfma_f32_16x16x32_bf16 v[112:115], a[12:15], v[88:91], v[112:115]
    ds_read_b128 v[104:107], v12 offset:10240
    v_mfma_f32_16x16x32_bf16 v[116:119], a[92:95], v[84:87], v[116:119]
    v_mfma_f32_16x16x32_bf16 v[120:123], a[92:95], v[88:91], v[120:123]
    s_waitcnt lgkmcnt(2)
    v_mfma_f32_16x16x32_bf16 v[108:111], a[16:19], v[92:95], v[108:111]
    ds_read_b128 v[84:87], v11 offset:12288
    v_mfma_f32_16x16x32_bf16 v[112:115], a[16:19], v[96:99], v[112:115]
    ds_read_b128 v[88:91], v11 offset:14336
    v_mfma_f32_16x16x32_bf16 v[116:119], a[96:99], v[92:95], v[116:119]
    v_mfma_f32_16x16x32_bf16 v[120:123], a[96:99], v[96:99], v[120:123]
    s_waitcnt lgkmcnt(2)
    v_mfma_f32_16x16x32_bf16 v[108:111], a[20:23], v[100:103], v[108:111]
    ds_read_b128 v[92:95], v12 offset:12288
    v_mfma_f32_16x16x32_bf16 v[112:115], a[20:23], v[104:107], v[112:115]
    ds_read_b128 v[96:99], v12 offset:14336
    v_mfma_f32_16x16x32_bf16 v[116:119], a[100:103], v[100:103], v[116:119]
    v_mfma_f32_16x16x32_bf16 v[120:123], a[100:103], v[104:107], v[120:123]
    s_waitcnt lgkmcnt(2)
    v_mfma_f32_16x16x32_bf16 v[108:111], a[24:27], v[84:87], v[108:111]
    ds_read_b128 v[100:103], v11 offset:16384
    v_mfma_f32_16x16x32_bf16 v[112:115], a[24:27], v[88:91], v[112:115]
    ds_read_b128 v[104:107], v11 offset:18432
    v_mfma_f32_16x16x32_bf16 v[116:119], a[104:107], v[84:87], v[116:119]
    v_mfma_f32_16x16x32_bf16 v[120:123], a[104:107], v[88:91], v[120:123]
    s_waitcnt lgkmcnt(2)
    v_mfma_f32_16x16x32_bf16 v[108:111], a[28:31], v[92:95], v[108:111]
    ds_read_b128 v[84:87], v12 offset:16384
    v_mfma_f32_16x16x32_bf16 v[112:115], a[28:31], v[96:99], v[112:115]
    ds_read_b128 v[88:91], v12 offset:18432
    v_mfma_f32_16x16x32_bf16 v[116:119], a[108:111], v[92:95], v[116:119]
    v_mfma_f32_16x16x32_bf16 v[120:123], a[108:111], v[96:99], v[120:123]
    s_waitcnt lgkmcnt(2)
    v_mfma_f32_16x16x32_bf16 v[108:111], a[32:35], v[100:103], v[108:111]
    ds_read_b128 v[92:95], v11 offset:20480
    v_mfma_f32_16x16x32_bf16 v[112:115], a[32:35], v[104:107], v[112:115]
    ds_read_b128 v[96:99], v11 offset:22528
    v_mfma_f32_16x16x32_bf16 v[116:119], a[112:115], v[100:103], v[116:119]
    v_mfma_f32_16x16x32_bf16 v[120:123], a[112:115], v[104:107], v[120:123]
    s_waitcnt lgkmcnt(2)
    v_mfma_f32_16x16x32_bf16 v[108:111], a[36:39], v[84:87], v[108:111]
    ds_read_b128 v[100:103], v12 offset:20480
    v_mfma_f32_16x16x32_bf16 v[112:115], a[36:39], v[88:91], v[112:115]
    ds_read_b128 v[104:107], v12 offset:22528
    v_mfma_f32_16x16x32_bf16 v[116:119], a[116:119], v[84:87], v[116:119]
    v_mfma_f32_16x16x32_bf16 v[120:123], a[116:119], v[88:91], v[120:123]
    s_waitcnt lgkmcnt(2)
    v_mfma_f32_16x16x32_bf16 v[108:111], a[40:43], v[92:95], v[108:111]
    ds_read_b128 v[84:87], v11 offset:24576
    v_mfma_f32_16x16x32_bf16 v[112:115], a[40:43], v[96:99], v[112:115]
    ds_read_b128 v[88:91], v11 offset:26624
    v_mfma_f32_16x16x32_bf16 v[116:119], a[120:123], v[92:95], v[116:119]
    v_mfma_f32_16x16x32_bf16 v[120:123], a[120:123], v[96:99], v[120:123]
    s_waitcnt lgkmcnt(2)
    v_mfma_f32_16x16x32_bf16 v[108:111], a[44:47], v[100:103], v[108:111]
    ds_read_b128 v[92:95], v12 offset:24576
    v_mfma_f32_16x16x32_bf16 v[112:115], a[44:47], v[104:107], v[112:115]
    ds_read_b128 v[96:99], v12 offset:26624
    v_mfma_f32_16x16x32_bf16 v[116:119], a[124:127], v[100:103], v[116:119]
    v_mfma_f32_16x16x32_bf16 v[120:123], a[124:127], v[104:107], v[120:123]
    s_waitcnt lgkmcnt(2)
    v_mfma_f32_16x16x32_bf16 v[108:111], a[48:51], v[84:87], v[108:111]
    ds_read_b128 v[100:103], v11 offset:28672
    v_mfma_f32_16x16x32_bf16 v[112:115], a[48:51], v[88:91], v[112:115]
    ds_read_b128 v[104:107], v11 offset:30720
    v_mfma_f32_16x16x32_bf16 v[116:119], a[128:131], v[84:87], v[116:119]
    v_mfma_f32_16x16x32_bf16 v[120:123], a[128:131], v[88:91], v[120:123]
    s_waitcnt lgkmcnt(2)
    v_mfma_f32_16x16x32_bf16 v[108:111], a[52:55], v[92:95], v[108:111]
    ds_read_b128 v[84:87], v12 offset:28672
    v_mfma_f32_16x16x32_bf16 v[112:115], a[52:55], v[96:99], v[112:115]
    ds_read_b128 v[88:91], v12 offset:30720
    v_mfma_f32_16x16x32_bf16 v[116:119], a[132:135], v[92:95], v[116:119]
    v_mfma_f32_16x16x32_bf16 v[120:123], a[132:135], v[96:99], v[120:123]
    s_waitcnt lgkmcnt(2)
    v_mfma_f32_16x16x32_bf16 v[108:111], a[56:59], v[100:103], v[108:111]
    ds_read_b128 v[92:95], v11 offset:32768
    v_mfma_f32_16x16x32_bf16 v[112:115], a[56:59], v[104:107], v[112:115]
    ds_read_b128 v[96:99], v11 offset:34816
    v_mfma_f32_16x16x32_bf16 v[116:119], a[136:139], v[100:103], v[116:119]
    v_mfma_f32_16x16x32_bf16 v[120:123], a[136:139], v[104:107], v[120:123]
    s_waitcnt lgkmcnt(2)
    v_mfma_f32_16x16x32_bf16 v[108:111], a[60:63], v[84:87], v[108:111]
    ds_read_b128 v[100:103], v12 offset:32768
    v_mfma_f32_16x16x32_bf16 v[112:115], a[60:63], v[88:91], v[112:115]
    ds_read_b128 v[104:107], v12 offset:34816
    v_mfma_f32_16x16x32_bf16 v[116:119], a[140:143], v[84:87], v[116:119]
    v_mfma_f32_16x16x32_bf16 v[120:123], a[140:143], v[88:91], v[120:123]
    s_waitcnt lgkmcnt(2)
    v_mfma_f32_16x16x32_bf16 v[108:111], a[64:67], v[92:95], v[108:111]
    ds_read_b128 v[84:87], v11 offset:36864
    v_mfma_f32_16x16x32_bf16 v[112:115], a[64:67], v[96:99], v[112:115]
    ds_read_b128 v[88:91], v11 offset:38912
    v_mfma_f32_16x16x32_bf16 v[116:119], a[144:147], v[92:95], v[116:119]
    v_mfma_f32_16x16x32_bf16 v[120:123], a[144:147], v[96:99], v[120:123]
    s_waitcnt lgkmcnt(2)
    v_mfma_f32_16x16x32_bf16 v[108:111], a[68:71], v[100:103], v[108:111]
    ds_read_b128 v[92:95], v12 offset:36864
    v_mfma_f32_16x16x32_bf16 v[112:115], a[68:71], v[104:107], v[112:115]
    ds_read_b128 v[96:99], v12 offset:38912
    v_mfma_f32_16x16x32_bf16 v[116:119], a[148:151], v[100:103], v[116:119]
    v_mfma_f32_16x16x32_bf16 v[120:123], a[148:151], v[104:107], v[120:123]
    s_waitcnt lgkmcnt(0)
    v_mfma_f32_16x16x32_bf16 v[108:111], a[72:75], v[84:87], v[108:111]
    v_add_u32 v11, s49, v11
    v_mfma_f32_16x16x32_bf16 v[112:115], a[72:75], v[88:91], v[112:115]
    v_add_u32 v12, s49, v12
    v_mfma_f32_16x16x32_bf16 v[108:111], a[76:79], v[92:95], v[108:111]
    s_sub_u32 s47, s47, s49
    v_mfma_f32_16x16x32_bf16 v[112:115], a[76:79], v[96:99], v[112:115]
    s_sub_u32 s49, 0, s49
    v_mfma_f32_16x16x32_bf16 v[116:119], a[152:155], v[84:87], v[116:119]
    v_mfma_f32_16x16x32_bf16 v[120:123], a[152:155], v[88:91], v[120:123]
    v_mfma_f32_16x16x32_bf16 v[116:119], a[156:159], v[92:95], v[116:119]
    v_mfma_f32_16x16x32_bf16 v[120:123], a[156:159], v[96:99], v[120:123]
    v_cvt_pk_bf16_f32 v124, v108, v109
    v_cvt_pk_bf16_f32 v125, v110, v111
    v_cvt_pk_bf16_f32 v126, v112, v113
    v_cvt_pk_bf16_f32 v127, v114, v115
    s_nop 0
    v_permlane16_swap_b32 v124, v126
    v_permlane16_swap_b32 v125, v127
    v_cvt_pk_bf16_f32 v128, v116, v117
    v_cvt_pk_bf16_f32 v129, v118, v119
    v_cvt_pk_bf16_f32 v130, v120, v121
    v_cvt_pk_bf16_f32 v131, v122, v123
    s_nop 0
    v_permlane16_swap_b32 v128, v130
    v_permlane16_swap_b32 v129, v131
    buffer_store_dwordx4 v[124:127], v19, s[4:7], s44 offen
    buffer_store_dwordx4 v[128:131], v19, s[4:7], s45 offen
    s_waitcnt vmcnt(2)
    s_branch L_gw_18c
L_gw_18:
    buffer_load_dword v2, v1, s[8:11], 0 offen sc1
    s_sub_u32 s36, s36, 1
    s_cbranch_scc1 L_exit
    s_waitcnt vmcnt(0)
L_gw_18c:
    v_readfirstlane_b32 s90, v2
    s_nop 0
    s_cmp_eq_u32 s90, 0
    s_cbranch_scc1 L_gw_18
    s_cmp_lg_u32 s90, 1
    s_cbranch_scc1 L_slow
    s_waitcnt vmcnt(2) lgkmcnt(0)
    s_barrier
    s_add_u32 s44, s38, 180224
    s_add_u32 s45, s44, s56
    s_mov_b32 s46, 81920
    v_mov_b32 v20, 1
    ds_read_b128 v[84:87], v11 offset:0
    ds_read_b128 v[88:91], v11 offset:2048
    ds_read_b128 v[92:95], v12 offset:0
    ds_read_b128 v[96:99], v12 offset:2048
    s_lshl_b32 s90, s32, 10
    s_add_u32 m0, s90, s47
    s_waitcnt lgkmcnt(2)
    v_mfma_f32_16x16x32_bf16 v[108:111], a[0:3], v[84:87], 0
    ds_read_b128 v[100:103], v11 offset:4096
    v_mfma_f32_16x16x32_bf16 v[112:115], a[0:3], v[88:91], 0
    ds_read_b128 v[104:107], v11 offset:6144
    v_mfma_f32_16x16x32_bf16 v[116:119], a[80:83], v[84:87], 0
    buffer_load_dwordx4 v10, s[24:27], s46 offen offset:0 lds
    s_add_u32 m0, m0, 3968
    v_mfma_f32_16x16x32_bf16 v[120:123], a[80:83], v[88:91], 0
    s_waitcnt lgkmcnt(2)
    v_mfma_f32_16x16x32_bf16 v[108:111], a[4:7], v[92:95], v[108:111]
    ds_read_b128 v[84:87], v12 offset:4096
    v_mfma_f32_16x16x32_bf16 v[112:115], a[4:7], v[96:99], v[112:115]
    ds_read_b128 v[88:91], v12 offset:6144
    v_mfma_f32_16x16x32_bf16 v[116:119], a[84:87], v[92:95], v[116:119]
    buffer_load_dwordx4 v10, s[24:27], s46 offen offset:128 lds
    s_add_u32 m0, m0, 3968
    v_mfma_f32_16x16x32_bf16 v[120:123], a[84:87], v[96:99], v[120:123]
    s_waitcnt lgkmcnt(2)
    v_mfma_f32_16x16x32_bf16 v[108:111], a[8:11], v[100:103], v[108:111]
    ds_read_b128 v[92:95], v11 offset:8192
    v_mfma_f32_16x16x32_bf16 v[112:115], a[8:11], v[104:107], v[112:115]
    ds_read_b128 v[96:99], v11 offset:10240
    v_mfma_f32_16x16x32_bf16 v[116:119], a[88:91], v[100:103], v[116:119]
    buffer_load_dwordx4 v10, s[24:27], s46 offen offset:256 lds
    s_add_u32 m0, m0, 3968
    v_mfma_f32_16x16x32_bf16 v[120:123], a[88:91], v[104:107], v[120:123]
    s_waitcnt lgkmcnt(2)
    v_mfma_f32_16x16x32_bf16 v[108:111], a[12:15], v[84:87], v[108:111]
    ds_read_b128 v[100:103], v12 offset:8192
    v_mfma_f32_16x16x32_bf16 v[112:115], a[12:15], v[88:91], v[112:115]
    ds_read_b128 v[104:107], v12 offset:10240
    v_mfma_f32_16x16x32_bf16 v[116:119], a[92:95], v[84:87], v[116:119]
    buffer_load_dwordx4 v10, s[24:27], s46 offen offset:384 lds
    s_add_u32 m0, m0, 3968
    v_mfma_f32_16x16x32_bf16 v[120:123], a[92:95], v[88:91], v[120:123]
    s_waitcnt lgkmcnt(2)
    v_mfma_f32_16x16x32_bf16 v[108:111], a[16:19], v[92:95], v[108:111]
    ds_read_b128 v[84:87], v11 offset:12288
    v_mfma_f32_16x16x32_bf16 v[112:115], a[16:19], v[96:99], v[112:115]
    ds_read_b128 v[88:91], v11 offset:14336
    v_mfma_f32_16x16x32_bf16 v[116:119], a[96:99], v[92:95], v[116:119]
    buffer_load_dwordx4 v10, s[24:27], s46 offen offset:512 lds
    s_add_u32 m0, m0, 3968
    v_mfma_f32_16x16x32_bf16 v[120:123], a[96:99], v[96:99], v[120:123]
    s_waitcnt lgkmcnt(2)
    v_mfma_f32_16x16x32_bf16 v[108:111], a[20:23], v[100:103], v[108:111]
    ds_read_b128 v[92:95], v12 offset:12288
    v_mfma_f32_16x16x32_bf16 v[112:115], a[20:23], v[104:107], v[112:115]
    ds_read_b128 v[96:99], v12 offset:14336
    v_mfma_f32_16x16x32_bf16 v[116:119], a[100:103], v[100:103], v[116:119]
    s_waitcnt vmcnt(5)
    buffer_store_dword v20, v136, s[4:7], s38 offen
    v_mfma_f32_16x16x32_bf16 v[120:123], a[100:103], v[104:107], v[120:123]
    s_waitcnt lgkmcnt(2)
    v_mfma_f32_16x16x32_bf16 v[108:111], a[24:27], v[84:87], v[108:111]
    ds_read_b128 v[100:103], v11 offset:16384
    v_mfma_f32_16x16x32_bf16 v[112:115], a[24:27], v[88:91], v[112:115]
    ds_read_b128 v[104:107], v11 offset:18432
    v_mfma_f32_16x16x32_bf16 v[116:119], a[104:107], v[84:87], v[116:119]
    buffer_load_dwordx4 v10, s[24:27], s46 offen offset:640 lds
    s_add_u32 m0, m0, 3968
    v_mfma_f32_16x16x32_bf16 v[120:123], a[104:107], v[88:91], v[120:123]
    s_waitcnt lgkmcnt(2)
    v_mfma_f32_16x16x32_bf16 v[108:111], a[28:31], v[92:95], v[108:111]
    ds_read_b128 v[84:87], v12 offset:16384
    v_mfma_f32_16x16x32_bf16 v[112:115], a[28:31], v[96:99], v[112:115]
    ds_read_b128 v[88:91], v12 offset:18432
    v_mfma_f32_16x16x32_bf16 v[116:119], a[108:111], v[92:95], v[116:119]
    buffer_load_dwordx4 v10, s[24:27], s46 offen offset:768 lds
    s_add_u32 m0, m0, 3968
    v_mfma_f32_16x16x32_bf16 v[120:123], a[108:111], v[96:99], v[120:123]
    s_waitcnt lgkmcnt(2)
    v_mfma_f32_16x16x32_bf16 v[108:111], a[32:35], v[100:103], v[108:111]
    ds_read_b128 v[92:95], v11 offset:20480
    v_mfma_f32_16x16x32_bf16 v[112:115], a[32:35], v[104:107], v[112:115]
    ds_read_b128 v[96:99], v11 offset:22528
    v_mfma_f32_16x16x32_bf16 v[116:119], a[112:115], v[100:103], v[116:119]
    buffer_load_dwordx4 v10, s[24:27], s46 offen offset:896 lds
    s_add_u32 m0, m0, 3968
    v_mfma_f32_16x16x32_bf16 v[120:123], a[112:115], v[104:107], v[120:123]
    s_waitcnt lgkmcnt(2)
    v_mfma_f32_16x16x32_bf16 v[108:111], a[36:39], v[84:87], v[108:111]
    ds_read_b128 v[100:103], v12 offset:20480
    v_mfma_f32_16x16x32_bf16 v[112:115], a[36:39], v[88:91], v[112:115]
    ds_read_b128 v[104:107], v12 offset:22528
    v_mfma_f32_16x16x32_bf16 v[116:119], a[116:119], v[84:87], v[116:119]
    buffer_load_dwordx4 v10, s[24:27], s46 offen offset:1024 lds
    s_add_u32 m0, m0, 3968
    v_mfma_f32_16x16x32_bf16 v[120:123], a[116:119], v[88:91], v[120:123]
    s_waitcnt lgkmcnt(2)
    v_mfma_f32_16x16x32_bf16 v[108:111], a[40:43], v[92:95], v[108:111]
    ds_read_b128 v[84:87], v11 offset:24576
    v_mfma_f32_16x16x32_bf16 v[112:115], a[40:43], v[96:99], v[112:115]
    ds_read_b128 v[88:91], v11 offset:26624
    v_mfma_f32_16x16x32_bf16 v[116:119], a[120:123], v[92:95], v[116:119]
    buffer_load_dwordx4 v10, s[24:27], s46 offen offset:1152 lds
    v_mfma_f32_16x16x32_bf16 v[120:123], a[120:123], v[96:99], v[120:123]
    s_waitcnt lgkmcnt(2)
    v_mfma_f32_16x16x32_bf16 v[108:111], a[44:47], v[100:103], v[108:111]
    ds_read_b128 v[92:95], v12 offset:24576
    v_mfma_f32_16x16x32_bf16 v[112:115], a[44:47], v[104:107], v[112:115]
    ds_read_b128 v[96:99], v12 offset:26624
    v_mfma_f32_16x16x32_bf16 v[116:119], a[124:127], v[100:103], v[116:119]
    v_mfma_f32_16x16x32_bf16 v[120:123], a[124:127], v[104:107], v[120:123]
    s_waitcnt lgkmcnt(2)
    v_mfma_f32_16x16x32_bf16 v[108:111], a[48:51], v[84:87], v[108:111]
    ds_read_b128 v[100:103], v11 offset:28672
    v_mfma_f32_16x16x32_bf16 v[112:115], a[48:51], v[88:91], v[112:115]
    ds_read_b128 v[104:107], v11 offset:30720
    v_mfma_f32_16x16x32_bf16 v[116:119], a[128:131], v[84:87], v[116:119]
    v_mfma_f32_16x16x32_bf16 v[120:123], a[128:131], v[88:91], v[120:123]
    s_waitcnt lgkmcnt(2)
    v_mfma_f32_16x16x32_bf16 v[108:111], a[52:55], v[92:95], v[108:111]
    ds_read_b128 v[84:87], v12 offset:28672
    v_mfma_f32_16x16x32_bf16 v[112:115], a[52:55], v[96:99], v[112:115]
    ds_read_b128 v[88:91], v12 offset:30720
    v_mfma_f32_16x16x32_bf16 v[116:119], a[132:135], v[92:95], v[116:119]
    v_mfma_f32_16x16x32_bf16 v[120:123], a[132:135], v[96:99], v[120:123]
    s_waitcnt lgkmcnt(2)
    v_mfma_f32_16x16x32_bf16 v[108:111], a[56:59], v[100:103], v[108:111]
    ds_read_b128 v[92:95], v11 offset:32768
    v_mfma_f32_16x16x32_bf16 v[112:115], a[56:59], v[104:107], v[112:115]
    ds_read_b128 v[96:99], v11 offset:34816
    v_mfma_f32_16x16x32_bf16 v[116:119], a[136:139], v[100:103], v[116:119]
    v_mfma_f32_16x16x32_bf16 v[120:123], a[136:139], v[104:107], v[120:123]
    s_waitcnt lgkmcnt(2)
    v_mfma_f32_16x16x32_bf16 v[108:111], a[60:63], v[84:87], v[108:111]
    ds_read_b128 v[100:103], v12 offset:32768
    v_mfma_f32_16x16x32_bf16 v[112:115], a[60:63], v[88:91], v[112:115]
    ds_read_b128 v[104:107], v12 offset:34816
    v_mfma_f32_16x16x32_bf16 v[116:119], a[140:143], v[84:87], v[116:119]
    v_mfma_f32_16x16x32_bf16 v[120:123], a[140:143], v[88:91], v[120:123]
    s_waitcnt lgkmcnt(2)
    v_mfma_f32_16x16x32_bf16 v[108:111], a[64:67], v[92:95], v[108:111]
    ds_read_b128 v[84:87], v11 offset:36864
    v_mfma_f32_16x16x32_bf16 v[112:115], a[64:67], v[96:99], v[112:115]
    ds_read_b128 v[88:91], v11 offset:38912
    v_mfma_f32_16x16x32_bf16 v[116:119], a[144:147], v[92:95], v[116:119]
    v_mfma_f32_16x16x32_bf16 v[120:123], a[144:147], v[96:99], v[120:123]
    s_waitcnt lgkmcnt(2)
    v_mfma_f32_16x16x32_bf16 v[108:111], a[68:71], v[100:103], v[108:111]
    ds_read_b128 v[92:95], v12 offset:36864
    v_mfma_f32_16x16x32_bf16 v[112:115], a[68:71], v[104:107], v[112:115]
    ds_read_b128 v[96:99], v12 offset:38912
    v_mfma_f32_16x16x32_bf16 v[116:119], a[148:151], v[100:103], v[116:119]
    v_mfma_f32_16x16x32_bf16 v[120:123], a[148:151], v[104:107], v[120:123]
    s_waitcnt lgkmcnt(0)
    v_mfma_f32_16x16x32_bf16 v[108:111], a[72:75], v[84:87], v[108:111]
    v_add_u32 v11, s49, v11
    v_mfma_f32_16x16x32_bf16 v[112:115], a[72:75], v[88:91], v[112:115]
    v_add_u32 v12, s49, v12
    v_mfma_f32_16x16x32_bf16 v[108:111], a[76:79], v[92:95], v[108:111]
    s_sub_u32 s47, s47, s49
    v_mfma_f32_16x16x32_bf16 v[112:115], a[76:79], v[96:99], v[112:115]
    s_sub_u32 s49, 0, s49
    v_mfma_f32_16x16x32_bf16 v[116:119], a[152:155], v[84:87], v[116:119]
    v_mfma_f32_16x16x32_bf16 v[120:123], a[152:155], v[88:91], v[120:123]
    v_mfma_f32_16x16x32_bf16 v[116:119], a[156:159], v[92:95], v[116:119]
    v_mfma_f32_16x16x32_bf16 v[120:123], a[156:159], v[96:99], v[120:123]
    v_cvt_pk_bf16_f32 v124, v108, v109
    v_cvt_pk_bf16_f32 v125, v110, v111
    v_cvt_pk_bf16_f32 v126, v112, v113
    v_cvt_pk_bf16_f32 v127, v114, v115
    s_nop 0
    v_permlane16_swap_b32 v124, v126
    v_permlane16_swap_b32 v125, v127
    v_cvt_pk_bf16_f32 v128, v116, v117
    v_cvt_pk_bf16_f32 v129, v118, v119
    v_cvt_pk_bf16_f32 v130, v120, v121
    v_cvt_pk_bf16_f32 v131, v122, v123
    s_nop 0
    v_permlane16_swap_b32 v128, v130
    v_permlane16_swap_b32 v129, v131
    buffer_store_dwordx4 v[124:127], v19, s[4:7], s44 offen
    buffer_store_dwordx4 v[128:131], v19, s[4:7], s45 offen
    s_waitcnt vmcnt(2) lgkmcnt(0)
    s_barrier
    s_add_u32 s44, s38, 294912
    s_add_u32 s45, s44, s56
    s_mov_b32 s46, 122880
    v_mov_b32 v20, 2
    ds_read_b128 v[84:87], v11 offset:0
    ds_read_b128 v[88:91], v11 offset:2048
    ds_read_b128 v[92:95], v12 offset:0
    ds_read_b128 v[96:99], v12 offset:2048
    s_lshl_b32 s90, s32, 10
    s_add_u32 m0, s90, s47
    s_waitcnt lgkmcnt(2)
    v_mfma_f32_16x16x32_bf16 v[108:111], a[0:3], v[84:87], 0
    ds_read_b128 v[100:103], v11 offset:4096
    s_add_u32 s51, s37, 3
    v_mfma_f32_16x16x32_bf16 v[112:115], a[0:3], v[88:91], 0
    ds_read_b128 v[104:107], v11 offset:6144
    s_and_b32 s50, s51, 3
    v_mfma_f32_16x16x32_bf16 v[116:119], a[80:83], v[84:87], 0
    buffer_load_dwordx4 v10, s[24:27], s46 offen offset:0 lds
    s_add_u32 m0, m0, 3968
    v_mfma_f32_16x16x32_bf16 v[120:123], a[80:83], v[88:91], 0
    s_waitcnt lgkmcnt(2)
    s_mul_i32 s50, s50, 114688
    v_mfma_f32_16x16x32_bf16 v[108:111], a[4:7], v[92:95], v[108:111]
    ds_read_b128 v[84:87], v12 offset:4096
    s_add_u32 s50, s50, 65536
    v_mfma_f32_16x16x32_bf16 v[112:115], a[4:7], v[96:99], v[112:115]
    ds_read_b128 v[88:91], v12 offset:6144
    s_add_u32 s44, s38, s50
    v_mfma_f32_16x16x32_bf16 v[116:119], a[84:87], v[92:95], v[116:119]
    buffer_load_dwordx4 v10, s[24:27], s46 offen offset:128 lds
    s_add_u32 m0, m0, 3968
    v_mfma_f32_16x16x32_bf16 v[120:123], a[84:87], v[96:99], v[120:123]
    s_waitcnt lgkmcnt(2)
    s_add_u32 s45, s44, s56
    v_mfma_f32_16x16x32_bf16 v[108:111], a[8:11], v[100:103], v[108:111]
    ds_read_b128 v[92:95], v11 offset:8192
    s_add_u32 s37, s37, 1
    v_mfma_f32_16x16x32_bf16 v[112:115], a[8:11], v[104:107], v[112:115]
    ds_read_b128 v[96:99], v11 offset:10240
    s_mov_b32 s52, 0
    v_mfma_f32_16x16x32_bf16 v[116:119], a[88:91], v[100:103], v[116:119]
    buffer_load_dwordx4 v10, s[24:27], s46 offen offset:256 lds
    s_add_u32 m0, m0, 3968
    v_mfma_f32_16x16x32_bf16 v[120:123], a[88:91], v[104:107], v[120:123]
    s_waitcnt lgkmcnt(2)
    s_and_b32 s50, s37, 3
    v_mfma_f32_16x16x32_bf16 v[108:111], a[12:15], v[84:87], v[108:111]
    ds_read_b128 v[100:103], v12 offset:8192
    s_mul_i32 s51, s50, 114688
    v_mfma_f32_16x16x32_bf16 v[112:115], a[12:15], v[88:91], v[112:115]
    ds_read_b128 v[104:107], v12 offset:10240
    s_add_u32 s41, s38, s51
    v_mfma_f32_16x16x32_bf16 v[116:119], a[92:95], v[84:87], v[116:119]
    buffer_load_dwordx4 v10, s[24:27], s46 offen offset:384 lds
    s_add_u32 m0, m0, 3968
    v_mfma_f32_16x16x32_bf16 v[120:123], a[92:95], v[88:91], v[120:123]
    s_waitcnt lgkmcnt(2)
    v_mfma_f32_16x16x32_bf16 v[108:111], a[16:19], v[92:95], v[108:111]
    ds_read_b128 v[84:87], v11 offset:12288
    v_mfma_f32_16x16x32_bf16 v[112:115], a[16:19], v[96:99], v[112:115]
    ds_read_b128 v[88:91], v11 offset:14336
    v_mfma_f32_16x16x32_bf16 v[116:119], a[96:99], v[92:95], v[116:119]
    buffer_load_dwordx4 v10, s[24:27], s46 offen offset:512 lds
    s_add_u32 m0, m0, 3968
    v_mfma_f32_16x16x32_bf16 v[120:123], a[96:99], v[96:99], v[120:123]
    s_waitcnt lgkmcnt(2)
    v_mfma_f32_16x16x32_bf16 v[108:111], a[20:23], v[100:103], v[108:111]
    ds_read_b128 v[92:95], v12 offset:12288
    v_mfma_f32_16x16x32_bf16 v[112:115], a[20:23], v[104:107], v[112:115]
    ds_read_b128 v[96:99], v12 offset:14336
    v_mfma_f32_16x16x32_bf16 v[116:119], a[100:103], v[100:103], v[116:119]
    s_waitcnt vmcnt(5)
    buffer_store_dword v20, v136, s[4:7], s38 offen
    v_mfma_f32_16x16x32_bf16 v[120:123], a[100:103], v[104:107], v[120:123]
    s_waitcnt lgkmcnt(2)
    v_mfma_f32_16x16x32_bf16 v[108:111], a[24:27], v[84:87], v[108:111]
    ds_read_b128 v[100:103], v11 offset:16384
    v_mfma_f32_16x16x32_bf16 v[112:115], a[24:27], v[88:91], v[112:115]
    ds_read_b128 v[104:107], v11 offset:18432
    v_mfma_f32_16x16x32_bf16 v[116:119], a[104:107], v[84:87], v[116:119]
    buffer_load_dwordx4 v10, s[24:27], s46 offen offset:640 lds
    s_add_u32 m0, m0, 3968
    v_mfma_f32_16x16x32_bf16 v[120:123], a[104:107], v[88:91], v[120:123]
    s_waitcnt lgkmcnt(2)
    v_mfma_f32_16x16x32_bf16 v[108:111], a[28:31], v[92:95], v[108:111]
    ds_read_b128 v[84:87], v12 offset:16384
    v_mfma_f32_16x16x32_bf16 v[112:115], a[28:31], v[96:99], v[112:115]
    ds_read_b128 v[88:91], v12 offset:18432
    v_mfma_f32_16x16x32_bf16 v[116:119], a[108:111], v[92:95], v[116:119]
    buffer_load_dwordx4 v10, s[24:27], s46 offen offset:768 lds
    s_add_u32 m0, m0, 3968
    v_mfma_f32_16x16x32_bf16 v[120:123], a[108:111], v[96:99], v[120:123]
    s_waitcnt lgkmcnt(2)
    v_mfma_f32_16x16x32_bf16 v[108:111], a[32:35], v[100:103], v[108:111]
    ds_read_b128 v[92:95], v11 offset:20480
    v_mfma_f32_16x16x32_bf16 v[112:115], a[32:35], v[104:107], v[112:115]
    ds_read_b128 v[96:99], v11 offset:22528
    v_mfma_f32_16x16x32_bf16 v[116:119], a[112:115], v[100:103], v[116:119]
    buffer_load_dwordx4 v10, s[24:27], s46 offen offset:896 lds
    s_add_u32 m0, m0, 3968
    v_mfma_f32_16x16x32_bf16 v[120:123], a[112:115], v[104:107], v[120:123]
    s_waitcnt lgkmcnt(2)
    v_mfma_f32_16x16x32_bf16 v[108:111], a[36:39], v[84:87], v[108:111]
    ds_read_b128 v[100:103], v12 offset:20480
    v_mfma_f32_16x16x32_bf16 v[112:115], a[36:39], v[88:91], v[112:115]
    ds_read_b128 v[104:107], v12 offset:22528
    v_mfma_f32_16x16x32_bf16 v[116:119], a[116:119], v[84:87], v[116:119]
    buffer_load_dwordx4 v10, s[24:27], s46 offen offset:1024 lds
    s_add_u32 m0, m0, 3968
    v_mfma_f32_16x16x32_bf16 v[120:123], a[116:119], v[88:91], v[120:123]
    s_waitcnt lgkmcnt(2)
    v_mfma_f32_16x16x32_bf16 v[108:111], a[40:43], v[92:95], v[108:111]
    ds_read_b128 v[84:87], v11 offset:24576
    v_mfma_f32_16x16x32_bf16 v[112:115], a[40:43], v[96:99], v[112:115]
    ds_read_b128 v[88:91], v11 offset:26624
    v_mfma_f32_16x16x32_bf16 v[116:119], a[120:123], v[92:95], v[116:119]
    buffer_load_dwordx4 v10, s[24:27], s46 offen offset:1152 lds
    v_mfma_f32_16x16x32_bf16 v[120:123], a[120:123], v[96:99], v[120:123]
    s_waitcnt lgkmcnt(2)
    v_mfma_f32_16x16x32_bf16 v[108:111], a[44:47], v[100:103], v[108:111]
    ds_read_b128 v[92:95], v12 offset:24576
    v_mfma_f32_16x16x32_bf16 v[112:115], a[44:47], v[104:107], v[112:115]
    ds_read_b128 v[96:99], v12 offset:26624
    v_mfma_f32_16x16x32_bf16 v[116:119], a[124:127], v[100:103], v[116:119]
    v_mfma_f32_16x16x32_bf16 v[120:123], a[124:127], v[104:107], v[120:123]
    s_waitcnt lgkmcnt(2)
    v_mfma_f32_16x16x32_bf16 v[108:111], a[48:51], v[84:87], v[108:111]
    ds_read_b128 v[100:103], v11 offset:28672
    v_mfma_f32_16x16x32_bf16 v[112:115], a[48:51], v[88:91], v[112:115]
    ds_read_b128 v[104:107], v11 offset:30720
    v_mfma_f32_16x16x32_bf16 v[116:119], a[128:131], v[84:87], v[116:119]
    v_mfma_f32_16x16x32_bf16 v[120:123], a[128:131], v[88:91], v[120:123]
    s_waitcnt lgkmcnt(2)
    v_mfma_f32_16x16x32_bf16 v[108:111], a[52:55], v[92:95], v[108:111]
    ds_read_b128 v[84:87], v12 offset:28672
    v_mfma_f32_16x16x32_bf16 v[112:115], a[52:55], v[96:99], v[112:115]
    ds_read_b128 v[88:91], v12 offset:30720
    v_mfma_f32_16x16x32_bf16 v[116:119], a[132:135], v[92:95], v[116:119]
    v_mfma_f32_16x16x32_bf16 v[120:123], a[132:135], v[96:99], v[120:123]
    s_waitcnt lgkmcnt(2)
    v_mfma_f32_16x16x32_bf16 v[108:111], a[56:59], v[100:103], v[108:111]
    ds_read_b128 v[92:95], v11 offset:32768
    v_mfma_f32_16x16x32_bf16 v[112:115], a[56:59], v[104:107], v[112:115]
    ds_read_b128 v[96:99], v11 offset:34816
    v_mfma_f32_16x16x32_bf16 v[116:119], a[136:139], v[100:103], v[116:119]
    v_mfma_f32_16x16x32_bf16 v[120:123], a[136:139], v[104:107], v[120:123]
    s_waitcnt lgkmcnt(2)
    v_mfma_f32_16x16x32_bf16 v[108:111], a[60:63], v[84:87], v[108:111]
    ds_read_b128 v[100:103], v12 offset:32768
    v_mfma_f32_16x16x32_bf16 v[112:115], a[60:63], v[88:91], v[112:115]
    ds_read_b128 v[104:107], v12 offset:34816
    v_mfma_f32_16x16x32_bf16 v[116:119], a[140:143], v[84:87], v[116:119]
    v_mfma_f32_16x16x32_bf16 v[120:123], a[140:143], v[88:91], v[120:123]
    s_waitcnt lgkmcnt(2)
    v_mfma_f32_16x16x32_bf16 v[108:111], a[64:67], v[92:95], v[108:111]
    ds_read_b128 v[84:87], v11 offset:36864
    v_mfma_f32_16x16x32_bf16 v[112:115], a[64:67], v[96:99], v[112:115]
    ds_read_b128 v[88:91], v11 offset:38912
    v_mfma_f32_16x16x32_bf16 v[116:119], a[144:147], v[92:95], v[116:119]
    v_mfma_f32_16x16x32_bf16 v[120:123], a[144:147], v[96:99], v[120:123]
    s_waitcnt lgkmcnt(2)
    v_mfma_f32_16x16x32_bf16 v[108:111], a[68:71], v[100:103], v[108:111]
    ds_read_b128 v[92:95], v12 offset:36864
    v_mfma_f32_16x16x32_bf16 v[112:115], a[68:71], v[104:107], v[112:115]
    ds_read_b128 v[96:99], v12 offset:38912
    v_mfma_f32_16x16x32_bf16 v[116:119], a[148:151], v[100:103], v[116:119]
    v_mfma_f32_16x16x32_bf16 v[120:123], a[148:151], v[104:107], v[120:123]
    s_waitcnt lgkmcnt(0)
    v_mfma_f32_16x16x32_bf16 v[108:111], a[72:75], v[84:87], v[108:111]
    v_add_u32 v11, s49, v11
    v_mfma_f32_16x16x32_bf16 v[112:115], a[72:75], v[88:91], v[112:115]
    v_add_u32 v12, s49, v12
    v_mfma_f32_16x16x32_bf16 v[108:111], a[76:79], v[92:95], v[108:111]
    s_sub_u32 s47, s47, s49
    v_mfma_f32_16x16x32_bf16 v[112:115], a[76:79], v[96:99], v[112:115]
    s_sub_u32 s49, 0, s49
    v_mfma_f32_16x16x32_bf16 v[116:119], a[152:155], v[84:87], v[116:119]
    v_mfma_f32_16x16x32_bf16 v[120:123], a[152:155], v[88:91], v[120:123]
    v_mfma_f32_16x16x32_bf16 v[116:119], a[156:159], v[92:95], v[116:119]
    v_mfma_f32_16x16x32_bf16 v[120:123], a[156:159], v[96:99], v[120:123]
    v_cvt_pk_bf16_f32 v124, v108, v109
    v_cvt_pk_bf16_f32 v125, v110, v111
    v_cvt_pk_bf16_f32 v126, v112, v113
    v_cvt_pk_bf16_f32 v127, v114, v115
    s_nop 0
    v_permlane16_swap_b32 v124, v126
    v_permlane16_swap_b32 v125, v127
    v_cvt_pk_bf16_f32 v128, v116, v117
    v_cvt_pk_bf16_f32 v129, v118, v119
    v_cvt_pk_bf16_f32 v130, v120, v121
    v_cvt_pk_bf16_f32 v131, v122, v123
    s_nop 0
    v_permlane16_swap_b32 v128, v130
    v_permlane16_swap_b32 v129, v131
    buffer_store_dwordx4 v[124:127], v19, s[4:7], s44 offen
    buffer_store_dwordx4 v[128:131], v19, s[4:7], s45 offen
    s_add_u32 s50, s37, 2
    s_and_b32 s50, s50, 3
    s_mul_i32 s50, s50, 114688
    s_add_u32 s42, s38, s50
    s_add_u32 s50, s37, 4
    s_min_u32 s50, s50, 63
    s_mul_i32 s46, s50, 40960
    s_add_u32 s51, s37, 1
    v_mov_b32 v20, s51
    s_mov_b32 m0, s48
    v_mov_b32 v68, 0
    v_mov_b32 v69, 0
    v_mov_b32 v70, 0
    v_mov_b32 v71, 0
    v_mov_b32 v72, 0
    v_mov_b32 v73, 0
    v_mov_b32 v74, 0
    v_mov_b32 v75, 0
    s_add_u32 s50, s37, 6
    s_min_u32 s50, s50, 63
    s_mul_i32 s57, s50, 40960
    s_and_b32 s50, s37, 3
    s_mul_i32 s51, s50, 40960
    s_add_u32 s43, s51, s38
    s_mul_i32 s51, s50, 327680
    s_add_u32 s53, s51, 4194304
    s_xor_b32 s50, s50, 2
    s_mul_i32 s51, s50, 327680
    s_add_u32 s54, s51, 4194304
    s_sub_u32 s51, s37, 6
    s_mul_i32 s60, s51, 81920
    s_branch L_v_first_f
L_v_loop_f:
    s_add_u32 s50, s37, 2
    s_and_b32 s50, s50, 3
    s_mul_i32 s50, s50, 114688
    s_add_u32 s42, s38, s50
    s_add_u32 s50, s37, 4
    s_min_u32 s50, s50, 63
    s_mul_i32 s46, s50, 40960
    s_add_u32 s51, s37, 1
    v_mov_b32 v20, s51
    s_mov_b32 m0, s48
    v_mov_b32 v68, 0
    v_mov_b32 v69, 0
    v_mov_b32 v70, 0
    v_mov_b32 v71, 0
    v_mov_b32 v72, 0
    v_mov_b32 v73, 0
    v_mov_b32 v74, 0
    v_mov_b32 v75, 0
    s_add_u32 s50, s37, 6
    s_min_u32 s50, s50, 63
    s_mul_i32 s57, s50, 40960
    s_and_b32 s50, s37, 3
    s_mul_i32 s51, s50, 40960
    s_add_u32 s43, s51, s38
    s_mul_i32 s51, s50, 327680
    s_add_u32 s53, s51, 4194304
    s_xor_b32 s50, s50, 2
    s_mul_i32 s51, s50, 327680
    s_add_u32 s54, s51, 4194304
    s_sub_u32 s51, s37, 6
    s_mul_i32 s60, s51, 81920
L_vg_19:
    buffer_load_dword v139, v138, s[4:7], s38 offen sc1
    s_sub_u32 s36, s36, 1
    s_cbranch_scc1 L_exit
    s_waitcnt vmcnt(0)
    v_cmp_gt_u32 vcc, s37, v139
    s_cbranch_vccnz L_vg_19
L_v_first_f:
    buffer_load_dwordx4 v13, s[4:7], s41 offen sc1 lds
    buffer_load_dwordx4 v13, s[4:7], s41 offen offset:1024 sc1 lds
    buffer_load_dword v14, s[4:7], s41 offen offset:2048 sc1 lds
    buffer_load_dword v14, s[4:7], s41 offen offset:2304 sc1 lds
L_poll_21:
    buffer_load_dwordx4 v13, s[4:7], s41 offen sc1 lds
    buffer_load_dwordx4 v13, s[4:7], s41 offen offset:1024 sc1 lds
    buffer_load_dword v14, s[4:7], s41 offen offset:2048 sc1 lds
    buffer_load_dword v14, s[4:7], s41 offen offset:2304 sc1 lds
    s_sub_u32 s36, s36, 1
    s_cbranch_scc1 L_exit
    s_waitcnt vmcnt(4)
    ds_read_b32 v18, v15
    s_waitcnt lgkmcnt(0)
    v_cmp_eq_u32 vcc, -1, v18
    s_cbranch_vccnz L_poll_21
    s_barrier
    ds_read_b128 v[28:31], v16 offset:0
    ds_read_b128 v[32:35], v16 offset:1024
    ds_read_b128 v[36:39], v16 offset:2048
    ds_read_b128 v[40:43], v16 offset:3072
    s_waitcnt lgkmcnt(3)
    v_smfmac_f32_16x16x64_bf16 v[68:71], v[28:31], a[0:7], v17
    ds_read_b128 v[44:47], v16 offset:4096
    v_smfmac_f32_16x16x64_bf16 v[72:75], v[28:31], a[80:87], v17
    ds_read_b128 v[48:51], v16 offset:5120
    s_waitcnt lgkmcnt(4)
    v_smfmac_f32_16x16x64_bf16 v[68:71], v[32:35], a[8:15], v17
    ds_read_b128 v[52:55], v16 offset:6144
    v_smfmac_f32_16x16x64_bf16 v[72:75], v[32:35], a[88:95], v17
    ds_read_b128 v[56:59], v16 offset:7168
    s_waitcnt lgkmcnt(5)
    v_smfmac_f32_16x16x64_bf16 v[68:71], v[36:39], a[16:23], v17
    ds_read_b128 v[60:63], v16 offset:8192
    v_smfmac_f32_16x16x64_bf16 v[72:75], v[36:39], a[96:103], v17
    ds_read_b128 v[64:67], v16 offset:9216
    s_waitcnt lgkmcnt(6)
    v_smfmac_f32_16x16x64_bf16 v[68:71], v[40:43], a[24:31], v17
    v_smfmac_f32_16x16x64_bf16 v[72:75], v[40:43], a[104:111], v17
    s_waitcnt lgkmcnt(5)
    v_smfmac_f32_16x16x64_bf16 v[68:71], v[44:47], a[32:39], v17
    v_smfmac_f32_16x16x64_bf16 v[72:75], v[44:47], a[112:119], v17
    s_waitcnt lgkmcnt(4)
    v_smfmac_f32_16x16x64_bf16 v[68:71], v[48:51], a[40:47], v17
    s_waitcnt lgkmcnt(3)
    v_smfmac_f32_16x16x64_bf16 v[68:71], v[52:55], a[48:55], v17
    s_waitcnt lgkmcnt(2)
    v_smfmac_f32_16x16x64_bf16 v[68:71], v[56:59], a[56:63], v17
    s_waitcnt lgkmcnt(1)
    v_smfmac_f32_16x16x64_bf16 v[68:71], v[60:63], a[64:71], v17
    s_waitcnt lgkmcnt(0)
    v_smfmac_f32_16x16x64_bf16 v[68:71], v[64:67], a[72:79], v17
L_redo_20:
    v_smfmac_f32_16x16x64_bf16 v[72:75], v[48:51], a[120:127], v17
    v_smfmac_f32_16x16x64_bf16 v[72:75], v[52:55], a[128:135], v17
    buffer_store_dword v20, v21, s[4:7], s38 offen offset:0
    v_smfmac_f32_16x16x64_bf16 v[72:75], v[56:59], a[136:143], v17
    v_add_f32 v68, v68, v70
    v_add_f32 v69, v69, v71
    v_smfmac_f32_16x16x64_bf16 v[72:75], v[60:63], a[144:151], v17
    v_cmp_u_f32 vcc, v68, v69
    v_cvt_pk_bf16_f32 v132, v68, v69
    v_smfmac_f32_16x16x64_bf16 v[72:75], v[64:67], a[152:159], v17
    s_cbranch_vccnz L_nan_22
L_cont_23:
    buffer_store_dword v132, v134, s[4:7], s41 offen offset:0
    s_nop 5
    v_pk_add_f32 v[72:73], v[72:73], v[74:75]
    v_cvt_pk_bf16_f32 v133, v72, v73
    buffer_store_dword v133, v134, s[4:7], s41 offen offset:1024
    ds_read_b128 v[84:87], v11 offset:0
    ds_read_b128 v[88:91], v11 offset:2048
    ds_read_b128 v[92:95], v12 offset:0
    ds_read_b128 v[96:99], v12 offset:2048
    s_cmp_eq_u32 s37, 63
    s_cbranch_scc1 L_end_24
    s_cmp_eq_u32 s37, 0
    s_cbranch_scc1 L_sd_25c
L_sd_25:
    s_cmp_eq_u32 s40, 0
    s_cbranch_scc1 L_an_26
    s_barrier
    s_lshl_b32 s90, s32, 10
    s_add_u32 m0, s90, s47
    s_waitcnt lgkmcnt(2)
    v_mfma_f32_16x16x32_bf16 v[108:111], a[0:3], v[84:87], 0
    ds_read_b128 v[100:103], v11 offset:4096
    s_add_u32 s51, s37, 3
    v_mfma_f32_16x16x32_bf16 v[112:115], a[0:3], v[88:91], 0
    ds_read_b128 v[104:107], v11 offset:6144
    s_and_b32 s50, s51, 3
    v_mfma_f32_16x16x32_bf16 v[116:119], a[80:83], v[84:87], 0
    buffer_load_dwordx4 v[148:151], v146, s[4:7], s43 offen offset:0 sc1
    buffer_load_dwordx4 v[152:155], v146, s[4:7], s43 offen offset:1024 sc1
    v_mfma_f32_16x16x32_bf16 v[120:123], a[80:83], v[88:91], 0
    s_waitcnt lgkmcnt(2)
    s_mul_i32 s50, s50, 114688
    v_mfma_f32_16x16x32_bf16 v[108:111], a[4:7], v[92:95], v[108:111]
    ds_read_b128 v[84:87], v12 offset:4096
    s_add_u32 s50, s50, 65536
    v_mfma_f32_16x16x32_bf16 v[112:115], a[4:7], v[96:99], v[112:115]
    ds_read_b128 v[88:91], v12 offset:6144
    s_add_u32 s44, s38, s50
    v_mfma_f32_16x16x32_bf16 v[116:119], a[84:87], v[92:95], v[116:119]
    s_cmp_lt_i32 s60, 0
    s_cselect_b32 s54, s38, s54
    buffer_load_dwordx4 v[156:159], v144, s[4:7], s54 offen offset:0 sc1
    buffer_load_dwordx4 v[160:163], v144, s[4:7], s54 offen offset:1024 sc1
    v_mfma_f32_16x16x32_bf16 v[120:123], a[84:87], v[96:99], v[120:123]
    s_waitcnt lgkmcnt(2)
    s_add_u32 s45, s44, s56
    v_mfma_f32_16x16x32_bf16 v[108:111], a[8:11], v[100:103], v[108:111]
    ds_read_b128 v[92:95], v11 offset:8192
    s_add_u32 s37, s37, 1
    v_mfma_f32_16x16x32_bf16 v[112:115], a[8:11], v[104:107], v[112:115]
    ds_read_b128 v[96:99], v11 offset:10240
    s_mov_b32 s52, 0
    v_mfma_f32_16x16x32_bf16 v[116:119], a[88:91], v[100:103], v[116:119]
    s_and_b32 s50, s37, 3
    s_mul_i32 s51, s50, 114688
    v_mfma_f32_16x16x32_bf16 v[120:123], a[88:91], v[104:107], v[120:123]
    s_waitcnt lgkmcnt(2)
    s_add_u32 s41, s38, s51
    v_mfma_f32_16x16x32_bf16 v[108:111], a[12:15], v[84:87], v[108:111]
    ds_read_b128 v[100:103], v12 offset:8192
    v_mfma_f32_16x16x32_bf16 v[112:115], a[12:15], v[88:91], v[112:115]
    ds_read_b128 v[104:107], v12 offset:10240
    v_mfma_f32_16x16x32_bf16 v[116:119], a[92:95], v[84:87], v[116:119]
    buffer_load_dwordx4 v[248:251], v137, s[24:27], s57 offen offset:0
    buffer_load_dwordx4 v[248:251], v137, s[24:27], s57 offen offset:1024
    v_mfma_f32_16x16x32_bf16 v[120:123], a[92:95], v[88:91], v[120:123]
    s_waitcnt lgkmcnt(2)
    v_mfma_f32_16x16x32_bf16 v[108:111], a[16:19], v[92:95], v[108:111]
    ds_read_b128 v[84:87], v11 offset:12288
    v_mfma_f32_16x16x32_bf16 v[112:115], a[16:19], v[96:99], v[112:115]
    ds_read_b128 v[88:91], v11 offset:14336
    v_mfma_f32_16x16x32_bf16 v[116:119], a[96:99], v[92:95], v[116:119]
    v_mfma_f32_16x16x32_bf16 v[120:123], a[96:99], v[96:99], v[120:123]
    s_waitcnt lgkmcnt(2)
    v_mfma_f32_16x16x32_bf16 v[108:111], a[20:23], v[100:103], v[108:111]
    ds_read_b128 v[92:95], v12 offset:12288
    v_mfma_f32_16x16x32_bf16 v[112:115], a[20:23], v[104:107], v[112:115]
    ds_read_b128 v[96:99], v12 offset:14336
    v_mfma_f32_16x16x32_bf16 v[116:119], a[100:103], v[100:103], v[116:119]
    s_waitcnt vmcnt(4)
    s_cmp_lt_i32 s60, -245760
    s_cbranch_scc1 L_fw_27c
L_fw_27:
    buffer_store_dwordx4 v[148:151], v143, s[4:7], s53 offen offset:0 sc1
    buffer_store_dwordx4 v[152:155], v143, s[4:7], s53 offen offset:1024 sc1
    v_mfma_f32_16x16x32_bf16 v[120:123], a[100:103], v[104:107], v[120:123]
    s_waitcnt lgkmcnt(2)
    v_mfma_f32_16x16x32_bf16 v[108:111], a[24:27], v[84:87], v[108:111]
    ds_read_b128 v[100:103], v11 offset:16384
    v_mfma_f32_16x16x32_bf16 v[112:115], a[24:27], v[88:91], v[112:115]
    ds_read_b128 v[104:107], v11 offset:18432
    v_mfma_f32_16x16x32_bf16 v[116:119], a[104:107], v[84:87], v[116:119]
    v_mfma_f32_16x16x32_bf16 v[120:123], a[104:107], v[88:91], v[120:123]
    s_waitcnt lgkmcnt(2)
    v_mfma_f32_16x16x32_bf16 v[108:111], a[28:31], v[92:95], v[108:111]
    ds_read_b128 v[84:87], v12 offset:16384
    v_mfma_f32_16x16x32_bf16 v[112:115], a[28:31], v[96:99], v[112:115]
    ds_read_b128 v[88:91], v12 offset:18432
    v_mfma_f32_16x16x32_bf16 v[116:119], a[108:111], v[92:95], v[116:119]
    buffer_store_dword v22, v135, s[4:7], s42 offen offset:0
    buffer_store_dword v22, v135, s[4:7], s42 offen offset:1024
    v_mfma_f32_16x16x32_bf16 v[120:123], a[108:111], v[96:99], v[120:123]
    s_waitcnt lgkmcnt(2)
    v_mfma_f32_16x16x32_bf16 v[108:111], a[32:35], v[100:103], v[108:111]
    ds_read_b128 v[92:95], v11 offset:20480
    v_mfma_f32_16x16x32_bf16 v[112:115], a[32:35], v[104:107], v[112:115]
    ds_read_b128 v[96:99], v11 offset:22528
    v_mfma_f32_16x16x32_bf16 v[116:119], a[112:115], v[100:103], v[116:119]
    buffer_load_dwordx4 v10, s[24:27], s46 offen offset:0 lds
    s_add_u32 m0, m0, 3968
    v_mfma_f32_16x16x32_bf16 v[120:123], a[112:115], v[104:107], v[120:123]
    s_waitcnt lgkmcnt(2)
    v_mfma_f32_16x16x32_bf16 v[108:111], a[36:39], v[84:87], v[108:111]
    ds_read_b128 v[100:103], v12 offset:20480
    v_mfma_f32_16x16x32_bf16 v[112:115], a[36:39], v[88:91], v[112:115]
    ds_read_b128 v[104:107], v12 offset:22528
    v_mfma_f32_16x16x32_bf16 v[116:119], a[116:119], v[84:87], v[116:119]
    buffer_load_dwordx4 v10, s[24:27], s46 offen offset:128 lds
    s_add_u32 m0, m0, 3968
    v_mfma_f32_16x16x32_bf16 v[120:123], a[116:119], v[88:91], v[120:123]
    s_waitcnt lgkmcnt(2)
    v_mfma_f32_16x16x32_bf16 v[108:111], a[40:43], v[92:95], v[108:111]
    ds_read_b128 v[84:87], v11 offset:24576
    v_mfma_f32_16x16x32_bf16 v[112:115], a[40:43], v[96:99], v[112:115]
    ds_read_b128 v[88:91], v11 offset:26624
    v_mfma_f32_16x16x32_bf16 v[116:119], a[120:123], v[92:95], v[116:119]
    buffer_load_dwordx4 v10, s[24:27], s46 offen offset:256 lds
    s_add_u32 m0, m0, 3968
    v_mfma_f32_16x16x32_bf16 v[120:123], a[120:123], v[96:99], v[120:123]
    s_waitcnt lgkmcnt(2)
    v_mfma_f32_16x16x32_bf16 v[108:111], a[44:47], v[100:103], v[108:111]
    ds_read_b128 v[92:95], v12 offset:24576
    v_mfma_f32_16x16x32_bf16 v[112:115], a[44:47], v[104:107], v[112:115]
    ds_read_b128 v[96:99], v12 offset:26624
    v_mfma_f32_16x16x32_bf16 v[116:119], a[124:127], v[100:103], v[116:119]
    buffer_load_dwordx4 v10, s[24:27], s46 offen offset:384 lds
    s_add_u32 m0, m0, 3968
    v_mfma_f32_16x16x32_bf16 v[120:123], a[124:127], v[104:107], v[120:123]
    s_waitcnt lgkmcnt(2)
    v_mfma_f32_16x16x32_bf16 v[108:111], a[48:51], v[84:87], v[108:111]
    ds_read_b128 v[100:103], v11 offset:28672
    v_mfma_f32_16x16x32_bf16 v[112:115], a[48:51], v[88:91], v[112:115]
    ds_read_b128 v[104:107], v11 offset:30720
    v_mfma_f32_16x16x32_bf16 v[116:119], a[128:131], v[84:87], v[116:119]
    buffer_load_dwordx4 v10, s[24:27], s46 offen offset:512 lds
    s_add_u32 m0, m0, 3968
    v_mfma_f32_16x16x32_bf16 v[120:123], a[128:131], v[88:91], v[120:123]
    s_waitcnt lgkmcnt(2)
    v_mfma_f32_16x16x32_bf16 v[108:111], a[52:55], v[92:95], v[108:111]
    ds_read_b128 v[84:87], v12 offset:28672
    v_mfma_f32_16x16x32_bf16 v[112:115], a[52:55], v[96:99], v[112:115]
    ds_read_b128 v[88:91], v12 offset:30720
    v_mfma_f32_16x16x32_bf16 v[116:119], a[132:135], v[92:95], v[116:119]
    buffer_load_dwordx4 v10, s[24:27], s46 offen offset:640 lds
    s_add_u32 m0, m0, 3968
    v_mfma_f32_16x16x32_bf16 v[120:123], a[132:135], v[96:99], v[120:123]
    s_waitcnt lgkmcnt(2)
    v_mfma_f32_16x16x32_bf16 v[108:111], a[56:59], v[100:103], v[108:111]
    ds_read_b128 v[92:95], v11 offset:32768
    v_mfma_f32_16x16x32_bf16 v[112:115], a[56:59], v[104:107], v[112:115]
    ds_read_b128 v[96:99], v11 offset:34816
    v_mfma_f32_16x16x32_bf16 v[116:119], a[136:139], v[100:103], v[116:119]
    buffer_load_dwordx4 v10, s[24:27], s46 offen offset:768 lds
    s_add_u32 m0, m0, 3968
    v_mfma_f32_16x16x32_bf16 v[120:123], a[136:139], v[104:107], v[120:123]
    s_waitcnt lgkmcnt(2)
    v_mfma_f32_16x16x32_bf16 v[108:111], a[60:63], v[84:87], v[108:111]
    ds_read_b128 v[100:103], v12 offset:32768
    v_mfma_f32_16x16x32_bf16 v[112:115], a[60:63], v[88:91], v[112:115]
    ds_read_b128 v[104:107], v12 offset:34816
    v_mfma_f32_16x16x32_bf16 v[116:119], a[140:143], v[84:87], v[116:119]
    buffer_load_dwordx4 v10, s[24:27], s46 offen offset:896 lds
    s_add_u32 m0, m0, 3968
    v_mfma_f32_16x16x32_bf16 v[120:123], a[140:143], v[88:91], v[120:123]
    s_waitcnt lgkmcnt(2)
    v_mfma_f32_16x16x32_bf16 v[108:111], a[64:67], v[92:95], v[108:111]
    ds_read_b128 v[84:87], v11 offset:36864
    v_mfma_f32_16x16x32_bf16 v[112:115], a[64:67], v[96:99], v[112:115]
    ds_read_b128 v[88:91], v11 offset:38912
    v_mfma_f32_16x16x32_bf16 v[116:119], a[144:147], v[92:95], v[116:119]
    buffer_load_dwordx4 v10, s[24:27], s46 offen offset:1024 lds
    s_add_u32 m0, m0, 3968
    v_mfma_f32_16x16x32_bf16 v[120:123], a[144:147], v[96:99], v[120:123]
    s_waitcnt lgkmcnt(2)
    v_mfma_f32_16x16x32_bf16 v[108:111], a[68:71], v[100:103], v[108:111]
    ds_read_b128 v[92:95], v12 offset:36864
    v_mfma_f32_16x16x32_bf16 v[112:115], a[68:71], v[104:107], v[112:115]
    ds_read_b128 v[96:99], v12 offset:38912
    v_mfma_f32_16x16x32_bf16 v[116:119], a[148:151], v[100:103], v[116:119]
    buffer_load_dwordx4 v10, s[24:27], s46 offen offset:1152 lds
    v_mfma_f32_16x16x32_bf16 v[120:123], a[148:151], v[104:107], v[120:123]
    s_waitcnt lgkmcnt(0)
    v_mfma_f32_16x16x32_bf16 v[108:111], a[72:75], v[84:87], v[108:111]
    v_add_u32 v11, s49, v11
    v_mfma_f32_16x16x32_bf16 v[112:115], a[72:75], v[88:91], v[112:115]
    v_add_u32 v12, s49, v12
    v_mfma_f32_16x16x32_bf16 v[108:111], a[76:79], v[92:95], v[108:111]
    s_sub_u32 s47, s47, s49
    v_mfma_f32_16x16x32_bf16 v[112:115], a[76:79], v[96:99], v[112:115]
    s_sub_u32 s49, 0, s49
    v_mfma_f32_16x16x32_bf16 v[116:119], a[152:155], v[84:87], v[116:119]
    v_mfma_f32_16x16x32_bf16 v[120:123], a[152:155], v[88:91], v[120:123]
    v_mfma_f32_16x16x32_bf16 v[116:119], a[156:159], v[92:95], v[116:119]
    v_mfma_f32_16x16x32_bf16 v[120:123], a[156:159], v[96:99], v[120:123]
    v_cvt_pk_bf16_f32 v124, v108, v109
    v_cvt_pk_bf16_f32 v125, v110, v111
    v_cvt_pk_bf16_f32 v126, v112, v113
    v_cvt_pk_bf16_f32 v127, v114, v115
    s_nop 0
    v_permlane16_swap_b32 v124, v126
    v_permlane16_swap_b32 v125, v127
    v_cvt_pk_bf16_f32 v128, v116, v117
    v_cvt_pk_bf16_f32 v129, v118, v119
    v_cvt_pk_bf16_f32 v130, v120, v121
    v_cvt_pk_bf16_f32 v131, v122, v123
    s_nop 0
    v_permlane16_swap_b32 v128, v130
    v_permlane16_swap_b32 v129, v131
    buffer_store_dwordx4 v[124:127], v19, s[4:7], s44 offen
    buffer_store_dwordx4 v[128:131], v19, s[4:7], s45 offen
    s_waitcnt vmcnt(18)
    s_cmp_lt_i32 s60, 0
    s_cbranch_scc1 L_fin_28
    v_mfma_f32_16x16x32_bf16 v[164:167], a[160:163], v[156:159], 0
    v_mfma_f32_16x16x32_bf16 v[168:171], a[160:163], v[160:163], 0
    s_nop 4
    v_cndmask_b32 v166, v164, v165, s[58:59]
    s_nop 1
    v_cndmask_b32 v170, v168, v169, s[58:59]
    v_cndmask_b32 v167, v165, v164, s[58:59]
    v_cndmask_b32 v171, v169, v168, s[58:59]
    s_nop 0
    v_add_f32_dpp v167, v166, v167 row_ror:8 row_mask:0xf bank_mask:0xf
    v_add_f32_dpp v171, v170, v171 row_ror:8 row_mask:0xf bank_mask:0xf
    v_cvt_pk_bf16_f32 v167, v167, v167
    v_cvt_pk_bf16_f32 v171, v171, v171
    buffer_store_short v167, v145, s[28:31], s60 offen offset:0
    buffer_store_short v171, v145, s[28:31], s60 offen offset:32
L_fin_28:
    s_branch L_v_loop_f
L_end_24:
    s_cmp_lt_i32 s60, 0
    s_cselect_b32 s54, s38, s54
    buffer_load_dwordx4 v[156:159], v144, s[4:7], s54 offen offset:0 sc1
    buffer_load_dwordx4 v[160:163], v144, s[4:7], s54 offen offset:1024 sc1
    s_waitcnt vmcnt(0) lgkmcnt(0)
    s_cmp_lt_i32 s60, 0
    s_cbranch_scc1 L_fin_29
    v_mfma_f32_16x16x32_bf16 v[164:167], a[160:163], v[156:159], 0
    v_mfma_f32_16x16x32_bf16 v[168:171], a[160:163], v[160:163], 0
    s_nop 4
    v_cndmask_b32 v166, v164, v165, s[58:59]
    s_nop 1
    v_cndmask_b32 v170, v168, v169, s[58:59]
    v_cndmask_b32 v167, v165, v164, s[58:59]
    v_cndmask_b32 v171, v169, v168, s[58:59]
    s_nop 0
    v_add_f32_dpp v167, v166, v167 row_ror:8 row_mask:0xf bank_mask:0xf
    v_add_f32_dpp v171, v170, v171 row_ror:8 row_mask:0xf bank_mask:0xf
    v_cvt_pk_bf16_f32 v167, v167, v167
    v_cvt_pk_bf16_f32 v171, v171, v171
    buffer_store_short v167, v145, s[28:31], s60 offen offset:0
    buffer_store_short v171, v145, s[28:31], s60 offen offset:32
L_fin_29:
    s_waitcnt vmcnt(0)
    s_cmp_lg_u32 s55, 0
    s_cbranch_scc1 L_wb_30
    buffer_wbl2 sc1
    s_waitcnt vmcnt(0)
L_wb_30:
    s_endpgm
L_nan_22:
    s_cmp_eq_u32 s52, 1
    s_cbranch_scc1 L_cont_23
    v_lshlrev_b32 v1, 4, v0
L_nan_22r:
    s_mov_b32 s90, s41
    v_mov_b32 v2, 0
    buffer_load_dwordx4 v[28:31], v1, s[4:7], s90 offen sc1
    s_add_u32 s90, s90, 1024
    buffer_load_dwordx4 v[32:35], v1, s[4:7], s90 offen sc1
    s_add_u32 s90, s90, 1024
    buffer_load_dwordx4 v[36:39], v1, s[4:7], s90 offen sc1
    s_add_u32 s90, s90, 1024
    buffer_load_dwordx4 v[40:43], v1, s[4:7], s90 offen sc1
    s_add_u32 s90, s90, 1024
    buffer_load_dwordx4 v[44:47], v1, s[4:7], s90 offen sc1
    s_add_u32 s90, s90, 1024
    buffer_load_dwordx4 v[48:51], v1, s[4:7], s90 offen sc1
    s_add_u32 s90, s90, 1024
    buffer_load_dwordx4 v[52:55], v1, s[4:7], s90 offen sc1
    s_add_u32 s90, s90, 1024
    buffer_load_dwordx4 v[56:59], v1, s[4:7], s90 offen sc1
    s_add_u32 s90, s90, 1024
    buffer_load_dwordx4 v[60:63], v1, s[4:7], s90 offen sc1
    s_add_u32 s90, s90, 1024
    buffer_load_dwordx4 v[64:67], v1, s[4:7], s90 offen sc1
    s_add_u32 s90, s90, 1024
    s_sub_u32 s36, s36, 1
    s_cbranch_scc1 L_exit
    s_waitcnt vmcnt(0) lgkmcnt(0)
    v_max3_u32 v2, v2, v28, v29
    v_max3_u32 v2, v2, v30, v31
    v_max3_u32 v2, v2, v32, v33
    v_max3_u32 v2, v2, v34, v35
    v_max3_u32 v2, v2, v36, v37
    v_max3_u32 v2, v2, v38, v39
    v_max3_u32 v2, v2, v40, v41
    v_max3_u32 v2, v2, v42, v43
    v_max3_u32 v2, v2, v44, v45
    v_max3_u32 v2, v2, v46, v47
    v_max3_u32 v2, v2, v48, v49
    v_max3_u32 v2, v2, v50, v51
    v_max3_u32 v2, v2, v52, v53
    v_max3_u32 v2, v2, v54, v55
    v_max3_u32 v2, v2, v56, v57
    v_max3_u32 v2, v2, v58, v59
    v_max3_u32 v2, v2, v60, v61
    v_max3_u32 v2, v2, v62, v63
    v_max3_u32 v2, v2, v64, v65
    v_max3_u32 v2, v2, v66, v67
    v_cmp_eq_u32 vcc, -1, v2
    s_cbranch_vccnz L_nan_22r
    s_mov_b32 s52, 1
    v_mov_b32 v68, 0
    v_mov_b32 v69, 0
    v_mov_b32 v70, 0
    v_mov_b32 v71, 0
    v_mov_b32 v72, 0
    v_mov_b32 v73, 0
    v_mov_b32 v74, 0
    v_mov_b32 v75, 0
    v_smfmac_f32_16x16x64_bf16 v[68:71], v[28:31], a[0:7], v17
    s_nop 0
    v_smfmac_f32_16x16x64_bf16 v[72:75], v[28:31], a[80:87], v17
    v_smfmac_f32_16x16x64_bf16 v[68:71], v[32:35], a[8:15], v17
    v_smfmac_f32_16x16x64_bf16 v[72:75], v[32:35], a[88:95], v17
    v_smfmac_f32_16x16x64_bf16 v[68:71], v[36:39], a[16:23], v17
    v_smfmac_f32_16x16x64_bf16 v[72:75], v[36:39], a[96:103], v17
    v_smfmac_f32_16x16x64_bf16 v[68:71], v[40:43], a[24:31], v17
    v_smfmac_f32_16x16x64_bf16 v[72:75], v[40:43], a[104:111], v17
    v_smfmac_f32_16x16x64_bf16 v[68:71], v[44:47], a[32:39], v17
    v_smfmac_f32_16x16x64_bf16 v[72:75], v[44:47], a[112:119], v17
    v_smfmac_f32_16x16x64_bf16 v[68:71], v[48:51], a[40:47], v17
    v_smfmac_f32_16x16x64_bf16 v[68:71], v[52:55], a[48:55], v17
    v_smfmac_f32_16x16x64_bf16 v[68:71], v[56:59], a[56:63], v17
    v_smfmac_f32_16x16x64_bf16 v[68:71], v[60:63], a[64:71], v17
    v_smfmac_f32_16x16x64_bf16 v[68:71], v[64:67], a[72:79], v17
    s_nop 2
    s_branch L_redo_20
L_sd_25c:
    v_mov_b32 v3, 200
L_p0_31:
    buffer_load_dword v4, v3, s[8:11], 0 offen sc1
    s_sub_u32 s36, s36, 1
    s_cbranch_scc1 L_exit
    s_waitcnt vmcnt(0)
    v_readfirstlane_b32 s90, v4
    s_nop 0
    s_cmp_eq_u32 s90, 0
    s_cbranch_scc1 L_p0_31
    s_and_b32 s90, s90, 2
    s_lshl_b32 s90, s90, 12
    v_xor_b32 v140, s90, v140
    v_xor_b32 v141, s90, v141
    v_xor_b32 v143, s90, v143
    v_xor_b32 v144, s90, v144
    s_branch L_sd_25
L_an_26:
    s_cmp_lg_u32 s55, 0
    s_cbranch_scc1 L_an_26x
    buffer_load_dword v139, v142, s[4:7], s38 offen sc1
    buffer_load_dword v139, v142, s[4:7], s38 offen sc1
    buffer_load_dword v139, v142, s[4:7], s38 offen sc1
    buffer_load_dword v139, v142, s[4:7], s38 offen sc1
    buffer_load_dword v139, v142, s[4:7], s38 offen sc1
    buffer_load_dword v139, v142, s[4:7], s38 offen sc1
L_sp_32:
    s_waitcnt vmcnt(5)
    v_cmp_ge_u32 vcc, s37, v139
    buffer_load_dword v139, v142, s[4:7], s38 offen sc1
    s_sub_u32 s36, s36, 1
    s_cbranch_scc1 L_exit
    s_cbranch_vccz L_sp_32x
    s_waitcnt vmcnt(5)
    v_cmp_ge_u32 vcc, s37, v139
    buffer_load_dword v139, v142, s[4:7], s38 offen sc1
    s_cbranch_vccz L_sp_32x
    s_waitcnt vmcnt(5)
    v_cmp_ge_u32 vcc, s37, v139
    buffer_load_dword v139, v142, s[4:7], s38 offen sc1
    s_cbranch_vccz L_sp_32x
    s_waitcnt vmcnt(5)
    v_cmp_ge_u32 vcc, s37, v139
    buffer_load_dword v139, v142, s[4:7], s38 offen sc1
    s_cbranch_vccnz L_sp_32
L_sp_32x:
L_an_26x:
    s_barrier
    s_lshl_b32 s90, s32, 10
    s_add_u32 m0, s90, s47
    s_waitcnt lgkmcnt(2)
    v_mfma_f32_16x16x32_bf16 v[108:111], a[0:3], v[84:87], 0
    ds_read_b128 v[100:103], v11 offset:4096
    s_add_u32 s51, s37, 3
    v_mfma_f32_16x16x32_bf16 v[112:115], a[0:3], v[88:91], 0
    ds_read_b128 v[104:107], v11 offset:6144
    s_and_b32 s50, s51, 3
    v_mfma_f32_16x16x32_bf16 v[116:119], a[80:83], v[84:87], 0
    buffer_store_dword v22, v135, s[4:7], s42 offen offset:0
    buffer_store_dword v22, v135, s[4:7], s42 offen offset:1024
    v_mfma_f32_16x16x32_bf16 v[120:123], a[80:83], v[88:91], 0
    s_waitcnt lgkmcnt(2)
    s_mul_i32 s50, s50, 114688
    v_mfma_f32_16x16x32_bf16 v[108:111], a[4:7], v[92:95], v[108:111]
    ds_read_b128 v[84:87], v12 offset:4096
    s_add_u32 s50, s50, 65536
    v_mfma_f32_16x16x32_bf16 v[112:115], a[4:7], v[96:99], v[112:115]
    ds_read_b128 v[88:91], v12 offset:6144
    s_add_u32 s44, s38, s50
    v_mfma_f32_16x16x32_bf16 v[116:119], a[84:87], v[92:95], v[116:119]
    buffer_load_dwordx4 v10, s[24:27], s46 offen offset:0 lds
    s_add_u32 m0, m0, 3968
    v_mfma_f32_16x16x32_bf16 v[120:123], a[84:87], v[96:99], v[120:123]
    s_waitcnt lgkmcnt(2)
    s_add_u32 s45, s44, s56
    v_mfma_f32_16x16x32_bf16 v[108:111], a[8:11], v[100:103], v[108:111]
    ds_read_b128 v[92:95], v11 offset:8192
    s_add_u32 s37, s37, 1
    v_mfma_f32_16x16x32_bf16 v[112:115], a[8:11], v[104:107], v[112:115]
    ds_read_b128 v[96:99], v11 offset:10240
    s_mov_b32 s52, 0
    v_mfma_f32_16x16x32_bf16 v[116:119], a[88:91], v[100:103], v[116:119]
    buffer_load_dwordx4 v10, s[24:27], s46 offen offset:128 lds
    s_add_u32 m0, m0, 3968
    v_mfma_f32_16x16x32_bf16 v[120:123], a[88:91], v[104:107], v[120:123]
    s_waitcnt lgkmcnt(2)
    s_and_b32 s50, s37, 3
    v_mfma_f32_16x16x32_bf16 v[108:111], a[12:15], v[84:87], v[108:111]
    ds_read_b128 v[100:103], v12 offset:8192
    s_mul_i32 s51, s50, 114688
    v_mfma_f32_16x16x32_bf16 v[112:115], a[12:15], v[88:91], v[112:115]
    ds_read_b128 v[104:107], v12 offset:10240
    s_add_u32 s41, s38, s51
    v_mfma_f32_16x16x32_bf16 v[116:119], a[92:95], v[84:87], v[116:119]
    buffer_load_dwordx4 v10, s[24:27], s46 offen offset:256 lds
    s_add_u32 m0, m0, 3968
    v_mfma_f32_16x16x32_bf16 v[120:123], a[92:95], v[88:91], v[120:123]
    buffer_store_dword v20, v140, s[4:7], 0 offen sc1
    s_waitcnt lgkmcnt(2)
    v_mfma_f32_16x16x32_bf16 v[108:111], a[16:19], v[92:95], v[108:111]
    ds_read_b128 v[84:87], v11 offset:12288
    v_mfma_f32_16x16x32_bf16 v[112:115], a[16:19], v[96:99], v[112:115]
    ds_read_b128 v[88:91], v11 offset:14336
    v_mfma_f32_16x16x32_bf16 v[116:119], a[96:99], v[92:95], v[116:119]
    buffer_load_dwordx4 v10, s[24:27], s46 offen offset:384 lds
    s_add_u32 m0, m0, 3968
    v_mfma_f32_16x16x32_bf16 v[120:123], a[96:99], v[96:99], v[120:123]
    s_waitcnt lgkmcnt(2)
    v_mfma_f32_16x16x32_bf16 v[108:111], a[20:23], v[100:103], v[108:111]
    ds_read_b128 v[92:95], v12 offset:12288
    v_mfma_f32_16x16x32_bf16 v[112:115], a[20:23], v[104:107], v[112:115]
    buffer_store_dword v20, v141, s[4:7], 0 offen sc1
    ds_read_b128 v[96:99], v12 offset:14336
    v_mfma_f32_16x16x32_bf16 v[116:119], a[100:103], v[100:103], v[116:119]
    buffer_load_dwordx4 v10, s[24:27], s46 offen offset:512 lds
    s_add_u32 m0, m0, 3968
    v_mfma_f32_16x16x32_bf16 v[120:123], a[100:103], v[104:107], v[120:123]
    s_waitcnt lgkmcnt(2)
    v_mfma_f32_16x16x32_bf16 v[108:111], a[24:27], v[84:87], v[108:111]
    ds_read_b128 v[100:103], v11 offset:16384
    v_mfma_f32_16x16x32_bf16 v[112:115], a[24:27], v[88:91], v[112:115]
    ds_read_b128 v[104:107], v11 offset:18432
    v_mfma_f32_16x16x32_bf16 v[116:119], a[104:107], v[84:87], v[116:119]
    buffer_load_dwordx4 v10, s[24:27], s46 offen offset:640 lds
    s_add_u32 m0, m0, 3968
    v_mfma_f32_16x16x32_bf16 v[120:123], a[104:107], v[88:91], v[120:123]
    s_waitcnt lgkmcnt(2)
    v_mfma_f32_16x16x32_bf16 v[108:111], a[28:31], v[92:95], v[108:111]
    ds_read_b128 v[84:87], v12 offset:16384
    v_mfma_f32_16x16x32_bf16 v[112:115], a[28:31], v[96:99], v[112:115]
    ds_read_b128 v[88:91], v12 offset:18432
    v_mfma_f32_16x16x32_bf16 v[116:119], a[108:111], v[92:95], v[116:119]
    buffer_load_dwordx4 v10, s[24:27], s46 offen offset:768 lds
    s_add_u32 m0, m0, 3968
    v_mfma_f32_16x16x32_bf16 v[120:123], a[108:111], v[96:99], v[120:123]
    s_waitcnt lgkmcnt(2)
    v_mfma_f32_16x16x32_bf16 v[108:111], a[32:35], v[100:103], v[108:111]
    ds_read_b128 v[92:95], v11 offset:20480
    v_mfma_f32_16x16x32_bf16 v[112:115], a[32:35], v[104:107], v[112:115]
    ds_read_b128 v[96:99], v11 offset:22528
    v_mfma_f32_16x16x32_bf16 v[116:119], a[112:115], v[100:103], v[116:119]
    buffer_load_dwordx4 v10, s[24:27], s46 offen offset:896 lds
    s_add_u32 m0, m0, 3968
    v_mfma_f32_16x16x32_bf16 v[120:123], a[112:115], v[104:107], v[120:123]
    s_waitcnt lgkmcnt(2)
    v_mfma_f32_16x16x32_bf16 v[108:111], a[36:39], v[84:87], v[108:111]
    ds_read_b128 v[100:103], v12 offset:20480
    v_mfma_f32_16x16x32_bf16 v[112:115], a[36:39], v[88:91], v[112:115]
    ds_read_b128 v[104:107], v12 offset:22528
    v_mfma_f32_16x16x32_bf16 v[116:119], a[116:119], v[84:87], v[116:119]
    buffer_load_dwordx4 v10, s[24:27], s46 offen offset:1024 lds
    s_add_u32 m0, m0, 3968
    v_mfma_f32_16x16x32_bf16 v[120:123], a[116:119], v[88:91], v[120:123]
    s_waitcnt lgkmcnt(2)
    v_mfma_f32_16x16x32_bf16 v[108:111], a[40:43], v[92:95], v[108:111]
    ds_read_b128 v[84:87], v11 offset:24576
    v_mfma_f32_16x16x32_bf16 v[112:115], a[40:43], v[96:99], v[112:115]
    ds_read_b128 v[88:91], v11 offset:26624
    v_mfma_f32_16x16x32_bf16 v[116:119], a[120:123], v[92:95], v[116:119]
    buffer_load_dwordx4 v10, s[24:27], s46 offen offset:1152 lds
    v_mfma_f32_16x16x32_bf16 v[120:123], a[120:123], v[96:99], v[120:123]
    s_waitcnt lgkmcnt(2)
    v_mfma_f32_16x16x32_bf16 v[108:111], a[44:47], v[100:103], v[108:111]
    ds_read_b128 v[92:95], v12 offset:24576
    v_mfma_f32_16x16x32_bf16 v[112:115], a[44:47], v[104:107], v[112:115]
    ds_read_b128 v[96:99], v12 offset:26624
    v_mfma_f32_16x16x32_bf16 v[116:119], a[124:127], v[100:103], v[116:119]
    v_mfma_f32_16x16x32_bf16 v[120:123], a[124:127], v[104:107], v[120:123]
    s_waitcnt lgkmcnt(2)
    v_mfma_f32_16x16x32_bf16 v[108:111], a[48:51], v[84:87], v[108:111]
    ds_read_b128 v[100:103], v11 offset:28672
    v_mfma_f32_16x16x32_bf16 v[112:115], a[48:51], v[88:91], v[112:115]
    ds_read_b128 v[104:107], v11 offset:30720
    v_mfma_f32_16x16x32_bf16 v[116:119], a[128:131], v[84:87], v[116:119]
    v_mfma_f32_16x16x32_bf16 v[120:123], a[128:131], v[88:91], v[120:123]
    s_waitcnt lgkmcnt(2)
    v_mfma_f32_16x16x32_bf16 v[108:111], a[52:55], v[92:95], v[108:111]
    ds_read_b128 v[84:87], v12 offset:28672
    v_mfma_f32_16x16x32_bf16 v[112:115], a[52:55], v[96:99], v[112:115]
    ds_read_b128 v[88:91], v12 offset:30720
    v_mfma_f32_16x16x32_bf16 v[116:119], a[132:135], v[92:95], v[116:119]
    v_mfma_f32_16x16x32_bf16 v[120:123], a[132:135], v[96:99], v[120:123]
    s_waitcnt lgkmcnt(2)
    v_mfma_f32_16x16x32_bf16 v[108:111], a[56:59], v[100:103], v[108:111]
    ds_read_b128 v[92:95], v11 offset:32768
    v_mfma_f32_16x16x32_bf16 v[112:115], a[56:59], v[104:107], v[112:115]
    ds_read_b128 v[96:99], v11 offset:34816
    v_mfma_f32_16x16x32_bf16 v[116:119], a[136:139], v[100:103], v[116:119]
    v_mfma_f32_16x16x32_bf16 v[120:123], a[136:139], v[104:107], v[120:123]
    s_waitcnt lgkmcnt(2)
    v_mfma_f32_16x16x32_bf16 v[108:111], a[60:63], v[84:87], v[108:111]
    ds_read_b128 v[100:103], v12 offset:32768
    v_mfma_f32_16x16x32_bf16 v[112:115], a[60:63], v[88:91], v[112:115]
    ds_read_b128 v[104:107], v12 offset:34816
    v_mfma_f32_16x16x32_bf16 v[116:119], a[140:143], v[84:87], v[116:119]
    v_mfma_f32_16x16x32_bf16 v[120:123], a[140:143], v[88:91], v[120:123]
    s_waitcnt lgkmcnt(2)
    v_mfma_f32_16x16x32_bf16 v[108:111], a[64:67], v[92:95], v[108:111]
    ds_read_b128 v[84:87], v11 offset:36864
    v_mfma_f32_16x16x32_bf16 v[112:115], a[64:67], v[96:99], v[112:115]
    ds_read_b128 v[88:91], v11 offset:38912
    v_mfma_f32_16x16x32_bf16 v[116:119], a[144:147], v[92:95], v[116:119]
    v_mfma_f32_16x16x32_bf16 v[120:123], a[144:147], v[96:99], v[120:123]
    s_waitcnt lgkmcnt(2)
    v_mfma_f32_16x16x32_bf16 v[108:111], a[68:71], v[100:103], v[108:111]
    ds_read_b128 v[92:95], v12 offset:36864
    v_mfma_f32_16x16x32_bf16 v[112:115], a[68:71], v[104:107], v[112:115]
    ds_read_b128 v[96:99], v12 offset:38912
    v_mfma_f32_16x16x32_bf16 v[116:119], a[148:151], v[100:103], v[116:119]
    v_mfma_f32_16x16x32_bf16 v[120:123], a[148:151], v[104:107], v[120:123]
    s_waitcnt lgkmcnt(0)
    v_mfma_f32_16x16x32_bf16 v[108:111], a[72:75], v[84:87], v[108:111]
    v_add_u32 v11, s49, v11
    v_mfma_f32_16x16x32_bf16 v[112:115], a[72:75], v[88:91], v[112:115]
    v_add_u32 v12, s49, v12
    v_mfma_f32_16x16x32_bf16 v[108:111], a[76:79], v[92:95], v[108:111]
    s_sub_u32 s47, s47, s49
    v_mfma_f32_16x16x32_bf16 v[112:115], a[76:79], v[96:99], v[112:115]
    s_sub_u32 s49, 0, s49
    v_mfma_f32_16x16x32_bf16 v[116:119], a[152:155], v[84:87], v[116:119]
    v_mfma_f32_16x16x32_bf16 v[120:123], a[152:155], v[88:91], v[120:123]
    v_mfma_f32_16x16x32_bf16 v[116:119], a[156:159], v[92:95], v[116:119]
    v_mfma_f32_16x16x32_bf16 v[120:123], a[156:159], v[96:99], v[120:123]
    v_cvt_pk_bf16_f32 v124, v108, v109
    v_cvt_pk_bf16_f32 v125, v110, v111
    v_cvt_pk_bf16_f32 v126, v112, v113
    v_cvt_pk_bf16_f32 v127, v114, v115
    s_nop 0
    v_permlane16_swap_b32 v124, v126
    v_permlane16_swap_b32 v125, v127
    v_cvt_pk_bf16_f32 v128, v116, v117
    v_cvt_pk_bf16_f32 v129, v118, v119
    v_cvt_pk_bf16_f32 v130, v120, v121
    v_cvt_pk_bf16_f32 v131, v122, v123
    s_nop 0
    v_permlane16_swap_b32 v128, v130
    v_permlane16_swap_b32 v129, v131
    buffer_store_dwordx4 v[124:127], v19, s[4:7], s44 offen
    buffer_store_dwordx4 v[128:131], v19, s[4:7], s45 offen
    s_branch L_v_loop_f
L_fw_27c:
    v_mov_b32 v148, -1
    v_mov_b32 v149, -1
    v_mov_b32 v150, -1
    v_mov_b32 v151, -1
    v_mov_b32 v152, -1
    v_mov_b32 v153, -1
    v_mov_b32 v154, -1
    v_mov_b32 v155, -1
    s_add_u32 s53, s53, 2293760
    buffer_store_dwordx4 v[148:151], v143, s[4:7], s53 offen offset:0 sc1
    buffer_store_dwordx4 v[152:155], v143, s[4:7], s53 offen offset:1024 sc1
    s_sub_u32 s53, s53, 983040
    s_branch L_fw_27
L_wo_f:
    s_mov_b32 s12, s80
    s_and_b32 s13, s81, 0xffff
    s_mov_b32 s14, 7864320
    s_mov_b32 s15, 0x20000
    s_mov_b32 s16, s72
    s_and_b32 s17, s73, 0xffff
    s_mov_b32 s18, 10240
    s_mov_b32 s19, 0x20000
    s_sub_u32 s40, s35, 18
    v_and_b32 v1, 15, v0
    v_lshrrev_b32 v2, 4, v0
    v_lshrrev_b32 v3, 3, v0
    v_and_b32 v4, 7, v0
    v_and_b32 v6, 2, v3
    v_xor_b32 v6, v6, v4
    v_lshlrev_b32 v6, 4, v6
    v_mul_u32_u24 v7, 1280, v3
    s_lshl_b32 s90, s34, 2
    s_add_u32 s90, s90, s32
    s_mul_i32 s90, s90, 245760
    s_lshl_b32 s91, s40, 7
    s_add_u32 s90, s90, s91
    v_add3_u32 v180, v6, v7, s90
    v_xor_b32 v181, 64, v180
    s_mul_i32 s90, s40, 32768
    s_lshl_b32 s91, s32, 11
    s_add_u32 s90, s90, s91
    s_lshr_b32 s91, s32, 1
    s_mul_i32 s91, s91, 0
    s_xor_b32 s91, s91, s34
    v_mul_u32_u24 v7, 0, v2
    v_xor_b32 v7, s91, v7
    v_lshlrev_b32 v6, 4, v1
    v_lshl_add_u32 v7, v7, 8, v6
    v_lshl_add_u32 v7, v2, 13, v7
    v_add_u32 v14, s90, v7
    v_lshlrev_b32 v12, 4, v0
    v_lshlrev_b32 v13, 2, v0
    v_add_u32 v46, s90, v13
    s_xor_b32 s92, s91, 0
    s_lshl_b32 s92, s92, 8
    s_add_u32 s60, s92, 0
    s_xor_b32 s92, s91, 0
    s_lshl_b32 s92, s92, 8
    s_add_u32 s61, s92, 8192
    s_xor_b32 s92, s91, 0
    s_lshl_b32 s92, s92, 8
    s_add_u32 s62, s92, 16384
    s_xor_b32 s92, s91, 0
    s_lshl_b32 s92, s92, 8
    s_add_u32 s63, s92, 24576
    v_cmp_gt_u32 vcc, 2, v2
    v_mov_b32 v9, 2146435072
    s_nop 0
    v_cndmask_b32 v14, v9, v14, vcc
    s_lshl_b32 s92, s40, 7
    s_lshl_b32 s93, s32, 2
    s_add_u32 s92, s92, s93
    s_add_u32 s92, s92, 460800
    v_mov_b32 v244, s92
    v_cmp_eq_u32 vcc, 0, v0
    v_mov_b32 v9, 2146435072
    s_nop 0
    v_cndmask_b32 v244, v9, v244, vcc
    s_lshl_b32 s92, s40, 4
    s_add_u32 s92, s92, s93
    s_add_u32 s92, s92, 460544
    v_mov_b32 v45, s92
    v_cndmask_b32 v45, v9, v45, vcc
    s_lshl_b32 s92, s32, 7
    s_add_u32 s92, s92, 462336
    v_min_u32 v3, 5, v0
    v_lshl_add_u32 v245, v3, 2, s92
    s_lshl_b32 s90, s40, 2
    s_add_u32 s90, s90, s32
    s_lshl_b32 s91, s90, 8
    v_add_u32 v17, s91, v6
    v_cmp_eq_u32 vcc, 0, v2
    v_mov_b32 v9, 2146435072
    s_nop 0
    v_cndmask_b32 v17, v9, v17, vcc
    v_lshrrev_b32 v3, 2, v1
    v_and_b32 v7, 1, v1
    v_lshl_or_b32 v4, v3, 1, v7
    v_mul_u32_u24 v4, 1280, v4
    v_and_b32 v5, 2, v1
    v_lshl_add_u32 v4, v5, 1, v4
    s_lshl_b32 s91, s90, 5
    v_add_u32 v4, s91, v4
    v_lshlrev_b32 v6, 6, v3
    v_lshl_add_u32 v6, v7, 5, v6
    v_lshl_add_u32 v6, v2, 3, v6
    v_lshl_add_u32 v6, v5, 1, v6
    s_mul_i32 s92, s32, 1152
    s_add_u32 s92, s92, 122880
    v_add_u32 v18, s92, v6
    buffer_load_dword v164, v4, s[16:19], 0 offen offset:0
    buffer_load_dword v165, v4, s[16:19], 0 offen offset:8
    buffer_load_dword v166, v4, s[16:19], 0 offen offset:16
    buffer_load_dword v167, v4, s[16:19], 0 offen offset:24
    v_mov_b32 v168, -1
    v_mov_b32 v169, -1
    v_mov_b32 v170, -1
    v_mov_b32 v171, -1
    s_mul_i32 s90, s32, 24576
    s_mov_b32 m0, s90
    s_mov_b32 s91, 0
    buffer_load_dwordx4 v180, s[12:15], s91 offen nt lds
    s_add_u32 m0, m0, 1024
    s_add_u32 s91, s91, 10240
    buffer_load_dwordx4 v181, s[12:15], s91 offen nt lds
    s_add_u32 m0, m0, 1024
    s_add_u32 s91, s91, 10240
    buffer_load_dwordx4 v180, s[12:15], s91 offen nt lds
    s_add_u32 m0, m0, 1024
    s_add_u32 s91, s91, 10240
    buffer_load_dwordx4 v181, s[12:15], s91 offen nt lds
    s_add_u32 m0, m0, 1024
    s_add_u32 s91, s91, 10240
    buffer_load_dwordx4 v180, s[12:15], s91 offen nt lds
    s_add_u32 m0, m0, 1024
    s_add_u32 s91, s91, 10240
    buffer_load_dwordx4 v181, s[12:15], s91 offen nt lds
    s_add_u32 m0, m0, 1024
    s_add_u32 s91, s91, 10240
    buffer_load_dwordx4 v180, s[12:15], s91 offen nt lds
    s_add_u32 m0, m0, 1024
    s_add_u32 s91, s91, 10240
    buffer_load_dwordx4 v181, s[12:15], s91 offen nt lds
    s_add_u32 m0, m0, 1024
    s_add_u32 s91, s91, 10240
    buffer_load_dwordx4 v180, s[12:15], s91 offen nt lds
    s_add_u32 m0, m0, 1024
    s_add_u32 s91, s91, 10240
    buffer_load_dwordx4 v181, s[12:15], s91 offen nt lds
    s_add_u32 m0, m0, 1024
    s_add_u32 s91, s91, 10240
    buffer_load_dwordx4 v180, s[12:15], s91 offen nt lds
    s_add_u32 m0, m0, 1024
    s_add_u32 s91, s91, 10240
    buffer_load_dwordx4 v181, s[12:15], s91 offen nt lds
    s_add_u32 m0, m0, 1024
    s_add_u32 s91, s91, 10240
    buffer_load_dwordx4 v180, s[12:15], s91 offen nt lds
    s_add_u32 m0, m0, 1024
    s_add_u32 s91, s91, 10240
    buffer_load_dwordx4 v181, s[12:15], s91 offen nt lds
    s_add_u32 m0, m0, 1024
    s_add_u32 s91, s91, 10240
    buffer_load_dwordx4 v180, s[12:15], s91 offen nt lds
    s_add_u32 m0, m0, 1024
    s_add_u32 s91, s91, 10240
    buffer_load_dwordx4 v181, s[12:15], s91 offen nt lds
    s_add_u32 m0, m0, 1024
    s_add_u32 s91, s91, 10240
    buffer_load_dwordx4 v180, s[12:15], s91 offen nt lds
    s_add_u32 m0, m0, 1024
    s_add_u32 s91, s91, 10240
    buffer_load_dwordx4 v181, s[12:15], s91 offen nt lds
    s_add_u32 m0, m0, 1024
    s_add_u32 s91, s91, 10240
    buffer_load_dwordx4 v180, s[12:15], s91 offen nt lds
    s_add_u32 m0, m0, 1024
    s_add_u32 s91, s91, 10240
    buffer_load_dwordx4 v181, s[12:15], s91 offen nt lds
    s_add_u32 m0, m0, 1024
    s_add_u32 s91, s91, 10240
    buffer_load_dwordx4 v180, s[12:15], s91 offen nt lds
    s_add_u32 m0, m0, 1024
    s_add_u32 s91, s91, 10240
    buffer_load_dwordx4 v181, s[12:15], s91 offen nt lds
    s_add_u32 m0, m0, 1024
    s_add_u32 s91, s91, 10240
    buffer_load_dwordx4 v180, s[12:15], s91 offen nt lds
    s_add_u32 m0, m0, 1024
    s_add_u32 s91, s91, 10240
    buffer_load_dwordx4 v181, s[12:15], s91 offen nt lds
    s_waitcnt vmcnt(24)
    v_min_u32 v164, -2, v164
    v_min_u32 v165, -2, v165
    v_min_u32 v166, -2, v166
    v_min_u32 v167, -2, v167
    v_and_b32 v7, 2, v1
    v_cmp_ne_u32 vcc, 0, v7
    v_mov_b32 v5, 0x4444
    v_mov_b32 v6, 0xeeee
    v_cndmask_b32 v10, v5, v6, vcc
    v_mov_b32 v5, 0xe484
    v_mov_b32 v6, 0xee9e
    v_cndmask_b32 v7, v5, v6, vcc
    v_mov_b32 v5, 0x84e4
    v_mov_b32 v6, 0x9eee
    v_cndmask_b32 v8, v5, v6, vcc
    v_cmp_gt_u32 vcc, 2, v2
    s_nop 1
    v_cndmask_b32 v11, v8, v7, vcc
    v_mov_b32 v84, 1065369472
    v_mov_b32 v85, 1065369472
    v_mov_b32 v86, 1065369472
    v_mov_b32 v87, 0
    v_mov_b32 v88, 1065369472
    v_mov_b32 v89, 1065369472
    v_mov_b32 v90, 1065369472
    v_mov_b32 v91, 0
    v_mov_b32 v51, 0
    v_mov_b32 v55, 0
    v_mov_b32 v59, 0
    v_mov_b32 v63, 0
    v_mov_b32 v67, 0
    v_mov_b32 v71, 0
    v_mov_b32 v75, 0
    v_mov_b32 v79, 0
    v_mov_b32 v210, 0
    v_mov_b32 v211, 0
    v_mov_b32 v218, 0
    v_mov_b32 v219, 0
    v_and_b32 v7, 1, v1
    v_cmp_ne_u32 vcc, 0, v7
    v_mov_b32 v5, 0x3f80
    v_mov_b32 v6, 0x3f800000
    v_cndmask_b32 v5, v5, v6, vcc
    v_bfe_u32 v6, v1, 1, 1
    v_cmp_eq_u32 vcc, 0, v6
    s_nop 1
    v_cndmask_b32 v110, 0, v5, vcc
    v_mov_b32 v108, 0
    v_mov_b32 v112, 0
    v_cmp_eq_u32 vcc, 1, v6
    s_nop 1
    v_cndmask_b32 v111, 0, v5, vcc
    v_mov_b32 v109, 0
    v_mov_b32 v113, 0
    v_mov_b32 v240, 0x3dd53b95
    v_mov_b32 v241, 0x3dd53b95
    s_lshl_b32 s90, s32, 8
    s_add_u32 s90, s90, 122880
    v_mul_u32_u24 v6, 1152, v2
    v_lshl_add_u32 v6, v1, 3, v6
    v_add_u32 v19, s90, v6
    s_mul_i32 s90, s32, 1536
    v_add_u32 v20, s90, v12
    s_add_u32 s90, s90, 1024
    v_lshl_add_u32 v21, v0, 3, s90
    s_mul_i32 s90, s32, 6144
    v_add_u32 v22, s90, v12
    s_add_u32 s90, s90, 1024
    v_lshl_add_u32 v23, v0, 3, s90
    v_add_u32 v28, 98304, v12
    s_mul_i32 s90, s32, 3072
    v_add_u32 v37, s90, v12
    v_add_u32 v44, 25600, v37
    s_add_u32 s54, s90, 98304
    s_mul_i32 s90, s32, 3840
    s_add_u32 s90, s90, 10240
    v_add_u32 v38, s90, v12
    s_add_u32 s90, s90, 1024
    v_add_u32 v39, s90, v13
    s_mul_i32 s90, s32, 12288
    v_add_u32 v40, s90, v12
    s_lshl_b32 s93, s40, 2
    s_add_u32 s93, s93, s32
    s_nop 0
    s_lshr_b32 s90, s93, 2
    s_lshl_b32 s90, s90, 15
    s_and_b32 s92, s93, 3
    s_lshl_b32 s92, s92, 10
    s_add_u32 s90, s90, s92
    v_mov_b32 v5, s34
    v_and_b32 v6, 7, v1
    v_lshlrev_b32 v6, 4, v6
    v_lshl_add_u32 v6, v5, 7, v6
    v_lshrrev_b32 v7, 3, v1
    v_lshl_add_u32 v6, v7, 12, v6
    v_lshrrev_b32 v5, 1, v2
    v_lshl_add_u32 v6, v5, 13, v6
    v_and_b32 v5, 1, v2
    v_lshl_add_u32 v6, v5, 14, v6
    v_add_u32 v30, s90, v6
    s_and_b32 s91, s34, 1
    s_lshl_b32 s91, s91, 12
    s_add_u32 s90, s90, s91
    s_lshr_b32 s91, s34, 2
    s_lshl_b32 s91, s91, 13
    s_add_u32 s90, s90, s91
    s_and_b32 s91, s34, 2
    s_lshl_b32 s91, s91, 13
    s_add_u32 s90, s90, s91
    v_lshl_add_u32 v31, v0, 4, s90
    s_lshl_b32 s91, s93, 10
    s_add_u32 s91, s91, 884736
    v_lshl_add_u32 v15, v0, 4, s91
    s_lshr_b32 s91, s34, 1
    s_mul_i32 s91, s91, 10240
    s_lshl_b32 s92, s93, 5
    s_add_u32 s91, s91, s92
    s_and_b32 s92, s34, 1
    s_mul_i32 s92, s92, 40960
    s_add_u32 s91, s91, s92
    s_add_u32 s91, s91, 1280
    v_mul_u32_u24 v6, 2560, v2
    v_lshl_add_u32 v6, v1, 1, v6
    v_add_u32 v32, s91, v6
    v_cmp_gt_u32 s[58:59], 8, v1
    v_and_b32 v5, 1, v1
    v_lshrrev_b32 v6, 3, v1
    v_lshl_add_u32 v5, v5, 1, v6
    v_bfe_u32 v6, v1, 2, 1
    v_cmp_ne_u32 vcc, 0, v6
    v_mov_b32 v6, 0x3f80
    v_mov_b32 v7, 0x3f800000
    v_cndmask_b32 v6, v6, v7, vcc
    v_cmp_eq_u32 vcc, 0, v5
    s_nop 1
    v_cndmask_b32 v7, 0, v6, vcc
    v_accvgpr_write_b32 a144, v7
    v_cmp_eq_u32 vcc, 1, v5
    s_nop 1
    v_cndmask_b32 v7, 0, v6, vcc
    v_accvgpr_write_b32 a145, v7
    v_cmp_eq_u32 vcc, 2, v5
    s_nop 1
    v_cndmask_b32 v7, 0, v6, vcc
    v_accvgpr_write_b32 a146, v7
    v_cmp_eq_u32 vcc, 3, v5
    s_nop 1
    v_cndmask_b32 v7, 0, v6, vcc
    v_accvgpr_write_b32 a147, v7
    s_lshl_b32 s90, s32, 7
    v_add_u32 v5, s90, v13
    v_add_u32 v6, 458752, v5
    v_add_u32 v7, 459728, v5
    v_cmp_gt_u32 vcc, 12, v0
    s_nop 1
    v_cndmask_b32 v33, v7, v6, vcc
    v_mov_b32 v5, -2
    v_cndmask_b32 v34, v5, 3, vcc
    v_cmp_gt_u32 vcc, 14, v0
    v_mov_b32 v9, 2146435072
    s_nop 0
    v_cndmask_b32 v33, v9, v33, vcc
    v_mov_b32 v5, -1000
    v_cndmask_b32 v34, v5, v34, vcc
    v_and_b32 v4, 3, v1
    v_lshlrev_b32 v6, 6, v4
    v_lshl_add_u32 v6, v3, 3, v6
    v_lshl_add_u32 v6, v2, 8, v6
    v_and_b32 v5, 1, v2
    v_lshl_add_u32 v6, v5, 5, v6
    s_mul_i32 s90, s32, 3072
    s_add_u32 s53, s90, 131072
    v_add_u32 v16, s53, v6
    v_xor_b32 v13, 32, v16
    v_and_b32 v4, 3, v1
    v_and_b32 v5, 1, v2
    v_lshl_add_u32 v6, v2, 3, v3
    v_lshlrev_b32 v6, 7, v6
    v_and_b32 v7, 2, v3
    v_lshl_or_b32 v7, v5, 2, v7
    v_lshrrev_b32 v8, 1, v4
    v_xor_b32 v7, v7, v8
    v_lshl_add_u32 v6, v7, 4, v6
    v_and_b32 v7, 1, v4
    v_lshl_add_u32 v6, v7, 3, v6
    s_mul_i32 s90, s32, 24576
    v_add_u32 v6, s90, v6
    v_xor_b32 v182, 0, v6
    v_xor_b32 v183, 32, v6
    v_xor_b32 v184, 64, v6
    v_xor_b32 v185, 96, v6
    s_waitcnt vmcnt(0)
    ds_read_b64_tr_b16 a[0:1], v182 offset:0
    ds_read_b64_tr_b16 a[2:3], v182 offset:512
    ds_read_b64_tr_b16 a[4:5], v182 offset:4096
    ds_read_b64_tr_b16 a[6:7], v182 offset:4608
    ds_read_b64_tr_b16 a[8:9], v182 offset:8192
    ds_read_b64_tr_b16 a[10:11], v182 offset:8704
    ds_read_b64_tr_b16 a[12:13], v182 offset:12288
    ds_read_b64_tr_b16 a[14:15], v182 offset:12800
    ds_read_b64_tr_b16 a[16:17], v182 offset:16384
    ds_read_b64_tr_b16 a[18:19], v182 offset:16896
    ds_read_b64_tr_b16 a[20:21], v182 offset:20480
    ds_read_b64_tr_b16 a[22:23], v182 offset:20992
    ds_read_b64_tr_b16 a[24:25], v183 offset:0
    ds_read_b64_tr_b16 a[26:27], v183 offset:512
    ds_read_b64_tr_b16 a[28:29], v183 offset:4096
    ds_read_b64_tr_b16 a[30:31], v183 offset:4608
    ds_read_b64_tr_b16 a[32:33], v183 offset:8192
    ds_read_b64_tr_b16 a[34:35], v183 offset:8704
    ds_read_b64_tr_b16 a[36:37], v183 offset:12288
    ds_read_b64_tr_b16 a[38:39], v183 offset:12800
    ds_read_b64_tr_b16 a[40:41], v183 offset:16384
    ds_read_b64_tr_b16 a[42:43], v183 offset:16896
    ds_read_b64_tr_b16 a[44:45], v183 offset:20480
    ds_read_b64_tr_b16 a[46:47], v183 offset:20992
    ds_read_b64_tr_b16 a[48:49], v184 offset:0
    ds_read_b64_tr_b16 a[50:51], v184 offset:512
    ds_read_b64_tr_b16 a[52:53], v184 offset:4096
    ds_read_b64_tr_b16 a[54:55], v184 offset:4608
    ds_read_b64_tr_b16 a[56:57], v184 offset:8192
    ds_read_b64_tr_b16 a[58:59], v184 offset:8704
    ds_read_b64_tr_b16 a[60:61], v184 offset:12288
    ds_read_b64_tr_b16 a[62:63], v184 offset:12800
    ds_read_b64_tr_b16 a[64:65], v184 offset:16384
    ds_read_b64_tr_b16 a[66:67], v184 offset:16896
    ds_read_b64_tr_b16 a[68:69], v184 offset:20480
    ds_read_b64_tr_b16 a[70:71], v184 offset:20992
    ds_read_b64_tr_b16 a[72:73], v185 offset:0
    ds_read_b64_tr_b16 a[74:75], v185 offset:512
    ds_read_b64_tr_b16 a[76:77], v185 offset:4096
    ds_read_b64_tr_b16 a[78:79], v185 offset:4608
    ds_read_b64_tr_b16 a[80:81], v185 offset:8192
    ds_read_b64_tr_b16 a[82:83], v185 offset:8704
    ds_read_b64_tr_b16 a[84:85], v185 offset:12288
    ds_read_b64_tr_b16 a[86:87], v185 offset:12800
    ds_read_b64_tr_b16 a[88:89], v185 offset:16384
    ds_read_b64_tr_b16 a[90:91], v185 offset:16896
    ds_read_b64_tr_b16 a[92:93], v185 offset:20480
    ds_read_b64_tr_b16 a[94:95], v185 offset:20992
    s_waitcnt lgkmcnt(0)
    s_barrier
    v_mov_b32 v1, 192
L_gw_33:
    buffer_load_dword v2, v1, s[8:11], 0 offen sc1
    s_sub_u32 s36, s36, 1
    s_cbranch_scc1 L_exit
    s_waitcnt vmcnt(0)
L_gw_33c:
    v_readfirstlane_b32 s90, v2
    s_nop 0
    s_cmp_eq_u32 s90, 0
    s_cbranch_scc1 L_gw_33
    s_cmp_lg_u32 s90, 1
    s_cbranch_scc1 L_slow
    buffer_store_dwordx4 v[164:167], v17, s[4:7], s38 offen
    s_mov_b32 s37, -1
    v_add_u32 v35, -2, v34
    s_add_u32 s45, s38, 65536
    s_add_u32 s46, s45, 4096
    s_add_u32 s47, s45, 8192
    v_mov_b32 v24, v20
    v_mov_b32 v25, v21
    buffer_load_dword v36, v33, s[4:7], s38 offen sc1
    s_waitcnt vmcnt(0)
    v_cmp_lt_i32 vcc, v36, v35
    s_cbranch_vccz L_fok_35
L_fw_34:
    buffer_load_dword v36, v33, s[4:7], s38 offen sc1
    s_sub_u32 s36, s36, 1
    s_cbranch_scc1 L_exit
    s_waitcnt vmcnt(0)
    v_cmp_lt_i32 vcc, v36, v35
    s_cbranch_vccnz L_fw_34
L_fok_35:
    buffer_load_dwordx4 a[96:99], v40, s[4:7], s45 offen offset:0 sc1
    buffer_load_dwordx4 a[100:103], v40, s[4:7], s45 offen offset:1024 sc1
    buffer_load_dwordx4 a[104:107], v40, s[4:7], s45 offen offset:2048 sc1
    buffer_load_dwordx4 a[108:111], v40, s[4:7], s45 offen offset:3072 sc1
    buffer_load_dwordx4 a[112:115], v40, s[4:7], s46 offen offset:0 sc1
    buffer_load_dwordx4 a[116:119], v40, s[4:7], s46 offen offset:1024 sc1
    buffer_load_dwordx4 a[120:123], v40, s[4:7], s46 offen offset:2048 sc1
    buffer_load_dwordx4 a[124:127], v40, s[4:7], s46 offen offset:3072 sc1
    buffer_load_dwordx4 a[128:131], v40, s[4:7], s47 offen offset:0 sc1
    buffer_load_dwordx4 a[132:135], v40, s[4:7], s47 offen offset:1024 sc1
    buffer_load_dwordx4 a[136:139], v40, s[4:7], s47 offen offset:2048 sc1
    buffer_load_dwordx4 a[140:143], v40, s[4:7], s47 offen offset:3072 sc1
    s_waitcnt vmcnt(0)
    v_mfma_f32_16x16x32_bf16 v[148:151], a[96:99], a[0:3], 0
    v_mfma_f32_16x16x32_bf16 v[152:155], a[120:123], a[0:3], 0
    v_mfma_f32_16x16x32_bf16 v[156:159], a[96:99], a[24:27], 0
    v_mfma_f32_16x16x32_bf16 v[160:163], a[120:123], a[24:27], 0
    v_mfma_f32_16x16x32_bf16 v[180:183], a[96:99], a[48:51], 0
    v_mfma_f32_16x16x32_bf16 v[184:187], a[120:123], a[48:51], 0
    v_mfma_f32_16x16x32_bf16 v[188:191], a[96:99], a[72:75], 0
    v_mfma_f32_16x16x32_bf16 v[192:195], a[120:123], a[72:75], 0
    v_mfma_f32_16x16x32_bf16 v[148:151], a[100:103], a[4:7], v[148:151]
    v_mfma_f32_16x16x32_bf16 v[152:155], a[124:127], a[4:7], v[152:155]
    v_mfma_f32_16x16x32_bf16 v[156:159], a[100:103], a[28:31], v[156:159]
    v_mfma_f32_16x16x32_bf16 v[160:163], a[124:127], a[28:31], v[160:163]
    v_mfma_f32_16x16x32_bf16 v[180:183], a[100:103], a[52:55], v[180:183]
    v_mfma_f32_16x16x32_bf16 v[184:187], a[124:127], a[52:55], v[184:187]
    v_mfma_f32_16x16x32_bf16 v[188:191], a[100:103], a[76:79], v[188:191]
    v_mfma_f32_16x16x32_bf16 v[192:195], a[124:127], a[76:79], v[192:195]
    v_mfma_f32_16x16x32_bf16 v[148:151], a[104:107], a[8:11], v[148:151]
    v_mfma_f32_16x16x32_bf16 v[152:155], a[128:131], a[8:11], v[152:155]
    v_mfma_f32_16x16x32_bf16 v[156:159], a[104:107], a[32:35], v[156:159]
    v_mfma_f32_16x16x32_bf16 v[160:163], a[128:131], a[32:35], v[160:163]
    v_mfma_f32_16x16x32_bf16 v[180:183], a[104:107], a[56:59], v[180:183]
    v_mfma_f32_16x16x32_bf16 v[184:187], a[128:131], a[56:59], v[184:187]
    v_mfma_f32_16x16x32_bf16 v[188:191], a[104:107], a[80:83], v[188:191]
    v_mfma_f32_16x16x32_bf16 v[192:195], a[128:131], a[80:83], v[192:195]
    v_mfma_f32_16x16x32_bf16 v[148:151], a[108:111], a[12:15], v[148:151]
    v_mfma_f32_16x16x32_bf16 v[152:155], a[132:135], a[12:15], v[152:155]
    v_mfma_f32_16x16x32_bf16 v[156:159], a[108:111], a[36:39], v[156:159]
    v_mfma_f32_16x16x32_bf16 v[160:163], a[132:135], a[36:39], v[160:163]
    v_mfma_f32_16x16x32_bf16 v[180:183], a[108:111], a[60:63], v[180:183]
    v_mfma_f32_16x16x32_bf16 v[184:187], a[132:135], a[60:63], v[184:187]
    v_mfma_f32_16x16x32_bf16 v[188:191], a[108:111], a[84:87], v[188:191]
    v_mfma_f32_16x16x32_bf16 v[192:195], a[132:135], a[84:87], v[192:195]
    v_mfma_f32_16x16x32_bf16 v[148:151], a[112:115], a[16:19], v[148:151]
    v_mfma_f32_16x16x32_bf16 v[152:155], a[136:139], a[16:19], v[152:155]
    v_mfma_f32_16x16x32_bf16 v[156:159], a[112:115], a[40:43], v[156:159]
    v_mfma_f32_16x16x32_bf16 v[160:163], a[136:139], a[40:43], v[160:163]
    v_mfma_f32_16x16x32_bf16 v[180:183], a[112:115], a[64:67], v[180:183]
    v_mfma_f32_16x16x32_bf16 v[184:187], a[136:139], a[64:67], v[184:187]
    v_mfma_f32_16x16x32_bf16 v[188:191], a[112:115], a[88:91], v[188:191]
    v_mfma_f32_16x16x32_bf16 v[192:195], a[136:139], a[88:91], v[192:195]
    v_mfma_f32_16x16x32_bf16 v[148:151], a[116:119], a[20:23], v[148:151]
    v_mfma_f32_16x16x32_bf16 v[152:155], a[140:143], a[20:23], v[152:155]
    v_mfma_f32_16x16x32_bf16 v[156:159], a[116:119], a[44:47], v[156:159]
    v_mfma_f32_16x16x32_bf16 v[160:163], a[140:143], a[44:47], v[160:163]
    v_mfma_f32_16x16x32_bf16 v[180:183], a[116:119], a[68:71], v[180:183]
    v_mfma_f32_16x16x32_bf16 v[184:187], a[140:143], a[68:71], v[184:187]
    v_mfma_f32_16x16x32_bf16 v[188:191], a[116:119], a[92:95], v[188:191]
    v_mfma_f32_16x16x32_bf16 v[192:195], a[140:143], a[92:95], v[192:195]
    v_cvt_pk_bf16_f32 v64, v180, v181
    v_cvt_pk_bf16_f32 v65, v182, v183
    ds_write_b64 v24, v[64:65] offset:12288
    v_cvt_pk_bf16_f32 v68, v184, v185
    v_cvt_pk_bf16_f32 v69, v186, v187
    ds_write_b64 v25, v[68:69] offset:12288
    v_cvt_pk_bf16_f32 v72, v188, v189
    v_cvt_pk_bf16_f32 v73, v190, v191
    ds_write_b64 v24, v[72:73] offset:18432
    v_cvt_pk_bf16_f32 v76, v192, v193
    v_cvt_pk_bf16_f32 v77, v194, v195
    ds_write_b64 v25, v[76:77] offset:18432
    v_cvt_pk_bf16_f32 v48, v148, v149
    v_cvt_pk_bf16_f32 v49, v150, v151
    ds_write_b64 v24, v[48:49] offset:0
    v_cvt_pk_bf16_f32 v52, v152, v153
    v_cvt_pk_bf16_f32 v53, v154, v155
    ds_write_b64 v25, v[52:53] offset:0
    v_cvt_pk_bf16_f32 v56, v156, v157
    v_cvt_pk_bf16_f32 v57, v158, v159
    ds_write_b64 v24, v[56:57] offset:6144
    v_cvt_pk_bf16_f32 v60, v160, v161
    v_cvt_pk_bf16_f32 v61, v162, v163
    ds_write_b64 v25, v[60:61] offset:6144
    s_add_u32 s56, s37, 2
    s_and_b32 s55, s56, 3
    s_mul_i32 s55, s55, 114688
    s_add_u32 s55, s55, 65536
    s_add_u32 s45, s38, s55
    s_add_u32 s46, s45, 4096
    s_add_u32 s47, s45, 8192
    s_add_u32 s56, s37, -1
    s_and_b32 s55, s56, 3
    s_mul_i32 s55, s55, 114688
    s_add_u32 s55, s55, 53248
    s_add_u32 s48, s38, s55
    s_and_b32 s55, s56, 1
    s_add_u32 s56, s56, 1
    v_mov_b32 v35, -16
    v_writelane_b32 v35, s56, 12
    s_mul_i32 s55, s55, 12288
    s_add_u32 m0, s54, s55
    v_add_u32 v35, -1, v34
    buffer_load_dword v36, v33, s[4:7], s38 offen sc1
    s_waitcnt vmcnt(0)
    v_cmp_lt_i32 vcc, v36, v35
    s_cbranch_vccz L_fok_37
L_fw_36:
    buffer_load_dword v36, v33, s[4:7], s38 offen sc1
    s_sub_u32 s36, s36, 1
    s_cbranch_scc1 L_exit
    s_waitcnt vmcnt(0)
    v_cmp_lt_i32 vcc, v36, v35
    s_cbranch_vccnz L_fw_36
L_fok_37:
    buffer_load_dwordx4 a[96:99], v40, s[4:7], s45 offen offset:0 sc1
    buffer_load_dwordx4 a[100:103], v40, s[4:7], s45 offen offset:1024 sc1
    buffer_load_dwordx4 a[104:107], v40, s[4:7], s45 offen offset:2048 sc1
    buffer_load_dwordx4 a[108:111], v40, s[4:7], s45 offen offset:3072 sc1
    buffer_load_dwordx4 a[112:115], v40, s[4:7], s46 offen offset:0 sc1
    buffer_load_dwordx4 a[116:119], v40, s[4:7], s46 offen offset:1024 sc1
    buffer_load_dwordx4 a[120:123], v40, s[4:7], s46 offen offset:2048 sc1
    buffer_load_dwordx4 a[124:127], v40, s[4:7], s46 offen offset:3072 sc1
    buffer_load_dwordx4 a[128:131], v40, s[4:7], s47 offen offset:0 sc1
    buffer_load_dwordx4 a[132:135], v40, s[4:7], s47 offen offset:1024 sc1
    buffer_load_dwordx4 a[136:139], v40, s[4:7], s47 offen offset:2048 sc1
    buffer_load_dwordx4 a[140:143], v40, s[4:7], s47 offen offset:3072 sc1
    s_mov_b32 s50, s42
    s_add_u32 s56, s37, 1
    v_mov_b32 v47, v24
    s_and_b32 s55, s56, 3
    s_mul_i32 s41, s55, 327680
    s_mul_i32 s56, s55, 114688
    s_add_u32 s43, s38, s56
    s_xor_b32 s55, s55, 2
    s_mul_i32 s42, s55, 327680
    s_add_u32 s56, s37, 2
    v_mov_b32 v107, s56
    s_and_b32 s55, s56, 3
    s_mul_i32 s44, s55, 24576
    s_add_u32 s56, s37, -1
    s_and_b32 s55, s56, 3
    s_mul_i32 s55, s55, 40960
    s_add_u32 s49, s55, s38
    s_add_u32 s56, s37, -1
    s_and_b32 s55, s56, 3
    s_mul_i32 s55, s55, 24576
    v_add_u32 v26, s55, v22
    v_add_u32 v27, s55, v23
    s_and_b32 s55, s56, 1
    s_mul_i32 s55, s55, 12288
    v_add_u32 v29, s55, v28
    s_add_u32 s37, s37, 1
    s_mov_b32 m0, s53
    v_add_u32 v24, s44, v20
    v_add_u32 v25, s44, v21
    v_pk_mul_f32 v[148:149], v[210:211], v[210:211]
    v_pk_mul_f32 v[150:151], v[210:211], v[210:211]
    v_pk_mul_f32 v[152:153], v[210:211], v[210:211]
    v_pk_mul_f32 v[154:155], v[210:211], v[210:211]
    v_pk_mul_f32 v[156:157], v[210:211], v[210:211]
    v_pk_mul_f32 v[158:159], v[210:211], v[210:211]
    v_pk_mul_f32 v[160:161], v[210:211], v[210:211]
    v_pk_mul_f32 v[162:163], v[210:211], v[210:211]
    v_mov_b32 v120, 0
    v_mov_b32 v121, 0
    v_mov_b32 v122, 0
    v_mov_b32 v123, 0
    v_mov_b32 v124, 0
    v_mov_b32 v125, 0
    v_mov_b32 v126, 0
    v_mov_b32 v127, 0
    v_mov_b32 v128, 0
    v_mov_b32 v129, 0
    v_mov_b32 v130, 0
    v_mov_b32 v131, 0
    v_mov_b32 v132, 0
    v_mov_b32 v133, 0
    v_mov_b32 v134, 0
    v_mov_b32 v135, 0
    v_mov_b32 v116, 0
    v_mov_b32 v117, 0
    v_mov_b32 v118, 0
    v_mov_b32 v119, 0
L_wo_loop_f:
    buffer_load_dword v41, v245, s[4:7], s38 offen sc1
    buffer_load_dword v41, v245, s[4:7], s38 offen sc1
    buffer_load_dword v41, v245, s[4:7], s38 offen sc1
    buffer_load_dword v41, v245, s[4:7], s38 offen sc1
    buffer_load_dword v41, v245, s[4:7], s38 offen sc1
    buffer_load_dword v41, v245, s[4:7], s38 offen sc1
L_sp_41:
    s_waitcnt vmcnt(5)
    v_cmp_ge_u32 vcc, s37, v41
    buffer_load_dword v41, v245, s[4:7], s38 offen sc1
    s_sub_u32 s36, s36, 1
    s_cbranch_scc1 L_exit
    s_cbranch_vccz L_sp_41x
    s_waitcnt vmcnt(5)
    v_cmp_ge_u32 vcc, s37, v41
    buffer_load_dword v41, v245, s[4:7], s38 offen sc1
    s_cbranch_vccz L_sp_41x
    s_waitcnt vmcnt(5)
    v_cmp_ge_u32 vcc, s37, v41
    buffer_load_dword v41, v245, s[4:7], s38 offen sc1
    s_cbranch_vccz L_sp_41x
    s_waitcnt vmcnt(5)
    v_cmp_ge_u32 vcc, s37, v41
    buffer_load_dword v41, v245, s[4:7], s38 offen sc1
    s_cbranch_vccnz L_sp_41
L_sp_41x:
    buffer_store_dword v107, v45, s[4:7], s38 offen
    buffer_load_dwordx4 v44, s[4:7], s43 offen offset:0 sc1 lds
    buffer_load_dwordx4 v44, s[4:7], s43 offen offset:1024 sc1 lds
    buffer_load_dwordx4 v44, s[4:7], s43 offen offset:2048 sc1 lds
    s_cmp_eq_u32 s37, 63
    s_waitcnt vmcnt(2)
    ds_read_b64_tr_b16 v[136:137], v16 offset:0
    ds_read_b64_tr_b16 v[138:139], v13 offset:0
    s_waitcnt vmcnt(1)
    ds_read_b64_tr_b16 v[140:141], v16 offset:1024
    ds_read_b64_tr_b16 v[142:143], v13 offset:1024
    s_waitcnt vmcnt(0)
    ds_read_b64_tr_b16 v[144:145], v16 offset:2048
    ds_read_b64_tr_b16 v[146:147], v13 offset:2048
    buffer_load_dwordx4 v[92:95], v38, s[4:7], s43 offen offset:0 sc1
    buffer_load_dwordx4 v[96:99], v38, s[4:7], s43 offen offset:1280 sc1
    buffer_load_dwordx4 v[100:103], v38, s[4:7], s43 offen offset:2560 sc1
    s_waitcnt lgkmcnt(4)
    v_smfmac_f32_16x16x64_bf16 v[148:151], v[136:139], a[0:7], v10
    v_smfmac_f32_16x16x64_bf16 v[152:155], v[136:139], a[24:31], v10
    v_smfmac_f32_16x16x64_bf16 v[156:159], v[136:139], a[48:55], v10
    v_smfmac_f32_16x16x64_bf16 v[160:163], v[136:139], a[72:79], v10
    buffer_load_dword v104, v39, s[4:7], s43 offen offset:0 sc1
    s_waitcnt lgkmcnt(2)
    v_smfmac_f32_16x16x64_bf16 v[148:151], v[140:143], a[8:15], v10
    buffer_load_dword v105, v39, s[4:7], s43 offen offset:1280 sc1
    v_smfmac_f32_16x16x64_bf16 v[152:155], v[140:143], a[32:39], v10
    buffer_load_dword v106, v39, s[4:7], s43 offen offset:2560 sc1
    v_smfmac_f32_16x16x64_bf16 v[156:159], v[140:143], a[56:63], v10
    v_smfmac_f32_16x16x64_bf16 v[160:163], v[140:143], a[80:87], v10
    s_waitcnt lgkmcnt(0)
    v_smfmac_f32_16x16x64_bf16 v[148:151], v[144:147], a[16:23], v10
    v_smfmac_f32_16x16x64_bf16 v[152:155], v[144:147], a[40:47], v10
    v_smfmac_f32_16x16x64_bf16 v[156:159], v[144:147], a[64:71], v10
    v_smfmac_f32_16x16x64_bf16 v[160:163], v[144:147], a[88:95], v10
    v_pk_add_f32 v[148:149], v[148:149], v[150:151]
    v_cmp_u_f32 vcc, v148, v149
    v_cvt_pk_bf16_f32 v50, v148, v149
    v_cvt_pk_bf16_f32 v54, v148, v149
    v_pk_add_f32 v[152:153], v[152:153], v[154:155]
    v_cvt_pk_bf16_f32 v58, v152, v153
    v_cvt_pk_bf16_f32 v62, v152, v153
    v_pk_add_f32 v[156:157], v[156:157], v[158:159]
    v_cvt_pk_bf16_f32 v66, v156, v157
    v_cvt_pk_bf16_f32 v70, v156, v157
    v_pk_add_f32 v[160:161], v[160:161], v[162:163]
    v_cvt_pk_bf16_f32 v74, v160, v161
    v_cvt_pk_bf16_f32 v78, v160, v161
    s_cbranch_vccnz L_vm_39
L_u_40:
    s_cbranch_scc1 L_wo_tail_f
L_sc_42:
    s_waitcnt vmcnt(4)
    v_pk_add_f32 v[236:237], v[92:93], v[96:97]
    v_pk_add_f32 v[238:239], v[94:95], v[98:99]
    s_waitcnt vmcnt(3)
    v_pk_add_f32 v[236:237], v[236:237], v[100:101]
    v_pk_add_f32 v[238:239], v[238:239], v[102:103]
    v_pk_mul_f32 v[236:237], v[236:237], v[240:241]
    v_pk_mul_f32 v[238:239], v[238:239], v[240:241]
    v_max3_f32 v41, v236, v237, v238
    v_pk_add_f32 v[242:243], v[236:237], v[238:239]
    s_waitcnt vmcnt(0)
    v_add_f32 v43, v104, v105
    v_add_f32 v43, v43, v106
    v_mul_f32 v43, v43, v240
    v_max3_f32 v41, v41, v239, v43
    v_add_f32 v242, v242, v43
    s_nop 0
    v_max_f32_dpp v42, v41, v41 quad_perm:[2,3,0,1] row_mask:0xf bank_mask:0xf
    v_max_f32_dpp v41, v41, v41 quad_perm:[2,3,0,1] row_mask:0xf bank_mask:0xf
    v_cmp_u_f32 vcc, v242, v243
    s_nop 0
    v_permlane16_swap_b32 v41, v42
    v_max_f32 v41, v41, v42
    v_mov_b32 v42, v41
    s_cbranch_vccnz L_sp_43
L_sg_44:
    s_nop 0
    v_permlane32_swap_b32 v41, v42
    v_max_f32 v242, v41, v42
    v_pk_add_f32 v[236:237], v[236:237], v[242:243] op_sel_hi:[1,0] neg_lo:[0,1] neg_hi:[0,1]
    v_pk_add_f32 v[238:239], v[238:239], v[242:243] op_sel_hi:[1,0] neg_lo:[0,1] neg_hi:[0,1]
    v_sub_f32 v43, v43, v242
    v_exp_f32 v236, v236
    v_exp_f32 v237, v237
    v_exp_f32 v238, v238
    v_exp_f32 v239, v239
    v_exp_f32 v43, v43
    v_cvt_pk_bf16_f32 v80, v236, v237
    v_cvt_pk_bf16_f32 v82, v238, v239
    v_cvt_pk_bf16_f32 v81, v43, 0
    v_cvt_pk_bf16_f32 v83, v43, 0
    s_nop 1
    v_smfmac_f32_16x16x64_bf16 v[116:119], v[80:83], v[84:91], v11
    v_smfmac_f32_16x16x64_bf16 v[120:123], v[80:83], v[48:55], v11
    v_smfmac_f32_16x16x64_bf16 v[124:127], v[80:83], v[56:63], v11
    v_smfmac_f32_16x16x64_bf16 v[128:131], v[80:83], v[64:71], v11
    v_add_f32 v116, v116, v118
    v_add_f32 v117, v117, v119
    v_smfmac_f32_16x16x64_bf16 v[132:135], v[80:83], v[72:79], v11
    v_rcp_f32 v116, v116
    v_rcp_f32 v117, v117
    v_pk_add_f32 v[120:121], v[120:121], v[122:123]
    v_pk_mul_f32 v[120:121], v[120:121], v[116:117]
    v_cvt_pk_bf16_f32 v236, v120, v121
    v_pk_add_f32 v[124:125], v[124:125], v[126:127]
    v_pk_mul_f32 v[124:125], v[124:125], v[116:117]
    v_cvt_pk_bf16_f32 v237, v124, v125
    ds_write2st64_b32 v18, v236, v237 offset0:0 offset1:1
    v_pk_add_f32 v[128:129], v[128:129], v[130:131]
    v_pk_mul_f32 v[128:129], v[128:129], v[116:117]
    v_cvt_pk_bf16_f32 v238, v128, v129
    v_pk_add_f32 v[132:133], v[132:133], v[134:135]
    v_pk_mul_f32 v[132:133], v[132:133], v[116:117]
    v_cvt_pk_bf16_f32 v239, v132, v133
    ds_write2st64_b32 v18, v238, v239 offset0:2 offset1:3
    buffer_store_dword v107, v244, s[4:7], s38 offen
    v_mov_b32 v120, 0
    v_mov_b32 v121, 0
    v_mov_b32 v122, 0
    v_mov_b32 v123, 0
    v_mov_b32 v124, 0
    v_mov_b32 v125, 0
    v_mov_b32 v126, 0
    v_mov_b32 v127, 0
    v_mov_b32 v128, 0
    v_mov_b32 v129, 0
    s_waitcnt lgkmcnt(0)
    s_barrier
    ds_read_b64_tr_b16 v[80:81], v19
    ds_read_b64_tr_b16 v[82:83], v19 offset:128
    v_mov_b32 v130, 0
    v_mov_b32 v131, 0
    v_mov_b32 v132, 0
    v_mov_b32 v133, 0
    v_mov_b32 v134, 0
    v_mov_b32 v135, 0
    v_mov_b32 v116, 0
    v_mov_b32 v117, 0
    v_mov_b32 v118, 0
    v_mov_b32 v119, 0
    s_waitcnt lgkmcnt(0)
    v_mfma_f32_16x16x32_bf16 v[172:175], v[110:113], v[80:83], 0
    v_mfma_f32_16x16x32_bf16 v[176:179], v[108:111], v[80:83], 0
    buffer_load_dword v36, v33, s[4:7], s38 offen sc1
    s_nop 3
    v_cvt_pk_bf16_f32 v236, v172, v173
    v_cvt_pk_bf16_f32 v237, v174, v175
    s_nop 0
    v_cvt_pk_bf16_f32 v238, v176, v177
    v_cvt_pk_bf16_f32 v239, v178, v179
    buffer_store_dwordx4 v[236:239], v14, s[4:7], s41 offen sc1
    ds_write_b32 v47, v50 offset:8
    ds_write_b32 v47, v58 offset:6152
    ds_write_b32 v47, v66 offset:12296
    ds_write_b32 v47, v74 offset:18440
    ds_read_b128 v[204:207], v26 offset:0
    ds_read_b128 v[180:183], v29 offset:0
    ds_read_b128 v[184:187], v29 offset:1024
    ds_read_b64 v[208:209], v27 offset:0
    ds_read_b128 v[188:191], v29 offset:2048
    ds_read_b128 v[212:215], v26 offset:1536
    ds_read_b128 v[192:195], v29 offset:3072
    ds_read_b128 v[196:199], v29 offset:4096
    ds_read_b64 v[216:217], v27 offset:1536
    ds_read_b128 v[200:203], v29 offset:5120
    s_add_u32 s55, s42, s60
    buffer_store_dword v168, v46, s[4:7], s55 offen sc1
    s_add_u32 s55, s42, s61
    buffer_store_dword v168, v46, s[4:7], s55 offen sc1
    s_waitcnt lgkmcnt(5)
    v_mfma_f32_16x16x32_bf16 v[220:223], v[180:183], v[204:207], 0
    v_mfma_f32_16x16x32_bf16 v[224:227], v[184:187], v[204:207], 0
    v_mfma_f32_16x16x32_bf16 v[224:227], v[188:191], v[208:211], v[224:227]
    ds_read_b128 v[204:207], v26 offset:3072
    ds_read_b128 v[180:183], v29 offset:6144
    ds_read_b128 v[184:187], v29 offset:7168
    ds_read_b64 v[208:209], v27 offset:3072
    ds_read_b128 v[188:191], v29 offset:8192
    s_add_u32 s56, s37, 2
    s_and_b32 s55, s56, 3
    s_mul_i32 s55, s55, 114688
    s_add_u32 s55, s55, 65536
    s_add_u32 s45, s38, s55
    s_add_u32 s46, s45, 4096
    s_add_u32 s47, s45, 8192
    s_add_u32 s56, s37, -1
    s_and_b32 s55, s56, 3
    s_mul_i32 s55, s55, 114688
    s_add_u32 s55, s55, 53248
    s_add_u32 s48, s38, s55
    s_and_b32 s55, s56, 1
    s_add_u32 s56, s56, 1
    v_mov_b32 v35, -16
    v_writelane_b32 v35, s56, 12
    s_mul_i32 s55, s55, 12288
    s_add_u32 m0, s54, s55
    s_waitcnt lgkmcnt(5)
    v_mfma_f32_16x16x32_bf16 v[220:223], v[192:195], v[212:215], v[220:223]
    v_mfma_f32_16x16x32_bf16 v[224:227], v[196:199], v[212:215], v[224:227]
    v_mfma_f32_16x16x32_bf16 v[224:227], v[200:203], v[216:219], v[224:227]
    ds_read_b128 v[212:215], v26 offset:4608
    ds_read_b128 v[192:195], v29 offset:9216
    ds_read_b128 v[196:199], v29 offset:10240
    ds_read_b64 v[216:217], v27 offset:4608
    ds_read_b128 v[200:203], v29 offset:11264
    s_waitcnt lgkmcnt(5)
    v_mfma_f32_16x16x32_bf16 v[220:223], v[180:183], v[204:207], v[220:223]
    v_mfma_f32_16x16x32_bf16 v[224:227], v[184:187], v[204:207], v[224:227]
    v_mfma_f32_16x16x32_bf16 v[224:227], v[188:191], v[208:211], v[224:227]
    s_waitcnt lgkmcnt(0)
    v_mfma_f32_16x16x32_bf16 v[220:223], v[192:195], v[212:215], v[220:223]
    v_mfma_f32_16x16x32_bf16 v[224:227], v[196:199], v[212:215], v[224:227]
    v_mfma_f32_16x16x32_bf16 v[224:227], v[200:203], v[216:219], v[224:227]
    s_waitcnt vmcnt(3)
    v_cmp_lt_i32 vcc, v36, v35
    s_cbranch_vccz L_fok_47
L_fw_46:
    buffer_load_dword v36, v33, s[4:7], s38 offen sc1
    s_sub_u32 s36, s36, 1
    s_cbranch_scc1 L_exit
    s_waitcnt vmcnt(0)
    v_cmp_lt_i32 vcc, v36, v35
    s_cbranch_vccnz L_fw_46
L_fok_47:
    buffer_load_dwordx4 v37, s[4:7], s48 offen offset:0 sc1 lds
    buffer_load_dwordx4 v37, s[4:7], s48 offen offset:1024 sc1 lds
    buffer_load_dwordx4 v37, s[4:7], s48 offen offset:2048 sc1 lds
    v_cvt_pk_bf16_f32 v220, v220, v221
    v_cvt_pk_bf16_f32 v221, v222, v223
    v_cvt_pk_bf16_f32 v222, v224, v225
    v_cvt_pk_bf16_f32 v223, v226, v227
    v_mov_b32 v224, v220
    v_mov_b32 v225, v221
    v_mov_b32_dpp v220, v222 row_ror:8 row_mask:0xf bank_mask:0xc
    v_mov_b32_dpp v221, v223 row_ror:8 row_mask:0xf bank_mask:0xc
    v_mov_b32_dpp v222, v224 row_ror:8 row_mask:0xf bank_mask:0x3
    v_mov_b32_dpp v223, v225 row_ror:8 row_mask:0xf bank_mask:0x3
    buffer_store_dwordx4 v[220:223], v15, s[4:7], s49 offen
    v_mfma_f32_16x16x32_bf16 v[148:151], a[96:99], a[0:3], 0
    s_mov_b32 s50, s42
    s_add_u32 s56, s37, 1
    v_mov_b32 v47, v24
    v_mfma_f32_16x16x32_bf16 v[152:155], a[120:123], a[0:3], 0
    s_and_b32 s55, s56, 3
    s_mul_i32 s41, s55, 327680
    s_mul_i32 s56, s55, 114688
    v_mfma_f32_16x16x32_bf16 v[156:159], a[96:99], a[24:27], 0
    s_add_u32 s43, s38, s56
    s_xor_b32 s55, s55, 2
    s_mul_i32 s42, s55, 327680
    v_mfma_f32_16x16x32_bf16 v[160:163], a[120:123], a[24:27], 0
    s_add_u32 s56, s37, 2
    v_mov_b32 v107, s56
    s_and_b32 s55, s56, 3
    v_mfma_f32_16x16x32_bf16 v[180:183], a[96:99], a[48:51], 0
    s_mul_i32 s44, s55, 24576
    s_add_u32 s56, s37, -1
    s_and_b32 s55, s56, 3
    v_mfma_f32_16x16x32_bf16 v[184:187], a[120:123], a[48:51], 0
    s_mul_i32 s55, s55, 40960
    s_add_u32 s49, s55, s38
    s_add_u32 s56, s37, -1
    v_mfma_f32_16x16x32_bf16 v[188:191], a[96:99], a[72:75], 0
    s_and_b32 s55, s56, 3
    s_mul_i32 s55, s55, 24576
    v_add_u32 v26, s55, v22
    v_mfma_f32_16x16x32_bf16 v[192:195], a[120:123], a[72:75], 0
    buffer_load_dwordx4 a[96:99], v40, s[4:7], s45 offen offset:0 sc1
    v_mfma_f32_16x16x32_bf16 v[148:151], a[100:103], a[4:7], v[148:151]
    v_add_u32 v27, s55, v23
    s_and_b32 s55, s56, 1
    s_mul_i32 s55, s55, 12288
    v_mfma_f32_16x16x32_bf16 v[152:155], a[124:127], a[4:7], v[152:155]
    buffer_load_dwordx4 a[120:123], v40, s[4:7], s46 offen offset:2048 sc1
    v_mfma_f32_16x16x32_bf16 v[156:159], a[100:103], a[28:31], v[156:159]
    v_add_u32 v29, s55, v28
    v_mfma_f32_16x16x32_bf16 v[160:163], a[124:127], a[28:31], v[160:163]
    v_mfma_f32_16x16x32_bf16 v[180:183], a[100:103], a[52:55], v[180:183]
    v_mfma_f32_16x16x32_bf16 v[184:187], a[124:127], a[52:55], v[184:187]
    v_mfma_f32_16x16x32_bf16 v[188:191], a[100:103], a[76:79], v[188:191]
    v_mfma_f32_16x16x32_bf16 v[192:195], a[124:127], a[76:79], v[192:195]
    buffer_load_dwordx4 a[100:103], v40, s[4:7], s45 offen offset:1024 sc1
    v_mfma_f32_16x16x32_bf16 v[148:151], a[104:107], a[8:11], v[148:151]
    v_mfma_f32_16x16x32_bf16 v[152:155], a[128:131], a[8:11], v[152:155]
    buffer_load_dwordx4 a[124:127], v40, s[4:7], s46 offen offset:3072 sc1
    v_mfma_f32_16x16x32_bf16 v[156:159], a[104:107], a[32:35], v[156:159]
    v_mfma_f32_16x16x32_bf16 v[160:163], a[128:131], a[32:35], v[160:163]
    v_mfma_f32_16x16x32_bf16 v[180:183], a[104:107], a[56:59], v[180:183]
    v_mfma_f32_16x16x32_bf16 v[184:187], a[128:131], a[56:59], v[184:187]
    v_mfma_f32_16x16x32_bf16 v[188:191], a[104:107], a[80:83], v[188:191]
    v_mfma_f32_16x16x32_bf16 v[192:195], a[128:131], a[80:83], v[192:195]
    buffer_load_dwordx4 a[104:107], v40, s[4:7], s45 offen offset:2048 sc1
    v_mfma_f32_16x16x32_bf16 v[148:151], a[108:111], a[12:15], v[148:151]
    v_mfma_f32_16x16x32_bf16 v[152:155], a[132:135], a[12:15], v[152:155]
    buffer_load_dwordx4 a[128:131], v40, s[4:7], s47 offen offset:0 sc1
    v_mfma_f32_16x16x32_bf16 v[156:159], a[108:111], a[36:39], v[156:159]
    v_mfma_f32_16x16x32_bf16 v[160:163], a[132:135], a[36:39], v[160:163]
    v_mfma_f32_16x16x32_bf16 v[180:183], a[108:111], a[60:63], v[180:183]
    v_mfma_f32_16x16x32_bf16 v[184:187], a[132:135], a[60:63], v[184:187]
    v_mfma_f32_16x16x32_bf16 v[188:191], a[108:111], a[84:87], v[188:191]
    v_mfma_f32_16x16x32_bf16 v[192:195], a[132:135], a[84:87], v[192:195]
    buffer_load_dwordx4 a[108:111], v40, s[4:7], s45 offen offset:3072 sc1
    v_mfma_f32_16x16x32_bf16 v[148:151], a[112:115], a[16:19], v[148:151]
    v_mfma_f32_16x16x32_bf16 v[152:155], a[136:139], a[16:19], v[152:155]
    buffer_load_dwordx4 a[132:135], v40, s[4:7], s47 offen offset:1024 sc1
    v_mfma_f32_16x16x32_bf16 v[156:159], a[112:115], a[40:43], v[156:159]
    v_mfma_f32_16x16x32_bf16 v[160:163], a[136:139], a[40:43], v[160:163]
    v_mfma_f32_16x16x32_bf16 v[180:183], a[112:115], a[64:67], v[180:183]
    v_mfma_f32_16x16x32_bf16 v[184:187], a[136:139], a[64:67], v[184:187]
    v_mfma_f32_16x16x32_bf16 v[188:191], a[112:115], a[88:91], v[188:191]
    v_mfma_f32_16x16x32_bf16 v[192:195], a[136:139], a[88:91], v[192:195]
    buffer_load_dwordx4 a[112:115], v40, s[4:7], s46 offen offset:0 sc1
    v_mfma_f32_16x16x32_bf16 v[148:151], a[116:119], a[20:23], v[148:151]
    v_mfma_f32_16x16x32_bf16 v[152:155], a[140:143], a[20:23], v[152:155]
    v_mfma_f32_16x16x32_bf16 v[156:159], a[116:119], a[44:47], v[156:159]
    v_mfma_f32_16x16x32_bf16 v[160:163], a[140:143], a[44:47], v[160:163]
    v_mfma_f32_16x16x32_bf16 v[180:183], a[116:119], a[68:71], v[180:183]
    v_mfma_f32_16x16x32_bf16 v[184:187], a[140:143], a[68:71], v[184:187]
    v_mfma_f32_16x16x32_bf16 v[188:191], a[116:119], a[92:95], v[188:191]
    v_mfma_f32_16x16x32_bf16 v[192:195], a[140:143], a[92:95], v[192:195]
    v_cvt_pk_bf16_f32 v64, v180, v181
    v_cvt_pk_bf16_f32 v65, v182, v183
    ds_write_b64 v24, v[64:65] offset:12288
    v_cvt_pk_bf16_f32 v68, v184, v185
    v_cvt_pk_bf16_f32 v69, v186, v187
    ds_write_b64 v25, v[68:69] offset:12288
    v_cvt_pk_bf16_f32 v72, v188, v189
    v_cvt_pk_bf16_f32 v73, v190, v191
    ds_write_b64 v24, v[72:73] offset:18432
    v_cvt_pk_bf16_f32 v76, v192, v193
    v_cvt_pk_bf16_f32 v77, v194, v195
    ds_write_b64 v25, v[76:77] offset:18432
    v_cvt_pk_bf16_f32 v48, v148, v149
    v_cvt_pk_bf16_f32 v49, v150, v151
    ds_write_b64 v24, v[48:49] offset:0
    v_cvt_pk_bf16_f32 v52, v152, v153
    v_cvt_pk_bf16_f32 v53, v154, v155
    ds_write_b64 v25, v[52:53] offset:0
    v_cvt_pk_bf16_f32 v56, v156, v157
    v_cvt_pk_bf16_f32 v57, v158, v159
    ds_write_b64 v24, v[56:57] offset:6144
    v_cvt_pk_bf16_f32 v60, v160, v161
    v_cvt_pk_bf16_f32 v61, v162, v163
    ds_write_b64 v25, v[60:61] offset:6144
    s_add_u32 s37, s37, 1
    s_mov_b32 m0, s53
    v_add_u32 v24, s44, v20
    v_add_u32 v25, s44, v21
    v_pk_mul_f32 v[148:149], v[210:211], v[210:211]
    v_pk_mul_f32 v[150:151], v[210:211], v[210:211]
    v_pk_mul_f32 v[152:153], v[210:211], v[210:211]
    v_pk_mul_f32 v[154:155], v[210:211], v[210:211]
    v_pk_mul_f32 v[156:157], v[210:211], v[210:211]
    v_pk_mul_f32 v[158:159], v[210:211], v[210:211]
    v_pk_mul_f32 v[160:161], v[210:211], v[210:211]
    v_pk_mul_f32 v[162:163], v[210:211], v[210:211]
    buffer_load_dwordx4 a[136:139], v40, s[4:7], s47 offen offset:2048 sc1
    buffer_load_dwordx4 a[116:119], v40, s[4:7], s46 offen offset:1024 sc1
    buffer_load_dwordx4 a[140:143], v40, s[4:7], s47 offen offset:3072 sc1
    s_branch L_wo_loop_f
L_wo_tail_f:
    ds_write_b32 v47, v50 offset:8
    ds_write_b32 v47, v58 offset:6152
    ds_write_b32 v47, v66 offset:12296
    ds_write_b32 v47, v74 offset:18440
    s_add_u32 s91, s38, 81920
    buffer_load_dwordx4 v[120:123], v15, s[4:7], s91 offen sc1
    s_add_u32 s91, s38, 122880
    buffer_load_dwordx4 v[124:127], v15, s[4:7], s91 offen sc1
    s_add_u32 s56, s37, -1
    s_and_b32 s55, s56, 3
    s_mul_i32 s55, s55, 114688
    s_add_u32 s55, s55, 53248
    s_add_u32 s48, s38, s55
    s_and_b32 s55, s56, 1
    s_add_u32 s56, s56, 1
    v_mov_b32 v35, -16
    v_writelane_b32 v35, s56, 12
    s_mul_i32 s55, s55, 12288
    s_add_u32 m0, s54, s55
    buffer_load_dword v36, v33, s[4:7], s38 offen sc1
    v_mov_b32 v3, 200
L_p0_48:
    buffer_load_dword v4, v3, s[8:11], 0 offen sc1
    s_sub_u32 s36, s36, 1
    s_cbranch_scc1 L_exit
    s_waitcnt vmcnt(0)
    v_readfirstlane_b32 s90, v4
    s_nop 0
    s_cmp_eq_u32 s90, 0
    s_cbranch_scc1 L_p0_48
    s_and_b32 s90, s90, 2
    s_lshl_b32 s90, s90, 12
    v_xor_b32 v30, s90, v30
    v_xor_b32 v31, s90, v31
    s_waitcnt lgkmcnt(0)
    s_barrier
    v_cmp_lt_i32 vcc, v36, v35
    s_cbranch_vccz L_fok_50
L_fw_49:
    buffer_load_dword v36, v33, s[4:7], s38 offen sc1
    s_sub_u32 s36, s36, 1
    s_cbranch_scc1 L_exit
    s_waitcnt vmcnt(0)
    v_cmp_lt_i32 vcc, v36, v35
    s_cbranch_vccnz L_fw_49
L_fok_50:
    buffer_load_dwordx4 v37, s[4:7], s48 offen offset:0 sc1 lds
    buffer_load_dwordx4 v37, s[4:7], s48 offen offset:1024 sc1 lds
    buffer_load_dwordx4 v37, s[4:7], s48 offen offset:2048 sc1 lds
    v_mov_b32 v128, v220
    v_mov_b32 v129, v221
    v_mov_b32 v130, v222
    v_mov_b32 v131, v223
    s_add_u32 s56, s37, -2
    s_and_b32 s55, s56, 3
    s_mul_i32 s55, s55, 24576
    v_add_u32 v26, s55, v22
    v_add_u32 v27, s55, v23
    s_and_b32 s55, s56, 1
    s_mul_i32 s55, s55, 12288
    v_add_u32 v29, s55, v28
    ds_read_b128 v[204:207], v26 offset:0
    ds_read_b128 v[180:183], v29 offset:0
    ds_read_b128 v[184:187], v29 offset:1024
    ds_read_b64 v[208:209], v27 offset:0
    ds_read_b128 v[188:191], v29 offset:2048
    ds_read_b128 v[212:215], v26 offset:1536
    ds_read_b128 v[192:195], v29 offset:3072
    ds_read_b128 v[196:199], v29 offset:4096
    ds_read_b64 v[216:217], v27 offset:1536
    ds_read_b128 v[200:203], v29 offset:5120
    s_waitcnt lgkmcnt(5)
    v_mfma_f32_16x16x32_bf16 v[220:223], v[180:183], v[204:207], 0
    v_mfma_f32_16x16x32_bf16 v[224:227], v[184:187], v[204:207], 0
    v_mfma_f32_16x16x32_bf16 v[224:227], v[188:191], v[208:211], v[224:227]
    ds_read_b128 v[204:207], v26 offset:3072
    ds_read_b128 v[180:183], v29 offset:6144
    ds_read_b128 v[184:187], v29 offset:7168
    ds_read_b64 v[208:209], v27 offset:3072
    ds_read_b128 v[188:191], v29 offset:8192
    s_waitcnt lgkmcnt(5)
    v_mfma_f32_16x16x32_bf16 v[220:223], v[192:195], v[212:215], v[220:223]
    v_mfma_f32_16x16x32_bf16 v[224:227], v[196:199], v[212:215], v[224:227]
    v_mfma_f32_16x16x32_bf16 v[224:227], v[200:203], v[216:219], v[224:227]
    ds_read_b128 v[212:215], v26 offset:4608
    ds_read_b128 v[192:195], v29 offset:9216
    ds_read_b128 v[196:199], v29 offset:10240
    ds_read_b64 v[216:217], v27 offset:4608
    ds_read_b128 v[200:203], v29 offset:11264
    s_waitcnt lgkmcnt(5)
    v_mfma_f32_16x16x32_bf16 v[220:223], v[180:183], v[204:207], v[220:223]
    v_mfma_f32_16x16x32_bf16 v[224:227], v[184:187], v[204:207], v[224:227]
    v_mfma_f32_16x16x32_bf16 v[224:227], v[188:191], v[208:211], v[224:227]
    s_waitcnt lgkmcnt(0)
    v_mfma_f32_16x16x32_bf16 v[220:223], v[192:195], v[212:215], v[220:223]
    v_mfma_f32_16x16x32_bf16 v[224:227], v[196:199], v[212:215], v[224:227]
    v_mfma_f32_16x16x32_bf16 v[224:227], v[200:203], v[216:219], v[224:227]
    s_nop 0
    v_cvt_pk_bf16_f32 v220, v220, v221
    v_cvt_pk_bf16_f32 v221, v222, v223
    s_nop 4
    v_cvt_pk_bf16_f32 v222, v224, v225
    v_cvt_pk_bf16_f32 v223, v226, v227
    v_mov_b32 v224, v220
    v_mov_b32 v225, v221
    v_mov_b32_dpp v220, v222 row_ror:8 row_mask:0xf bank_mask:0xc
    v_mov_b32_dpp v221, v223 row_ror:8 row_mask:0xf bank_mask:0xc
    v_mov_b32_dpp v222, v224 row_ror:8 row_mask:0xf bank_mask:0x3
    v_mov_b32_dpp v223, v225 row_ror:8 row_mask:0xf bank_mask:0x3
    v_mov_b32 v132, v220
    v_mov_b32 v133, v221
    v_mov_b32 v134, v222
    v_mov_b32 v135, v223
    s_waitcnt vmcnt(0)
    s_barrier
    s_add_u32 s56, s37, -1
    s_and_b32 s55, s56, 3
    s_mul_i32 s55, s55, 24576
    v_add_u32 v26, s55, v22
    v_add_u32 v27, s55, v23
    s_and_b32 s55, s56, 1
    s_mul_i32 s55, s55, 12288
    v_add_u32 v29, s55, v28
    ds_read_b128 v[204:207], v26 offset:0
    ds_read_b128 v[180:183], v29 offset:0
    ds_read_b128 v[184:187], v29 offset:1024
    ds_read_b64 v[208:209], v27 offset:0
    ds_read_b128 v[188:191], v29 offset:2048
    ds_read_b128 v[212:215], v26 offset:1536
    ds_read_b128 v[192:195], v29 offset:3072
    ds_read_b128 v[196:199], v29 offset:4096
    ds_read_b64 v[216:217], v27 offset:1536
    ds_read_b128 v[200:203], v29 offset:5120
    s_waitcnt lgkmcnt(5)
    v_mfma_f32_16x16x32_bf16 v[220:223], v[180:183], v[204:207], 0
    v_mfma_f32_16x16x32_bf16 v[224:227], v[184:187], v[204:207], 0
    v_mfma_f32_16x16x32_bf16 v[224:227], v[188:191], v[208:211], v[224:227]
    ds_read_b128 v[204:207], v26 offset:3072
    ds_read_b128 v[180:183], v29 offset:6144
    ds_read_b128 v[184:187], v29 offset:7168
    ds_read_b64 v[208:209], v27 offset:3072
    ds_read_b128 v[188:191], v29 offset:8192
    s_waitcnt lgkmcnt(5)
    v_mfma_f32_16x16x32_bf16 v[220:223], v[192:195], v[212:215], v[220:223]
    v_mfma_f32_16x16x32_bf16 v[224:227], v[196:199], v[212:215], v[224:227]
    v_mfma_f32_16x16x32_bf16 v[224:227], v[200:203], v[216:219], v[224:227]
    ds_read_b128 v[212:215], v26 offset:4608
    ds_read_b128 v[192:195], v29 offset:9216
    ds_read_b128 v[196:199], v29 offset:10240
    ds_read_b64 v[216:217], v27 offset:4608
    ds_read_b128 v[200:203], v29 offset:11264
    s_waitcnt lgkmcnt(5)
    v_mfma_f32_16x16x32_bf16 v[220:223], v[180:183], v[204:207], v[220:223]
    v_mfma_f32_16x16x32_bf16 v[224:227], v[184:187], v[204:207], v[224:227]
    v_mfma_f32_16x16x32_bf16 v[224:227], v[188:191], v[208:211], v[224:227]
    s_waitcnt lgkmcnt(0)
    v_mfma_f32_16x16x32_bf16 v[220:223], v[192:195], v[212:215], v[220:223]
    v_mfma_f32_16x16x32_bf16 v[224:227], v[196:199], v[212:215], v[224:227]
    v_mfma_f32_16x16x32_bf16 v[224:227], v[200:203], v[216:219], v[224:227]
    s_nop 0
    v_cvt_pk_bf16_f32 v220, v220, v221
    v_cvt_pk_bf16_f32 v221, v222, v223
    s_nop 4
    v_cvt_pk_bf16_f32 v222, v224, v225
    v_cvt_pk_bf16_f32 v223, v226, v227
    v_mov_b32 v224, v220
    v_mov_b32 v225, v221
    v_mov_b32_dpp v220, v222 row_ror:8 row_mask:0xf bank_mask:0xc
    v_mov_b32_dpp v221, v223 row_ror:8 row_mask:0xf bank_mask:0xc
    v_mov_b32_dpp v222, v224 row_ror:8 row_mask:0xf bank_mask:0x3
    v_mov_b32_dpp v223, v225 row_ror:8 row_mask:0xf bank_mask:0x3
    v_mov_b32 v80, v220
    v_mov_b32 v81, v221
    v_mov_b32 v82, v222
    v_mov_b32 v83, v223
    s_add_u32 s56, s37, 0
    s_and_b32 s55, s56, 3
    s_mul_i32 s55, s55, 114688
    s_add_u32 s55, s55, 53248
    s_add_u32 s48, s38, s55
    s_and_b32 s55, s56, 1
    s_add_u32 s56, s56, 1
    v_mov_b32 v35, -16
    v_writelane_b32 v35, s56, 12
    s_mul_i32 s55, s55, 12288
    s_add_u32 m0, s54, s55
    s_add_u32 s56, s37, 0
    s_and_b32 s55, s56, 3
    s_mul_i32 s55, s55, 24576
    v_add_u32 v26, s55, v22
    v_add_u32 v27, s55, v23
    s_and_b32 s55, s56, 1
    s_mul_i32 s55, s55, 12288
    v_add_u32 v29, s55, v28
    buffer_load_dword v36, v33, s[4:7], s38 offen sc1
    buffer_load_dword v36, v33, s[4:7], s38 offen sc1
    buffer_load_dword v36, v33, s[4:7], s38 offen sc1
    buffer_load_dword v36, v33, s[4:7], s38 offen sc1
    buffer_load_dword v36, v33, s[4:7], s38 offen sc1
L_sp_51:
    s_waitcnt vmcnt(4)
    v_cmp_lt_i32 vcc, v36, v35
    buffer_load_dword v36, v33, s[4:7], s38 offen sc1
    s_sub_u32 s36, s36, 1
    s_cbranch_scc1 L_exit
    s_cbranch_vccz L_sp_51x
    s_waitcnt vmcnt(4)
    v_cmp_lt_i32 vcc, v36, v35
    buffer_load_dword v36, v33, s[4:7], s38 offen sc1
    s_cbranch_vccz L_sp_51x
    s_waitcnt vmcnt(4)
    v_cmp_lt_i32 vcc, v36, v35
    buffer_load_dword v36, v33, s[4:7], s38 offen sc1
    s_cbranch_vccz L_sp_51x
    s_waitcnt vmcnt(4)
    v_cmp_lt_i32 vcc, v36, v35
    buffer_load_dword v36, v33, s[4:7], s38 offen sc1
    s_cbranch_vccnz L_sp_51
L_sp_51x:
    buffer_load_dwordx4 v37, s[4:7], s48 offen offset:0 sc1 lds
    buffer_load_dwordx4 v37, s[4:7], s48 offen offset:1024 sc1 lds
    buffer_load_dwordx4 v37, s[4:7], s48 offen offset:2048 sc1 lds
    s_waitcnt vmcnt(0)
    s_barrier
    s_mov_b32 s49, 7143424
    buffer_store_dwordx4 v[120:123], v30, s[4:7], s49 offen sc1
    s_mov_b32 s49, 6815744
    buffer_store_dwordx4 v[124:127], v30, s[4:7], s49 offen sc1
    s_mov_b32 s49, 6488064
    buffer_store_dwordx4 v[128:131], v30, s[4:7], s49 offen sc1
    s_mov_b32 s49, 6160384
    buffer_store_dwordx4 v[132:135], v30, s[4:7], s49 offen sc1
    s_mov_b32 s49, 5832704
    buffer_store_dwordx4 v[80:83], v30, s[4:7], s49 offen sc1
    ds_read_b128 v[204:207], v26 offset:0
    ds_read_b128 v[180:183], v29 offset:0
    ds_read_b128 v[184:187], v29 offset:1024
    ds_read_b64 v[208:209], v27 offset:0
    ds_read_b128 v[188:191], v29 offset:2048
    ds_read_b128 v[212:215], v26 offset:1536
    ds_read_b128 v[192:195], v29 offset:3072
    ds_read_b128 v[196:199], v29 offset:4096
    ds_read_b64 v[216:217], v27 offset:1536
    ds_read_b128 v[200:203], v29 offset:5120
    s_waitcnt lgkmcnt(5)
    v_mfma_f32_16x16x32_bf16 v[220:223], v[180:183], v[204:207], 0
    v_mfma_f32_16x16x32_bf16 v[224:227], v[184:187], v[204:207], 0
    v_mfma_f32_16x16x32_bf16 v[224:227], v[188:191], v[208:211], v[224:227]
    ds_read_b128 v[204:207], v26 offset:3072
    ds_read_b128 v[180:183], v29 offset:6144
    ds_read_b128 v[184:187], v29 offset:7168
    ds_read_b64 v[208:209], v27 offset:3072
    ds_read_b128 v[188:191], v29 offset:8192
    s_waitcnt lgkmcnt(5)
    v_mfma_f32_16x16x32_bf16 v[220:223], v[192:195], v[212:215], v[220:223]
    v_mfma_f32_16x16x32_bf16 v[224:227], v[196:199], v[212:215], v[224:227]
    v_mfma_f32_16x16x32_bf16 v[224:227], v[200:203], v[216:219], v[224:227]
    ds_read_b128 v[212:215], v26 offset:4608
    ds_read_b128 v[192:195], v29 offset:9216
    ds_read_b128 v[196:199], v29 offset:10240
    ds_read_b64 v[216:217], v27 offset:4608
    ds_read_b128 v[200:203], v29 offset:11264
    s_waitcnt lgkmcnt(5)
    v_mfma_f32_16x16x32_bf16 v[220:223], v[180:183], v[204:207], v[220:223]
    v_mfma_f32_16x16x32_bf16 v[224:227], v[184:187], v[204:207], v[224:227]
    v_mfma_f32_16x16x32_bf16 v[224:227], v[188:191], v[208:211], v[224:227]
    s_waitcnt lgkmcnt(0)
    v_mfma_f32_16x16x32_bf16 v[220:223], v[192:195], v[212:215], v[220:223]
    v_mfma_f32_16x16x32_bf16 v[224:227], v[196:199], v[212:215], v[224:227]
    v_mfma_f32_16x16x32_bf16 v[224:227], v[200:203], v[216:219], v[224:227]
    s_nop 0
    v_cvt_pk_bf16_f32 v220, v220, v221
    v_cvt_pk_bf16_f32 v221, v222, v223
    s_nop 4
    v_cvt_pk_bf16_f32 v222, v224, v225
    v_cvt_pk_bf16_f32 v223, v226, v227
    v_mov_b32 v224, v220
    v_mov_b32 v225, v221
    v_mov_b32_dpp v220, v222 row_ror:8 row_mask:0xf bank_mask:0xc
    v_mov_b32_dpp v221, v223 row_ror:8 row_mask:0xf bank_mask:0xc
    v_mov_b32_dpp v222, v224 row_ror:8 row_mask:0xf bank_mask:0x3
    v_mov_b32_dpp v223, v225 row_ror:8 row_mask:0xf bank_mask:0x3
    s_mov_b32 s49, 5505024
    buffer_store_dwordx4 v[220:223], v30, s[4:7], s49 offen sc1
    s_waitcnt vmcnt(0)
L_fp_52:
    s_mov_b32 s51, 5505024
    buffer_load_dwordx4 v[96:99], v31, s[4:7], s51 offen sc1
    s_mov_b32 s51, 7143424
    buffer_load_dwordx4 v[148:151], v31, s[4:7], s51 offen sc1
    s_mov_b32 s51, 6815744
    buffer_load_dwordx4 v[152:155], v31, s[4:7], s51 offen sc1
    s_mov_b32 s51, 6488064
    buffer_load_dwordx4 v[156:159], v31, s[4:7], s51 offen sc1
    s_mov_b32 s51, 6160384
    buffer_load_dwordx4 v[160:163], v31, s[4:7], s51 offen sc1
    s_mov_b32 s51, 5832704
    buffer_load_dwordx4 v[92:95], v31, s[4:7], s51 offen sc1
    s_sub_u32 s36, s36, 1
    s_cbranch_scc1 L_exit
    s_waitcnt vmcnt(0)
L_fp_52c:
    v_mov_b32 v41, 0
    v_max3_u32 v41, v41, v96, v97
    v_max3_u32 v41, v41, v98, v99
    v_max3_u32 v41, v41, v148, v149
    v_max3_u32 v41, v41, v150, v151
    v_max3_u32 v41, v41, v152, v153
    v_max3_u32 v41, v41, v154, v155
    v_max3_u32 v41, v41, v156, v157
    v_max3_u32 v41, v41, v158, v159
    v_max3_u32 v41, v41, v160, v161
    v_max3_u32 v41, v41, v162, v163
    v_max3_u32 v41, v41, v92, v93
    v_max3_u32 v41, v41, v94, v95
    v_cmp_eq_u32 vcc, -1, v41
    s_cbranch_vccnz L_fp_52
    s_mov_b32 s52, 5160960
    v_mfma_f32_16x16x32_bf16 v[232:235], a[144:147], v[96:99], 0
    s_nop 7
    v_cndmask_b32 v234, v232, v233, s[58:59]
    v_cndmask_b32 v235, v233, v232, s[58:59]
    s_nop 1
    v_add_f32_dpp v235, v234, v235 row_ror:8 row_mask:0xf bank_mask:0xf
    v_cvt_pk_bf16_f32 v235, v235, v235
    buffer_store_short v235, v32, s[28:31], s52 offen offset:0
    s_mov_b32 s52, 4751360
    v_mfma_f32_16x16x32_bf16 v[232:235], a[144:147], v[148:151], 0
    s_nop 7
    v_cndmask_b32 v234, v232, v233, s[58:59]
    v_cndmask_b32 v235, v233, v232, s[58:59]
    s_nop 1
    v_add_f32_dpp v235, v234, v235 row_ror:8 row_mask:0xf bank_mask:0xf
    v_cvt_pk_bf16_f32 v235, v235, v235
    buffer_store_short v235, v32, s[28:31], s52 offen offset:0
    s_mov_b32 s52, 4833280
    v_mfma_f32_16x16x32_bf16 v[232:235], a[144:147], v[152:155], 0
    s_nop 7
    v_cndmask_b32 v234, v232, v233, s[58:59]
    v_cndmask_b32 v235, v233, v232, s[58:59]
    s_nop 1
    v_add_f32_dpp v235, v234, v235 row_ror:8 row_mask:0xf bank_mask:0xf
    v_cvt_pk_bf16_f32 v235, v235, v235
    buffer_store_short v235, v32, s[28:31], s52 offen offset:0
    s_mov_b32 s52, 4915200
    v_mfma_f32_16x16x32_bf16 v[232:235], a[144:147], v[156:159], 0
    s_nop 7
    v_cndmask_b32 v234, v232, v233, s[58:59]
    v_cndmask_b32 v235, v233, v232, s[58:59]
    s_nop 1
    v_add_f32_dpp v235, v234, v235 row_ror:8 row_mask:0xf bank_mask:0xf
    v_cvt_pk_bf16_f32 v235, v235, v235
    buffer_store_short v235, v32, s[28:31], s52 offen offset:0
    s_mov_b32 s52, 4997120
    v_mfma_f32_16x16x32_bf16 v[232:235], a[144:147], v[160:163], 0
    s_nop 7
    v_cndmask_b32 v234, v232, v233, s[58:59]
    v_cndmask_b32 v235, v233, v232, s[58:59]
    s_nop 1
    v_add_f32_dpp v235, v234, v235 row_ror:8 row_mask:0xf bank_mask:0xf
    v_cvt_pk_bf16_f32 v235, v235, v235
    buffer_store_short v235, v32, s[28:31], s52 offen offset:0
    s_mov_b32 s52, 5079040
    v_mfma_f32_16x16x32_bf16 v[232:235], a[144:147], v[92:95], 0
    s_nop 7
    v_cndmask_b32 v234, v232, v233, s[58:59]
    v_cndmask_b32 v235, v233, v232, s[58:59]
    s_nop 1
    v_add_f32_dpp v235, v234, v235 row_ror:8 row_mask:0xf bank_mask:0xf
    v_cvt_pk_bf16_f32 v235, v235, v235
    buffer_store_short v235, v32, s[28:31], s52 offen offset:0
    s_endpgm
L_vm_39:
    buffer_load_dwordx4 v44, s[4:7], s43 offen offset:0 sc1 lds
    buffer_load_dwordx4 v44, s[4:7], s43 offen offset:1024 sc1 lds
    buffer_load_dwordx4 v44, s[4:7], s43 offen offset:2048 sc1 lds
    s_sub_u32 s36, s36, 1
    s_cbranch_scc1 L_exit
    v_add_u32 v5, s53, v12
    s_waitcnt vmcnt(0)
    ds_read_b128 v[136:139], v5 offset:0
    ds_read_b128 v[140:143], v5 offset:1024
    ds_read_b128 v[144:147], v5 offset:2048
    s_waitcnt lgkmcnt(0)
    v_max_u32 v4, v136, v137
    v_max3_u32 v4, v4, v138, v139
    v_max3_u32 v4, v4, v140, v141
    v_max3_u32 v4, v4, v142, v143
    v_max3_u32 v4, v4, v144, v145
    v_max3_u32 v4, v4, v146, v147
    v_cmp_eq_u32 vcc, -1, v4
    s_cbranch_vccnz L_vm_39
    buffer_load_dwordx4 v[92:95], v38, s[4:7], s43 offen offset:0 sc1
    buffer_load_dwordx4 v[96:99], v38, s[4:7], s43 offen offset:1280 sc1
    buffer_load_dwordx4 v[100:103], v38, s[4:7], s43 offen offset:2560 sc1
    buffer_load_dword v104, v39, s[4:7], s43 offen offset:0 sc1
    buffer_load_dword v105, v39, s[4:7], s43 offen offset:1280 sc1
    buffer_load_dword v106, v39, s[4:7], s43 offen offset:2560 sc1
    ds_read_b64_tr_b16 v[136:137], v16 offset:0
    ds_read_b64_tr_b16 v[138:139], v13 offset:0
    ds_read_b64_tr_b16 v[140:141], v16 offset:1024
    ds_read_b64_tr_b16 v[142:143], v13 offset:1024
    ds_read_b64_tr_b16 v[144:145], v16 offset:2048
    ds_read_b64_tr_b16 v[146:147], v13 offset:2048
    v_mov_b32 v148, 0
    v_mov_b32 v149, 0
    v_mov_b32 v150, 0
    v_mov_b32 v151, 0
    v_mov_b32 v152, 0
    v_mov_b32 v153, 0
    v_mov_b32 v154, 0
    v_mov_b32 v155, 0
    v_mov_b32 v156, 0
    v_mov_b32 v157, 0
    v_mov_b32 v158, 0
    v_mov_b32 v159, 0
    v_mov_b32 v160, 0
    v_mov_b32 v161, 0
    v_mov_b32 v162, 0
    v_mov_b32 v163, 0
    s_waitcnt lgkmcnt(0)
    v_smfmac_f32_16x16x64_bf16 v[148:151], v[136:139], a[0:7], v10
    v_smfmac_f32_16x16x64_bf16 v[152:155], v[136:139], a[24:31], v10
    v_smfmac_f32_16x16x64_bf16 v[156:159], v[136:139], a[48:55], v10
    v_smfmac_f32_16x16x64_bf16 v[160:163], v[136:139], a[72:79], v10
    v_smfmac_f32_16x16x64_bf16 v[148:151], v[140:143], a[8:15], v10
    v_smfmac_f32_16x16x64_bf16 v[152:155], v[140:143], a[32:39], v10
    v_smfmac_f32_16x16x64_bf16 v[156:159], v[140:143], a[56:63], v10
    v_smfmac_f32_16x16x64_bf16 v[160:163], v[140:143], a[80:87], v10
    v_smfmac_f32_16x16x64_bf16 v[148:151], v[144:147], a[16:23], v10
    v_smfmac_f32_16x16x64_bf16 v[152:155], v[144:147], a[40:47], v10
    v_smfmac_f32_16x16x64_bf16 v[156:159], v[144:147], a[64:71], v10
    v_smfmac_f32_16x16x64_bf16 v[160:163], v[144:147], a[88:95], v10
    v_pk_add_f32 v[148:149], v[148:149], v[150:151]
    v_cmp_u_f32 vcc, v148, v149
    v_cvt_pk_bf16_f32 v50, v148, v149
    v_cvt_pk_bf16_f32 v54, v148, v149
    v_pk_add_f32 v[152:153], v[152:153], v[154:155]
    v_cvt_pk_bf16_f32 v58, v152, v153
    v_cvt_pk_bf16_f32 v62, v152, v153
    v_pk_add_f32 v[156:157], v[156:157], v[158:159]
    v_cvt_pk_bf16_f32 v66, v156, v157
    v_cvt_pk_bf16_f32 v70, v156, v157
    v_pk_add_f32 v[160:161], v[160:161], v[162:163]
    v_cvt_pk_bf16_f32 v74, v160, v161
    v_cvt_pk_bf16_f32 v78, v160, v161
    s_cmp_eq_u32 s37, 63
    s_branch L_u_40
L_sp_43:
    v_max3_u32 v4, v104, v105, v106
    v_max3_u32 v4, v4, v92, v93
    v_max3_u32 v4, v4, v94, v95
    v_max3_u32 v4, v4, v96, v97
    v_max3_u32 v4, v4, v98, v99
    v_max3_u32 v4, v4, v100, v101
    v_max3_u32 v4, v4, v102, v103
    v_cmp_eq_u32 vcc, -1, v4
    s_cbranch_vccz L_sg_44
    buffer_load_dwordx4 v[92:95], v38, s[4:7], s43 offen offset:0 sc1
    buffer_load_dwordx4 v[96:99], v38, s[4:7], s43 offen offset:1280 sc1
    buffer_load_dwordx4 v[100:103], v38, s[4:7], s43 offen offset:2560 sc1
    buffer_load_dword v104, v39, s[4:7], s43 offen offset:0 sc1
    buffer_load_dword v105, v39, s[4:7], s43 offen offset:1280 sc1
    buffer_load_dword v106, v39, s[4:7], s43 offen offset:2560 sc1
    s_sub_u32 s36, s36, 1
    s_cbranch_scc1 L_exit
    s_branch L_sc_42
L_px_f:
    v_and_b32 v1, 15, v0
    v_lshrrev_b32 v2, 4, v0
    s_mul_i32 s90, s32, 12288
    v_lshl_add_u32 v10, v0, 4, s90
    s_mul_i32 s90, s32, 3072
    v_lshl_add_u32 v12, v0, 4, s90
    v_lshrrev_b32 v3, 2, v1
    v_lshlrev_b32 v3, 1, v3
    v_and_b32 v4, 1, v1
    v_or_b32 v3, v3, v4
    v_lshl_add_u32 v3, v2, 3, v3
    v_lshl_add_u32 v11, v3, 4, s90
    s_lshl_b32 s90, s32, 7
    v_min_u32 v3, 11, v0
    v_lshl_add_u32 v3, v3, 2, s90
    v_add_u32 v13, 458752, v3
    v_min_u32 v3, 2, v0
    v_lshl_add_u32 v3, v3, 2, s90
    v_add_u32 v14, 459264, v3
    v_add_u32 v22, 462336, v3
    s_add_u32 s90, s90, 459776
    v_mov_b32 v15, s90
    v_cmp_eq_u32 vcc, 0, v0
    v_mov_b32 v9, 2146435072
    s_nop 0
    v_cndmask_b32 v15, v9, v15, vcc
    s_nop 0
    v_mov_b32 v21, 0xd04e79ff
    s_mov_b32 s44, 0x3dd53b95
    v_lshl_add_u32 v3, v2, 2, 0
    v_cmp_le_u32 s[48:49], v3, v1
    v_lshl_add_u32 v3, v2, 2, 1
    v_cmp_le_u32 s[50:51], v3, v1
    v_lshl_add_u32 v3, v2, 2, 2
    v_cmp_le_u32 s[52:53], v3, v1
    v_lshl_add_u32 v3, v2, 2, 3
    v_cmp_le_u32 s[54:55], v3, v1
    v_mov_b32 v167, 0
    v_mov_b32 v171, 0
    v_mov_b32 v174, 0
    v_mov_b32 v175, 0
    s_mov_b32 s37, 0
    v_mov_b32 v1, 192
L_gw_54:
    buffer_load_dword v2, v1, s[8:11], 0 offen sc1
    s_sub_u32 s36, s36, 1
    s_cbranch_scc1 L_exit
    s_waitcnt vmcnt(0)
L_gw_54c:
    v_readfirstlane_b32 s90, v2
    s_nop 0
    s_cmp_eq_u32 s90, 0
    s_cbranch_scc1 L_gw_54
    s_cmp_lg_u32 s90, 1
    s_cbranch_scc1 L_slow
    s_cmp_lg_u32 s32, 0
    s_cbranch_scc1 L_xg_53
    s_lshl_b32 s92, s34, 14
    s_add_u32 s92, s92, 1966080
    s_add_u32 s93, s92, 8192
    v_lshlrev_b32 v3, 4, v0
    buffer_store_dwordx4 v[24:27], v3, s[4:7], s92 offen offset:0 sc1
    buffer_store_dwordx4 v[24:27], v3, s[4:7], s93 offen offset:0 sc1
    buffer_store_dwordx4 v[24:27], v3, s[4:7], s92 offen offset:1024 sc1
    buffer_store_dwordx4 v[24:27], v3, s[4:7], s93 offen offset:1024 sc1
    buffer_store_dwordx4 v[24:27], v3, s[4:7], s92 offen offset:2048 sc1
    buffer_store_dwordx4 v[24:27], v3, s[4:7], s93 offen offset:2048 sc1
    buffer_store_dwordx4 v[24:27], v3, s[4:7], s92 offen offset:3072 sc1
    buffer_store_dwordx4 v[24:27], v3, s[4:7], s93 offen offset:3072 sc1
    v_mov_b32 v3, 0
    s_mov_b32 s56, -1
    s_mov_b32 s57, -1
    s_mov_b32 s62, 0
    s_mov_b32 s63, 0
    s_waitcnt vmcnt(0)
L_pr_55:
    s_memtime s[58:59]
    s_waitcnt lgkmcnt(0)
    buffer_load_dword v4, v3, s[4:7], s92 offen sc1
    s_waitcnt vmcnt(0)
    s_memtime s[60:61]
    s_waitcnt lgkmcnt(0)
    s_sub_u32 s60, s60, s58
    s_min_u32 s56, s56, s60
    s_memtime s[58:59]
    s_waitcnt lgkmcnt(0)
    buffer_load_dword v4, v3, s[4:7], s93 offen sc1
    s_waitcnt vmcnt(0)
    s_memtime s[60:61]
    s_waitcnt lgkmcnt(0)
    s_sub_u32 s60, s60, s58
    s_min_u32 s57, s57, s60
    buffer_load_dword v4, v13, s[4:7], s38 offen sc1
    v_add_u32 v3, 128, v3
    s_add_u32 s62, s62, 1
    s_waitcnt vmcnt(0)
    v_cmp_eq_u32 vcc, 0, v4
    s_nop 0
    s_cmp_eq_u64 vcc, 0
    s_addc_u32 s63, s63, 0
    s_cmp_ge_u32 s63, 2
    s_cselect_b32 s62, 32, s62
    s_min_u32 s58, s56, s57
    s_max_u32 s59, s56, s57
    s_sub_u32 s59, s59, s58
    s_cmp_ge_u32 s59, 150
    s_cselect_b32 s58, s58, -1
    s_cmp_le_u32 s58, 540
    s_cselect_b32 s62, 32, s62
    s_cmp_lt_u32 s62, 32
    s_cbranch_scc1 L_pr_55
    s_cmp_lt_u32 s57, s56
    s_cselect_b32 s62, 2, 1
    s_nop 0
    v_mov_b32 v3, 460288
    v_mov_b32 v4, s62
    buffer_store_dword v4, v3, s[4:7], s38 offen
    s_cmp_lg_u32 s34, 0
    s_cbranch_scc1 L_xg_53
    v_mov_b32 v3, 200
    buffer_store_dword v4, v3, s[8:11], 0 offen sc1
L_xg_53:
    s_barrier
    s_add_u32 s41, s38, 475136
    buffer_load_dword v16, v22, s[4:7], s38 offen sc1
    buffer_load_dword v16, v22, s[4:7], s38 offen sc1
L_sp_56:
    s_waitcnt vmcnt(1)
    v_cmp_ge_u32 vcc, s37, v16
    buffer_load_dword v16, v22, s[4:7], s38 offen sc1
    s_sub_u32 s36, s36, 1
    s_cbranch_scc1 L_exit
    s_cbranch_vccz L_sp_56x
    s_waitcnt vmcnt(1)
    v_cmp_ge_u32 vcc, s37, v16
    buffer_load_dword v16, v22, s[4:7], s38 offen sc1
    s_cbranch_vccz L_sp_56x
    s_waitcnt vmcnt(1)
    v_cmp_ge_u32 vcc, s37, v16
    buffer_load_dword v16, v22, s[4:7], s38 offen sc1
    s_cbranch_vccz L_sp_56x
    s_waitcnt vmcnt(1)
    v_cmp_ge_u32 vcc, s37, v16
    buffer_load_dword v16, v22, s[4:7], s38 offen sc1
    s_cbranch_vccnz L_sp_56
L_sp_56x:
    s_add_u32 s90, s41, 49152
    buffer_load_dwordx4 v[72:75], v10, s[4:7], s90 offen offset:0 sc1
    buffer_load_dwordx4 v[76:79], v10, s[4:7], s90 offen offset:1024 sc1
    buffer_load_dwordx4 v[80:83], v10, s[4:7], s90 offen offset:2048 sc1
    buffer_load_dwordx4 v[84:87], v10, s[4:7], s90 offen offset:3072 sc1
    s_add_u32 s90, s41, 53248
    buffer_load_dwordx4 v[88:91], v10, s[4:7], s90 offen offset:0 sc1
    buffer_load_dwordx4 v[92:95], v10, s[4:7], s90 offen offset:1024 sc1
    buffer_load_dwordx4 v[96:99], v10, s[4:7], s90 offen offset:2048 sc1
    buffer_load_dwordx4 v[100:103], v10, s[4:7], s90 offen offset:3072 sc1
    s_add_u32 s90, s41, 57344
    buffer_load_dwordx4 v[104:107], v10, s[4:7], s90 offen offset:0 sc1
    buffer_load_dwordx4 v[108:111], v10, s[4:7], s90 offen offset:1024 sc1
    buffer_load_dwordx4 v[112:115], v10, s[4:7], s90 offen offset:2048 sc1
    buffer_load_dwordx4 v[116:119], v10, s[4:7], s90 offen offset:3072 sc1
    s_add_u32 s90, s41, 0
    buffer_load_dwordx4 v[24:27], v10, s[4:7], s90 offen offset:0 sc1
    buffer_load_dwordx4 v[28:31], v10, s[4:7], s90 offen offset:1024 sc1
    buffer_load_dwordx4 v[32:35], v10, s[4:7], s90 offen offset:2048 sc1
    buffer_load_dwordx4 v[36:39], v10, s[4:7], s90 offen offset:3072 sc1
    s_add_u32 s90, s41, 4096
    buffer_load_dwordx4 v[40:43], v10, s[4:7], s90 offen offset:0 sc1
    buffer_load_dwordx4 v[44:47], v10, s[4:7], s90 offen offset:1024 sc1
    buffer_load_dwordx4 v[48:51], v10, s[4:7], s90 offen offset:2048 sc1
    buffer_load_dwordx4 v[52:55], v10, s[4:7], s90 offen offset:3072 sc1
    s_add_u32 s90, s41, 8192
    buffer_load_dwordx4 v[56:59], v10, s[4:7], s90 offen offset:0 sc1
    buffer_load_dwordx4 v[60:63], v10, s[4:7], s90 offen offset:1024 sc1
    buffer_load_dwordx4 v[64:67], v10, s[4:7], s90 offen offset:2048 sc1
    buffer_load_dwordx4 v[68:71], v10, s[4:7], s90 offen offset:3072 sc1
    s_waitcnt vmcnt(0)
L_px_loop_f:
    s_and_b32 s90, s37, 3
    s_mul_i32 s91, s90, 114688
    s_add_u32 s91, s91, s38
    s_add_u32 s42, s91, 40960
    s_add_u32 s43, s91, 53248
    s_add_u32 s90, s37, 1
    v_mov_b32 v17, s90
    s_and_b32 s90, s90, 3
    s_mul_i32 s91, s90, 98304
    s_add_u32 s91, s91, 475136
    s_add_u32 s41, s38, s91
    v_mfma_f32_16x16x32_bf16 v[144:147], v[72:75], v[24:27], 0
    v_mfma_f32_16x16x32_bf16 v[152:155], v[72:75], v[48:51], 0
    v_mfma_f32_16x16x32_bf16 v[156:159], v[96:99], v[48:51], 0
    v_mfma_f32_16x16x32_bf16 v[144:147], v[76:79], v[28:31], v[144:147]
    v_mfma_f32_16x16x32_bf16 v[152:155], v[76:79], v[52:55], v[152:155]
    v_mfma_f32_16x16x32_bf16 v[156:159], v[100:103], v[52:55], v[156:159]
    v_mfma_f32_16x16x32_bf16 v[144:147], v[80:83], v[32:35], v[144:147]
    v_mfma_f32_16x16x32_bf16 v[152:155], v[80:83], v[56:59], v[152:155]
    v_mfma_f32_16x16x32_bf16 v[156:159], v[104:107], v[56:59], v[156:159]
    v_mfma_f32_16x16x32_bf16 v[144:147], v[84:87], v[36:39], v[144:147]
    v_mfma_f32_16x16x32_bf16 v[152:155], v[84:87], v[60:63], v[152:155]
    v_mfma_f32_16x16x32_bf16 v[156:159], v[108:111], v[60:63], v[156:159]
    v_mfma_f32_16x16x32_bf16 v[144:147], v[88:91], v[40:43], v[144:147]
    v_mfma_f32_16x16x32_bf16 v[152:155], v[88:91], v[64:67], v[152:155]
    v_mfma_f32_16x16x32_bf16 v[156:159], v[112:115], v[64:67], v[156:159]
    v_mfma_f32_16x16x32_bf16 v[144:147], v[92:95], v[44:47], v[144:147]
    v_mfma_f32_16x16x32_bf16 v[152:155], v[92:95], v[68:71], v[152:155]
    v_mfma_f32_16x16x32_bf16 v[156:159], v[116:119], v[68:71], v[156:159]
    s_nop 0
    v_cndmask_b32 v144, v21, v144, s[48:49]
    v_cndmask_b32 v145, v21, v145, s[50:51]
    v_cndmask_b32 v146, v21, v146, s[52:53]
    v_cndmask_b32 v147, v21, v147, s[54:55]
    s_nop 2
    v_cndmask_b32 v156, v21, v156, s[48:49]
    v_cndmask_b32 v157, v21, v157, s[50:51]
    v_cndmask_b32 v158, v21, v158, s[52:53]
    v_cndmask_b32 v159, v21, v159, s[54:55]
    buffer_load_dword v16, v14, s[4:7], s38 offen sc1
    buffer_load_dword v16, v14, s[4:7], s38 offen sc1
L_sp_57:
    s_waitcnt vmcnt(1)
    v_cmp_ge_u32 vcc, s37, v16
    buffer_load_dword v16, v14, s[4:7], s38 offen sc1
    s_sub_u32 s36, s36, 1
    s_cbranch_scc1 L_exit
    s_cbranch_vccz L_sp_57x
    s_waitcnt vmcnt(1)
    v_cmp_ge_u32 vcc, s37, v16
    buffer_load_dword v16, v14, s[4:7], s38 offen sc1
    s_cbranch_vccz L_sp_57x
    s_waitcnt vmcnt(1)
    v_cmp_ge_u32 vcc, s37, v16
    buffer_load_dword v16, v14, s[4:7], s38 offen sc1
    s_cbranch_vccz L_sp_57x
    s_waitcnt vmcnt(1)
    v_cmp_ge_u32 vcc, s37, v16
    buffer_load_dword v16, v14, s[4:7], s38 offen sc1
    s_cbranch_vccnz L_sp_57
L_sp_57x:
    buffer_load_dwordx4 v[120:123], v11, s[4:7], s42 offen offset:0 sc1
    buffer_load_dwordx4 v[124:127], v11, s[4:7], s42 offen offset:512 sc1
    buffer_load_dwordx4 v[128:131], v11, s[4:7], s42 offen offset:1024 sc1
    buffer_load_dwordx4 v[132:135], v11, s[4:7], s42 offen offset:1536 sc1
    buffer_load_dwordx4 v[136:139], v11, s[4:7], s42 offen offset:2048 sc1
    buffer_load_dwordx4 v[140:143], v11, s[4:7], s42 offen offset:2560 sc1
    s_waitcnt vmcnt(5)
    v_mfma_f32_16x16x32_bf16 v[148:151], v[120:123], v[24:27], 0
    v_mfma_f32_16x16x32_bf16 v[160:163], v[120:123], v[48:51], 0
    s_waitcnt vmcnt(4)
    v_mfma_f32_16x16x32_bf16 v[148:151], v[124:127], v[28:31], v[148:151]
    v_mfma_f32_16x16x32_bf16 v[160:163], v[124:127], v[52:55], v[160:163]
    s_waitcnt vmcnt(3)
    v_mfma_f32_16x16x32_bf16 v[148:151], v[128:131], v[32:35], v[148:151]
    v_mfma_f32_16x16x32_bf16 v[160:163], v[128:131], v[56:59], v[160:163]
    s_waitcnt vmcnt(2)
    v_mfma_f32_16x16x32_bf16 v[148:151], v[132:135], v[36:39], v[148:151]
    v_mfma_f32_16x16x32_bf16 v[160:163], v[132:135], v[60:63], v[160:163]
    s_waitcnt vmcnt(1)
    v_mfma_f32_16x16x32_bf16 v[148:151], v[136:139], v[40:43], v[148:151]
    v_mfma_f32_16x16x32_bf16 v[160:163], v[136:139], v[64:67], v[160:163]
    s_waitcnt vmcnt(0)
    v_mfma_f32_16x16x32_bf16 v[148:151], v[140:143], v[44:47], v[148:151]
    v_mfma_f32_16x16x32_bf16 v[160:163], v[140:143], v[68:71], v[160:163]
    s_cmp_eq_u32 s37, 63
    s_nop 2
    s_cbranch_scc1 L_pxl_58
    s_add_u32 s90, s41, 49152
    v_max_f32 v18, v144, v145
    v_max3_f32 v18, v18, v146, v147
    v_max3_f32 v18, v18, v148, v149
    v_mov_b32 v19, v18
    buffer_load_dwordx4 v[72:75], v10, s[4:7], s90 offen offset:0 sc1
    s_nop 0
    v_permlane16_swap_b32 v18, v19
    v_max_f32 v18, v18, v19
    v_mov_b32 v19, v18
    s_nop 1
    v_permlane32_swap_b32 v18, v19
    buffer_load_dwordx4 v[76:79], v10, s[4:7], s90 offen offset:1024 sc1
    v_max_f32 v18, v18, v19
    v_sub_f32 v144, v144, v18
    v_sub_f32 v145, v145, v18
    v_sub_f32 v146, v146, v18
    buffer_load_dwordx4 v[80:83], v10, s[4:7], s90 offen offset:2048 sc1
    v_sub_f32 v147, v147, v18
    v_sub_f32 v148, v148, v18
    v_sub_f32 v149, v149, v18
    v_mul_f32 v144, s44, v144
    buffer_load_dwordx4 v[84:87], v10, s[4:7], s90 offen offset:3072 sc1
    v_mul_f32 v145, s44, v145
    v_mul_f32 v146, s44, v146
    v_mul_f32 v147, s44, v147
    v_mul_f32 v148, s44, v148
    s_add_u32 s90, s41, 53248
    v_mul_f32 v149, s44, v149
    v_exp_f32 v144, v144
    v_exp_f32 v145, v145
    v_exp_f32 v146, v146
    buffer_load_dwordx4 v[88:91], v10, s[4:7], s90 offen offset:0 sc1
    v_exp_f32 v147, v147
    v_exp_f32 v148, v148
    v_exp_f32 v149, v149
    v_add_f32 v20, v144, v145
    buffer_load_dwordx4 v[92:95], v10, s[4:7], s90 offen offset:1024 sc1
    v_add_f32 v20, v20, v146
    v_add_f32 v20, v20, v147
    v_add_f32 v20, v20, v148
    v_add_f32 v20, v20, v149
    buffer_load_dwordx4 v[96:99], v10, s[4:7], s90 offen offset:2048 sc1
    v_mov_b32 v19, v20
    s_nop 1
    v_permlane16_swap_b32 v20, v19
    v_add_f32 v20, v20, v19
    v_mov_b32 v19, v20
    buffer_load_dwordx4 v[100:103], v10, s[4:7], s90 offen offset:3072 sc1
    s_nop 0
    v_permlane32_swap_b32 v20, v19
    v_add_f32 v20, v20, v19
    v_rcp_f32 v20, v20
    s_nop 0
    v_mul_f32 v144, v144, v20
    s_add_u32 s90, s41, 57344
    v_mul_f32 v145, v145, v20
    v_mul_f32 v146, v146, v20
    v_mul_f32 v147, v147, v20
    v_mul_f32 v148, v148, v20
    buffer_load_dwordx4 v[104:107], v10, s[4:7], s90 offen offset:0 sc1
    v_mul_f32 v149, v149, v20
    v_cvt_pk_bf16_f32 v164, v144, v145
    v_cvt_pk_bf16_f32 v165, v146, v147
    v_cvt_pk_bf16_f32 v166, v148, v149
    buffer_load_dwordx4 v[108:111], v10, s[4:7], s90 offen offset:1024 sc1
    v_max_f32 v18, v152, v153
    v_max3_f32 v18, v18, v154, v155
    v_max3_f32 v18, v18, v160, v161
    v_max3_f32 v18, v18, v156, v157
    buffer_load_dwordx4 v[112:115], v10, s[4:7], s90 offen offset:2048 sc1
    v_max3_f32 v18, v18, v158, v159
    v_mov_b32 v19, v18
    s_nop 1
    v_permlane16_swap_b32 v18, v19
    v_max_f32 v18, v18, v19
    buffer_load_dwordx4 v[116:119], v10, s[4:7], s90 offen offset:3072 sc1
    v_mov_b32 v19, v18
    s_nop 1
    v_permlane32_swap_b32 v18, v19
    v_max_f32 v18, v18, v19
    v_sub_f32 v152, v152, v18
    s_add_u32 s90, s41, 0
    v_sub_f32 v153, v153, v18
    v_sub_f32 v154, v154, v18
    v_sub_f32 v155, v155, v18
    v_sub_f32 v160, v160, v18
    buffer_load_dwordx4 v[24:27], v10, s[4:7], s90 offen offset:0 sc1
    v_sub_f32 v161, v161, v18
    v_sub_f32 v156, v156, v18
    v_sub_f32 v157, v157, v18
    v_sub_f32 v158, v158, v18
    buffer_load_dwordx4 v[28:31], v10, s[4:7], s90 offen offset:1024 sc1
    v_sub_f32 v159, v159, v18
    v_mul_f32 v152, s44, v152
    v_mul_f32 v153, s44, v153
    v_mul_f32 v154, s44, v154
    buffer_load_dwordx4 v[32:35], v10, s[4:7], s90 offen offset:2048 sc1
    v_mul_f32 v155, s44, v155
    v_mul_f32 v160, s44, v160
    v_mul_f32 v161, s44, v161
    v_mul_f32 v156, s44, v156
    buffer_load_dwordx4 v[36:39], v10, s[4:7], s90 offen offset:3072 sc1
    v_mul_f32 v157, s44, v157
    v_mul_f32 v158, s44, v158
    v_mul_f32 v159, s44, v159
    v_exp_f32 v152, v152
    s_add_u32 s90, s41, 4096
    v_exp_f32 v153, v153
    v_exp_f32 v154, v154
    v_exp_f32 v155, v155
    v_exp_f32 v160, v160
    buffer_load_dwordx4 v[40:43], v10, s[4:7], s90 offen offset:0 sc1
    v_exp_f32 v161, v161
    v_exp_f32 v156, v156
    v_exp_f32 v157, v157
    v_exp_f32 v158, v158
    buffer_load_dwordx4 v[44:47], v10, s[4:7], s90 offen offset:1024 sc1
    v_exp_f32 v159, v159
    v_add_f32 v20, v152, v153
    v_add_f32 v20, v20, v154
    v_add_f32 v20, v20, v155
    buffer_load_dwordx4 v[48:51], v10, s[4:7], s90 offen offset:2048 sc1
    v_add_f32 v20, v20, v160
    v_add_f32 v20, v20, v161
    v_add_f32 v20, v20, v156
    v_add_f32 v20, v20, v157
    buffer_load_dwordx4 v[52:55], v10, s[4:7], s90 offen offset:3072 sc1
    v_add_f32 v20, v20, v158
    v_add_f32 v20, v20, v159
    v_mov_b32 v19, v20
    s_nop 1
    v_permlane16_swap_b32 v20, v19
    s_add_u32 s90, s41, 8192
    v_add_f32 v20, v20, v19
    v_mov_b32 v19, v20
    s_nop 1
    v_permlane32_swap_b32 v20, v19
    v_add_f32 v20, v20, v19
    buffer_load_dwordx4 v[56:59], v10, s[4:7], s90 offen offset:0 sc1
    v_rcp_f32 v20, v20
    s_nop 0
    v_mul_f32 v152, v152, v20
    v_mul_f32 v153, v153, v20
    v_mul_f32 v154, v154, v20
    buffer_load_dwordx4 v[60:63], v10, s[4:7], s90 offen offset:1024 sc1
    v_mul_f32 v155, v155, v20
    v_mul_f32 v160, v160, v20
    v_mul_f32 v161, v161, v20
    v_mul_f32 v156, v156, v20
    buffer_load_dwordx4 v[64:67], v10, s[4:7], s90 offen offset:2048 sc1
    v_mul_f32 v157, v157, v20
    v_mul_f32 v158, v158, v20
    v_mul_f32 v159, v159, v20
    v_cvt_pk_bf16_f32 v168, v152, v153
    buffer_load_dwordx4 v[68:71], v10, s[4:7], s90 offen offset:3072 sc1
    v_cvt_pk_bf16_f32 v169, v154, v155
    v_cvt_pk_bf16_f32 v170, v160, v161
    v_cvt_pk_bf16_f32 v172, v156, v157
    v_cvt_pk_bf16_f32 v173, v158, v159
    buffer_store_dwordx4 v[164:167], v12, s[4:7], s43 offen offset:0
    buffer_store_dwordx4 v[168:171], v12, s[4:7], s43 offen offset:1024
    buffer_store_dwordx4 v[172:175], v12, s[4:7], s43 offen offset:2048
    s_waitcnt vmcnt(0)
    buffer_store_dword v17, v15, s[4:7], s38 offen
    s_add_u32 s37, s37, 1
    s_branch L_px_loop_f
L_pxl_58:
    v_max_f32 v18, v144, v145
    v_max3_f32 v18, v18, v146, v147
    v_max3_f32 v18, v18, v148, v149
    v_mov_b32 v19, v18
    s_nop 1
    v_permlane16_swap_b32 v18, v19
    v_max_f32 v18, v18, v19
    v_mov_b32 v19, v18
    s_nop 1
    v_permlane32_swap_b32 v18, v19
    v_max_f32 v18, v18, v19
    v_sub_f32 v144, v144, v18
    v_sub_f32 v145, v145, v18
    v_sub_f32 v146, v146, v18
    v_sub_f32 v147, v147, v18
    v_sub_f32 v148, v148, v18
    v_sub_f32 v149, v149, v18
    v_mul_f32 v144, s44, v144
    v_mul_f32 v145, s44, v145
    v_mul_f32 v146, s44, v146
    v_mul_f32 v147, s44, v147
    v_mul_f32 v148, s44, v148
    v_mul_f32 v149, s44, v149
    v_exp_f32 v144, v144
    v_exp_f32 v145, v145
    v_exp_f32 v146, v146
    v_exp_f32 v147, v147
    v_exp_f32 v148, v148
    v_exp_f32 v149, v149
    v_add_f32 v20, v144, v145
    v_add_f32 v20, v20, v146
    v_add_f32 v20, v20, v147
    v_add_f32 v20, v20, v148
    v_add_f32 v20, v20, v149
    v_mov_b32 v19, v20
    s_nop 1
    v_permlane16_swap_b32 v20, v19
    v_add_f32 v20, v20, v19
    v_mov_b32 v19, v20
    s_nop 1
    v_permlane32_swap_b32 v20, v19
    v_add_f32 v20, v20, v19
    v_rcp_f32 v20, v20
    s_nop 0
    v_mul_f32 v144, v144, v20
    v_mul_f32 v145, v145, v20
    v_mul_f32 v146, v146, v20
    v_mul_f32 v147, v147, v20
    v_mul_f32 v148, v148, v20
    v_mul_f32 v149, v149, v20
    v_cvt_pk_bf16_f32 v164, v144, v145
    v_cvt_pk_bf16_f32 v165, v146, v147
    v_cvt_pk_bf16_f32 v166, v148, v149
    v_max_f32 v18, v152, v153
    v_max3_f32 v18, v18, v154, v155
    v_max3_f32 v18, v18, v160, v161
    v_max3_f32 v18, v18, v156, v157
    v_max3_f32 v18, v18, v158, v159
    v_mov_b32 v19, v18
    s_nop 1
    v_permlane16_swap_b32 v18, v19
    v_max_f32 v18, v18, v19
    v_mov_b32 v19, v18
    s_nop 1
    v_permlane32_swap_b32 v18, v19
    v_max_f32 v18, v18, v19
    v_sub_f32 v152, v152, v18
    v_sub_f32 v153, v153, v18
    v_sub_f32 v154, v154, v18
    v_sub_f32 v155, v155, v18
    v_sub_f32 v160, v160, v18
    v_sub_f32 v161, v161, v18
    v_sub_f32 v156, v156, v18
    v_sub_f32 v157, v157, v18
    v_sub_f32 v158, v158, v18
    v_sub_f32 v159, v159, v18
    v_mul_f32 v152, s44, v152
    v_mul_f32 v153, s44, v153
    v_mul_f32 v154, s44, v154
    v_mul_f32 v155, s44, v155
    v_mul_f32 v160, s44, v160
    v_mul_f32 v161, s44, v161
    v_mul_f32 v156, s44, v156
    v_mul_f32 v157, s44, v157
    v_mul_f32 v158, s44, v158
    v_mul_f32 v159, s44, v159
    v_exp_f32 v152, v152
    v_exp_f32 v153, v153
    v_exp_f32 v154, v154
    v_exp_f32 v155, v155
    v_exp_f32 v160, v160
    v_exp_f32 v161, v161
    v_exp_f32 v156, v156
    v_exp_f32 v157, v157
    v_exp_f32 v158, v158
    v_exp_f32 v159, v159
    v_add_f32 v20, v152, v153
    v_add_f32 v20, v20, v154
    v_add_f32 v20, v20, v155
    v_add_f32 v20, v20, v160
    v_add_f32 v20, v20, v161
    v_add_f32 v20, v20, v156
    v_add_f32 v20, v20, v157
    v_add_f32 v20, v20, v158
    v_add_f32 v20, v20, v159
    v_mov_b32 v19, v20
    s_nop 1
    v_permlane16_swap_b32 v20, v19
    v_add_f32 v20, v20, v19
    v_mov_b32 v19, v20
    s_nop 1
    v_permlane32_swap_b32 v20, v19
    v_add_f32 v20, v20, v19
    v_rcp_f32 v20, v20
    s_nop 0
    v_mul_f32 v152, v152, v20
    v_mul_f32 v153, v153, v20
    v_mul_f32 v154, v154, v20
    v_mul_f32 v155, v155, v20
    v_mul_f32 v160, v160, v20
    v_mul_f32 v161, v161, v20
    v_mul_f32 v156, v156, v20
    v_mul_f32 v157, v157, v20
    v_mul_f32 v158, v158, v20
    v_mul_f32 v159, v159, v20
    v_cvt_pk_bf16_f32 v168, v152, v153
    v_cvt_pk_bf16_f32 v169, v154, v155
    v_cvt_pk_bf16_f32 v170, v160, v161
    v_cvt_pk_bf16_f32 v172, v156, v157
    v_cvt_pk_bf16_f32 v173, v158, v159
    buffer_store_dwordx4 v[164:167], v12, s[4:7], s43 offen offset:0
    buffer_store_dwordx4 v[168:171], v12, s[4:7], s43 offen offset:1024
    buffer_store_dwordx4 v[172:175], v12, s[4:7], s43 offen offset:2048
    s_waitcnt vmcnt(0)
    buffer_store_dword v17, v15, s[4:7], s38 offen
    s_endpgm
L_pa_f:
    s_mov_b32 s24, s70
    s_and_b32 s25, s71, 0xffff
    s_mov_b32 s26, 2621440
    s_mov_b32 s27, 0x20000
    s_sub_u32 s93, s35, 29
    s_lshl_b32 s93, s93, 2
    s_add_u32 s93, s93, s32
    s_lshl_b32 s93, s93, 11
    v_lshl_add_u32 v4, v0, 4, s93
    v_mov_b32 v1, 192
L_gw_59:
    buffer_load_dword v2, v1, s[8:11], 0 offen sc1
    s_sub_u32 s36, s36, 1
    s_cbranch_scc1 L_exit
    s_waitcnt vmcnt(0)
L_gw_59c:
    v_readfirstlane_b32 s90, v2
    s_nop 0
    s_cmp_eq_u32 s90, 0
    s_cbranch_scc1 L_gw_59
    s_cmp_lg_u32 s90, 1
    s_cbranch_scc1 L_slow
    s_mov_b32 s92, 0
L_tch_60:
    s_add_u32 s91, s92, s38
    buffer_load_dwordx4 v[248:251], v4, s[4:7], s91 offen
    buffer_load_dwordx4 v[248:251], v4, s[4:7], s91 offen offset:1024
    s_add_u32 s92, s92, 24576
    s_waitcnt vmcnt(24)
    s_cmp_lt_u32 s92, 475136
    s_cbranch_scc1 L_tch_60
    s_mov_b32 s92, 81920
L_tch_61:
    s_add_u32 s91, s92, 0
    buffer_load_dwordx4 v[248:251], v4, s[24:27], s91 offen
    buffer_load_dwordx4 v[248:251], v4, s[24:27], s91 offen offset:1024
    s_add_u32 s92, s92, 24576
    s_waitcnt vmcnt(24)
    s_cmp_lt_u32 s92, 245760
    s_cbranch_scc1 L_tch_61
    s_mov_b32 s92, 475136
L_tch_62:
    s_add_u32 s91, s92, s38
    buffer_load_dwordx4 v[248:251], v4, s[4:7], s91 offen
    buffer_load_dwordx4 v[248:251], v4, s[4:7], s91 offen offset:1024
    s_add_u32 s92, s92, 24576
    s_waitcnt vmcnt(24)
    s_cmp_lt_u32 s92, 1048576
    s_cbranch_scc1 L_tch_62
    s_waitcnt vmcnt(0)
    s_branch L_pa_body
L_pa_body:
    s_sub_u32 s90, s35, 29
    s_cmp_ge_u32 s90, 3
    s_cbranch_scc1 L_pa_end
    s_mul_i32 s52, s90, 3
    s_add_u32 s52, s52, s34
    s_and_b32 s52, s52, 7
    s_cmp_eq_u32 s90, 0
    s_cselect_b32 s91, 0x76543210, 0
    s_cmp_eq_u32 s90, 1
    s_cselect_b32 s91, 0x54c321b0, s91
    s_cmp_eq_u32 s90, 2
    s_cselect_b32 s91, 0xf9ea87d6, s91
    s_lshl_b32 s92, s34, 2
    s_lshr_b32 s91, s91, s92
    s_and_b32 s91, s91, 15
    s_min_u32 s90, s90, 1
    s_lshl_b32 s90, s90, 3
    s_add_u32 s54, s90, s91
    s_mul_i32 s40, s54, 112
    s_lshl_b32 s90, s32, 5
    s_add_u32 s40, s40, s90
    s_sub_u32 s40, s40, 16
    s_mov_b32 s12, s64
    s_and_b32 s13, s65, 0xffff
    s_mov_b32 s14, 2621440
    s_mov_b32 s15, 0x20000
    s_mov_b32 s16, s66
    s_and_b32 s17, s67, 0xffff
    s_mov_b32 s18, 2457600
    s_mov_b32 s19, 0x20000
    s_mov_b32 s20, s68
    s_and_b32 s21, s69, 0xffff
    s_mov_b32 s22, 819200
    s_mov_b32 s23, 0x20000
    v_and_b32 v1, 15, v0
    v_lshrrev_b32 v2, 4, v0
    s_add_u32 s90, s40, 0
    v_add_u32 v3, s90, v1
    v_cmp_gt_u32 vcc, 2048, v3
    v_mul_u32_u24 v3, 1280, v3
    v_lshl_add_u32 v3, v2, 4, v3
    v_mov_b32 v4, 2146435072
    v_cndmask_b32 v3, v4, v3, vcc
    buffer_load_dwordx4 a[0:3], v3, s[12:15], 0 offen offset:0
    buffer_load_dwordx4 a[4:7], v3, s[12:15], 0 offen offset:64
    buffer_load_dwordx4 a[8:11], v3, s[12:15], 0 offen offset:128
    buffer_load_dwordx4 a[12:15], v3, s[12:15], 0 offen offset:192
    buffer_load_dwordx4 a[16:19], v3, s[12:15], 0 offen offset:256
    buffer_load_dwordx4 a[20:23], v3, s[12:15], 0 offen offset:320
    buffer_load_dwordx4 a[24:27], v3, s[12:15], 0 offen offset:384
    buffer_load_dwordx4 a[28:31], v3, s[12:15], 0 offen offset:448
    buffer_load_dwordx4 a[32:35], v3, s[12:15], 0 offen offset:512
    buffer_load_dwordx4 a[36:39], v3, s[12:15], 0 offen offset:576
    buffer_load_dwordx4 a[40:43], v3, s[12:15], 0 offen offset:640
    buffer_load_dwordx4 a[44:47], v3, s[12:15], 0 offen offset:704
    buffer_load_dwordx4 a[48:51], v3, s[12:15], 0 offen offset:768
    buffer_load_dwordx4 a[52:55], v3, s[12:15], 0 offen offset:832
    buffer_load_dwordx4 a[56:59], v3, s[12:15], 0 offen offset:896
    buffer_load_dwordx4 a[60:63], v3, s[12:15], 0 offen offset:960
    buffer_load_dwordx4 a[64:67], v3, s[12:15], 0 offen offset:1024
    buffer_load_dwordx4 a[68:71], v3, s[12:15], 0 offen offset:1088
    buffer_load_dwordx4 a[72:75], v3, s[12:15], 0 offen offset:1152
    buffer_load_dwordx4 a[76:79], v3, s[12:15], 0 offen offset:1216
    s_add_u32 s90, s40, 16
    v_add_u32 v3, s90, v1
    v_cmp_gt_u32 vcc, 2048, v3
    v_mul_u32_u24 v3, 1280, v3
    v_lshl_add_u32 v3, v2, 4, v3
    v_mov_b32 v4, 2146435072
    v_cndmask_b32 v3, v4, v3, vcc
    buffer_load_dwordx4 a[80:83], v3, s[12:15], 0 offen offset:0
    buffer_load_dwordx4 a[84:87], v3, s[12:15], 0 offen offset:64
    buffer_load_dwordx4 a[88:91], v3, s[12:15], 0 offen offset:128
    buffer_load_dwordx4 a[92:95], v3, s[12:15], 0 offen offset:192
    buffer_load_dwordx4 a[96:99], v3, s[12:15], 0 offen offset:256
    buffer_load_dwordx4 a[100:103], v3, s[12:15], 0 offen offset:320
    buffer_load_dwordx4 a[104:107], v3, s[12:15], 0 offen offset:384
    buffer_load_dwordx4 a[108:111], v3, s[12:15], 0 offen offset:448
    buffer_load_dwordx4 a[112:115], v3, s[12:15], 0 offen offset:512
    buffer_load_dwordx4 a[116:119], v3, s[12:15], 0 offen offset:576
    buffer_load_dwordx4 a[120:123], v3, s[12:15], 0 offen offset:640
    buffer_load_dwordx4 a[124:127], v3, s[12:15], 0 offen offset:704
    buffer_load_dwordx4 a[128:131], v3, s[12:15], 0 offen offset:768
    buffer_load_dwordx4 a[132:135], v3, s[12:15], 0 offen offset:832
    buffer_load_dwordx4 a[136:139], v3, s[12:15], 0 offen offset:896
    buffer_load_dwordx4 a[140:143], v3, s[12:15], 0 offen offset:960
    buffer_load_dwordx4 a[144:147], v3, s[12:15], 0 offen offset:1024
    buffer_load_dwordx4 a[148:151], v3, s[12:15], 0 offen offset:1088
    buffer_load_dwordx4 a[152:155], v3, s[12:15], 0 offen offset:1152
    buffer_load_dwordx4 a[156:159], v3, s[12:15], 0 offen offset:1216
    v_add_u32 v3, 0, v0
    v_mul_u32_u24 v4, 6554, v3
    v_lshrrev_b32 v4, 16, v4
    v_mul_u32_u24 v5, 10, v4
    v_sub_u32 v5, v3, v5
    v_and_b32 v6, 19, v4
    v_and_b32 v7, 4, v4
    v_lshl_or_b32 v6, v7, 1, v6
    v_and_b32 v7, 8, v4
    v_lshrrev_b32 v7, 1, v7
    v_or_b32 v6, v6, v7
    s_lshl_b32 s90, s32, 5
    v_add_u32 v6, s90, v6
    v_mul_u32_u24 v6, 3840, v6
    v_lshl_add_u32 v10, v5, 4, v6
    v_add_u32 v3, 64, v0
    v_mul_u32_u24 v4, 6554, v3
    v_lshrrev_b32 v4, 16, v4
    v_mul_u32_u24 v5, 10, v4
    v_sub_u32 v5, v3, v5
    v_and_b32 v6, 19, v4
    v_and_b32 v7, 4, v4
    v_lshl_or_b32 v6, v7, 1, v6
    v_and_b32 v7, 8, v4
    v_lshrrev_b32 v7, 1, v7
    v_or_b32 v6, v6, v7
    s_lshl_b32 s90, s32, 5
    v_add_u32 v6, s90, v6
    v_mul_u32_u24 v6, 3840, v6
    v_lshl_add_u32 v11, v5, 4, v6
    v_add_u32 v3, 128, v0
    v_mul_u32_u24 v4, 6554, v3
    v_lshrrev_b32 v4, 16, v4
    v_mul_u32_u24 v5, 10, v4
    v_sub_u32 v5, v3, v5
    v_and_b32 v6, 19, v4
    v_and_b32 v7, 4, v4
    v_lshl_or_b32 v6, v7, 1, v6
    v_and_b32 v7, 8, v4
    v_lshrrev_b32 v7, 1, v7
    v_or_b32 v6, v6, v7
    s_lshl_b32 s90, s32, 5
    v_add_u32 v6, s90, v6
    v_mul_u32_u24 v6, 3840, v6
    v_lshl_add_u32 v12, v5, 4, v6
    v_add_u32 v3, 192, v0
    v_mul_u32_u24 v4, 6554, v3
    v_lshrrev_b32 v4, 16, v4
    v_mul_u32_u24 v5, 10, v4
    v_sub_u32 v5, v3, v5
    v_and_b32 v6, 19, v4
    v_and_b32 v7, 4, v4
    v_lshl_or_b32 v6, v7, 1, v6
    v_and_b32 v7, 8, v4
    v_lshrrev_b32 v7, 1, v7
    v_or_b32 v6, v6, v7
    s_lshl_b32 s90, s32, 5
    v_add_u32 v6, s90, v6
    v_mul_u32_u24 v6, 3840, v6
    v_lshl_add_u32 v13, v5, 4, v6
    v_add_u32 v3, 256, v0
    v_mul_u32_u24 v4, 6554, v3
    v_lshrrev_b32 v4, 16, v4
    v_mul_u32_u24 v5, 10, v4
    v_sub_u32 v5, v3, v5
    v_and_b32 v6, 19, v4
    v_and_b32 v7, 4, v4
    v_lshl_or_b32 v6, v7, 1, v6
    v_and_b32 v7, 8, v4
    v_lshrrev_b32 v7, 1, v7
    v_or_b32 v6, v6, v7
    s_lshl_b32 s90, s32, 5
    v_add_u32 v6, s90, v6
    v_mul_u32_u24 v6, 3840, v6
    v_lshl_add_u32 v14, v5, 4, v6
    v_lshrrev_b32 v3, 2, v1
    v_and_b32 v4, 3, v1
    v_and_b32 v5, 1, v2
    v_lshl_add_u32 v3, v5, 2, v3
    v_lshrrev_b32 v6, 1, v2
    v_lshl_add_u32 v3, v6, 4, v3
    v_mul_u32_u24 v3, 160, v3
    v_lshl_add_u32 v15, v4, 3, v3
    s_lshl_b32 s90, s32, 5
    v_add_u32 v3, s90, v1
    v_mul_u32_u24 v3, 168, v3
    v_add_u32 v3, 81920, v3
    v_lshl_add_u32 v17, v2, 3, v3
    v_lshl_add_u32 v28, v2, 4, v3
    v_add_u32 v28, -32, v28
    v_lshl_add_u32 v3, v5, 4, v1
    v_add_u32 v4, s90, v3
    v_add_u32 v3, s40, v3
    v_cmp_le_u32 s[92:93], 16, v4
    v_cmp_gt_u32 vcc, 2048, v3
    s_nop 0
    s_and_b64 vcc, vcc, s[92:93]
    v_mul_u32_u24 v3, 2560, v3
    v_lshl_add_u32 v3, v6, 4, v3
    v_mov_b32 v4, 2146435072
    v_cndmask_b32 v19, v4, v3, vcc
    v_and_b32 v3, 31, v0
    v_add_u32 v24, s40, v3
    v_add_u32 v3, s90, v3
    v_mul_u32_u24 v3, 168, v3
    v_lshrrev_b32 v4, 5, v0
    v_mul_u32_u24 v4, 40, v4
    v_add_u32 v3, v3, v4
    v_add_u32 v20, 81920, v3
    v_add_u32 v21, 101072, v3
    v_mov_b32 v27, 0xcf8547b1
    s_mov_b32 s49, 0x3ea52b5c
    s_cmp_lt_u32 s54, 19
    s_cbranch_scc1 L_pa_rows
    s_mov_b32 s24, s70
    s_and_b32 s25, s71, 0xffff
    s_mov_b32 s26, 2621440
    s_mov_b32 s27, 0x20000
    s_sub_u32 s90, s54, 19
    s_lshl_b32 s90, s90, 2
    s_add_u32 s90, s90, s32
    s_lshl_b32 s90, s90, 11
    v_lshl_add_u32 v3, v0, 4, s90
    s_mov_b32 s91, 245760
L_pa_xw:
    buffer_load_dwordx4 v[248:251], v3, s[24:27], s91 offen
    buffer_load_dwordx4 v[248:251], v3, s[24:27], s91 offen offset:1024
    s_add_u32 s91, s91, 40960
    s_waitcnt vmcnt(20)
    s_cmp_lt_u32 s91, 2621440
    s_cbranch_scc1 L_pa_xw
    s_mov_b32 s46, 0
    s_mov_b32 s47, 0
    s_mul_i32 s43, s52, 160
    s_mov_b32 s44, 0
    s_mov_b32 s45, 0
    s_mov_b32 s51, 45
    s_mov_b32 s48, s52
    s_mov_b32 s53, 0
L_pa_pf_63:
    s_mul_i32 s90, s32, 5120
    s_add_u32 m0, s90, s47
    s_mul_i32 s91, s44, 491520
    s_add_u32 s91, s91, s43
    buffer_load_dwordx4 v[248:251], v10, s[16:19], s91 offen
    s_add_u32 s47, s47, 20480
    s_cmp_eq_u32 s47, 81920
    s_cselect_b32 s47, 0, s47
    s_cmp_lg_u32 s51, 0
    s_cselect_b32 s90, 1, 0
    s_sub_u32 s51, s51, s90
    s_add_u32 s44, s44, s90
    s_cmp_eq_u32 s44, 5
    s_cselect_b32 s44, 0, s44
    s_cselect_b32 s90, 1280, 0
    s_addc_u32 s45, s45, 0
    s_add_u32 s43, s43, s90
    s_cmp_eq_u32 s45, 3
    s_cselect_b32 s45, 0, s45
    s_cselect_b32 s90, 3680, 0
    s_cmp_eq_u32 s43, 4960
    s_cselect_b32 s90, s43, s90
    s_sub_u32 s43, s43, s90
    s_add_u32 m0, m0, 1024
    buffer_load_dwordx4 v[248:251], v11, s[16:19], s91 offen
    s_add_u32 m0, m0, 1024
    buffer_load_dwordx4 v[248:251], v12, s[16:19], s91 offen
    s_add_u32 m0, m0, 1024
    buffer_load_dwordx4 v[248:251], v13, s[16:19], s91 offen
    s_add_u32 m0, m0, 1024
    buffer_load_dwordx4 v[248:251], v14, s[16:19], s91 offen
    s_waitcnt vmcnt(20)
    s_cmp_lg_u32 s51, 0
    s_cbranch_scc1 L_pa_pf_63
    v_add_u32 v3, 0, v0
    v_mul_u32_u24 v4, 6554, v3
    v_lshrrev_b32 v4, 16, v4
    v_mul_u32_u24 v5, 10, v4
    v_sub_u32 v5, v3, v5
    v_and_b32 v6, 19, v4
    v_and_b32 v7, 4, v4
    v_lshl_or_b32 v6, v7, 1, v6
    v_and_b32 v7, 8, v4
    v_lshrrev_b32 v7, 1, v7
    v_or_b32 v6, v6, v7
    s_lshl_b32 s90, s32, 5
    v_add_u32 v6, s90, v6
    v_mul_u32_u24 v6, 1280, v6
    v_lshl_add_u32 v10, v5, 4, v6
    v_add_u32 v3, 64, v0
    v_mul_u32_u24 v4, 6554, v3
    v_lshrrev_b32 v4, 16, v4
    v_mul_u32_u24 v5, 10, v4
    v_sub_u32 v5, v3, v5
    v_and_b32 v6, 19, v4
    v_and_b32 v7, 4, v4
    v_lshl_or_b32 v6, v7, 1, v6
    v_and_b32 v7, 8, v4
    v_lshrrev_b32 v7, 1, v7
    v_or_b32 v6, v6, v7
    s_lshl_b32 s90, s32, 5
    v_add_u32 v6, s90, v6
    v_mul_u32_u24 v6, 1280, v6
    v_lshl_add_u32 v11, v5, 4, v6
    v_add_u32 v3, 128, v0
    v_mul_u32_u24 v4, 6554, v3
    v_lshrrev_b32 v4, 16, v4
    v_mul_u32_u24 v5, 10, v4
    v_sub_u32 v5, v3, v5
    v_and_b32 v6, 19, v4
    v_and_b32 v7, 4, v4
    v_lshl_or_b32 v6, v7, 1, v6
    v_and_b32 v7, 8, v4
    v_lshrrev_b32 v7, 1, v7
    v_or_b32 v6, v6, v7
    s_lshl_b32 s90, s32, 5
    v_add_u32 v6, s90, v6
    v_mul_u32_u24 v6, 1280, v6
    v_lshl_add_u32 v12, v5, 4, v6
    v_add_u32 v3, 192, v0
    v_mul_u32_u24 v4, 6554, v3
    v_lshrrev_b32 v4, 16, v4
    v_mul_u32_u24 v5, 10, v4
    v_sub_u32 v5, v3, v5
    v_and_b32 v6, 19, v4
    v_and_b32 v7, 4, v4
    v_lshl_or_b32 v6, v7, 1, v6
    v_and_b32 v7, 8, v4
    v_lshrrev_b32 v7, 1, v7
    v_or_b32 v6, v6, v7
    s_lshl_b32 s90, s32, 5
    v_add_u32 v6, s90, v6
    v_mul_u32_u24 v6, 1280, v6
    v_lshl_add_u32 v13, v5, 4, v6
    v_add_u32 v3, 256, v0
    v_mul_u32_u24 v4, 6554, v3
    v_lshrrev_b32 v4, 16, v4
    v_mul_u32_u24 v5, 10, v4
    v_sub_u32 v5, v3, v5
    v_and_b32 v6, 19, v4
    v_and_b32 v7, 4, v4
    v_lshl_or_b32 v6, v7, 1, v6
    v_and_b32 v7, 8, v4
    v_lshrrev_b32 v7, 1, v7
    v_or_b32 v6, v6, v7
    s_lshl_b32 s90, s32, 5
    v_add_u32 v6, s90, v6
    v_mul_u32_u24 v6, 1280, v6
    v_lshl_add_u32 v14, v5, 4, v6
    s_mov_b32 s46, 0
    s_mov_b32 s47, 0
    s_mul_i32 s43, s52, 160
    s_mov_b32 s44, 0
    s_mov_b32 s45, 0
    s_mov_b32 s51, 40
    s_mov_b32 s48, s52
    s_mov_b32 s53, 0
L_pa_pf_64:
    s_mul_i32 s90, s32, 5120
    s_add_u32 m0, s90, s47
    s_mul_i32 s91, s44, 163840
    s_add_u32 s91, s91, s43
    buffer_load_dwordx4 v[248:251], v10, s[20:23], s91 offen
    s_add_u32 s47, s47, 20480
    s_cmp_eq_u32 s47, 81920
    s_cselect_b32 s47, 0, s47
    s_cmp_lg_u32 s51, 0
    s_cselect_b32 s90, 1, 0
    s_sub_u32 s51, s51, s90
    s_add_u32 s44, s44, s90
    s_cmp_eq_u32 s44, 5
    s_cselect_b32 s44, 0, s44
    s_cselect_b32 s90, 160, 0
    s_add_u32 s43, s43, s90
    s_cmp_eq_u32 s43, 1280
    s_cselect_b32 s43, 0, s43
    s_add_u32 m0, m0, 1024
    buffer_load_dwordx4 v[248:251], v11, s[20:23], s91 offen
    s_add_u32 m0, m0, 1024
    buffer_load_dwordx4 v[248:251], v12, s[20:23], s91 offen
    s_add_u32 m0, m0, 1024
    buffer_load_dwordx4 v[248:251], v13, s[20:23], s91 offen
    s_add_u32 m0, m0, 1024
    buffer_load_dwordx4 v[248:251], v14, s[20:23], s91 offen
    s_waitcnt vmcnt(20)
    s_cmp_lg_u32 s51, 0
    s_cbranch_scc1 L_pa_pf_64
    s_branch L_pa_end
L_pa_rows:
    s_mov_b32 s46, 0
    s_mov_b32 s47, 0
    s_mul_i32 s43, s52, 160
    s_mov_b32 s44, 0
    s_mov_b32 s45, 0
    s_mov_b32 s51, 119
    s_mov_b32 s48, s52
    s_mov_b32 s53, 0
    s_mul_i32 s90, s32, 5120
    s_add_u32 m0, s90, s47
    s_mul_i32 s91, s44, 491520
    s_add_u32 s91, s91, s43
    buffer_load_dwordx4 v10, s[16:19], s91 offen lds
    s_add_u32 s47, s47, 20480
    s_cmp_eq_u32 s47, 81920
    s_cselect_b32 s47, 0, s47
    s_cmp_lg_u32 s51, 0
    s_cselect_b32 s90, 1, 0
    s_sub_u32 s51, s51, s90
    s_add_u32 s44, s44, s90
    s_cmp_eq_u32 s44, 5
    s_cselect_b32 s44, 0, s44
    s_cselect_b32 s90, 1280, 0
    s_addc_u32 s45, s45, 0
    s_add_u32 s43, s43, s90
    s_cmp_eq_u32 s45, 3
    s_cselect_b32 s45, 0, s45
    s_cselect_b32 s90, 3680, 0
    s_cmp_eq_u32 s43, 4960
    s_cselect_b32 s90, s43, s90
    s_sub_u32 s43, s43, s90
    s_add_u32 m0, m0, 1024
    s_nop 0
    buffer_load_dwordx4 v11, s[16:19], s91 offen lds
    s_add_u32 m0, m0, 1024
    s_nop 0
    buffer_load_dwordx4 v12, s[16:19], s91 offen lds
    s_add_u32 m0, m0, 1024
    s_nop 0
    buffer_load_dwordx4 v13, s[16:19], s91 offen lds
    s_add_u32 m0, m0, 1024
    s_nop 0
    buffer_load_dwordx4 v14, s[16:19], s91 offen lds
    s_mul_i32 s90, s32, 5120
    s_add_u32 m0, s90, s47
    s_mul_i32 s91, s44, 491520
    s_add_u32 s91, s91, s43
    buffer_load_dwordx4 v10, s[16:19], s91 offen lds
    s_add_u32 s47, s47, 20480
    s_cmp_eq_u32 s47, 81920
    s_cselect_b32 s47, 0, s47
    s_cmp_lg_u32 s51, 0
    s_cselect_b32 s90, 1, 0
    s_sub_u32 s51, s51, s90
    s_add_u32 s44, s44, s90
    s_cmp_eq_u32 s44, 5
    s_cselect_b32 s44, 0, s44
    s_cselect_b32 s90, 1280, 0
    s_addc_u32 s45, s45, 0
    s_add_u32 s43, s43, s90
    s_cmp_eq_u32 s45, 3
    s_cselect_b32 s45, 0, s45
    s_cselect_b32 s90, 3680, 0
    s_cmp_eq_u32 s43, 4960
    s_cselect_b32 s90, s43, s90
    s_sub_u32 s43, s43, s90
    s_add_u32 m0, m0, 1024
    s_nop 0
    buffer_load_dwordx4 v11, s[16:19], s91 offen lds
    s_add_u32 m0, m0, 1024
    s_nop 0
    buffer_load_dwordx4 v12, s[16:19], s91 offen lds
    s_add_u32 m0, m0, 1024
    s_nop 0
    buffer_load_dwordx4 v13, s[16:19], s91 offen lds
    s_add_u32 m0, m0, 1024
    s_nop 0
    buffer_load_dwordx4 v14, s[16:19], s91 offen lds
    s_mul_i32 s90, s32, 5120
    s_add_u32 m0, s90, s47
    s_mul_i32 s91, s44, 491520
    s_add_u32 s91, s91, s43
    buffer_load_dwordx4 v10, s[16:19], s91 offen lds
    s_add_u32 s47, s47, 20480
    s_cmp_eq_u32 s47, 81920
    s_cselect_b32 s47, 0, s47
    s_cmp_lg_u32 s51, 0
    s_cselect_b32 s90, 1, 0
    s_sub_u32 s51, s51, s90
    s_add_u32 s44, s44, s90
    s_cmp_eq_u32 s44, 5
    s_cselect_b32 s44, 0, s44
    s_cselect_b32 s90, 1280, 0
    s_addc_u32 s45, s45, 0
    s_add_u32 s43, s43, s90
    s_cmp_eq_u32 s45, 3
    s_cselect_b32 s45, 0, s45
    s_cselect_b32 s90, 3680, 0
    s_cmp_eq_u32 s43, 4960
    s_cselect_b32 s90, s43, s90
    s_sub_u32 s43, s43, s90
    s_add_u32 m0, m0, 1024
    s_nop 0
    buffer_load_dwordx4 v11, s[16:19], s91 offen lds
    s_add_u32 m0, m0, 1024
    s_nop 0
    buffer_load_dwordx4 v12, s[16:19], s91 offen lds
    s_add_u32 m0, m0, 1024
    s_nop 0
    buffer_load_dwordx4 v13, s[16:19], s91 offen lds
    s_add_u32 m0, m0, 1024
    s_nop 0
    buffer_load_dwordx4 v14, s[16:19], s91 offen lds
    v_add_u32 v16, s46, v15
    s_waitcnt vmcnt(10) lgkmcnt(0)
    s_barrier
    ds_read_b64_tr_b16 v[96:97], v16 offset:0
    ds_read_b64_tr_b16 v[98:99], v16 offset:1280
    ds_read_b64_tr_b16 v[100:101], v16 offset:32
    ds_read_b64_tr_b16 v[102:103], v16 offset:1312
    ds_read_b64_tr_b16 v[104:105], v16 offset:64
    ds_read_b64_tr_b16 v[106:107], v16 offset:1344
    ds_read_b64_tr_b16 v[108:109], v16 offset:96
    ds_read_b64_tr_b16 v[110:111], v16 offset:1376
    ds_read_b64_tr_b16 v[112:113], v16 offset:128
    ds_read_b64_tr_b16 v[114:115], v16 offset:1408
L_pa_grp:
    s_mov_b32 s41, 0
L_pa_blk:
    s_waitcnt lgkmcnt(8)
    v_mfma_f32_16x16x32_bf16 v[136:139], v[96:99], a[0:3], 0
    ds_read_b64_tr_b16 v[116:117], v16 offset:5120
    s_add_u32 s46, s46, 20480
    s_cmp_eq_u32 s46, 81920
    v_mfma_f32_16x16x32_bf16 v[140:143], v[96:99], a[80:83], 0
    ds_read_b64_tr_b16 v[118:119], v16 offset:6400
    s_cselect_b32 s46, 0, s46
    s_mul_i32 s90, s32, 5120
    s_waitcnt lgkmcnt(8)
    v_mfma_f32_16x16x32_bf16 v[144:147], v[100:103], a[0:3], 0
    ds_read_b64_tr_b16 v[120:121], v16 offset:5152
    s_add_u32 m0, s90, s47
    s_mul_i32 s91, s44, 491520
    v_mfma_f32_16x16x32_bf16 v[148:151], v[100:103], a[80:83], 0
    ds_read_b64_tr_b16 v[122:123], v16 offset:6432
    s_add_u32 s91, s91, s43
    buffer_load_dwordx4 v10, s[16:19], s91 offen lds
    s_waitcnt lgkmcnt(8)
    v_mfma_f32_16x16x32_bf16 v[152:155], v[104:107], a[0:3], 0
    ds_read_b64_tr_b16 v[124:125], v16 offset:5184
    s_add_u32 s47, s47, 20480
    s_cmp_eq_u32 s47, 81920
    v_mfma_f32_16x16x32_bf16 v[156:159], v[104:107], a[80:83], 0
    ds_read_b64_tr_b16 v[126:127], v16 offset:6464
    s_cselect_b32 s47, 0, s47
    s_cmp_lg_u32 s51, 0
    s_waitcnt lgkmcnt(8)
    v_mfma_f32_16x16x32_bf16 v[160:163], v[108:111], a[0:3], 0
    ds_read_b64_tr_b16 v[128:129], v16 offset:5216
    s_cselect_b32 s90, 1, 0
    s_sub_u32 s51, s51, s90
    v_mfma_f32_16x16x32_bf16 v[164:167], v[108:111], a[80:83], 0
    ds_read_b64_tr_b16 v[130:131], v16 offset:6496
    s_add_u32 s44, s44, s90
    s_cmp_eq_u32 s44, 5
    s_waitcnt lgkmcnt(8)
    v_mfma_f32_16x16x32_bf16 v[168:171], v[112:115], a[0:3], 0
    ds_read_b64_tr_b16 v[132:133], v16 offset:5248
    s_cselect_b32 s44, 0, s44
    s_cselect_b32 s90, 1280, 0
    v_mfma_f32_16x16x32_bf16 v[172:175], v[112:115], a[80:83], 0
    ds_read_b64_tr_b16 v[134:135], v16 offset:6528
    s_addc_u32 s45, s45, 0
    s_add_u32 s43, s43, s90
    s_waitcnt lgkmcnt(8)
    v_mfma_f32_16x16x32_bf16 v[136:139], v[116:119], a[4:7], v[136:139]
    ds_read_b64_tr_b16 v[96:97], v16 offset:10240
    s_cmp_eq_u32 s45, 3
    s_cselect_b32 s45, 0, s45
    v_mfma_f32_16x16x32_bf16 v[140:143], v[116:119], a[84:87], v[140:143]
    ds_read_b64_tr_b16 v[98:99], v16 offset:11520
    s_cselect_b32 s90, 3680, 0
    s_cmp_eq_u32 s43, 4960
    s_waitcnt lgkmcnt(8)
    v_mfma_f32_16x16x32_bf16 v[144:147], v[120:123], a[4:7], v[144:147]
    ds_read_b64_tr_b16 v[100:101], v16 offset:10272
    s_cselect_b32 s90, s43, s90
    s_sub_u32 s43, s43, s90
    v_mfma_f32_16x16x32_bf16 v[148:151], v[120:123], a[84:87], v[148:151]
    ds_read_b64_tr_b16 v[102:103], v16 offset:11552
    s_add_u32 m0, m0, 1024
    s_nop 0
    buffer_load_dwordx4 v11, s[16:19], s91 offen lds
    s_waitcnt lgkmcnt(8)
    v_mfma_f32_16x16x32_bf16 v[152:155], v[124:127], a[4:7], v[152:155]
    ds_read_b64_tr_b16 v[104:105], v16 offset:10304
    s_add_u32 m0, m0, 1024
    v_mfma_f32_16x16x32_bf16 v[156:159], v[124:127], a[84:87], v[156:159]
    ds_read_b64_tr_b16 v[106:107], v16 offset:11584
    s_waitcnt lgkmcnt(8)
    v_mfma_f32_16x16x32_bf16 v[160:163], v[128:131], a[4:7], v[160:163]
    ds_read_b64_tr_b16 v[108:109], v16 offset:10336
    v_mfma_f32_16x16x32_bf16 v[164:167], v[128:131], a[84:87], v[164:167]
    ds_read_b64_tr_b16 v[110:111], v16 offset:11616
    s_waitcnt lgkmcnt(8)
    v_mfma_f32_16x16x32_bf16 v[168:171], v[132:135], a[4:7], v[168:171]
    ds_read_b64_tr_b16 v[112:113], v16 offset:10368
    buffer_load_dwordx4 v12, s[16:19], s91 offen lds
    s_add_u32 m0, m0, 1024
    v_mfma_f32_16x16x32_bf16 v[172:175], v[132:135], a[84:87], v[172:175]
    ds_read_b64_tr_b16 v[114:115], v16 offset:11648
    s_waitcnt lgkmcnt(8)
    v_mfma_f32_16x16x32_bf16 v[136:139], v[96:99], a[8:11], v[136:139]
    ds_read_b64_tr_b16 v[116:117], v16 offset:15360
    v_mfma_f32_16x16x32_bf16 v[140:143], v[96:99], a[88:91], v[140:143]
    ds_read_b64_tr_b16 v[118:119], v16 offset:16640
    s_waitcnt lgkmcnt(8)
    v_mfma_f32_16x16x32_bf16 v[144:147], v[100:103], a[8:11], v[144:147]
    ds_read_b64_tr_b16 v[120:121], v16 offset:15392
    v_mfma_f32_16x16x32_bf16 v[148:151], v[100:103], a[88:91], v[148:151]
    ds_read_b64_tr_b16 v[122:123], v16 offset:16672
    buffer_load_dwordx4 v13, s[16:19], s91 offen lds
    s_add_u32 m0, m0, 1024
    s_waitcnt lgkmcnt(8)
    v_mfma_f32_16x16x32_bf16 v[152:155], v[104:107], a[8:11], v[152:155]
    ds_read_b64_tr_b16 v[124:125], v16 offset:15424
    v_mfma_f32_16x16x32_bf16 v[156:159], v[104:107], a[88:91], v[156:159]
    ds_read_b64_tr_b16 v[126:127], v16 offset:16704
    s_waitcnt lgkmcnt(8)
    v_mfma_f32_16x16x32_bf16 v[160:163], v[108:111], a[8:11], v[160:163]
    ds_read_b64_tr_b16 v[128:129], v16 offset:15456
    v_mfma_f32_16x16x32_bf16 v[164:167], v[108:111], a[88:91], v[164:167]
    ds_read_b64_tr_b16 v[130:131], v16 offset:16736
    s_waitcnt lgkmcnt(8)
    v_mfma_f32_16x16x32_bf16 v[168:171], v[112:115], a[8:11], v[168:171]
    ds_read_b64_tr_b16 v[132:133], v16 offset:15488
    buffer_load_dwordx4 v14, s[16:19], s91 offen lds
    v_mfma_f32_16x16x32_bf16 v[172:175], v[112:115], a[88:91], v[172:175]
    ds_read_b64_tr_b16 v[134:135], v16 offset:16768
    s_waitcnt lgkmcnt(8)
    v_mfma_f32_16x16x32_bf16 v[136:139], v[116:119], a[12:15], v[136:139]
    v_mfma_f32_16x16x32_bf16 v[140:143], v[116:119], a[92:95], v[140:143]
    s_waitcnt lgkmcnt(6)
    v_mfma_f32_16x16x32_bf16 v[144:147], v[120:123], a[12:15], v[144:147]
    v_mfma_f32_16x16x32_bf16 v[148:151], v[120:123], a[92:95], v[148:151]
    v_add_u32 v16, s46, v15
    s_waitcnt vmcnt(10) lgkmcnt(0)
    s_barrier
    v_mfma_f32_16x16x32_bf16 v[152:155], v[124:127], a[12:15], v[152:155]
    ds_read_b64_tr_b16 v[96:97], v16 offset:0
    ds_read_b64_tr_b16 v[98:99], v16 offset:1280
    v_mfma_f32_16x16x32_bf16 v[156:159], v[124:127], a[92:95], v[156:159]
    ds_read_b64_tr_b16 v[100:101], v16 offset:32
    ds_read_b64_tr_b16 v[102:103], v16 offset:1312
    v_mfma_f32_16x16x32_bf16 v[160:163], v[128:131], a[12:15], v[160:163]
    ds_read_b64_tr_b16 v[104:105], v16 offset:64
    ds_read_b64_tr_b16 v[106:107], v16 offset:1344
    v_mfma_f32_16x16x32_bf16 v[164:167], v[128:131], a[92:95], v[164:167]
    ds_read_b64_tr_b16 v[108:109], v16 offset:96
    ds_read_b64_tr_b16 v[110:111], v16 offset:1376
    v_mfma_f32_16x16x32_bf16 v[168:171], v[132:135], a[12:15], v[168:171]
    ds_read_b64_tr_b16 v[112:113], v16 offset:128
    ds_read_b64_tr_b16 v[114:115], v16 offset:1408
    v_mfma_f32_16x16x32_bf16 v[172:175], v[132:135], a[92:95], v[172:175]
    s_waitcnt lgkmcnt(8)
    v_mfma_f32_16x16x32_bf16 v[136:139], v[96:99], a[16:19], v[136:139]
    ds_read_b64_tr_b16 v[116:117], v16 offset:5120
    s_add_u32 s46, s46, 20480
    s_cmp_eq_u32 s46, 81920
    v_mfma_f32_16x16x32_bf16 v[140:143], v[96:99], a[96:99], v[140:143]
    ds_read_b64_tr_b16 v[118:119], v16 offset:6400
    s_cselect_b32 s46, 0, s46
    s_mul_i32 s90, s32, 5120
    s_waitcnt lgkmcnt(8)
    v_mfma_f32_16x16x32_bf16 v[144:147], v[100:103], a[16:19], v[144:147]
    ds_read_b64_tr_b16 v[120:121], v16 offset:5152
    s_add_u32 m0, s90, s47
    s_mul_i32 s91, s44, 491520
    v_mfma_f32_16x16x32_bf16 v[148:151], v[100:103], a[96:99], v[148:151]
    ds_read_b64_tr_b16 v[122:123], v16 offset:6432
    s_add_u32 s91, s91, s43
    buffer_load_dwordx4 v10, s[16:19], s91 offen lds
    s_waitcnt lgkmcnt(8)
    v_mfma_f32_16x16x32_bf16 v[152:155], v[104:107], a[16:19], v[152:155]
    ds_read_b64_tr_b16 v[124:125], v16 offset:5184
    s_add_u32 s47, s47, 20480
    s_cmp_eq_u32 s47, 81920
    v_mfma_f32_16x16x32_bf16 v[156:159], v[104:107], a[96:99], v[156:159]
    ds_read_b64_tr_b16 v[126:127], v16 offset:6464
    s_cselect_b32 s47, 0, s47
    s_cmp_lg_u32 s51, 0
    s_waitcnt lgkmcnt(8)
    v_mfma_f32_16x16x32_bf16 v[160:163], v[108:111], a[16:19], v[160:163]
    ds_read_b64_tr_b16 v[128:129], v16 offset:5216
    s_cselect_b32 s90, 1, 0
    s_sub_u32 s51, s51, s90
    v_mfma_f32_16x16x32_bf16 v[164:167], v[108:111], a[96:99], v[164:167]
    ds_read_b64_tr_b16 v[130:131], v16 offset:6496
    s_add_u32 s44, s44, s90
    s_cmp_eq_u32 s44, 5
    s_waitcnt lgkmcnt(8)
    v_mfma_f32_16x16x32_bf16 v[168:171], v[112:115], a[16:19], v[168:171]
    ds_read_b64_tr_b16 v[132:133], v16 offset:5248
    s_cselect_b32 s44, 0, s44
    s_cselect_b32 s90, 1280, 0
    v_mfma_f32_16x16x32_bf16 v[172:175], v[112:115], a[96:99], v[172:175]
    ds_read_b64_tr_b16 v[134:135], v16 offset:6528
    s_addc_u32 s45, s45, 0
    s_add_u32 s43, s43, s90
    s_waitcnt lgkmcnt(8)
    v_mfma_f32_16x16x32_bf16 v[136:139], v[116:119], a[20:23], v[136:139]
    ds_read_b64_tr_b16 v[96:97], v16 offset:10240
    s_cmp_eq_u32 s45, 3
    s_cselect_b32 s45, 0, s45
    v_mfma_f32_16x16x32_bf16 v[140:143], v[116:119], a[100:103], v[140:143]
    ds_read_b64_tr_b16 v[98:99], v16 offset:11520
    s_cselect_b32 s90, 3680, 0
    s_cmp_eq_u32 s43, 4960
    s_waitcnt lgkmcnt(8)
    v_mfma_f32_16x16x32_bf16 v[144:147], v[120:123], a[20:23], v[144:147]
    ds_read_b64_tr_b16 v[100:101], v16 offset:10272
    s_cselect_b32 s90, s43, s90
    s_sub_u32 s43, s43, s90
    v_mfma_f32_16x16x32_bf16 v[148:151], v[120:123], a[100:103], v[148:151]
    ds_read_b64_tr_b16 v[102:103], v16 offset:11552
    s_add_u32 m0, m0, 1024
    s_nop 0
    buffer_load_dwordx4 v11, s[16:19], s91 offen lds
    s_waitcnt lgkmcnt(8)
    v_mfma_f32_16x16x32_bf16 v[152:155], v[124:127], a[20:23], v[152:155]
    ds_read_b64_tr_b16 v[104:105], v16 offset:10304
    s_add_u32 m0, m0, 1024
    v_mfma_f32_16x16x32_bf16 v[156:159], v[124:127], a[100:103], v[156:159]
    ds_read_b64_tr_b16 v[106:107], v16 offset:11584
    s_waitcnt lgkmcnt(8)
    v_mfma_f32_16x16x32_bf16 v[160:163], v[128:131], a[20:23], v[160:163]
    ds_read_b64_tr_b16 v[108:109], v16 offset:10336
    v_mfma_f32_16x16x32_bf16 v[164:167], v[128:131], a[100:103], v[164:167]
    ds_read_b64_tr_b16 v[110:111], v16 offset:11616
    s_waitcnt lgkmcnt(8)
    v_mfma_f32_16x16x32_bf16 v[168:171], v[132:135], a[20:23], v[168:171]
    ds_read_b64_tr_b16 v[112:113], v16 offset:10368
    buffer_load_dwordx4 v12, s[16:19], s91 offen lds
    s_add_u32 m0, m0, 1024
    v_mfma_f32_16x16x32_bf16 v[172:175], v[132:135], a[100:103], v[172:175]
    ds_read_b64_tr_b16 v[114:115], v16 offset:11648
    s_waitcnt lgkmcnt(8)
    v_mfma_f32_16x16x32_bf16 v[136:139], v[96:99], a[24:27], v[136:139]
    ds_read_b64_tr_b16 v[116:117], v16 offset:15360
    v_mfma_f32_16x16x32_bf16 v[140:143], v[96:99], a[104:107], v[140:143]
    ds_read_b64_tr_b16 v[118:119], v16 offset:16640
    s_waitcnt lgkmcnt(8)
    v_mfma_f32_16x16x32_bf16 v[144:147], v[100:103], a[24:27], v[144:147]
    ds_read_b64_tr_b16 v[120:121], v16 offset:15392
    v_mfma_f32_16x16x32_bf16 v[148:151], v[100:103], a[104:107], v[148:151]
    ds_read_b64_tr_b16 v[122:123], v16 offset:16672
    buffer_load_dwordx4 v13, s[16:19], s91 offen lds
    s_add_u32 m0, m0, 1024
    s_waitcnt lgkmcnt(8)
    v_mfma_f32_16x16x32_bf16 v[152:155], v[104:107], a[24:27], v[152:155]
    ds_read_b64_tr_b16 v[124:125], v16 offset:15424
    v_mfma_f32_16x16x32_bf16 v[156:159], v[104:107], a[104:107], v[156:159]
    ds_read_b64_tr_b16 v[126:127], v16 offset:16704
    s_waitcnt lgkmcnt(8)
    v_mfma_f32_16x16x32_bf16 v[160:163], v[108:111], a[24:27], v[160:163]
    ds_read_b64_tr_b16 v[128:129], v16 offset:15456
    v_mfma_f32_16x16x32_bf16 v[164:167], v[108:111], a[104:107], v[164:167]
    ds_read_b64_tr_b16 v[130:131], v16 offset:16736
    s_waitcnt lgkmcnt(8)
    v_mfma_f32_16x16x32_bf16 v[168:171], v[112:115], a[24:27], v[168:171]
    ds_read_b64_tr_b16 v[132:133], v16 offset:15488
    buffer_load_dwordx4 v14, s[16:19], s91 offen lds
    v_mfma_f32_16x16x32_bf16 v[172:175], v[112:115], a[104:107], v[172:175]
    ds_read_b64_tr_b16 v[134:135], v16 offset:16768
    s_waitcnt lgkmcnt(8)
    v_mfma_f32_16x16x32_bf16 v[136:139], v[116:119], a[28:31], v[136:139]
    v_mfma_f32_16x16x32_bf16 v[140:143], v[116:119], a[108:111], v[140:143]
    s_waitcnt lgkmcnt(6)
    v_mfma_f32_16x16x32_bf16 v[144:147], v[120:123], a[28:31], v[144:147]
    v_mfma_f32_16x16x32_bf16 v[148:151], v[120:123], a[108:111], v[148:151]
    v_add_u32 v16, s46, v15
    s_waitcnt vmcnt(10) lgkmcnt(0)
    s_barrier
    v_mfma_f32_16x16x32_bf16 v[152:155], v[124:127], a[28:31], v[152:155]
    ds_read_b64_tr_b16 v[96:97], v16 offset:0
    ds_read_b64_tr_b16 v[98:99], v16 offset:1280
    v_mfma_f32_16x16x32_bf16 v[156:159], v[124:127], a[108:111], v[156:159]
    ds_read_b64_tr_b16 v[100:101], v16 offset:32
    ds_read_b64_tr_b16 v[102:103], v16 offset:1312
    v_mfma_f32_16x16x32_bf16 v[160:163], v[128:131], a[28:31], v[160:163]
    ds_read_b64_tr_b16 v[104:105], v16 offset:64
    ds_read_b64_tr_b16 v[106:107], v16 offset:1344
    v_mfma_f32_16x16x32_bf16 v[164:167], v[128:131], a[108:111], v[164:167]
    ds_read_b64_tr_b16 v[108:109], v16 offset:96
    ds_read_b64_tr_b16 v[110:111], v16 offset:1376
    v_mfma_f32_16x16x32_bf16 v[168:171], v[132:135], a[28:31], v[168:171]
    ds_read_b64_tr_b16 v[112:113], v16 offset:128
    ds_read_b64_tr_b16 v[114:115], v16 offset:1408
    v_mfma_f32_16x16x32_bf16 v[172:175], v[132:135], a[108:111], v[172:175]
    s_waitcnt lgkmcnt(8)
    v_mfma_f32_16x16x32_bf16 v[136:139], v[96:99], a[32:35], v[136:139]
    ds_read_b64_tr_b16 v[116:117], v16 offset:5120
    s_add_u32 s46, s46, 20480
    s_cmp_eq_u32 s46, 81920
    v_mfma_f32_16x16x32_bf16 v[140:143], v[96:99], a[112:115], v[140:143]
    ds_read_b64_tr_b16 v[118:119], v16 offset:6400
    s_cselect_b32 s46, 0, s46
    s_mul_i32 s90, s32, 5120
    s_waitcnt lgkmcnt(8)
    v_mfma_f32_16x16x32_bf16 v[144:147], v[100:103], a[32:35], v[144:147]
    ds_read_b64_tr_b16 v[120:121], v16 offset:5152
    s_add_u32 m0, s90, s47
    s_mul_i32 s91, s44, 491520
    v_mfma_f32_16x16x32_bf16 v[148:151], v[100:103], a[112:115], v[148:151]
    ds_read_b64_tr_b16 v[122:123], v16 offset:6432
    s_add_u32 s91, s91, s43
    buffer_load_dwordx4 v10, s[16:19], s91 offen lds
    s_waitcnt lgkmcnt(8)
    v_mfma_f32_16x16x32_bf16 v[152:155], v[104:107], a[32:35], v[152:155]
    ds_read_b64_tr_b16 v[124:125], v16 offset:5184
    s_add_u32 s47, s47, 20480
    s_cmp_eq_u32 s47, 81920
    v_mfma_f32_16x16x32_bf16 v[156:159], v[104:107], a[112:115], v[156:159]
    ds_read_b64_tr_b16 v[126:127], v16 offset:6464
    s_cselect_b32 s47, 0, s47
    s_cmp_lg_u32 s51, 0
    s_waitcnt lgkmcnt(8)
    v_mfma_f32_16x16x32_bf16 v[160:163], v[108:111], a[32:35], v[160:163]
    ds_read_b64_tr_b16 v[128:129], v16 offset:5216
    s_cselect_b32 s90, 1, 0
    s_sub_u32 s51, s51, s90
    v_mfma_f32_16x16x32_bf16 v[164:167], v[108:111], a[112:115], v[164:167]
    ds_read_b64_tr_b16 v[130:131], v16 offset:6496
    s_add_u32 s44, s44, s90
    s_cmp_eq_u32 s44, 5
    s_waitcnt lgkmcnt(8)
    v_mfma_f32_16x16x32_bf16 v[168:171], v[112:115], a[32:35], v[168:171]
    ds_read_b64_tr_b16 v[132:133], v16 offset:5248
    s_cselect_b32 s44, 0, s44
    s_cselect_b32 s90, 1280, 0
    v_mfma_f32_16x16x32_bf16 v[172:175], v[112:115], a[112:115], v[172:175]
    ds_read_b64_tr_b16 v[134:135], v16 offset:6528
    s_addc_u32 s45, s45, 0
    s_add_u32 s43, s43, s90
    s_waitcnt lgkmcnt(8)
    v_mfma_f32_16x16x32_bf16 v[136:139], v[116:119], a[36:39], v[136:139]
    ds_read_b64_tr_b16 v[96:97], v16 offset:10240
    s_cmp_eq_u32 s45, 3
    s_cselect_b32 s45, 0, s45
    v_mfma_f32_16x16x32_bf16 v[140:143], v[116:119], a[116:119], v[140:143]
    ds_read_b64_tr_b16 v[98:99], v16 offset:11520
    s_cselect_b32 s90, 3680, 0
    s_cmp_eq_u32 s43, 4960
    s_waitcnt lgkmcnt(8)
    v_mfma_f32_16x16x32_bf16 v[144:147], v[120:123], a[36:39], v[144:147]
    ds_read_b64_tr_b16 v[100:101], v16 offset:10272
    s_cselect_b32 s90, s43, s90
    s_sub_u32 s43, s43, s90
    v_mfma_f32_16x16x32_bf16 v[148:151], v[120:123], a[116:119], v[148:151]
    ds_read_b64_tr_b16 v[102:103], v16 offset:11552
    s_add_u32 m0, m0, 1024
    s_nop 0
    buffer_load_dwordx4 v11, s[16:19], s91 offen lds
    s_waitcnt lgkmcnt(8)
    v_mfma_f32_16x16x32_bf16 v[152:155], v[124:127], a[36:39], v[152:155]
    ds_read_b64_tr_b16 v[104:105], v16 offset:10304
    s_add_u32 m0, m0, 1024
    v_mfma_f32_16x16x32_bf16 v[156:159], v[124:127], a[116:119], v[156:159]
    ds_read_b64_tr_b16 v[106:107], v16 offset:11584
    s_waitcnt lgkmcnt(8)
    v_mfma_f32_16x16x32_bf16 v[160:163], v[128:131], a[36:39], v[160:163]
    ds_read_b64_tr_b16 v[108:109], v16 offset:10336
    v_mfma_f32_16x16x32_bf16 v[164:167], v[128:131], a[116:119], v[164:167]
    ds_read_b64_tr_b16 v[110:111], v16 offset:11616
    s_waitcnt lgkmcnt(8)
    v_mfma_f32_16x16x32_bf16 v[168:171], v[132:135], a[36:39], v[168:171]
    ds_read_b64_tr_b16 v[112:113], v16 offset:10368
    buffer_load_dwordx4 v12, s[16:19], s91 offen lds
    s_add_u32 m0, m0, 1024
    v_mfma_f32_16x16x32_bf16 v[172:175], v[132:135], a[116:119], v[172:175]
    ds_read_b64_tr_b16 v[114:115], v16 offset:11648
    s_waitcnt lgkmcnt(8)
    v_mfma_f32_16x16x32_bf16 v[136:139], v[96:99], a[40:43], v[136:139]
    ds_read_b64_tr_b16 v[116:117], v16 offset:15360
    v_mfma_f32_16x16x32_bf16 v[140:143], v[96:99], a[120:123], v[140:143]
    ds_read_b64_tr_b16 v[118:119], v16 offset:16640
    s_waitcnt lgkmcnt(8)
    v_mfma_f32_16x16x32_bf16 v[144:147], v[100:103], a[40:43], v[144:147]
    ds_read_b64_tr_b16 v[120:121], v16 offset:15392
    v_mfma_f32_16x16x32_bf16 v[148:151], v[100:103], a[120:123], v[148:151]
    ds_read_b64_tr_b16 v[122:123], v16 offset:16672
    buffer_load_dwordx4 v13, s[16:19], s91 offen lds
    s_add_u32 m0, m0, 1024
    s_waitcnt lgkmcnt(8)
    v_mfma_f32_16x16x32_bf16 v[152:155], v[104:107], a[40:43], v[152:155]
    ds_read_b64_tr_b16 v[124:125], v16 offset:15424
    v_mfma_f32_16x16x32_bf16 v[156:159], v[104:107], a[120:123], v[156:159]
    ds_read_b64_tr_b16 v[126:127], v16 offset:16704
    s_waitcnt lgkmcnt(8)
    v_mfma_f32_16x16x32_bf16 v[160:163], v[108:111], a[40:43], v[160:163]
    ds_read_b64_tr_b16 v[128:129], v16 offset:15456
    v_mfma_f32_16x16x32_bf16 v[164:167], v[108:111], a[120:123], v[164:167]
    ds_read_b64_tr_b16 v[130:131], v16 offset:16736
    s_waitcnt lgkmcnt(8)
    v_mfma_f32_16x16x32_bf16 v[168:171], v[112:115], a[40:43], v[168:171]
    ds_read_b64_tr_b16 v[132:133], v16 offset:15488
    buffer_load_dwordx4 v14, s[16:19], s91 offen lds
    v_mfma_f32_16x16x32_bf16 v[172:175], v[112:115], a[120:123], v[172:175]
    ds_read_b64_tr_b16 v[134:135], v16 offset:16768
    s_waitcnt lgkmcnt(8)
    v_mfma_f32_16x16x32_bf16 v[136:139], v[116:119], a[44:47], v[136:139]
    v_mfma_f32_16x16x32_bf16 v[140:143], v[116:119], a[124:127], v[140:143]
    s_waitcnt lgkmcnt(6)
    v_mfma_f32_16x16x32_bf16 v[144:147], v[120:123], a[44:47], v[144:147]
    v_mfma_f32_16x16x32_bf16 v[148:151], v[120:123], a[124:127], v[148:151]
    v_add_u32 v16, s46, v15
    s_waitcnt vmcnt(10) lgkmcnt(0)
    s_barrier
    v_mfma_f32_16x16x32_bf16 v[152:155], v[124:127], a[44:47], v[152:155]
    ds_read_b64_tr_b16 v[96:97], v16 offset:0
    ds_read_b64_tr_b16 v[98:99], v16 offset:1280
    v_mfma_f32_16x16x32_bf16 v[156:159], v[124:127], a[124:127], v[156:159]
    ds_read_b64_tr_b16 v[100:101], v16 offset:32
    ds_read_b64_tr_b16 v[102:103], v16 offset:1312
    v_mfma_f32_16x16x32_bf16 v[160:163], v[128:131], a[44:47], v[160:163]
    ds_read_b64_tr_b16 v[104:105], v16 offset:64
    ds_read_b64_tr_b16 v[106:107], v16 offset:1344
    v_mfma_f32_16x16x32_bf16 v[164:167], v[128:131], a[124:127], v[164:167]
    ds_read_b64_tr_b16 v[108:109], v16 offset:96
    ds_read_b64_tr_b16 v[110:111], v16 offset:1376
    v_mfma_f32_16x16x32_bf16 v[168:171], v[132:135], a[44:47], v[168:171]
    ds_read_b64_tr_b16 v[112:113], v16 offset:128
    ds_read_b64_tr_b16 v[114:115], v16 offset:1408
    v_mfma_f32_16x16x32_bf16 v[172:175], v[132:135], a[124:127], v[172:175]
    s_waitcnt lgkmcnt(8)
    v_mfma_f32_16x16x32_bf16 v[136:139], v[96:99], a[48:51], v[136:139]
    ds_read_b64_tr_b16 v[116:117], v16 offset:5120
    s_add_u32 s46, s46, 20480
    s_cmp_eq_u32 s46, 81920
    v_mfma_f32_16x16x32_bf16 v[140:143], v[96:99], a[128:131], v[140:143]
    ds_read_b64_tr_b16 v[118:119], v16 offset:6400
    s_cselect_b32 s46, 0, s46
    s_mul_i32 s90, s32, 5120
    s_waitcnt lgkmcnt(8)
    v_mfma_f32_16x16x32_bf16 v[144:147], v[100:103], a[48:51], v[144:147]
    ds_read_b64_tr_b16 v[120:121], v16 offset:5152
    s_add_u32 m0, s90, s47
    s_mul_i32 s91, s44, 491520
    v_mfma_f32_16x16x32_bf16 v[148:151], v[100:103], a[128:131], v[148:151]
    ds_read_b64_tr_b16 v[122:123], v16 offset:6432
    s_add_u32 s91, s91, s43
    buffer_load_dwordx4 v10, s[16:19], s91 offen lds
    s_waitcnt lgkmcnt(8)
    v_mfma_f32_16x16x32_bf16 v[152:155], v[104:107], a[48:51], v[152:155]
    ds_read_b64_tr_b16 v[124:125], v16 offset:5184
    s_add_u32 s47, s47, 20480
    s_cmp_eq_u32 s47, 81920
    v_mfma_f32_16x16x32_bf16 v[156:159], v[104:107], a[128:131], v[156:159]
    ds_read_b64_tr_b16 v[126:127], v16 offset:6464
    s_cselect_b32 s47, 0, s47
    s_cmp_lg_u32 s51, 0
    s_waitcnt lgkmcnt(8)
    v_mfma_f32_16x16x32_bf16 v[160:163], v[108:111], a[48:51], v[160:163]
    ds_read_b64_tr_b16 v[128:129], v16 offset:5216
    s_cselect_b32 s90, 1, 0
    s_sub_u32 s51, s51, s90
    v_mfma_f32_16x16x32_bf16 v[164:167], v[108:111], a[128:131], v[164:167]
    ds_read_b64_tr_b16 v[130:131], v16 offset:6496
    s_add_u32 s44, s44, s90
    s_cmp_eq_u32 s44, 5
    s_waitcnt lgkmcnt(8)
    v_mfma_f32_16x16x32_bf16 v[168:171], v[112:115], a[48:51], v[168:171]
    ds_read_b64_tr_b16 v[132:133], v16 offset:5248
    s_cselect_b32 s44, 0, s44
    s_cselect_b32 s90, 1280, 0
    v_mfma_f32_16x16x32_bf16 v[172:175], v[112:115], a[128:131], v[172:175]
    ds_read_b64_tr_b16 v[134:135], v16 offset:6528
    s_addc_u32 s45, s45, 0
    s_add_u32 s43, s43, s90
    s_waitcnt lgkmcnt(8)
    v_mfma_f32_16x16x32_bf16 v[136:139], v[116:119], a[52:55], v[136:139]
    ds_read_b64_tr_b16 v[96:97], v16 offset:10240
    s_cmp_eq_u32 s45, 3
    s_cselect_b32 s45, 0, s45
    v_mfma_f32_16x16x32_bf16 v[140:143], v[116:119], a[132:135], v[140:143]
    ds_read_b64_tr_b16 v[98:99], v16 offset:11520
    s_cselect_b32 s90, 3680, 0
    s_cmp_eq_u32 s43, 4960
    s_waitcnt lgkmcnt(8)
    v_mfma_f32_16x16x32_bf16 v[144:147], v[120:123], a[52:55], v[144:147]
    ds_read_b64_tr_b16 v[100:101], v16 offset:10272
    s_cselect_b32 s90, s43, s90
    s_sub_u32 s43, s43, s90
    v_mfma_f32_16x16x32_bf16 v[148:151], v[120:123], a[132:135], v[148:151]
    ds_read_b64_tr_b16 v[102:103], v16 offset:11552
    s_add_u32 m0, m0, 1024
    s_nop 0
    buffer_load_dwordx4 v11, s[16:19], s91 offen lds
    s_waitcnt lgkmcnt(8)
    v_mfma_f32_16x16x32_bf16 v[152:155], v[124:127], a[52:55], v[152:155]
    ds_read_b64_tr_b16 v[104:105], v16 offset:10304
    s_add_u32 m0, m0, 1024
    v_mfma_f32_16x16x32_bf16 v[156:159], v[124:127], a[132:135], v[156:159]
    ds_read_b64_tr_b16 v[106:107], v16 offset:11584
    s_waitcnt lgkmcnt(8)
    v_mfma_f32_16x16x32_bf16 v[160:163], v[128:131], a[52:55], v[160:163]
    ds_read_b64_tr_b16 v[108:109], v16 offset:10336
    v_mfma_f32_16x16x32_bf16 v[164:167], v[128:131], a[132:135], v[164:167]
    ds_read_b64_tr_b16 v[110:111], v16 offset:11616
    s_waitcnt lgkmcnt(8)
    v_mfma_f32_16x16x32_bf16 v[168:171], v[132:135], a[52:55], v[168:171]
    ds_read_b64_tr_b16 v[112:113], v16 offset:10368
    buffer_load_dwordx4 v12, s[16:19], s91 offen lds
    s_add_u32 m0, m0, 1024
    v_mfma_f32_16x16x32_bf16 v[172:175], v[132:135], a[132:135], v[172:175]
    ds_read_b64_tr_b16 v[114:115], v16 offset:11648
    s_waitcnt lgkmcnt(8)
    v_mfma_f32_16x16x32_bf16 v[136:139], v[96:99], a[56:59], v[136:139]
    ds_read_b64_tr_b16 v[116:117], v16 offset:15360
    v_mfma_f32_16x16x32_bf16 v[140:143], v[96:99], a[136:139], v[140:143]
    ds_read_b64_tr_b16 v[118:119], v16 offset:16640
    s_waitcnt lgkmcnt(8)
    v_mfma_f32_16x16x32_bf16 v[144:147], v[100:103], a[56:59], v[144:147]
    ds_read_b64_tr_b16 v[120:121], v16 offset:15392
    v_mfma_f32_16x16x32_bf16 v[148:151], v[100:103], a[136:139], v[148:151]
    ds_read_b64_tr_b16 v[122:123], v16 offset:16672
    buffer_load_dwordx4 v13, s[16:19], s91 offen lds
    s_add_u32 m0, m0, 1024
    s_waitcnt lgkmcnt(8)
    v_mfma_f32_16x16x32_bf16 v[152:155], v[104:107], a[56:59], v[152:155]
    ds_read_b64_tr_b16 v[124:125], v16 offset:15424
    v_mfma_f32_16x16x32_bf16 v[156:159], v[104:107], a[136:139], v[156:159]
    ds_read_b64_tr_b16 v[126:127], v16 offset:16704
    s_waitcnt lgkmcnt(8)
    v_mfma_f32_16x16x32_bf16 v[160:163], v[108:111], a[56:59], v[160:163]
    ds_read_b64_tr_b16 v[128:129], v16 offset:15456
    v_mfma_f32_16x16x32_bf16 v[164:167], v[108:111], a[136:139], v[164:167]
    ds_read_b64_tr_b16 v[130:131], v16 offset:16736
    s_waitcnt lgkmcnt(8)
    v_mfma_f32_16x16x32_bf16 v[168:171], v[112:115], a[56:59], v[168:171]
    ds_read_b64_tr_b16 v[132:133], v16 offset:15488
    buffer_load_dwordx4 v14, s[16:19], s91 offen lds
    v_mfma_f32_16x16x32_bf16 v[172:175], v[112:115], a[136:139], v[172:175]
    ds_read_b64_tr_b16 v[134:135], v16 offset:16768
    s_waitcnt lgkmcnt(8)
    v_mfma_f32_16x16x32_bf16 v[136:139], v[116:119], a[60:63], v[136:139]
    v_mfma_f32_16x16x32_bf16 v[140:143], v[116:119], a[140:143], v[140:143]
    s_waitcnt lgkmcnt(6)
    v_mfma_f32_16x16x32_bf16 v[144:147], v[120:123], a[60:63], v[144:147]
    v_mfma_f32_16x16x32_bf16 v[148:151], v[120:123], a[140:143], v[148:151]
    v_add_u32 v16, s46, v15
    s_waitcnt vmcnt(10) lgkmcnt(0)
    s_barrier
    v_mfma_f32_16x16x32_bf16 v[152:155], v[124:127], a[60:63], v[152:155]
    ds_read_b64_tr_b16 v[96:97], v16 offset:0
    ds_read_b64_tr_b16 v[98:99], v16 offset:1280
    v_mfma_f32_16x16x32_bf16 v[156:159], v[124:127], a[140:143], v[156:159]
    ds_read_b64_tr_b16 v[100:101], v16 offset:32
    ds_read_b64_tr_b16 v[102:103], v16 offset:1312
    v_mfma_f32_16x16x32_bf16 v[160:163], v[128:131], a[60:63], v[160:163]
    ds_read_b64_tr_b16 v[104:105], v16 offset:64
    ds_read_b64_tr_b16 v[106:107], v16 offset:1344
    v_mfma_f32_16x16x32_bf16 v[164:167], v[128:131], a[140:143], v[164:167]
    ds_read_b64_tr_b16 v[108:109], v16 offset:96
    ds_read_b64_tr_b16 v[110:111], v16 offset:1376
    v_mfma_f32_16x16x32_bf16 v[168:171], v[132:135], a[60:63], v[168:171]
    ds_read_b64_tr_b16 v[112:113], v16 offset:128
    ds_read_b64_tr_b16 v[114:115], v16 offset:1408
    v_mfma_f32_16x16x32_bf16 v[172:175], v[132:135], a[140:143], v[172:175]
    s_waitcnt lgkmcnt(8)
    v_mfma_f32_16x16x32_bf16 v[136:139], v[96:99], a[64:67], v[136:139]
    ds_read_b64_tr_b16 v[116:117], v16 offset:5120
    s_add_u32 s46, s46, 20480
    s_cmp_eq_u32 s46, 81920
    v_mfma_f32_16x16x32_bf16 v[140:143], v[96:99], a[144:147], v[140:143]
    ds_read_b64_tr_b16 v[118:119], v16 offset:6400
    s_cselect_b32 s46, 0, s46
    s_mul_i32 s90, s32, 5120
    s_waitcnt lgkmcnt(8)
    v_mfma_f32_16x16x32_bf16 v[144:147], v[100:103], a[64:67], v[144:147]
    ds_read_b64_tr_b16 v[120:121], v16 offset:5152
    s_add_u32 m0, s90, s47
    s_mul_i32 s91, s44, 491520
    v_mfma_f32_16x16x32_bf16 v[148:151], v[100:103], a[144:147], v[148:151]
    ds_read_b64_tr_b16 v[122:123], v16 offset:6432
    s_add_u32 s91, s91, s43
    buffer_load_dwordx4 v10, s[16:19], s91 offen lds
    s_waitcnt lgkmcnt(8)
    v_mfma_f32_16x16x32_bf16 v[152:155], v[104:107], a[64:67], v[152:155]
    ds_read_b64_tr_b16 v[124:125], v16 offset:5184
    s_add_u32 s47, s47, 20480
    s_cmp_eq_u32 s47, 81920
    v_mfma_f32_16x16x32_bf16 v[156:159], v[104:107], a[144:147], v[156:159]
    ds_read_b64_tr_b16 v[126:127], v16 offset:6464
    s_cselect_b32 s47, 0, s47
    s_cmp_lg_u32 s51, 0
    s_waitcnt lgkmcnt(8)
    v_mfma_f32_16x16x32_bf16 v[160:163], v[108:111], a[64:67], v[160:163]
    ds_read_b64_tr_b16 v[128:129], v16 offset:5216
    s_cselect_b32 s90, 1, 0
    s_sub_u32 s51, s51, s90
    v_mfma_f32_16x16x32_bf16 v[164:167], v[108:111], a[144:147], v[164:167]
    ds_read_b64_tr_b16 v[130:131], v16 offset:6496
    s_add_u32 s44, s44, s90
    s_cmp_eq_u32 s44, 5
    s_waitcnt lgkmcnt(8)
    v_mfma_f32_16x16x32_bf16 v[168:171], v[112:115], a[64:67], v[168:171]
    ds_read_b64_tr_b16 v[132:133], v16 offset:5248
    s_cselect_b32 s44, 0, s44
    s_cselect_b32 s90, 1280, 0
    v_mfma_f32_16x16x32_bf16 v[172:175], v[112:115], a[144:147], v[172:175]
    ds_read_b64_tr_b16 v[134:135], v16 offset:6528
    s_addc_u32 s45, s45, 0
    s_add_u32 s43, s43, s90
    s_waitcnt lgkmcnt(8)
    v_mfma_f32_16x16x32_bf16 v[136:139], v[116:119], a[68:71], v[136:139]
    ds_read_b64_tr_b16 v[96:97], v16 offset:10240
    s_cmp_eq_u32 s45, 3
    s_cselect_b32 s45, 0, s45
    v_mfma_f32_16x16x32_bf16 v[140:143], v[116:119], a[148:151], v[140:143]
    ds_read_b64_tr_b16 v[98:99], v16 offset:11520
    s_cselect_b32 s90, 3680, 0
    s_cmp_eq_u32 s43, 4960
    s_waitcnt lgkmcnt(8)
    v_mfma_f32_16x16x32_bf16 v[144:147], v[120:123], a[68:71], v[144:147]
    ds_read_b64_tr_b16 v[100:101], v16 offset:10272
    s_cselect_b32 s90, s43, s90
    s_sub_u32 s43, s43, s90
    v_mfma_f32_16x16x32_bf16 v[148:151], v[120:123], a[148:151], v[148:151]
    ds_read_b64_tr_b16 v[102:103], v16 offset:11552
    s_add_u32 m0, m0, 1024
    s_nop 0
    buffer_load_dwordx4 v11, s[16:19], s91 offen lds
    s_waitcnt lgkmcnt(8)
    v_mfma_f32_16x16x32_bf16 v[152:155], v[124:127], a[68:71], v[152:155]
    ds_read_b64_tr_b16 v[104:105], v16 offset:10304
    s_add_u32 m0, m0, 1024
    v_mfma_f32_16x16x32_bf16 v[156:159], v[124:127], a[148:151], v[156:159]
    ds_read_b64_tr_b16 v[106:107], v16 offset:11584
    s_waitcnt lgkmcnt(8)
    v_mfma_f32_16x16x32_bf16 v[160:163], v[128:131], a[68:71], v[160:163]
    ds_read_b64_tr_b16 v[108:109], v16 offset:10336
    v_mfma_f32_16x16x32_bf16 v[164:167], v[128:131], a[148:151], v[164:167]
    ds_read_b64_tr_b16 v[110:111], v16 offset:11616
    s_waitcnt lgkmcnt(8)
    v_mfma_f32_16x16x32_bf16 v[168:171], v[132:135], a[68:71], v[168:171]
    ds_read_b64_tr_b16 v[112:113], v16 offset:10368
    buffer_load_dwordx4 v12, s[16:19], s91 offen lds
    s_add_u32 m0, m0, 1024
    v_mfma_f32_16x16x32_bf16 v[172:175], v[132:135], a[148:151], v[172:175]
    ds_read_b64_tr_b16 v[114:115], v16 offset:11648
    s_waitcnt lgkmcnt(8)
    v_mfma_f32_16x16x32_bf16 v[136:139], v[96:99], a[72:75], v[136:139]
    ds_read_b64_tr_b16 v[116:117], v16 offset:15360
    v_mfma_f32_16x16x32_bf16 v[140:143], v[96:99], a[152:155], v[140:143]
    ds_read_b64_tr_b16 v[118:119], v16 offset:16640
    s_waitcnt lgkmcnt(8)
    v_mfma_f32_16x16x32_bf16 v[144:147], v[100:103], a[72:75], v[144:147]
    ds_read_b64_tr_b16 v[120:121], v16 offset:15392
    v_mfma_f32_16x16x32_bf16 v[148:151], v[100:103], a[152:155], v[148:151]
    ds_read_b64_tr_b16 v[122:123], v16 offset:16672
    buffer_load_dwordx4 v13, s[16:19], s91 offen lds
    s_add_u32 m0, m0, 1024
    s_waitcnt lgkmcnt(8)
    v_mfma_f32_16x16x32_bf16 v[152:155], v[104:107], a[72:75], v[152:155]
    ds_read_b64_tr_b16 v[124:125], v16 offset:15424
    v_mfma_f32_16x16x32_bf16 v[156:159], v[104:107], a[152:155], v[156:159]
    ds_read_b64_tr_b16 v[126:127], v16 offset:16704
    s_waitcnt lgkmcnt(8)
    v_mfma_f32_16x16x32_bf16 v[160:163], v[108:111], a[72:75], v[160:163]
    ds_read_b64_tr_b16 v[128:129], v16 offset:15456
    v_mfma_f32_16x16x32_bf16 v[164:167], v[108:111], a[152:155], v[164:167]
    ds_read_b64_tr_b16 v[130:131], v16 offset:16736
    s_waitcnt lgkmcnt(8)
    v_mfma_f32_16x16x32_bf16 v[168:171], v[112:115], a[72:75], v[168:171]
    ds_read_b64_tr_b16 v[132:133], v16 offset:15488
    buffer_load_dwordx4 v14, s[16:19], s91 offen lds
    v_mfma_f32_16x16x32_bf16 v[172:175], v[112:115], a[152:155], v[172:175]
    ds_read_b64_tr_b16 v[134:135], v16 offset:16768
    s_waitcnt lgkmcnt(8)
    v_mfma_f32_16x16x32_bf16 v[136:139], v[116:119], a[76:79], v[136:139]
    v_mfma_f32_16x16x32_bf16 v[140:143], v[116:119], a[156:159], v[140:143]
    s_waitcnt lgkmcnt(6)
    v_mfma_f32_16x16x32_bf16 v[144:147], v[120:123], a[76:79], v[144:147]
    v_mfma_f32_16x16x32_bf16 v[148:151], v[120:123], a[156:159], v[148:151]
    v_add_u32 v16, s46, v15
    s_waitcnt vmcnt(10) lgkmcnt(0)
    s_barrier
    v_mfma_f32_16x16x32_bf16 v[152:155], v[124:127], a[76:79], v[152:155]
    ds_read_b64_tr_b16 v[96:97], v16 offset:0
    ds_read_b64_tr_b16 v[98:99], v16 offset:1280
    v_mfma_f32_16x16x32_bf16 v[156:159], v[124:127], a[156:159], v[156:159]
    ds_read_b64_tr_b16 v[100:101], v16 offset:32
    ds_read_b64_tr_b16 v[102:103], v16 offset:1312
    v_mfma_f32_16x16x32_bf16 v[160:163], v[128:131], a[76:79], v[160:163]
    ds_read_b64_tr_b16 v[104:105], v16 offset:64
    ds_read_b64_tr_b16 v[106:107], v16 offset:1344
    v_mfma_f32_16x16x32_bf16 v[164:167], v[128:131], a[156:159], v[164:167]
    ds_read_b64_tr_b16 v[108:109], v16 offset:96
    ds_read_b64_tr_b16 v[110:111], v16 offset:1376
    v_mfma_f32_16x16x32_bf16 v[168:171], v[132:135], a[76:79], v[168:171]
    ds_read_b64_tr_b16 v[112:113], v16 offset:128
    ds_read_b64_tr_b16 v[114:115], v16 offset:1408
    v_mfma_f32_16x16x32_bf16 v[172:175], v[132:135], a[156:159], v[172:175]
    v_add_u32 v18, s41, v17
    v_cvt_pk_bf16_f32 v176, v136, v137
    v_cvt_pk_bf16_f32 v177, v138, v139
    v_cvt_pk_bf16_f32 v178, v140, v141
    v_cvt_pk_bf16_f32 v179, v142, v143
    ds_write_b64 v18, v[176:177] offset:0
    ds_write_b64 v18, v[178:179] offset:2688
    v_cvt_pk_bf16_f32 v176, v144, v145
    v_cvt_pk_bf16_f32 v177, v146, v147
    v_cvt_pk_bf16_f32 v178, v148, v149
    v_cvt_pk_bf16_f32 v179, v150, v151
    ds_write_b64 v18, v[176:177] offset:32
    ds_write_b64 v18, v[178:179] offset:2720
    v_cvt_pk_bf16_f32 v176, v152, v153
    v_cvt_pk_bf16_f32 v177, v154, v155
    v_cvt_pk_bf16_f32 v178, v156, v157
    v_cvt_pk_bf16_f32 v179, v158, v159
    ds_write_b64 v18, v[176:177] offset:64
    ds_write_b64 v18, v[178:179] offset:2752
    v_cvt_pk_bf16_f32 v176, v160, v161
    v_cvt_pk_bf16_f32 v177, v162, v163
    v_cvt_pk_bf16_f32 v178, v164, v165
    v_cvt_pk_bf16_f32 v179, v166, v167
    ds_write_b64 v18, v[176:177] offset:96
    ds_write_b64 v18, v[178:179] offset:2784
    v_cvt_pk_bf16_f32 v176, v168, v169
    v_cvt_pk_bf16_f32 v177, v170, v171
    v_cvt_pk_bf16_f32 v178, v172, v173
    v_cvt_pk_bf16_f32 v179, v174, v175
    ds_write_b64 v18, v[176:177] offset:128
    ds_write_b64 v18, v[178:179] offset:2816
    s_waitcnt lgkmcnt(0)
    s_add_u32 s41, s41, 21504
    s_cmp_lt_u32 s41, 64512
    s_cbranch_scc1 L_pa_blk
    s_barrier
    s_mov_b32 s50, 0
L_pa_att:
    v_add_u32 v23, s50, v21
    v_add_u32 v22, s50, v20
    ds_read_b64 v[116:117], v22 offset:0
    ds_read_b64 v[118:119], v22 offset:8
    ds_read_b64 v[120:121], v22 offset:16
    ds_read_b64 v[122:123], v22 offset:24
    ds_read_b64 v[124:125], v22 offset:32
    ds_read_b64 v[126:127], v23 offset:2352
    ds_read_b64 v[128:129], v23 offset:2360
    ds_read_b64 v[130:131], v23 offset:2368
    ds_read_b64 v[132:133], v23 offset:2376
    ds_read_b64 v[134:135], v23 offset:2384
    ds_read_b64 v[136:137], v23 offset:2016
    ds_read_b64 v[138:139], v23 offset:2024
    ds_read_b64 v[140:141], v23 offset:2032
    ds_read_b64 v[142:143], v23 offset:2040
    ds_read_b64 v[144:145], v23 offset:2048
    s_waitcnt lgkmcnt(5)
    v_dot2_f32_bf16 v146, v116, v126, 0
    v_dot2_f32_bf16 v146, v117, v127, v146
    v_dot2_f32_bf16 v146, v118, v128, v146
    v_dot2_f32_bf16 v146, v119, v129, v146
    v_dot2_f32_bf16 v146, v120, v130, v146
    v_dot2_f32_bf16 v146, v121, v131, v146
    v_dot2_f32_bf16 v146, v122, v132, v146
    v_dot2_f32_bf16 v146, v123, v133, v146
    v_dot2_f32_bf16 v146, v124, v134, v146
    v_dot2_f32_bf16 v146, v125, v135, v146
    ds_read_b64 v[126:127], v23 offset:1680
    ds_read_b64 v[128:129], v23 offset:1688
    ds_read_b64 v[130:131], v23 offset:1696
    ds_read_b64 v[132:133], v23 offset:1704
    ds_read_b64 v[134:135], v23 offset:1712
    s_waitcnt lgkmcnt(5)
    v_dot2_f32_bf16 v147, v116, v136, 0
    v_dot2_f32_bf16 v147, v117, v137, v147
    v_dot2_f32_bf16 v147, v118, v138, v147
    v_dot2_f32_bf16 v147, v119, v139, v147
    v_dot2_f32_bf16 v147, v120, v140, v147
    v_dot2_f32_bf16 v147, v121, v141, v147
    v_dot2_f32_bf16 v147, v122, v142, v147
    v_dot2_f32_bf16 v147, v123, v143, v147
    v_dot2_f32_bf16 v147, v124, v144, v147
    v_dot2_f32_bf16 v147, v125, v145, v147
    ds_read_b64 v[136:137], v23 offset:1344
    ds_read_b64 v[138:139], v23 offset:1352
    ds_read_b64 v[140:141], v23 offset:1360
    ds_read_b64 v[142:143], v23 offset:1368
    ds_read_b64 v[144:145], v23 offset:1376
    s_waitcnt lgkmcnt(5)
    v_dot2_f32_bf16 v148, v116, v126, 0
    v_dot2_f32_bf16 v148, v117, v127, v148
    v_dot2_f32_bf16 v148, v118, v128, v148
    v_dot2_f32_bf16 v148, v119, v129, v148
    v_dot2_f32_bf16 v148, v120, v130, v148
    v_dot2_f32_bf16 v148, v121, v131, v148
    v_dot2_f32_bf16 v148, v122, v132, v148
    v_dot2_f32_bf16 v148, v123, v133, v148
    v_dot2_f32_bf16 v148, v124, v134, v148
    v_dot2_f32_bf16 v148, v125, v135, v148
    ds_read_b64 v[126:127], v23 offset:1008
    ds_read_b64 v[128:129], v23 offset:1016
    ds_read_b64 v[130:131], v23 offset:1024
    ds_read_b64 v[132:133], v23 offset:1032
    ds_read_b64 v[134:135], v23 offset:1040
    s_waitcnt lgkmcnt(5)
    v_dot2_f32_bf16 v149, v116, v136, 0
    v_dot2_f32_bf16 v149, v117, v137, v149
    v_dot2_f32_bf16 v149, v118, v138, v149
    v_dot2_f32_bf16 v149, v119, v139, v149
    v_dot2_f32_bf16 v149, v120, v140, v149
    v_dot2_f32_bf16 v149, v121, v141, v149
    v_dot2_f32_bf16 v149, v122, v142, v149
    v_dot2_f32_bf16 v149, v123, v143, v149
    v_dot2_f32_bf16 v149, v124, v144, v149
    v_dot2_f32_bf16 v149, v125, v145, v149
    ds_read_b64 v[136:137], v23 offset:672
    ds_read_b64 v[138:139], v23 offset:680
    ds_read_b64 v[140:141], v23 offset:688
    ds_read_b64 v[142:143], v23 offset:696
    ds_read_b64 v[144:145], v23 offset:704
    s_waitcnt lgkmcnt(5)
    v_dot2_f32_bf16 v150, v116, v126, 0
    v_dot2_f32_bf16 v150, v117, v127, v150
    v_dot2_f32_bf16 v150, v118, v128, v150
    v_dot2_f32_bf16 v150, v119, v129, v150
    v_dot2_f32_bf16 v150, v120, v130, v150
    v_dot2_f32_bf16 v150, v121, v131, v150
    v_dot2_f32_bf16 v150, v122, v132, v150
    v_dot2_f32_bf16 v150, v123, v133, v150
    v_dot2_f32_bf16 v150, v124, v134, v150
    v_dot2_f32_bf16 v150, v125, v135, v150
    ds_read_b64 v[126:127], v23 offset:336
    ds_read_b64 v[128:129], v23 offset:344
    ds_read_b64 v[130:131], v23 offset:352
    ds_read_b64 v[132:133], v23 offset:360
    ds_read_b64 v[134:135], v23 offset:368
    s_waitcnt lgkmcnt(5)
    v_dot2_f32_bf16 v151, v116, v136, 0
    v_dot2_f32_bf16 v151, v117, v137, v151
    v_dot2_f32_bf16 v151, v118, v138, v151
    v_dot2_f32_bf16 v151, v119, v139, v151
    v_dot2_f32_bf16 v151, v120, v140, v151
    v_dot2_f32_bf16 v151, v121, v141, v151
    v_dot2_f32_bf16 v151, v122, v142, v151
    v_dot2_f32_bf16 v151, v123, v143, v151
    v_dot2_f32_bf16 v151, v124, v144, v151
    v_dot2_f32_bf16 v151, v125, v145, v151
    ds_read_b64 v[136:137], v23 offset:0
    ds_read_b64 v[138:139], v23 offset:8
    ds_read_b64 v[140:141], v23 offset:16
    ds_read_b64 v[142:143], v23 offset:24
    ds_read_b64 v[144:145], v23 offset:32
    s_waitcnt lgkmcnt(5)
    v_dot2_f32_bf16 v152, v116, v126, 0
    v_dot2_f32_bf16 v152, v117, v127, v152
    v_dot2_f32_bf16 v152, v118, v128, v152
    v_dot2_f32_bf16 v152, v119, v129, v152
    v_dot2_f32_bf16 v152, v120, v130, v152
    v_dot2_f32_bf16 v152, v121, v131, v152
    v_dot2_f32_bf16 v152, v122, v132, v152
    v_dot2_f32_bf16 v152, v123, v133, v152
    v_dot2_f32_bf16 v152, v124, v134, v152
    v_dot2_f32_bf16 v152, v125, v135, v152
    ds_read_b64 v[126:127], v23 offset:23856
    ds_read_b64 v[128:129], v23 offset:23864
    ds_read_b64 v[130:131], v23 offset:23872
    ds_read_b64 v[132:133], v23 offset:23880
    ds_read_b64 v[134:135], v23 offset:23888
    s_waitcnt lgkmcnt(5)
    v_dot2_f32_bf16 v153, v116, v136, 0
    v_dot2_f32_bf16 v153, v117, v137, v153
    v_dot2_f32_bf16 v153, v118, v138, v153
    v_dot2_f32_bf16 v153, v119, v139, v153
    v_dot2_f32_bf16 v153, v120, v140, v153
    v_dot2_f32_bf16 v153, v121, v141, v153
    v_dot2_f32_bf16 v153, v122, v142, v153
    v_dot2_f32_bf16 v153, v123, v143, v153
    v_dot2_f32_bf16 v153, v124, v144, v153
    v_dot2_f32_bf16 v153, v125, v145, v153
    v_cmp_le_i32 vcc, 2, v24
    s_nop 1
    v_cndmask_b32 v147, v27, v147, vcc
    v_cmp_le_i32 vcc, 4, v24
    s_nop 1
    v_cndmask_b32 v148, v27, v148, vcc
    v_cmp_le_i32 vcc, 6, v24
    s_nop 1
    v_cndmask_b32 v149, v27, v149, vcc
    v_cmp_le_i32 vcc, 8, v24
    s_nop 1
    v_cndmask_b32 v150, v27, v150, vcc
    v_cmp_le_i32 vcc, 10, v24
    s_nop 1
    v_cndmask_b32 v151, v27, v151, vcc
    v_cmp_le_i32 vcc, 12, v24
    s_nop 1
    v_cndmask_b32 v152, v27, v152, vcc
    v_cmp_le_i32 vcc, 14, v24
    s_nop 1
    v_cndmask_b32 v153, v27, v153, vcc
    v_max_f32 v25, v146, v147
    v_max3_f32 v25, v25, v148, v149
    v_max3_f32 v25, v25, v150, v151
    v_max3_f32 v25, v25, v152, v153
    v_sub_f32 v146, v146, v25
    v_sub_f32 v147, v147, v25
    v_sub_f32 v148, v148, v25
    v_sub_f32 v149, v149, v25
    v_sub_f32 v150, v150, v25
    v_sub_f32 v151, v151, v25
    v_sub_f32 v152, v152, v25
    v_sub_f32 v153, v153, v25
    v_mul_f32 v146, s49, v146
    v_mul_f32 v147, s49, v147
    v_mul_f32 v148, s49, v148
    v_mul_f32 v149, s49, v149
    v_mul_f32 v150, s49, v150
    v_mul_f32 v151, s49, v151
    v_mul_f32 v152, s49, v152
    v_mul_f32 v153, s49, v153
    v_exp_f32 v146, v146
    v_exp_f32 v147, v147
    v_exp_f32 v148, v148
    v_exp_f32 v149, v149
    v_exp_f32 v150, v150
    v_exp_f32 v151, v151
    v_exp_f32 v152, v152
    v_exp_f32 v153, v153
    v_add_f32 v26, v146, v147
    v_add_f32 v26, v26, v148
    v_add_f32 v26, v26, v149
    v_add_f32 v26, v26, v150
    v_add_f32 v26, v26, v151
    v_add_f32 v26, v26, v152
    v_add_f32 v26, v26, v153
    v_rcp_f32 v26, v26
    s_nop 0
    v_mul_f32 v146, v146, v26
    v_cvt_pk_bf16_f32 v154, v146, 0
    v_cvt_pk_bf16_f32 v155, 0, v146
    v_mul_f32 v147, v147, v26
    v_cvt_pk_bf16_f32 v156, v147, 0
    v_cvt_pk_bf16_f32 v157, 0, v147
    v_mul_f32 v148, v148, v26
    v_cvt_pk_bf16_f32 v158, v148, 0
    v_cvt_pk_bf16_f32 v159, 0, v148
    v_mul_f32 v149, v149, v26
    v_cvt_pk_bf16_f32 v160, v149, 0
    v_cvt_pk_bf16_f32 v161, 0, v149
    v_mul_f32 v150, v150, v26
    v_cvt_pk_bf16_f32 v162, v150, 0
    v_cvt_pk_bf16_f32 v163, 0, v150
    v_mul_f32 v151, v151, v26
    v_cvt_pk_bf16_f32 v164, v151, 0
    v_cvt_pk_bf16_f32 v165, 0, v151
    v_mul_f32 v152, v152, v26
    v_cvt_pk_bf16_f32 v166, v152, 0
    v_cvt_pk_bf16_f32 v167, 0, v152
    v_mul_f32 v153, v153, v26
    v_cvt_pk_bf16_f32 v168, v153, 0
    v_cvt_pk_bf16_f32 v169, 0, v153
    ds_read_b64 v[136:137], v23 offset:23520
    ds_read_b64 v[138:139], v23 offset:23528
    ds_read_b64 v[140:141], v23 offset:23536
    ds_read_b64 v[142:143], v23 offset:23544
    ds_read_b64 v[144:145], v23 offset:23552
    s_waitcnt lgkmcnt(5)
    v_dot2_f32_bf16 v170, v126, v154, 0
    v_dot2_f32_bf16 v171, v126, v155, 0
    v_dot2_f32_bf16 v172, v127, v154, 0
    v_dot2_f32_bf16 v173, v127, v155, 0
    v_dot2_f32_bf16 v174, v128, v154, 0
    v_dot2_f32_bf16 v175, v128, v155, 0
    v_dot2_f32_bf16 v176, v129, v154, 0
    v_dot2_f32_bf16 v177, v129, v155, 0
    v_dot2_f32_bf16 v178, v130, v154, 0
    v_dot2_f32_bf16 v179, v130, v155, 0
    v_dot2_f32_bf16 v180, v131, v154, 0
    v_dot2_f32_bf16 v181, v131, v155, 0
    v_dot2_f32_bf16 v182, v132, v154, 0
    v_dot2_f32_bf16 v183, v132, v155, 0
    v_dot2_f32_bf16 v184, v133, v154, 0
    v_dot2_f32_bf16 v185, v133, v155, 0
    v_dot2_f32_bf16 v186, v134, v154, 0
    v_dot2_f32_bf16 v187, v134, v155, 0
    v_dot2_f32_bf16 v188, v135, v154, 0
    v_dot2_f32_bf16 v189, v135, v155, 0
    ds_read_b64 v[126:127], v23 offset:23184
    ds_read_b64 v[128:129], v23 offset:23192
    ds_read_b64 v[130:131], v23 offset:23200
    ds_read_b64 v[132:133], v23 offset:23208
    ds_read_b64 v[134:135], v23 offset:23216
    s_waitcnt lgkmcnt(5)
    v_dot2_f32_bf16 v170, v136, v156, v170
    v_dot2_f32_bf16 v171, v136, v157, v171
    v_dot2_f32_bf16 v172, v137, v156, v172
    v_dot2_f32_bf16 v173, v137, v157, v173
    v_dot2_f32_bf16 v174, v138, v156, v174
    v_dot2_f32_bf16 v175, v138, v157, v175
    v_dot2_f32_bf16 v176, v139, v156, v176
    v_dot2_f32_bf16 v177, v139, v157, v177
    v_dot2_f32_bf16 v178, v140, v156, v178
    v_dot2_f32_bf16 v179, v140, v157, v179
    v_dot2_f32_bf16 v180, v141, v156, v180
    v_dot2_f32_bf16 v181, v141, v157, v181
    v_dot2_f32_bf16 v182, v142, v156, v182
    v_dot2_f32_bf16 v183, v142, v157, v183
    v_dot2_f32_bf16 v184, v143, v156, v184
    v_dot2_f32_bf16 v185, v143, v157, v185
    v_dot2_f32_bf16 v186, v144, v156, v186
    v_dot2_f32_bf16 v187, v144, v157, v187
    v_dot2_f32_bf16 v188, v145, v156, v188
    v_dot2_f32_bf16 v189, v145, v157, v189
    ds_read_b64 v[136:137], v23 offset:22848
    ds_read_b64 v[138:139], v23 offset:22856
    ds_read_b64 v[140:141], v23 offset:22864
    ds_read_b64 v[142:143], v23 offset:22872
    ds_read_b64 v[144:145], v23 offset:22880
    s_waitcnt lgkmcnt(5)
    v_dot2_f32_bf16 v170, v126, v158, v170
    v_dot2_f32_bf16 v171, v126, v159, v171
    v_dot2_f32_bf16 v172, v127, v158, v172
    v_dot2_f32_bf16 v173, v127, v159, v173
    v_dot2_f32_bf16 v174, v128, v158, v174
    v_dot2_f32_bf16 v175, v128, v159, v175
    v_dot2_f32_bf16 v176, v129, v158, v176
    v_dot2_f32_bf16 v177, v129, v159, v177
    v_dot2_f32_bf16 v178, v130, v158, v178
    v_dot2_f32_bf16 v179, v130, v159, v179
    v_dot2_f32_bf16 v180, v131, v158, v180
    v_dot2_f32_bf16 v181, v131, v159, v181
    v_dot2_f32_bf16 v182, v132, v158, v182
    v_dot2_f32_bf16 v183, v132, v159, v183
    v_dot2_f32_bf16 v184, v133, v158, v184
    v_dot2_f32_bf16 v185, v133, v159, v185
    v_dot2_f32_bf16 v186, v134, v158, v186
    v_dot2_f32_bf16 v187, v134, v159, v187
    v_dot2_f32_bf16 v188, v135, v158, v188
    v_dot2_f32_bf16 v189, v135, v159, v189
    ds_read_b64 v[126:127], v23 offset:22512
    ds_read_b64 v[128:129], v23 offset:22520
    ds_read_b64 v[130:131], v23 offset:22528
    ds_read_b64 v[132:133], v23 offset:22536
    ds_read_b64 v[134:135], v23 offset:22544
    s_waitcnt lgkmcnt(5)
    v_dot2_f32_bf16 v170, v136, v160, v170
    v_dot2_f32_bf16 v171, v136, v161, v171
    v_dot2_f32_bf16 v172, v137, v160, v172
    v_dot2_f32_bf16 v173, v137, v161, v173
    v_dot2_f32_bf16 v174, v138, v160, v174
    v_dot2_f32_bf16 v175, v138, v161, v175
    v_dot2_f32_bf16 v176, v139, v160, v176
    v_dot2_f32_bf16 v177, v139, v161, v177
    v_dot2_f32_bf16 v178, v140, v160, v178
    v_dot2_f32_bf16 v179, v140, v161, v179
    v_dot2_f32_bf16 v180, v141, v160, v180
    v_dot2_f32_bf16 v181, v141, v161, v181
    v_dot2_f32_bf16 v182, v142, v160, v182
    v_dot2_f32_bf16 v183, v142, v161, v183
    v_dot2_f32_bf16 v184, v143, v160, v184
    v_dot2_f32_bf16 v185, v143, v161, v185
    v_dot2_f32_bf16 v186, v144, v160, v186
    v_dot2_f32_bf16 v187, v144, v161, v187
    v_dot2_f32_bf16 v188, v145, v160, v188
    v_dot2_f32_bf16 v189, v145, v161, v189
    ds_read_b64 v[136:137], v23 offset:22176
    ds_read_b64 v[138:139], v23 offset:22184
    ds_read_b64 v[140:141], v23 offset:22192
    ds_read_b64 v[142:143], v23 offset:22200
    ds_read_b64 v[144:145], v23 offset:22208
    s_waitcnt lgkmcnt(5)
    v_dot2_f32_bf16 v170, v126, v162, v170
    v_dot2_f32_bf16 v171, v126, v163, v171
    v_dot2_f32_bf16 v172, v127, v162, v172
    v_dot2_f32_bf16 v173, v127, v163, v173
    v_dot2_f32_bf16 v174, v128, v162, v174
    v_dot2_f32_bf16 v175, v128, v163, v175
    v_dot2_f32_bf16 v176, v129, v162, v176
    v_dot2_f32_bf16 v177, v129, v163, v177
    v_dot2_f32_bf16 v178, v130, v162, v178
    v_dot2_f32_bf16 v179, v130, v163, v179
    v_dot2_f32_bf16 v180, v131, v162, v180
    v_dot2_f32_bf16 v181, v131, v163, v181
    v_dot2_f32_bf16 v182, v132, v162, v182
    v_dot2_f32_bf16 v183, v132, v163, v183
    v_dot2_f32_bf16 v184, v133, v162, v184
    v_dot2_f32_bf16 v185, v133, v163, v185
    v_dot2_f32_bf16 v186, v134, v162, v186
    v_dot2_f32_bf16 v187, v134, v163, v187
    v_dot2_f32_bf16 v188, v135, v162, v188
    v_dot2_f32_bf16 v189, v135, v163, v189
    ds_read_b64 v[126:127], v23 offset:21840
    ds_read_b64 v[128:129], v23 offset:21848
    ds_read_b64 v[130:131], v23 offset:21856
    ds_read_b64 v[132:133], v23 offset:21864
    ds_read_b64 v[134:135], v23 offset:21872
    s_waitcnt lgkmcnt(5)
    v_dot2_f32_bf16 v170, v136, v164, v170
    v_dot2_f32_bf16 v171, v136, v165, v171
    v_dot2_f32_bf16 v172, v137, v164, v172
    v_dot2_f32_bf16 v173, v137, v165, v173
    v_dot2_f32_bf16 v174, v138, v164, v174
    v_dot2_f32_bf16 v175, v138, v165, v175
    v_dot2_f32_bf16 v176, v139, v164, v176
    v_dot2_f32_bf16 v177, v139, v165, v177
    v_dot2_f32_bf16 v178, v140, v164, v178
    v_dot2_f32_bf16 v179, v140, v165, v179
    v_dot2_f32_bf16 v180, v141, v164, v180
    v_dot2_f32_bf16 v181, v141, v165, v181
    v_dot2_f32_bf16 v182, v142, v164, v182
    v_dot2_f32_bf16 v183, v142, v165, v183
    v_dot2_f32_bf16 v184, v143, v164, v184
    v_dot2_f32_bf16 v185, v143, v165, v185
    v_dot2_f32_bf16 v186, v144, v164, v186
    v_dot2_f32_bf16 v187, v144, v165, v187
    v_dot2_f32_bf16 v188, v145, v164, v188
    v_dot2_f32_bf16 v189, v145, v165, v189
    ds_read_b64 v[136:137], v23 offset:21504
    ds_read_b64 v[138:139], v23 offset:21512
    ds_read_b64 v[140:141], v23 offset:21520
    ds_read_b64 v[142:143], v23 offset:21528
    ds_read_b64 v[144:145], v23 offset:21536
    s_waitcnt lgkmcnt(5)
    v_dot2_f32_bf16 v170, v126, v166, v170
    v_dot2_f32_bf16 v171, v126, v167, v171
    v_dot2_f32_bf16 v172, v127, v166, v172
    v_dot2_f32_bf16 v173, v127, v167, v173
    v_dot2_f32_bf16 v174, v128, v166, v174
    v_dot2_f32_bf16 v175, v128, v167, v175
    v_dot2_f32_bf16 v176, v129, v166, v176
    v_dot2_f32_bf16 v177, v129, v167, v177
    v_dot2_f32_bf16 v178, v130, v166, v178
    v_dot2_f32_bf16 v179, v130, v167, v179
    v_dot2_f32_bf16 v180, v131, v166, v180
    v_dot2_f32_bf16 v181, v131, v167, v181
    v_dot2_f32_bf16 v182, v132, v166, v182
    v_dot2_f32_bf16 v183, v132, v167, v183
    v_dot2_f32_bf16 v184, v133, v166, v184
    v_dot2_f32_bf16 v185, v133, v167, v185
    v_dot2_f32_bf16 v186, v134, v166, v186
    v_dot2_f32_bf16 v187, v134, v167, v187
    v_dot2_f32_bf16 v188, v135, v166, v188
    v_dot2_f32_bf16 v189, v135, v167, v189
    s_waitcnt lgkmcnt(0)
    v_dot2_f32_bf16 v170, v136, v168, v170
    v_dot2_f32_bf16 v171, v136, v169, v171
    v_dot2_f32_bf16 v172, v137, v168, v172
    v_dot2_f32_bf16 v173, v137, v169, v173
    v_dot2_f32_bf16 v174, v138, v168, v174
    v_dot2_f32_bf16 v175, v138, v169, v175
    v_dot2_f32_bf16 v176, v139, v168, v176
    v_dot2_f32_bf16 v177, v139, v169, v177
    v_dot2_f32_bf16 v178, v140, v168, v178
    v_dot2_f32_bf16 v179, v140, v169, v179
    v_dot2_f32_bf16 v180, v141, v168, v180
    v_dot2_f32_bf16 v181, v141, v169, v181
    v_dot2_f32_bf16 v182, v142, v168, v182
    v_dot2_f32_bf16 v183, v142, v169, v183
    v_dot2_f32_bf16 v184, v143, v168, v184
    v_dot2_f32_bf16 v185, v143, v169, v185
    v_dot2_f32_bf16 v186, v144, v168, v186
    v_dot2_f32_bf16 v187, v144, v169, v187
    v_dot2_f32_bf16 v188, v145, v168, v188
    v_dot2_f32_bf16 v189, v145, v169, v189
    v_cvt_pk_bf16_f32 v116, v170, v171
    v_cvt_pk_bf16_f32 v117, v172, v173
    v_cvt_pk_bf16_f32 v118, v174, v175
    v_cvt_pk_bf16_f32 v119, v176, v177
    v_cvt_pk_bf16_f32 v120, v178, v179
    v_cvt_pk_bf16_f32 v121, v180, v181
    v_cvt_pk_bf16_f32 v122, v182, v183
    v_cvt_pk_bf16_f32 v123, v184, v185
    v_cvt_pk_bf16_f32 v124, v186, v187
    v_cvt_pk_bf16_f32 v125, v188, v189
    ds_write_b64 v22, v[116:117] offset:0
    ds_write_b64 v22, v[118:119] offset:8
    ds_write_b64 v22, v[120:121] offset:16
    ds_write_b64 v22, v[122:123] offset:24
    ds_write_b64 v22, v[124:125] offset:32
    s_waitcnt lgkmcnt(0)
    s_add_u32 s50, s50, 80
    s_cmp_lt_u32 s50, 160
    s_cbranch_scc1 L_pa_att
    s_cmp_lg_u32 s48, 0
    s_cbranch_scc1 L_pa_o1
    ds_read_b64 a[160:161], v28 offset:32
    ds_read_b64 a[162:163], v28 offset:40
    ds_read_b64 a[240:241], v28 offset:2720
    ds_read_b64 a[242:243], v28 offset:2728
    ds_read_b64 a[164:165], v28 offset:96
    ds_read_b64 a[166:167], v28 offset:104
    ds_read_b64 a[244:245], v28 offset:2784
    ds_read_b64 a[246:247], v28 offset:2792
    s_mov_b32 exec_hi, 0
    ds_read_b64 a[168:169], v28 offset:160
    ds_read_b64 a[170:171], v28 offset:168
    ds_read_b64 a[248:249], v28 offset:2848
    ds_read_b64 a[250:251], v28 offset:2856
    s_mov_b64 exec, -1
    s_branch L_pa_oe
L_pa_o1:
    s_cmp_lg_u32 s48, 1
    s_cbranch_scc1 L_pa_o2
    s_mov_b32 exec_lo, 0
    ds_read_b64 a[168:169], v28 offset:0
    ds_read_b64 a[170:171], v28 offset:8
    ds_read_b64 a[248:249], v28 offset:2688
    ds_read_b64 a[250:251], v28 offset:2696
    s_mov_b64 exec, -1
    ds_read_b64 a[172:173], v28 offset:64
    ds_read_b64 a[174:175], v28 offset:72
    ds_read_b64 a[252:253], v28 offset:2752
    ds_read_b64 a[254:255], v28 offset:2760
    ds_read_b64 a[176:177], v28 offset:128
    ds_read_b64 a[178:179], v28 offset:136
    ds_read_b64 v[32:33], v28 offset:2816
    ds_read_b64 v[34:35], v28 offset:2824
    s_branch L_pa_oe
L_pa_o2:
    s_cmp_lg_u32 s48, 2
    s_cbranch_scc1 L_pa_o3
    ds_read_b64 a[180:181], v28 offset:32
    ds_read_b64 a[182:183], v28 offset:40
    ds_read_b64 v[36:37], v28 offset:2720
    ds_read_b64 v[38:39], v28 offset:2728
    ds_read_b64 a[184:185], v28 offset:96
    ds_read_b64 a[186:187], v28 offset:104
    ds_read_b64 v[40:41], v28 offset:2784
    ds_read_b64 v[42:43], v28 offset:2792
    s_mov_b32 exec_hi, 0
    ds_read_b64 a[188:189], v28 offset:160
    ds_read_b64 a[190:191], v28 offset:168
    ds_read_b64 v[44:45], v28 offset:2848
    ds_read_b64 v[46:47], v28 offset:2856
    s_mov_b64 exec, -1
    s_branch L_pa_oe
L_pa_o3:
    s_cmp_lg_u32 s48, 3
    s_cbranch_scc1 L_pa_o4
    s_mov_b32 exec_lo, 0
    ds_read_b64 a[188:189], v28 offset:0
    ds_read_b64 a[190:191], v28 offset:8
    ds_read_b64 v[44:45], v28 offset:2688
    ds_read_b64 v[46:47], v28 offset:2696
    s_mov_b64 exec, -1
    ds_read_b64 a[192:193], v28 offset:64
    ds_read_b64 a[194:195], v28 offset:72
    ds_read_b64 v[48:49], v28 offset:2752
    ds_read_b64 v[50:51], v28 offset:2760
    ds_read_b64 a[196:197], v28 offset:128
    ds_read_b64 a[198:199], v28 offset:136
    ds_read_b64 v[52:53], v28 offset:2816
    ds_read_b64 v[54:55], v28 offset:2824
    s_branch L_pa_oe
L_pa_o4:
    s_cmp_lg_u32 s48, 4
    s_cbranch_scc1 L_pa_o5
    ds_read_b64 a[200:201], v28 offset:32
    ds_read_b64 a[202:203], v28 offset:40
    ds_read_b64 v[56:57], v28 offset:2720
    ds_read_b64 v[58:59], v28 offset:2728
    ds_read_b64 a[204:205], v28 offset:96
    ds_read_b64 a[206:207], v28 offset:104
    ds_read_b64 v[60:61], v28 offset:2784
    ds_read_b64 v[62:63], v28 offset:2792
    s_mov_b32 exec_hi, 0
    ds_read_b64 a[208:209], v28 offset:160
    ds_read_b64 a[210:211], v28 offset:168
    ds_read_b64 v[64:65], v28 offset:2848
    ds_read_b64 v[66:67], v28 offset:2856
    s_mov_b64 exec, -1
    s_branch L_pa_oe
L_pa_o5:
    s_cmp_lg_u32 s48, 5
    s_cbranch_scc1 L_pa_o6
    s_mov_b32 exec_lo, 0
    ds_read_b64 a[208:209], v28 offset:0
    ds_read_b64 a[210:211], v28 offset:8
    ds_read_b64 v[64:65], v28 offset:2688
    ds_read_b64 v[66:67], v28 offset:2696
    s_mov_b64 exec, -1
    ds_read_b64 a[212:213], v28 offset:64
    ds_read_b64 a[214:215], v28 offset:72
    ds_read_b64 v[68:69], v28 offset:2752
    ds_read_b64 v[70:71], v28 offset:2760
    ds_read_b64 a[216:217], v28 offset:128
    ds_read_b64 a[218:219], v28 offset:136
    ds_read_b64 v[72:73], v28 offset:2816
    ds_read_b64 v[74:75], v28 offset:2824
    s_branch L_pa_oe
L_pa_o6:
    s_cmp_lg_u32 s48, 6
    s_cbranch_scc1 L_pa_o7
    ds_read_b64 a[220:221], v28 offset:32
    ds_read_b64 a[222:223], v28 offset:40
    ds_read_b64 v[76:77], v28 offset:2720
    ds_read_b64 v[78:79], v28 offset:2728
    ds_read_b64 a[224:225], v28 offset:96
    ds_read_b64 a[226:227], v28 offset:104
    ds_read_b64 v[80:81], v28 offset:2784
    ds_read_b64 v[82:83], v28 offset:2792
    s_mov_b32 exec_hi, 0
    ds_read_b64 a[228:229], v28 offset:160
    ds_read_b64 a[230:231], v28 offset:168
    ds_read_b64 v[84:85], v28 offset:2848
    ds_read_b64 v[86:87], v28 offset:2856
    s_mov_b64 exec, -1
    s_branch L_pa_oe
L_pa_o7:
    s_mov_b32 exec_lo, 0
    ds_read_b64 a[228:229], v28 offset:0
    ds_read_b64 a[230:231], v28 offset:8
    ds_read_b64 v[84:85], v28 offset:2688
    ds_read_b64 v[86:87], v28 offset:2696
    s_mov_b64 exec, -1
    ds_read_b64 a[232:233], v28 offset:64
    ds_read_b64 a[234:235], v28 offset:72
    ds_read_b64 v[88:89], v28 offset:2752
    ds_read_b64 v[90:91], v28 offset:2760
    ds_read_b64 a[236:237], v28 offset:128
    ds_read_b64 a[238:239], v28 offset:136
    ds_read_b64 v[92:93], v28 offset:2816
    ds_read_b64 v[94:95], v28 offset:2824
L_pa_oe:
    s_waitcnt lgkmcnt(0)
    s_add_u32 s48, s48, 1
    s_and_b32 s48, s48, 7
    s_cmp_lg_u32 s48, s52
    s_cbranch_scc1 L_pa_grp
    v_add_u32 v3, 0, v0
    v_mul_u32_u24 v4, 6554, v3
    v_lshrrev_b32 v4, 16, v4
    v_mul_u32_u24 v5, 10, v4
    v_sub_u32 v5, v3, v5
    v_and_b32 v6, 19, v4
    v_and_b32 v7, 4, v4
    v_lshl_or_b32 v6, v7, 1, v6
    v_and_b32 v7, 8, v4
    v_lshrrev_b32 v7, 1, v7
    v_or_b32 v6, v6, v7
    s_lshl_b32 s90, s32, 5
    v_add_u32 v6, s90, v6
    v_mul_u32_u24 v6, 1280, v6
    v_lshl_add_u32 v10, v5, 4, v6
    v_add_u32 v3, 64, v0
    v_mul_u32_u24 v4, 6554, v3
    v_lshrrev_b32 v4, 16, v4
    v_mul_u32_u24 v5, 10, v4
    v_sub_u32 v5, v3, v5
    v_and_b32 v6, 19, v4
    v_and_b32 v7, 4, v4
    v_lshl_or_b32 v6, v7, 1, v6
    v_and_b32 v7, 8, v4
    v_lshrrev_b32 v7, 1, v7
    v_or_b32 v6, v6, v7
    s_lshl_b32 s90, s32, 5
    v_add_u32 v6, s90, v6
    v_mul_u32_u24 v6, 1280, v6
    v_lshl_add_u32 v11, v5, 4, v6
    v_add_u32 v3, 128, v0
    v_mul_u32_u24 v4, 6554, v3
    v_lshrrev_b32 v4, 16, v4
    v_mul_u32_u24 v5, 10, v4
    v_sub_u32 v5, v3, v5
    v_and_b32 v6, 19, v4
    v_and_b32 v7, 4, v4
    v_lshl_or_b32 v6, v7, 1, v6
    v_and_b32 v7, 8, v4
    v_lshrrev_b32 v7, 1, v7
    v_or_b32 v6, v6, v7
    s_lshl_b32 s90, s32, 5
    v_add_u32 v6, s90, v6
    v_mul_u32_u24 v6, 1280, v6
    v_lshl_add_u32 v12, v5, 4, v6
    v_add_u32 v3, 192, v0
    v_mul_u32_u24 v4, 6554, v3
    v_lshrrev_b32 v4, 16, v4
    v_mul_u32_u24 v5, 10, v4
    v_sub_u32 v5, v3, v5
    v_and_b32 v6, 19, v4
    v_and_b32 v7, 4, v4
    v_lshl_or_b32 v6, v7, 1, v6
    v_and_b32 v7, 8, v4
    v_lshrrev_b32 v7, 1, v7
    v_or_b32 v6, v6, v7
    s_lshl_b32 s90, s32, 5
    v_add_u32 v6, s90, v6
    v_mul_u32_u24 v6, 1280, v6
    v_lshl_add_u32 v13, v5, 4, v6
    v_add_u32 v3, 256, v0
    v_mul_u32_u24 v4, 6554, v3
    v_lshrrev_b32 v4, 16, v4
    v_mul_u32_u24 v5, 10, v4
    v_sub_u32 v5, v3, v5
    v_and_b32 v6, 19, v4
    v_and_b32 v7, 4, v4
    v_lshl_or_b32 v6, v7, 1, v6
    v_and_b32 v7, 8, v4
    v_lshrrev_b32 v7, 1, v7
    v_or_b32 v6, v6, v7
    s_lshl_b32 s90, s32, 5
    v_add_u32 v6, s90, v6
    v_mul_u32_u24 v6, 1280, v6
    v_lshl_add_u32 v14, v5, 4, v6
    s_waitcnt vmcnt(0) lgkmcnt(0)
    s_barrier
    s_mov_b32 s46, 0
    s_mov_b32 s47, 0
    s_mul_i32 s43, s52, 160
    s_mov_b32 s44, 0
    s_mov_b32 s45, 0
    s_mov_b32 s51, 39
    s_mov_b32 s48, s52
    s_mov_b32 s53, 0
    s_mul_i32 s90, s32, 5120
    s_add_u32 m0, s90, s47
    s_mul_i32 s91, s44, 163840
    s_add_u32 s91, s91, s43
    buffer_load_dwordx4 v10, s[20:23], s91 offen lds
    s_add_u32 s47, s47, 20480
    s_cmp_eq_u32 s47, 81920
    s_cselect_b32 s47, 0, s47
    s_cmp_lg_u32 s51, 0
    s_cselect_b32 s90, 1, 0
    s_sub_u32 s51, s51, s90
    s_add_u32 s44, s44, s90
    s_cmp_eq_u32 s44, 5
    s_cselect_b32 s44, 0, s44
    s_cselect_b32 s90, 160, 0
    s_add_u32 s43, s43, s90
    s_cmp_eq_u32 s43, 1280
    s_cselect_b32 s43, 0, s43
    s_add_u32 m0, m0, 1024
    s_nop 0
    buffer_load_dwordx4 v11, s[20:23], s91 offen lds
    s_add_u32 m0, m0, 1024
    s_nop 0
    buffer_load_dwordx4 v12, s[20:23], s91 offen lds
    s_add_u32 m0, m0, 1024
    s_nop 0
    buffer_load_dwordx4 v13, s[20:23], s91 offen lds
    s_add_u32 m0, m0, 1024
    s_nop 0
    buffer_load_dwordx4 v14, s[20:23], s91 offen lds
    s_mul_i32 s90, s32, 5120
    s_add_u32 m0, s90, s47
    s_mul_i32 s91, s44, 163840
    s_add_u32 s91, s91, s43
    buffer_load_dwordx4 v10, s[20:23], s91 offen lds
    s_add_u32 s47, s47, 20480
    s_cmp_eq_u32 s47, 81920
    s_cselect_b32 s47, 0, s47
    s_cmp_lg_u32 s51, 0
    s_cselect_b32 s90, 1, 0
    s_sub_u32 s51, s51, s90
    s_add_u32 s44, s44, s90
    s_cmp_eq_u32 s44, 5
    s_cselect_b32 s44, 0, s44
    s_cselect_b32 s90, 160, 0
    s_add_u32 s43, s43, s90
    s_cmp_eq_u32 s43, 1280
    s_cselect_b32 s43, 0, s43
    s_add_u32 m0, m0, 1024
    s_nop 0
    buffer_load_dwordx4 v11, s[20:23], s91 offen lds
    s_add_u32 m0, m0, 1024
    s_nop 0
    buffer_load_dwordx4 v12, s[20:23], s91 offen lds
    s_add_u32 m0, m0, 1024
    s_nop 0
    buffer_load_dwordx4 v13, s[20:23], s91 offen lds
    s_add_u32 m0, m0, 1024
    s_nop 0
    buffer_load_dwordx4 v14, s[20:23], s91 offen lds
    s_mul_i32 s90, s32, 5120
    s_add_u32 m0, s90, s47
    s_mul_i32 s91, s44, 163840
    s_add_u32 s91, s91, s43
    buffer_load_dwordx4 v10, s[20:23], s91 offen lds
    s_add_u32 s47, s47, 20480
    s_cmp_eq_u32 s47, 81920
    s_cselect_b32 s47, 0, s47
    s_cmp_lg_u32 s51, 0
    s_cselect_b32 s90, 1, 0
    s_sub_u32 s51, s51, s90
    s_add_u32 s44, s44, s90
    s_cmp_eq_u32 s44, 5
    s_cselect_b32 s44, 0, s44
    s_cselect_b32 s90, 160, 0
    s_add_u32 s43, s43, s90
    s_cmp_eq_u32 s43, 1280
    s_cselect_b32 s43, 0, s43
    s_add_u32 m0, m0, 1024
    s_nop 0
    buffer_load_dwordx4 v11, s[20:23], s91 offen lds
    s_add_u32 m0, m0, 1024
    s_nop 0
    buffer_load_dwordx4 v12, s[20:23], s91 offen lds
    s_add_u32 m0, m0, 1024
    s_nop 0
    buffer_load_dwordx4 v13, s[20:23], s91 offen lds
    s_add_u32 m0, m0, 1024
    s_nop 0
    buffer_load_dwordx4 v14, s[20:23], s91 offen lds
    v_add_u32 v16, s46, v15
    s_waitcnt vmcnt(10) lgkmcnt(0)
    s_barrier
    ds_read_b64_tr_b16 v[96:97], v16 offset:0
    ds_read_b64_tr_b16 v[98:99], v16 offset:1280
    ds_read_b64_tr_b16 v[100:101], v16 offset:32
    ds_read_b64_tr_b16 v[102:103], v16 offset:1312
    ds_read_b64_tr_b16 v[104:105], v16 offset:64
    ds_read_b64_tr_b16 v[106:107], v16 offset:1344
    ds_read_b64_tr_b16 v[108:109], v16 offset:96
    ds_read_b64_tr_b16 v[110:111], v16 offset:1376
    ds_read_b64_tr_b16 v[112:113], v16 offset:128
    ds_read_b64_tr_b16 v[114:115], v16 offset:1408
    s_mul_i32 s42, s52, 160
L_pa_oblk:
    s_waitcnt lgkmcnt(8)
    v_mfma_f32_16x16x32_bf16 v[136:139], v[96:99], a[160:163], 0
    ds_read_b64_tr_b16 v[116:117], v16 offset:5120
    s_add_u32 s46, s46, 20480
    s_cmp_eq_u32 s46, 81920
    v_mfma_f32_16x16x32_bf16 v[140:143], v[96:99], a[240:243], 0
    ds_read_b64_tr_b16 v[118:119], v16 offset:6400
    s_cselect_b32 s46, 0, s46
    s_mul_i32 s90, s32, 5120
    s_waitcnt lgkmcnt(8)
    v_mfma_f32_16x16x32_bf16 v[144:147], v[100:103], a[160:163], 0
    ds_read_b64_tr_b16 v[120:121], v16 offset:5152
    s_add_u32 m0, s90, s47
    s_mul_i32 s91, s44, 163840
    v_mfma_f32_16x16x32_bf16 v[148:151], v[100:103], a[240:243], 0
    ds_read_b64_tr_b16 v[122:123], v16 offset:6432
    s_add_u32 s91, s91, s43
    buffer_load_dwordx4 v10, s[20:23], s91 offen lds
    s_waitcnt lgkmcnt(8)
    v_mfma_f32_16x16x32_bf16 v[152:155], v[104:107], a[160:163], 0
    ds_read_b64_tr_b16 v[124:125], v16 offset:5184
    s_add_u32 s47, s47, 20480
    s_cmp_eq_u32 s47, 81920
    v_mfma_f32_16x16x32_bf16 v[156:159], v[104:107], a[240:243], 0
    ds_read_b64_tr_b16 v[126:127], v16 offset:6464
    s_cselect_b32 s47, 0, s47
    s_cmp_lg_u32 s51, 0
    s_waitcnt lgkmcnt(8)
    v_mfma_f32_16x16x32_bf16 v[160:163], v[108:111], a[160:163], 0
    ds_read_b64_tr_b16 v[128:129], v16 offset:5216
    s_cselect_b32 s90, 1, 0
    s_sub_u32 s51, s51, s90
    v_mfma_f32_16x16x32_bf16 v[164:167], v[108:111], a[240:243], 0
    ds_read_b64_tr_b16 v[130:131], v16 offset:6496
    s_add_u32 s44, s44, s90
    s_cmp_eq_u32 s44, 5
    s_waitcnt lgkmcnt(8)
    v_mfma_f32_16x16x32_bf16 v[168:171], v[112:115], a[160:163], 0
    ds_read_b64_tr_b16 v[132:133], v16 offset:5248
    s_cselect_b32 s44, 0, s44
    s_cselect_b32 s90, 160, 0
    v_mfma_f32_16x16x32_bf16 v[172:175], v[112:115], a[240:243], 0
    ds_read_b64_tr_b16 v[134:135], v16 offset:6528
    s_add_u32 s43, s43, s90
    s_cmp_eq_u32 s43, 1280
    s_waitcnt lgkmcnt(8)
    v_mfma_f32_16x16x32_bf16 v[136:139], v[116:119], a[164:167], v[136:139]
    ds_read_b64_tr_b16 v[96:97], v16 offset:10240
    s_cselect_b32 s43, 0, s43
    s_add_u32 m0, m0, 1024
    v_mfma_f32_16x16x32_bf16 v[140:143], v[116:119], a[244:247], v[140:143]
    ds_read_b64_tr_b16 v[98:99], v16 offset:11520
    buffer_load_dwordx4 v11, s[20:23], s91 offen lds
    s_add_u32 m0, m0, 1024
    s_waitcnt lgkmcnt(8)
    v_mfma_f32_16x16x32_bf16 v[144:147], v[120:123], a[164:167], v[144:147]
    ds_read_b64_tr_b16 v[100:101], v16 offset:10272
    v_mfma_f32_16x16x32_bf16 v[148:151], v[120:123], a[244:247], v[148:151]
    ds_read_b64_tr_b16 v[102:103], v16 offset:11552
    s_waitcnt lgkmcnt(8)
    v_mfma_f32_16x16x32_bf16 v[152:155], v[124:127], a[164:167], v[152:155]
    ds_read_b64_tr_b16 v[104:105], v16 offset:10304
    v_mfma_f32_16x16x32_bf16 v[156:159], v[124:127], a[244:247], v[156:159]
    ds_read_b64_tr_b16 v[106:107], v16 offset:11584
    s_waitcnt lgkmcnt(8)
    v_mfma_f32_16x16x32_bf16 v[160:163], v[128:131], a[164:167], v[160:163]
    ds_read_b64_tr_b16 v[108:109], v16 offset:10336
    buffer_load_dwordx4 v12, s[20:23], s91 offen lds
    s_add_u32 m0, m0, 1024
    v_mfma_f32_16x16x32_bf16 v[164:167], v[128:131], a[244:247], v[164:167]
    ds_read_b64_tr_b16 v[110:111], v16 offset:11616
    s_waitcnt lgkmcnt(8)
    v_mfma_f32_16x16x32_bf16 v[168:171], v[132:135], a[164:167], v[168:171]
    ds_read_b64_tr_b16 v[112:113], v16 offset:10368
    v_mfma_f32_16x16x32_bf16 v[172:175], v[132:135], a[244:247], v[172:175]
    ds_read_b64_tr_b16 v[114:115], v16 offset:11648
    s_waitcnt lgkmcnt(8)
    v_mfma_f32_16x16x32_bf16 v[136:139], v[96:99], a[168:171], v[136:139]
    ds_read_b64_tr_b16 v[116:117], v16 offset:15360
    v_mfma_f32_16x16x32_bf16 v[140:143], v[96:99], a[248:251], v[140:143]
    ds_read_b64_tr_b16 v[118:119], v16 offset:16640
    buffer_load_dwordx4 v13, s[20:23], s91 offen lds
    s_add_u32 m0, m0, 1024
    s_waitcnt lgkmcnt(8)
    v_mfma_f32_16x16x32_bf16 v[144:147], v[100:103], a[168:171], v[144:147]
    ds_read_b64_tr_b16 v[120:121], v16 offset:15392
    v_mfma_f32_16x16x32_bf16 v[148:151], v[100:103], a[248:251], v[148:151]
    ds_read_b64_tr_b16 v[122:123], v16 offset:16672
    s_waitcnt lgkmcnt(8)
    v_mfma_f32_16x16x32_bf16 v[152:155], v[104:107], a[168:171], v[152:155]
    ds_read_b64_tr_b16 v[124:125], v16 offset:15424
    v_mfma_f32_16x16x32_bf16 v[156:159], v[104:107], a[248:251], v[156:159]
    ds_read_b64_tr_b16 v[126:127], v16 offset:16704
    s_waitcnt lgkmcnt(8)
    v_mfma_f32_16x16x32_bf16 v[160:163], v[108:111], a[168:171], v[160:163]
    ds_read_b64_tr_b16 v[128:129], v16 offset:15456
    buffer_load_dwordx4 v14, s[20:23], s91 offen lds
    v_mfma_f32_16x16x32_bf16 v[164:167], v[108:111], a[248:251], v[164:167]
    ds_read_b64_tr_b16 v[130:131], v16 offset:16736
    s_waitcnt lgkmcnt(8)
    v_mfma_f32_16x16x32_bf16 v[168:171], v[112:115], a[168:171], v[168:171]
    ds_read_b64_tr_b16 v[132:133], v16 offset:15488
    v_mfma_f32_16x16x32_bf16 v[172:175], v[112:115], a[248:251], v[172:175]
    ds_read_b64_tr_b16 v[134:135], v16 offset:16768
    s_waitcnt lgkmcnt(8)
    v_mfma_f32_16x16x32_bf16 v[136:139], v[116:119], a[172:175], v[136:139]
    v_mfma_f32_16x16x32_bf16 v[140:143], v[116:119], a[252:255], v[140:143]
    s_waitcnt lgkmcnt(6)
    v_mfma_f32_16x16x32_bf16 v[144:147], v[120:123], a[172:175], v[144:147]
    v_mfma_f32_16x16x32_bf16 v[148:151], v[120:123], a[252:255], v[148:151]
    v_add_u32 v16, s46, v15
    s_waitcnt vmcnt(10) lgkmcnt(0)
    s_barrier
    v_mfma_f32_16x16x32_bf16 v[152:155], v[124:127], a[172:175], v[152:155]
    ds_read_b64_tr_b16 v[96:97], v16 offset:0
    ds_read_b64_tr_b16 v[98:99], v16 offset:1280
    v_mfma_f32_16x16x32_bf16 v[156:159], v[124:127], a[252:255], v[156:159]
    ds_read_b64_tr_b16 v[100:101], v16 offset:32
    ds_read_b64_tr_b16 v[102:103], v16 offset:1312
    v_mfma_f32_16x16x32_bf16 v[160:163], v[128:131], a[172:175], v[160:163]
    ds_read_b64_tr_b16 v[104:105], v16 offset:64
    ds_read_b64_tr_b16 v[106:107], v16 offset:1344
    v_mfma_f32_16x16x32_bf16 v[164:167], v[128:131], a[252:255], v[164:167]
    ds_read_b64_tr_b16 v[108:109], v16 offset:96
    ds_read_b64_tr_b16 v[110:111], v16 offset:1376
    v_mfma_f32_16x16x32_bf16 v[168:171], v[132:135], a[172:175], v[168:171]
    ds_read_b64_tr_b16 v[112:113], v16 offset:128
    ds_read_b64_tr_b16 v[114:115], v16 offset:1408
    v_mfma_f32_16x16x32_bf16 v[172:175], v[132:135], a[252:255], v[172:175]
    s_waitcnt lgkmcnt(8)
    v_mfma_f32_16x16x32_bf16 v[136:139], v[96:99], a[176:179], v[136:139]
    ds_read_b64_tr_b16 v[116:117], v16 offset:5120
    s_add_u32 s46, s46, 20480
    s_cmp_eq_u32 s46, 81920
    v_mfma_f32_16x16x32_bf16 v[140:143], v[96:99], v[32:35], v[140:143]
    ds_read_b64_tr_b16 v[118:119], v16 offset:6400
    s_cselect_b32 s46, 0, s46
    s_mul_i32 s90, s32, 5120
    s_waitcnt lgkmcnt(8)
    v_mfma_f32_16x16x32_bf16 v[144:147], v[100:103], a[176:179], v[144:147]
    ds_read_b64_tr_b16 v[120:121], v16 offset:5152
    s_add_u32 m0, s90, s47
    s_mul_i32 s91, s44, 163840
    v_mfma_f32_16x16x32_bf16 v[148:151], v[100:103], v[32:35], v[148:151]
    ds_read_b64_tr_b16 v[122:123], v16 offset:6432
    s_add_u32 s91, s91, s43
    buffer_load_dwordx4 v10, s[20:23], s91 offen lds
    s_waitcnt lgkmcnt(8)
    v_mfma_f32_16x16x32_bf16 v[152:155], v[104:107], a[176:179], v[152:155]
    ds_read_b64_tr_b16 v[124:125], v16 offset:5184
    s_add_u32 s47, s47, 20480
    s_cmp_eq_u32 s47, 81920
    v_mfma_f32_16x16x32_bf16 v[156:159], v[104:107], v[32:35], v[156:159]
    ds_read_b64_tr_b16 v[126:127], v16 offset:6464
    s_cselect_b32 s47, 0, s47
    s_cmp_lg_u32 s51, 0
    s_waitcnt lgkmcnt(8)
    v_mfma_f32_16x16x32_bf16 v[160:163], v[108:111], a[176:179], v[160:163]
    ds_read_b64_tr_b16 v[128:129], v16 offset:5216
    s_cselect_b32 s90, 1, 0
    s_sub_u32 s51, s51, s90
    v_mfma_f32_16x16x32_bf16 v[164:167], v[108:111], v[32:35], v[164:167]
    ds_read_b64_tr_b16 v[130:131], v16 offset:6496
    s_add_u32 s44, s44, s90
    s_cmp_eq_u32 s44, 5
    s_waitcnt lgkmcnt(8)
    v_mfma_f32_16x16x32_bf16 v[168:171], v[112:115], a[176:179], v[168:171]
    ds_read_b64_tr_b16 v[132:133], v16 offset:5248
    s_cselect_b32 s44, 0, s44
    s_cselect_b32 s90, 160, 0
    v_mfma_f32_16x16x32_bf16 v[172:175], v[112:115], v[32:35], v[172:175]
    ds_read_b64_tr_b16 v[134:135], v16 offset:6528
    s_add_u32 s43, s43, s90
    s_cmp_eq_u32 s43, 1280
    s_waitcnt lgkmcnt(8)
    v_mfma_f32_16x16x32_bf16 v[136:139], v[116:119], a[180:183], v[136:139]
    ds_read_b64_tr_b16 v[96:97], v16 offset:10240
    s_cselect_b32 s43, 0, s43
    s_add_u32 m0, m0, 1024
    v_mfma_f32_16x16x32_bf16 v[140:143], v[116:119], v[36:39], v[140:143]
    ds_read_b64_tr_b16 v[98:99], v16 offset:11520
    buffer_load_dwordx4 v11, s[20:23], s91 offen lds
    s_add_u32 m0, m0, 1024
    s_waitcnt lgkmcnt(8)
    v_mfma_f32_16x16x32_bf16 v[144:147], v[120:123], a[180:183], v[144:147]
    ds_read_b64_tr_b16 v[100:101], v16 offset:10272
    v_mfma_f32_16x16x32_bf16 v[148:151], v[120:123], v[36:39], v[148:151]
    ds_read_b64_tr_b16 v[102:103], v16 offset:11552
    s_waitcnt lgkmcnt(8)
    v_mfma_f32_16x16x32_bf16 v[152:155], v[124:127], a[180:183], v[152:155]
    ds_read_b64_tr_b16 v[104:105], v16 offset:10304
    v_mfma_f32_16x16x32_bf16 v[156:159], v[124:127], v[36:39], v[156:159]
    ds_read_b64_tr_b16 v[106:107], v16 offset:11584
    s_waitcnt lgkmcnt(8)
    v_mfma_f32_16x16x32_bf16 v[160:163], v[128:131], a[180:183], v[160:163]
    ds_read_b64_tr_b16 v[108:109], v16 offset:10336
    buffer_load_dwordx4 v12, s[20:23], s91 offen lds
    s_add_u32 m0, m0, 1024
    v_mfma_f32_16x16x32_bf16 v[164:167], v[128:131], v[36:39], v[164:167]
    ds_read_b64_tr_b16 v[110:111], v16 offset:11616
    s_waitcnt lgkmcnt(8)
    v_mfma_f32_16x16x32_bf16 v[168:171], v[132:135], a[180:183], v[168:171]
    ds_read_b64_tr_b16 v[112:113], v16 offset:10368
    v_mfma_f32_16x16x32_bf16 v[172:175], v[132:135], v[36:39], v[172:175]
    ds_read_b64_tr_b16 v[114:115], v16 offset:11648
    s_waitcnt lgkmcnt(8)
    v_mfma_f32_16x16x32_bf16 v[136:139], v[96:99], a[184:187], v[136:139]
    ds_read_b64_tr_b16 v[116:117], v16 offset:15360
    v_mfma_f32_16x16x32_bf16 v[140:143], v[96:99], v[40:43], v[140:143]
    ds_read_b64_tr_b16 v[118:119], v16 offset:16640
    buffer_load_dwordx4 v13, s[20:23], s91 offen lds
    s_add_u32 m0, m0, 1024
    s_waitcnt lgkmcnt(8)
    v_mfma_f32_16x16x32_bf16 v[144:147], v[100:103], a[184:187], v[144:147]
    ds_read_b64_tr_b16 v[120:121], v16 offset:15392
    v_mfma_f32_16x16x32_bf16 v[148:151], v[100:103], v[40:43], v[148:151]
    ds_read_b64_tr_b16 v[122:123], v16 offset:16672
    s_waitcnt lgkmcnt(8)
    v_mfma_f32_16x16x32_bf16 v[152:155], v[104:107], a[184:187], v[152:155]
    ds_read_b64_tr_b16 v[124:125], v16 offset:15424
    v_mfma_f32_16x16x32_bf16 v[156:159], v[104:107], v[40:43], v[156:159]
    ds_read_b64_tr_b16 v[126:127], v16 offset:16704
    s_waitcnt lgkmcnt(8)
    v_mfma_f32_16x16x32_bf16 v[160:163], v[108:111], a[184:187], v[160:163]
    ds_read_b64_tr_b16 v[128:129], v16 offset:15456
    buffer_load_dwordx4 v14, s[20:23], s91 offen lds
    v_mfma_f32_16x16x32_bf16 v[164:167], v[108:111], v[40:43], v[164:167]
    ds_read_b64_tr_b16 v[130:131], v16 offset:16736
    s_waitcnt lgkmcnt(8)
    v_mfma_f32_16x16x32_bf16 v[168:171], v[112:115], a[184:187], v[168:171]
    ds_read_b64_tr_b16 v[132:133], v16 offset:15488
    v_mfma_f32_16x16x32_bf16 v[172:175], v[112:115], v[40:43], v[172:175]
    ds_read_b64_tr_b16 v[134:135], v16 offset:16768
    s_waitcnt lgkmcnt(8)
    v_mfma_f32_16x16x32_bf16 v[136:139], v[116:119], a[188:191], v[136:139]
    v_mfma_f32_16x16x32_bf16 v[140:143], v[116:119], v[44:47], v[140:143]
    s_waitcnt lgkmcnt(6)
    v_mfma_f32_16x16x32_bf16 v[144:147], v[120:123], a[188:191], v[144:147]
    v_mfma_f32_16x16x32_bf16 v[148:151], v[120:123], v[44:47], v[148:151]
    v_add_u32 v16, s46, v15
    s_waitcnt vmcnt(10) lgkmcnt(0)
    s_barrier
    v_mfma_f32_16x16x32_bf16 v[152:155], v[124:127], a[188:191], v[152:155]
    ds_read_b64_tr_b16 v[96:97], v16 offset:0
    ds_read_b64_tr_b16 v[98:99], v16 offset:1280
    v_mfma_f32_16x16x32_bf16 v[156:159], v[124:127], v[44:47], v[156:159]
    ds_read_b64_tr_b16 v[100:101], v16 offset:32
    ds_read_b64_tr_b16 v[102:103], v16 offset:1312
    v_mfma_f32_16x16x32_bf16 v[160:163], v[128:131], a[188:191], v[160:163]
    ds_read_b64_tr_b16 v[104:105], v16 offset:64
    ds_read_b64_tr_b16 v[106:107], v16 offset:1344
    v_mfma_f32_16x16x32_bf16 v[164:167], v[128:131], v[44:47], v[164:167]
    ds_read_b64_tr_b16 v[108:109], v16 offset:96
    ds_read_b64_tr_b16 v[110:111], v16 offset:1376
    v_mfma_f32_16x16x32_bf16 v[168:171], v[132:135], a[188:191], v[168:171]
    ds_read_b64_tr_b16 v[112:113], v16 offset:128
    ds_read_b64_tr_b16 v[114:115], v16 offset:1408
    v_mfma_f32_16x16x32_bf16 v[172:175], v[132:135], v[44:47], v[172:175]
    s_waitcnt lgkmcnt(8)
    v_mfma_f32_16x16x32_bf16 v[136:139], v[96:99], a[192:195], v[136:139]
    ds_read_b64_tr_b16 v[116:117], v16 offset:5120
    s_add_u32 s46, s46, 20480
    s_cmp_eq_u32 s46, 81920
    v_mfma_f32_16x16x32_bf16 v[140:143], v[96:99], v[48:51], v[140:143]
    ds_read_b64_tr_b16 v[118:119], v16 offset:6400
    s_cselect_b32 s46, 0, s46
    s_mul_i32 s90, s32, 5120
    s_waitcnt lgkmcnt(8)
    v_mfma_f32_16x16x32_bf16 v[144:147], v[100:103], a[192:195], v[144:147]
    ds_read_b64_tr_b16 v[120:121], v16 offset:5152
    s_add_u32 m0, s90, s47
    s_mul_i32 s91, s44, 163840
    v_mfma_f32_16x16x32_bf16 v[148:151], v[100:103], v[48:51], v[148:151]
    ds_read_b64_tr_b16 v[122:123], v16 offset:6432
    s_add_u32 s91, s91, s43
    buffer_load_dwordx4 v10, s[20:23], s91 offen lds
    s_waitcnt lgkmcnt(8)
    v_mfma_f32_16x16x32_bf16 v[152:155], v[104:107], a[192:195], v[152:155]
    ds_read_b64_tr_b16 v[124:125], v16 offset:5184
    s_add_u32 s47, s47, 20480
    s_cmp_eq_u32 s47, 81920
    v_mfma_f32_16x16x32_bf16 v[156:159], v[104:107], v[48:51], v[156:159]
    ds_read_b64_tr_b16 v[126:127], v16 offset:6464
    s_cselect_b32 s47, 0, s47
    s_cmp_lg_u32 s51, 0
    s_waitcnt lgkmcnt(8)
    v_mfma_f32_16x16x32_bf16 v[160:163], v[108:111], a[192:195], v[160:163]
    ds_read_b64_tr_b16 v[128:129], v16 offset:5216
    s_cselect_b32 s90, 1, 0
    s_sub_u32 s51, s51, s90
    v_mfma_f32_16x16x32_bf16 v[164:167], v[108:111], v[48:51], v[164:167]
    ds_read_b64_tr_b16 v[130:131], v16 offset:6496
    s_add_u32 s44, s44, s90
    s_cmp_eq_u32 s44, 5
    s_waitcnt lgkmcnt(8)
    v_mfma_f32_16x16x32_bf16 v[168:171], v[112:115], a[192:195], v[168:171]
    ds_read_b64_tr_b16 v[132:133], v16 offset:5248
    s_cselect_b32 s44, 0, s44
    s_cselect_b32 s90, 160, 0
    v_mfma_f32_16x16x32_bf16 v[172:175], v[112:115], v[48:51], v[172:175]
    ds_read_b64_tr_b16 v[134:135], v16 offset:6528
    s_add_u32 s43, s43, s90
    s_cmp_eq_u32 s43, 1280
    s_waitcnt lgkmcnt(8)
    v_mfma_f32_16x16x32_bf16 v[136:139], v[116:119], a[196:199], v[136:139]
    ds_read_b64_tr_b16 v[96:97], v16 offset:10240
    s_cselect_b32 s43, 0, s43
    s_add_u32 m0, m0, 1024
    v_mfma_f32_16x16x32_bf16 v[140:143], v[116:119], v[52:55], v[140:143]
    ds_read_b64_tr_b16 v[98:99], v16 offset:11520
    buffer_load_dwordx4 v11, s[20:23], s91 offen lds
    s_add_u32 m0, m0, 1024
    s_waitcnt lgkmcnt(8)
    v_mfma_f32_16x16x32_bf16 v[144:147], v[120:123], a[196:199], v[144:147]
    ds_read_b64_tr_b16 v[100:101], v16 offset:10272
    v_mfma_f32_16x16x32_bf16 v[148:151], v[120:123], v[52:55], v[148:151]
    ds_read_b64_tr_b16 v[102:103], v16 offset:11552
    s_waitcnt lgkmcnt(8)
    v_mfma_f32_16x16x32_bf16 v[152:155], v[124:127], a[196:199], v[152:155]
    ds_read_b64_tr_b16 v[104:105], v16 offset:10304
    v_mfma_f32_16x16x32_bf16 v[156:159], v[124:127], v[52:55], v[156:159]
    ds_read_b64_tr_b16 v[106:107], v16 offset:11584
    s_waitcnt lgkmcnt(8)
    v_mfma_f32_16x16x32_bf16 v[160:163], v[128:131], a[196:199], v[160:163]
    ds_read_b64_tr_b16 v[108:109], v16 offset:10336
    buffer_load_dwordx4 v12, s[20:23], s91 offen lds
    s_add_u32 m0, m0, 1024
    v_mfma_f32_16x16x32_bf16 v[164:167], v[128:131], v[52:55], v[164:167]
    ds_read_b64_tr_b16 v[110:111], v16 offset:11616
    s_waitcnt lgkmcnt(8)
    v_mfma_f32_16x16x32_bf16 v[168:171], v[132:135], a[196:199], v[168:171]
    ds_read_b64_tr_b16 v[112:113], v16 offset:10368
    v_mfma_f32_16x16x32_bf16 v[172:175], v[132:135], v[52:55], v[172:175]
    ds_read_b64_tr_b16 v[114:115], v16 offset:11648
    s_waitcnt lgkmcnt(8)
    v_mfma_f32_16x16x32_bf16 v[136:139], v[96:99], a[200:203], v[136:139]
    ds_read_b64_tr_b16 v[116:117], v16 offset:15360
    v_mfma_f32_16x16x32_bf16 v[140:143], v[96:99], v[56:59], v[140:143]
    ds_read_b64_tr_b16 v[118:119], v16 offset:16640
    buffer_load_dwordx4 v13, s[20:23], s91 offen lds
    s_add_u32 m0, m0, 1024
    s_waitcnt lgkmcnt(8)
    v_mfma_f32_16x16x32_bf16 v[144:147], v[100:103], a[200:203], v[144:147]
    ds_read_b64_tr_b16 v[120:121], v16 offset:15392
    v_mfma_f32_16x16x32_bf16 v[148:151], v[100:103], v[56:59], v[148:151]
    ds_read_b64_tr_b16 v[122:123], v16 offset:16672
    s_waitcnt lgkmcnt(8)
    v_mfma_f32_16x16x32_bf16 v[152:155], v[104:107], a[200:203], v[152:155]
    ds_read_b64_tr_b16 v[124:125], v16 offset:15424
    v_mfma_f32_16x16x32_bf16 v[156:159], v[104:107], v[56:59], v[156:159]
    ds_read_b64_tr_b16 v[126:127], v16 offset:16704
    s_waitcnt lgkmcnt(8)
    v_mfma_f32_16x16x32_bf16 v[160:163], v[108:111], a[200:203], v[160:163]
    ds_read_b64_tr_b16 v[128:129], v16 offset:15456
    buffer_load_dwordx4 v14, s[20:23], s91 offen lds
    v_mfma_f32_16x16x32_bf16 v[164:167], v[108:111], v[56:59], v[164:167]
    ds_read_b64_tr_b16 v[130:131], v16 offset:16736
    s_waitcnt lgkmcnt(8)
    v_mfma_f32_16x16x32_bf16 v[168:171], v[112:115], a[200:203], v[168:171]
    ds_read_b64_tr_b16 v[132:133], v16 offset:15488
    v_mfma_f32_16x16x32_bf16 v[172:175], v[112:115], v[56:59], v[172:175]
    ds_read_b64_tr_b16 v[134:135], v16 offset:16768
    s_waitcnt lgkmcnt(8)
    v_mfma_f32_16x16x32_bf16 v[136:139], v[116:119], a[204:207], v[136:139]
    v_mfma_f32_16x16x32_bf16 v[140:143], v[116:119], v[60:63], v[140:143]
    s_waitcnt lgkmcnt(6)
    v_mfma_f32_16x16x32_bf16 v[144:147], v[120:123], a[204:207], v[144:147]
    v_mfma_f32_16x16x32_bf16 v[148:151], v[120:123], v[60:63], v[148:151]
    v_add_u32 v16, s46, v15
    s_waitcnt vmcnt(10) lgkmcnt(0)
    s_barrier
    v_mfma_f32_16x16x32_bf16 v[152:155], v[124:127], a[204:207], v[152:155]
    ds_read_b64_tr_b16 v[96:97], v16 offset:0
    ds_read_b64_tr_b16 v[98:99], v16 offset:1280
    v_mfma_f32_16x16x32_bf16 v[156:159], v[124:127], v[60:63], v[156:159]
    ds_read_b64_tr_b16 v[100:101], v16 offset:32
    ds_read_b64_tr_b16 v[102:103], v16 offset:1312
    v_mfma_f32_16x16x32_bf16 v[160:163], v[128:131], a[204:207], v[160:163]
    ds_read_b64_tr_b16 v[104:105], v16 offset:64
    ds_read_b64_tr_b16 v[106:107], v16 offset:1344
    v_mfma_f32_16x16x32_bf16 v[164:167], v[128:131], v[60:63], v[164:167]
    ds_read_b64_tr_b16 v[108:109], v16 offset:96
    ds_read_b64_tr_b16 v[110:111], v16 offset:1376
    v_mfma_f32_16x16x32_bf16 v[168:171], v[132:135], a[204:207], v[168:171]
    ds_read_b64_tr_b16 v[112:113], v16 offset:128
    ds_read_b64_tr_b16 v[114:115], v16 offset:1408
    v_mfma_f32_16x16x32_bf16 v[172:175], v[132:135], v[60:63], v[172:175]
    s_waitcnt lgkmcnt(8)
    v_mfma_f32_16x16x32_bf16 v[136:139], v[96:99], a[208:211], v[136:139]
    ds_read_b64_tr_b16 v[116:117], v16 offset:5120
    s_add_u32 s46, s46, 20480
    s_cmp_eq_u32 s46, 81920
    v_mfma_f32_16x16x32_bf16 v[140:143], v[96:99], v[64:67], v[140:143]
    ds_read_b64_tr_b16 v[118:119], v16 offset:6400
    s_cselect_b32 s46, 0, s46
    s_mul_i32 s90, s32, 5120
    s_waitcnt lgkmcnt(8)
    v_mfma_f32_16x16x32_bf16 v[144:147], v[100:103], a[208:211], v[144:147]
    ds_read_b64_tr_b16 v[120:121], v16 offset:5152
    s_add_u32 m0, s90, s47
    s_mul_i32 s91, s44, 163840
    v_mfma_f32_16x16x32_bf16 v[148:151], v[100:103], v[64:67], v[148:151]
    ds_read_b64_tr_b16 v[122:123], v16 offset:6432
    s_add_u32 s91, s91, s43
    buffer_load_dwordx4 v10, s[20:23], s91 offen lds
    s_waitcnt lgkmcnt(8)
    v_mfma_f32_16x16x32_bf16 v[152:155], v[104:107], a[208:211], v[152:155]
    ds_read_b64_tr_b16 v[124:125], v16 offset:5184
    s_add_u32 s47, s47, 20480
    s_cmp_eq_u32 s47, 81920
    v_mfma_f32_16x16x32_bf16 v[156:159], v[104:107], v[64:67], v[156:159]
    ds_read_b64_tr_b16 v[126:127], v16 offset:6464
    s_cselect_b32 s47, 0, s47
    s_cmp_lg_u32 s51, 0
    s_waitcnt lgkmcnt(8)
    v_mfma_f32_16x16x32_bf16 v[160:163], v[108:111], a[208:211], v[160:163]
    ds_read_b64_tr_b16 v[128:129], v16 offset:5216
    s_cselect_b32 s90, 1, 0
    s_sub_u32 s51, s51, s90
    v_mfma_f32_16x16x32_bf16 v[164:167], v[108:111], v[64:67], v[164:167]
    ds_read_b64_tr_b16 v[130:131], v16 offset:6496
    s_add_u32 s44, s44, s90
    s_cmp_eq_u32 s44, 5
    s_waitcnt lgkmcnt(8)
    v_mfma_f32_16x16x32_bf16 v[168:171], v[112:115], a[208:211], v[168:171]
    ds_read_b64_tr_b16 v[132:133], v16 offset:5248
    s_cselect_b32 s44, 0, s44
    s_cselect_b32 s90, 160, 0
    v_mfma_f32_16x16x32_bf16 v[172:175], v[112:115], v[64:67], v[172:175]
    ds_read_b64_tr_b16 v[134:135], v16 offset:6528
    s_add_u32 s43, s43, s90
    s_cmp_eq_u32 s43, 1280
    s_waitcnt lgkmcnt(8)
    v_mfma_f32_16x16x32_bf16 v[136:139], v[116:119], a[212:215], v[136:139]
    ds_read_b64_tr_b16 v[96:97], v16 offset:10240
    s_cselect_b32 s43, 0, s43
    s_add_u32 m0, m0, 1024
    v_mfma_f32_16x16x32_bf16 v[140:143], v[116:119], v[68:71], v[140:143]
    ds_read_b64_tr_b16 v[98:99], v16 offset:11520
    buffer_load_dwordx4 v11, s[20:23], s91 offen lds
    s_add_u32 m0, m0, 1024
    s_waitcnt lgkmcnt(8)
    v_mfma_f32_16x16x32_bf16 v[144:147], v[120:123], a[212:215], v[144:147]
    ds_read_b64_tr_b16 v[100:101], v16 offset:10272
    v_mfma_f32_16x16x32_bf16 v[148:151], v[120:123], v[68:71], v[148:151]
    ds_read_b64_tr_b16 v[102:103], v16 offset:11552
    s_waitcnt lgkmcnt(8)
    v_mfma_f32_16x16x32_bf16 v[152:155], v[124:127], a[212:215], v[152:155]
    ds_read_b64_tr_b16 v[104:105], v16 offset:10304
    v_mfma_f32_16x16x32_bf16 v[156:159], v[124:127], v[68:71], v[156:159]
    ds_read_b64_tr_b16 v[106:107], v16 offset:11584
    s_waitcnt lgkmcnt(8)
    v_mfma_f32_16x16x32_bf16 v[160:163], v[128:131], a[212:215], v[160:163]
    ds_read_b64_tr_b16 v[108:109], v16 offset:10336
    buffer_load_dwordx4 v12, s[20:23], s91 offen lds
    s_add_u32 m0, m0, 1024
    v_mfma_f32_16x16x32_bf16 v[164:167], v[128:131], v[68:71], v[164:167]
    ds_read_b64_tr_b16 v[110:111], v16 offset:11616
    s_waitcnt lgkmcnt(8)
    v_mfma_f32_16x16x32_bf16 v[168:171], v[132:135], a[212:215], v[168:171]
    ds_read_b64_tr_b16 v[112:113], v16 offset:10368
    v_mfma_f32_16x16x32_bf16 v[172:175], v[132:135], v[68:71], v[172:175]
    ds_read_b64_tr_b16 v[114:115], v16 offset:11648
    s_waitcnt lgkmcnt(8)
    v_mfma_f32_16x16x32_bf16 v[136:139], v[96:99], a[216:219], v[136:139]
    ds_read_b64_tr_b16 v[116:117], v16 offset:15360
    v_mfma_f32_16x16x32_bf16 v[140:143], v[96:99], v[72:75], v[140:143]
    ds_read_b64_tr_b16 v[118:119], v16 offset:16640
    buffer_load_dwordx4 v13, s[20:23], s91 offen lds
    s_add_u32 m0, m0, 1024
    s_waitcnt lgkmcnt(8)
    v_mfma_f32_16x16x32_bf16 v[144:147], v[100:103], a[216:219], v[144:147]
    ds_read_b64_tr_b16 v[120:121], v16 offset:15392
    v_mfma_f32_16x16x32_bf16 v[148:151], v[100:103], v[72:75], v[148:151]
    ds_read_b64_tr_b16 v[122:123], v16 offset:16672
    s_waitcnt lgkmcnt(8)
    v_mfma_f32_16x16x32_bf16 v[152:155], v[104:107], a[216:219], v[152:155]
    ds_read_b64_tr_b16 v[124:125], v16 offset:15424
    v_mfma_f32_16x16x32_bf16 v[156:159], v[104:107], v[72:75], v[156:159]
    ds_read_b64_tr_b16 v[126:127], v16 offset:16704
    s_waitcnt lgkmcnt(8)
    v_mfma_f32_16x16x32_bf16 v[160:163], v[108:111], a[216:219], v[160:163]
    ds_read_b64_tr_b16 v[128:129], v16 offset:15456
    buffer_load_dwordx4 v14, s[20:23], s91 offen lds
    v_mfma_f32_16x16x32_bf16 v[164:167], v[108:111], v[72:75], v[164:167]
    ds_read_b64_tr_b16 v[130:131], v16 offset:16736
    s_waitcnt lgkmcnt(8)
    v_mfma_f32_16x16x32_bf16 v[168:171], v[112:115], a[216:219], v[168:171]
    ds_read_b64_tr_b16 v[132:133], v16 offset:15488
    v_mfma_f32_16x16x32_bf16 v[172:175], v[112:115], v[72:75], v[172:175]
    ds_read_b64_tr_b16 v[134:135], v16 offset:16768
    s_waitcnt lgkmcnt(8)
    v_mfma_f32_16x16x32_bf16 v[136:139], v[116:119], a[220:223], v[136:139]
    v_mfma_f32_16x16x32_bf16 v[140:143], v[116:119], v[76:79], v[140:143]
    s_waitcnt lgkmcnt(6)
    v_mfma_f32_16x16x32_bf16 v[144:147], v[120:123], a[220:223], v[144:147]
    v_mfma_f32_16x16x32_bf16 v[148:151], v[120:123], v[76:79], v[148:151]
    v_add_u32 v16, s46, v15
    s_waitcnt vmcnt(10) lgkmcnt(0)
    s_barrier
    v_mfma_f32_16x16x32_bf16 v[152:155], v[124:127], a[220:223], v[152:155]
    ds_read_b64_tr_b16 v[96:97], v16 offset:0
    ds_read_b64_tr_b16 v[98:99], v16 offset:1280
    v_mfma_f32_16x16x32_bf16 v[156:159], v[124:127], v[76:79], v[156:159]
    ds_read_b64_tr_b16 v[100:101], v16 offset:32
    ds_read_b64_tr_b16 v[102:103], v16 offset:1312
    v_mfma_f32_16x16x32_bf16 v[160:163], v[128:131], a[220:223], v[160:163]
    ds_read_b64_tr_b16 v[104:105], v16 offset:64
    ds_read_b64_tr_b16 v[106:107], v16 offset:1344
    v_mfma_f32_16x16x32_bf16 v[164:167], v[128:131], v[76:79], v[164:167]
    ds_read_b64_tr_b16 v[108:109], v16 offset:96
    ds_read_b64_tr_b16 v[110:111], v16 offset:1376
    v_mfma_f32_16x16x32_bf16 v[168:171], v[132:135], a[220:223], v[168:171]
    ds_read_b64_tr_b16 v[112:113], v16 offset:128
    ds_read_b64_tr_b16 v[114:115], v16 offset:1408
    v_mfma_f32_16x16x32_bf16 v[172:175], v[132:135], v[76:79], v[172:175]
    s_waitcnt lgkmcnt(8)
    v_mfma_f32_16x16x32_bf16 v[136:139], v[96:99], a[224:227], v[136:139]
    ds_read_b64_tr_b16 v[116:117], v16 offset:5120
    s_add_u32 s46, s46, 20480
    s_cmp_eq_u32 s46, 81920
    v_mfma_f32_16x16x32_bf16 v[140:143], v[96:99], v[80:83], v[140:143]
    ds_read_b64_tr_b16 v[118:119], v16 offset:6400
    s_cselect_b32 s46, 0, s46
    s_mul_i32 s90, s32, 5120
    s_waitcnt lgkmcnt(8)
    v_mfma_f32_16x16x32_bf16 v[144:147], v[100:103], a[224:227], v[144:147]
    ds_read_b64_tr_b16 v[120:121], v16 offset:5152
    s_add_u32 m0, s90, s47
    s_mul_i32 s91, s44, 163840
    v_mfma_f32_16x16x32_bf16 v[148:151], v[100:103], v[80:83], v[148:151]
    ds_read_b64_tr_b16 v[122:123], v16 offset:6432
    s_add_u32 s91, s91, s43
    buffer_load_dwordx4 v10, s[20:23], s91 offen lds
    s_waitcnt lgkmcnt(8)
    v_mfma_f32_16x16x32_bf16 v[152:155], v[104:107], a[224:227], v[152:155]
    ds_read_b64_tr_b16 v[124:125], v16 offset:5184
    s_add_u32 s47, s47, 20480
    s_cmp_eq_u32 s47, 81920
    v_mfma_f32_16x16x32_bf16 v[156:159], v[104:107], v[80:83], v[156:159]
    ds_read_b64_tr_b16 v[126:127], v16 offset:6464
    s_cselect_b32 s47, 0, s47
    s_cmp_lg_u32 s51, 0
    s_waitcnt lgkmcnt(8)
    v_mfma_f32_16x16x32_bf16 v[160:163], v[108:111], a[224:227], v[160:163]
    ds_read_b64_tr_b16 v[128:129], v16 offset:5216
    s_cselect_b32 s90, 1, 0
    s_sub_u32 s51, s51, s90
    v_mfma_f32_16x16x32_bf16 v[164:167], v[108:111], v[80:83], v[164:167]
    ds_read_b64_tr_b16 v[130:131], v16 offset:6496
    s_add_u32 s44, s44, s90
    s_cmp_eq_u32 s44, 5
    s_waitcnt lgkmcnt(8)
    v_mfma_f32_16x16x32_bf16 v[168:171], v[112:115], a[224:227], v[168:171]
    ds_read_b64_tr_b16 v[132:133], v16 offset:5248
    s_cselect_b32 s44, 0, s44
    s_cselect_b32 s90, 160, 0
    v_mfma_f32_16x16x32_bf16 v[172:175], v[112:115], v[80:83], v[172:175]
    ds_read_b64_tr_b16 v[134:135], v16 offset:6528
    s_add_u32 s43, s43, s90
    s_cmp_eq_u32 s43, 1280
    s_waitcnt lgkmcnt(8)
    v_mfma_f32_16x16x32_bf16 v[136:139], v[116:119], a[228:231], v[136:139]
    ds_read_b64_tr_b16 v[96:97], v16 offset:10240
    s_cselect_b32 s43, 0, s43
    s_add_u32 m0, m0, 1024
    v_mfma_f32_16x16x32_bf16 v[140:143], v[116:119], v[84:87], v[140:143]
    ds_read_b64_tr_b16 v[98:99], v16 offset:11520
    buffer_load_dwordx4 v11, s[20:23], s91 offen lds
    s_add_u32 m0, m0, 1024
    s_waitcnt lgkmcnt(8)
    v_mfma_f32_16x16x32_bf16 v[144:147], v[120:123], a[228:231], v[144:147]
    ds_read_b64_tr_b16 v[100:101], v16 offset:10272
    v_mfma_f32_16x16x32_bf16 v[148:151], v[120:123], v[84:87], v[148:151]
    ds_read_b64_tr_b16 v[102:103], v16 offset:11552
    s_waitcnt lgkmcnt(8)
    v_mfma_f32_16x16x32_bf16 v[152:155], v[124:127], a[228:231], v[152:155]
    ds_read_b64_tr_b16 v[104:105], v16 offset:10304
    v_mfma_f32_16x16x32_bf16 v[156:159], v[124:127], v[84:87], v[156:159]
    ds_read_b64_tr_b16 v[106:107], v16 offset:11584
    s_waitcnt lgkmcnt(8)
    v_mfma_f32_16x16x32_bf16 v[160:163], v[128:131], a[228:231], v[160:163]
    ds_read_b64_tr_b16 v[108:109], v16 offset:10336
    buffer_load_dwordx4 v12, s[20:23], s91 offen lds
    s_add_u32 m0, m0, 1024
    v_mfma_f32_16x16x32_bf16 v[164:167], v[128:131], v[84:87], v[164:167]
    ds_read_b64_tr_b16 v[110:111], v16 offset:11616
    s_waitcnt lgkmcnt(8)
    v_mfma_f32_16x16x32_bf16 v[168:171], v[132:135], a[228:231], v[168:171]
    ds_read_b64_tr_b16 v[112:113], v16 offset:10368
    v_mfma_f32_16x16x32_bf16 v[172:175], v[132:135], v[84:87], v[172:175]
    ds_read_b64_tr_b16 v[114:115], v16 offset:11648
    s_waitcnt lgkmcnt(8)
    v_mfma_f32_16x16x32_bf16 v[136:139], v[96:99], a[232:235], v[136:139]
    ds_read_b64_tr_b16 v[116:117], v16 offset:15360
    v_mfma_f32_16x16x32_bf16 v[140:143], v[96:99], v[88:91], v[140:143]
    ds_read_b64_tr_b16 v[118:119], v16 offset:16640
    buffer_load_dwordx4 v13, s[20:23], s91 offen lds
    s_add_u32 m0, m0, 1024
    s_waitcnt lgkmcnt(8)
    v_mfma_f32_16x16x32_bf16 v[144:147], v[100:103], a[232:235], v[144:147]
    ds_read_b64_tr_b16 v[120:121], v16 offset:15392
    v_mfma_f32_16x16x32_bf16 v[148:151], v[100:103], v[88:91], v[148:151]
    ds_read_b64_tr_b16 v[122:123], v16 offset:16672
    s_waitcnt lgkmcnt(8)
    v_mfma_f32_16x16x32_bf16 v[152:155], v[104:107], a[232:235], v[152:155]
    ds_read_b64_tr_b16 v[124:125], v16 offset:15424
    v_mfma_f32_16x16x32_bf16 v[156:159], v[104:107], v[88:91], v[156:159]
    ds_read_b64_tr_b16 v[126:127], v16 offset:16704
    s_waitcnt lgkmcnt(8)
    v_mfma_f32_16x16x32_bf16 v[160:163], v[108:111], a[232:235], v[160:163]
    ds_read_b64_tr_b16 v[128:129], v16 offset:15456
    buffer_load_dwordx4 v14, s[20:23], s91 offen lds
    v_mfma_f32_16x16x32_bf16 v[164:167], v[108:111], v[88:91], v[164:167]
    ds_read_b64_tr_b16 v[130:131], v16 offset:16736
    s_waitcnt lgkmcnt(8)
    v_mfma_f32_16x16x32_bf16 v[168:171], v[112:115], a[232:235], v[168:171]
    ds_read_b64_tr_b16 v[132:133], v16 offset:15488
    v_mfma_f32_16x16x32_bf16 v[172:175], v[112:115], v[88:91], v[172:175]
    ds_read_b64_tr_b16 v[134:135], v16 offset:16768
    s_waitcnt lgkmcnt(8)
    v_mfma_f32_16x16x32_bf16 v[136:139], v[116:119], a[236:239], v[136:139]
    v_mfma_f32_16x16x32_bf16 v[140:143], v[116:119], v[92:95], v[140:143]
    s_waitcnt lgkmcnt(6)
    v_mfma_f32_16x16x32_bf16 v[144:147], v[120:123], a[236:239], v[144:147]
    v_mfma_f32_16x16x32_bf16 v[148:151], v[120:123], v[92:95], v[148:151]
    v_add_u32 v16, s46, v15
    s_waitcnt vmcnt(10) lgkmcnt(0)
    s_barrier
    v_mfma_f32_16x16x32_bf16 v[152:155], v[124:127], a[236:239], v[152:155]
    ds_read_b64_tr_b16 v[96:97], v16 offset:0
    ds_read_b64_tr_b16 v[98:99], v16 offset:1280
    v_mfma_f32_16x16x32_bf16 v[156:159], v[124:127], v[92:95], v[156:159]
    ds_read_b64_tr_b16 v[100:101], v16 offset:32
    ds_read_b64_tr_b16 v[102:103], v16 offset:1312
    v_mfma_f32_16x16x32_bf16 v[160:163], v[128:131], a[236:239], v[160:163]
    ds_read_b64_tr_b16 v[104:105], v16 offset:64
    ds_read_b64_tr_b16 v[106:107], v16 offset:1344
    v_mfma_f32_16x16x32_bf16 v[164:167], v[128:131], v[92:95], v[164:167]
    ds_read_b64_tr_b16 v[108:109], v16 offset:96
    ds_read_b64_tr_b16 v[110:111], v16 offset:1376
    v_mfma_f32_16x16x32_bf16 v[168:171], v[132:135], a[236:239], v[168:171]
    ds_read_b64_tr_b16 v[112:113], v16 offset:128
    ds_read_b64_tr_b16 v[114:115], v16 offset:1408
    v_mfma_f32_16x16x32_bf16 v[172:175], v[132:135], v[92:95], v[172:175]
    v_cvt_pk_bf16_f32 v176, v136, v137
    v_cvt_pk_bf16_f32 v177, v138, v139
    v_cvt_pk_bf16_f32 v178, v140, v141
    v_cvt_pk_bf16_f32 v179, v142, v143
    s_nop 0
    v_permlane16_swap_b32 v176, v178
    v_permlane16_swap_b32 v177, v179
    buffer_store_dwordx4 v[176:179], v19, s[28:31], s42 offen offset:0
    s_nop 1
    v_cvt_pk_bf16_f32 v176, v144, v145
    v_cvt_pk_bf16_f32 v177, v146, v147
    v_cvt_pk_bf16_f32 v178, v148, v149
    v_cvt_pk_bf16_f32 v179, v150, v151
    s_nop 0
    v_permlane16_swap_b32 v176, v178
    v_permlane16_swap_b32 v177, v179
    buffer_store_dwordx4 v[176:179], v19, s[28:31], s42 offen offset:32
    s_nop 1
    v_cvt_pk_bf16_f32 v176, v152, v153
    v_cvt_pk_bf16_f32 v177, v154, v155
    v_cvt_pk_bf16_f32 v178, v156, v157
    v_cvt_pk_bf16_f32 v179, v158, v159
    s_nop 0
    v_permlane16_swap_b32 v176, v178
    v_permlane16_swap_b32 v177, v179
    buffer_store_dwordx4 v[176:179], v19, s[28:31], s42 offen offset:64
    s_nop 1
    v_cvt_pk_bf16_f32 v176, v160, v161
    v_cvt_pk_bf16_f32 v177, v162, v163
    v_cvt_pk_bf16_f32 v178, v164, v165
    v_cvt_pk_bf16_f32 v179, v166, v167
    s_nop 0
    v_permlane16_swap_b32 v176, v178
    v_permlane16_swap_b32 v177, v179
    buffer_store_dwordx4 v[176:179], v19, s[28:31], s42 offen offset:96
    s_nop 1
    v_cvt_pk_bf16_f32 v176, v168, v169
    v_cvt_pk_bf16_f32 v177, v170, v171
    v_cvt_pk_bf16_f32 v178, v172, v173
    v_cvt_pk_bf16_f32 v179, v174, v175
    s_nop 0
    v_permlane16_swap_b32 v176, v178
    v_permlane16_swap_b32 v177, v179
    buffer_store_dwordx4 v[176:179], v19, s[28:31], s42 offen offset:128
    s_add_u32 s42, s42, 160
    s_cmp_eq_u32 s42, 1280
    s_cselect_b32 s42, 0, s42
    s_add_u32 s53, s53, 1
    s_cmp_lt_u32 s53, 8
    s_cbranch_scc1 L_pa_oblk
L_pa_end:
    s_waitcnt vmcnt(0)
    s_endpgm
L_slow:
    s_waitcnt vmcnt(0) lgkmcnt(0)
    s_barrier
    s_and_b32 s34, s2, 7
    s_lshr_b32 s35, s2, 3
    s_add_u32 s4, s88, 33554432
    s_addc_u32 s5, s89, 0
    s_and_b32 s5, s5, 0xffff
    s_lshl_b32 s38, s34, 21
    s_add_u32 s38, s38, 8388608
    s_cmp_lt_u32 s35, 28
    s_cbranch_scc1 L_noini_65
    v_mov_b32 v240, -1
    v_mov_b32 v241, -1
    v_mov_b32 v242, -1
    v_mov_b32 v243, -1
    v_mov_b32 v244, 0
    v_lshlrev_b32 v4, 4, v0
    v_lshlrev_b32 v5, 2, v0
    s_sub_u32 s93, s35, 28
    s_lshl_b32 s93, s93, 2
    s_add_u32 s93, s93, s32
    s_lshl_b32 s91, s34, 4
    s_add_u32 s91, s91, s93
    s_lshl_b32 s41, s91, 8
    s_add_u32 s41, s41, 1933312
    s_mul_i32 s91, s91, 5120
    s_lshl_b32 s40, s93, 8
    s_add_u32 s40, s40, s38
    s_add_u32 s40, s40, 458752
    s_lshr_b32 s92, s93, 3
    s_mul_i32 s92, s92, 114688
    s_add_u32 s92, s92, s38
    s_and_b32 s93, s93, 7
    s_mul_i32 s93, s93, 5120
    s_add_u32 s92, s92, s93
    buffer_store_dwordx4 v[240:243], v4, s[4:7], s91 offen offset:0 sc1
    buffer_store_dwordx4 v[240:243], v4, s[4:7], s91 offen offset:1024 sc1
    buffer_store_dwordx4 v[240:243], v4, s[4:7], s91 offen offset:2048 sc1
    buffer_store_dwordx4 v[240:243], v4, s[4:7], s91 offen offset:3072 sc1
    s_add_u32 s91, s91, 4096
    buffer_store_dwordx4 v[240:243], v4, s[4:7], s91 offen offset:0 sc1
    buffer_store_dwordx4 v[240:243], v4, s[4:7], s92 offen offset:0 sc1
    buffer_store_dwordx4 v[240:243], v4, s[4:7], s92 offen offset:1024 sc1
    buffer_store_dwordx4 v[240:243], v4, s[4:7], s92 offen offset:2048 sc1
    buffer_store_dwordx4 v[240:243], v4, s[4:7], s92 offen offset:3072 sc1
    s_add_u32 s92, s92, 4096
    buffer_store_dwordx4 v[240:243], v4, s[4:7], s92 offen offset:0 sc1
    buffer_store_dword v244, v5, s[4:7], s40 offen sc1
    buffer_store_dword v244, v5, s[4:7], s41 offen sc1
    s_waitcnt vmcnt(0)
    s_barrier
    s_cmp_lg_u32 s32, 0
    s_cbranch_scc1 L_ini_66
    v_mov_b32 v1, 68
    v_mov_b32 v2, 1
    s_mov_b64 exec, 1
    buffer_atomic_add v2, v1, s[8:11], 0 offen sc0 sc1
    s_waitcnt vmcnt(0)
    v_readfirstlane_b32 s90, v2
    s_mov_b64 exec, -1
    s_cmp_lg_u32 s90, 31
    s_cbranch_scc1 L_ini_66
    v_mov_b32 v1, 196
    v_mov_b32 v2, 1
    s_mov_b64 exec, 1
    buffer_store_dword v2, v1, s[8:11], 0 offen sc1
    s_mov_b64 exec, -1
L_ini_66:
    s_barrier
    s_cmp_eq_u32 s35, 28
    s_cbranch_scc1 L_px_s
L_noini_65:
    s_nop 0
    s_cmp_lt_u32 s35, 12
    s_cbranch_scc1 L_qkv_s
    s_cmp_lt_u32 s35, 18
    s_cbranch_scc1 L_v_s
    s_cmp_lt_u32 s35, 28
    s_cbranch_scc1 L_wo_s
    s_cmp_lt_u32 s35, 29
    s_cbranch_scc1 L_px_s
    s_branch L_pa_s
L_qkv_s:
    s_mov_b32 s12, s74
    s_and_b32 s13, s75, 0xffff
    s_mov_b32 s14, 7864320
    s_mov_b32 s15, 0x20000
    s_mov_b32 s16, s76
    s_and_b32 s17, s77, 0xffff
    s_mov_b32 s18, 7864320
    s_mov_b32 s19, 0x20000
    s_mov_b32 s40, s35
    s_mov_b32 s24, s70
    s_and_b32 s25, s71, 0xffff
    s_mov_b32 s26, 2621440
    s_mov_b32 s27, 0x20000
    v_and_b32 v1, 15, v0
    v_lshrrev_b32 v2, 4, v0
    v_lshrrev_b32 v3, 3, v0
    v_and_b32 v4, 7, v0
    s_lshl_b32 s90, s32, 3
    v_add_u32 v5, s90, v3
    s_and_b32 s91, s32, 1
    s_lshl_b32 s91, s91, 2
    v_and_b32 v6, 2, v3
    v_or_b32 v6, s91, v6
    v_xor_b32 v6, v6, v4
    v_lshlrev_b32 v6, 4, v6
    v_mul_u32_u24 v7, 12288, v5
    s_mul_i32 s92, s34, 1536
    s_lshl_b32 s93, s40, 7
    s_add_u32 s92, s92, s93
    v_add3_u32 v124, v6, v7, s92
    v_lshrrev_b32 v6, 1, v3
    v_or_b32 v6, s91, v6
    v_xor_b32 v6, v6, v4
    v_lshlrev_b32 v6, 4, v6
    v_mul_u32_u24 v7, 1280, v5
    v_add_u32 v10, v6, v7
    s_lshl_b32 s90, s32, 10
    s_add_u32 m0, s90, 81920
    s_mov_b32 s91, 0
    buffer_load_dwordx4 v124, s[16:19], s91 offen nt lds
    s_add_u32 m0, m0, 4096
    s_add_u32 s91, s91, 393216
    buffer_load_dwordx4 v124, s[16:19], s91 offen nt lds
    s_add_u32 m0, m0, 4096
    s_add_u32 s91, s91, 393216
    buffer_load_dwordx4 v124, s[16:19], s91 offen nt lds
    s_add_u32 m0, m0, 4096
    s_add_u32 s91, s91, 393216
    buffer_load_dwordx4 v124, s[16:19], s91 offen nt lds
    s_add_u32 m0, m0, 4096
    s_add_u32 s91, s91, 393216
    buffer_load_dwordx4 v124, s[16:19], s91 offen nt lds
    s_add_u32 m0, m0, 4096
    s_add_u32 s91, s91, 393216
    buffer_load_dwordx4 v124, s[16:19], s91 offen nt lds
    s_add_u32 m0, m0, 4096
    s_add_u32 s91, s91, 393216
    buffer_load_dwordx4 v124, s[16:19], s91 offen nt lds
    s_add_u32 m0, m0, 4096
    s_add_u32 s91, s91, 393216
    buffer_load_dwordx4 v124, s[16:19], s91 offen nt lds
    s_add_u32 m0, m0, 4096
    s_add_u32 s91, s91, 393216
    buffer_load_dwordx4 v124, s[16:19], s91 offen nt lds
    s_add_u32 m0, m0, 4096
    s_add_u32 s91, s91, 393216
    buffer_load_dwordx4 v124, s[16:19], s91 offen nt lds
    s_mul_i32 s60, s40, 86
    s_lshr_b32 s60, s60, 8
    s_mul_i32 s61, s60, 3
    s_sub_u32 s61, s40, s61
    s_add_u32 s90, s40, 1
    s_mul_i32 s62, s90, 86
    s_lshr_b32 s62, s62, 8
    s_mul_i32 s63, s62, 3
    s_sub_u32 s63, s90, s63
    v_lshrrev_b32 v3, 1, v2
    v_and_b32 v5, 1, v2
    s_lshl_b32 s90, s32, 9
    v_lshlrev_b32 v6, 4, v1
    v_lshl_add_u32 v6, v3, 8, v6
    v_add_u32 v6, s90, v6
    s_mul_i32 s90, s60, 12288
    s_lshl_b32 s91, s61, 11
    s_add_u32 s90, s90, s91
    v_mul_u32_u24 v7, 6144, v5
    v_add3_u32 v19, v6, v7, s90
    v_mov_b32 v22, -1
    s_mov_b32 s56, 49152
    v_lshl_add_u32 v137, v5, 11, v6
    v_add_u32 v137, 135168, v137
    s_mul_i32 s90, s40, 1280
    s_add_u32 s90, s90, 10240
    v_lshlrev_b32 v6, 1, v5
    v_or_b32 v7, v6, v3
    v_lshl_add_u32 v7, v7, 4, v1
    v_lshlrev_b32 v7, 2, v7
    v_add_u32 v7, 1024, v7
    v_or_b32 v6, v6, v1
    v_lshl_add_u32 v6, v3, 4, v6
    v_lshlrev_b32 v6, 4, v6
    s_sub_u32 s91, s32, 1
    s_lshl_b32 s91, s91, 9
    v_add_u32 v6, s91, v6
    s_cmp_eq_u32 s32, 0
    s_cselect_b64 vcc, -1, 0
    v_cndmask_b32 v6, v6, v7, vcc
    v_add_u32 v135, s90, v6
    s_lshl_b32 s91, s32, 8
    s_add_u32 s91, s91, s90
    v_lshl_add_u32 v150, v0, 2, s91
    v_and_b32 v4, 2, v1
    v_cmp_eq_u32 vcc, 0, v4
    v_mov_b32 v9, 2146435072
    s_nop 0
    v_cndmask_b32 v135, v9, v135, vcc
    s_lshl_b32 s90, s40, 10
    v_lshrrev_b32 v3, 2, v1
    v_lshlrev_b32 v3, 1, v3
    v_and_b32 v6, 1, v1
    v_or_b32 v3, v3, v6
    v_lshl_add_u32 v3, v2, 3, v3
    v_lshl_add_u32 v136, v3, 4, s90
    v_cmp_ne_u32 vcc, 0, v4
    v_mov_b32 v9, 2146435072
    s_nop 0
    v_cndmask_b32 v136, v9, v136, vcc
    v_and_b32 v6, 9, v1
    v_lshl_or_b32 v6, v4, 1, v6
    v_and_b32 v7, 4, v1
    v_lshrrev_b32 v7, 1, v7
    v_or_b32 v6, v6, v7
    v_lshlrev_b32 v6, 4, v6
    v_lshl_add_u32 v6, v2, 8, v6
    s_cmp_eq_u32 s32, 2
    s_cselect_b32 s90, 2048, 0
    s_add_u32 s90, s90, 135168
    v_add_u32 v138, s90, v6
    s_lshl_b32 s90, s60, 7
    s_lshl_b32 s91, s61, 2
    s_add_u32 s91, s91, s90
    s_add_u32 s91, s91, 459264
    s_cmp_eq_u32 s32, 3
    s_cselect_b32 s91, s91, 2146435072
    s_cselect_b32 s55, -1, 0
    v_mov_b32 v139, s91
    v_cmp_eq_u32 vcc, 0, v0
    v_mov_b32 v9, 2146435072
    s_nop 0
    v_cndmask_b32 v139, v9, v139, vcc
    v_add_u32 v21, 3072, v139
    s_mul_i32 s90, s35, 32768
    s_lshl_b32 s91, s32, 11
    s_add_u32 s90, s90, s91
    s_lshl_b32 s92, s35, 10
    s_lshl_b32 s91, s32, 8
    s_add_u32 s92, s92, s91
    s_cmp_lt_u32 s35, 10
    s_cselect_b32 s90, s90, 2146435072
    s_cselect_b32 s92, s92, 2146435072
    s_lshl_b32 s91, s34, 8
    v_lshlrev_b32 v3, 4, v0
    v_xor_b32 v3, s91, v3
    v_add_u32 v142, s90, v3
    v_xor_b32 v3, 1024, v3
    v_add_u32 v143, s90, v3
    s_min_u32 s90, s35, 9
    s_lshl_b32 s90, s90, 7
    s_add_u32 s90, s90, 460800
    s_add_u32 s90, s90, s38
    v_and_b32 v3, 3, v0
    v_lshl_add_u32 v146, v3, 2, s90
    v_lshl_add_u32 v149, v0, 2, s92
    v_lshl_add_u32 v148, v1, 4, s92
    v_cmp_eq_u32 vcc, 0, v2
    v_mov_b32 v9, 2146435072
    s_nop 0
    v_cndmask_b32 v148, v9, v148, vcc
    v_and_b32 v7, 1, v1
    v_cmp_ne_u32 vcc, 0, v7
    v_mov_b32 v5, 0x3f80
    v_mov_b32 v6, 0x3f800000
    v_cndmask_b32 v5, v5, v6, vcc
    v_bfe_u32 v6, v1, 1, 1
    v_cmp_eq_u32 vcc, 0, v6
    s_nop 1
    v_cndmask_b32 v198, 0, v5, vcc
    v_mov_b32 v196, 0
    v_mov_b32 v200, 0
    v_cmp_eq_u32 vcc, 1, v6
    s_nop 1
    v_cndmask_b32 v199, 0, v5, vcc
    v_mov_b32 v197, 0
    v_mov_b32 v201, 0
    v_lshrrev_b32 v3, 2, v1
    v_and_b32 v4, 3, v1
    v_and_b32 v5, 1, v2
    v_lshl_add_u32 v6, v2, 3, v3
    v_lshlrev_b32 v6, 7, v6
    v_and_b32 v7, 2, v3
    v_lshl_or_b32 v7, v5, 2, v7
    v_lshrrev_b32 v8, 1, v4
    s_lshl_b32 s90, s32, 1
    v_or_b32 v8, s90, v8
    v_xor_b32 v7, v7, v8
    v_lshl_add_u32 v6, v7, 4, v6
    v_and_b32 v7, 1, v4
    v_lshl_add_u32 v6, v7, 3, v6
    v_add_u32 v125, 81920, v6
    v_add_u32 v126, 40960, v6
    v_add_u32 v127, 122880, v6
    s_lshl_b32 s90, s32, 9
    s_add_u32 s90, s90, 133120
    v_xor_b32 v6, 0, v5
    v_lshl_add_u32 v6, v6, 2, v3
    v_lshl_add_u32 v6, v2, 3, v6
    v_lshlrev_b32 v6, 5, v6
    v_lshl_or_b32 v7, v5, 1, 0
    v_xor_b32 v7, v7, v4
    v_lshl_add_u32 v6, v7, 3, v6
    v_add_u32 v24, 133120, v6
    v_xor_b32 v6, 1, v5
    v_lshl_add_u32 v6, v6, 2, v3
    v_lshl_add_u32 v6, v2, 3, v6
    v_lshlrev_b32 v6, 5, v6
    v_lshl_or_b32 v7, v5, 1, 1
    v_xor_b32 v7, v7, v4
    v_lshl_add_u32 v6, v7, 3, v6
    v_add_u32 v134, 133120, v6
    v_lshrrev_b32 v6, 3, v1
    v_lshlrev_b32 v6, 2, v6
    v_xor_b32 v6, v6, v1
    v_lshlrev_b32 v6, 5, v6
    v_xor_b32 v7, v2, v3
    v_lshl_add_u32 v6, v7, 3, v6
    v_add_u32 v23, s90, v6
    v_and_b32 v7, 2, v1
    v_cmp_ne_u32 vcc, 0, v7
    v_mov_b32 v6, 0x4444
    v_mov_b32 v8, 0xeeee
    v_cndmask_b32 v17, v6, v8, vcc
    v_lshlrev_b32 v6, 4, v0
    v_add_u32 v16, 122880, v6
    s_mul_i32 s90, s32, 2560
    v_lshl_add_u32 v13, v0, 4, s90
    v_lshl_add_u32 v14, v0, 2, s90
    s_add_u32 s48, s90, 122880
    v_mul_u32_u24 v6, 40, v0
    v_add_u32 v15, s48, v6
    v_mul_u32_u24 v6, 164, v0
    v_min_u32 v6, 10236, v6
    v_add_u32 v25, 122880, v6
    v_lshrrev_b32 v6, 3, v1
    v_lshlrev_b32 v6, 10, v6
    v_and_b32 v7, 7, v1
    v_lshl_add_u32 v6, v7, 7, v6
    v_lshrrev_b32 v7, 1, v1
    v_xor_b32 v7, v7, v2
    v_lshl_add_u32 v11, v7, 4, v6
    v_xor_b32 v12, 64, v11
    s_and_b32 s91, s34, 1
    s_lshl_b32 s91, s91, 12
    s_lshr_b32 s92, s34, 2
    s_lshl_b32 s92, s92, 13
    s_add_u32 s91, s91, s92
    s_and_b32 s92, s34, 2
    s_lshl_b32 s92, s92, 13
    s_add_u32 s91, s91, s92
    s_add_u32 s91, s91, 1933312
    v_lshrrev_b32 v4, 2, v0
    v_lshl_add_u32 v3, v4, 9, s91
    v_cmp_ne_u32 s[92:93], s34, v4
    v_cmp_gt_u32 vcc, 32, v0
    s_nop 0
    s_and_b64 vcc, vcc, s[92:93]
    s_and_b32 vcc_lo, vcc_lo, s55
    v_cndmask_b32 v146, v146, v3, vcc
    v_cndmask_b32 v152, 0, -1, vcc
    s_lshl_b32 s90, s32, 10
    s_add_u32 m0, s90, 40960
    s_mov_b32 s91, 0
    buffer_load_dwordx4 v124, s[12:15], s91 offen nt lds
    s_add_u32 m0, m0, 4096
    s_add_u32 s91, s91, 393216
    buffer_load_dwordx4 v124, s[12:15], s91 offen nt lds
    s_add_u32 m0, m0, 4096
    s_add_u32 s91, s91, 393216
    buffer_load_dwordx4 v124, s[12:15], s91 offen nt lds
    s_add_u32 m0, m0, 4096
    s_add_u32 s91, s91, 393216
    buffer_load_dwordx4 v124, s[12:15], s91 offen nt lds
    s_add_u32 m0, m0, 4096
    s_add_u32 s91, s91, 393216
    buffer_load_dwordx4 v124, s[12:15], s91 offen nt lds
    s_add_u32 m0, m0, 4096
    s_add_u32 s91, s91, 393216
    buffer_load_dwordx4 v124, s[12:15], s91 offen nt lds
    s_add_u32 m0, m0, 4096
    s_add_u32 s91, s91, 393216
    buffer_load_dwordx4 v124, s[12:15], s91 offen nt lds
    s_add_u32 m0, m0, 4096
    s_add_u32 s91, s91, 393216
    buffer_load_dwordx4 v124, s[12:15], s91 offen nt lds
    s_add_u32 m0, m0, 4096
    s_add_u32 s91, s91, 393216
    buffer_load_dwordx4 v124, s[12:15], s91 offen nt lds
    s_add_u32 m0, m0, 4096
    s_add_u32 s91, s91, 393216
    buffer_load_dwordx4 v124, s[12:15], s91 offen nt lds
    s_lshl_b32 s90, s32, 10
    s_add_u32 m0, s90, 122880
    s_mov_b32 s91, 3932160
    buffer_load_dwordx4 v124, s[16:19], s91 offen nt lds
    s_add_u32 m0, m0, 4096
    s_add_u32 s91, s91, 393216
    buffer_load_dwordx4 v124, s[16:19], s91 offen nt lds
    s_add_u32 m0, m0, 4096
    s_add_u32 s91, s91, 393216
    buffer_load_dwordx4 v124, s[16:19], s91 offen nt lds
    s_add_u32 m0, m0, 4096
    s_add_u32 s91, s91, 393216
    buffer_load_dwordx4 v124, s[16:19], s91 offen nt lds
    s_add_u32 m0, m0, 4096
    s_add_u32 s91, s91, 393216
    buffer_load_dwordx4 v124, s[16:19], s91 offen nt lds
    s_add_u32 m0, m0, 4096
    s_add_u32 s91, s91, 393216
    buffer_load_dwordx4 v124, s[16:19], s91 offen nt lds
    s_add_u32 m0, m0, 4096
    s_add_u32 s91, s91, 393216
    buffer_load_dwordx4 v124, s[16:19], s91 offen nt lds
    s_add_u32 m0, m0, 4096
    s_add_u32 s91, s91, 393216
    buffer_load_dwordx4 v124, s[16:19], s91 offen nt lds
    s_add_u32 m0, m0, 4096
    s_add_u32 s91, s91, 393216
    buffer_load_dwordx4 v124, s[16:19], s91 offen nt lds
    s_add_u32 m0, m0, 4096
    s_add_u32 s91, s91, 393216
    buffer_load_dwordx4 v124, s[16:19], s91 offen nt lds
    s_mov_b32 s46, 0
    s_lshl_b32 s90, s32, 10
    s_add_u32 m0, s90, 0
    s_nop 0
    buffer_load_dwordx4 v10, s[24:27], s46 offen offset:0 lds
    s_add_u32 m0, m0, 3968
    s_nop 0
    buffer_load_dwordx4 v10, s[24:27], s46 offen offset:128 lds
    s_add_u32 m0, m0, 3968
    s_nop 0
    buffer_load_dwordx4 v10, s[24:27], s46 offen offset:256 lds
    s_add_u32 m0, m0, 3968
    s_nop 0
    buffer_load_dwordx4 v10, s[24:27], s46 offen offset:384 lds
    s_add_u32 m0, m0, 3968
    s_nop 0
    buffer_load_dwordx4 v10, s[24:27], s46 offen offset:512 lds
    s_add_u32 m0, m0, 3968
    s_nop 0
    buffer_load_dwordx4 v10, s[24:27], s46 offen offset:640 lds
    s_add_u32 m0, m0, 3968
    s_nop 0
    buffer_load_dwordx4 v10, s[24:27], s46 offen offset:768 lds
    s_add_u32 m0, m0, 3968
    s_nop 0
    buffer_load_dwordx4 v10, s[24:27], s46 offen offset:896 lds
    s_add_u32 m0, m0, 3968
    s_nop 0
    buffer_load_dwordx4 v10, s[24:27], s46 offen offset:1024 lds
    s_add_u32 m0, m0, 3968
    s_nop 0
    buffer_load_dwordx4 v10, s[24:27], s46 offen offset:1152 lds
    s_waitcnt vmcnt(30)
    s_barrier
    ds_read_b64_tr_b16 a[80:81], v125 offset:0
    ds_read_b64_tr_b16 a[82:83], v125 offset:512
    ds_read_b64_tr_b16 a[84:85], v125 offset:4096
    ds_read_b64_tr_b16 a[86:87], v125 offset:4608
    ds_read_b64_tr_b16 a[88:89], v125 offset:8192
    ds_read_b64_tr_b16 a[90:91], v125 offset:8704
    ds_read_b64_tr_b16 a[92:93], v125 offset:12288
    ds_read_b64_tr_b16 a[94:95], v125 offset:12800
    ds_read_b64_tr_b16 a[96:97], v125 offset:16384
    ds_read_b64_tr_b16 a[98:99], v125 offset:16896
    ds_read_b64_tr_b16 a[100:101], v125 offset:20480
    ds_read_b64_tr_b16 a[102:103], v125 offset:20992
    ds_read_b64_tr_b16 a[104:105], v125 offset:24576
    ds_read_b64_tr_b16 a[106:107], v125 offset:25088
    ds_read_b64_tr_b16 a[108:109], v125 offset:28672
    ds_read_b64_tr_b16 a[110:111], v125 offset:29184
    ds_read_b64_tr_b16 a[112:113], v125 offset:32768
    ds_read_b64_tr_b16 a[114:115], v125 offset:33280
    ds_read_b64_tr_b16 a[116:117], v125 offset:36864
    ds_read_b64_tr_b16 a[118:119], v125 offset:37376
    s_waitcnt lgkmcnt(0)
    s_barrier
    s_lshl_b32 s90, s32, 10
    s_add_u32 m0, s90, 81920
    s_mov_b32 s91, 3932160
    buffer_load_dwordx4 v124, s[12:15], s91 offen nt lds
    s_add_u32 m0, m0, 4096
    s_add_u32 s91, s91, 393216
    buffer_load_dwordx4 v124, s[12:15], s91 offen nt lds
    s_add_u32 m0, m0, 4096
    s_add_u32 s91, s91, 393216
    buffer_load_dwordx4 v124, s[12:15], s91 offen nt lds
    s_add_u32 m0, m0, 4096
    s_add_u32 s91, s91, 393216
    buffer_load_dwordx4 v124, s[12:15], s91 offen nt lds
    s_add_u32 m0, m0, 4096
    s_add_u32 s91, s91, 393216
    buffer_load_dwordx4 v124, s[12:15], s91 offen nt lds
    s_add_u32 m0, m0, 4096
    s_add_u32 s91, s91, 393216
    buffer_load_dwordx4 v124, s[12:15], s91 offen nt lds
    s_add_u32 m0, m0, 4096
    s_add_u32 s91, s91, 393216
    buffer_load_dwordx4 v124, s[12:15], s91 offen nt lds
    s_add_u32 m0, m0, 4096
    s_add_u32 s91, s91, 393216
    buffer_load_dwordx4 v124, s[12:15], s91 offen nt lds
    s_add_u32 m0, m0, 4096
    s_add_u32 s91, s91, 393216
    buffer_load_dwordx4 v124, s[12:15], s91 offen nt lds
    s_add_u32 m0, m0, 4096
    s_add_u32 s91, s91, 393216
    buffer_load_dwordx4 v124, s[12:15], s91 offen nt lds
    s_waitcnt vmcnt(30)
    s_barrier
    ds_read_b64_tr_b16 a[0:1], v126 offset:0
    ds_read_b64_tr_b16 a[2:3], v126 offset:512
    ds_read_b64_tr_b16 a[4:5], v126 offset:4096
    ds_read_b64_tr_b16 a[6:7], v126 offset:4608
    ds_read_b64_tr_b16 a[8:9], v126 offset:8192
    ds_read_b64_tr_b16 a[10:11], v126 offset:8704
    ds_read_b64_tr_b16 a[12:13], v126 offset:12288
    ds_read_b64_tr_b16 a[14:15], v126 offset:12800
    ds_read_b64_tr_b16 a[16:17], v126 offset:16384
    ds_read_b64_tr_b16 a[18:19], v126 offset:16896
    ds_read_b64_tr_b16 a[20:21], v126 offset:20480
    ds_read_b64_tr_b16 a[22:23], v126 offset:20992
    ds_read_b64_tr_b16 a[24:25], v126 offset:24576
    ds_read_b64_tr_b16 a[26:27], v126 offset:25088
    ds_read_b64_tr_b16 a[28:29], v126 offset:28672
    ds_read_b64_tr_b16 a[30:31], v126 offset:29184
    ds_read_b64_tr_b16 a[32:33], v126 offset:32768
    ds_read_b64_tr_b16 a[34:35], v126 offset:33280
    ds_read_b64_tr_b16 a[36:37], v126 offset:36864
    ds_read_b64_tr_b16 a[38:39], v126 offset:37376
    s_waitcnt lgkmcnt(0)
    s_barrier
    s_mov_b32 s46, 40960
    s_lshl_b32 s90, s32, 10
    s_add_u32 m0, s90, 40960
    s_nop 0
    buffer_load_dwordx4 v10, s[24:27], s46 offen offset:0 lds
    s_add_u32 m0, m0, 3968
    s_nop 0
    buffer_load_dwordx4 v10, s[24:27], s46 offen offset:128 lds
    s_add_u32 m0, m0, 3968
    s_nop 0
    buffer_load_dwordx4 v10, s[24:27], s46 offen offset:256 lds
    s_add_u32 m0, m0, 3968
    s_nop 0
    buffer_load_dwordx4 v10, s[24:27], s46 offen offset:384 lds
    s_add_u32 m0, m0, 3968
    s_nop 0
    buffer_load_dwordx4 v10, s[24:27], s46 offen offset:512 lds
    s_add_u32 m0, m0, 3968
    s_nop 0
    buffer_load_dwordx4 v10, s[24:27], s46 offen offset:640 lds
    s_add_u32 m0, m0, 3968
    s_nop 0
    buffer_load_dwordx4 v10, s[24:27], s46 offen offset:768 lds
    s_add_u32 m0, m0, 3968
    s_nop 0
    buffer_load_dwordx4 v10, s[24:27], s46 offen offset:896 lds
    s_add_u32 m0, m0, 3968
    s_nop 0
    buffer_load_dwordx4 v10, s[24:27], s46 offen offset:1024 lds
    s_add_u32 m0, m0, 3968
    s_nop 0
    buffer_load_dwordx4 v10, s[24:27], s46 offen offset:1152 lds
    s_waitcnt vmcnt(30)
    s_barrier
    ds_read_b64_tr_b16 a[120:121], v127 offset:0
    ds_read_b64_tr_b16 a[122:123], v127 offset:512
    ds_read_b64_tr_b16 a[124:125], v127 offset:4096
    ds_read_b64_tr_b16 a[126:127], v127 offset:4608
    ds_read_b64_tr_b16 a[128:129], v127 offset:8192
    ds_read_b64_tr_b16 a[130:131], v127 offset:8704
    ds_read_b64_tr_b16 a[132:133], v127 offset:12288
    ds_read_b64_tr_b16 a[134:135], v127 offset:12800
    ds_read_b64_tr_b16 a[136:137], v127 offset:16384
    ds_read_b64_tr_b16 a[138:139], v127 offset:16896
    ds_read_b64_tr_b16 a[140:141], v127 offset:20480
    ds_read_b64_tr_b16 a[142:143], v127 offset:20992
    ds_read_b64_tr_b16 a[144:145], v127 offset:24576
    ds_read_b64_tr_b16 a[146:147], v127 offset:25088
    ds_read_b64_tr_b16 a[148:149], v127 offset:28672
    ds_read_b64_tr_b16 a[150:151], v127 offset:29184
    ds_read_b64_tr_b16 a[152:153], v127 offset:32768
    ds_read_b64_tr_b16 a[154:155], v127 offset:33280
    ds_read_b64_tr_b16 a[156:157], v127 offset:36864
    ds_read_b64_tr_b16 a[158:159], v127 offset:37376
    s_waitcnt lgkmcnt(0)
    s_waitcnt vmcnt(10)
    s_barrier
    ds_read_b64_tr_b16 a[40:41], v125 offset:0
    ds_read_b64_tr_b16 a[42:43], v125 offset:512
    ds_read_b64_tr_b16 a[44:45], v125 offset:4096
    ds_read_b64_tr_b16 a[46:47], v125 offset:4608
    ds_read_b64_tr_b16 a[48:49], v125 offset:8192
    ds_read_b64_tr_b16 a[50:51], v125 offset:8704
    ds_read_b64_tr_b16 a[52:53], v125 offset:12288
    ds_read_b64_tr_b16 a[54:55], v125 offset:12800
    ds_read_b64_tr_b16 a[56:57], v125 offset:16384
    ds_read_b64_tr_b16 a[58:59], v125 offset:16896
    ds_read_b64_tr_b16 a[60:61], v125 offset:20480
    ds_read_b64_tr_b16 a[62:63], v125 offset:20992
    ds_read_b64_tr_b16 a[64:65], v125 offset:24576
    ds_read_b64_tr_b16 a[66:67], v125 offset:25088
    ds_read_b64_tr_b16 a[68:69], v125 offset:28672
    ds_read_b64_tr_b16 a[70:71], v125 offset:29184
    ds_read_b64_tr_b16 a[72:73], v125 offset:32768
    ds_read_b64_tr_b16 a[74:75], v125 offset:33280
    ds_read_b64_tr_b16 a[76:77], v125 offset:36864
    ds_read_b64_tr_b16 a[78:79], v125 offset:37376
    s_waitcnt lgkmcnt(0)
    s_mov_b32 s49, 40960
    s_mov_b32 s47, 40960
    s_mov_b32 s37, -1
    s_add_u32 s44, s38, 475136
    s_add_u32 s45, s44, s56
    s_mov_b32 s46, 40960
    v_add_u32 v140, 0, v137
    v_mov_b32 v1, 196
    buffer_load_dword v2, v1, s[8:11], 0 offen sc1
    ds_read_b128 v[84:87], v11 offset:0
    ds_read_b128 v[88:91], v11 offset:2048
    ds_read_b128 v[92:95], v12 offset:0
    ds_read_b128 v[96:99], v12 offset:2048
    s_waitcnt lgkmcnt(2)
    v_mfma_f32_16x16x32_bf16 v[108:111], a[0:3], v[84:87], 0
    ds_read_b128 v[100:103], v11 offset:4096
    v_mfma_f32_16x16x32_bf16 v[112:115], a[0:3], v[88:91], 0
    ds_read_b128 v[104:107], v11 offset:6144
    v_mfma_f32_16x16x32_bf16 v[116:119], a[80:83], v[84:87], 0
    v_mfma_f32_16x16x32_bf16 v[120:123], a[80:83], v[88:91], 0
    s_waitcnt lgkmcnt(2)
    v_mfma_f32_16x16x32_bf16 v[108:111], a[4:7], v[92:95], v[108:111]
    ds_read_b128 v[84:87], v12 offset:4096
    v_mfma_f32_16x16x32_bf16 v[112:115], a[4:7], v[96:99], v[112:115]
    ds_read_b128 v[88:91], v12 offset:6144
    v_mfma_f32_16x16x32_bf16 v[116:119], a[84:87], v[92:95], v[116:119]
    v_mfma_f32_16x16x32_bf16 v[120:123], a[84:87], v[96:99], v[120:123]
    s_waitcnt lgkmcnt(2)
    v_mfma_f32_16x16x32_bf16 v[108:111], a[8:11], v[100:103], v[108:111]
    ds_read_b128 v[92:95], v11 offset:8192
    v_mfma_f32_16x16x32_bf16 v[112:115], a[8:11], v[104:107], v[112:115]
    ds_read_b128 v[96:99], v11 offset:10240
    v_mfma_f32_16x16x32_bf16 v[116:119], a[88:91], v[100:103], v[116:119]
    v_mfma_f32_16x16x32_bf16 v[120:123], a[88:91], v[104:107], v[120:123]
    s_waitcnt lgkmcnt(2)
    v_mfma_f32_16x16x32_bf16 v[108:111], a[12:15], v[84:87], v[108:111]
    ds_read_b128 v[100:103], v12 offset:8192
    v_mfma_f32_16x16x32_bf16 v[112:115], a[12:15], v[88:91], v[112:115]
    ds_read_b128 v[104:107], v12 offset:10240
    v_mfma_f32_16x16x32_bf16 v[116:119], a[92:95], v[84:87], v[116:119]
    v_mfma_f32_16x16x32_bf16 v[120:123], a[92:95], v[88:91], v[120:123]
    s_waitcnt lgkmcnt(2)
    v_mfma_f32_16x16x32_bf16 v[108:111], a[16:19], v[92:95], v[108:111]
    ds_read_b128 v[84:87], v11 offset:12288
    v_mfma_f32_16x16x32_bf16 v[112:115], a[16:19], v[96:99], v[112:115]
    ds_read_b128 v[88:91], v11 offset:14336
    v_mfma_f32_16x16x32_bf16 v[116:119], a[96:99], v[92:95], v[116:119]
    v_mfma_f32_16x16x32_bf16 v[120:123], a[96:99], v[96:99], v[120:123]
    s_waitcnt lgkmcnt(2)
    v_mfma_f32_16x16x32_bf16 v[108:111], a[20:23], v[100:103], v[108:111]
    ds_read_b128 v[92:95], v12 offset:12288
    v_mfma_f32_16x16x32_bf16 v[112:115], a[20:23], v[104:107], v[112:115]
    ds_read_b128 v[96:99], v12 offset:14336
    v_mfma_f32_16x16x32_bf16 v[116:119], a[100:103], v[100:103], v[116:119]
    v_mfma_f32_16x16x32_bf16 v[120:123], a[100:103], v[104:107], v[120:123]
    s_waitcnt lgkmcnt(2)
    v_mfma_f32_16x16x32_bf16 v[108:111], a[24:27], v[84:87], v[108:111]
    ds_read_b128 v[100:103], v11 offset:16384
    v_mfma_f32_16x16x32_bf16 v[112:115], a[24:27], v[88:91], v[112:115]
    ds_read_b128 v[104:107], v11 offset:18432
    v_mfma_f32_16x16x32_bf16 v[116:119], a[104:107], v[84:87], v[116:119]
    v_mfma_f32_16x16x32_bf16 v[120:123], a[104:107], v[88:91], v[120:123]
    s_waitcnt lgkmcnt(2)
    v_mfma_f32_16x16x32_bf16 v[108:111], a[28:31], v[92:95], v[108:111]
    ds_read_b128 v[84:87], v12 offset:16384
    v_mfma_f32_16x16x32_bf16 v[112:115], a[28:31], v[96:99], v[112:115]
    ds_read_b128 v[88:91], v12 offset:18432
    v_mfma_f32_16x16x32_bf16 v[116:119], a[108:111], v[92:95], v[116:119]
    v_mfma_f32_16x16x32_bf16 v[120:123], a[108:111], v[96:99], v[120:123]
    s_waitcnt lgkmcnt(2)
    v_mfma_f32_16x16x32_bf16 v[108:111], a[32:35], v[100:103], v[108:111]
    ds_read_b128 v[92:95], v11 offset:20480
    v_mfma_f32_16x16x32_bf16 v[112:115], a[32:35], v[104:107], v[112:115]
    ds_read_b128 v[96:99], v11 offset:22528
    v_mfma_f32_16x16x32_bf16 v[116:119], a[112:115], v[100:103], v[116:119]
    v_mfma_f32_16x16x32_bf16 v[120:123], a[112:115], v[104:107], v[120:123]
    s_waitcnt lgkmcnt(2)
    v_mfma_f32_16x16x32_bf16 v[108:111], a[36:39], v[84:87], v[108:111]
    ds_read_b128 v[100:103], v12 offset:20480
    v_mfma_f32_16x16x32_bf16 v[112:115], a[36:39], v[88:91], v[112:115]
    ds_read_b128 v[104:107], v12 offset:22528
    v_mfma_f32_16x16x32_bf16 v[116:119], a[116:119], v[84:87], v[116:119]
    v_mfma_f32_16x16x32_bf16 v[120:123], a[116:119], v[88:91], v[120:123]
    s_waitcnt lgkmcnt(2)
    v_mfma_f32_16x16x32_bf16 v[108:111], a[40:43], v[92:95], v[108:111]
    ds_read_b128 v[84:87], v11 offset:24576
    v_mfma_f32_16x16x32_bf16 v[112:115], a[40:43], v[96:99], v[112:115]
    ds_read_b128 v[88:91], v11 offset:26624
    v_mfma_f32_16x16x32_bf16 v[116:119], a[120:123], v[92:95], v[116:119]
    v_mfma_f32_16x16x32_bf16 v[120:123], a[120:123], v[96:99], v[120:123]
    s_waitcnt lgkmcnt(2)
    v_mfma_f32_16x16x32_bf16 v[108:111], a[44:47], v[100:103], v[108:111]
    ds_read_b128 v[92:95], v12 offset:24576
    v_mfma_f32_16x16x32_bf16 v[112:115], a[44:47], v[104:107], v[112:115]
    ds_read_b128 v[96:99], v12 offset:26624
    v_mfma_f32_16x16x32_bf16 v[116:119], a[124:127], v[100:103], v[116:119]
    v_mfma_f32_16x16x32_bf16 v[120:123], a[124:127], v[104:107], v[120:123]
    s_waitcnt lgkmcnt(2)
    v_mfma_f32_16x16x32_bf16 v[108:111], a[48:51], v[84:87], v[108:111]
    ds_read_b128 v[100:103], v11 offset:28672
    v_mfma_f32_16x16x32_bf16 v[112:115], a[48:51], v[88:91], v[112:115]
    ds_read_b128 v[104:107], v11 offset:30720
    v_mfma_f32_16x16x32_bf16 v[116:119], a[128:131], v[84:87], v[116:119]
    v_mfma_f32_16x16x32_bf16 v[120:123], a[128:131], v[88:91], v[120:123]
    s_waitcnt lgkmcnt(2)
    v_mfma_f32_16x16x32_bf16 v[108:111], a[52:55], v[92:95], v[108:111]
    ds_read_b128 v[84:87], v12 offset:28672
    v_mfma_f32_16x16x32_bf16 v[112:115], a[52:55], v[96:99], v[112:115]
    ds_read_b128 v[88:91], v12 offset:30720
    v_mfma_f32_16x16x32_bf16 v[116:119], a[132:135], v[92:95], v[116:119]
    v_mfma_f32_16x16x32_bf16 v[120:123], a[132:135], v[96:99], v[120:123]
    s_waitcnt lgkmcnt(2)
    v_mfma_f32_16x16x32_bf16 v[108:111], a[56:59], v[100:103], v[108:111]
    ds_read_b128 v[92:95], v11 offset:32768
    v_mfma_f32_16x16x32_bf16 v[112:115], a[56:59], v[104:107], v[112:115]
    ds_read_b128 v[96:99], v11 offset:34816
    v_mfma_f32_16x16x32_bf16 v[116:119], a[136:139], v[100:103], v[116:119]
    v_mfma_f32_16x16x32_bf16 v[120:123], a[136:139], v[104:107], v[120:123]
    s_waitcnt lgkmcnt(2)
    v_mfma_f32_16x16x32_bf16 v[108:111], a[60:63], v[84:87], v[108:111]
    ds_read_b128 v[100:103], v12 offset:32768
    v_mfma_f32_16x16x32_bf16 v[112:115], a[60:63], v[88:91], v[112:115]
    ds_read_b128 v[104:107], v12 offset:34816
    v_mfma_f32_16x16x32_bf16 v[116:119], a[140:143], v[84:87], v[116:119]
    v_mfma_f32_16x16x32_bf16 v[120:123], a[140:143], v[88:91], v[120:123]
    s_waitcnt lgkmcnt(2)
    v_mfma_f32_16x16x32_bf16 v[108:111], a[64:67], v[92:95], v[108:111]
    ds_read_b128 v[84:87], v11 offset:36864
    v_mfma_f32_16x16x32_bf16 v[112:115], a[64:67], v[96:99], v[112:115]
    ds_read_b128 v[88:91], v11 offset:38912
    v_mfma_f32_16x16x32_bf16 v[116:119], a[144:147], v[92:95], v[116:119]
    v_mfma_f32_16x16x32_bf16 v[120:123], a[144:147], v[96:99], v[120:123]
    s_waitcnt lgkmcnt(2)
    v_mfma_f32_16x16x32_bf16 v[108:111], a[68:71], v[100:103], v[108:111]
    ds_read_b128 v[92:95], v12 offset:36864
    v_mfma_f32_16x16x32_bf16 v[112:115], a[68:71], v[104:107], v[112:115]
    ds_read_b128 v[96:99], v12 offset:38912
    v_mfma_f32_16x16x32_bf16 v[116:119], a[148:151], v[100:103], v[116:119]
    v_mfma_f32_16x16x32_bf16 v[120:123], a[148:151], v[104:107], v[120:123]
    s_waitcnt lgkmcnt(0)
    v_mfma_f32_16x16x32_bf16 v[108:111], a[72:75], v[84:87], v[108:111]
    v_add_u32 v11, s49, v11
    v_mfma_f32_16x16x32_bf16 v[112:115], a[72:75], v[88:91], v[112:115]
    v_add_u32 v12, s49, v12
    v_mfma_f32_16x16x32_bf16 v[108:111], a[76:79], v[92:95], v[108:111]
    s_sub_u32 s47, s47, s49
    v_mfma_f32_16x16x32_bf16 v[112:115], a[76:79], v[96:99], v[112:115]
    s_sub_u32 s49, 0, s49
    v_mfma_f32_16x16x32_bf16 v[116:119], a[152:155], v[84:87], v[116:119]
    v_mfma_f32_16x16x32_bf16 v[120:123], a[152:155], v[88:91], v[120:123]
    v_mfma_f32_16x16x32_bf16 v[116:119], a[156:159], v[92:95], v[116:119]
    v_mfma_f32_16x16x32_bf16 v[120:123], a[156:159], v[96:99], v[120:123]
    v_cvt_pk_bf16_f32 v124, v108, v109
    v_cvt_pk_bf16_f32 v125, v110, v111
    v_cvt_pk_bf16_f32 v126, v112, v113
    v_cvt_pk_bf16_f32 v127, v114, v115
    s_nop 0
    v_permlane16_swap_b32 v124, v126
    v_permlane16_swap_b32 v125, v127
    v_cvt_pk_bf16_f32 v128, v116, v117
    v_cvt_pk_bf16_f32 v129, v118, v119
    v_cvt_pk_bf16_f32 v130, v120, v121
    v_cvt_pk_bf16_f32 v131, v122, v123
    s_nop 0
    v_permlane16_swap_b32 v128, v130
    v_permlane16_swap_b32 v129, v131
    ds_write_b128 v140, v[128:131]
    buffer_store_dwordx4 v[124:127], v19, s[4:7], s44 offen sc1
    buffer_store_dwordx4 v[128:131], v19, s[4:7], s45 offen sc1
    s_waitcnt vmcnt(2)
    s_branch L_gw_67c
L_gw_67:
    buffer_load_dword v2, v1, s[8:11], 0 offen sc1
    s_sub_u32 s36, s36, 1
    s_cbranch_scc1 L_exit
    s_waitcnt vmcnt(0)
L_gw_67c:
    v_readfirstlane_b32 s90, v2
    s_nop 0
    s_cmp_eq_u32 s90, 0
    s_cbranch_scc1 L_gw_67
    s_waitcnt vmcnt(2) lgkmcnt(0)
    s_barrier
    s_add_u32 s44, s38, 573440
    s_add_u32 s45, s44, s56
    s_mov_b32 s46, 81920
    v_add_u32 v140, 4096, v137
    ds_read_b128 v[84:87], v11 offset:0
    ds_read_b128 v[88:91], v11 offset:2048
    ds_read_b128 v[92:95], v12 offset:0
    ds_read_b128 v[96:99], v12 offset:2048
    s_lshl_b32 s90, s32, 10
    s_add_u32 m0, s90, s47
    s_waitcnt lgkmcnt(2)
    v_mfma_f32_16x16x32_bf16 v[108:111], a[0:3], v[84:87], 0
    ds_read_b128 v[100:103], v11 offset:4096
    s_and_b32 s50, s37, 3
    v_mfma_f32_16x16x32_bf16 v[112:115], a[0:3], v[88:91], 0
    ds_read_b128 v[104:107], v11 offset:6144
    s_mul_i32 s53, s50, 327680
    v_mfma_f32_16x16x32_bf16 v[116:119], a[80:83], v[84:87], 0
    buffer_load_dwordx4 v10, s[24:27], s46 offen offset:0 lds
    s_add_u32 m0, m0, 3968
    v_mfma_f32_16x16x32_bf16 v[120:123], a[80:83], v[88:91], 0
    s_waitcnt lgkmcnt(2)
    s_add_u32 s51, s37, 2
    v_mfma_f32_16x16x32_bf16 v[108:111], a[4:7], v[92:95], v[108:111]
    ds_read_b128 v[84:87], v12 offset:4096
    s_and_b32 s50, s51, 3
    v_mfma_f32_16x16x32_bf16 v[112:115], a[4:7], v[96:99], v[112:115]
    ds_read_b128 v[88:91], v12 offset:6144
    s_mul_i32 s50, s50, 98304
    v_mfma_f32_16x16x32_bf16 v[116:119], a[84:87], v[92:95], v[116:119]
    buffer_load_dwordx4 v10, s[24:27], s46 offen offset:128 lds
    s_add_u32 m0, m0, 3968
    v_mfma_f32_16x16x32_bf16 v[120:123], a[84:87], v[96:99], v[120:123]
    s_waitcnt lgkmcnt(2)
    s_add_u32 s50, s50, 475136
    v_mfma_f32_16x16x32_bf16 v[108:111], a[8:11], v[100:103], v[108:111]
    ds_read_b128 v[92:95], v11 offset:8192
    s_add_u32 s44, s38, s50
    v_mfma_f32_16x16x32_bf16 v[112:115], a[8:11], v[104:107], v[112:115]
    ds_read_b128 v[96:99], v11 offset:10240
    s_add_u32 s45, s44, s56
    v_mfma_f32_16x16x32_bf16 v[116:119], a[88:91], v[100:103], v[116:119]
    buffer_load_dwordx4 v10, s[24:27], s46 offen offset:256 lds
    s_add_u32 m0, m0, 3968
    v_mfma_f32_16x16x32_bf16 v[120:123], a[88:91], v[104:107], v[120:123]
    s_waitcnt lgkmcnt(2)
    s_and_b32 s50, s51, 3
    v_mfma_f32_16x16x32_bf16 v[108:111], a[12:15], v[84:87], v[108:111]
    ds_read_b128 v[100:103], v12 offset:8192
    s_lshl_b32 s50, s50, 12
    v_mfma_f32_16x16x32_bf16 v[112:115], a[12:15], v[88:91], v[112:115]
    ds_read_b128 v[104:107], v12 offset:10240
    v_add_u32 v140, s50, v137
    v_mfma_f32_16x16x32_bf16 v[116:119], a[92:95], v[84:87], v[116:119]
    buffer_load_dwordx4 v10, s[24:27], s46 offen offset:384 lds
    s_add_u32 m0, m0, 3968
    v_mfma_f32_16x16x32_bf16 v[120:123], a[92:95], v[88:91], v[120:123]
    s_waitcnt lgkmcnt(2)
    s_add_u32 s37, s37, 1
    v_mfma_f32_16x16x32_bf16 v[108:111], a[16:19], v[92:95], v[108:111]
    ds_read_b128 v[84:87], v11 offset:12288
    s_mov_b32 s52, 0
    v_mfma_f32_16x16x32_bf16 v[112:115], a[16:19], v[96:99], v[112:115]
    ds_read_b128 v[88:91], v11 offset:14336
    s_and_b32 s50, s37, 3
    v_mfma_f32_16x16x32_bf16 v[116:119], a[96:99], v[92:95], v[116:119]
    buffer_load_dwordx4 v10, s[24:27], s46 offen offset:512 lds
    s_add_u32 m0, m0, 3968
    v_mfma_f32_16x16x32_bf16 v[120:123], a[96:99], v[96:99], v[120:123]
    s_waitcnt lgkmcnt(2)
    s_mul_i32 s51, s50, 114688
    v_mfma_f32_16x16x32_bf16 v[108:111], a[20:23], v[100:103], v[108:111]
    ds_read_b128 v[92:95], v12 offset:12288
    s_add_u32 s41, s38, s51
    v_mfma_f32_16x16x32_bf16 v[112:115], a[20:23], v[104:107], v[112:115]
    ds_read_b128 v[96:99], v12 offset:14336
    s_and_b32 s54, s37, s55
    v_mfma_f32_16x16x32_bf16 v[116:119], a[100:103], v[100:103], v[116:119]
    buffer_load_dwordx4 v10, s[24:27], s46 offen offset:640 lds
    s_add_u32 m0, m0, 3968
    v_mfma_f32_16x16x32_bf16 v[120:123], a[100:103], v[104:107], v[120:123]
    s_waitcnt lgkmcnt(2)
    s_lshl_b32 s50, s50, 12
    v_mfma_f32_16x16x32_bf16 v[108:111], a[24:27], v[84:87], v[108:111]
    ds_read_b128 v[100:103], v11 offset:16384
    v_add_u32 v141, s50, v138
    v_mfma_f32_16x16x32_bf16 v[112:115], a[24:27], v[88:91], v[112:115]
    ds_read_b128 v[104:107], v11 offset:18432
    s_add_u32 s43, s41, 40960
    v_mfma_f32_16x16x32_bf16 v[116:119], a[104:107], v[84:87], v[116:119]
    buffer_load_dwordx4 v10, s[24:27], s46 offen offset:768 lds
    s_add_u32 m0, m0, 3968
    v_mfma_f32_16x16x32_bf16 v[120:123], a[104:107], v[88:91], v[120:123]
    s_waitcnt lgkmcnt(2)
    v_mfma_f32_16x16x32_bf16 v[108:111], a[28:31], v[92:95], v[108:111]
    ds_read_b128 v[84:87], v12 offset:16384
    v_mfma_f32_16x16x32_bf16 v[112:115], a[28:31], v[96:99], v[112:115]
    ds_read_b128 v[88:91], v12 offset:18432
    v_mfma_f32_16x16x32_bf16 v[116:119], a[108:111], v[92:95], v[116:119]
    buffer_load_dwordx4 v10, s[24:27], s46 offen offset:896 lds
    s_add_u32 m0, m0, 3968
    v_mfma_f32_16x16x32_bf16 v[120:123], a[108:111], v[96:99], v[120:123]
    s_waitcnt lgkmcnt(2)
    v_mfma_f32_16x16x32_bf16 v[108:111], a[32:35], v[100:103], v[108:111]
    ds_read_b128 v[92:95], v11 offset:20480
    v_mfma_f32_16x16x32_bf16 v[112:115], a[32:35], v[104:107], v[112:115]
    ds_read_b128 v[96:99], v11 offset:22528
    v_mfma_f32_16x16x32_bf16 v[116:119], a[112:115], v[100:103], v[116:119]
    buffer_load_dwordx4 v10, s[24:27], s46 offen offset:1024 lds
    s_add_u32 m0, m0, 3968
    v_mfma_f32_16x16x32_bf16 v[120:123], a[112:115], v[104:107], v[120:123]
    s_waitcnt lgkmcnt(2)
    v_mfma_f32_16x16x32_bf16 v[108:111], a[36:39], v[84:87], v[108:111]
    ds_read_b128 v[100:103], v12 offset:20480
    v_mfma_f32_16x16x32_bf16 v[112:115], a[36:39], v[88:91], v[112:115]
    ds_read_b128 v[104:107], v12 offset:22528
    v_mfma_f32_16x16x32_bf16 v[116:119], a[116:119], v[84:87], v[116:119]
    buffer_load_dwordx4 v10, s[24:27], s46 offen offset:1152 lds
    v_mfma_f32_16x16x32_bf16 v[120:123], a[116:119], v[88:91], v[120:123]
    s_waitcnt lgkmcnt(2)
    v_mfma_f32_16x16x32_bf16 v[108:111], a[40:43], v[92:95], v[108:111]
    ds_read_b128 v[84:87], v11 offset:24576
    v_mfma_f32_16x16x32_bf16 v[112:115], a[40:43], v[96:99], v[112:115]
    ds_read_b128 v[88:91], v11 offset:26624
    v_mfma_f32_16x16x32_bf16 v[116:119], a[120:123], v[92:95], v[116:119]
    v_mfma_f32_16x16x32_bf16 v[120:123], a[120:123], v[96:99], v[120:123]
    s_waitcnt lgkmcnt(2)
    v_mfma_f32_16x16x32_bf16 v[108:111], a[44:47], v[100:103], v[108:111]
    ds_read_b128 v[92:95], v12 offset:24576
    v_mfma_f32_16x16x32_bf16 v[112:115], a[44:47], v[104:107], v[112:115]
    ds_read_b128 v[96:99], v12 offset:26624
    v_mfma_f32_16x16x32_bf16 v[116:119], a[124:127], v[100:103], v[116:119]
    v_mfma_f32_16x16x32_bf16 v[120:123], a[124:127], v[104:107], v[120:123]
    s_waitcnt lgkmcnt(2)
    v_mfma_f32_16x16x32_bf16 v[108:111], a[48:51], v[84:87], v[108:111]
    ds_read_b128 v[100:103], v11 offset:28672
    v_mfma_f32_16x16x32_bf16 v[112:115], a[48:51], v[88:91], v[112:115]
    ds_read_b128 v[104:107], v11 offset:30720
    v_mfma_f32_16x16x32_bf16 v[116:119], a[128:131], v[84:87], v[116:119]
    v_mfma_f32_16x16x32_bf16 v[120:123], a[128:131], v[88:91], v[120:123]
    s_waitcnt lgkmcnt(2)
    v_mfma_f32_16x16x32_bf16 v[108:111], a[52:55], v[92:95], v[108:111]
    ds_read_b128 v[84:87], v12 offset:28672
    v_mfma_f32_16x16x32_bf16 v[112:115], a[52:55], v[96:99], v[112:115]
    ds_read_b128 v[88:91], v12 offset:30720
    v_mfma_f32_16x16x32_bf16 v[116:119], a[132:135], v[92:95], v[116:119]
    v_mfma_f32_16x16x32_bf16 v[120:123], a[132:135], v[96:99], v[120:123]
    s_waitcnt lgkmcnt(2)
    v_mfma_f32_16x16x32_bf16 v[108:111], a[56:59], v[100:103], v[108:111]
    ds_read_b128 v[92:95], v11 offset:32768
    v_mfma_f32_16x16x32_bf16 v[112:115], a[56:59], v[104:107], v[112:115]
    ds_read_b128 v[96:99], v11 offset:34816
    v_mfma_f32_16x16x32_bf16 v[116:119], a[136:139], v[100:103], v[116:119]
    v_mfma_f32_16x16x32_bf16 v[120:123], a[136:139], v[104:107], v[120:123]
    s_waitcnt lgkmcnt(2)
    v_mfma_f32_16x16x32_bf16 v[108:111], a[60:63], v[84:87], v[108:111]
    ds_read_b128 v[100:103], v12 offset:32768
    v_mfma_f32_16x16x32_bf16 v[112:115], a[60:63], v[88:91], v[112:115]
    ds_read_b128 v[104:107], v12 offset:34816
    v_mfma_f32_16x16x32_bf16 v[116:119], a[140:143], v[84:87], v[116:119]
    v_mfma_f32_16x16x32_bf16 v[120:123], a[140:143], v[88:91], v[120:123]
    s_waitcnt lgkmcnt(2)
    v_mfma_f32_16x16x32_bf16 v[108:111], a[64:67], v[92:95], v[108:111]
    ds_read_b128 v[84:87], v11 offset:36864
    v_mfma_f32_16x16x32_bf16 v[112:115], a[64:67], v[96:99], v[112:115]
    ds_read_b128 v[88:91], v11 offset:38912
    v_mfma_f32_16x16x32_bf16 v[116:119], a[144:147], v[92:95], v[116:119]
    v_mfma_f32_16x16x32_bf16 v[120:123], a[144:147], v[96:99], v[120:123]
    s_waitcnt lgkmcnt(2)
    v_mfma_f32_16x16x32_bf16 v[108:111], a[68:71], v[100:103], v[108:111]
    ds_read_b128 v[92:95], v12 offset:36864
    v_mfma_f32_16x16x32_bf16 v[112:115], a[68:71], v[104:107], v[112:115]
    ds_read_b128 v[96:99], v12 offset:38912
    v_mfma_f32_16x16x32_bf16 v[116:119], a[148:151], v[100:103], v[116:119]
    v_mfma_f32_16x16x32_bf16 v[120:123], a[148:151], v[104:107], v[120:123]
    s_waitcnt lgkmcnt(0)
    v_mfma_f32_16x16x32_bf16 v[108:111], a[72:75], v[84:87], v[108:111]
    v_add_u32 v11, s49, v11
    v_mfma_f32_16x16x32_bf16 v[112:115], a[72:75], v[88:91], v[112:115]
    v_add_u32 v12, s49, v12
    v_mfma_f32_16x16x32_bf16 v[108:111], a[76:79], v[92:95], v[108:111]
    s_sub_u32 s47, s47, s49
    v_mfma_f32_16x16x32_bf16 v[112:115], a[76:79], v[96:99], v[112:115]
    s_sub_u32 s49, 0, s49
    v_mfma_f32_16x16x32_bf16 v[116:119], a[152:155], v[84:87], v[116:119]
    v_mfma_f32_16x16x32_bf16 v[120:123], a[152:155], v[88:91], v[120:123]
    v_mfma_f32_16x16x32_bf16 v[116:119], a[156:159], v[92:95], v[116:119]
    v_mfma_f32_16x16x32_bf16 v[120:123], a[156:159], v[96:99], v[120:123]
    v_cvt_pk_bf16_f32 v124, v108, v109
    v_cvt_pk_bf16_f32 v125, v110, v111
    v_cvt_pk_bf16_f32 v126, v112, v113
    v_cvt_pk_bf16_f32 v127, v114, v115
    s_nop 0
    v_permlane16_swap_b32 v124, v126
    v_permlane16_swap_b32 v125, v127
    v_cvt_pk_bf16_f32 v128, v116, v117
    v_cvt_pk_bf16_f32 v129, v118, v119
    v_cvt_pk_bf16_f32 v130, v120, v121
    v_cvt_pk_bf16_f32 v131, v122, v123
    s_nop 0
    v_permlane16_swap_b32 v128, v130
    v_permlane16_swap_b32 v129, v131
    ds_write_b128 v140, v[128:131]
    buffer_store_dwordx4 v[124:127], v19, s[4:7], s44 offen sc1
    buffer_store_dwordx4 v[128:131], v19, s[4:7], s45 offen sc1
    s_mov_b32 m0, s48
L_qkv_loop_s:
    s_add_u32 s50, s37, 2
    s_and_b32 s50, s50, 3
    s_mul_i32 s50, s50, 114688
    s_add_u32 s42, s38, s50
    s_add_u32 s50, s37, 3
    s_min_u32 s50, s50, 63
    s_mul_i32 s46, s50, 40960
    s_add_u32 s51, s37, 1
    v_mov_b32 v20, s51
    s_mov_b32 m0, s48
    v_mov_b32 v68, 0
    v_mov_b32 v69, 0
    v_mov_b32 v70, 0
    v_mov_b32 v71, 0
    v_mov_b32 v72, 0
    v_mov_b32 v73, 0
    v_mov_b32 v74, 0
    v_mov_b32 v75, 0
    ds_read_b128 v[156:159], v141
    ds_read_b128 v[160:163], v141 offset:1024
    buffer_load_dwordx4 v13, s[4:7], s41 offen sc1 lds
    buffer_load_dwordx4 v13, s[4:7], s41 offen offset:1024 sc1 lds
    buffer_load_dword v14, s[4:7], s41 offen offset:2048 sc1 lds
    buffer_load_dword v14, s[4:7], s41 offen offset:2304 sc1 lds
L_poll_69:
    buffer_load_dwordx4 v13, s[4:7], s41 offen sc1 lds
    buffer_load_dwordx4 v13, s[4:7], s41 offen offset:1024 sc1 lds
    buffer_load_dword v14, s[4:7], s41 offen offset:2048 sc1 lds
    buffer_load_dword v14, s[4:7], s41 offen offset:2304 sc1 lds
    s_sub_u32 s36, s36, 1
    s_cbranch_scc1 L_exit
    s_waitcnt vmcnt(4)
    ds_read_b32 v18, v15
    s_waitcnt lgkmcnt(0)
    v_cmp_eq_u32 vcc, -1, v18
    s_cbranch_vccnz L_poll_69
    s_barrier
    ds_read_b128 v[28:31], v16 offset:0
    ds_read_b128 v[32:35], v16 offset:1024
    ds_read_b128 v[36:39], v16 offset:2048
    ds_read_b128 v[40:43], v16 offset:3072
    s_waitcnt lgkmcnt(3)
    v_smfmac_f32_16x16x64_bf16 v[68:71], v[28:31], a[0:7], v17
    ds_read_b128 v[44:47], v16 offset:4096
    v_smfmac_f32_16x16x64_bf16 v[72:75], v[28:31], a[80:87], v17
    ds_read_b128 v[48:51], v16 offset:5120
    s_waitcnt lgkmcnt(4)
    v_smfmac_f32_16x16x64_bf16 v[68:71], v[32:35], a[8:15], v17
    ds_read_b128 v[52:55], v16 offset:6144
    v_smfmac_f32_16x16x64_bf16 v[72:75], v[32:35], a[88:95], v17
    ds_read_b128 v[56:59], v16 offset:7168
    s_waitcnt lgkmcnt(5)
    v_smfmac_f32_16x16x64_bf16 v[68:71], v[36:39], a[16:23], v17
    ds_read_b128 v[60:63], v16 offset:8192
    s_waitcnt lgkmcnt(5)
    v_smfmac_f32_16x16x64_bf16 v[68:71], v[40:43], a[24:31], v17
    ds_read_b128 v[64:67], v16 offset:9216
    s_waitcnt lgkmcnt(5)
    v_smfmac_f32_16x16x64_bf16 v[68:71], v[44:47], a[32:39], v17
    s_waitcnt lgkmcnt(4)
    v_smfmac_f32_16x16x64_bf16 v[68:71], v[48:51], a[40:47], v17
    s_waitcnt lgkmcnt(3)
    v_smfmac_f32_16x16x64_bf16 v[68:71], v[52:55], a[48:55], v17
    s_waitcnt lgkmcnt(2)
    v_smfmac_f32_16x16x64_bf16 v[68:71], v[56:59], a[56:63], v17
    s_waitcnt lgkmcnt(1)
    v_smfmac_f32_16x16x64_bf16 v[68:71], v[60:63], a[64:71], v17
    buffer_store_dword v20, v21, s[4:7], s38 offen offset:0 sc1
    s_waitcnt lgkmcnt(0)
    v_smfmac_f32_16x16x64_bf16 v[68:71], v[64:67], a[72:79], v17
L_redo_68:
    v_smfmac_f32_16x16x64_bf16 v[72:75], v[36:39], a[96:103], v17
    v_smfmac_f32_16x16x64_bf16 v[72:75], v[40:43], a[104:111], v17
    v_smfmac_f32_16x16x64_bf16 v[72:75], v[44:47], a[112:119], v17
    v_add_f32 v68, v68, v70
    v_add_f32 v69, v69, v71
    v_smfmac_f32_16x16x64_bf16 v[72:75], v[48:51], a[120:127], v17
    v_cvt_pk_bf16_f32 v132, v68, v69
    ds_write_b32 v23, v132
    v_smfmac_f32_16x16x64_bf16 v[72:75], v[52:55], a[128:135], v17
    v_cmp_u_f32 vcc, v68, v69
    v_smfmac_f32_16x16x64_bf16 v[72:75], v[56:59], a[136:143], v17
    v_smfmac_f32_16x16x64_bf16 v[72:75], v[60:63], a[144:151], v17
    s_cbranch_vccnz L_nan_70
L_cont_71:
    v_smfmac_f32_16x16x64_bf16 v[72:75], v[64:67], a[152:159], v17
    s_waitcnt lgkmcnt(0)
    s_barrier
    ds_read_b64_tr_b16 v[76:77], v24 offset:0
    ds_read_b64_tr_b16 v[78:79], v134 offset:0
    ds_read_b64_tr_b16 v[80:81], v24 offset:1024
    ds_read_b64_tr_b16 v[82:83], v134 offset:1024
    s_cmp_eq_u32 s32, 0
    s_cbranch_scc1 L_w0_72
    s_cmp_eq_u32 s32, 3
    s_cbranch_scc1 L_w3_73
    v_pk_add_f32 v[72:73], v[72:73], v[74:75]
    v_cvt_pk_bf16_f32 v133, v72, v73
    ds_write_b32 v23, v133 offset:4
    s_waitcnt lgkmcnt(3)
    v_mfma_f32_16x16x32_bf16 v[164:167], v[156:159], v[76:79], 0
    s_waitcnt lgkmcnt(1)
    v_mfma_f32_16x16x32_bf16 v[164:167], v[160:163], v[80:83], v[164:167]
    s_waitcnt lgkmcnt(0)
    s_barrier
    s_nop 5
    buffer_store_dwordx4 v[164:167], v135, s[4:7], s41 offen sc1
    ds_read_b128 v[84:87], v11 offset:0
    ds_read_b128 v[88:91], v11 offset:2048
    ds_read_b128 v[92:95], v12 offset:0
    ds_read_b128 v[96:99], v12 offset:2048
    s_branch L_join_74
L_w0_72:
    v_pk_add_f32 v[72:73], v[72:73], v[74:75]
    v_cvt_pk_bf16_f32 v133, v72, v73
    ds_write_b32 v23, v133 offset:4
    s_waitcnt lgkmcnt(0)
    s_barrier
    ds_read_b64_tr_b16 v[76:77], v24 offset:0
    ds_read_b64_tr_b16 v[78:79], v134 offset:0
    ds_read_b64_tr_b16 v[80:81], v24 offset:1024
    ds_read_b64_tr_b16 v[82:83], v134 offset:1024
    s_waitcnt lgkmcnt(2)
    v_mfma_f32_16x16x32_bf16 v[164:167], v[76:79], v[76:79], 0
    s_waitcnt lgkmcnt(0)
    v_mfma_f32_16x16x32_bf16 v[164:167], v[80:83], v[80:83], v[164:167]
    ds_read_b128 v[84:87], v11 offset:0
    ds_read_b128 v[88:91], v11 offset:2048
    ds_read_b128 v[92:95], v12 offset:0
    ds_read_b128 v[96:99], v12 offset:2048
    s_nop 3
    buffer_store_dword v166, v135, s[4:7], s41 offen sc1
    buffer_store_dword v167, v135, s[4:7], s41 offen offset:8 sc1
    s_branch L_join_74
L_w3_73:
    v_pk_add_f32 v[72:73], v[72:73], v[74:75]
    v_cvt_pk_bf16_f32 v133, v72, v73
    ds_write_b32 v23, v133 offset:4
    s_waitcnt lgkmcnt(0)
    s_barrier
    ds_read_b64_tr_b16 v[76:77], v24 offset:0
    ds_read_b64_tr_b16 v[78:79], v134 offset:0
    ds_read_b64_tr_b16 v[80:81], v24 offset:1024
    ds_read_b64_tr_b16 v[82:83], v134 offset:1024
    s_waitcnt lgkmcnt(0)
    ds_read_b128 v[84:87], v11 offset:0
    ds_read_b128 v[88:91], v11 offset:2048
    ds_read_b128 v[92:95], v12 offset:0
    ds_read_b128 v[96:99], v12 offset:2048
    s_waitcnt lgkmcnt(0)
    buffer_store_dwordx4 v[76:79], v136, s[4:7], s43 offen sc1
    buffer_store_dwordx4 v[80:83], v136, s[4:7], s43 offen offset:512 sc1
L_join_74:
    s_cmp_eq_u32 s37, 63
    s_cbranch_scc1 L_end_75
    s_cmp_eq_u32 s37, 0
    s_cbranch_scc1 L_sd_76c
L_sd_76:
    s_lshl_b32 s90, s32, 10
    s_add_u32 m0, s90, s47
    s_waitcnt lgkmcnt(2)
    v_mfma_f32_16x16x32_bf16 v[108:111], a[0:3], v[84:87], 0
    ds_read_b128 v[100:103], v11 offset:4096
    s_and_b32 s50, s37, 3
    v_mfma_f32_16x16x32_bf16 v[112:115], a[0:3], v[88:91], 0
    ds_read_b128 v[104:107], v11 offset:6144
    s_mul_i32 s53, s50, 327680
    v_mfma_f32_16x16x32_bf16 v[116:119], a[80:83], v[84:87], 0
    s_add_u32 s51, s37, 2
    s_and_b32 s50, s51, 3
    v_mfma_f32_16x16x32_bf16 v[120:123], a[80:83], v[88:91], 0
    s_waitcnt lgkmcnt(2)
    s_mul_i32 s50, s50, 98304
    v_mfma_f32_16x16x32_bf16 v[108:111], a[4:7], v[92:95], v[108:111]
    ds_read_b128 v[84:87], v12 offset:4096
    s_add_u32 s50, s50, 475136
    v_mfma_f32_16x16x32_bf16 v[112:115], a[4:7], v[96:99], v[112:115]
    ds_read_b128 v[88:91], v12 offset:6144
    s_add_u32 s44, s38, s50
    v_mfma_f32_16x16x32_bf16 v[116:119], a[84:87], v[92:95], v[116:119]
    s_add_u32 s45, s44, s56
    s_and_b32 s50, s51, 3
    v_mfma_f32_16x16x32_bf16 v[120:123], a[84:87], v[96:99], v[120:123]
    s_waitcnt lgkmcnt(2)
    s_lshl_b32 s50, s50, 12
    v_mfma_f32_16x16x32_bf16 v[108:111], a[8:11], v[100:103], v[108:111]
    ds_read_b128 v[92:95], v11 offset:8192
    v_add_u32 v140, s50, v137
    v_mfma_f32_16x16x32_bf16 v[112:115], a[8:11], v[104:107], v[112:115]
    ds_read_b128 v[96:99], v11 offset:10240
    s_add_u32 s37, s37, 1
    v_mfma_f32_16x16x32_bf16 v[116:119], a[88:91], v[100:103], v[116:119]
    s_mov_b32 s52, 0
    s_and_b32 s50, s37, 3
    v_mfma_f32_16x16x32_bf16 v[120:123], a[88:91], v[104:107], v[120:123]
    s_waitcnt lgkmcnt(2)
    s_mul_i32 s51, s50, 114688
    v_mfma_f32_16x16x32_bf16 v[108:111], a[12:15], v[84:87], v[108:111]
    ds_read_b128 v[100:103], v12 offset:8192
    s_add_u32 s41, s38, s51
    v_mfma_f32_16x16x32_bf16 v[112:115], a[12:15], v[88:91], v[112:115]
    ds_read_b128 v[104:107], v12 offset:10240
    s_and_b32 s54, s37, s55
    v_mfma_f32_16x16x32_bf16 v[116:119], a[92:95], v[84:87], v[116:119]
    buffer_store_dword v22, v150, s[4:7], s42 offen offset:0 sc1
    buffer_store_dword v22, v149, s[4:7], s42 offen offset:0 sc1
    v_mfma_f32_16x16x32_bf16 v[120:123], a[92:95], v[88:91], v[120:123]
    s_waitcnt lgkmcnt(2)
    s_lshl_b32 s50, s50, 12
    v_mfma_f32_16x16x32_bf16 v[108:111], a[16:19], v[92:95], v[108:111]
    ds_read_b128 v[84:87], v11 offset:12288
    v_add_u32 v141, s50, v138
    v_mfma_f32_16x16x32_bf16 v[112:115], a[16:19], v[96:99], v[112:115]
    ds_read_b128 v[88:91], v11 offset:14336
    s_add_u32 s43, s41, 40960
    v_mfma_f32_16x16x32_bf16 v[116:119], a[96:99], v[92:95], v[116:119]
    buffer_store_dword v22, v150, s[4:7], s42 offen offset:256 sc1
    v_mfma_f32_16x16x32_bf16 v[120:123], a[96:99], v[96:99], v[120:123]
    s_waitcnt lgkmcnt(2)
    v_mfma_f32_16x16x32_bf16 v[108:111], a[20:23], v[100:103], v[108:111]
    ds_read_b128 v[92:95], v12 offset:12288
    v_mfma_f32_16x16x32_bf16 v[112:115], a[20:23], v[104:107], v[112:115]
    ds_read_b128 v[96:99], v12 offset:14336
    v_mfma_f32_16x16x32_bf16 v[116:119], a[100:103], v[100:103], v[116:119]
    buffer_load_dwordx4 v10, s[24:27], s46 offen offset:0 lds
    s_add_u32 m0, m0, 3968
    v_mfma_f32_16x16x32_bf16 v[120:123], a[100:103], v[104:107], v[120:123]
    s_waitcnt lgkmcnt(2)
    v_mfma_f32_16x16x32_bf16 v[108:111], a[24:27], v[84:87], v[108:111]
    ds_read_b128 v[100:103], v11 offset:16384
    v_mfma_f32_16x16x32_bf16 v[112:115], a[24:27], v[88:91], v[112:115]
    ds_read_b128 v[104:107], v11 offset:18432
    v_mfma_f32_16x16x32_bf16 v[116:119], a[104:107], v[84:87], v[116:119]
    buffer_load_dwordx4 v10, s[24:27], s46 offen offset:128 lds
    s_add_u32 m0, m0, 3968
    v_mfma_f32_16x16x32_bf16 v[120:123], a[104:107], v[88:91], v[120:123]
    s_waitcnt lgkmcnt(2)
    v_mfma_f32_16x16x32_bf16 v[108:111], a[28:31], v[92:95], v[108:111]
    ds_read_b128 v[84:87], v12 offset:16384
    v_mfma_f32_16x16x32_bf16 v[112:115], a[28:31], v[96:99], v[112:115]
    ds_read_b128 v[88:91], v12 offset:18432
    v_mfma_f32_16x16x32_bf16 v[116:119], a[108:111], v[92:95], v[116:119]
    buffer_load_dwordx4 v10, s[24:27], s46 offen offset:256 lds
    s_add_u32 m0, m0, 3968
    v_mfma_f32_16x16x32_bf16 v[120:123], a[108:111], v[96:99], v[120:123]
    s_waitcnt lgkmcnt(2)
    v_mfma_f32_16x16x32_bf16 v[108:111], a[32:35], v[100:103], v[108:111]
    ds_read_b128 v[92:95], v11 offset:20480
    v_mfma_f32_16x16x32_bf16 v[112:115], a[32:35], v[104:107], v[112:115]
    ds_read_b128 v[96:99], v11 offset:22528
    v_mfma_f32_16x16x32_bf16 v[116:119], a[112:115], v[100:103], v[116:119]
    s_waitcnt vmcnt(6)
    buffer_store_dword v20, v139, s[4:7], s38 offen sc1
    v_mfma_f32_16x16x32_bf16 v[120:123], a[112:115], v[104:107], v[120:123]
    s_waitcnt lgkmcnt(2)
    v_mfma_f32_16x16x32_bf16 v[108:111], a[36:39], v[84:87], v[108:111]
    ds_read_b128 v[100:103], v12 offset:20480
    v_mfma_f32_16x16x32_bf16 v[112:115], a[36:39], v[88:91], v[112:115]
    buffer_load_dword v147, v146, s[4:7], 0 offen sc1
    ds_read_b128 v[104:107], v12 offset:22528
    v_mfma_f32_16x16x32_bf16 v[116:119], a[116:119], v[84:87], v[116:119]
    buffer_load_dwordx4 v10, s[24:27], s46 offen offset:384 lds
    s_add_u32 m0, m0, 3968
    v_mfma_f32_16x16x32_bf16 v[120:123], a[116:119], v[88:91], v[120:123]
    s_waitcnt lgkmcnt(2)
    v_mfma_f32_16x16x32_bf16 v[108:111], a[40:43], v[92:95], v[108:111]
    ds_read_b128 v[84:87], v11 offset:24576
    v_mfma_f32_16x16x32_bf16 v[112:115], a[40:43], v[96:99], v[112:115]
    buffer_load_dword v147, v146, s[4:7], 0 offen sc1
    ds_read_b128 v[88:91], v11 offset:26624
    v_mfma_f32_16x16x32_bf16 v[116:119], a[120:123], v[92:95], v[116:119]
    buffer_load_dwordx4 v10, s[24:27], s46 offen offset:512 lds
    s_add_u32 m0, m0, 3968
    v_mfma_f32_16x16x32_bf16 v[120:123], a[120:123], v[96:99], v[120:123]
    s_waitcnt lgkmcnt(2)
    v_mfma_f32_16x16x32_bf16 v[108:111], a[44:47], v[100:103], v[108:111]
    ds_read_b128 v[92:95], v12 offset:24576
    v_mfma_f32_16x16x32_bf16 v[112:115], a[44:47], v[104:107], v[112:115]
    buffer_load_dword v147, v146, s[4:7], 0 offen sc1
    ds_read_b128 v[96:99], v12 offset:26624
    v_mfma_f32_16x16x32_bf16 v[116:119], a[124:127], v[100:103], v[116:119]
    buffer_load_dwordx4 v10, s[24:27], s46 offen offset:640 lds
    s_add_u32 m0, m0, 3968
    v_mfma_f32_16x16x32_bf16 v[120:123], a[124:127], v[104:107], v[120:123]
    s_waitcnt lgkmcnt(2)
    v_mfma_f32_16x16x32_bf16 v[108:111], a[48:51], v[84:87], v[108:111]
    ds_read_b128 v[100:103], v11 offset:28672
    v_mfma_f32_16x16x32_bf16 v[112:115], a[48:51], v[88:91], v[112:115]
    buffer_load_dword v147, v146, s[4:7], 0 offen sc1
    ds_read_b128 v[104:107], v11 offset:30720
    v_mfma_f32_16x16x32_bf16 v[116:119], a[128:131], v[84:87], v[116:119]
    buffer_load_dwordx4 v10, s[24:27], s46 offen offset:768 lds
    s_add_u32 m0, m0, 3968
    v_mfma_f32_16x16x32_bf16 v[120:123], a[128:131], v[88:91], v[120:123]
    s_waitcnt lgkmcnt(2)
    v_mfma_f32_16x16x32_bf16 v[108:111], a[52:55], v[92:95], v[108:111]
    ds_read_b128 v[84:87], v12 offset:28672
    v_mfma_f32_16x16x32_bf16 v[112:115], a[52:55], v[96:99], v[112:115]
    buffer_load_dword v147, v146, s[4:7], 0 offen sc1
    ds_read_b128 v[88:91], v12 offset:30720
    v_mfma_f32_16x16x32_bf16 v[116:119], a[132:135], v[92:95], v[116:119]
    buffer_load_dwordx4 v10, s[24:27], s46 offen offset:896 lds
    s_add_u32 m0, m0, 3968
    v_mfma_f32_16x16x32_bf16 v[120:123], a[132:135], v[96:99], v[120:123]
    s_waitcnt lgkmcnt(2)
    v_mfma_f32_16x16x32_bf16 v[108:111], a[56:59], v[100:103], v[108:111]
    ds_read_b128 v[92:95], v11 offset:32768
    v_mfma_f32_16x16x32_bf16 v[112:115], a[56:59], v[104:107], v[112:115]
    buffer_load_dword v147, v146, s[4:7], 0 offen sc1
    ds_read_b128 v[96:99], v11 offset:34816
    v_mfma_f32_16x16x32_bf16 v[116:119], a[136:139], v[100:103], v[116:119]
    buffer_load_dwordx4 v10, s[24:27], s46 offen offset:1024 lds
    s_add_u32 m0, m0, 3968
    v_mfma_f32_16x16x32_bf16 v[120:123], a[136:139], v[104:107], v[120:123]
    s_waitcnt lgkmcnt(2)
    v_mfma_f32_16x16x32_bf16 v[108:111], a[60:63], v[84:87], v[108:111]
    ds_read_b128 v[100:103], v12 offset:32768
    v_mfma_f32_16x16x32_bf16 v[112:115], a[60:63], v[88:91], v[112:115]
    buffer_load_dword v147, v146, s[4:7], 0 offen sc1
    ds_read_b128 v[104:107], v12 offset:34816
    v_mfma_f32_16x16x32_bf16 v[116:119], a[140:143], v[84:87], v[116:119]
    buffer_load_dwordx4 v10, s[24:27], s46 offen offset:1152 lds
    v_mfma_f32_16x16x32_bf16 v[120:123], a[140:143], v[88:91], v[120:123]
    s_waitcnt lgkmcnt(2)
    v_mfma_f32_16x16x32_bf16 v[108:111], a[64:67], v[92:95], v[108:111]
    ds_read_b128 v[84:87], v11 offset:36864
    v_mfma_f32_16x16x32_bf16 v[112:115], a[64:67], v[96:99], v[112:115]
L_sp_77:
    s_waitcnt vmcnt(6)
    v_cmp_gt_u32 vcc, s54, v147
    buffer_load_dword v147, v146, s[4:7], 0 offen sc1
    s_sub_u32 s36, s36, 1
    s_cbranch_scc1 L_exit
    s_cbranch_vccz L_sp_77x
    s_waitcnt vmcnt(6)
    v_cmp_gt_u32 vcc, s54, v147
    buffer_load_dword v147, v146, s[4:7], 0 offen sc1
    s_cbranch_vccz L_sp_77x
    s_waitcnt vmcnt(6)
    v_cmp_gt_u32 vcc, s54, v147
    buffer_load_dword v147, v146, s[4:7], 0 offen sc1
    s_cbranch_vccz L_sp_77x
    s_waitcnt vmcnt(6)
    v_cmp_gt_u32 vcc, s54, v147
    buffer_load_dword v147, v146, s[4:7], 0 offen sc1
    s_cbranch_vccnz L_sp_77
L_sp_77x:
    s_barrier
    buffer_load_dwordx4 v[168:171], v142, s[4:7], s53 offen sc1
    ds_read_b128 v[88:91], v11 offset:38912
    v_mfma_f32_16x16x32_bf16 v[116:119], a[144:147], v[92:95], v[116:119]
    v_mfma_f32_16x16x32_bf16 v[120:123], a[144:147], v[96:99], v[120:123]
    s_waitcnt lgkmcnt(2)
    v_mfma_f32_16x16x32_bf16 v[108:111], a[68:71], v[100:103], v[108:111]
    ds_read_b128 v[92:95], v12 offset:36864
    v_mfma_f32_16x16x32_bf16 v[112:115], a[68:71], v[104:107], v[112:115]
    ds_read_b128 v[96:99], v12 offset:38912
    v_mfma_f32_16x16x32_bf16 v[116:119], a[148:151], v[100:103], v[116:119]
    v_mfma_f32_16x16x32_bf16 v[120:123], a[148:151], v[104:107], v[120:123]
    buffer_load_dwordx4 v[172:175], v143, s[4:7], s53 offen sc1
    s_waitcnt lgkmcnt(0)
    v_mfma_f32_16x16x32_bf16 v[108:111], a[72:75], v[84:87], v[108:111]
    v_add_u32 v11, s49, v11
    v_mfma_f32_16x16x32_bf16 v[112:115], a[72:75], v[88:91], v[112:115]
    v_add_u32 v12, s49, v12
    v_mfma_f32_16x16x32_bf16 v[108:111], a[76:79], v[92:95], v[108:111]
    s_sub_u32 s47, s47, s49
    v_mfma_f32_16x16x32_bf16 v[112:115], a[76:79], v[96:99], v[112:115]
    s_sub_u32 s49, 0, s49
    v_mfma_f32_16x16x32_bf16 v[116:119], a[152:155], v[84:87], v[116:119]
    v_mfma_f32_16x16x32_bf16 v[120:123], a[152:155], v[88:91], v[120:123]
    v_mfma_f32_16x16x32_bf16 v[116:119], a[156:159], v[92:95], v[116:119]
    v_mfma_f32_16x16x32_bf16 v[120:123], a[156:159], v[96:99], v[120:123]
    v_cvt_pk_bf16_f32 v124, v108, v109
    v_cvt_pk_bf16_f32 v125, v110, v111
    v_cvt_pk_bf16_f32 v126, v112, v113
    v_cvt_pk_bf16_f32 v127, v114, v115
    s_nop 0
    v_permlane16_swap_b32 v124, v126
    v_permlane16_swap_b32 v125, v127
    v_cvt_pk_bf16_f32 v128, v116, v117
    v_cvt_pk_bf16_f32 v129, v118, v119
    v_cvt_pk_bf16_f32 v130, v120, v121
    v_cvt_pk_bf16_f32 v131, v122, v123
    s_nop 0
    v_permlane16_swap_b32 v128, v130
    v_permlane16_swap_b32 v129, v131
    ds_write_b128 v140, v[128:131]
    buffer_store_dwordx4 v[124:127], v19, s[4:7], s44 offen sc1
    buffer_store_dwordx4 v[128:131], v19, s[4:7], s45 offen sc1
    s_mov_b32 m0, s48
    s_waitcnt vmcnt(3)
    v_mfma_f32_16x16x32_bf16 v[184:187], v[198:201], v[168:171], 0
    v_mfma_f32_16x16x32_bf16 v[188:191], v[196:199], v[168:171], 0
    s_waitcnt vmcnt(2)
    v_mfma_f32_16x16x32_bf16 v[184:187], v[198:201], v[172:175], v[184:187]
    v_mfma_f32_16x16x32_bf16 v[188:191], v[196:199], v[172:175], v[188:191]
    s_nop 4
    v_cmp_u_f32 vcc, v184, v184
    v_cvt_pk_bf16_f32 v192, v184, v185
    v_cvt_pk_bf16_f32 v193, v186, v187
    v_cvt_pk_bf16_f32 v194, v188, v189
    v_cvt_pk_bf16_f32 v195, v190, v191
    s_cbranch_vccnz L_pp_78
L_pc_79:
    buffer_store_dwordx4 v[192:195], v148, s[4:7], s41 offen sc1
    s_barrier
    s_branch L_qkv_loop_s
L_end_75:
    s_waitcnt vmcnt(0) lgkmcnt(0)
    buffer_store_dword v20, v139, s[4:7], s38 offen sc1
    s_endpgm
L_nan_70:
    s_cmp_eq_u32 s52, 1
    s_cbranch_scc1 L_cont_71
    v_lshlrev_b32 v1, 4, v0
L_nan_70r:
    s_mov_b32 s90, s41
    v_mov_b32 v2, 0
    buffer_load_dwordx4 v[28:31], v1, s[4:7], s90 offen sc1
    s_add_u32 s90, s90, 1024
    buffer_load_dwordx4 v[32:35], v1, s[4:7], s90 offen sc1
    s_add_u32 s90, s90, 1024
    buffer_load_dwordx4 v[36:39], v1, s[4:7], s90 offen sc1
    s_add_u32 s90, s90, 1024
    buffer_load_dwordx4 v[40:43], v1, s[4:7], s90 offen sc1
    s_add_u32 s90, s90, 1024
    buffer_load_dwordx4 v[44:47], v1, s[4:7], s90 offen sc1
    s_add_u32 s90, s90, 1024
    buffer_load_dwordx4 v[48:51], v1, s[4:7], s90 offen sc1
    s_add_u32 s90, s90, 1024
    buffer_load_dwordx4 v[52:55], v1, s[4:7], s90 offen sc1
    s_add_u32 s90, s90, 1024
    buffer_load_dwordx4 v[56:59], v1, s[4:7], s90 offen sc1
    s_add_u32 s90, s90, 1024
    buffer_load_dwordx4 v[60:63], v1, s[4:7], s90 offen sc1
    s_add_u32 s90, s90, 1024
    buffer_load_dwordx4 v[64:67], v1, s[4:7], s90 offen sc1
    s_add_u32 s90, s90, 1024
    s_sub_u32 s36, s36, 1
    s_cbranch_scc1 L_exit
    s_waitcnt vmcnt(0) lgkmcnt(0)
    v_max3_u32 v2, v2, v28, v29
    v_max3_u32 v2, v2, v30, v31
    v_max3_u32 v2, v2, v32, v33
    v_max3_u32 v2, v2, v34, v35
    v_max3_u32 v2, v2, v36, v37
    v_max3_u32 v2, v2, v38, v39
    v_max3_u32 v2, v2, v40, v41
    v_max3_u32 v2, v2, v42, v43
    v_max3_u32 v2, v2, v44, v45
    v_max3_u32 v2, v2, v46, v47
    v_max3_u32 v2, v2, v48, v49
    v_max3_u32 v2, v2, v50, v51
    v_max3_u32 v2, v2, v52, v53
    v_max3_u32 v2, v2, v54, v55
    v_max3_u32 v2, v2, v56, v57
    v_max3_u32 v2, v2, v58, v59
    v_max3_u32 v2, v2, v60, v61
    v_max3_u32 v2, v2, v62, v63
    v_max3_u32 v2, v2, v64, v65
    v_max3_u32 v2, v2, v66, v67
    v_cmp_eq_u32 vcc, -1, v2
    s_cbranch_vccnz L_nan_70r
    s_mov_b32 s52, 1
    v_mov_b32 v68, 0
    v_mov_b32 v69, 0
    v_mov_b32 v70, 0
    v_mov_b32 v71, 0
    v_mov_b32 v72, 0
    v_mov_b32 v73, 0
    v_mov_b32 v74, 0
    v_mov_b32 v75, 0
    v_smfmac_f32_16x16x64_bf16 v[68:71], v[28:31], a[0:7], v17
    s_nop 0
    v_smfmac_f32_16x16x64_bf16 v[72:75], v[28:31], a[80:87], v17
    v_smfmac_f32_16x16x64_bf16 v[68:71], v[32:35], a[8:15], v17
    v_smfmac_f32_16x16x64_bf16 v[72:75], v[32:35], a[88:95], v17
    v_smfmac_f32_16x16x64_bf16 v[68:71], v[36:39], a[16:23], v17
    v_smfmac_f32_16x16x64_bf16 v[68:71], v[40:43], a[24:31], v17
    v_smfmac_f32_16x16x64_bf16 v[68:71], v[44:47], a[32:39], v17
    v_smfmac_f32_16x16x64_bf16 v[68:71], v[48:51], a[40:47], v17
    v_smfmac_f32_16x16x64_bf16 v[68:71], v[52:55], a[48:55], v17
    v_smfmac_f32_16x16x64_bf16 v[68:71], v[56:59], a[56:63], v17
    v_smfmac_f32_16x16x64_bf16 v[68:71], v[60:63], a[64:71], v17
    v_smfmac_f32_16x16x64_bf16 v[68:71], v[64:67], a[72:79], v17
    s_nop 3
    s_branch L_redo_68
L_sd_76c:
    v_mov_b32 v5, 460288
L_pf_80:
    buffer_load_dword v6, v5, s[4:7], s38 offen sc1
    v_mov_b32 v3, 204
L_p0_81:
    buffer_load_dword v4, v3, s[8:11], 0 offen sc1
    s_sub_u32 s36, s36, 1
    s_cbranch_scc1 L_exit
    s_waitcnt vmcnt(0)
    v_readfirstlane_b32 s90, v4
    s_nop 0
    s_cmp_eq_u32 s90, 0
    s_cbranch_scc1 L_p0_81
    s_and_b32 s90, s90, 2
    s_lshl_b32 s90, s90, 12
    v_readfirstlane_b32 s91, v6
    s_nop 0
    s_cmp_eq_u32 s91, 0
    s_cbranch_scc1 L_pf_80
    s_and_b32 s91, s91, 2
    s_lshl_b32 s91, s91, 12
    v_add_u32 v142, s91, v142
    v_add_u32 v143, s91, v143
    v_and_b32 v3, s90, v152
    v_xor_b32 v146, v3, v146
    s_branch L_sd_76
L_pp_78:
    buffer_load_dwordx4 v[176:179], v142, s[4:7], s53 offen sc1
    buffer_load_dwordx4 v[180:183], v143, s[4:7], s53 offen sc1
    s_sub_u32 s36, s36, 1
    s_cbranch_scc1 L_exit
    v_max_u32 v151, v168, v169
    v_max3_u32 v151, v151, v170, v171
    v_max3_u32 v151, v151, v172, v173
    v_max3_u32 v151, v151, v174, v175
    v_cmp_eq_u32 vcc, -1, v151
    s_cbranch_vccz L_pc_79
    s_waitcnt vmcnt(1)
    v_mfma_f32_16x16x32_bf16 v[184:187], v[198:201], v[176:179], 0
    v_mfma_f32_16x16x32_bf16 v[188:191], v[196:199], v[176:179], 0
    s_waitcnt vmcnt(0)
    v_mfma_f32_16x16x32_bf16 v[184:187], v[198:201], v[180:183], v[184:187]
    v_mfma_f32_16x16x32_bf16 v[188:191], v[196:199], v[180:183], v[188:191]
    s_nop 4
    v_cmp_u_f32 vcc, v184, v184
    v_cvt_pk_bf16_f32 v192, v184, v185
    v_cvt_pk_bf16_f32 v193, v186, v187
    v_cvt_pk_bf16_f32 v194, v188, v189
    v_cvt_pk_bf16_f32 v195, v190, v191
    s_cbranch_vccnz L_pp_78_1
    s_branch L_pc_79
L_pp_78_1:
    buffer_load_dwordx4 v[168:171], v142, s[4:7], s53 offen sc1
    buffer_load_dwordx4 v[172:175], v143, s[4:7], s53 offen sc1
    s_sub_u32 s36, s36, 1
    s_cbranch_scc1 L_exit
    v_max_u32 v151, v176, v177
    v_max3_u32 v151, v151, v178, v179
    v_max3_u32 v151, v151, v180, v181
    v_max3_u32 v151, v151, v182, v183
    v_cmp_eq_u32 vcc, -1, v151
    s_cbranch_vccz L_pc_79
    s_waitcnt vmcnt(1)
    v_mfma_f32_16x16x32_bf16 v[184:187], v[198:201], v[168:171], 0
    v_mfma_f32_16x16x32_bf16 v[188:191], v[196:199], v[168:171], 0
    s_waitcnt vmcnt(0)
    v_mfma_f32_16x16x32_bf16 v[184:187], v[198:201], v[172:175], v[184:187]
    v_mfma_f32_16x16x32_bf16 v[188:191], v[196:199], v[172:175], v[188:191]
    s_nop 4
    v_cmp_u_f32 vcc, v184, v184
    v_cvt_pk_bf16_f32 v192, v184, v185
    v_cvt_pk_bf16_f32 v193, v186, v187
    v_cvt_pk_bf16_f32 v194, v188, v189
    v_cvt_pk_bf16_f32 v195, v190, v191
    s_cbranch_vccnz L_pp_78
    s_branch L_pc_79
L_v_s:
    s_mov_b32 s12, s78
    s_and_b32 s13, s79, 0xffff
    s_mov_b32 s14, 7864320
    s_mov_b32 s15, 0x20000
    s_sub_u32 s40, s35, 12
    s_lshl_b32 s40, s40, 1
    s_mov_b32 s24, s70
    s_and_b32 s25, s71, 0xffff
    s_mov_b32 s26, 2621440
    s_mov_b32 s27, 0x20000
    v_and_b32 v1, 15, v0
    v_lshrrev_b32 v2, 4, v0
    v_lshrrev_b32 v3, 3, v0
    v_and_b32 v4, 7, v0
    s_lshl_b32 s90, s32, 3
    v_add_u32 v5, s90, v3
    s_and_b32 s91, s32, 1
    s_lshl_b32 s91, s91, 2
    v_and_b32 v6, 2, v3
    v_or_b32 v6, s91, v6
    v_xor_b32 v6, v6, v4
    v_lshlrev_b32 v6, 4, v6
    v_mul_u32_u24 v7, 12288, v5
    s_mul_i32 s92, s34, 1536
    s_lshl_b32 s93, s40, 7
    s_add_u32 s92, s92, s93
    v_add3_u32 v124, v6, v7, s92
    v_lshrrev_b32 v6, 1, v3
    v_or_b32 v6, s91, v6
    v_xor_b32 v6, v6, v4
    v_lshlrev_b32 v6, 4, v6
    v_mul_u32_u24 v7, 1280, v5
    v_add_u32 v10, v6, v7
    s_lshl_b32 s90, s32, 10
    s_add_u32 m0, s90, 81920
    s_mov_b32 s91, 128
    buffer_load_dwordx4 v124, s[12:15], s91 offen nt lds
    s_add_u32 m0, m0, 4096
    s_add_u32 s91, s91, 393216
    buffer_load_dwordx4 v124, s[12:15], s91 offen nt lds
    s_add_u32 m0, m0, 4096
    s_add_u32 s91, s91, 393216
    buffer_load_dwordx4 v124, s[12:15], s91 offen nt lds
    s_add_u32 m0, m0, 4096
    s_add_u32 s91, s91, 393216
    buffer_load_dwordx4 v124, s[12:15], s91 offen nt lds
    s_add_u32 m0, m0, 4096
    s_add_u32 s91, s91, 393216
    buffer_load_dwordx4 v124, s[12:15], s91 offen nt lds
    s_add_u32 m0, m0, 4096
    s_add_u32 s91, s91, 393216
    buffer_load_dwordx4 v124, s[12:15], s91 offen nt lds
    s_add_u32 m0, m0, 4096
    s_add_u32 s91, s91, 393216
    buffer_load_dwordx4 v124, s[12:15], s91 offen nt lds
    s_add_u32 m0, m0, 4096
    s_add_u32 s91, s91, 393216
    buffer_load_dwordx4 v124, s[12:15], s91 offen nt lds
    s_add_u32 m0, m0, 4096
    s_add_u32 s91, s91, 393216
    buffer_load_dwordx4 v124, s[12:15], s91 offen nt lds
    s_add_u32 m0, m0, 4096
    s_add_u32 s91, s91, 393216
    buffer_load_dwordx4 v124, s[12:15], s91 offen nt lds
    s_mul_i32 s60, s40, 86
    s_lshr_b32 s60, s60, 8
    s_mul_i32 s61, s60, 3
    s_sub_u32 s61, s40, s61
    s_add_u32 s90, s40, 1
    s_mul_i32 s62, s90, 86
    s_lshr_b32 s62, s62, 8
    s_mul_i32 s63, s62, 3
    s_sub_u32 s63, s90, s63
    v_lshrrev_b32 v3, 1, v2
    v_and_b32 v5, 1, v2
    s_lshl_b32 s90, s32, 9
    v_lshlrev_b32 v6, 4, v1
    v_lshl_add_u32 v6, v3, 8, v6
    v_add_u32 v6, s90, v6
    s_mul_i32 s90, s60, 12288
    s_lshl_b32 s91, s61, 11
    s_add_u32 s90, s90, s91
    v_mul_u32_u24 v7, 6144, v5
    v_add3_u32 v19, v6, v7, s90
    v_mov_b32 v22, -1
    s_mul_i32 s56, s62, 12288
    s_lshl_b32 s91, s63, 11
    s_add_u32 s56, s56, s91
    s_sub_u32 s56, s56, s90
    s_lshl_b32 s90, s40, 10
    s_lshl_b32 s91, s32, 8
    s_add_u32 s91, s91, s90
    s_add_u32 s91, s91, 25600
    v_lshl_add_u32 v135, v0, 2, s91
    v_and_b32 v6, 60, v0
    v_bfe_u32 v7, v0, 1, 1
    v_or_b32 v6, v6, v7
    v_and_b32 v7, 1, v0
    v_lshl_or_b32 v6, v7, 1, v6
    s_and_b32 s90, s32, 1
    s_lshl_b32 s90, s90, 3
    v_xor_b32 v6, s90, v6
    v_lshl_add_u32 v134, v6, 2, s91
    s_lshl_b32 s90, s60, 5
    s_lshl_b32 s91, s62, 5
    v_mov_b32 v3, s90
    v_mov_b32 v4, s91
    v_mov_b32 v6, s61
    v_mov_b32 v7, s63
    v_cmp_eq_u32 vcc, 0, v0
    s_nop 1
    v_cndmask_b32 v3, v4, v3, vcc
    v_cndmask_b32 v6, v7, v6, vcc
    v_add_u32 v4, v3, v6
    s_cmp_eq_u32 s32, 3
    s_cselect_b32 s91, 0, 2146435072
    s_add_u32 s91, s91, 462348
    v_lshl_add_u32 v21, v4, 2, s91
    v_lshl_add_u32 v4, v6, 2, v3
    s_lshl_b32 s91, s32, 2
    s_add_u32 s91, s91, 458752
    v_lshl_add_u32 v136, v4, 2, s91
    v_cmp_gt_u32 vcc, 2, v0
    v_mov_b32 v9, 2146435072
    s_nop 0
    v_cndmask_b32 v21, v9, v21, vcc
    v_cndmask_b32 v136, v9, v136, vcc
    s_lshl_b32 s90, s40, 1
    s_add_u32 s90, s90, s32
    s_sub_u32 s90, s90, 4
    s_lshl_b32 s90, s90, 11
    s_cmp_eq_u32 s40, 0
    s_cselect_b32 s90, 2146435072, s90
    v_lshl_add_u32 v137, v0, 4, s90
    v_mov_b32 v138, 460800
    v_lshrrev_b32 v3, 2, v1
    v_and_b32 v4, 3, v1
    v_and_b32 v5, 1, v2
    v_lshl_add_u32 v6, v2, 3, v3
    v_lshlrev_b32 v6, 7, v6
    v_and_b32 v7, 2, v3
    v_lshl_or_b32 v7, v5, 2, v7
    v_lshrrev_b32 v8, 1, v4
    s_lshl_b32 s90, s32, 1
    v_or_b32 v8, s90, v8
    v_xor_b32 v7, v7, v8
    v_lshl_add_u32 v6, v7, 4, v6
    v_and_b32 v7, 1, v4
    v_lshl_add_u32 v6, v7, 3, v6
    v_add_u32 v125, 81920, v6
    v_add_u32 v126, 40960, v6
    v_add_u32 v127, 122880, v6
    s_lshl_b32 s90, s32, 9
    s_add_u32 s90, s90, 133120
    v_and_b32 v7, 2, v1
    v_cmp_ne_u32 vcc, 0, v7
    v_mov_b32 v6, 0x4444
    v_mov_b32 v8, 0xeeee
    v_cndmask_b32 v17, v6, v8, vcc
    v_lshlrev_b32 v6, 4, v0
    v_add_u32 v16, 122880, v6
    s_mul_i32 s90, s32, 2560
    v_lshl_add_u32 v13, v0, 4, s90
    v_lshl_add_u32 v14, v0, 2, s90
    s_add_u32 s48, s90, 122880
    v_mul_u32_u24 v6, 40, v0
    v_add_u32 v15, s48, v6
    v_mul_u32_u24 v6, 164, v0
    v_min_u32 v6, 10236, v6
    v_add_u32 v25, 122880, v6
    v_lshrrev_b32 v6, 3, v1
    v_lshlrev_b32 v6, 10, v6
    v_and_b32 v7, 7, v1
    v_lshl_add_u32 v6, v7, 7, v6
    v_lshrrev_b32 v7, 1, v1
    v_xor_b32 v7, v7, v2
    v_lshl_add_u32 v11, v7, 4, v6
    v_xor_b32 v12, 64, v11
    v_and_b32 v3, 1, v0
    v_lshlrev_b32 v3, 12, v3
    v_bfe_u32 v5, v0, 2, 1
    v_lshl_add_u32 v3, v5, 13, v3
    v_bfe_u32 v4, v0, 1, 1
    v_lshl_add_u32 v3, v4, 14, v3
    s_lshl_b32 s91, s34, 9
    s_add_u32 s91, s91, 1933312
    s_xor_b32 s55, s32, 3
    s_or_b32 s55, s55, s40
    s_cselect_b32 s91, 2146435072, s91
    v_add_u32 v140, s91, v3
    v_cmp_gt_u32 vcc, 8, v0
    v_mov_b32 v9, 2146435072
    s_nop 0
    v_cndmask_b32 v140, v9, v140, vcc
    v_cmp_ne_u32 vcc, s34, v0
    v_mov_b32 v9, 2146435072
    s_nop 0
    v_cndmask_b32 v140, v9, v140, vcc
    s_lshr_b32 s91, s34, 2
    v_cmp_eq_u32 vcc, s91, v5
    s_nop 1
    v_cndmask_b32 v141, v9, v140, vcc
    v_cndmask_b32 v140, v140, v9, vcc
    v_and_b32 v3, 7, v0
    v_min_u32 v3, 5, v3
    v_bfe_u32 v4, v0, 3, 2
    v_lshlrev_b32 v4, 7, v4
    v_lshl_add_u32 v3, v3, 2, v4
    v_add_u32 v142, 462368, v3
    v_min_u32 v3, 39, v0
    v_lshlrev_b32 v3, 2, v3
    v_add_u32 v142, 460544, v3
    s_lshl_b32 s93, s40, 1
    s_add_u32 s93, s93, s32
    s_lshl_b32 s93, s93, 1
    s_sub_u32 s93, s93, 8
    s_nop 0
    s_lshr_b32 s90, s93, 2
    s_lshl_b32 s90, s90, 15
    s_and_b32 s92, s93, 3
    s_lshl_b32 s92, s92, 10
    s_add_u32 s90, s90, s92
    v_mov_b32 v5, s34
    v_and_b32 v6, 7, v1
    v_lshlrev_b32 v6, 4, v6
    v_lshl_add_u32 v6, v5, 7, v6
    v_lshrrev_b32 v7, 3, v1
    v_lshl_add_u32 v6, v7, 12, v6
    v_lshrrev_b32 v5, 1, v2
    v_lshl_add_u32 v6, v5, 13, v6
    v_and_b32 v5, 1, v2
    v_lshl_add_u32 v6, v5, 14, v6
    v_add_u32 v143, s90, v6
    s_and_b32 s91, s34, 1
    s_lshl_b32 s91, s91, 12
    s_add_u32 s90, s90, s91
    s_lshr_b32 s91, s34, 2
    s_lshl_b32 s91, s91, 13
    s_add_u32 s90, s90, s91
    s_and_b32 s91, s34, 2
    s_lshl_b32 s91, s91, 13
    s_add_u32 s90, s90, s91
    v_lshl_add_u32 v144, v0, 4, s90
    s_lshl_b32 s91, s93, 10
    s_add_u32 s91, s91, 884736
    v_lshl_add_u32 v146, v0, 4, s91
    s_lshr_b32 s91, s34, 1
    s_mul_i32 s91, s91, 10240
    s_lshl_b32 s92, s93, 5
    s_add_u32 s91, s91, s92
    s_and_b32 s92, s34, 1
    s_mul_i32 s92, s92, 40960
    s_add_u32 s91, s91, s92
    s_add_u32 s91, s91, 1280
    v_mul_u32_u24 v6, 2560, v2
    v_lshl_add_u32 v6, v1, 1, v6
    v_add_u32 v145, s91, v6
    v_cmp_gt_u32 s[58:59], 8, v1
    v_and_b32 v5, 1, v1
    v_lshrrev_b32 v6, 3, v1
    v_lshl_add_u32 v5, v5, 1, v6
    v_bfe_u32 v6, v1, 2, 1
    v_cmp_ne_u32 vcc, 0, v6
    v_mov_b32 v6, 0x3f80
    v_mov_b32 v7, 0x3f800000
    v_cndmask_b32 v6, v6, v7, vcc
    v_cmp_eq_u32 vcc, 0, v5
    s_nop 1
    v_cndmask_b32 v7, 0, v6, vcc
    v_accvgpr_write_b32 a160, v7
    v_cmp_eq_u32 vcc, 1, v5
    s_nop 1
    v_cndmask_b32 v7, 0, v6, vcc
    v_accvgpr_write_b32 a161, v7
    v_cmp_eq_u32 vcc, 2, v5
    s_nop 1
    v_cndmask_b32 v7, 0, v6, vcc
    v_accvgpr_write_b32 a162, v7
    v_cmp_eq_u32 vcc, 3, v5
    s_nop 1
    v_cndmask_b32 v7, 0, v6, vcc
    v_accvgpr_write_b32 a163, v7
    s_cmp_lg_u32 s40, 0
    s_cselect_b64 vcc, -1, 0
    v_cndmask_b32 v143, v9, v143, vcc
    v_cndmask_b32 v144, v9, v144, vcc
    v_cndmask_b32 v145, v9, v145, vcc
    v_cndmask_b32 v146, v9, v146, vcc
    s_lshl_b32 s90, s32, 10
    s_add_u32 m0, s90, 40960
    s_mov_b32 s91, 0
    buffer_load_dwordx4 v124, s[12:15], s91 offen nt lds
    s_add_u32 m0, m0, 4096
    s_add_u32 s91, s91, 393216
    buffer_load_dwordx4 v124, s[12:15], s91 offen nt lds
    s_add_u32 m0, m0, 4096
    s_add_u32 s91, s91, 393216
    buffer_load_dwordx4 v124, s[12:15], s91 offen nt lds
    s_add_u32 m0, m0, 4096
    s_add_u32 s91, s91, 393216
    buffer_load_dwordx4 v124, s[12:15], s91 offen nt lds
    s_add_u32 m0, m0, 4096
    s_add_u32 s91, s91, 393216
    buffer_load_dwordx4 v124, s[12:15], s91 offen nt lds
    s_add_u32 m0, m0, 4096
    s_add_u32 s91, s91, 393216
    buffer_load_dwordx4 v124, s[12:15], s91 offen nt lds
    s_add_u32 m0, m0, 4096
    s_add_u32 s91, s91, 393216
    buffer_load_dwordx4 v124, s[12:15], s91 offen nt lds
    s_add_u32 m0, m0, 4096
    s_add_u32 s91, s91, 393216
    buffer_load_dwordx4 v124, s[12:15], s91 offen nt lds
    s_add_u32 m0, m0, 4096
    s_add_u32 s91, s91, 393216
    buffer_load_dwordx4 v124, s[12:15], s91 offen nt lds
    s_add_u32 m0, m0, 4096
    s_add_u32 s91, s91, 393216
    buffer_load_dwordx4 v124, s[12:15], s91 offen nt lds
    s_lshl_b32 s90, s32, 10
    s_add_u32 m0, s90, 122880
    s_mov_b32 s91, 3932288
    buffer_load_dwordx4 v124, s[12:15], s91 offen nt lds
    s_add_u32 m0, m0, 4096
    s_add_u32 s91, s91, 393216
    buffer_load_dwordx4 v124, s[12:15], s91 offen nt lds
    s_add_u32 m0, m0, 4096
    s_add_u32 s91, s91, 393216
    buffer_load_dwordx4 v124, s[12:15], s91 offen nt lds
    s_add_u32 m0, m0, 4096
    s_add_u32 s91, s91, 393216
    buffer_load_dwordx4 v124, s[12:15], s91 offen nt lds
    s_add_u32 m0, m0, 4096
    s_add_u32 s91, s91, 393216
    buffer_load_dwordx4 v124, s[12:15], s91 offen nt lds
    s_add_u32 m0, m0, 4096
    s_add_u32 s91, s91, 393216
    buffer_load_dwordx4 v124, s[12:15], s91 offen nt lds
    s_add_u32 m0, m0, 4096
    s_add_u32 s91, s91, 393216
    buffer_load_dwordx4 v124, s[12:15], s91 offen nt lds
    s_add_u32 m0, m0, 4096
    s_add_u32 s91, s91, 393216
    buffer_load_dwordx4 v124, s[12:15], s91 offen nt lds
    s_add_u32 m0, m0, 4096
    s_add_u32 s91, s91, 393216
    buffer_load_dwordx4 v124, s[12:15], s91 offen nt lds
    s_add_u32 m0, m0, 4096
    s_add_u32 s91, s91, 393216
    buffer_load_dwordx4 v124, s[12:15], s91 offen nt lds
    s_mov_b32 s46, 0
    s_lshl_b32 s90, s32, 10
    s_add_u32 m0, s90, 0
    s_nop 0
    buffer_load_dwordx4 v10, s[24:27], s46 offen offset:0 lds
    s_add_u32 m0, m0, 3968
    s_nop 0
    buffer_load_dwordx4 v10, s[24:27], s46 offen offset:128 lds
    s_add_u32 m0, m0, 3968
    s_nop 0
    buffer_load_dwordx4 v10, s[24:27], s46 offen offset:256 lds
    s_add_u32 m0, m0, 3968
    s_nop 0
    buffer_load_dwordx4 v10, s[24:27], s46 offen offset:384 lds
    s_add_u32 m0, m0, 3968
    s_nop 0
    buffer_load_dwordx4 v10, s[24:27], s46 offen offset:512 lds
    s_add_u32 m0, m0, 3968
    s_nop 0
    buffer_load_dwordx4 v10, s[24:27], s46 offen offset:640 lds
    s_add_u32 m0, m0, 3968
    s_nop 0
    buffer_load_dwordx4 v10, s[24:27], s46 offen offset:768 lds
    s_add_u32 m0, m0, 3968
    s_nop 0
    buffer_load_dwordx4 v10, s[24:27], s46 offen offset:896 lds
    s_add_u32 m0, m0, 3968
    s_nop 0
    buffer_load_dwordx4 v10, s[24:27], s46 offen offset:1024 lds
    s_add_u32 m0, m0, 3968
    s_nop 0
    buffer_load_dwordx4 v10, s[24:27], s46 offen offset:1152 lds
    s_waitcnt vmcnt(30)
    s_barrier
    ds_read_b64_tr_b16 a[80:81], v125 offset:0
    ds_read_b64_tr_b16 a[82:83], v125 offset:512
    ds_read_b64_tr_b16 a[84:85], v125 offset:4096
    ds_read_b64_tr_b16 a[86:87], v125 offset:4608
    ds_read_b64_tr_b16 a[88:89], v125 offset:8192
    ds_read_b64_tr_b16 a[90:91], v125 offset:8704
    ds_read_b64_tr_b16 a[92:93], v125 offset:12288
    ds_read_b64_tr_b16 a[94:95], v125 offset:12800
    ds_read_b64_tr_b16 a[96:97], v125 offset:16384
    ds_read_b64_tr_b16 a[98:99], v125 offset:16896
    ds_read_b64_tr_b16 a[100:101], v125 offset:20480
    ds_read_b64_tr_b16 a[102:103], v125 offset:20992
    ds_read_b64_tr_b16 a[104:105], v125 offset:24576
    ds_read_b64_tr_b16 a[106:107], v125 offset:25088
    ds_read_b64_tr_b16 a[108:109], v125 offset:28672
    ds_read_b64_tr_b16 a[110:111], v125 offset:29184
    ds_read_b64_tr_b16 a[112:113], v125 offset:32768
    ds_read_b64_tr_b16 a[114:115], v125 offset:33280
    ds_read_b64_tr_b16 a[116:117], v125 offset:36864
    ds_read_b64_tr_b16 a[118:119], v125 offset:37376
    s_waitcnt lgkmcnt(0)
    s_barrier
    s_lshl_b32 s90, s32, 10
    s_add_u32 m0, s90, 81920
    s_mov_b32 s91, 3932160
    buffer_load_dwordx4 v124, s[12:15], s91 offen nt lds
    s_add_u32 m0, m0, 4096
    s_add_u32 s91, s91, 393216
    buffer_load_dwordx4 v124, s[12:15], s91 offen nt lds
    s_add_u32 m0, m0, 4096
    s_add_u32 s91, s91, 393216
    buffer_load_dwordx4 v124, s[12:15], s91 offen nt lds
    s_add_u32 m0, m0, 4096
    s_add_u32 s91, s91, 393216
    buffer_load_dwordx4 v124, s[12:15], s91 offen nt lds
    s_add_u32 m0, m0, 4096
    s_add_u32 s91, s91, 393216
    buffer_load_dwordx4 v124, s[12:15], s91 offen nt lds
    s_add_u32 m0, m0, 4096
    s_add_u32 s91, s91, 393216
    buffer_load_dwordx4 v124, s[12:15], s91 offen nt lds
    s_add_u32 m0, m0, 4096
    s_add_u32 s91, s91, 393216
    buffer_load_dwordx4 v124, s[12:15], s91 offen nt lds
    s_add_u32 m0, m0, 4096
    s_add_u32 s91, s91, 393216
    buffer_load_dwordx4 v124, s[12:15], s91 offen nt lds
    s_add_u32 m0, m0, 4096
    s_add_u32 s91, s91, 393216
    buffer_load_dwordx4 v124, s[12:15], s91 offen nt lds
    s_add_u32 m0, m0, 4096
    s_add_u32 s91, s91, 393216
    buffer_load_dwordx4 v124, s[12:15], s91 offen nt lds
    s_waitcnt vmcnt(30)
    s_barrier
    ds_read_b64_tr_b16 a[0:1], v126 offset:0
    ds_read_b64_tr_b16 a[2:3], v126 offset:512
    ds_read_b64_tr_b16 a[4:5], v126 offset:4096
    ds_read_b64_tr_b16 a[6:7], v126 offset:4608
    ds_read_b64_tr_b16 a[8:9], v126 offset:8192
    ds_read_b64_tr_b16 a[10:11], v126 offset:8704
    ds_read_b64_tr_b16 a[12:13], v126 offset:12288
    ds_read_b64_tr_b16 a[14:15], v126 offset:12800
    ds_read_b64_tr_b16 a[16:17], v126 offset:16384
    ds_read_b64_tr_b16 a[18:19], v126 offset:16896
    ds_read_b64_tr_b16 a[20:21], v126 offset:20480
    ds_read_b64_tr_b16 a[22:23], v126 offset:20992
    ds_read_b64_tr_b16 a[24:25], v126 offset:24576
    ds_read_b64_tr_b16 a[26:27], v126 offset:25088
    ds_read_b64_tr_b16 a[28:29], v126 offset:28672
    ds_read_b64_tr_b16 a[30:31], v126 offset:29184
    ds_read_b64_tr_b16 a[32:33], v126 offset:32768
    ds_read_b64_tr_b16 a[34:35], v126 offset:33280
    ds_read_b64_tr_b16 a[36:37], v126 offset:36864
    ds_read_b64_tr_b16 a[38:39], v126 offset:37376
    s_waitcnt lgkmcnt(0)
    s_barrier
    s_mov_b32 s46, 40960
    s_lshl_b32 s90, s32, 10
    s_add_u32 m0, s90, 40960
    s_nop 0
    buffer_load_dwordx4 v10, s[24:27], s46 offen offset:0 lds
    s_add_u32 m0, m0, 3968
    s_nop 0
    buffer_load_dwordx4 v10, s[24:27], s46 offen offset:128 lds
    s_add_u32 m0, m0, 3968
    s_nop 0
    buffer_load_dwordx4 v10, s[24:27], s46 offen offset:256 lds
    s_add_u32 m0, m0, 3968
    s_nop 0
    buffer_load_dwordx4 v10, s[24:27], s46 offen offset:384 lds
    s_add_u32 m0, m0, 3968
    s_nop 0
    buffer_load_dwordx4 v10, s[24:27], s46 offen offset:512 lds
    s_add_u32 m0, m0, 3968
    s_nop 0
    buffer_load_dwordx4 v10, s[24:27], s46 offen offset:640 lds
    s_add_u32 m0, m0, 3968
    s_nop 0
    buffer_load_dwordx4 v10, s[24:27], s46 offen offset:768 lds
    s_add_u32 m0, m0, 3968
    s_nop 0
    buffer_load_dwordx4 v10, s[24:27], s46 offen offset:896 lds
    s_add_u32 m0, m0, 3968
    s_nop 0
    buffer_load_dwordx4 v10, s[24:27], s46 offen offset:1024 lds
    s_add_u32 m0, m0, 3968
    s_nop 0
    buffer_load_dwordx4 v10, s[24:27], s46 offen offset:1152 lds
    s_waitcnt vmcnt(30)
    s_barrier
    ds_read_b64_tr_b16 a[120:121], v127 offset:0
    ds_read_b64_tr_b16 a[122:123], v127 offset:512
    ds_read_b64_tr_b16 a[124:125], v127 offset:4096
    ds_read_b64_tr_b16 a[126:127], v127 offset:4608
    ds_read_b64_tr_b16 a[128:129], v127 offset:8192
    ds_read_b64_tr_b16 a[130:131], v127 offset:8704
    ds_read_b64_tr_b16 a[132:133], v127 offset:12288
    ds_read_b64_tr_b16 a[134:135], v127 offset:12800
    ds_read_b64_tr_b16 a[136:137], v127 offset:16384
    ds_read_b64_tr_b16 a[138:139], v127 offset:16896
    ds_read_b64_tr_b16 a[140:141], v127 offset:20480
    ds_read_b64_tr_b16 a[142:143], v127 offset:20992
    ds_read_b64_tr_b16 a[144:145], v127 offset:24576
    ds_read_b64_tr_b16 a[146:147], v127 offset:25088
    ds_read_b64_tr_b16 a[148:149], v127 offset:28672
    ds_read_b64_tr_b16 a[150:151], v127 offset:29184
    ds_read_b64_tr_b16 a[152:153], v127 offset:32768
    ds_read_b64_tr_b16 a[154:155], v127 offset:33280
    ds_read_b64_tr_b16 a[156:157], v127 offset:36864
    ds_read_b64_tr_b16 a[158:159], v127 offset:37376
    s_waitcnt lgkmcnt(0)
    s_waitcnt vmcnt(10)
    s_barrier
    ds_read_b64_tr_b16 a[40:41], v125 offset:0
    ds_read_b64_tr_b16 a[42:43], v125 offset:512
    ds_read_b64_tr_b16 a[44:45], v125 offset:4096
    ds_read_b64_tr_b16 a[46:47], v125 offset:4608
    ds_read_b64_tr_b16 a[48:49], v125 offset:8192
    ds_read_b64_tr_b16 a[50:51], v125 offset:8704
    ds_read_b64_tr_b16 a[52:53], v125 offset:12288
    ds_read_b64_tr_b16 a[54:55], v125 offset:12800
    ds_read_b64_tr_b16 a[56:57], v125 offset:16384
    ds_read_b64_tr_b16 a[58:59], v125 offset:16896
    ds_read_b64_tr_b16 a[60:61], v125 offset:20480
    ds_read_b64_tr_b16 a[62:63], v125 offset:20992
    ds_read_b64_tr_b16 a[64:65], v125 offset:24576
    ds_read_b64_tr_b16 a[66:67], v125 offset:25088
    ds_read_b64_tr_b16 a[68:69], v125 offset:28672
    ds_read_b64_tr_b16 a[70:71], v125 offset:29184
    ds_read_b64_tr_b16 a[72:73], v125 offset:32768
    ds_read_b64_tr_b16 a[74:75], v125 offset:33280
    ds_read_b64_tr_b16 a[76:77], v125 offset:36864
    ds_read_b64_tr_b16 a[78:79], v125 offset:37376
    s_waitcnt lgkmcnt(0)
    s_mov_b32 s49, 40960
    s_mov_b32 s47, 40960
    s_mov_b32 s37, -1
    s_add_u32 s44, s38, 65536
    s_add_u32 s45, s44, s56
    s_mov_b32 s46, 40960
    v_mov_b32 v1, 196
    buffer_load_dword v2, v1, s[8:11], 0 offen sc1
    ds_read_b128 v[84:87], v11 offset:0
    ds_read_b128 v[88:91], v11 offset:2048
    ds_read_b128 v[92:95], v12 offset:0
    ds_read_b128 v[96:99], v12 offset:2048
    s_waitcnt lgkmcnt(2)
    v_mfma_f32_16x16x32_bf16 v[108:111], a[0:3], v[84:87], 0
    ds_read_b128 v[100:103], v11 offset:4096
    v_mfma_f32_16x16x32_bf16 v[112:115], a[0:3], v[88:91], 0
    ds_read_b128 v[104:107], v11 offset:6144
    v_mfma_f32_16x16x32_bf16 v[116:119], a[80:83], v[84:87], 0
    v_mfma_f32_16x16x32_bf16 v[120:123], a[80:83], v[88:91], 0
    s_waitcnt lgkmcnt(2)
    v_mfma_f32_16x16x32_bf16 v[108:111], a[4:7], v[92:95], v[108:111]
    ds_read_b128 v[84:87], v12 offset:4096
    v_mfma_f32_16x16x32_bf16 v[112:115], a[4:7], v[96:99], v[112:115]
    ds_read_b128 v[88:91], v12 offset:6144
    v_mfma_f32_16x16x32_bf16 v[116:119], a[84:87], v[92:95], v[116:119]
    v_mfma_f32_16x16x32_bf16 v[120:123], a[84:87], v[96:99], v[120:123]
    s_waitcnt lgkmcnt(2)
    v_mfma_f32_16x16x32_bf16 v[108:111], a[8:11], v[100:103], v[108:111]
    ds_read_b128 v[92:95], v11 offset:8192
    v_mfma_f32_16x16x32_bf16 v[112:115], a[8:11], v[104:107], v[112:115]
    ds_read_b128 v[96:99], v11 offset:10240
    v_mfma_f32_16x16x32_bf16 v[116:119], a[88:91], v[100:103], v[116:119]
    v_mfma_f32_16x16x32_bf16 v[120:123], a[88:91], v[104:107], v[120:123]
    s_waitcnt lgkmcnt(2)
    v_mfma_f32_16x16x32_bf16 v[108:111], a[12:15], v[84:87], v[108:111]
    ds_read_b128 v[100:103], v12 offset:8192
    v_mfma_f32_16x16x32_bf16 v[112:115], a[12:15], v[88:91], v[112:115]
    ds_read_b128 v[104:107], v12 offset:10240
    v_mfma_f32_16x16x32_bf16 v[116:119], a[92:95], v[84:87], v[116:119]
    v_mfma_f32_16x16x32_bf16 v[120:123], a[92:95], v[88:91], v[120:123]
    s_waitcnt lgkmcnt(2)
    v_mfma_f32_16x16x32_bf16 v[108:111], a[16:19], v[92:95], v[108:111]
    ds_read_b128 v[84:87], v11 offset:12288
    v_mfma_f32_16x16x32_bf16 v[112:115], a[16:19], v[96:99], v[112:115]
    ds_read_b128 v[88:91], v11 offset:14336
    v_mfma_f32_16x16x32_bf16 v[116:119], a[96:99], v[92:95], v[116:119]
    v_mfma_f32_16x16x32_bf16 v[120:123], a[96:99], v[96:99], v[120:123]
    s_waitcnt lgkmcnt(2)
    v_mfma_f32_16x16x32_bf16 v[108:111], a[20:23], v[100:103], v[108:111]
    ds_read_b128 v[92:95], v12 offset:12288
    v_mfma_f32_16x16x32_bf16 v[112:115], a[20:23], v[104:107], v[112:115]
    ds_read_b128 v[96:99], v12 offset:14336
    v_mfma_f32_16x16x32_bf16 v[116:119], a[100:103], v[100:103], v[116:119]
    v_mfma_f32_16x16x32_bf16 v[120:123], a[100:103], v[104:107], v[120:123]
    s_waitcnt lgkmcnt(2)
    v_mfma_f32_16x16x32_bf16 v[108:111], a[24:27], v[84:87], v[108:111]
    ds_read_b128 v[100:103], v11 offset:16384
    v_mfma_f32_16x16x32_bf16 v[112:115], a[24:27], v[88:91], v[112:115]
    ds_read_b128 v[104:107], v11 offset:18432
    v_mfma_f32_16x16x32_bf16 v[116:119], a[104:107], v[84:87], v[116:119]
    v_mfma_f32_16x16x32_bf16 v[120:123], a[104:107], v[88:91], v[120:123]
    s_waitcnt lgkmcnt(2)
    v_mfma_f32_16x16x32_bf16 v[108:111], a[28:31], v[92:95], v[108:111]
    ds_read_b128 v[84:87], v12 offset:16384
    v_mfma_f32_16x16x32_bf16 v[112:115], a[28:31], v[96:99], v[112:115]
    ds_read_b128 v[88:91], v12 offset:18432
    v_mfma_f32_16x16x32_bf16 v[116:119], a[108:111], v[92:95], v[116:119]
    v_mfma_f32_16x16x32_bf16 v[120:123], a[108:111], v[96:99], v[120:123]
    s_waitcnt lgkmcnt(2)
    v_mfma_f32_16x16x32_bf16 v[108:111], a[32:35], v[100:103], v[108:111]
    ds_read_b128 v[92:95], v11 offset:20480
    v_mfma_f32_16x16x32_bf16 v[112:115], a[32:35], v[104:107], v[112:115]
    ds_read_b128 v[96:99], v11 offset:22528
    v_mfma_f32_16x16x32_bf16 v[116:119], a[112:115], v[100:103], v[116:119]
    v_mfma_f32_16x16x32_bf16 v[120:123], a[112:115], v[104:107], v[120:123]
    s_waitcnt lgkmcnt(2)
    v_mfma_f32_16x16x32_bf16 v[108:111], a[36:39], v[84:87], v[108:111]
    ds_read_b128 v[100:103], v12 offset:20480
    v_mfma_f32_16x16x32_bf16 v[112:115], a[36:39], v[88:91], v[112:115]
    ds_read_b128 v[104:107], v12 offset:22528
    v_mfma_f32_16x16x32_bf16 v[116:119], a[116:119], v[84:87], v[116:119]
    v_mfma_f32_16x16x32_bf16 v[120:123], a[116:119], v[88:91], v[120:123]
    s_waitcnt lgkmcnt(2)
    v_mfma_f32_16x16x32_bf16 v[108:111], a[40:43], v[92:95], v[108:111]
    ds_read_b128 v[84:87], v11 offset:24576
    v_mfma_f32_16x16x32_bf16 v[112:115], a[40:43], v[96:99], v[112:115]
    ds_read_b128 v[88:91], v11 offset:26624
    v_mfma_f32_16x16x32_bf16 v[116:119], a[120:123], v[92:95], v[116:119]
    v_mfma_f32_16x16x32_bf16 v[120:123], a[120:123], v[96:99], v[120:123]
    s_waitcnt lgkmcnt(2)
    v_mfma_f32_16x16x32_bf16 v[108:111], a[44:47], v[100:103], v[108:111]
    ds_read_b128 v[92:95], v12 offset:24576
    v_mfma_f32_16x16x32_bf16 v[112:115], a[44:47], v[104:107], v[112:115]
    ds_read_b128 v[96:99], v12 offset:26624
    v_mfma_f32_16x16x32_bf16 v[116:119], a[124:127], v[100:103], v[116:119]
    v_mfma_f32_16x16x32_bf16 v[120:123], a[124:127], v[104:107], v[120:123]
    s_waitcnt lgkmcnt(2)
    v_mfma_f32_16x16x32_bf16 v[108:111], a[48:51], v[84:87], v[108:111]
    ds_read_b128 v[100:103], v11 offset:28672
    v_mfma_f32_16x16x32_bf16 v[112:115], a[48:51], v[88:91], v[112:115]
    ds_read_b128 v[104:107], v11 offset:30720
    v_mfma_f32_16x16x32_bf16 v[116:119], a[128:131], v[84:87], v[116:119]
    v_mfma_f32_16x16x32_bf16 v[120:123], a[128:131], v[88:91], v[120:123]
    s_waitcnt lgkmcnt(2)
    v_mfma_f32_16x16x32_bf16 v[108:111], a[52:55], v[92:95], v[108:111]
    ds_read_b128 v[84:87], v12 offset:28672
    v_mfma_f32_16x16x32_bf16 v[112:115], a[52:55], v[96:99], v[112:115]
    ds_read_b128 v[88:91], v12 offset:30720
    v_mfma_f32_16x16x32_bf16 v[116:119], a[132:135], v[92:95], v[116:119]
    v_mfma_f32_16x16x32_bf16 v[120:123], a[132:135], v[96:99], v[120:123]
    s_waitcnt lgkmcnt(2)
    v_mfma_f32_16x16x32_bf16 v[108:111], a[56:59], v[100:103], v[108:111]
    ds_read_b128 v[92:95], v11 offset:32768
    v_mfma_f32_16x16x32_bf16 v[112:115], a[56:59], v[104:107], v[112:115]
    ds_read_b128 v[96:99], v11 offset:34816
    v_mfma_f32_16x16x32_bf16 v[116:119], a[136:139], v[100:103], v[116:119]
    v_mfma_f32_16x16x32_bf16 v[120:123], a[136:139], v[104:107], v[120:123]
    s_waitcnt lgkmcnt(2)
    v_mfma_f32_16x16x32_bf16 v[108:111], a[60:63], v[84:87], v[108:111]
    ds_read_b128 v[100:103], v12 offset:32768
    v_mfma_f32_16x16x32_bf16 v[112:115], a[60:63], v[88:91], v[112:115]
    ds_read_b128 v[104:107], v12 offset:34816
    v_mfma_f32_16x16x32_bf16 v[116:119], a[140:143], v[84:87], v[116:119]
    v_mfma_f32_16x16x32_bf16 v[120:123], a[140:143], v[88:91], v[120:123]
    s_waitcnt lgkmcnt(2)
    v_mfma_f32_16x16x32_bf16 v[108:111], a[64:67], v[92:95], v[108:111]
    ds_read_b128 v[84:87], v11 offset:36864
    v_mfma_f32_16x16x32_bf16 v[112:115], a[64:67], v[96:99], v[112:115]
    ds_read_b128 v[88:91], v11 offset:38912
    v_mfma_f32_16x16x32_bf16 v[116:119], a[144:147], v[92:95], v[116:119]
    v_mfma_f32_16x16x32_bf16 v[120:123], a[144:147], v[96:99], v[120:123]
    s_waitcnt lgkmcnt(2)
    v_mfma_f32_16x16x32_bf16 v[108:111], a[68:71], v[100:103], v[108:111]
    ds_read_b128 v[92:95], v12 offset:36864
    v_mfma_f32_16x16x32_bf16 v[112:115], a[68:71], v[104:107], v[112:115]
    ds_read_b128 v[96:99], v12 offset:38912
    v_mfma_f32_16x16x32_bf16 v[116:119], a[148:151], v[100:103], v[116:119]
    v_mfma_f32_16x16x32_bf16 v[120:123], a[148:151], v[104:107], v[120:123]
    s_waitcnt lgkmcnt(0)
    v_mfma_f32_16x16x32_bf16 v[108:111], a[72:75], v[84:87], v[108:111]
    v_add_u32 v11, s49, v11
    v_mfma_f32_16x16x32_bf16 v[112:115], a[72:75], v[88:91], v[112:115]
    v_add_u32 v12, s49, v12
    v_mfma_f32_16x16x32_bf16 v[108:111], a[76:79], v[92:95], v[108:111]
    s_sub_u32 s47, s47, s49
    v_mfma_f32_16x16x32_bf16 v[112:115], a[76:79], v[96:99], v[112:115]
    s_sub_u32 s49, 0, s49
    v_mfma_f32_16x16x32_bf16 v[116:119], a[152:155], v[84:87], v[116:119]
    v_mfma_f32_16x16x32_bf16 v[120:123], a[152:155], v[88:91], v[120:123]
    v_mfma_f32_16x16x32_bf16 v[116:119], a[156:159], v[92:95], v[116:119]
    v_mfma_f32_16x16x32_bf16 v[120:123], a[156:159], v[96:99], v[120:123]
    v_cvt_pk_bf16_f32 v124, v108, v109
    v_cvt_pk_bf16_f32 v125, v110, v111
    v_cvt_pk_bf16_f32 v126, v112, v113
    v_cvt_pk_bf16_f32 v127, v114, v115
    s_nop 0
    v_permlane16_swap_b32 v124, v126
    v_permlane16_swap_b32 v125, v127
    v_cvt_pk_bf16_f32 v128, v116, v117
    v_cvt_pk_bf16_f32 v129, v118, v119
    v_cvt_pk_bf16_f32 v130, v120, v121
    v_cvt_pk_bf16_f32 v131, v122, v123
    s_nop 0
    v_permlane16_swap_b32 v128, v130
    v_permlane16_swap_b32 v129, v131
    buffer_store_dwordx4 v[124:127], v19, s[4:7], s44 offen sc1
    buffer_store_dwordx4 v[128:131], v19, s[4:7], s45 offen sc1
    s_waitcnt vmcnt(2)
    s_branch L_gw_82c
L_gw_82:
    buffer_load_dword v2, v1, s[8:11], 0 offen sc1
    s_sub_u32 s36, s36, 1
    s_cbranch_scc1 L_exit
    s_waitcnt vmcnt(0)
L_gw_82c:
    v_readfirstlane_b32 s90, v2
    s_nop 0
    s_cmp_eq_u32 s90, 0
    s_cbranch_scc1 L_gw_82
    s_waitcnt vmcnt(2) lgkmcnt(0)
    s_barrier
    s_add_u32 s44, s38, 180224
    s_add_u32 s45, s44, s56
    s_mov_b32 s46, 81920
    v_mov_b32 v20, 1
    ds_read_b128 v[84:87], v11 offset:0
    ds_read_b128 v[88:91], v11 offset:2048
    ds_read_b128 v[92:95], v12 offset:0
    ds_read_b128 v[96:99], v12 offset:2048
    s_lshl_b32 s90, s32, 10
    s_add_u32 m0, s90, s47
    s_waitcnt lgkmcnt(2)
    v_mfma_f32_16x16x32_bf16 v[108:111], a[0:3], v[84:87], 0
    ds_read_b128 v[100:103], v11 offset:4096
    v_mfma_f32_16x16x32_bf16 v[112:115], a[0:3], v[88:91], 0
    ds_read_b128 v[104:107], v11 offset:6144
    v_mfma_f32_16x16x32_bf16 v[116:119], a[80:83], v[84:87], 0
    buffer_load_dwordx4 v10, s[24:27], s46 offen offset:0 lds
    s_add_u32 m0, m0, 3968
    v_mfma_f32_16x16x32_bf16 v[120:123], a[80:83], v[88:91], 0
    s_waitcnt lgkmcnt(2)
    v_mfma_f32_16x16x32_bf16 v[108:111], a[4:7], v[92:95], v[108:111]
    ds_read_b128 v[84:87], v12 offset:4096
    v_mfma_f32_16x16x32_bf16 v[112:115], a[4:7], v[96:99], v[112:115]
    ds_read_b128 v[88:91], v12 offset:6144
    v_mfma_f32_16x16x32_bf16 v[116:119], a[84:87], v[92:95], v[116:119]
    buffer_load_dwordx4 v10, s[24:27], s46 offen offset:128 lds
    s_add_u32 m0, m0, 3968
    v_mfma_f32_16x16x32_bf16 v[120:123], a[84:87], v[96:99], v[120:123]
    s_waitcnt lgkmcnt(2)
    v_mfma_f32_16x16x32_bf16 v[108:111], a[8:11], v[100:103], v[108:111]
    ds_read_b128 v[92:95], v11 offset:8192
    v_mfma_f32_16x16x32_bf16 v[112:115], a[8:11], v[104:107], v[112:115]
    ds_read_b128 v[96:99], v11 offset:10240
    v_mfma_f32_16x16x32_bf16 v[116:119], a[88:91], v[100:103], v[116:119]
    buffer_load_dwordx4 v10, s[24:27], s46 offen offset:256 lds
    s_add_u32 m0, m0, 3968
    v_mfma_f32_16x16x32_bf16 v[120:123], a[88:91], v[104:107], v[120:123]
    s_waitcnt lgkmcnt(2)
    v_mfma_f32_16x16x32_bf16 v[108:111], a[12:15], v[84:87], v[108:111]
    ds_read_b128 v[100:103], v12 offset:8192
    v_mfma_f32_16x16x32_bf16 v[112:115], a[12:15], v[88:91], v[112:115]
    ds_read_b128 v[104:107], v12 offset:10240
    v_mfma_f32_16x16x32_bf16 v[116:119], a[92:95], v[84:87], v[116:119]
    buffer_load_dwordx4 v10, s[24:27], s46 offen offset:384 lds
    s_add_u32 m0, m0, 3968
    v_mfma_f32_16x16x32_bf16 v[120:123], a[92:95], v[88:91], v[120:123]
    s_waitcnt lgkmcnt(2)
    v_mfma_f32_16x16x32_bf16 v[108:111], a[16:19], v[92:95], v[108:111]
    ds_read_b128 v[84:87], v11 offset:12288
    v_mfma_f32_16x16x32_bf16 v[112:115], a[16:19], v[96:99], v[112:115]
    ds_read_b128 v[88:91], v11 offset:14336
    v_mfma_f32_16x16x32_bf16 v[116:119], a[96:99], v[92:95], v[116:119]
    buffer_load_dwordx4 v10, s[24:27], s46 offen offset:512 lds
    s_add_u32 m0, m0, 3968
    v_mfma_f32_16x16x32_bf16 v[120:123], a[96:99], v[96:99], v[120:123]
    s_waitcnt lgkmcnt(2)
    v_mfma_f32_16x16x32_bf16 v[108:111], a[20:23], v[100:103], v[108:111]
    ds_read_b128 v[92:95], v12 offset:12288
    v_mfma_f32_16x16x32_bf16 v[112:115], a[20:23], v[104:107], v[112:115]
    ds_read_b128 v[96:99], v12 offset:14336
    v_mfma_f32_16x16x32_bf16 v[116:119], a[100:103], v[100:103], v[116:119]
    s_waitcnt vmcnt(5)
    buffer_store_dword v20, v136, s[4:7], s38 offen sc1
    v_mfma_f32_16x16x32_bf16 v[120:123], a[100:103], v[104:107], v[120:123]
    s_waitcnt lgkmcnt(2)
    v_mfma_f32_16x16x32_bf16 v[108:111], a[24:27], v[84:87], v[108:111]
    ds_read_b128 v[100:103], v11 offset:16384
    v_mfma_f32_16x16x32_bf16 v[112:115], a[24:27], v[88:91], v[112:115]
    ds_read_b128 v[104:107], v11 offset:18432
    v_mfma_f32_16x16x32_bf16 v[116:119], a[104:107], v[84:87], v[116:119]
    buffer_load_dwordx4 v10, s[24:27], s46 offen offset:640 lds
    s_add_u32 m0, m0, 3968
    v_mfma_f32_16x16x32_bf16 v[120:123], a[104:107], v[88:91], v[120:123]
    s_waitcnt lgkmcnt(2)
    v_mfma_f32_16x16x32_bf16 v[108:111], a[28:31], v[92:95], v[108:111]
    ds_read_b128 v[84:87], v12 offset:16384
    v_mfma_f32_16x16x32_bf16 v[112:115], a[28:31], v[96:99], v[112:115]
    ds_read_b128 v[88:91], v12 offset:18432
    v_mfma_f32_16x16x32_bf16 v[116:119], a[108:111], v[92:95], v[116:119]
    buffer_load_dwordx4 v10, s[24:27], s46 offen offset:768 lds
    s_add_u32 m0, m0, 3968
    v_mfma_f32_16x16x32_bf16 v[120:123], a[108:111], v[96:99], v[120:123]
    s_waitcnt lgkmcnt(2)
    v_mfma_f32_16x16x32_bf16 v[108:111], a[32:35], v[100:103], v[108:111]
    ds_read_b128 v[92:95], v11 offset:20480
    v_mfma_f32_16x16x32_bf16 v[112:115], a[32:35], v[104:107], v[112:115]
    ds_read_b128 v[96:99], v11 offset:22528
    v_mfma_f32_16x16x32_bf16 v[116:119], a[112:115], v[100:103], v[116:119]
    buffer_load_dwordx4 v10, s[24:27], s46 offen offset:896 lds
    s_add_u32 m0, m0, 3968
    v_mfma_f32_16x16x32_bf16 v[120:123], a[112:115], v[104:107], v[120:123]
    s_waitcnt lgkmcnt(2)
    v_mfma_f32_16x16x32_bf16 v[108:111], a[36:39], v[84:87], v[108:111]
    ds_read_b128 v[100:103], v12 offset:20480
    v_mfma_f32_16x16x32_bf16 v[112:115], a[36:39], v[88:91], v[112:115]
    ds_read_b128 v[104:107], v12 offset:22528
    v_mfma_f32_16x16x32_bf16 v[116:119], a[116:119], v[84:87], v[116:119]
    buffer_load_dwordx4 v10, s[24:27], s46 offen offset:1024 lds
    s_add_u32 m0, m0, 3968
    v_mfma_f32_16x16x32_bf16 v[120:123], a[116:119], v[88:91], v[120:123]
    s_waitcnt lgkmcnt(2)
    v_mfma_f32_16x16x32_bf16 v[108:111], a[40:43], v[92:95], v[108:111]
    ds_read_b128 v[84:87], v11 offset:24576
    v_mfma_f32_16x16x32_bf16 v[112:115], a[40:43], v[96:99], v[112:115]
    ds_read_b128 v[88:91], v11 offset:26624
    v_mfma_f32_16x16x32_bf16 v[116:119], a[120:123], v[92:95], v[116:119]
    buffer_load_dwordx4 v10, s[24:27], s46 offen offset:1152 lds
    v_mfma_f32_16x16x32_bf16 v[120:123], a[120:123], v[96:99], v[120:123]
    s_waitcnt lgkmcnt(2)
    v_mfma_f32_16x16x32_bf16 v[108:111], a[44:47], v[100:103], v[108:111]
    ds_read_b128 v[92:95], v12 offset:24576
    v_mfma_f32_16x16x32_bf16 v[112:115], a[44:47], v[104:107], v[112:115]
    ds_read_b128 v[96:99], v12 offset:26624
    v_mfma_f32_16x16x32_bf16 v[116:119], a[124:127], v[100:103], v[116:119]
    v_mfma_f32_16x16x32_bf16 v[120:123], a[124:127], v[104:107], v[120:123]
    s_waitcnt lgkmcnt(2)
    v_mfma_f32_16x16x32_bf16 v[108:111], a[48:51], v[84:87], v[108:111]
    ds_read_b128 v[100:103], v11 offset:28672
    v_mfma_f32_16x16x32_bf16 v[112:115], a[48:51], v[88:91], v[112:115]
    ds_read_b128 v[104:107], v11 offset:30720
    v_mfma_f32_16x16x32_bf16 v[116:119], a[128:131], v[84:87], v[116:119]
    v_mfma_f32_16x16x32_bf16 v[120:123], a[128:131], v[88:91], v[120:123]
    s_waitcnt lgkmcnt(2)
    v_mfma_f32_16x16x32_bf16 v[108:111], a[52:55], v[92:95], v[108:111]
    ds_read_b128 v[84:87], v12 offset:28672
    v_mfma_f32_16x16x32_bf16 v[112:115], a[52:55], v[96:99], v[112:115]
    ds_read_b128 v[88:91], v12 offset:30720
    v_mfma_f32_16x16x32_bf16 v[116:119], a[132:135], v[92:95], v[116:119]
    v_mfma_f32_16x16x32_bf16 v[120:123], a[132:135], v[96:99], v[120:123]
    s_waitcnt lgkmcnt(2)
    v_mfma_f32_16x16x32_bf16 v[108:111], a[56:59], v[100:103], v[108:111]
    ds_read_b128 v[92:95], v11 offset:32768
    v_mfma_f32_16x16x32_bf16 v[112:115], a[56:59], v[104:107], v[112:115]
    ds_read_b128 v[96:99], v11 offset:34816
    v_mfma_f32_16x16x32_bf16 v[116:119], a[136:139], v[100:103], v[116:119]
    v_mfma_f32_16x16x32_bf16 v[120:123], a[136:139], v[104:107], v[120:123]
    s_waitcnt lgkmcnt(2)
    v_mfma_f32_16x16x32_bf16 v[108:111], a[60:63], v[84:87], v[108:111]
    ds_read_b128 v[100:103], v12 offset:32768
    v_mfma_f32_16x16x32_bf16 v[112:115], a[60:63], v[88:91], v[112:115]
    ds_read_b128 v[104:107], v12 offset:34816
    v_mfma_f32_16x16x32_bf16 v[116:119], a[140:143], v[84:87], v[116:119]
    v_mfma_f32_16x16x32_bf16 v[120:123], a[140:143], v[88:91], v[120:123]
    s_waitcnt lgkmcnt(2)
    v_mfma_f32_16x16x32_bf16 v[108:111], a[64:67], v[92:95], v[108:111]
    ds_read_b128 v[84:87], v11 offset:36864
    v_mfma_f32_16x16x32_bf16 v[112:115], a[64:67], v[96:99], v[112:115]
    ds_read_b128 v[88:91], v11 offset:38912
    v_mfma_f32_16x16x32_bf16 v[116:119], a[144:147], v[92:95], v[116:119]
    v_mfma_f32_16x16x32_bf16 v[120:123], a[144:147], v[96:99], v[120:123]
    s_waitcnt lgkmcnt(2)
    v_mfma_f32_16x16x32_bf16 v[108:111], a[68:71], v[100:103], v[108:111]
    ds_read_b128 v[92:95], v12 offset:36864
    v_mfma_f32_16x16x32_bf16 v[112:115], a[68:71], v[104:107], v[112:115]
    ds_read_b128 v[96:99], v12 offset:38912
    v_mfma_f32_16x16x32_bf16 v[116:119], a[148:151], v[100:103], v[116:119]
    v_mfma_f32_16x16x32_bf16 v[120:123], a[148:151], v[104:107], v[120:123]
    s_waitcnt lgkmcnt(0)
    v_mfma_f32_16x16x32_bf16 v[108:111], a[72:75], v[84:87], v[108:111]
    v_add_u32 v11, s49, v11
    v_mfma_f32_16x16x32_bf16 v[112:115], a[72:75], v[88:91], v[112:115]
    v_add_u32 v12, s49, v12
    v_mfma_f32_16x16x32_bf16 v[108:111], a[76:79], v[92:95], v[108:111]
    s_sub_u32 s47, s47, s49
    v_mfma_f32_16x16x32_bf16 v[112:115], a[76:79], v[96:99], v[112:115]
    s_sub_u32 s49, 0, s49
    v_mfma_f32_16x16x32_bf16 v[116:119], a[152:155], v[84:87], v[116:119]
    v_mfma_f32_16x16x32_bf16 v[120:123], a[152:155], v[88:91], v[120:123]
    v_mfma_f32_16x16x32_bf16 v[116:119], a[156:159], v[92:95], v[116:119]
    v_mfma_f32_16x16x32_bf16 v[120:123], a[156:159], v[96:99], v[120:123]
    v_cvt_pk_bf16_f32 v124, v108, v109
    v_cvt_pk_bf16_f32 v125, v110, v111
    v_cvt_pk_bf16_f32 v126, v112, v113
    v_cvt_pk_bf16_f32 v127, v114, v115
    s_nop 0
    v_permlane16_swap_b32 v124, v126
    v_permlane16_swap_b32 v125, v127
    v_cvt_pk_bf16_f32 v128, v116, v117
    v_cvt_pk_bf16_f32 v129, v118, v119
    v_cvt_pk_bf16_f32 v130, v120, v121
    v_cvt_pk_bf16_f32 v131, v122, v123
    s_nop 0
    v_permlane16_swap_b32 v128, v130
    v_permlane16_swap_b32 v129, v131
    buffer_store_dwordx4 v[124:127], v19, s[4:7], s44 offen sc1
    buffer_store_dwordx4 v[128:131], v19, s[4:7], s45 offen sc1
    s_waitcnt vmcnt(2) lgkmcnt(0)
    s_barrier
    s_add_u32 s44, s38, 294912
    s_add_u32 s45, s44, s56
    s_mov_b32 s46, 122880
    v_mov_b32 v20, 2
    ds_read_b128 v[84:87], v11 offset:0
    ds_read_b128 v[88:91], v11 offset:2048
    ds_read_b128 v[92:95], v12 offset:0
    ds_read_b128 v[96:99], v12 offset:2048
    s_lshl_b32 s90, s32, 10
    s_add_u32 m0, s90, s47
    s_waitcnt lgkmcnt(2)
    v_mfma_f32_16x16x32_bf16 v[108:111], a[0:3], v[84:87], 0
    ds_read_b128 v[100:103], v11 offset:4096
    s_add_u32 s51, s37, 3
    v_mfma_f32_16x16x32_bf16 v[112:115], a[0:3], v[88:91], 0
    ds_read_b128 v[104:107], v11 offset:6144
    s_and_b32 s50, s51, 3
    v_mfma_f32_16x16x32_bf16 v[116:119], a[80:83], v[84:87], 0
    buffer_load_dwordx4 v10, s[24:27], s46 offen offset:0 lds
    s_add_u32 m0, m0, 3968
    v_mfma_f32_16x16x32_bf16 v[120:123], a[80:83], v[88:91], 0
    s_waitcnt lgkmcnt(2)
    s_mul_i32 s50, s50, 114688
    v_mfma_f32_16x16x32_bf16 v[108:111], a[4:7], v[92:95], v[108:111]
    ds_read_b128 v[84:87], v12 offset:4096
    s_add_u32 s50, s50, 65536
    v_mfma_f32_16x16x32_bf16 v[112:115], a[4:7], v[96:99], v[112:115]
    ds_read_b128 v[88:91], v12 offset:6144
    s_add_u32 s44, s38, s50
    v_mfma_f32_16x16x32_bf16 v[116:119], a[84:87], v[92:95], v[116:119]
    buffer_load_dwordx4 v10, s[24:27], s46 offen offset:128 lds
    s_add_u32 m0, m0, 3968
    v_mfma_f32_16x16x32_bf16 v[120:123], a[84:87], v[96:99], v[120:123]
    s_waitcnt lgkmcnt(2)
    s_add_u32 s45, s44, s56
    v_mfma_f32_16x16x32_bf16 v[108:111], a[8:11], v[100:103], v[108:111]
    ds_read_b128 v[92:95], v11 offset:8192
    s_add_u32 s37, s37, 1
    v_mfma_f32_16x16x32_bf16 v[112:115], a[8:11], v[104:107], v[112:115]
    ds_read_b128 v[96:99], v11 offset:10240
    s_mov_b32 s52, 0
    v_mfma_f32_16x16x32_bf16 v[116:119], a[88:91], v[100:103], v[116:119]
    buffer_load_dwordx4 v10, s[24:27], s46 offen offset:256 lds
    s_add_u32 m0, m0, 3968
    v_mfma_f32_16x16x32_bf16 v[120:123], a[88:91], v[104:107], v[120:123]
    s_waitcnt lgkmcnt(2)
    s_and_b32 s50, s37, 3
    v_mfma_f32_16x16x32_bf16 v[108:111], a[12:15], v[84:87], v[108:111]
    ds_read_b128 v[100:103], v12 offset:8192
    s_mul_i32 s51, s50, 114688
    v_mfma_f32_16x16x32_bf16 v[112:115], a[12:15], v[88:91], v[112:115]
    ds_read_b128 v[104:107], v12 offset:10240
    s_add_u32 s41, s38, s51
    v_mfma_f32_16x16x32_bf16 v[116:119], a[92:95], v[84:87], v[116:119]
    buffer_load_dwordx4 v10, s[24:27], s46 offen offset:384 lds
    s_add_u32 m0, m0, 3968
    v_mfma_f32_16x16x32_bf16 v[120:123], a[92:95], v[88:91], v[120:123]
    s_waitcnt lgkmcnt(2)
    v_mfma_f32_16x16x32_bf16 v[108:111], a[16:19], v[92:95], v[108:111]
    ds_read_b128 v[84:87], v11 offset:12288
    v_mfma_f32_16x16x32_bf16 v[112:115], a[16:19], v[96:99], v[112:115]
    ds_read_b128 v[88:91], v11 offset:14336
    v_mfma_f32_16x16x32_bf16 v[116:119], a[96:99], v[92:95], v[116:119]
    buffer_load_dwordx4 v10, s[24:27], s46 offen offset:512 lds
    s_add_u32 m0, m0, 3968
    v_mfma_f32_16x16x32_bf16 v[120:123], a[96:99], v[96:99], v[120:123]
    s_waitcnt lgkmcnt(2)
    v_mfma_f32_16x16x32_bf16 v[108:111], a[20:23], v[100:103], v[108:111]
    ds_read_b128 v[92:95], v12 offset:12288
    v_mfma_f32_16x16x32_bf16 v[112:115], a[20:23], v[104:107], v[112:115]
    ds_read_b128 v[96:99], v12 offset:14336
    v_mfma_f32_16x16x32_bf16 v[116:119], a[100:103], v[100:103], v[116:119]
    s_waitcnt vmcnt(5)
    buffer_store_dword v20, v136, s[4:7], s38 offen sc1
    v_mfma_f32_16x16x32_bf16 v[120:123], a[100:103], v[104:107], v[120:123]
    s_waitcnt lgkmcnt(2)
    v_mfma_f32_16x16x32_bf16 v[108:111], a[24:27], v[84:87], v[108:111]
    ds_read_b128 v[100:103], v11 offset:16384
    v_mfma_f32_16x16x32_bf16 v[112:115], a[24:27], v[88:91], v[112:115]
    ds_read_b128 v[104:107], v11 offset:18432
    v_mfma_f32_16x16x32_bf16 v[116:119], a[104:107], v[84:87], v[116:119]
    buffer_load_dwordx4 v10, s[24:27], s46 offen offset:640 lds
    s_add_u32 m0, m0, 3968
    v_mfma_f32_16x16x32_bf16 v[120:123], a[104:107], v[88:91], v[120:123]
    s_waitcnt lgkmcnt(2)
    v_mfma_f32_16x16x32_bf16 v[108:111], a[28:31], v[92:95], v[108:111]
    ds_read_b128 v[84:87], v12 offset:16384
    v_mfma_f32_16x16x32_bf16 v[112:115], a[28:31], v[96:99], v[112:115]
    ds_read_b128 v[88:91], v12 offset:18432
    v_mfma_f32_16x16x32_bf16 v[116:119], a[108:111], v[92:95], v[116:119]
    buffer_load_dwordx4 v10, s[24:27], s46 offen offset:768 lds
    s_add_u32 m0, m0, 3968
    v_mfma_f32_16x16x32_bf16 v[120:123], a[108:111], v[96:99], v[120:123]
    s_waitcnt lgkmcnt(2)
    v_mfma_f32_16x16x32_bf16 v[108:111], a[32:35], v[100:103], v[108:111]
    ds_read_b128 v[92:95], v11 offset:20480
    v_mfma_f32_16x16x32_bf16 v[112:115], a[32:35], v[104:107], v[112:115]
    ds_read_b128 v[96:99], v11 offset:22528
    v_mfma_f32_16x16x32_bf16 v[116:119], a[112:115], v[100:103], v[116:119]
    buffer_load_dwordx4 v10, s[24:27], s46 offen offset:896 lds
    s_add_u32 m0, m0, 3968
    v_mfma_f32_16x16x32_bf16 v[120:123], a[112:115], v[104:107], v[120:123]
    s_waitcnt lgkmcnt(2)
    v_mfma_f32_16x16x32_bf16 v[108:111], a[36:39], v[84:87], v[108:111]
    ds_read_b128 v[100:103], v12 offset:20480
    v_mfma_f32_16x16x32_bf16 v[112:115], a[36:39], v[88:91], v[112:115]
    ds_read_b128 v[104:107], v12 offset:22528
    v_mfma_f32_16x16x32_bf16 v[116:119], a[116:119], v[84:87], v[116:119]
    buffer_load_dwordx4 v10, s[24:27], s46 offen offset:1024 lds
    s_add_u32 m0, m0, 3968
    v_mfma_f32_16x16x32_bf16 v[120:123], a[116:119], v[88:91], v[120:123]
    s_waitcnt lgkmcnt(2)
    v_mfma_f32_16x16x32_bf16 v[108:111], a[40:43], v[92:95], v[108:111]
    ds_read_b128 v[84:87], v11 offset:24576
    v_mfma_f32_16x16x32_bf16 v[112:115], a[40:43], v[96:99], v[112:115]
    ds_read_b128 v[88:91], v11 offset:26624
    v_mfma_f32_16x16x32_bf16 v[116:119], a[120:123], v[92:95], v[116:119]
    buffer_load_dwordx4 v10, s[24:27], s46 offen offset:1152 lds
    v_mfma_f32_16x16x32_bf16 v[120:123], a[120:123], v[96:99], v[120:123]
    s_waitcnt lgkmcnt(2)
    v_mfma_f32_16x16x32_bf16 v[108:111], a[44:47], v[100:103], v[108:111]
    ds_read_b128 v[92:95], v12 offset:24576
    v_mfma_f32_16x16x32_bf16 v[112:115], a[44:47], v[104:107], v[112:115]
    ds_read_b128 v[96:99], v12 offset:26624
    v_mfma_f32_16x16x32_bf16 v[116:119], a[124:127], v[100:103], v[116:119]
    v_mfma_f32_16x16x32_bf16 v[120:123], a[124:127], v[104:107], v[120:123]
    s_waitcnt lgkmcnt(2)
    v_mfma_f32_16x16x32_bf16 v[108:111], a[48:51], v[84:87], v[108:111]
    ds_read_b128 v[100:103], v11 offset:28672
    v_mfma_f32_16x16x32_bf16 v[112:115], a[48:51], v[88:91], v[112:115]
    ds_read_b128 v[104:107], v11 offset:30720
    v_mfma_f32_16x16x32_bf16 v[116:119], a[128:131], v[84:87], v[116:119]
    v_mfma_f32_16x16x32_bf16 v[120:123], a[128:131], v[88:91], v[120:123]
    s_waitcnt lgkmcnt(2)
    v_mfma_f32_16x16x32_bf16 v[108:111], a[52:55], v[92:95], v[108:111]
    ds_read_b128 v[84:87], v12 offset:28672
    v_mfma_f32_16x16x32_bf16 v[112:115], a[52:55], v[96:99], v[112:115]
    ds_read_b128 v[88:91], v12 offset:30720
    v_mfma_f32_16x16x32_bf16 v[116:119], a[132:135], v[92:95], v[116:119]
    v_mfma_f32_16x16x32_bf16 v[120:123], a[132:135], v[96:99], v[120:123]
    s_waitcnt lgkmcnt(2)
    v_mfma_f32_16x16x32_bf16 v[108:111], a[56:59], v[100:103], v[108:111]
    ds_read_b128 v[92:95], v11 offset:32768
    v_mfma_f32_16x16x32_bf16 v[112:115], a[56:59], v[104:107], v[112:115]
    ds_read_b128 v[96:99], v11 offset:34816
    v_mfma_f32_16x16x32_bf16 v[116:119], a[136:139], v[100:103], v[116:119]
    v_mfma_f32_16x16x32_bf16 v[120:123], a[136:139], v[104:107], v[120:123]
    s_waitcnt lgkmcnt(2)
    v_mfma_f32_16x16x32_bf16 v[108:111], a[60:63], v[84:87], v[108:111]
    ds_read_b128 v[100:103], v12 offset:32768
    v_mfma_f32_16x16x32_bf16 v[112:115], a[60:63], v[88:91], v[112:115]
    ds_read_b128 v[104:107], v12 offset:34816
    v_mfma_f32_16x16x32_bf16 v[116:119], a[140:143], v[84:87], v[116:119]
    v_mfma_f32_16x16x32_bf16 v[120:123], a[140:143], v[88:91], v[120:123]
    s_waitcnt lgkmcnt(2)
    v_mfma_f32_16x16x32_bf16 v[108:111], a[64:67], v[92:95], v[108:111]
    ds_read_b128 v[84:87], v11 offset:36864
    v_mfma_f32_16x16x32_bf16 v[112:115], a[64:67], v[96:99], v[112:115]
    ds_read_b128 v[88:91], v11 offset:38912
    v_mfma_f32_16x16x32_bf16 v[116:119], a[144:147], v[92:95], v[116:119]
    v_mfma_f32_16x16x32_bf16 v[120:123], a[144:147], v[96:99], v[120:123]
    s_waitcnt lgkmcnt(2)
    v_mfma_f32_16x16x32_bf16 v[108:111], a[68:71], v[100:103], v[108:111]
    ds_read_b128 v[92:95], v12 offset:36864
    v_mfma_f32_16x16x32_bf16 v[112:115], a[68:71], v[104:107], v[112:115]
    ds_read_b128 v[96:99], v12 offset:38912
    v_mfma_f32_16x16x32_bf16 v[116:119], a[148:151], v[100:103], v[116:119]
    v_mfma_f32_16x16x32_bf16 v[120:123], a[148:151], v[104:107], v[120:123]
    s_waitcnt lgkmcnt(0)
    v_mfma_f32_16x16x32_bf16 v[108:111], a[72:75], v[84:87], v[108:111]
    v_add_u32 v11, s49, v11
    v_mfma_f32_16x16x32_bf16 v[112:115], a[72:75], v[88:91], v[112:115]
    v_add_u32 v12, s49, v12
    v_mfma_f32_16x16x32_bf16 v[108:111], a[76:79], v[92:95], v[108:111]
    s_sub_u32 s47, s47, s49
    v_mfma_f32_16x16x32_bf16 v[112:115], a[76:79], v[96:99], v[112:115]
    s_sub_u32 s49, 0, s49
    v_mfma_f32_16x16x32_bf16 v[116:119], a[152:155], v[84:87], v[116:119]
    v_mfma_f32_16x16x32_bf16 v[120:123], a[152:155], v[88:91], v[120:123]
    v_mfma_f32_16x16x32_bf16 v[116:119], a[156:159], v[92:95], v[116:119]
    v_mfma_f32_16x16x32_bf16 v[120:123], a[156:159], v[96:99], v[120:123]
    v_cvt_pk_bf16_f32 v124, v108, v109
    v_cvt_pk_bf16_f32 v125, v110, v111
    v_cvt_pk_bf16_f32 v126, v112, v113
    v_cvt_pk_bf16_f32 v127, v114, v115
    s_nop 0
    v_permlane16_swap_b32 v124, v126
    v_permlane16_swap_b32 v125, v127
    v_cvt_pk_bf16_f32 v128, v116, v117
    v_cvt_pk_bf16_f32 v129, v118, v119
    v_cvt_pk_bf16_f32 v130, v120, v121
    v_cvt_pk_bf16_f32 v131, v122, v123
    s_nop 0
    v_permlane16_swap_b32 v128, v130
    v_permlane16_swap_b32 v129, v131
    buffer_store_dwordx4 v[124:127], v19, s[4:7], s44 offen sc1
    buffer_store_dwordx4 v[128:131], v19, s[4:7], s45 offen sc1
    s_add_u32 s50, s37, 2
    s_and_b32 s50, s50, 3
    s_mul_i32 s50, s50, 114688
    s_add_u32 s42, s38, s50
    s_add_u32 s50, s37, 4
    s_min_u32 s50, s50, 63
    s_mul_i32 s46, s50, 40960
    s_add_u32 s51, s37, 1
    v_mov_b32 v20, s51
    s_mov_b32 m0, s48
    v_mov_b32 v68, 0
    v_mov_b32 v69, 0
    v_mov_b32 v70, 0
    v_mov_b32 v71, 0
    v_mov_b32 v72, 0
    v_mov_b32 v73, 0
    v_mov_b32 v74, 0
    v_mov_b32 v75, 0
    s_add_u32 s50, s37, 6
    s_min_u32 s50, s50, 63
    s_mul_i32 s57, s50, 40960
    s_and_b32 s50, s37, 3
    s_mul_i32 s51, s50, 40960
    s_add_u32 s43, s51, s38
    s_mul_i32 s51, s50, 327680
    s_add_u32 s53, s51, 4194304
    s_xor_b32 s50, s50, 2
    s_mul_i32 s51, s50, 327680
    s_add_u32 s54, s51, 4194304
    s_sub_u32 s51, s37, 6
    s_mul_i32 s60, s51, 81920
    s_branch L_v_first_s
L_v_loop_s:
    s_add_u32 s50, s37, 2
    s_and_b32 s50, s50, 3
    s_mul_i32 s50, s50, 114688
    s_add_u32 s42, s38, s50
    s_add_u32 s50, s37, 4
    s_min_u32 s50, s50, 63
    s_mul_i32 s46, s50, 40960
    s_add_u32 s51, s37, 1
    v_mov_b32 v20, s51
    s_mov_b32 m0, s48
    v_mov_b32 v68, 0
    v_mov_b32 v69, 0
    v_mov_b32 v70, 0
    v_mov_b32 v71, 0
    v_mov_b32 v72, 0
    v_mov_b32 v73, 0
    v_mov_b32 v74, 0
    v_mov_b32 v75, 0
    s_add_u32 s50, s37, 6
    s_min_u32 s50, s50, 63
    s_mul_i32 s57, s50, 40960
    s_and_b32 s50, s37, 3
    s_mul_i32 s51, s50, 40960
    s_add_u32 s43, s51, s38
    s_mul_i32 s51, s50, 327680
    s_add_u32 s53, s51, 4194304
    s_xor_b32 s50, s50, 2
    s_mul_i32 s51, s50, 327680
    s_add_u32 s54, s51, 4194304
    s_sub_u32 s51, s37, 6
    s_mul_i32 s60, s51, 81920
L_vg_83:
    buffer_load_dword v139, v138, s[4:7], s38 offen sc1
    s_sub_u32 s36, s36, 1
    s_cbranch_scc1 L_exit
    s_waitcnt vmcnt(0)
    v_cmp_gt_u32 vcc, s37, v139
    s_cbranch_vccnz L_vg_83
L_v_first_s:
    buffer_load_dwordx4 v13, s[4:7], s41 offen sc1 lds
    buffer_load_dwordx4 v13, s[4:7], s41 offen offset:1024 sc1 lds
    buffer_load_dword v14, s[4:7], s41 offen offset:2048 sc1 lds
    buffer_load_dword v14, s[4:7], s41 offen offset:2304 sc1 lds
L_poll_85:
    buffer_load_dwordx4 v13, s[4:7], s41 offen sc1 lds
    buffer_load_dwordx4 v13, s[4:7], s41 offen offset:1024 sc1 lds
    buffer_load_dword v14, s[4:7], s41 offen offset:2048 sc1 lds
    buffer_load_dword v14, s[4:7], s41 offen offset:2304 sc1 lds
    s_sub_u32 s36, s36, 1
    s_cbranch_scc1 L_exit
    s_waitcnt vmcnt(4)
    ds_read_b32 v18, v15
    s_waitcnt lgkmcnt(0)
    v_cmp_eq_u32 vcc, -1, v18
    s_cbranch_vccnz L_poll_85
    s_barrier
    ds_read_b128 v[28:31], v16 offset:0
    ds_read_b128 v[32:35], v16 offset:1024
    ds_read_b128 v[36:39], v16 offset:2048
    ds_read_b128 v[40:43], v16 offset:3072
    s_waitcnt lgkmcnt(3)
    v_smfmac_f32_16x16x64_bf16 v[68:71], v[28:31], a[0:7], v17
    ds_read_b128 v[44:47], v16 offset:4096
    v_smfmac_f32_16x16x64_bf16 v[72:75], v[28:31], a[80:87], v17
    ds_read_b128 v[48:51], v16 offset:5120
    s_waitcnt lgkmcnt(4)
    v_smfmac_f32_16x16x64_bf16 v[68:71], v[32:35], a[8:15], v17
    ds_read_b128 v[52:55], v16 offset:6144
    v_smfmac_f32_16x16x64_bf16 v[72:75], v[32:35], a[88:95], v17
    ds_read_b128 v[56:59], v16 offset:7168
    s_waitcnt lgkmcnt(5)
    v_smfmac_f32_16x16x64_bf16 v[68:71], v[36:39], a[16:23], v17
    ds_read_b128 v[60:63], v16 offset:8192
    v_smfmac_f32_16x16x64_bf16 v[72:75], v[36:39], a[96:103], v17
    ds_read_b128 v[64:67], v16 offset:9216
    s_waitcnt lgkmcnt(6)
    v_smfmac_f32_16x16x64_bf16 v[68:71], v[40:43], a[24:31], v17
    v_smfmac_f32_16x16x64_bf16 v[72:75], v[40:43], a[104:111], v17
    s_waitcnt lgkmcnt(5)
    v_smfmac_f32_16x16x64_bf16 v[68:71], v[44:47], a[32:39], v17
    v_smfmac_f32_16x16x64_bf16 v[72:75], v[44:47], a[112:119], v17
    s_waitcnt lgkmcnt(4)
    v_smfmac_f32_16x16x64_bf16 v[68:71], v[48:51], a[40:47], v17
    s_waitcnt lgkmcnt(3)
    v_smfmac_f32_16x16x64_bf16 v[68:71], v[52:55], a[48:55], v17
    s_waitcnt lgkmcnt(2)
    v_smfmac_f32_16x16x64_bf16 v[68:71], v[56:59], a[56:63], v17
    s_waitcnt lgkmcnt(1)
    v_smfmac_f32_16x16x64_bf16 v[68:71], v[60:63], a[64:71], v17
    s_waitcnt lgkmcnt(0)
    v_smfmac_f32_16x16x64_bf16 v[68:71], v[64:67], a[72:79], v17
L_redo_84:
    v_smfmac_f32_16x16x64_bf16 v[72:75], v[48:51], a[120:127], v17
    v_smfmac_f32_16x16x64_bf16 v[72:75], v[52:55], a[128:135], v17
    buffer_store_dword v20, v21, s[4:7], s38 offen offset:0 sc1
    v_smfmac_f32_16x16x64_bf16 v[72:75], v[56:59], a[136:143], v17
    v_add_f32 v68, v68, v70
    v_add_f32 v69, v69, v71
    v_smfmac_f32_16x16x64_bf16 v[72:75], v[60:63], a[144:151], v17
    v_cmp_u_f32 vcc, v68, v69
    v_cvt_pk_bf16_f32 v132, v68, v69
    v_smfmac_f32_16x16x64_bf16 v[72:75], v[64:67], a[152:159], v17
    s_cbranch_vccnz L_nan_86
L_cont_87:
    buffer_store_dword v132, v134, s[4:7], s41 offen offset:0 sc1
    s_nop 5
    v_pk_add_f32 v[72:73], v[72:73], v[74:75]
    v_cvt_pk_bf16_f32 v133, v72, v73
    buffer_store_dword v133, v134, s[4:7], s41 offen offset:1024 sc1
    ds_read_b128 v[84:87], v11 offset:0
    ds_read_b128 v[88:91], v11 offset:2048
    ds_read_b128 v[92:95], v12 offset:0
    ds_read_b128 v[96:99], v12 offset:2048
    s_cmp_eq_u32 s37, 63
    s_cbranch_scc1 L_end_88
    s_cmp_eq_u32 s37, 0
    s_cbranch_scc1 L_sd_89c
L_sd_89:
    s_cmp_eq_u32 s40, 0
    s_cbranch_scc1 L_an_90
    s_barrier
    s_lshl_b32 s90, s32, 10
    s_add_u32 m0, s90, s47
    s_waitcnt lgkmcnt(2)
    v_mfma_f32_16x16x32_bf16 v[108:111], a[0:3], v[84:87], 0
    ds_read_b128 v[100:103], v11 offset:4096
    s_add_u32 s51, s37, 3
    v_mfma_f32_16x16x32_bf16 v[112:115], a[0:3], v[88:91], 0
    ds_read_b128 v[104:107], v11 offset:6144
    s_and_b32 s50, s51, 3
    v_mfma_f32_16x16x32_bf16 v[116:119], a[80:83], v[84:87], 0
    buffer_load_dwordx4 v[148:151], v146, s[4:7], s43 offen offset:0 sc1
    buffer_load_dwordx4 v[152:155], v146, s[4:7], s43 offen offset:1024 sc1
    v_mfma_f32_16x16x32_bf16 v[120:123], a[80:83], v[88:91], 0
    s_waitcnt lgkmcnt(2)
    s_mul_i32 s50, s50, 114688
    v_mfma_f32_16x16x32_bf16 v[108:111], a[4:7], v[92:95], v[108:111]
    ds_read_b128 v[84:87], v12 offset:4096
    s_add_u32 s50, s50, 65536
    v_mfma_f32_16x16x32_bf16 v[112:115], a[4:7], v[96:99], v[112:115]
    ds_read_b128 v[88:91], v12 offset:6144
    s_add_u32 s44, s38, s50
    v_mfma_f32_16x16x32_bf16 v[116:119], a[84:87], v[92:95], v[116:119]
    s_cmp_lt_i32 s60, 0
    s_cselect_b32 s54, s38, s54
    buffer_load_dwordx4 v[156:159], v144, s[4:7], s54 offen offset:0 sc1
    buffer_load_dwordx4 v[160:163], v144, s[4:7], s54 offen offset:1024 sc1
    v_mfma_f32_16x16x32_bf16 v[120:123], a[84:87], v[96:99], v[120:123]
    s_waitcnt lgkmcnt(2)
    s_add_u32 s45, s44, s56
    v_mfma_f32_16x16x32_bf16 v[108:111], a[8:11], v[100:103], v[108:111]
    ds_read_b128 v[92:95], v11 offset:8192
    s_add_u32 s37, s37, 1
    v_mfma_f32_16x16x32_bf16 v[112:115], a[8:11], v[104:107], v[112:115]
    ds_read_b128 v[96:99], v11 offset:10240
    s_mov_b32 s52, 0
    v_mfma_f32_16x16x32_bf16 v[116:119], a[88:91], v[100:103], v[116:119]
    s_and_b32 s50, s37, 3
    s_mul_i32 s51, s50, 114688
    v_mfma_f32_16x16x32_bf16 v[120:123], a[88:91], v[104:107], v[120:123]
    s_waitcnt lgkmcnt(2)
    s_add_u32 s41, s38, s51
    v_mfma_f32_16x16x32_bf16 v[108:111], a[12:15], v[84:87], v[108:111]
    ds_read_b128 v[100:103], v12 offset:8192
    v_mfma_f32_16x16x32_bf16 v[112:115], a[12:15], v[88:91], v[112:115]
    ds_read_b128 v[104:107], v12 offset:10240
    v_mfma_f32_16x16x32_bf16 v[116:119], a[92:95], v[84:87], v[116:119]
    buffer_load_dwordx4 v[248:251], v137, s[24:27], s57 offen offset:0
    buffer_load_dwordx4 v[248:251], v137, s[24:27], s57 offen offset:1024
    v_mfma_f32_16x16x32_bf16 v[120:123], a[92:95], v[88:91], v[120:123]
    s_waitcnt lgkmcnt(2)
    v_mfma_f32_16x16x32_bf16 v[108:111], a[16:19], v[92:95], v[108:111]
    ds_read_b128 v[84:87], v11 offset:12288
    v_mfma_f32_16x16x32_bf16 v[112:115], a[16:19], v[96:99], v[112:115]
    ds_read_b128 v[88:91], v11 offset:14336
    v_mfma_f32_16x16x32_bf16 v[116:119], a[96:99], v[92:95], v[116:119]
    v_mfma_f32_16x16x32_bf16 v[120:123], a[96:99], v[96:99], v[120:123]
    s_waitcnt lgkmcnt(2)
    v_mfma_f32_16x16x32_bf16 v[108:111], a[20:23], v[100:103], v[108:111]
    ds_read_b128 v[92:95], v12 offset:12288
    v_mfma_f32_16x16x32_bf16 v[112:115], a[20:23], v[104:107], v[112:115]
    ds_read_b128 v[96:99], v12 offset:14336
    v_mfma_f32_16x16x32_bf16 v[116:119], a[100:103], v[100:103], v[116:119]
    s_waitcnt vmcnt(4)
    s_cmp_lt_i32 s60, -245760
    s_cbranch_scc1 L_fw_91c
L_fw_91:
    buffer_store_dwordx4 v[148:151], v143, s[4:7], s53 offen offset:0 sc1
    buffer_store_dwordx4 v[152:155], v143, s[4:7], s53 offen offset:1024 sc1
    v_mfma_f32_16x16x32_bf16 v[120:123], a[100:103], v[104:107], v[120:123]
    s_waitcnt lgkmcnt(2)
    v_mfma_f32_16x16x32_bf16 v[108:111], a[24:27], v[84:87], v[108:111]
    ds_read_b128 v[100:103], v11 offset:16384
    v_mfma_f32_16x16x32_bf16 v[112:115], a[24:27], v[88:91], v[112:115]
    ds_read_b128 v[104:107], v11 offset:18432
    v_mfma_f32_16x16x32_bf16 v[116:119], a[104:107], v[84:87], v[116:119]
    v_mfma_f32_16x16x32_bf16 v[120:123], a[104:107], v[88:91], v[120:123]
    s_waitcnt lgkmcnt(2)
    v_mfma_f32_16x16x32_bf16 v[108:111], a[28:31], v[92:95], v[108:111]
    ds_read_b128 v[84:87], v12 offset:16384
    v_mfma_f32_16x16x32_bf16 v[112:115], a[28:31], v[96:99], v[112:115]
    ds_read_b128 v[88:91], v12 offset:18432
    v_mfma_f32_16x16x32_bf16 v[116:119], a[108:111], v[92:95], v[116:119]
    buffer_store_dword v22, v135, s[4:7], s42 offen offset:0 sc1
    buffer_store_dword v22, v135, s[4:7], s42 offen offset:1024 sc1
    v_mfma_f32_16x16x32_bf16 v[120:123], a[108:111], v[96:99], v[120:123]
    s_waitcnt lgkmcnt(2)
    v_mfma_f32_16x16x32_bf16 v[108:111], a[32:35], v[100:103], v[108:111]
    ds_read_b128 v[92:95], v11 offset:20480
    v_mfma_f32_16x16x32_bf16 v[112:115], a[32:35], v[104:107], v[112:115]
    ds_read_b128 v[96:99], v11 offset:22528
    v_mfma_f32_16x16x32_bf16 v[116:119], a[112:115], v[100:103], v[116:119]
    buffer_load_dwordx4 v10, s[24:27], s46 offen offset:0 lds
    s_add_u32 m0, m0, 3968
    v_mfma_f32_16x16x32_bf16 v[120:123], a[112:115], v[104:107], v[120:123]
    s_waitcnt lgkmcnt(2)
    v_mfma_f32_16x16x32_bf16 v[108:111], a[36:39], v[84:87], v[108:111]
    ds_read_b128 v[100:103], v12 offset:20480
    v_mfma_f32_16x16x32_bf16 v[112:115], a[36:39], v[88:91], v[112:115]
    ds_read_b128 v[104:107], v12 offset:22528
    v_mfma_f32_16x16x32_bf16 v[116:119], a[116:119], v[84:87], v[116:119]
    buffer_load_dwordx4 v10, s[24:27], s46 offen offset:128 lds
    s_add_u32 m0, m0, 3968
    v_mfma_f32_16x16x32_bf16 v[120:123], a[116:119], v[88:91], v[120:123]
    s_waitcnt lgkmcnt(2)
    v_mfma_f32_16x16x32_bf16 v[108:111], a[40:43], v[92:95], v[108:111]
    ds_read_b128 v[84:87], v11 offset:24576
    v_mfma_f32_16x16x32_bf16 v[112:115], a[40:43], v[96:99], v[112:115]
    ds_read_b128 v[88:91], v11 offset:26624
    v_mfma_f32_16x16x32_bf16 v[116:119], a[120:123], v[92:95], v[116:119]
    buffer_load_dwordx4 v10, s[24:27], s46 offen offset:256 lds
    s_add_u32 m0, m0, 3968
    v_mfma_f32_16x16x32_bf16 v[120:123], a[120:123], v[96:99], v[120:123]
    s_waitcnt lgkmcnt(2)
    v_mfma_f32_16x16x32_bf16 v[108:111], a[44:47], v[100:103], v[108:111]
    ds_read_b128 v[92:95], v12 offset:24576
    v_mfma_f32_16x16x32_bf16 v[112:115], a[44:47], v[104:107], v[112:115]
    ds_read_b128 v[96:99], v12 offset:26624
    v_mfma_f32_16x16x32_bf16 v[116:119], a[124:127], v[100:103], v[116:119]
    buffer_load_dwordx4 v10, s[24:27], s46 offen offset:384 lds
    s_add_u32 m0, m0, 3968
    v_mfma_f32_16x16x32_bf16 v[120:123], a[124:127], v[104:107], v[120:123]
    s_waitcnt lgkmcnt(2)
    v_mfma_f32_16x16x32_bf16 v[108:111], a[48:51], v[84:87], v[108:111]
    ds_read_b128 v[100:103], v11 offset:28672
    v_mfma_f32_16x16x32_bf16 v[112:115], a[48:51], v[88:91], v[112:115]
    ds_read_b128 v[104:107], v11 offset:30720
    v_mfma_f32_16x16x32_bf16 v[116:119], a[128:131], v[84:87], v[116:119]
    buffer_load_dwordx4 v10, s[24:27], s46 offen offset:512 lds
    s_add_u32 m0, m0, 3968
    v_mfma_f32_16x16x32_bf16 v[120:123], a[128:131], v[88:91], v[120:123]
    s_waitcnt lgkmcnt(2)
    v_mfma_f32_16x16x32_bf16 v[108:111], a[52:55], v[92:95], v[108:111]
    ds_read_b128 v[84:87], v12 offset:28672
    v_mfma_f32_16x16x32_bf16 v[112:115], a[52:55], v[96:99], v[112:115]
    ds_read_b128 v[88:91], v12 offset:30720
    v_mfma_f32_16x16x32_bf16 v[116:119], a[132:135], v[92:95], v[116:119]
    buffer_load_dwordx4 v10, s[24:27], s46 offen offset:640 lds
    s_add_u32 m0, m0, 3968
    v_mfma_f32_16x16x32_bf16 v[120:123], a[132:135], v[96:99], v[120:123]
    s_waitcnt lgkmcnt(2)
    v_mfma_f32_16x16x32_bf16 v[108:111], a[56:59], v[100:103], v[108:111]
    ds_read_b128 v[92:95], v11 offset:32768
    v_mfma_f32_16x16x32_bf16 v[112:115], a[56:59], v[104:107], v[112:115]
    ds_read_b128 v[96:99], v11 offset:34816
    v_mfma_f32_16x16x32_bf16 v[116:119], a[136:139], v[100:103], v[116:119]
    buffer_load_dwordx4 v10, s[24:27], s46 offen offset:768 lds
    s_add_u32 m0, m0, 3968
    v_mfma_f32_16x16x32_bf16 v[120:123], a[136:139], v[104:107], v[120:123]
    s_waitcnt lgkmcnt(2)
    v_mfma_f32_16x16x32_bf16 v[108:111], a[60:63], v[84:87], v[108:111]
    ds_read_b128 v[100:103], v12 offset:32768
    v_mfma_f32_16x16x32_bf16 v[112:115], a[60:63], v[88:91], v[112:115]
    ds_read_b128 v[104:107], v12 offset:34816
    v_mfma_f32_16x16x32_bf16 v[116:119], a[140:143], v[84:87], v[116:119]
    buffer_load_dwordx4 v10, s[24:27], s46 offen offset:896 lds
    s_add_u32 m0, m0, 3968
    v_mfma_f32_16x16x32_bf16 v[120:123], a[140:143], v[88:91], v[120:123]
    s_waitcnt lgkmcnt(2)
    v_mfma_f32_16x16x32_bf16 v[108:111], a[64:67], v[92:95], v[108:111]
    ds_read_b128 v[84:87], v11 offset:36864
    v_mfma_f32_16x16x32_bf16 v[112:115], a[64:67], v[96:99], v[112:115]
    ds_read_b128 v[88:91], v11 offset:38912
    v_mfma_f32_16x16x32_bf16 v[116:119], a[144:147], v[92:95], v[116:119]
    buffer_load_dwordx4 v10, s[24:27], s46 offen offset:1024 lds
    s_add_u32 m0, m0, 3968
    v_mfma_f32_16x16x32_bf16 v[120:123], a[144:147], v[96:99], v[120:123]
    s_waitcnt lgkmcnt(2)
    v_mfma_f32_16x16x32_bf16 v[108:111], a[68:71], v[100:103], v[108:111]
    ds_read_b128 v[92:95], v12 offset:36864
    v_mfma_f32_16x16x32_bf16 v[112:115], a[68:71], v[104:107], v[112:115]
    ds_read_b128 v[96:99], v12 offset:38912
    v_mfma_f32_16x16x32_bf16 v[116:119], a[148:151], v[100:103], v[116:119]
    buffer_load_dwordx4 v10, s[24:27], s46 offen offset:1152 lds
    v_mfma_f32_16x16x32_bf16 v[120:123], a[148:151], v[104:107], v[120:123]
    s_waitcnt lgkmcnt(0)
    v_mfma_f32_16x16x32_bf16 v[108:111], a[72:75], v[84:87], v[108:111]
    v_add_u32 v11, s49, v11
    v_mfma_f32_16x16x32_bf16 v[112:115], a[72:75], v[88:91], v[112:115]
    v_add_u32 v12, s49, v12
    v_mfma_f32_16x16x32_bf16 v[108:111], a[76:79], v[92:95], v[108:111]
    s_sub_u32 s47, s47, s49
    v_mfma_f32_16x16x32_bf16 v[112:115], a[76:79], v[96:99], v[112:115]
    s_sub_u32 s49, 0, s49
    v_mfma_f32_16x16x32_bf16 v[116:119], a[152:155], v[84:87], v[116:119]
    v_mfma_f32_16x16x32_bf16 v[120:123], a[152:155], v[88:91], v[120:123]
    v_mfma_f32_16x16x32_bf16 v[116:119], a[156:159], v[92:95], v[116:119]
    v_mfma_f32_16x16x32_bf16 v[120:123], a[156:159], v[96:99], v[120:123]
    v_cvt_pk_bf16_f32 v124, v108, v109
    v_cvt_pk_bf16_f32 v125, v110, v111
    v_cvt_pk_bf16_f32 v126, v112, v113
    v_cvt_pk_bf16_f32 v127, v114, v115
    s_nop 0
    v_permlane16_swap_b32 v124, v126
    v_permlane16_swap_b32 v125, v127
    v_cvt_pk_bf16_f32 v128, v116, v117
    v_cvt_pk_bf16_f32 v129, v118, v119
    v_cvt_pk_bf16_f32 v130, v120, v121
    v_cvt_pk_bf16_f32 v131, v122, v123
    s_nop 0
    v_permlane16_swap_b32 v128, v130
    v_permlane16_swap_b32 v129, v131
    buffer_store_dwordx4 v[124:127], v19, s[4:7], s44 offen sc1
    buffer_store_dwordx4 v[128:131], v19, s[4:7], s45 offen sc1
    s_waitcnt vmcnt(18)
    s_cmp_lt_i32 s60, 0
    s_cbranch_scc1 L_fin_92
    v_mfma_f32_16x16x32_bf16 v[164:167], a[160:163], v[156:159], 0
    v_mfma_f32_16x16x32_bf16 v[168:171], a[160:163], v[160:163], 0
    s_nop 4
    v_cndmask_b32 v166, v164, v165, s[58:59]
    s_nop 1
    v_cndmask_b32 v170, v168, v169, s[58:59]
    v_cndmask_b32 v167, v165, v164, s[58:59]
    v_cndmask_b32 v171, v169, v168, s[58:59]
    s_nop 0
    v_add_f32_dpp v167, v166, v167 row_ror:8 row_mask:0xf bank_mask:0xf
    v_add_f32_dpp v171, v170, v171 row_ror:8 row_mask:0xf bank_mask:0xf
    v_cvt_pk_bf16_f32 v167, v167, v167
    v_cvt_pk_bf16_f32 v171, v171, v171
    buffer_store_short v167, v145, s[28:31], s60 offen offset:0
    buffer_store_short v171, v145, s[28:31], s60 offen offset:32
L_fin_92:
    s_branch L_v_loop_s
L_end_88:
    s_cmp_lt_i32 s60, 0
    s_cselect_b32 s54, s38, s54
    buffer_load_dwordx4 v[156:159], v144, s[4:7], s54 offen offset:0 sc1
    buffer_load_dwordx4 v[160:163], v144, s[4:7], s54 offen offset:1024 sc1
    s_waitcnt vmcnt(0) lgkmcnt(0)
    s_cmp_lt_i32 s60, 0
    s_cbranch_scc1 L_fin_93
    v_mfma_f32_16x16x32_bf16 v[164:167], a[160:163], v[156:159], 0
    v_mfma_f32_16x16x32_bf16 v[168:171], a[160:163], v[160:163], 0
    s_nop 4
    v_cndmask_b32 v166, v164, v165, s[58:59]
    s_nop 1
    v_cndmask_b32 v170, v168, v169, s[58:59]
    v_cndmask_b32 v167, v165, v164, s[58:59]
    v_cndmask_b32 v171, v169, v168, s[58:59]
    s_nop 0
    v_add_f32_dpp v167, v166, v167 row_ror:8 row_mask:0xf bank_mask:0xf
    v_add_f32_dpp v171, v170, v171 row_ror:8 row_mask:0xf bank_mask:0xf
    v_cvt_pk_bf16_f32 v167, v167, v167
    v_cvt_pk_bf16_f32 v171, v171, v171
    buffer_store_short v167, v145, s[28:31], s60 offen offset:0
    buffer_store_short v171, v145, s[28:31], s60 offen offset:32
L_fin_93:
    s_waitcnt vmcnt(0)
    s_cmp_lg_u32 s55, 0
    s_cbranch_scc1 L_wb_94
    buffer_wbl2 sc1
    s_waitcnt vmcnt(0)
L_wb_94:
    s_endpgm
L_nan_86:
    s_cmp_eq_u32 s52, 1
    s_cbranch_scc1 L_cont_87
    v_lshlrev_b32 v1, 4, v0
L_nan_86r:
    s_mov_b32 s90, s41
    v_mov_b32 v2, 0
    buffer_load_dwordx4 v[28:31], v1, s[4:7], s90 offen sc1
    s_add_u32 s90, s90, 1024
    buffer_load_dwordx4 v[32:35], v1, s[4:7], s90 offen sc1
    s_add_u32 s90, s90, 1024
    buffer_load_dwordx4 v[36:39], v1, s[4:7], s90 offen sc1
    s_add_u32 s90, s90, 1024
    buffer_load_dwordx4 v[40:43], v1, s[4:7], s90 offen sc1
    s_add_u32 s90, s90, 1024
    buffer_load_dwordx4 v[44:47], v1, s[4:7], s90 offen sc1
    s_add_u32 s90, s90, 1024
    buffer_load_dwordx4 v[48:51], v1, s[4:7], s90 offen sc1
    s_add_u32 s90, s90, 1024
    buffer_load_dwordx4 v[52:55], v1, s[4:7], s90 offen sc1
    s_add_u32 s90, s90, 1024
    buffer_load_dwordx4 v[56:59], v1, s[4:7], s90 offen sc1
    s_add_u32 s90, s90, 1024
    buffer_load_dwordx4 v[60:63], v1, s[4:7], s90 offen sc1
    s_add_u32 s90, s90, 1024
    buffer_load_dwordx4 v[64:67], v1, s[4:7], s90 offen sc1
    s_add_u32 s90, s90, 1024
    s_sub_u32 s36, s36, 1
    s_cbranch_scc1 L_exit
    s_waitcnt vmcnt(0) lgkmcnt(0)
    v_max3_u32 v2, v2, v28, v29
    v_max3_u32 v2, v2, v30, v31
    v_max3_u32 v2, v2, v32, v33
    v_max3_u32 v2, v2, v34, v35
    v_max3_u32 v2, v2, v36, v37
    v_max3_u32 v2, v2, v38, v39
    v_max3_u32 v2, v2, v40, v41
    v_max3_u32 v2, v2, v42, v43
    v_max3_u32 v2, v2, v44, v45
    v_max3_u32 v2, v2, v46, v47
    v_max3_u32 v2, v2, v48, v49
    v_max3_u32 v2, v2, v50, v51
    v_max3_u32 v2, v2, v52, v53
    v_max3_u32 v2, v2, v54, v55
    v_max3_u32 v2, v2, v56, v57
    v_max3_u32 v2, v2, v58, v59
    v_max3_u32 v2, v2, v60, v61
    v_max3_u32 v2, v2, v62, v63
    v_max3_u32 v2, v2, v64, v65
    v_max3_u32 v2, v2, v66, v67
    v_cmp_eq_u32 vcc, -1, v2
    s_cbranch_vccnz L_nan_86r
    s_mov_b32 s52, 1
    v_mov_b32 v68, 0
    v_mov_b32 v69, 0
    v_mov_b32 v70, 0
    v_mov_b32 v71, 0
    v_mov_b32 v72, 0
    v_mov_b32 v73, 0
    v_mov_b32 v74, 0
    v_mov_b32 v75, 0
    v_smfmac_f32_16x16x64_bf16 v[68:71], v[28:31], a[0:7], v17
    s_nop 0
    v_smfmac_f32_16x16x64_bf16 v[72:75], v[28:31], a[80:87], v17
    v_smfmac_f32_16x16x64_bf16 v[68:71], v[32:35], a[8:15], v17
    v_smfmac_f32_16x16x64_bf16 v[72:75], v[32:35], a[88:95], v17
    v_smfmac_f32_16x16x64_bf16 v[68:71], v[36:39], a[16:23], v17
    v_smfmac_f32_16x16x64_bf16 v[72:75], v[36:39], a[96:103], v17
    v_smfmac_f32_16x16x64_bf16 v[68:71], v[40:43], a[24:31], v17
    v_smfmac_f32_16x16x64_bf16 v[72:75], v[40:43], a[104:111], v17
    v_smfmac_f32_16x16x64_bf16 v[68:71], v[44:47], a[32:39], v17
    v_smfmac_f32_16x16x64_bf16 v[72:75], v[44:47], a[112:119], v17
    v_smfmac_f32_16x16x64_bf16 v[68:71], v[48:51], a[40:47], v17
    v_smfmac_f32_16x16x64_bf16 v[68:71], v[52:55], a[48:55], v17
    v_smfmac_f32_16x16x64_bf16 v[68:71], v[56:59], a[56:63], v17
    v_smfmac_f32_16x16x64_bf16 v[68:71], v[60:63], a[64:71], v17
    v_smfmac_f32_16x16x64_bf16 v[68:71], v[64:67], a[72:79], v17
    s_nop 2
    s_branch L_redo_84
L_wo_s:
    s_mov_b32 s12, s80
    s_and_b32 s13, s81, 0xffff
    s_mov_b32 s14, 7864320
    s_mov_b32 s15, 0x20000
    s_mov_b32 s16, s72
    s_and_b32 s17, s73, 0xffff
    s_mov_b32 s18, 10240
    s_mov_b32 s19, 0x20000
    s_sub_u32 s40, s35, 18
    v_and_b32 v1, 15, v0
    v_lshrrev_b32 v2, 4, v0
    v_lshrrev_b32 v3, 3, v0
    v_and_b32 v4, 7, v0
    v_and_b32 v6, 2, v3
    v_xor_b32 v6, v6, v4
    v_lshlrev_b32 v6, 4, v6
    v_mul_u32_u24 v7, 1280, v3
    s_lshl_b32 s90, s34, 2
    s_add_u32 s90, s90, s32
    s_mul_i32 s90, s90, 245760
    s_lshl_b32 s91, s40, 7
    s_add_u32 s90, s90, s91
    v_add3_u32 v180, v6, v7, s90
    v_xor_b32 v181, 64, v180
    s_mul_i32 s90, s40, 32768
    s_lshl_b32 s91, s32, 11
    s_add_u32 s90, s90, s91
    s_lshr_b32 s91, s32, 1
    s_mul_i32 s91, s91, 0
    s_xor_b32 s91, s91, s34
    v_mul_u32_u24 v7, 0, v2
    v_xor_b32 v7, s91, v7
    v_lshlrev_b32 v6, 4, v1
    v_lshl_add_u32 v7, v7, 8, v6
    v_lshl_add_u32 v7, v2, 13, v7
    v_add_u32 v14, s90, v7
    v_lshlrev_b32 v12, 4, v0
    v_lshlrev_b32 v13, 2, v0
    v_add_u32 v46, s90, v13
    s_xor_b32 s92, s91, 0
    s_lshl_b32 s92, s92, 8
    s_add_u32 s60, s92, 0
    s_xor_b32 s92, s91, 0
    s_lshl_b32 s92, s92, 8
    s_add_u32 s61, s92, 8192
    s_xor_b32 s92, s91, 0
    s_lshl_b32 s92, s92, 8
    s_add_u32 s62, s92, 16384
    s_xor_b32 s92, s91, 0
    s_lshl_b32 s92, s92, 8
    s_add_u32 s63, s92, 24576
    v_cmp_gt_u32 vcc, 2, v2
    v_mov_b32 v9, 2146435072
    s_nop 0
    v_cndmask_b32 v14, v9, v14, vcc
    s_lshl_b32 s92, s40, 7
    s_lshl_b32 s93, s32, 2
    s_add_u32 s92, s92, s93
    s_add_u32 s92, s92, 460800
    v_mov_b32 v244, s92
    v_cmp_eq_u32 vcc, 0, v0
    v_mov_b32 v9, 2146435072
    s_nop 0
    v_cndmask_b32 v244, v9, v244, vcc
    s_lshl_b32 s92, s40, 4
    s_add_u32 s92, s92, s93
    s_add_u32 s92, s92, 460544
    v_mov_b32 v45, s92
    v_cndmask_b32 v45, v9, v45, vcc
    s_lshl_b32 s92, s32, 7
    s_add_u32 s92, s92, 462336
    v_min_u32 v3, 5, v0
    v_lshl_add_u32 v245, v3, 2, s92
    s_lshl_b32 s90, s40, 2
    s_add_u32 s90, s90, s32
    s_lshl_b32 s91, s90, 8
    v_add_u32 v17, s91, v6
    v_cmp_eq_u32 vcc, 0, v2
    v_mov_b32 v9, 2146435072
    s_nop 0
    v_cndmask_b32 v17, v9, v17, vcc
    v_lshrrev_b32 v3, 2, v1
    v_and_b32 v7, 1, v1
    v_lshl_or_b32 v4, v3, 1, v7
    v_mul_u32_u24 v4, 1280, v4
    v_and_b32 v5, 2, v1
    v_lshl_add_u32 v4, v5, 1, v4
    s_lshl_b32 s91, s90, 5
    v_add_u32 v4, s91, v4
    v_lshlrev_b32 v6, 6, v3
    v_lshl_add_u32 v6, v7, 5, v6
    v_lshl_add_u32 v6, v2, 3, v6
    v_lshl_add_u32 v6, v5, 1, v6
    s_mul_i32 s92, s32, 1152
    s_add_u32 s92, s92, 122880
    v_add_u32 v18, s92, v6
    buffer_load_dword v164, v4, s[16:19], 0 offen offset:0
    buffer_load_dword v165, v4, s[16:19], 0 offen offset:8
    buffer_load_dword v166, v4, s[16:19], 0 offen offset:16
    buffer_load_dword v167, v4, s[16:19], 0 offen offset:24
    v_mov_b32 v168, -1
    v_mov_b32 v169, -1
    v_mov_b32 v170, -1
    v_mov_b32 v171, -1
    s_mul_i32 s90, s32, 24576
    s_mov_b32 m0, s90
    s_mov_b32 s91, 0
    buffer_load_dwordx4 v180, s[12:15], s91 offen nt lds
    s_add_u32 m0, m0, 1024
    s_add_u32 s91, s91, 10240
    buffer_load_dwordx4 v181, s[12:15], s91 offen nt lds
    s_add_u32 m0, m0, 1024
    s_add_u32 s91, s91, 10240
    buffer_load_dwordx4 v180, s[12:15], s91 offen nt lds
    s_add_u32 m0, m0, 1024
    s_add_u32 s91, s91, 10240
    buffer_load_dwordx4 v181, s[12:15], s91 offen nt lds
    s_add_u32 m0, m0, 1024
    s_add_u32 s91, s91, 10240
    buffer_load_dwordx4 v180, s[12:15], s91 offen nt lds
    s_add_u32 m0, m0, 1024
    s_add_u32 s91, s91, 10240
    buffer_load_dwordx4 v181, s[12:15], s91 offen nt lds
    s_add_u32 m0, m0, 1024
    s_add_u32 s91, s91, 10240
    buffer_load_dwordx4 v180, s[12:15], s91 offen nt lds
    s_add_u32 m0, m0, 1024
    s_add_u32 s91, s91, 10240
    buffer_load_dwordx4 v181, s[12:15], s91 offen nt lds
    s_add_u32 m0, m0, 1024
    s_add_u32 s91, s91, 10240
    buffer_load_dwordx4 v180, s[12:15], s91 offen nt lds
    s_add_u32 m0, m0, 1024
    s_add_u32 s91, s91, 10240
    buffer_load_dwordx4 v181, s[12:15], s91 offen nt lds
    s_add_u32 m0, m0, 1024
    s_add_u32 s91, s91, 10240
    buffer_load_dwordx4 v180, s[12:15], s91 offen nt lds
    s_add_u32 m0, m0, 1024
    s_add_u32 s91, s91, 10240
    buffer_load_dwordx4 v181, s[12:15], s91 offen nt lds
    s_add_u32 m0, m0, 1024
    s_add_u32 s91, s91, 10240
    buffer_load_dwordx4 v180, s[12:15], s91 offen nt lds
    s_add_u32 m0, m0, 1024
    s_add_u32 s91, s91, 10240
    buffer_load_dwordx4 v181, s[12:15], s91 offen nt lds
    s_add_u32 m0, m0, 1024
    s_add_u32 s91, s91, 10240
    buffer_load_dwordx4 v180, s[12:15], s91 offen nt lds
    s_add_u32 m0, m0, 1024
    s_add_u32 s91, s91, 10240
    buffer_load_dwordx4 v181, s[12:15], s91 offen nt lds
    s_add_u32 m0, m0, 1024
    s_add_u32 s91, s91, 10240
    buffer_load_dwordx4 v180, s[12:15], s91 offen nt lds
    s_add_u32 m0, m0, 1024
    s_add_u32 s91, s91, 10240
    buffer_load_dwordx4 v181, s[12:15], s91 offen nt lds
    s_add_u32 m0, m0, 1024
    s_add_u32 s91, s91, 10240
    buffer_load_dwordx4 v180, s[12:15], s91 offen nt lds
    s_add_u32 m0, m0, 1024
    s_add_u32 s91, s91, 10240
    buffer_load_dwordx4 v181, s[12:15], s91 offen nt lds
    s_add_u32 m0, m0, 1024
    s_add_u32 s91, s91, 10240
    buffer_load_dwordx4 v180, s[12:15], s91 offen nt lds
    s_add_u32 m0, m0, 1024
    s_add_u32 s91, s91, 10240
    buffer_load_dwordx4 v181, s[12:15], s91 offen nt lds
    s_add_u32 m0, m0, 1024
    s_add_u32 s91, s91, 10240
    buffer_load_dwordx4 v180, s[12:15], s91 offen nt lds
    s_add_u32 m0, m0, 1024
    s_add_u32 s91, s91, 10240
    buffer_load_dwordx4 v181, s[12:15], s91 offen nt lds
    s_waitcnt vmcnt(24)
    v_min_u32 v164, -2, v164
    v_min_u32 v165, -2, v165
    v_min_u32 v166, -2, v166
    v_min_u32 v167, -2, v167
    v_and_b32 v7, 2, v1
    v_cmp_ne_u32 vcc, 0, v7
    v_mov_b32 v5, 0x4444
    v_mov_b32 v6, 0xeeee
    v_cndmask_b32 v10, v5, v6, vcc
    v_mov_b32 v5, 0xe484
    v_mov_b32 v6, 0xee9e
    v_cndmask_b32 v7, v5, v6, vcc
    v_mov_b32 v5, 0x84e4
    v_mov_b32 v6, 0x9eee
    v_cndmask_b32 v8, v5, v6, vcc
    v_cmp_gt_u32 vcc, 2, v2
    s_nop 1
    v_cndmask_b32 v11, v8, v7, vcc
    v_mov_b32 v84, 1065369472
    v_mov_b32 v85, 1065369472
    v_mov_b32 v86, 1065369472
    v_mov_b32 v87, 0
    v_mov_b32 v88, 1065369472
    v_mov_b32 v89, 1065369472
    v_mov_b32 v90, 1065369472
    v_mov_b32 v91, 0
    v_mov_b32 v51, 0
    v_mov_b32 v55, 0
    v_mov_b32 v59, 0
    v_mov_b32 v63, 0
    v_mov_b32 v67, 0
    v_mov_b32 v71, 0
    v_mov_b32 v75, 0
    v_mov_b32 v79, 0
    v_mov_b32 v210, 0
    v_mov_b32 v211, 0
    v_mov_b32 v218, 0
    v_mov_b32 v219, 0
    v_and_b32 v7, 1, v1
    v_cmp_ne_u32 vcc, 0, v7
    v_mov_b32 v5, 0x3f80
    v_mov_b32 v6, 0x3f800000
    v_cndmask_b32 v5, v5, v6, vcc
    v_bfe_u32 v6, v1, 1, 1
    v_cmp_eq_u32 vcc, 0, v6
    s_nop 1
    v_cndmask_b32 v110, 0, v5, vcc
    v_mov_b32 v108, 0
    v_mov_b32 v112, 0
    v_cmp_eq_u32 vcc, 1, v6
    s_nop 1
    v_cndmask_b32 v111, 0, v5, vcc
    v_mov_b32 v109, 0
    v_mov_b32 v113, 0
    v_mov_b32 v240, 0x3dd53b95
    v_mov_b32 v241, 0x3dd53b95
    s_lshl_b32 s90, s32, 8
    s_add_u32 s90, s90, 122880
    v_mul_u32_u24 v6, 1152, v2
    v_lshl_add_u32 v6, v1, 3, v6
    v_add_u32 v19, s90, v6
    s_mul_i32 s90, s32, 1536
    v_add_u32 v20, s90, v12
    s_add_u32 s90, s90, 1024
    v_lshl_add_u32 v21, v0, 3, s90
    s_mul_i32 s90, s32, 6144
    v_add_u32 v22, s90, v12
    s_add_u32 s90, s90, 1024
    v_lshl_add_u32 v23, v0, 3, s90
    v_add_u32 v28, 98304, v12
    s_mul_i32 s90, s32, 3072
    v_add_u32 v37, s90, v12
    v_add_u32 v44, 25600, v37
    s_add_u32 s54, s90, 98304
    s_mul_i32 s90, s32, 3840
    s_add_u32 s90, s90, 10240
    v_add_u32 v38, s90, v12
    s_add_u32 s90, s90, 1024
    v_add_u32 v39, s90, v13
    s_mul_i32 s90, s32, 12288
    v_add_u32 v40, s90, v12
    s_lshl_b32 s93, s40, 2
    s_add_u32 s93, s93, s32
    s_nop 0
    s_lshr_b32 s90, s93, 2
    s_lshl_b32 s90, s90, 15
    s_and_b32 s92, s93, 3
    s_lshl_b32 s92, s92, 10
    s_add_u32 s90, s90, s92
    v_mov_b32 v5, s34
    v_and_b32 v6, 7, v1
    v_lshlrev_b32 v6, 4, v6
    v_lshl_add_u32 v6, v5, 7, v6
    v_lshrrev_b32 v7, 3, v1
    v_lshl_add_u32 v6, v7, 12, v6
    v_lshrrev_b32 v5, 1, v2
    v_lshl_add_u32 v6, v5, 13, v6
    v_and_b32 v5, 1, v2
    v_lshl_add_u32 v6, v5, 14, v6
    v_add_u32 v30, s90, v6
    s_and_b32 s91, s34, 1
    s_lshl_b32 s91, s91, 12
    s_add_u32 s90, s90, s91
    s_lshr_b32 s91, s34, 2
    s_lshl_b32 s91, s91, 13
    s_add_u32 s90, s90, s91
    s_and_b32 s91, s34, 2
    s_lshl_b32 s91, s91, 13
    s_add_u32 s90, s90, s91
    v_lshl_add_u32 v31, v0, 4, s90
    s_lshl_b32 s91, s93, 10
    s_add_u32 s91, s91, 884736
    v_lshl_add_u32 v15, v0, 4, s91
    s_lshr_b32 s91, s34, 1
    s_mul_i32 s91, s91, 10240
    s_lshl_b32 s92, s93, 5
    s_add_u32 s91, s91, s92
    s_and_b32 s92, s34, 1
    s_mul_i32 s92, s92, 40960
    s_add_u32 s91, s91, s92
    s_add_u32 s91, s91, 1280
    v_mul_u32_u24 v6, 2560, v2
    v_lshl_add_u32 v6, v1, 1, v6
    v_add_u32 v32, s91, v6
    v_cmp_gt_u32 s[58:59], 8, v1
    v_and_b32 v5, 1, v1
    v_lshrrev_b32 v6, 3, v1
    v_lshl_add_u32 v5, v5, 1, v6
    v_bfe_u32 v6, v1, 2, 1
    v_cmp_ne_u32 vcc, 0, v6
    v_mov_b32 v6, 0x3f80
    v_mov_b32 v7, 0x3f800000
    v_cndmask_b32 v6, v6, v7, vcc
    v_cmp_eq_u32 vcc, 0, v5
    s_nop 1
    v_cndmask_b32 v7, 0, v6, vcc
    v_accvgpr_write_b32 a144, v7
    v_cmp_eq_u32 vcc, 1, v5
    s_nop 1
    v_cndmask_b32 v7, 0, v6, vcc
    v_accvgpr_write_b32 a145, v7
    v_cmp_eq_u32 vcc, 2, v5
    s_nop 1
    v_cndmask_b32 v7, 0, v6, vcc
    v_accvgpr_write_b32 a146, v7
    v_cmp_eq_u32 vcc, 3, v5
    s_nop 1
    v_cndmask_b32 v7, 0, v6, vcc
    v_accvgpr_write_b32 a147, v7
    s_lshl_b32 s90, s32, 7
    v_add_u32 v5, s90, v13
    v_add_u32 v6, 458752, v5
    v_add_u32 v7, 459728, v5
    v_cmp_gt_u32 vcc, 12, v0
    s_nop 1
    v_cndmask_b32 v33, v7, v6, vcc
    v_mov_b32 v5, -2
    v_cndmask_b32 v34, v5, 3, vcc
    v_cmp_gt_u32 vcc, 14, v0
    v_mov_b32 v9, 2146435072
    s_nop 0
    v_cndmask_b32 v33, v9, v33, vcc
    v_mov_b32 v5, -1000
    v_cndmask_b32 v34, v5, v34, vcc
    v_and_b32 v4, 3, v1
    v_lshlrev_b32 v6, 6, v4
    v_lshl_add_u32 v6, v3, 3, v6
    v_lshl_add_u32 v6, v2, 8, v6
    v_and_b32 v5, 1, v2
    v_lshl_add_u32 v6, v5, 5, v6
    s_mul_i32 s90, s32, 3072
    s_add_u32 s53, s90, 131072
    v_add_u32 v16, s53, v6
    v_xor_b32 v13, 32, v16
    v_and_b32 v4, 3, v1
    v_and_b32 v5, 1, v2
    v_lshl_add_u32 v6, v2, 3, v3
    v_lshlrev_b32 v6, 7, v6
    v_and_b32 v7, 2, v3
    v_lshl_or_b32 v7, v5, 2, v7
    v_lshrrev_b32 v8, 1, v4
    v_xor_b32 v7, v7, v8
    v_lshl_add_u32 v6, v7, 4, v6
    v_and_b32 v7, 1, v4
    v_lshl_add_u32 v6, v7, 3, v6
    s_mul_i32 s90, s32, 24576
    v_add_u32 v6, s90, v6
    v_xor_b32 v182, 0, v6
    v_xor_b32 v183, 32, v6
    v_xor_b32 v184, 64, v6
    v_xor_b32 v185, 96, v6
    s_waitcnt vmcnt(0)
    ds_read_b64_tr_b16 a[0:1], v182 offset:0
    ds_read_b64_tr_b16 a[2:3], v182 offset:512
    ds_read_b64_tr_b16 a[4:5], v182 offset:4096
    ds_read_b64_tr_b16 a[6:7], v182 offset:4608
    ds_read_b64_tr_b16 a[8:9], v182 offset:8192
    ds_read_b64_tr_b16 a[10:11], v182 offset:8704
    ds_read_b64_tr_b16 a[12:13], v182 offset:12288
    ds_read_b64_tr_b16 a[14:15], v182 offset:12800
    ds_read_b64_tr_b16 a[16:17], v182 offset:16384
    ds_read_b64_tr_b16 a[18:19], v182 offset:16896
    ds_read_b64_tr_b16 a[20:21], v182 offset:20480
    ds_read_b64_tr_b16 a[22:23], v182 offset:20992
    ds_read_b64_tr_b16 a[24:25], v183 offset:0
    ds_read_b64_tr_b16 a[26:27], v183 offset:512
    ds_read_b64_tr_b16 a[28:29], v183 offset:4096
    ds_read_b64_tr_b16 a[30:31], v183 offset:4608
    ds_read_b64_tr_b16 a[32:33], v183 offset:8192
    ds_read_b64_tr_b16 a[34:35], v183 offset:8704
    ds_read_b64_tr_b16 a[36:37], v183 offset:12288
    ds_read_b64_tr_b16 a[38:39], v183 offset:12800
    ds_read_b64_tr_b16 a[40:41], v183 offset:16384
    ds_read_b64_tr_b16 a[42:43], v183 offset:16896
    ds_read_b64_tr_b16 a[44:45], v183 offset:20480
    ds_read_b64_tr_b16 a[46:47], v183 offset:20992
    ds_read_b64_tr_b16 a[48:49], v184 offset:0
    ds_read_b64_tr_b16 a[50:51], v184 offset:512
    ds_read_b64_tr_b16 a[52:53], v184 offset:4096
    ds_read_b64_tr_b16 a[54:55], v184 offset:4608
    ds_read_b64_tr_b16 a[56:57], v184 offset:8192
    ds_read_b64_tr_b16 a[58:59], v184 offset:8704
    ds_read_b64_tr_b16 a[60:61], v184 offset:12288
    ds_read_b64_tr_b16 a[62:63], v184 offset:12800
    ds_read_b64_tr_b16 a[64:65], v184 offset:16384
    ds_read_b64_tr_b16 a[66:67], v184 offset:16896
    ds_read_b64_tr_b16 a[68:69], v184 offset:20480
    ds_read_b64_tr_b16 a[70:71], v184 offset:20992
    ds_read_b64_tr_b16 a[72:73], v185 offset:0
    ds_read_b64_tr_b16 a[74:75], v185 offset:512
    ds_read_b64_tr_b16 a[76:77], v185 offset:4096
    ds_read_b64_tr_b16 a[78:79], v185 offset:4608
    ds_read_b64_tr_b16 a[80:81], v185 offset:8192
    ds_read_b64_tr_b16 a[82:83], v185 offset:8704
    ds_read_b64_tr_b16 a[84:85], v185 offset:12288
    ds_read_b64_tr_b16 a[86:87], v185 offset:12800
    ds_read_b64_tr_b16 a[88:89], v185 offset:16384
    ds_read_b64_tr_b16 a[90:91], v185 offset:16896
    ds_read_b64_tr_b16 a[92:93], v185 offset:20480
    ds_read_b64_tr_b16 a[94:95], v185 offset:20992
    s_waitcnt lgkmcnt(0)
    s_barrier
    v_mov_b32 v1, 196
L_gw_95:
    buffer_load_dword v2, v1, s[8:11], 0 offen sc1
    s_sub_u32 s36, s36, 1
    s_cbranch_scc1 L_exit
    s_waitcnt vmcnt(0)
L_gw_95c:
    v_readfirstlane_b32 s90, v2
    s_nop 0
    s_cmp_eq_u32 s90, 0
    s_cbranch_scc1 L_gw_95
    buffer_store_dwordx4 v[164:167], v17, s[4:7], s38 offen sc1
    s_mov_b32 s37, -1
    v_add_u32 v35, -2, v34
    s_add_u32 s45, s38, 65536
    s_add_u32 s46, s45, 4096
    s_add_u32 s47, s45, 8192
    v_mov_b32 v24, v20
    v_mov_b32 v25, v21
    buffer_load_dword v36, v33, s[4:7], s38 offen sc1
    s_waitcnt vmcnt(0)
    v_cmp_lt_i32 vcc, v36, v35
    s_cbranch_vccz L_fok_97
L_fw_96:
    buffer_load_dword v36, v33, s[4:7], s38 offen sc1
    s_sub_u32 s36, s36, 1
    s_cbranch_scc1 L_exit
    s_waitcnt vmcnt(0)
    v_cmp_lt_i32 vcc, v36, v35
    s_cbranch_vccnz L_fw_96
L_fok_97:
    buffer_load_dwordx4 a[96:99], v40, s[4:7], s45 offen offset:0 sc1
    buffer_load_dwordx4 a[100:103], v40, s[4:7], s45 offen offset:1024 sc1
    buffer_load_dwordx4 a[104:107], v40, s[4:7], s45 offen offset:2048 sc1
    buffer_load_dwordx4 a[108:111], v40, s[4:7], s45 offen offset:3072 sc1
    buffer_load_dwordx4 a[112:115], v40, s[4:7], s46 offen offset:0 sc1
    buffer_load_dwordx4 a[116:119], v40, s[4:7], s46 offen offset:1024 sc1
    buffer_load_dwordx4 a[120:123], v40, s[4:7], s46 offen offset:2048 sc1
    buffer_load_dwordx4 a[124:127], v40, s[4:7], s46 offen offset:3072 sc1
    buffer_load_dwordx4 a[128:131], v40, s[4:7], s47 offen offset:0 sc1
    buffer_load_dwordx4 a[132:135], v40, s[4:7], s47 offen offset:1024 sc1
    buffer_load_dwordx4 a[136:139], v40, s[4:7], s47 offen offset:2048 sc1
    buffer_load_dwordx4 a[140:143], v40, s[4:7], s47 offen offset:3072 sc1
    s_waitcnt vmcnt(0)
    v_mfma_f32_16x16x32_bf16 v[148:151], a[96:99], a[0:3], 0
    v_mfma_f32_16x16x32_bf16 v[152:155], a[120:123], a[0:3], 0
    v_mfma_f32_16x16x32_bf16 v[156:159], a[96:99], a[24:27], 0
    v_mfma_f32_16x16x32_bf16 v[160:163], a[120:123], a[24:27], 0
    v_mfma_f32_16x16x32_bf16 v[180:183], a[96:99], a[48:51], 0
    v_mfma_f32_16x16x32_bf16 v[184:187], a[120:123], a[48:51], 0
    v_mfma_f32_16x16x32_bf16 v[188:191], a[96:99], a[72:75], 0
    v_mfma_f32_16x16x32_bf16 v[192:195], a[120:123], a[72:75], 0
    v_mfma_f32_16x16x32_bf16 v[148:151], a[100:103], a[4:7], v[148:151]
    v_mfma_f32_16x16x32_bf16 v[152:155], a[124:127], a[4:7], v[152:155]
    v_mfma_f32_16x16x32_bf16 v[156:159], a[100:103], a[28:31], v[156:159]
    v_mfma_f32_16x16x32_bf16 v[160:163], a[124:127], a[28:31], v[160:163]
    v_mfma_f32_16x16x32_bf16 v[180:183], a[100:103], a[52:55], v[180:183]
    v_mfma_f32_16x16x32_bf16 v[184:187], a[124:127], a[52:55], v[184:187]
    v_mfma_f32_16x16x32_bf16 v[188:191], a[100:103], a[76:79], v[188:191]
    v_mfma_f32_16x16x32_bf16 v[192:195], a[124:127], a[76:79], v[192:195]
    v_mfma_f32_16x16x32_bf16 v[148:151], a[104:107], a[8:11], v[148:151]
    v_mfma_f32_16x16x32_bf16 v[152:155], a[128:131], a[8:11], v[152:155]
    v_mfma_f32_16x16x32_bf16 v[156:159], a[104:107], a[32:35], v[156:159]
    v_mfma_f32_16x16x32_bf16 v[160:163], a[128:131], a[32:35], v[160:163]
    v_mfma_f32_16x16x32_bf16 v[180:183], a[104:107], a[56:59], v[180:183]
    v_mfma_f32_16x16x32_bf16 v[184:187], a[128:131], a[56:59], v[184:187]
    v_mfma_f32_16x16x32_bf16 v[188:191], a[104:107], a[80:83], v[188:191]
    v_mfma_f32_16x16x32_bf16 v[192:195], a[128:131], a[80:83], v[192:195]
    v_mfma_f32_16x16x32_bf16 v[148:151], a[108:111], a[12:15], v[148:151]
    v_mfma_f32_16x16x32_bf16 v[152:155], a[132:135], a[12:15], v[152:155]
    v_mfma_f32_16x16x32_bf16 v[156:159], a[108:111], a[36:39], v[156:159]
    v_mfma_f32_16x16x32_bf16 v[160:163], a[132:135], a[36:39], v[160:163]
    v_mfma_f32_16x16x32_bf16 v[180:183], a[108:111], a[60:63], v[180:183]
    v_mfma_f32_16x16x32_bf16 v[184:187], a[132:135], a[60:63], v[184:187]
    v_mfma_f32_16x16x32_bf16 v[188:191], a[108:111], a[84:87], v[188:191]
    v_mfma_f32_16x16x32_bf16 v[192:195], a[132:135], a[84:87], v[192:195]
    v_mfma_f32_16x16x32_bf16 v[148:151], a[112:115], a[16:19], v[148:151]
    v_mfma_f32_16x16x32_bf16 v[152:155], a[136:139], a[16:19], v[152:155]
    v_mfma_f32_16x16x32_bf16 v[156:159], a[112:115], a[40:43], v[156:159]
    v_mfma_f32_16x16x32_bf16 v[160:163], a[136:139], a[40:43], v[160:163]
    v_mfma_f32_16x16x32_bf16 v[180:183], a[112:115], a[64:67], v[180:183]
    v_mfma_f32_16x16x32_bf16 v[184:187], a[136:139], a[64:67], v[184:187]
    v_mfma_f32_16x16x32_bf16 v[188:191], a[112:115], a[88:91], v[188:191]
    v_mfma_f32_16x16x32_bf16 v[192:195], a[136:139], a[88:91], v[192:195]
    v_mfma_f32_16x16x32_bf16 v[148:151], a[116:119], a[20:23], v[148:151]
    v_mfma_f32_16x16x32_bf16 v[152:155], a[140:143], a[20:23], v[152:155]
    v_mfma_f32_16x16x32_bf16 v[156:159], a[116:119], a[44:47], v[156:159]
    v_mfma_f32_16x16x32_bf16 v[160:163], a[140:143], a[44:47], v[160:163]
    v_mfma_f32_16x16x32_bf16 v[180:183], a[116:119], a[68:71], v[180:183]
    v_mfma_f32_16x16x32_bf16 v[184:187], a[140:143], a[68:71], v[184:187]
    v_mfma_f32_16x16x32_bf16 v[188:191], a[116:119], a[92:95], v[188:191]
    v_mfma_f32_16x16x32_bf16 v[192:195], a[140:143], a[92:95], v[192:195]
    v_cvt_pk_bf16_f32 v64, v180, v181
    v_cvt_pk_bf16_f32 v65, v182, v183
    ds_write_b64 v24, v[64:65] offset:12288
    v_cvt_pk_bf16_f32 v68, v184, v185
    v_cvt_pk_bf16_f32 v69, v186, v187
    ds_write_b64 v25, v[68:69] offset:12288
    v_cvt_pk_bf16_f32 v72, v188, v189
    v_cvt_pk_bf16_f32 v73, v190, v191
    ds_write_b64 v24, v[72:73] offset:18432
    v_cvt_pk_bf16_f32 v76, v192, v193
    v_cvt_pk_bf16_f32 v77, v194, v195
    ds_write_b64 v25, v[76:77] offset:18432
    v_cvt_pk_bf16_f32 v48, v148, v149
    v_cvt_pk_bf16_f32 v49, v150, v151
    ds_write_b64 v24, v[48:49] offset:0
    v_cvt_pk_bf16_f32 v52, v152, v153
    v_cvt_pk_bf16_f32 v53, v154, v155
    ds_write_b64 v25, v[52:53] offset:0
    v_cvt_pk_bf16_f32 v56, v156, v157
    v_cvt_pk_bf16_f32 v57, v158, v159
    ds_write_b64 v24, v[56:57] offset:6144
    v_cvt_pk_bf16_f32 v60, v160, v161
    v_cvt_pk_bf16_f32 v61, v162, v163
    ds_write_b64 v25, v[60:61] offset:6144
    s_add_u32 s56, s37, 2
    s_and_b32 s55, s56, 3
    s_mul_i32 s55, s55, 114688
    s_add_u32 s55, s55, 65536
    s_add_u32 s45, s38, s55
    s_add_u32 s46, s45, 4096
    s_add_u32 s47, s45, 8192
    s_add_u32 s56, s37, -1
    s_and_b32 s55, s56, 3
    s_mul_i32 s55, s55, 114688
    s_add_u32 s55, s55, 53248
    s_add_u32 s48, s38, s55
    s_and_b32 s55, s56, 1
    s_add_u32 s56, s56, 1
    v_mov_b32 v35, -16
    v_writelane_b32 v35, s56, 12
    s_mul_i32 s55, s55, 12288
    s_add_u32 m0, s54, s55
    v_add_u32 v35, -1, v34
    buffer_load_dword v36, v33, s[4:7], s38 offen sc1
    s_waitcnt vmcnt(0)
    v_cmp_lt_i32 vcc, v36, v35
    s_cbranch_vccz L_fok_99
L_fw_98:
    buffer_load_dword v36, v33, s[4:7], s38 offen sc1
    s_sub_u32 s36, s36, 1
    s_cbranch_scc1 L_exit
    s_waitcnt vmcnt(0)
    v_cmp_lt_i32 vcc, v36, v35
    s_cbranch_vccnz L_fw_98
L_fok_99:
    buffer_load_dwordx4 a[96:99], v40, s[4:7], s45 offen offset:0 sc1
    buffer_load_dwordx4 a[100:103], v40, s[4:7], s45 offen offset:1024 sc1
    buffer_load_dwordx4 a[104:107], v40, s[4:7], s45 offen offset:2048 sc1
    buffer_load_dwordx4 a[108:111], v40, s[4:7], s45 offen offset:3072 sc1
    buffer_load_dwordx4 a[112:115], v40, s[4:7], s46 offen offset:0 sc1
    buffer_load_dwordx4 a[116:119], v40, s[4:7], s46 offen offset:1024 sc1
    buffer_load_dwordx4 a[120:123], v40, s[4:7], s46 offen offset:2048 sc1
    buffer_load_dwordx4 a[124:127], v40, s[4:7], s46 offen offset:3072 sc1
    buffer_load_dwordx4 a[128:131], v40, s[4:7], s47 offen offset:0 sc1
    buffer_load_dwordx4 a[132:135], v40, s[4:7], s47 offen offset:1024 sc1
    buffer_load_dwordx4 a[136:139], v40, s[4:7], s47 offen offset:2048 sc1
    buffer_load_dwordx4 a[140:143], v40, s[4:7], s47 offen offset:3072 sc1
    s_mov_b32 s50, s42
    s_add_u32 s56, s37, 1
    v_mov_b32 v47, v24
    s_and_b32 s55, s56, 3
    s_mul_i32 s41, s55, 327680
    s_mul_i32 s56, s55, 114688
    s_add_u32 s43, s38, s56
    s_xor_b32 s55, s55, 2
    s_mul_i32 s42, s55, 327680
    s_add_u32 s56, s37, 2
    v_mov_b32 v107, s56
    s_and_b32 s55, s56, 3
    s_mul_i32 s44, s55, 24576
    s_add_u32 s56, s37, -1
    s_and_b32 s55, s56, 3
    s_mul_i32 s55, s55, 40960
    s_add_u32 s49, s55, s38
    s_add_u32 s56, s37, -1
    s_and_b32 s55, s56, 3
    s_mul_i32 s55, s55, 24576
    v_add_u32 v26, s55, v22
    v_add_u32 v27, s55, v23
    s_and_b32 s55, s56, 1
    s_mul_i32 s55, s55, 12288
    v_add_u32 v29, s55, v28
    s_add_u32 s37, s37, 1
    s_mov_b32 m0, s53
    v_add_u32 v24, s44, v20
    v_add_u32 v25, s44, v21
    v_pk_mul_f32 v[148:149], v[210:211], v[210:211]
    v_pk_mul_f32 v[150:151], v[210:211], v[210:211]
    v_pk_mul_f32 v[152:153], v[210:211], v[210:211]
    v_pk_mul_f32 v[154:155], v[210:211], v[210:211]
    v_pk_mul_f32 v[156:157], v[210:211], v[210:211]
    v_pk_mul_f32 v[158:159], v[210:211], v[210:211]
    v_pk_mul_f32 v[160:161], v[210:211], v[210:211]
    v_pk_mul_f32 v[162:163], v[210:211], v[210:211]
    v_mov_b32 v120, 0
    v_mov_b32 v121, 0
    v_mov_b32 v122, 0
    v_mov_b32 v123, 0
    v_mov_b32 v124, 0
    v_mov_b32 v125, 0
    v_mov_b32 v126, 0
    v_mov_b32 v127, 0
    v_mov_b32 v128, 0
    v_mov_b32 v129, 0
    v_mov_b32 v130, 0
    v_mov_b32 v131, 0
    v_mov_b32 v132, 0
    v_mov_b32 v133, 0
    v_mov_b32 v134, 0
    v_mov_b32 v135, 0
    v_mov_b32 v116, 0
    v_mov_b32 v117, 0
    v_mov_b32 v118, 0
    v_mov_b32 v119, 0
L_wo_loop_s:
    buffer_load_dword v41, v245, s[4:7], s38 offen sc1
    buffer_load_dword v41, v245, s[4:7], s38 offen sc1
    buffer_load_dword v41, v245, s[4:7], s38 offen sc1
    buffer_load_dword v41, v245, s[4:7], s38 offen sc1
    buffer_load_dword v41, v245, s[4:7], s38 offen sc1
    buffer_load_dword v41, v245, s[4:7], s38 offen sc1
L_sp_103:
    s_waitcnt vmcnt(5)
    v_cmp_ge_u32 vcc, s37, v41
    buffer_load_dword v41, v245, s[4:7], s38 offen sc1
    s_sub_u32 s36, s36, 1
    s_cbranch_scc1 L_exit
    s_cbranch_vccz L_sp_103x
    s_waitcnt vmcnt(5)
    v_cmp_ge_u32 vcc, s37, v41
    buffer_load_dword v41, v245, s[4:7], s38 offen sc1
    s_cbranch_vccz L_sp_103x
    s_waitcnt vmcnt(5)
    v_cmp_ge_u32 vcc, s37, v41
    buffer_load_dword v41, v245, s[4:7], s38 offen sc1
    s_cbranch_vccz L_sp_103x
    s_waitcnt vmcnt(5)
    v_cmp_ge_u32 vcc, s37, v41
    buffer_load_dword v41, v245, s[4:7], s38 offen sc1
    s_cbranch_vccnz L_sp_103
L_sp_103x:
    buffer_store_dword v107, v45, s[4:7], s38 offen sc1
    buffer_load_dwordx4 v44, s[4:7], s43 offen offset:0 sc1 lds
    buffer_load_dwordx4 v44, s[4:7], s43 offen offset:1024 sc1 lds
    buffer_load_dwordx4 v44, s[4:7], s43 offen offset:2048 sc1 lds
    s_cmp_eq_u32 s37, 63
    s_waitcnt vmcnt(2)
    ds_read_b64_tr_b16 v[136:137], v16 offset:0
    ds_read_b64_tr_b16 v[138:139], v13 offset:0
    s_waitcnt vmcnt(1)
    ds_read_b64_tr_b16 v[140:141], v16 offset:1024
    ds_read_b64_tr_b16 v[142:143], v13 offset:1024
    s_waitcnt vmcnt(0)
    ds_read_b64_tr_b16 v[144:145], v16 offset:2048
    ds_read_b64_tr_b16 v[146:147], v13 offset:2048
    buffer_load_dwordx4 v[92:95], v38, s[4:7], s43 offen offset:0 sc1
    buffer_load_dwordx4 v[96:99], v38, s[4:7], s43 offen offset:1280 sc1
    buffer_load_dwordx4 v[100:103], v38, s[4:7], s43 offen offset:2560 sc1
    s_waitcnt lgkmcnt(4)
    v_smfmac_f32_16x16x64_bf16 v[148:151], v[136:139], a[0:7], v10
    v_smfmac_f32_16x16x64_bf16 v[152:155], v[136:139], a[24:31], v10
    v_smfmac_f32_16x16x64_bf16 v[156:159], v[136:139], a[48:55], v10
    v_smfmac_f32_16x16x64_bf16 v[160:163], v[136:139], a[72:79], v10
    buffer_load_dword v104, v39, s[4:7], s43 offen offset:0 sc1
    s_waitcnt lgkmcnt(2)
    v_smfmac_f32_16x16x64_bf16 v[148:151], v[140:143], a[8:15], v10
    buffer_load_dword v105, v39, s[4:7], s43 offen offset:1280 sc1
    v_smfmac_f32_16x16x64_bf16 v[152:155], v[140:143], a[32:39], v10
    buffer_load_dword v106, v39, s[4:7], s43 offen offset:2560 sc1
    v_smfmac_f32_16x16x64_bf16 v[156:159], v[140:143], a[56:63], v10
    v_smfmac_f32_16x16x64_bf16 v[160:163], v[140:143], a[80:87], v10
    s_waitcnt lgkmcnt(0)
    v_smfmac_f32_16x16x64_bf16 v[148:151], v[144:147], a[16:23], v10
    v_smfmac_f32_16x16x64_bf16 v[152:155], v[144:147], a[40:47], v10
    v_smfmac_f32_16x16x64_bf16 v[156:159], v[144:147], a[64:71], v10
    v_smfmac_f32_16x16x64_bf16 v[160:163], v[144:147], a[88:95], v10
    v_pk_add_f32 v[148:149], v[148:149], v[150:151]
    v_cmp_u_f32 vcc, v148, v149
    v_cvt_pk_bf16_f32 v50, v148, v149
    v_cvt_pk_bf16_f32 v54, v148, v149
    v_pk_add_f32 v[152:153], v[152:153], v[154:155]
    v_cvt_pk_bf16_f32 v58, v152, v153
    v_cvt_pk_bf16_f32 v62, v152, v153
    v_pk_add_f32 v[156:157], v[156:157], v[158:159]
    v_cvt_pk_bf16_f32 v66, v156, v157
    v_cvt_pk_bf16_f32 v70, v156, v157
    v_pk_add_f32 v[160:161], v[160:161], v[162:163]
    v_cvt_pk_bf16_f32 v74, v160, v161
    v_cvt_pk_bf16_f32 v78, v160, v161
    s_cbranch_vccnz L_vm_101
L_u_102:
    s_cbranch_scc1 L_wo_tail_s
L_sc_104:
    s_waitcnt vmcnt(4)
    v_pk_add_f32 v[236:237], v[92:93], v[96:97]
    v_pk_add_f32 v[238:239], v[94:95], v[98:99]
    s_waitcnt vmcnt(3)
    v_pk_add_f32 v[236:237], v[236:237], v[100:101]
    v_pk_add_f32 v[238:239], v[238:239], v[102:103]
    v_pk_mul_f32 v[236:237], v[236:237], v[240:241]
    v_pk_mul_f32 v[238:239], v[238:239], v[240:241]
    v_max3_f32 v41, v236, v237, v238
    v_pk_add_f32 v[242:243], v[236:237], v[238:239]
    s_waitcnt vmcnt(0)
    v_add_f32 v43, v104, v105
    v_add_f32 v43, v43, v106
    v_mul_f32 v43, v43, v240
    v_max3_f32 v41, v41, v239, v43
    v_add_f32 v242, v242, v43
    s_nop 0
    v_max_f32_dpp v42, v41, v41 quad_perm:[2,3,0,1] row_mask:0xf bank_mask:0xf
    v_max_f32_dpp v41, v41, v41 quad_perm:[2,3,0,1] row_mask:0xf bank_mask:0xf
    v_cmp_u_f32 vcc, v242, v243
    s_nop 0
    v_permlane16_swap_b32 v41, v42
    v_max_f32 v41, v41, v42
    v_mov_b32 v42, v41
    s_cbranch_vccnz L_sp_105
L_sg_106:
    s_nop 0
    v_permlane32_swap_b32 v41, v42
    v_max_f32 v242, v41, v42
    v_pk_add_f32 v[236:237], v[236:237], v[242:243] op_sel_hi:[1,0] neg_lo:[0,1] neg_hi:[0,1]
    v_pk_add_f32 v[238:239], v[238:239], v[242:243] op_sel_hi:[1,0] neg_lo:[0,1] neg_hi:[0,1]
    v_sub_f32 v43, v43, v242
    v_exp_f32 v236, v236
    v_exp_f32 v237, v237
    v_exp_f32 v238, v238
    v_exp_f32 v239, v239
    v_exp_f32 v43, v43
    v_cvt_pk_bf16_f32 v80, v236, v237
    v_cvt_pk_bf16_f32 v82, v238, v239
    v_cvt_pk_bf16_f32 v81, v43, 0
    v_cvt_pk_bf16_f32 v83, v43, 0
    s_nop 1
    v_smfmac_f32_16x16x64_bf16 v[116:119], v[80:83], v[84:91], v11
    v_smfmac_f32_16x16x64_bf16 v[120:123], v[80:83], v[48:55], v11
    v_smfmac_f32_16x16x64_bf16 v[124:127], v[80:83], v[56:63], v11
    v_smfmac_f32_16x16x64_bf16 v[128:131], v[80:83], v[64:71], v11
    v_add_f32 v116, v116, v118
    v_add_f32 v117, v117, v119
    v_smfmac_f32_16x16x64_bf16 v[132:135], v[80:83], v[72:79], v11
    v_rcp_f32 v116, v116
    v_rcp_f32 v117, v117
    v_pk_add_f32 v[120:121], v[120:121], v[122:123]
    v_pk_mul_f32 v[120:121], v[120:121], v[116:117]
    v_cvt_pk_bf16_f32 v236, v120, v121
    v_pk_add_f32 v[124:125], v[124:125], v[126:127]
    v_pk_mul_f32 v[124:125], v[124:125], v[116:117]
    v_cvt_pk_bf16_f32 v237, v124, v125
    ds_write2st64_b32 v18, v236, v237 offset0:0 offset1:1
    v_pk_add_f32 v[128:129], v[128:129], v[130:131]
    v_pk_mul_f32 v[128:129], v[128:129], v[116:117]
    v_cvt_pk_bf16_f32 v238, v128, v129
    v_pk_add_f32 v[132:133], v[132:133], v[134:135]
    v_pk_mul_f32 v[132:133], v[132:133], v[116:117]
    v_cvt_pk_bf16_f32 v239, v132, v133
    ds_write2st64_b32 v18, v238, v239 offset0:2 offset1:3
    buffer_store_dword v107, v244, s[4:7], s38 offen sc1
    v_mov_b32 v120, 0
    v_mov_b32 v121, 0
    v_mov_b32 v122, 0
    v_mov_b32 v123, 0
    v_mov_b32 v124, 0
    v_mov_b32 v125, 0
    v_mov_b32 v126, 0
    v_mov_b32 v127, 0
    v_mov_b32 v128, 0
    v_mov_b32 v129, 0
    s_waitcnt lgkmcnt(0)
    s_barrier
    ds_read_b64_tr_b16 v[80:81], v19
    ds_read_b64_tr_b16 v[82:83], v19 offset:128
    v_mov_b32 v130, 0
    v_mov_b32 v131, 0
    v_mov_b32 v132, 0
    v_mov_b32 v133, 0
    v_mov_b32 v134, 0
    v_mov_b32 v135, 0
    v_mov_b32 v116, 0
    v_mov_b32 v117, 0
    v_mov_b32 v118, 0
    v_mov_b32 v119, 0
    s_waitcnt lgkmcnt(0)
    v_mfma_f32_16x16x32_bf16 v[172:175], v[110:113], v[80:83], 0
    v_mfma_f32_16x16x32_bf16 v[176:179], v[108:111], v[80:83], 0
    buffer_load_dword v36, v33, s[4:7], s38 offen sc1
    s_nop 3
    v_cvt_pk_bf16_f32 v236, v172, v173
    v_cvt_pk_bf16_f32 v237, v174, v175
    s_nop 0
    v_cvt_pk_bf16_f32 v238, v176, v177
    v_cvt_pk_bf16_f32 v239, v178, v179
    buffer_store_dwordx4 v[236:239], v14, s[4:7], s41 offen sc1
    ds_write_b32 v47, v50 offset:8
    ds_write_b32 v47, v58 offset:6152
    ds_write_b32 v47, v66 offset:12296
    ds_write_b32 v47, v74 offset:18440
    ds_read_b128 v[204:207], v26 offset:0
    ds_read_b128 v[180:183], v29 offset:0
    ds_read_b128 v[184:187], v29 offset:1024
    ds_read_b64 v[208:209], v27 offset:0
    ds_read_b128 v[188:191], v29 offset:2048
    ds_read_b128 v[212:215], v26 offset:1536
    ds_read_b128 v[192:195], v29 offset:3072
    ds_read_b128 v[196:199], v29 offset:4096
    ds_read_b64 v[216:217], v27 offset:1536
    ds_read_b128 v[200:203], v29 offset:5120
    s_add_u32 s55, s42, s60
    buffer_store_dword v168, v46, s[4:7], s55 offen sc1
    s_add_u32 s55, s42, s61
    buffer_store_dword v168, v46, s[4:7], s55 offen sc1
    s_waitcnt lgkmcnt(5)
    v_mfma_f32_16x16x32_bf16 v[220:223], v[180:183], v[204:207], 0
    v_mfma_f32_16x16x32_bf16 v[224:227], v[184:187], v[204:207], 0
    v_mfma_f32_16x16x32_bf16 v[224:227], v[188:191], v[208:211], v[224:227]
    ds_read_b128 v[204:207], v26 offset:3072
    ds_read_b128 v[180:183], v29 offset:6144
    ds_read_b128 v[184:187], v29 offset:7168
    ds_read_b64 v[208:209], v27 offset:3072
    ds_read_b128 v[188:191], v29 offset:8192
    s_add_u32 s56, s37, 2
    s_and_b32 s55, s56, 3
    s_mul_i32 s55, s55, 114688
    s_add_u32 s55, s55, 65536
    s_add_u32 s45, s38, s55
    s_add_u32 s46, s45, 4096
    s_add_u32 s47, s45, 8192
    s_add_u32 s56, s37, -1
    s_and_b32 s55, s56, 3
    s_mul_i32 s55, s55, 114688
    s_add_u32 s55, s55, 53248
    s_add_u32 s48, s38, s55
    s_and_b32 s55, s56, 1
    s_add_u32 s56, s56, 1
    v_mov_b32 v35, -16
    v_writelane_b32 v35, s56, 12
    s_mul_i32 s55, s55, 12288
    s_add_u32 m0, s54, s55
    s_waitcnt lgkmcnt(5)
    v_mfma_f32_16x16x32_bf16 v[220:223], v[192:195], v[212:215], v[220:223]
    v_mfma_f32_16x16x32_bf16 v[224:227], v[196:199], v[212:215], v[224:227]
    v_mfma_f32_16x16x32_bf16 v[224:227], v[200:203], v[216:219], v[224:227]
    ds_read_b128 v[212:215], v26 offset:4608
    ds_read_b128 v[192:195], v29 offset:9216
    ds_read_b128 v[196:199], v29 offset:10240
    ds_read_b64 v[216:217], v27 offset:4608
    ds_read_b128 v[200:203], v29 offset:11264
    s_waitcnt lgkmcnt(5)
    v_mfma_f32_16x16x32_bf16 v[220:223], v[180:183], v[204:207], v[220:223]
    v_mfma_f32_16x16x32_bf16 v[224:227], v[184:187], v[204:207], v[224:227]
    v_mfma_f32_16x16x32_bf16 v[224:227], v[188:191], v[208:211], v[224:227]
    s_waitcnt lgkmcnt(0)
    v_mfma_f32_16x16x32_bf16 v[220:223], v[192:195], v[212:215], v[220:223]
    v_mfma_f32_16x16x32_bf16 v[224:227], v[196:199], v[212:215], v[224:227]
    v_mfma_f32_16x16x32_bf16 v[224:227], v[200:203], v[216:219], v[224:227]
    s_waitcnt vmcnt(3)
    v_cmp_lt_i32 vcc, v36, v35
    s_cbranch_vccz L_fok_109
L_fw_108:
    buffer_load_dword v36, v33, s[4:7], s38 offen sc1
    s_sub_u32 s36, s36, 1
    s_cbranch_scc1 L_exit
    s_waitcnt vmcnt(0)
    v_cmp_lt_i32 vcc, v36, v35
    s_cbranch_vccnz L_fw_108
L_fok_109:
    buffer_load_dwordx4 v37, s[4:7], s48 offen offset:0 sc1 lds
    buffer_load_dwordx4 v37, s[4:7], s48 offen offset:1024 sc1 lds
    buffer_load_dwordx4 v37, s[4:7], s48 offen offset:2048 sc1 lds
    v_cvt_pk_bf16_f32 v220, v220, v221
    v_cvt_pk_bf16_f32 v221, v222, v223
    v_cvt_pk_bf16_f32 v222, v224, v225
    v_cvt_pk_bf16_f32 v223, v226, v227
    v_mov_b32 v224, v220
    v_mov_b32 v225, v221
    v_mov_b32_dpp v220, v222 row_ror:8 row_mask:0xf bank_mask:0xc
    v_mov_b32_dpp v221, v223 row_ror:8 row_mask:0xf bank_mask:0xc
    v_mov_b32_dpp v222, v224 row_ror:8 row_mask:0xf bank_mask:0x3
    v_mov_b32_dpp v223, v225 row_ror:8 row_mask:0xf bank_mask:0x3
    buffer_store_dwordx4 v[220:223], v15, s[4:7], s49 offen sc1
    v_mfma_f32_16x16x32_bf16 v[148:151], a[96:99], a[0:3], 0
    s_mov_b32 s50, s42
    s_add_u32 s56, s37, 1
    v_mov_b32 v47, v24
    v_mfma_f32_16x16x32_bf16 v[152:155], a[120:123], a[0:3], 0
    s_and_b32 s55, s56, 3
    s_mul_i32 s41, s55, 327680
    s_mul_i32 s56, s55, 114688
    v_mfma_f32_16x16x32_bf16 v[156:159], a[96:99], a[24:27], 0
    s_add_u32 s43, s38, s56
    s_xor_b32 s55, s55, 2
    s_mul_i32 s42, s55, 327680
    v_mfma_f32_16x16x32_bf16 v[160:163], a[120:123], a[24:27], 0
    s_add_u32 s56, s37, 2
    v_mov_b32 v107, s56
    s_and_b32 s55, s56, 3
    v_mfma_f32_16x16x32_bf16 v[180:183], a[96:99], a[48:51], 0
    s_mul_i32 s44, s55, 24576
    s_add_u32 s56, s37, -1
    s_and_b32 s55, s56, 3
    v_mfma_f32_16x16x32_bf16 v[184:187], a[120:123], a[48:51], 0
    s_mul_i32 s55, s55, 40960
    s_add_u32 s49, s55, s38
    s_add_u32 s56, s37, -1
    v_mfma_f32_16x16x32_bf16 v[188:191], a[96:99], a[72:75], 0
    s_and_b32 s55, s56, 3
    s_mul_i32 s55, s55, 24576
    v_add_u32 v26, s55, v22
    v_mfma_f32_16x16x32_bf16 v[192:195], a[120:123], a[72:75], 0
    buffer_load_dwordx4 a[96:99], v40, s[4:7], s45 offen offset:0 sc1
    v_mfma_f32_16x16x32_bf16 v[148:151], a[100:103], a[4:7], v[148:151]
    v_add_u32 v27, s55, v23
    s_and_b32 s55, s56, 1
    s_mul_i32 s55, s55, 12288
    v_mfma_f32_16x16x32_bf16 v[152:155], a[124:127], a[4:7], v[152:155]
    buffer_load_dwordx4 a[120:123], v40, s[4:7], s46 offen offset:2048 sc1
    v_mfma_f32_16x16x32_bf16 v[156:159], a[100:103], a[28:31], v[156:159]
    v_add_u32 v29, s55, v28
    v_mfma_f32_16x16x32_bf16 v[160:163], a[124:127], a[28:31], v[160:163]
    v_mfma_f32_16x16x32_bf16 v[180:183], a[100:103], a[52:55], v[180:183]
    v_mfma_f32_16x16x32_bf16 v[184:187], a[124:127], a[52:55], v[184:187]
    v_mfma_f32_16x16x32_bf16 v[188:191], a[100:103], a[76:79], v[188:191]
    v_mfma_f32_16x16x32_bf16 v[192:195], a[124:127], a[76:79], v[192:195]
    buffer_load_dwordx4 a[100:103], v40, s[4:7], s45 offen offset:1024 sc1
    v_mfma_f32_16x16x32_bf16 v[148:151], a[104:107], a[8:11], v[148:151]
    v_mfma_f32_16x16x32_bf16 v[152:155], a[128:131], a[8:11], v[152:155]
    buffer_load_dwordx4 a[124:127], v40, s[4:7], s46 offen offset:3072 sc1
    v_mfma_f32_16x16x32_bf16 v[156:159], a[104:107], a[32:35], v[156:159]
    v_mfma_f32_16x16x32_bf16 v[160:163], a[128:131], a[32:35], v[160:163]
    v_mfma_f32_16x16x32_bf16 v[180:183], a[104:107], a[56:59], v[180:183]
    v_mfma_f32_16x16x32_bf16 v[184:187], a[128:131], a[56:59], v[184:187]
    v_mfma_f32_16x16x32_bf16 v[188:191], a[104:107], a[80:83], v[188:191]
    v_mfma_f32_16x16x32_bf16 v[192:195], a[128:131], a[80:83], v[192:195]
    buffer_load_dwordx4 a[104:107], v40, s[4:7], s45 offen offset:2048 sc1
    v_mfma_f32_16x16x32_bf16 v[148:151], a[108:111], a[12:15], v[148:151]
    v_mfma_f32_16x16x32_bf16 v[152:155], a[132:135], a[12:15], v[152:155]
    buffer_load_dwordx4 a[128:131], v40, s[4:7], s47 offen offset:0 sc1
    v_mfma_f32_16x16x32_bf16 v[156:159], a[108:111], a[36:39], v[156:159]
    v_mfma_f32_16x16x32_bf16 v[160:163], a[132:135], a[36:39], v[160:163]
    v_mfma_f32_16x16x32_bf16 v[180:183], a[108:111], a[60:63], v[180:183]
    v_mfma_f32_16x16x32_bf16 v[184:187], a[132:135], a[60:63], v[184:187]
    v_mfma_f32_16x16x32_bf16 v[188:191], a[108:111], a[84:87], v[188:191]
    v_mfma_f32_16x16x32_bf16 v[192:195], a[132:135], a[84:87], v[192:195]
    buffer_load_dwordx4 a[108:111], v40, s[4:7], s45 offen offset:3072 sc1
    v_mfma_f32_16x16x32_bf16 v[148:151], a[112:115], a[16:19], v[148:151]
    v_mfma_f32_16x16x32_bf16 v[152:155], a[136:139], a[16:19], v[152:155]
    buffer_load_dwordx4 a[132:135], v40, s[4:7], s47 offen offset:1024 sc1
    v_mfma_f32_16x16x32_bf16 v[156:159], a[112:115], a[40:43], v[156:159]
    v_mfma_f32_16x16x32_bf16 v[160:163], a[136:139], a[40:43], v[160:163]
    v_mfma_f32_16x16x32_bf16 v[180:183], a[112:115], a[64:67], v[180:183]
    v_mfma_f32_16x16x32_bf16 v[184:187], a[136:139], a[64:67], v[184:187]
    v_mfma_f32_16x16x32_bf16 v[188:191], a[112:115], a[88:91], v[188:191]
    v_mfma_f32_16x16x32_bf16 v[192:195], a[136:139], a[88:91], v[192:195]
    buffer_load_dwordx4 a[112:115], v40, s[4:7], s46 offen offset:0 sc1
    v_mfma_f32_16x16x32_bf16 v[148:151], a[116:119], a[20:23], v[148:151]
    v_mfma_f32_16x16x32_bf16 v[152:155], a[140:143], a[20:23], v[152:155]
    v_mfma_f32_16x16x32_bf16 v[156:159], a[116:119], a[44:47], v[156:159]
    v_mfma_f32_16x16x32_bf16 v[160:163], a[140:143], a[44:47], v[160:163]
    v_mfma_f32_16x16x32_bf16 v[180:183], a[116:119], a[68:71], v[180:183]
    v_mfma_f32_16x16x32_bf16 v[184:187], a[140:143], a[68:71], v[184:187]
    v_mfma_f32_16x16x32_bf16 v[188:191], a[116:119], a[92:95], v[188:191]
    v_mfma_f32_16x16x32_bf16 v[192:195], a[140:143], a[92:95], v[192:195]
    v_cvt_pk_bf16_f32 v64, v180, v181
    v_cvt_pk_bf16_f32 v65, v182, v183
    ds_write_b64 v24, v[64:65] offset:12288
    v_cvt_pk_bf16_f32 v68, v184, v185
    v_cvt_pk_bf16_f32 v69, v186, v187
    ds_write_b64 v25, v[68:69] offset:12288
    v_cvt_pk_bf16_f32 v72, v188, v189
    v_cvt_pk_bf16_f32 v73, v190, v191
    ds_write_b64 v24, v[72:73] offset:18432
    v_cvt_pk_bf16_f32 v76, v192, v193
    v_cvt_pk_bf16_f32 v77, v194, v195
    ds_write_b64 v25, v[76:77] offset:18432
    v_cvt_pk_bf16_f32 v48, v148, v149
    v_cvt_pk_bf16_f32 v49, v150, v151
    ds_write_b64 v24, v[48:49] offset:0
    v_cvt_pk_bf16_f32 v52, v152, v153
    v_cvt_pk_bf16_f32 v53, v154, v155
    ds_write_b64 v25, v[52:53] offset:0
    v_cvt_pk_bf16_f32 v56, v156, v157
    v_cvt_pk_bf16_f32 v57, v158, v159
    ds_write_b64 v24, v[56:57] offset:6144
    v_cvt_pk_bf16_f32 v60, v160, v161
    v_cvt_pk_bf16_f32 v61, v162, v163
    ds_write_b64 v25, v[60:61] offset:6144
    s_add_u32 s37, s37, 1
    s_mov_b32 m0, s53
    v_add_u32 v24, s44, v20
    v_add_u32 v25, s44, v21
    v_pk_mul_f32 v[148:149], v[210:211], v[210:211]
    v_pk_mul_f32 v[150:151], v[210:211], v[210:211]
    v_pk_mul_f32 v[152:153], v[210:211], v[210:211]
    v_pk_mul_f32 v[154:155], v[210:211], v[210:211]
    v_pk_mul_f32 v[156:157], v[210:211], v[210:211]
    v_pk_mul_f32 v[158:159], v[210:211], v[210:211]
    v_pk_mul_f32 v[160:161], v[210:211], v[210:211]
    v_pk_mul_f32 v[162:163], v[210:211], v[210:211]
    buffer_load_dwordx4 a[136:139], v40, s[4:7], s47 offen offset:2048 sc1
    buffer_load_dwordx4 a[116:119], v40, s[4:7], s46 offen offset:1024 sc1
    buffer_load_dwordx4 a[140:143], v40, s[4:7], s47 offen offset:3072 sc1
    s_branch L_wo_loop_s
L_wo_tail_s:
    ds_write_b32 v47, v50 offset:8
    ds_write_b32 v47, v58 offset:6152
    ds_write_b32 v47, v66 offset:12296
    ds_write_b32 v47, v74 offset:18440
    s_add_u32 s91, s38, 81920
    buffer_load_dwordx4 v[120:123], v15, s[4:7], s91 offen sc1
    s_add_u32 s91, s38, 122880
    buffer_load_dwordx4 v[124:127], v15, s[4:7], s91 offen sc1
    s_add_u32 s56, s37, -1
    s_and_b32 s55, s56, 3
    s_mul_i32 s55, s55, 114688
    s_add_u32 s55, s55, 53248
    s_add_u32 s48, s38, s55
    s_and_b32 s55, s56, 1
    s_add_u32 s56, s56, 1
    v_mov_b32 v35, -16
    v_writelane_b32 v35, s56, 12
    s_mul_i32 s55, s55, 12288
    s_add_u32 m0, s54, s55
    buffer_load_dword v36, v33, s[4:7], s38 offen sc1
    v_mov_b32 v3, 204
L_p0_110:
    buffer_load_dword v4, v3, s[8:11], 0 offen sc1
    s_sub_u32 s36, s36, 1
    s_cbranch_scc1 L_exit
    s_waitcnt vmcnt(0)
    v_readfirstlane_b32 s90, v4
    s_nop 0
    s_cmp_eq_u32 s90, 0
    s_cbranch_scc1 L_p0_110
    s_and_b32 s90, s90, 2
    s_lshl_b32 s90, s90, 12
    v_xor_b32 v30, s90, v30
    v_xor_b32 v31, s90, v31
    s_waitcnt lgkmcnt(0)
    s_barrier
    v_cmp_lt_i32 vcc, v36, v35
    s_cbranch_vccz L_fok_112
L_fw_111:
    buffer_load_dword v36, v33, s[4:7], s38 offen sc1
    s_sub_u32 s36, s36, 1
    s_cbranch_scc1 L_exit
    s_waitcnt vmcnt(0)
    v_cmp_lt_i32 vcc, v36, v35
    s_cbranch_vccnz L_fw_111
L_fok_112:
    buffer_load_dwordx4 v37, s[4:7], s48 offen offset:0 sc1 lds
    buffer_load_dwordx4 v37, s[4:7], s48 offen offset:1024 sc1 lds
    buffer_load_dwordx4 v37, s[4:7], s48 offen offset:2048 sc1 lds
    v_mov_b32 v128, v220
    v_mov_b32 v129, v221
    v_mov_b32 v130, v222
    v_mov_b32 v131, v223
    s_add_u32 s56, s37, -2
    s_and_b32 s55, s56, 3
    s_mul_i32 s55, s55, 24576
    v_add_u32 v26, s55, v22
    v_add_u32 v27, s55, v23
    s_and_b32 s55, s56, 1
    s_mul_i32 s55, s55, 12288
    v_add_u32 v29, s55, v28
    ds_read_b128 v[204:207], v26 offset:0
    ds_read_b128 v[180:183], v29 offset:0
    ds_read_b128 v[184:187], v29 offset:1024
    ds_read_b64 v[208:209], v27 offset:0
    ds_read_b128 v[188:191], v29 offset:2048
    ds_read_b128 v[212:215], v26 offset:1536
    ds_read_b128 v[192:195], v29 offset:3072
    ds_read_b128 v[196:199], v29 offset:4096
    ds_read_b64 v[216:217], v27 offset:1536
    ds_read_b128 v[200:203], v29 offset:5120
    s_waitcnt lgkmcnt(5)
    v_mfma_f32_16x16x32_bf16 v[220:223], v[180:183], v[204:207], 0
    v_mfma_f32_16x16x32_bf16 v[224:227], v[184:187], v[204:207], 0
    v_mfma_f32_16x16x32_bf16 v[224:227], v[188:191], v[208:211], v[224:227]
    ds_read_b128 v[204:207], v26 offset:3072
    ds_read_b128 v[180:183], v29 offset:6144
    ds_read_b128 v[184:187], v29 offset:7168
    ds_read_b64 v[208:209], v27 offset:3072
    ds_read_b128 v[188:191], v29 offset:8192
    s_waitcnt lgkmcnt(5)
    v_mfma_f32_16x16x32_bf16 v[220:223], v[192:195], v[212:215], v[220:223]
    v_mfma_f32_16x16x32_bf16 v[224:227], v[196:199], v[212:215], v[224:227]
    v_mfma_f32_16x16x32_bf16 v[224:227], v[200:203], v[216:219], v[224:227]
    ds_read_b128 v[212:215], v26 offset:4608
    ds_read_b128 v[192:195], v29 offset:9216
    ds_read_b128 v[196:199], v29 offset:10240
    ds_read_b64 v[216:217], v27 offset:4608
    ds_read_b128 v[200:203], v29 offset:11264
    s_waitcnt lgkmcnt(5)
    v_mfma_f32_16x16x32_bf16 v[220:223], v[180:183], v[204:207], v[220:223]
    v_mfma_f32_16x16x32_bf16 v[224:227], v[184:187], v[204:207], v[224:227]
    v_mfma_f32_16x16x32_bf16 v[224:227], v[188:191], v[208:211], v[224:227]
    s_waitcnt lgkmcnt(0)
    v_mfma_f32_16x16x32_bf16 v[220:223], v[192:195], v[212:215], v[220:223]
    v_mfma_f32_16x16x32_bf16 v[224:227], v[196:199], v[212:215], v[224:227]
    v_mfma_f32_16x16x32_bf16 v[224:227], v[200:203], v[216:219], v[224:227]
    s_nop 0
    v_cvt_pk_bf16_f32 v220, v220, v221
    v_cvt_pk_bf16_f32 v221, v222, v223
    s_nop 4
    v_cvt_pk_bf16_f32 v222, v224, v225
    v_cvt_pk_bf16_f32 v223, v226, v227
    v_mov_b32 v224, v220
    v_mov_b32 v225, v221
    v_mov_b32_dpp v220, v222 row_ror:8 row_mask:0xf bank_mask:0xc
    v_mov_b32_dpp v221, v223 row_ror:8 row_mask:0xf bank_mask:0xc
    v_mov_b32_dpp v222, v224 row_ror:8 row_mask:0xf bank_mask:0x3
    v_mov_b32_dpp v223, v225 row_ror:8 row_mask:0xf bank_mask:0x3
    v_mov_b32 v132, v220
    v_mov_b32 v133, v221
    v_mov_b32 v134, v222
    v_mov_b32 v135, v223
    s_waitcnt vmcnt(0)
    s_barrier
    s_add_u32 s56, s37, -1
    s_and_b32 s55, s56, 3
    s_mul_i32 s55, s55, 24576
    v_add_u32 v26, s55, v22
    v_add_u32 v27, s55, v23
    s_and_b32 s55, s56, 1
    s_mul_i32 s55, s55, 12288
    v_add_u32 v29, s55, v28
    ds_read_b128 v[204:207], v26 offset:0
    ds_read_b128 v[180:183], v29 offset:0
    ds_read_b128 v[184:187], v29 offset:1024
    ds_read_b64 v[208:209], v27 offset:0
    ds_read_b128 v[188:191], v29 offset:2048
    ds_read_b128 v[212:215], v26 offset:1536
    ds_read_b128 v[192:195], v29 offset:3072
    ds_read_b128 v[196:199], v29 offset:4096
    ds_read_b64 v[216:217], v27 offset:1536
    ds_read_b128 v[200:203], v29 offset:5120
    s_waitcnt lgkmcnt(5)
    v_mfma_f32_16x16x32_bf16 v[220:223], v[180:183], v[204:207], 0
    v_mfma_f32_16x16x32_bf16 v[224:227], v[184:187], v[204:207], 0
    v_mfma_f32_16x16x32_bf16 v[224:227], v[188:191], v[208:211], v[224:227]
    ds_read_b128 v[204:207], v26 offset:3072
    ds_read_b128 v[180:183], v29 offset:6144
    ds_read_b128 v[184:187], v29 offset:7168
    ds_read_b64 v[208:209], v27 offset:3072
    ds_read_b128 v[188:191], v29 offset:8192
    s_waitcnt lgkmcnt(5)
    v_mfma_f32_16x16x32_bf16 v[220:223], v[192:195], v[212:215], v[220:223]
    v_mfma_f32_16x16x32_bf16 v[224:227], v[196:199], v[212:215], v[224:227]
    v_mfma_f32_16x16x32_bf16 v[224:227], v[200:203], v[216:219], v[224:227]
    ds_read_b128 v[212:215], v26 offset:4608
    ds_read_b128 v[192:195], v29 offset:9216
    ds_read_b128 v[196:199], v29 offset:10240
    ds_read_b64 v[216:217], v27 offset:4608
    ds_read_b128 v[200:203], v29 offset:11264
    s_waitcnt lgkmcnt(5)
    v_mfma_f32_16x16x32_bf16 v[220:223], v[180:183], v[204:207], v[220:223]
    v_mfma_f32_16x16x32_bf16 v[224:227], v[184:187], v[204:207], v[224:227]
    v_mfma_f32_16x16x32_bf16 v[224:227], v[188:191], v[208:211], v[224:227]
    s_waitcnt lgkmcnt(0)
    v_mfma_f32_16x16x32_bf16 v[220:223], v[192:195], v[212:215], v[220:223]
    v_mfma_f32_16x16x32_bf16 v[224:227], v[196:199], v[212:215], v[224:227]
    v_mfma_f32_16x16x32_bf16 v[224:227], v[200:203], v[216:219], v[224:227]
    s_nop 0
    v_cvt_pk_bf16_f32 v220, v220, v221
    v_cvt_pk_bf16_f32 v221, v222, v223
    s_nop 4
    v_cvt_pk_bf16_f32 v222, v224, v225
    v_cvt_pk_bf16_f32 v223, v226, v227
    v_mov_b32 v224, v220
    v_mov_b32 v225, v221
    v_mov_b32_dpp v220, v222 row_ror:8 row_mask:0xf bank_mask:0xc
    v_mov_b32_dpp v221, v223 row_ror:8 row_mask:0xf bank_mask:0xc
    v_mov_b32_dpp v222, v224 row_ror:8 row_mask:0xf bank_mask:0x3
    v_mov_b32_dpp v223, v225 row_ror:8 row_mask:0xf bank_mask:0x3
    v_mov_b32 v80, v220
    v_mov_b32 v81, v221
    v_mov_b32 v82, v222
    v_mov_b32 v83, v223
    s_add_u32 s56, s37, 0
    s_and_b32 s55, s56, 3
    s_mul_i32 s55, s55, 114688
    s_add_u32 s55, s55, 53248
    s_add_u32 s48, s38, s55
    s_and_b32 s55, s56, 1
    s_add_u32 s56, s56, 1
    v_mov_b32 v35, -16
    v_writelane_b32 v35, s56, 12
    s_mul_i32 s55, s55, 12288
    s_add_u32 m0, s54, s55
    s_add_u32 s56, s37, 0
    s_and_b32 s55, s56, 3
    s_mul_i32 s55, s55, 24576
    v_add_u32 v26, s55, v22
    v_add_u32 v27, s55, v23
    s_and_b32 s55, s56, 1
    s_mul_i32 s55, s55, 12288
    v_add_u32 v29, s55, v28
    buffer_load_dword v36, v33, s[4:7], s38 offen sc1
    buffer_load_dword v36, v33, s[4:7], s38 offen sc1
    buffer_load_dword v36, v33, s[4:7], s38 offen sc1
    buffer_load_dword v36, v33, s[4:7], s38 offen sc1
    buffer_load_dword v36, v33, s[4:7], s38 offen sc1
L_sp_113:
    s_waitcnt vmcnt(4)
    v_cmp_lt_i32 vcc, v36, v35
    buffer_load_dword v36, v33, s[4:7], s38 offen sc1
    s_sub_u32 s36, s36, 1
    s_cbranch_scc1 L_exit
    s_cbranch_vccz L_sp_113x
    s_waitcnt vmcnt(4)
    v_cmp_lt_i32 vcc, v36, v35
    buffer_load_dword v36, v33, s[4:7], s38 offen sc1
    s_cbranch_vccz L_sp_113x
    s_waitcnt vmcnt(4)
    v_cmp_lt_i32 vcc, v36, v35
    buffer_load_dword v36, v33, s[4:7], s38 offen sc1
    s_cbranch_vccz L_sp_113x
    s_waitcnt vmcnt(4)
    v_cmp_lt_i32 vcc, v36, v35
    buffer_load_dword v36, v33, s[4:7], s38 offen sc1
    s_cbranch_vccnz L_sp_113
L_sp_113x:
    buffer_load_dwordx4 v37, s[4:7], s48 offen offset:0 sc1 lds
    buffer_load_dwordx4 v37, s[4:7], s48 offen offset:1024 sc1 lds
    buffer_load_dwordx4 v37, s[4:7], s48 offen offset:2048 sc1 lds
    s_waitcnt vmcnt(0)
    s_barrier
    s_mov_b32 s49, 7143424
    buffer_store_dwordx4 v[120:123], v30, s[4:7], s49 offen sc1
    s_mov_b32 s49, 6815744
    buffer_store_dwordx4 v[124:127], v30, s[4:7], s49 offen sc1
    s_mov_b32 s49, 6488064
    buffer_store_dwordx4 v[128:131], v30, s[4:7], s49 offen sc1
    s_mov_b32 s49, 6160384
    buffer_store_dwordx4 v[132:135], v30, s[4:7], s49 offen sc1
    s_mov_b32 s49, 5832704
    buffer_store_dwordx4 v[80:83], v30, s[4:7], s49 offen sc1
    ds_read_b128 v[204:207], v26 offset:0
    ds_read_b128 v[180:183], v29 offset:0
    ds_read_b128 v[184:187], v29 offset:1024
    ds_read_b64 v[208:209], v27 offset:0
    ds_read_b128 v[188:191], v29 offset:2048
    ds_read_b128 v[212:215], v26 offset:1536
    ds_read_b128 v[192:195], v29 offset:3072
    ds_read_b128 v[196:199], v29 offset:4096
    ds_read_b64 v[216:217], v27 offset:1536
    ds_read_b128 v[200:203], v29 offset:5120
    s_waitcnt lgkmcnt(5)
    v_mfma_f32_16x16x32_bf16 v[220:223], v[180:183], v[204:207], 0
    v_mfma_f32_16x16x32_bf16 v[224:227], v[184:187], v[204:207], 0
    v_mfma_f32_16x16x32_bf16 v[224:227], v[188:191], v[208:211], v[224:227]
    ds_read_b128 v[204:207], v26 offset:3072
    ds_read_b128 v[180:183], v29 offset:6144
    ds_read_b128 v[184:187], v29 offset:7168
    ds_read_b64 v[208:209], v27 offset:3072
    ds_read_b128 v[188:191], v29 offset:8192
    s_waitcnt lgkmcnt(5)
    v_mfma_f32_16x16x32_bf16 v[220:223], v[192:195], v[212:215], v[220:223]
    v_mfma_f32_16x16x32_bf16 v[224:227], v[196:199], v[212:215], v[224:227]
    v_mfma_f32_16x16x32_bf16 v[224:227], v[200:203], v[216:219], v[224:227]
    ds_read_b128 v[212:215], v26 offset:4608
    ds_read_b128 v[192:195], v29 offset:9216
    ds_read_b128 v[196:199], v29 offset:10240
    ds_read_b64 v[216:217], v27 offset:4608
    ds_read_b128 v[200:203], v29 offset:11264
    s_waitcnt lgkmcnt(5)
    v_mfma_f32_16x16x32_bf16 v[220:223], v[180:183], v[204:207], v[220:223]
    v_mfma_f32_16x16x32_bf16 v[224:227], v[184:187], v[204:207], v[224:227]
    v_mfma_f32_16x16x32_bf16 v[224:227], v[188:191], v[208:211], v[224:227]
    s_waitcnt lgkmcnt(0)
    v_mfma_f32_16x16x32_bf16 v[220:223], v[192:195], v[212:215], v[220:223]
    v_mfma_f32_16x16x32_bf16 v[224:227], v[196:199], v[212:215], v[224:227]
    v_mfma_f32_16x16x32_bf16 v[224:227], v[200:203], v[216:219], v[224:227]
    s_nop 0
    v_cvt_pk_bf16_f32 v220, v220, v221
    v_cvt_pk_bf16_f32 v221, v222, v223
    s_nop 4
    v_cvt_pk_bf16_f32 v222, v224, v225
    v_cvt_pk_bf16_f32 v223, v226, v227
    v_mov_b32 v224, v220
    v_mov_b32 v225, v221
    v_mov_b32_dpp v220, v222 row_ror:8 row_mask:0xf bank_mask:0xc
    v_mov_b32_dpp v221, v223 row_ror:8 row_mask:0xf bank_mask:0xc
    v_mov_b32_dpp v222, v224 row_ror:8 row_mask:0xf bank_mask:0x3
    v_mov_b32_dpp v223, v225 row_ror:8 row_mask:0xf bank_mask:0x3
    s_mov_b32 s49, 5505024
    buffer_store_dwordx4 v[220:223], v30, s[4:7], s49 offen sc1
    s_waitcnt vmcnt(0)
L_fp_114:
    s_mov_b32 s51, 5505024
    buffer_load_dwordx4 v[96:99], v31, s[4:7], s51 offen sc1
    s_mov_b32 s51, 7143424
    buffer_load_dwordx4 v[148:151], v31, s[4:7], s51 offen sc1
    s_mov_b32 s51, 6815744
    buffer_load_dwordx4 v[152:155], v31, s[4:7], s51 offen sc1
    s_mov_b32 s51, 6488064
    buffer_load_dwordx4 v[156:159], v31, s[4:7], s51 offen sc1
    s_mov_b32 s51, 6160384
    buffer_load_dwordx4 v[160:163], v31, s[4:7], s51 offen sc1
    s_mov_b32 s51, 5832704
    buffer_load_dwordx4 v[92:95], v31, s[4:7], s51 offen sc1
    s_sub_u32 s36, s36, 1
    s_cbranch_scc1 L_exit
    s_waitcnt vmcnt(0)
L_fp_114c:
    v_mov_b32 v41, 0
    v_max3_u32 v41, v41, v96, v97
    v_max3_u32 v41, v41, v98, v99
    v_max3_u32 v41, v41, v148, v149
    v_max3_u32 v41, v41, v150, v151
    v_max3_u32 v41, v41, v152, v153
    v_max3_u32 v41, v41, v154, v155
    v_max3_u32 v41, v41, v156, v157
    v_max3_u32 v41, v41, v158, v159
    v_max3_u32 v41, v41, v160, v161
    v_max3_u32 v41, v41, v162, v163
    v_max3_u32 v41, v41, v92, v93
    v_max3_u32 v41, v41, v94, v95
    v_cmp_eq_u32 vcc, -1, v41
    s_cbranch_vccnz L_fp_114
    s_mov_b32 s52, 5160960
    v_mfma_f32_16x16x32_bf16 v[232:235], a[144:147], v[96:99], 0
    s_nop 7
    v_cndmask_b32 v234, v232, v233, s[58:59]
    v_cndmask_b32 v235, v233, v232, s[58:59]
    s_nop 1
    v_add_f32_dpp v235, v234, v235 row_ror:8 row_mask:0xf bank_mask:0xf
    v_cvt_pk_bf16_f32 v235, v235, v235
    buffer_store_short v235, v32, s[28:31], s52 offen offset:0
    s_mov_b32 s52, 4751360
    v_mfma_f32_16x16x32_bf16 v[232:235], a[144:147], v[148:151], 0
    s_nop 7
    v_cndmask_b32 v234, v232, v233, s[58:59]
    v_cndmask_b32 v235, v233, v232, s[58:59]
    s_nop 1
    v_add_f32_dpp v235, v234, v235 row_ror:8 row_mask:0xf bank_mask:0xf
    v_cvt_pk_bf16_f32 v235, v235, v235
    buffer_store_short v235, v32, s[28:31], s52 offen offset:0
    s_mov_b32 s52, 4833280
    v_mfma_f32_16x16x32_bf16 v[232:235], a[144:147], v[152:155], 0
    s_nop 7
    v_cndmask_b32 v234, v232, v233, s[58:59]
    v_cndmask_b32 v235, v233, v232, s[58:59]
    s_nop 1
    v_add_f32_dpp v235, v234, v235 row_ror:8 row_mask:0xf bank_mask:0xf
    v_cvt_pk_bf16_f32 v235, v235, v235
    buffer_store_short v235, v32, s[28:31], s52 offen offset:0
    s_mov_b32 s52, 4915200
    v_mfma_f32_16x16x32_bf16 v[232:235], a[144:147], v[156:159], 0
    s_nop 7
    v_cndmask_b32 v234, v232, v233, s[58:59]
    v_cndmask_b32 v235, v233, v232, s[58:59]
    s_nop 1
    v_add_f32_dpp v235, v234, v235 row_ror:8 row_mask:0xf bank_mask:0xf
    v_cvt_pk_bf16_f32 v235, v235, v235
    buffer_store_short v235, v32, s[28:31], s52 offen offset:0
    s_mov_b32 s52, 4997120
    v_mfma_f32_16x16x32_bf16 v[232:235], a[144:147], v[160:163], 0
    s_nop 7
    v_cndmask_b32 v234, v232, v233, s[58:59]
    v_cndmask_b32 v235, v233, v232, s[58:59]
    s_nop 1
    v_add_f32_dpp v235, v234, v235 row_ror:8 row_mask:0xf bank_mask:0xf
    v_cvt_pk_bf16_f32 v235, v235, v235
    buffer_store_short v235, v32, s[28:31], s52 offen offset:0
    s_mov_b32 s52, 5079040
    v_mfma_f32_16x16x32_bf16 v[232:235], a[144:147], v[92:95], 0
    s_nop 7
    v_cndmask_b32 v234, v232, v233, s[58:59]
    v_cndmask_b32 v235, v233, v232, s[58:59]
    s_nop 1
    v_add_f32_dpp v235, v234, v235 row_ror:8 row_mask:0xf bank_mask:0xf
    v_cvt_pk_bf16_f32 v235, v235, v235
    buffer_store_short v235, v32, s[28:31], s52 offen offset:0
    s_endpgm
L_sd_89c:
    v_mov_b32 v3, 204
L_p0_115:
    buffer_load_dword v4, v3, s[8:11], 0 offen sc1
    s_sub_u32 s36, s36, 1
    s_cbranch_scc1 L_exit
    s_waitcnt vmcnt(0)
    v_readfirstlane_b32 s90, v4
    s_nop 0
    s_cmp_eq_u32 s90, 0
    s_cbranch_scc1 L_p0_115
    s_and_b32 s90, s90, 2
    s_lshl_b32 s90, s90, 12
    v_xor_b32 v140, s90, v140
    v_xor_b32 v141, s90, v141
    v_xor_b32 v143, s90, v143
    v_xor_b32 v144, s90, v144
    s_branch L_sd_89
L_an_90:
    s_cmp_lg_u32 s55, 0
    s_cbranch_scc1 L_an_90x
    buffer_load_dword v139, v142, s[4:7], s38 offen sc1
    buffer_load_dword v139, v142, s[4:7], s38 offen sc1
    buffer_load_dword v139, v142, s[4:7], s38 offen sc1
    buffer_load_dword v139, v142, s[4:7], s38 offen sc1
    buffer_load_dword v139, v142, s[4:7], s38 offen sc1
    buffer_load_dword v139, v142, s[4:7], s38 offen sc1
L_sp_116:
    s_waitcnt vmcnt(5)
    v_cmp_ge_u32 vcc, s37, v139
    buffer_load_dword v139, v142, s[4:7], s38 offen sc1
    s_sub_u32 s36, s36, 1
    s_cbranch_scc1 L_exit
    s_cbranch_vccz L_sp_116x
    s_waitcnt vmcnt(5)
    v_cmp_ge_u32 vcc, s37, v139
    buffer_load_dword v139, v142, s[4:7], s38 offen sc1
    s_cbranch_vccz L_sp_116x
    s_waitcnt vmcnt(5)
    v_cmp_ge_u32 vcc, s37, v139
    buffer_load_dword v139, v142, s[4:7], s38 offen sc1
    s_cbranch_vccz L_sp_116x
    s_waitcnt vmcnt(5)
    v_cmp_ge_u32 vcc, s37, v139
    buffer_load_dword v139, v142, s[4:7], s38 offen sc1
    s_cbranch_vccnz L_sp_116
L_sp_116x:
L_an_90x:
    s_barrier
    s_lshl_b32 s90, s32, 10
    s_add_u32 m0, s90, s47
    s_waitcnt lgkmcnt(2)
    v_mfma_f32_16x16x32_bf16 v[108:111], a[0:3], v[84:87], 0
    ds_read_b128 v[100:103], v11 offset:4096
    s_add_u32 s51, s37, 3
    v_mfma_f32_16x16x32_bf16 v[112:115], a[0:3], v[88:91], 0
    ds_read_b128 v[104:107], v11 offset:6144
    s_and_b32 s50, s51, 3
    v_mfma_f32_16x16x32_bf16 v[116:119], a[80:83], v[84:87], 0
    buffer_store_dword v22, v135, s[4:7], s42 offen offset:0 sc1
    buffer_store_dword v22, v135, s[4:7], s42 offen offset:1024 sc1
    v_mfma_f32_16x16x32_bf16 v[120:123], a[80:83], v[88:91], 0
    s_waitcnt lgkmcnt(2)
    s_mul_i32 s50, s50, 114688
    v_mfma_f32_16x16x32_bf16 v[108:111], a[4:7], v[92:95], v[108:111]
    ds_read_b128 v[84:87], v12 offset:4096
    s_add_u32 s50, s50, 65536
    v_mfma_f32_16x16x32_bf16 v[112:115], a[4:7], v[96:99], v[112:115]
    ds_read_b128 v[88:91], v12 offset:6144
    s_add_u32 s44, s38, s50
    v_mfma_f32_16x16x32_bf16 v[116:119], a[84:87], v[92:95], v[116:119]
    buffer_load_dwordx4 v10, s[24:27], s46 offen offset:0 lds
    s_add_u32 m0, m0, 3968
    v_mfma_f32_16x16x32_bf16 v[120:123], a[84:87], v[96:99], v[120:123]
    s_waitcnt lgkmcnt(2)
    s_add_u32 s45, s44, s56
    v_mfma_f32_16x16x32_bf16 v[108:111], a[8:11], v[100:103], v[108:111]
    ds_read_b128 v[92:95], v11 offset:8192
    s_add_u32 s37, s37, 1
    v_mfma_f32_16x16x32_bf16 v[112:115], a[8:11], v[104:107], v[112:115]
    ds_read_b128 v[96:99], v11 offset:10240
    s_mov_b32 s52, 0
    v_mfma_f32_16x16x32_bf16 v[116:119], a[88:91], v[100:103], v[116:119]
    buffer_load_dwordx4 v10, s[24:27], s46 offen offset:128 lds
    s_add_u32 m0, m0, 3968
    v_mfma_f32_16x16x32_bf16 v[120:123], a[88:91], v[104:107], v[120:123]
    s_waitcnt lgkmcnt(2)
    s_and_b32 s50, s37, 3
    v_mfma_f32_16x16x32_bf16 v[108:111], a[12:15], v[84:87], v[108:111]
    ds_read_b128 v[100:103], v12 offset:8192
    s_mul_i32 s51, s50, 114688
    v_mfma_f32_16x16x32_bf16 v[112:115], a[12:15], v[88:91], v[112:115]
    ds_read_b128 v[104:107], v12 offset:10240
    s_add_u32 s41, s38, s51
    v_mfma_f32_16x16x32_bf16 v[116:119], a[92:95], v[84:87], v[116:119]
    buffer_load_dwordx4 v10, s[24:27], s46 offen offset:256 lds
    s_add_u32 m0, m0, 3968
    v_mfma_f32_16x16x32_bf16 v[120:123], a[92:95], v[88:91], v[120:123]
    buffer_store_dword v20, v140, s[4:7], 0 offen sc1
    s_waitcnt lgkmcnt(2)
    v_mfma_f32_16x16x32_bf16 v[108:111], a[16:19], v[92:95], v[108:111]
    ds_read_b128 v[84:87], v11 offset:12288
    v_mfma_f32_16x16x32_bf16 v[112:115], a[16:19], v[96:99], v[112:115]
    ds_read_b128 v[88:91], v11 offset:14336
    v_mfma_f32_16x16x32_bf16 v[116:119], a[96:99], v[92:95], v[116:119]
    buffer_load_dwordx4 v10, s[24:27], s46 offen offset:384 lds
    s_add_u32 m0, m0, 3968
    v_mfma_f32_16x16x32_bf16 v[120:123], a[96:99], v[96:99], v[120:123]
    s_waitcnt lgkmcnt(2)
    v_mfma_f32_16x16x32_bf16 v[108:111], a[20:23], v[100:103], v[108:111]
    ds_read_b128 v[92:95], v12 offset:12288
    v_mfma_f32_16x16x32_bf16 v[112:115], a[20:23], v[104:107], v[112:115]
    buffer_store_dword v20, v141, s[4:7], 0 offen sc1
    ds_read_b128 v[96:99], v12 offset:14336
    v_mfma_f32_16x16x32_bf16 v[116:119], a[100:103], v[100:103], v[116:119]
    buffer_load_dwordx4 v10, s[24:27], s46 offen offset:512 lds
    s_add_u32 m0, m0, 3968
    v_mfma_f32_16x16x32_bf16 v[120:123], a[100:103], v[104:107], v[120:123]
    s_waitcnt lgkmcnt(2)
    v_mfma_f32_16x16x32_bf16 v[108:111], a[24:27], v[84:87], v[108:111]
    ds_read_b128 v[100:103], v11 offset:16384
    v_mfma_f32_16x16x32_bf16 v[112:115], a[24:27], v[88:91], v[112:115]
    ds_read_b128 v[104:107], v11 offset:18432
    v_mfma_f32_16x16x32_bf16 v[116:119], a[104:107], v[84:87], v[116:119]
    buffer_load_dwordx4 v10, s[24:27], s46 offen offset:640 lds
    s_add_u32 m0, m0, 3968
    v_mfma_f32_16x16x32_bf16 v[120:123], a[104:107], v[88:91], v[120:123]
    s_waitcnt lgkmcnt(2)
    v_mfma_f32_16x16x32_bf16 v[108:111], a[28:31], v[92:95], v[108:111]
    ds_read_b128 v[84:87], v12 offset:16384
    v_mfma_f32_16x16x32_bf16 v[112:115], a[28:31], v[96:99], v[112:115]
    ds_read_b128 v[88:91], v12 offset:18432
    v_mfma_f32_16x16x32_bf16 v[116:119], a[108:111], v[92:95], v[116:119]
    buffer_load_dwordx4 v10, s[24:27], s46 offen offset:768 lds
    s_add_u32 m0, m0, 3968
    v_mfma_f32_16x16x32_bf16 v[120:123], a[108:111], v[96:99], v[120:123]
    s_waitcnt lgkmcnt(2)
    v_mfma_f32_16x16x32_bf16 v[108:111], a[32:35], v[100:103], v[108:111]
    ds_read_b128 v[92:95], v11 offset:20480
    v_mfma_f32_16x16x32_bf16 v[112:115], a[32:35], v[104:107], v[112:115]
    ds_read_b128 v[96:99], v11 offset:22528
    v_mfma_f32_16x16x32_bf16 v[116:119], a[112:115], v[100:103], v[116:119]
    buffer_load_dwordx4 v10, s[24:27], s46 offen offset:896 lds
    s_add_u32 m0, m0, 3968
    v_mfma_f32_16x16x32_bf16 v[120:123], a[112:115], v[104:107], v[120:123]
    s_waitcnt lgkmcnt(2)
    v_mfma_f32_16x16x32_bf16 v[108:111], a[36:39], v[84:87], v[108:111]
    ds_read_b128 v[100:103], v12 offset:20480
    v_mfma_f32_16x16x32_bf16 v[112:115], a[36:39], v[88:91], v[112:115]
    ds_read_b128 v[104:107], v12 offset:22528
    v_mfma_f32_16x16x32_bf16 v[116:119], a[116:119], v[84:87], v[116:119]
    buffer_load_dwordx4 v10, s[24:27], s46 offen offset:1024 lds
    s_add_u32 m0, m0, 3968
    v_mfma_f32_16x16x32_bf16 v[120:123], a[116:119], v[88:91], v[120:123]
    s_waitcnt lgkmcnt(2)
    v_mfma_f32_16x16x32_bf16 v[108:111], a[40:43], v[92:95], v[108:111]
    ds_read_b128 v[84:87], v11 offset:24576
    v_mfma_f32_16x16x32_bf16 v[112:115], a[40:43], v[96:99], v[112:115]
    ds_read_b128 v[88:91], v11 offset:26624
    v_mfma_f32_16x16x32_bf16 v[116:119], a[120:123], v[92:95], v[116:119]
    buffer_load_dwordx4 v10, s[24:27], s46 offen offset:1152 lds
    v_mfma_f32_16x16x32_bf16 v[120:123], a[120:123], v[96:99], v[120:123]
    s_waitcnt lgkmcnt(2)
    v_mfma_f32_16x16x32_bf16 v[108:111], a[44:47], v[100:103], v[108:111]
    ds_read_b128 v[92:95], v12 offset:24576
    v_mfma_f32_16x16x32_bf16 v[112:115], a[44:47], v[104:107], v[112:115]
    ds_read_b128 v[96:99], v12 offset:26624
    v_mfma_f32_16x16x32_bf16 v[116:119], a[124:127], v[100:103], v[116:119]
    v_mfma_f32_16x16x32_bf16 v[120:123], a[124:127], v[104:107], v[120:123]
    s_waitcnt lgkmcnt(2)
    v_mfma_f32_16x16x32_bf16 v[108:111], a[48:51], v[84:87], v[108:111]
    ds_read_b128 v[100:103], v11 offset:28672
    v_mfma_f32_16x16x32_bf16 v[112:115], a[48:51], v[88:91], v[112:115]
    ds_read_b128 v[104:107], v11 offset:30720
    v_mfma_f32_16x16x32_bf16 v[116:119], a[128:131], v[84:87], v[116:119]
    v_mfma_f32_16x16x32_bf16 v[120:123], a[128:131], v[88:91], v[120:123]
    s_waitcnt lgkmcnt(2)
    v_mfma_f32_16x16x32_bf16 v[108:111], a[52:55], v[92:95], v[108:111]
    ds_read_b128 v[84:87], v12 offset:28672
    v_mfma_f32_16x16x32_bf16 v[112:115], a[52:55], v[96:99], v[112:115]
    ds_read_b128 v[88:91], v12 offset:30720
    v_mfma_f32_16x16x32_bf16 v[116:119], a[132:135], v[92:95], v[116:119]
    v_mfma_f32_16x16x32_bf16 v[120:123], a[132:135], v[96:99], v[120:123]
    s_waitcnt lgkmcnt(2)
    v_mfma_f32_16x16x32_bf16 v[108:111], a[56:59], v[100:103], v[108:111]
    ds_read_b128 v[92:95], v11 offset:32768
    v_mfma_f32_16x16x32_bf16 v[112:115], a[56:59], v[104:107], v[112:115]
    ds_read_b128 v[96:99], v11 offset:34816
    v_mfma_f32_16x16x32_bf16 v[116:119], a[136:139], v[100:103], v[116:119]
    v_mfma_f32_16x16x32_bf16 v[120:123], a[136:139], v[104:107], v[120:123]
    s_waitcnt lgkmcnt(2)
    v_mfma_f32_16x16x32_bf16 v[108:111], a[60:63], v[84:87], v[108:111]
    ds_read_b128 v[100:103], v12 offset:32768
    v_mfma_f32_16x16x32_bf16 v[112:115], a[60:63], v[88:91], v[112:115]
    ds_read_b128 v[104:107], v12 offset:34816
    v_mfma_f32_16x16x32_bf16 v[116:119], a[140:143], v[84:87], v[116:119]
    v_mfma_f32_16x16x32_bf16 v[120:123], a[140:143], v[88:91], v[120:123]
    s_waitcnt lgkmcnt(2)
    v_mfma_f32_16x16x32_bf16 v[108:111], a[64:67], v[92:95], v[108:111]
    ds_read_b128 v[84:87], v11 offset:36864
    v_mfma_f32_16x16x32_bf16 v[112:115], a[64:67], v[96:99], v[112:115]
    ds_read_b128 v[88:91], v11 offset:38912
    v_mfma_f32_16x16x32_bf16 v[116:119], a[144:147], v[92:95], v[116:119]
    v_mfma_f32_16x16x32_bf16 v[120:123], a[144:147], v[96:99], v[120:123]
    s_waitcnt lgkmcnt(2)
    v_mfma_f32_16x16x32_bf16 v[108:111], a[68:71], v[100:103], v[108:111]
    ds_read_b128 v[92:95], v12 offset:36864
    v_mfma_f32_16x16x32_bf16 v[112:115], a[68:71], v[104:107], v[112:115]
    ds_read_b128 v[96:99], v12 offset:38912
    v_mfma_f32_16x16x32_bf16 v[116:119], a[148:151], v[100:103], v[116:119]
    v_mfma_f32_16x16x32_bf16 v[120:123], a[148:151], v[104:107], v[120:123]
    s_waitcnt lgkmcnt(0)
    v_mfma_f32_16x16x32_bf16 v[108:111], a[72:75], v[84:87], v[108:111]
    v_add_u32 v11, s49, v11
    v_mfma_f32_16x16x32_bf16 v[112:115], a[72:75], v[88:91], v[112:115]
    v_add_u32 v12, s49, v12
    v_mfma_f32_16x16x32_bf16 v[108:111], a[76:79], v[92:95], v[108:111]
    s_sub_u32 s47, s47, s49
    v_mfma_f32_16x16x32_bf16 v[112:115], a[76:79], v[96:99], v[112:115]
    s_sub_u32 s49, 0, s49
    v_mfma_f32_16x16x32_bf16 v[116:119], a[152:155], v[84:87], v[116:119]
    v_mfma_f32_16x16x32_bf16 v[120:123], a[152:155], v[88:91], v[120:123]
    v_mfma_f32_16x16x32_bf16 v[116:119], a[156:159], v[92:95], v[116:119]
    v_mfma_f32_16x16x32_bf16 v[120:123], a[156:159], v[96:99], v[120:123]
    v_cvt_pk_bf16_f32 v124, v108, v109
    v_cvt_pk_bf16_f32 v125, v110, v111
    v_cvt_pk_bf16_f32 v126, v112, v113
    v_cvt_pk_bf16_f32 v127, v114, v115
    s_nop 0
    v_permlane16_swap_b32 v124, v126
    v_permlane16_swap_b32 v125, v127
    v_cvt_pk_bf16_f32 v128, v116, v117
    v_cvt_pk_bf16_f32 v129, v118, v119
    v_cvt_pk_bf16_f32 v130, v120, v121
    v_cvt_pk_bf16_f32 v131, v122, v123
    s_nop 0
    v_permlane16_swap_b32 v128, v130
    v_permlane16_swap_b32 v129, v131
    buffer_store_dwordx4 v[124:127], v19, s[4:7], s44 offen sc1
    buffer_store_dwordx4 v[128:131], v19, s[4:7], s45 offen sc1
    s_branch L_v_loop_s
L_fw_91c:
    v_mov_b32 v148, -1
    v_mov_b32 v149, -1
    v_mov_b32 v150, -1
    v_mov_b32 v151, -1
    v_mov_b32 v152, -1
    v_mov_b32 v153, -1
    v_mov_b32 v154, -1
    v_mov_b32 v155, -1
    s_add_u32 s53, s53, 2293760
    buffer_store_dwordx4 v[148:151], v143, s[4:7], s53 offen offset:0 sc1
    buffer_store_dwordx4 v[152:155], v143, s[4:7], s53 offen offset:1024 sc1
    s_sub_u32 s53, s53, 983040
    s_branch L_fw_91
L_vm_101:
    buffer_load_dwordx4 v44, s[4:7], s43 offen offset:0 sc1 lds
    buffer_load_dwordx4 v44, s[4:7], s43 offen offset:1024 sc1 lds
    buffer_load_dwordx4 v44, s[4:7], s43 offen offset:2048 sc1 lds
    s_sub_u32 s36, s36, 1
    s_cbranch_scc1 L_exit
    v_add_u32 v5, s53, v12
    s_waitcnt vmcnt(0)
    ds_read_b128 v[136:139], v5 offset:0
    ds_read_b128 v[140:143], v5 offset:1024
    ds_read_b128 v[144:147], v5 offset:2048
    s_waitcnt lgkmcnt(0)
    v_max_u32 v4, v136, v137
    v_max3_u32 v4, v4, v138, v139
    v_max3_u32 v4, v4, v140, v141
    v_max3_u32 v4, v4, v142, v143
    v_max3_u32 v4, v4, v144, v145
    v_max3_u32 v4, v4, v146, v147
    v_cmp_eq_u32 vcc, -1, v4
    s_cbranch_vccnz L_vm_101
    buffer_load_dwordx4 v[92:95], v38, s[4:7], s43 offen offset:0 sc1
    buffer_load_dwordx4 v[96:99], v38, s[4:7], s43 offen offset:1280 sc1
    buffer_load_dwordx4 v[100:103], v38, s[4:7], s43 offen offset:2560 sc1
    buffer_load_dword v104, v39, s[4:7], s43 offen offset:0 sc1
    buffer_load_dword v105, v39, s[4:7], s43 offen offset:1280 sc1
    buffer_load_dword v106, v39, s[4:7], s43 offen offset:2560 sc1
    ds_read_b64_tr_b16 v[136:137], v16 offset:0
    ds_read_b64_tr_b16 v[138:139], v13 offset:0
    ds_read_b64_tr_b16 v[140:141], v16 offset:1024
    ds_read_b64_tr_b16 v[142:143], v13 offset:1024
    ds_read_b64_tr_b16 v[144:145], v16 offset:2048
    ds_read_b64_tr_b16 v[146:147], v13 offset:2048
    v_mov_b32 v148, 0
    v_mov_b32 v149, 0
    v_mov_b32 v150, 0
    v_mov_b32 v151, 0
    v_mov_b32 v152, 0
    v_mov_b32 v153, 0
    v_mov_b32 v154, 0
    v_mov_b32 v155, 0
    v_mov_b32 v156, 0
    v_mov_b32 v157, 0
    v_mov_b32 v158, 0
    v_mov_b32 v159, 0
    v_mov_b32 v160, 0
    v_mov_b32 v161, 0
    v_mov_b32 v162, 0
    v_mov_b32 v163, 0
    s_waitcnt lgkmcnt(0)
    v_smfmac_f32_16x16x64_bf16 v[148:151], v[136:139], a[0:7], v10
    v_smfmac_f32_16x16x64_bf16 v[152:155], v[136:139], a[24:31], v10
    v_smfmac_f32_16x16x64_bf16 v[156:159], v[136:139], a[48:55], v10
    v_smfmac_f32_16x16x64_bf16 v[160:163], v[136:139], a[72:79], v10
    v_smfmac_f32_16x16x64_bf16 v[148:151], v[140:143], a[8:15], v10
    v_smfmac_f32_16x16x64_bf16 v[152:155], v[140:143], a[32:39], v10
    v_smfmac_f32_16x16x64_bf16 v[156:159], v[140:143], a[56:63], v10
    v_smfmac_f32_16x16x64_bf16 v[160:163], v[140:143], a[80:87], v10
    v_smfmac_f32_16x16x64_bf16 v[148:151], v[144:147], a[16:23], v10
    v_smfmac_f32_16x16x64_bf16 v[152:155], v[144:147], a[40:47], v10
    v_smfmac_f32_16x16x64_bf16 v[156:159], v[144:147], a[64:71], v10
    v_smfmac_f32_16x16x64_bf16 v[160:163], v[144:147], a[88:95], v10
    v_pk_add_f32 v[148:149], v[148:149], v[150:151]
    v_cmp_u_f32 vcc, v148, v149
    v_cvt_pk_bf16_f32 v50, v148, v149
    v_cvt_pk_bf16_f32 v54, v148, v149
    v_pk_add_f32 v[152:153], v[152:153], v[154:155]
    v_cvt_pk_bf16_f32 v58, v152, v153
    v_cvt_pk_bf16_f32 v62, v152, v153
    v_pk_add_f32 v[156:157], v[156:157], v[158:159]
    v_cvt_pk_bf16_f32 v66, v156, v157
    v_cvt_pk_bf16_f32 v70, v156, v157
    v_pk_add_f32 v[160:161], v[160:161], v[162:163]
    v_cvt_pk_bf16_f32 v74, v160, v161
    v_cvt_pk_bf16_f32 v78, v160, v161
    s_cmp_eq_u32 s37, 63
    s_branch L_u_102
L_sp_105:
    v_max3_u32 v4, v104, v105, v106
    v_max3_u32 v4, v4, v92, v93
    v_max3_u32 v4, v4, v94, v95
    v_max3_u32 v4, v4, v96, v97
    v_max3_u32 v4, v4, v98, v99
    v_max3_u32 v4, v4, v100, v101
    v_max3_u32 v4, v4, v102, v103
    v_cmp_eq_u32 vcc, -1, v4
    s_cbranch_vccz L_sg_106
    buffer_load_dwordx4 v[92:95], v38, s[4:7], s43 offen offset:0 sc1
    buffer_load_dwordx4 v[96:99], v38, s[4:7], s43 offen offset:1280 sc1
    buffer_load_dwordx4 v[100:103], v38, s[4:7], s43 offen offset:2560 sc1
    buffer_load_dword v104, v39, s[4:7], s43 offen offset:0 sc1
    buffer_load_dword v105, v39, s[4:7], s43 offen offset:1280 sc1
    buffer_load_dword v106, v39, s[4:7], s43 offen offset:2560 sc1
    s_sub_u32 s36, s36, 1
    s_cbranch_scc1 L_exit
    s_branch L_sc_104
L_px_s:
    v_and_b32 v1, 15, v0
    v_lshrrev_b32 v2, 4, v0
    s_mul_i32 s90, s32, 12288
    v_lshl_add_u32 v10, v0, 4, s90
    s_mul_i32 s90, s32, 3072
    v_lshl_add_u32 v12, v0, 4, s90
    v_lshrrev_b32 v3, 2, v1
    v_lshlrev_b32 v3, 1, v3
    v_and_b32 v4, 1, v1
    v_or_b32 v3, v3, v4
    v_lshl_add_u32 v3, v2, 3, v3
    v_lshl_add_u32 v11, v3, 4, s90
    s_lshl_b32 s90, s32, 7
    v_min_u32 v3, 11, v0
    v_lshl_add_u32 v3, v3, 2, s90
    v_add_u32 v13, 458752, v3
    v_min_u32 v3, 2, v0
    v_lshl_add_u32 v3, v3, 2, s90
    v_add_u32 v14, 459264, v3
    v_add_u32 v22, 462336, v3
    s_add_u32 s90, s90, 459776
    v_mov_b32 v15, s90
    v_cmp_eq_u32 vcc, 0, v0
    v_mov_b32 v9, 2146435072
    s_nop 0
    v_cndmask_b32 v15, v9, v15, vcc
    s_nop 0
    v_mov_b32 v21, 0xd04e79ff
    s_mov_b32 s44, 0x3dd53b95
    v_lshl_add_u32 v3, v2, 2, 0
    v_cmp_le_u32 s[48:49], v3, v1
    v_lshl_add_u32 v3, v2, 2, 1
    v_cmp_le_u32 s[50:51], v3, v1
    v_lshl_add_u32 v3, v2, 2, 2
    v_cmp_le_u32 s[52:53], v3, v1
    v_lshl_add_u32 v3, v2, 2, 3
    v_cmp_le_u32 s[54:55], v3, v1
    v_mov_b32 v167, 0
    v_mov_b32 v171, 0
    v_mov_b32 v174, 0
    v_mov_b32 v175, 0
    s_mov_b32 s37, 0
    v_mov_b32 v1, 196
L_gw_118:
    buffer_load_dword v2, v1, s[8:11], 0 offen sc1
    s_sub_u32 s36, s36, 1
    s_cbranch_scc1 L_exit
    s_waitcnt vmcnt(0)
L_gw_118c:
    v_readfirstlane_b32 s90, v2
    s_nop 0
    s_cmp_eq_u32 s90, 0
    s_cbranch_scc1 L_gw_118
    s_cmp_lg_u32 s32, 0
    s_cbranch_scc1 L_xg_117
    s_lshl_b32 s92, s34, 14
    s_add_u32 s92, s92, 1966080
    s_add_u32 s93, s92, 8192
    v_lshlrev_b32 v3, 4, v0
    buffer_store_dwordx4 v[24:27], v3, s[4:7], s92 offen offset:0 sc1
    buffer_store_dwordx4 v[24:27], v3, s[4:7], s93 offen offset:0 sc1
    buffer_store_dwordx4 v[24:27], v3, s[4:7], s92 offen offset:1024 sc1
    buffer_store_dwordx4 v[24:27], v3, s[4:7], s93 offen offset:1024 sc1
    buffer_store_dwordx4 v[24:27], v3, s[4:7], s92 offen offset:2048 sc1
    buffer_store_dwordx4 v[24:27], v3, s[4:7], s93 offen offset:2048 sc1
    buffer_store_dwordx4 v[24:27], v3, s[4:7], s92 offen offset:3072 sc1
    buffer_store_dwordx4 v[24:27], v3, s[4:7], s93 offen offset:3072 sc1
    v_mov_b32 v3, 0
    s_mov_b32 s56, -1
    s_mov_b32 s57, -1
    s_mov_b32 s62, 0
    s_mov_b32 s63, 0
    s_waitcnt vmcnt(0)
L_pr_119:
    s_memtime s[58:59]
    s_waitcnt lgkmcnt(0)
    buffer_load_dword v4, v3, s[4:7], s92 offen sc1
    s_waitcnt vmcnt(0)
    s_memtime s[60:61]
    s_waitcnt lgkmcnt(0)
    s_sub_u32 s60, s60, s58
    s_min_u32 s56, s56, s60
    s_memtime s[58:59]
    s_waitcnt lgkmcnt(0)
    buffer_load_dword v4, v3, s[4:7], s93 offen sc1
    s_waitcnt vmcnt(0)
    s_memtime s[60:61]
    s_waitcnt lgkmcnt(0)
    s_sub_u32 s60, s60, s58
    s_min_u32 s57, s57, s60
    buffer_load_dword v4, v13, s[4:7], s38 offen sc1
    v_add_u32 v3, 128, v3
    s_add_u32 s62, s62, 1
    s_waitcnt vmcnt(0)
    v_cmp_eq_u32 vcc, 0, v4
    s_nop 0
    s_cmp_eq_u64 vcc, 0
    s_addc_u32 s63, s63, 0
    s_cmp_ge_u32 s63, 2
    s_cselect_b32 s62, 32, s62
    s_min_u32 s58, s56, s57
    s_max_u32 s59, s56, s57
    s_sub_u32 s59, s59, s58
    s_cmp_ge_u32 s59, 150
    s_cselect_b32 s58, s58, -1
    s_cmp_le_u32 s58, 540
    s_cselect_b32 s62, 32, s62
    s_cmp_lt_u32 s62, 32
    s_cbranch_scc1 L_pr_119
    s_cmp_lt_u32 s57, s56
    s_cselect_b32 s62, 2, 1
    s_nop 0
    v_mov_b32 v3, 460288
    v_mov_b32 v4, s62
    buffer_store_dword v4, v3, s[4:7], s38 offen sc1
    s_cmp_lg_u32 s34, 0
    s_cbranch_scc1 L_xg_117
    v_mov_b32 v3, 204
    buffer_store_dword v4, v3, s[8:11], 0 offen sc1
L_xg_117:
    s_barrier
    s_add_u32 s41, s38, 475136
    buffer_load_dword v16, v22, s[4:7], s38 offen sc1
    buffer_load_dword v16, v22, s[4:7], s38 offen sc1
L_sp_120:
    s_waitcnt vmcnt(1)
    v_cmp_ge_u32 vcc, s37, v16
    buffer_load_dword v16, v22, s[4:7], s38 offen sc1
    s_sub_u32 s36, s36, 1
    s_cbranch_scc1 L_exit
    s_cbranch_vccz L_sp_120x
    s_waitcnt vmcnt(1)
    v_cmp_ge_u32 vcc, s37, v16
    buffer_load_dword v16, v22, s[4:7], s38 offen sc1
    s_cbranch_vccz L_sp_120x
    s_waitcnt vmcnt(1)
    v_cmp_ge_u32 vcc, s37, v16
    buffer_load_dword v16, v22, s[4:7], s38 offen sc1
    s_cbranch_vccz L_sp_120x
    s_waitcnt vmcnt(1)
    v_cmp_ge_u32 vcc, s37, v16
    buffer_load_dword v16, v22, s[4:7], s38 offen sc1
    s_cbranch_vccnz L_sp_120
L_sp_120x:
    s_add_u32 s90, s41, 49152
    buffer_load_dwordx4 v[72:75], v10, s[4:7], s90 offen offset:0 sc1
    buffer_load_dwordx4 v[76:79], v10, s[4:7], s90 offen offset:1024 sc1
    buffer_load_dwordx4 v[80:83], v10, s[4:7], s90 offen offset:2048 sc1
    buffer_load_dwordx4 v[84:87], v10, s[4:7], s90 offen offset:3072 sc1
    s_add_u32 s90, s41, 53248
    buffer_load_dwordx4 v[88:91], v10, s[4:7], s90 offen offset:0 sc1
    buffer_load_dwordx4 v[92:95], v10, s[4:7], s90 offen offset:1024 sc1
    buffer_load_dwordx4 v[96:99], v10, s[4:7], s90 offen offset:2048 sc1
    buffer_load_dwordx4 v[100:103], v10, s[4:7], s90 offen offset:3072 sc1
    s_add_u32 s90, s41, 57344
    buffer_load_dwordx4 v[104:107], v10, s[4:7], s90 offen offset:0 sc1
    buffer_load_dwordx4 v[108:111], v10, s[4:7], s90 offen offset:1024 sc1
    buffer_load_dwordx4 v[112:115], v10, s[4:7], s90 offen offset:2048 sc1
    buffer_load_dwordx4 v[116:119], v10, s[4:7], s90 offen offset:3072 sc1
    s_add_u32 s90, s41, 0
    buffer_load_dwordx4 v[24:27], v10, s[4:7], s90 offen offset:0 sc1
    buffer_load_dwordx4 v[28:31], v10, s[4:7], s90 offen offset:1024 sc1
    buffer_load_dwordx4 v[32:35], v10, s[4:7], s90 offen offset:2048 sc1
    buffer_load_dwordx4 v[36:39], v10, s[4:7], s90 offen offset:3072 sc1
    s_add_u32 s90, s41, 4096
    buffer_load_dwordx4 v[40:43], v10, s[4:7], s90 offen offset:0 sc1
    buffer_load_dwordx4 v[44:47], v10, s[4:7], s90 offen offset:1024 sc1
    buffer_load_dwordx4 v[48:51], v10, s[4:7], s90 offen offset:2048 sc1
    buffer_load_dwordx4 v[52:55], v10, s[4:7], s90 offen offset:3072 sc1
    s_add_u32 s90, s41, 8192
    buffer_load_dwordx4 v[56:59], v10, s[4:7], s90 offen offset:0 sc1
    buffer_load_dwordx4 v[60:63], v10, s[4:7], s90 offen offset:1024 sc1
    buffer_load_dwordx4 v[64:67], v10, s[4:7], s90 offen offset:2048 sc1
    buffer_load_dwordx4 v[68:71], v10, s[4:7], s90 offen offset:3072 sc1
    s_waitcnt vmcnt(0)
L_px_loop_s:
    s_and_b32 s90, s37, 3
    s_mul_i32 s91, s90, 114688
    s_add_u32 s91, s91, s38
    s_add_u32 s42, s91, 40960
    s_add_u32 s43, s91, 53248
    s_add_u32 s90, s37, 1
    v_mov_b32 v17, s90
    s_and_b32 s90, s90, 3
    s_mul_i32 s91, s90, 98304
    s_add_u32 s91, s91, 475136
    s_add_u32 s41, s38, s91
    v_mfma_f32_16x16x32_bf16 v[144:147], v[72:75], v[24:27], 0
    v_mfma_f32_16x16x32_bf16 v[152:155], v[72:75], v[48:51], 0
    v_mfma_f32_16x16x32_bf16 v[156:159], v[96:99], v[48:51], 0
    v_mfma_f32_16x16x32_bf16 v[144:147], v[76:79], v[28:31], v[144:147]
    v_mfma_f32_16x16x32_bf16 v[152:155], v[76:79], v[52:55], v[152:155]
    v_mfma_f32_16x16x32_bf16 v[156:159], v[100:103], v[52:55], v[156:159]
    v_mfma_f32_16x16x32_bf16 v[144:147], v[80:83], v[32:35], v[144:147]
    v_mfma_f32_16x16x32_bf16 v[152:155], v[80:83], v[56:59], v[152:155]
    v_mfma_f32_16x16x32_bf16 v[156:159], v[104:107], v[56:59], v[156:159]
    v_mfma_f32_16x16x32_bf16 v[144:147], v[84:87], v[36:39], v[144:147]
    v_mfma_f32_16x16x32_bf16 v[152:155], v[84:87], v[60:63], v[152:155]
    v_mfma_f32_16x16x32_bf16 v[156:159], v[108:111], v[60:63], v[156:159]
    v_mfma_f32_16x16x32_bf16 v[144:147], v[88:91], v[40:43], v[144:147]
    v_mfma_f32_16x16x32_bf16 v[152:155], v[88:91], v[64:67], v[152:155]
    v_mfma_f32_16x16x32_bf16 v[156:159], v[112:115], v[64:67], v[156:159]
    v_mfma_f32_16x16x32_bf16 v[144:147], v[92:95], v[44:47], v[144:147]
    v_mfma_f32_16x16x32_bf16 v[152:155], v[92:95], v[68:71], v[152:155]
    v_mfma_f32_16x16x32_bf16 v[156:159], v[116:119], v[68:71], v[156:159]
    s_nop 0
    v_cndmask_b32 v144, v21, v144, s[48:49]
    v_cndmask_b32 v145, v21, v145, s[50:51]
    v_cndmask_b32 v146, v21, v146, s[52:53]
    v_cndmask_b32 v147, v21, v147, s[54:55]
    s_nop 2
    v_cndmask_b32 v156, v21, v156, s[48:49]
    v_cndmask_b32 v157, v21, v157, s[50:51]
    v_cndmask_b32 v158, v21, v158, s[52:53]
    v_cndmask_b32 v159, v21, v159, s[54:55]
    buffer_load_dword v16, v14, s[4:7], s38 offen sc1
    buffer_load_dword v16, v14, s[4:7], s38 offen sc1
L_sp_121:
    s_waitcnt vmcnt(1)
    v_cmp_ge_u32 vcc, s37, v16
    buffer_load_dword v16, v14, s[4:7], s38 offen sc1
    s_sub_u32 s36, s36, 1
    s_cbranch_scc1 L_exit
    s_cbranch_vccz L_sp_121x
    s_waitcnt vmcnt(1)
    v_cmp_ge_u32 vcc, s37, v16
    buffer_load_dword v16, v14, s[4:7], s38 offen sc1
    s_cbranch_vccz L_sp_121x
    s_waitcnt vmcnt(1)
    v_cmp_ge_u32 vcc, s37, v16
    buffer_load_dword v16, v14, s[4:7], s38 offen sc1
    s_cbranch_vccz L_sp_121x
    s_waitcnt vmcnt(1)
    v_cmp_ge_u32 vcc, s37, v16
    buffer_load_dword v16, v14, s[4:7], s38 offen sc1
    s_cbranch_vccnz L_sp_121
L_sp_121x:
    buffer_load_dwordx4 v[120:123], v11, s[4:7], s42 offen offset:0 sc1
    buffer_load_dwordx4 v[124:127], v11, s[4:7], s42 offen offset:512 sc1
    buffer_load_dwordx4 v[128:131], v11, s[4:7], s42 offen offset:1024 sc1
    buffer_load_dwordx4 v[132:135], v11, s[4:7], s42 offen offset:1536 sc1
    buffer_load_dwordx4 v[136:139], v11, s[4:7], s42 offen offset:2048 sc1
    buffer_load_dwordx4 v[140:143], v11, s[4:7], s42 offen offset:2560 sc1
    s_waitcnt vmcnt(5)
    v_mfma_f32_16x16x32_bf16 v[148:151], v[120:123], v[24:27], 0
    v_mfma_f32_16x16x32_bf16 v[160:163], v[120:123], v[48:51], 0
    s_waitcnt vmcnt(4)
    v_mfma_f32_16x16x32_bf16 v[148:151], v[124:127], v[28:31], v[148:151]
    v_mfma_f32_16x16x32_bf16 v[160:163], v[124:127], v[52:55], v[160:163]
    s_waitcnt vmcnt(3)
    v_mfma_f32_16x16x32_bf16 v[148:151], v[128:131], v[32:35], v[148:151]
    v_mfma_f32_16x16x32_bf16 v[160:163], v[128:131], v[56:59], v[160:163]
    s_waitcnt vmcnt(2)
    v_mfma_f32_16x16x32_bf16 v[148:151], v[132:135], v[36:39], v[148:151]
    v_mfma_f32_16x16x32_bf16 v[160:163], v[132:135], v[60:63], v[160:163]
    s_waitcnt vmcnt(1)
    v_mfma_f32_16x16x32_bf16 v[148:151], v[136:139], v[40:43], v[148:151]
    v_mfma_f32_16x16x32_bf16 v[160:163], v[136:139], v[64:67], v[160:163]
    s_waitcnt vmcnt(0)
    v_mfma_f32_16x16x32_bf16 v[148:151], v[140:143], v[44:47], v[148:151]
    v_mfma_f32_16x16x32_bf16 v[160:163], v[140:143], v[68:71], v[160:163]
    s_cmp_eq_u32 s37, 63
    s_nop 2
    s_cbranch_scc1 L_pxl_122
    s_add_u32 s90, s41, 49152
    v_max_f32 v18, v144, v145
    v_max3_f32 v18, v18, v146, v147
    v_max3_f32 v18, v18, v148, v149
    v_mov_b32 v19, v18
    buffer_load_dwordx4 v[72:75], v10, s[4:7], s90 offen offset:0 sc1
    s_nop 0
    v_permlane16_swap_b32 v18, v19
    v_max_f32 v18, v18, v19
    v_mov_b32 v19, v18
    s_nop 1
    v_permlane32_swap_b32 v18, v19
    buffer_load_dwordx4 v[76:79], v10, s[4:7], s90 offen offset:1024 sc1
    v_max_f32 v18, v18, v19
    v_sub_f32 v144, v144, v18
    v_sub_f32 v145, v145, v18
    v_sub_f32 v146, v146, v18
    buffer_load_dwordx4 v[80:83], v10, s[4:7], s90 offen offset:2048 sc1
    v_sub_f32 v147, v147, v18
    v_sub_f32 v148, v148, v18
    v_sub_f32 v149, v149, v18
    v_mul_f32 v144, s44, v144
    buffer_load_dwordx4 v[84:87], v10, s[4:7], s90 offen offset:3072 sc1
    v_mul_f32 v145, s44, v145
    v_mul_f32 v146, s44, v146
    v_mul_f32 v147, s44, v147
    v_mul_f32 v148, s44, v148
    s_add_u32 s90, s41, 53248
    v_mul_f32 v149, s44, v149
    v_exp_f32 v144, v144
    v_exp_f32 v145, v145
    v_exp_f32 v146, v146
    buffer_load_dwordx4 v[88:91], v10, s[4:7], s90 offen offset:0 sc1
    v_exp_f32 v147, v147
    v_exp_f32 v148, v148
    v_exp_f32 v149, v149
    v_add_f32 v20, v144, v145
    buffer_load_dwordx4 v[92:95], v10, s[4:7], s90 offen offset:1024 sc1
    v_add_f32 v20, v20, v146
    v_add_f32 v20, v20, v147
    v_add_f32 v20, v20, v148
    v_add_f32 v20, v20, v149
    buffer_load_dwordx4 v[96:99], v10, s[4:7], s90 offen offset:2048 sc1
    v_mov_b32 v19, v20
    s_nop 1
    v_permlane16_swap_b32 v20, v19
    v_add_f32 v20, v20, v19
    v_mov_b32 v19, v20
    buffer_load_dwordx4 v[100:103], v10, s[4:7], s90 offen offset:3072 sc1
    s_nop 0
    v_permlane32_swap_b32 v20, v19
    v_add_f32 v20, v20, v19
    v_rcp_f32 v20, v20
    s_nop 0
    v_mul_f32 v144, v144, v20
    s_add_u32 s90, s41, 57344
    v_mul_f32 v145, v145, v20
    v_mul_f32 v146, v146, v20
    v_mul_f32 v147, v147, v20
    v_mul_f32 v148, v148, v20
    buffer_load_dwordx4 v[104:107], v10, s[4:7], s90 offen offset:0 sc1
    v_mul_f32 v149, v149, v20
    v_cvt_pk_bf16_f32 v164, v144, v145
    v_cvt_pk_bf16_f32 v165, v146, v147
    v_cvt_pk_bf16_f32 v166, v148, v149
    buffer_load_dwordx4 v[108:111], v10, s[4:7], s90 offen offset:1024 sc1
    v_max_f32 v18, v152, v153
    v_max3_f32 v18, v18, v154, v155
    v_max3_f32 v18, v18, v160, v161
    v_max3_f32 v18, v18, v156, v157
    buffer_load_dwordx4 v[112:115], v10, s[4:7], s90 offen offset:2048 sc1
    v_max3_f32 v18, v18, v158, v159
    v_mov_b32 v19, v18
    s_nop 1
    v_permlane16_swap_b32 v18, v19
    v_max_f32 v18, v18, v19
    buffer_load_dwordx4 v[116:119], v10, s[4:7], s90 offen offset:3072 sc1
    v_mov_b32 v19, v18
    s_nop 1
    v_permlane32_swap_b32 v18, v19
    v_max_f32 v18, v18, v19
    v_sub_f32 v152, v152, v18
    s_add_u32 s90, s41, 0
    v_sub_f32 v153, v153, v18
    v_sub_f32 v154, v154, v18
    v_sub_f32 v155, v155, v18
    v_sub_f32 v160, v160, v18
    buffer_load_dwordx4 v[24:27], v10, s[4:7], s90 offen offset:0 sc1
    v_sub_f32 v161, v161, v18
    v_sub_f32 v156, v156, v18
    v_sub_f32 v157, v157, v18
    v_sub_f32 v158, v158, v18
    buffer_load_dwordx4 v[28:31], v10, s[4:7], s90 offen offset:1024 sc1
    v_sub_f32 v159, v159, v18
    v_mul_f32 v152, s44, v152
    v_mul_f32 v153, s44, v153
    v_mul_f32 v154, s44, v154
    buffer_load_dwordx4 v[32:35], v10, s[4:7], s90 offen offset:2048 sc1
    v_mul_f32 v155, s44, v155
    v_mul_f32 v160, s44, v160
    v_mul_f32 v161, s44, v161
    v_mul_f32 v156, s44, v156
    buffer_load_dwordx4 v[36:39], v10, s[4:7], s90 offen offset:3072 sc1
    v_mul_f32 v157, s44, v157
    v_mul_f32 v158, s44, v158
    v_mul_f32 v159, s44, v159
    v_exp_f32 v152, v152
    s_add_u32 s90, s41, 4096
    v_exp_f32 v153, v153
    v_exp_f32 v154, v154
    v_exp_f32 v155, v155
    v_exp_f32 v160, v160
    buffer_load_dwordx4 v[40:43], v10, s[4:7], s90 offen offset:0 sc1
    v_exp_f32 v161, v161
    v_exp_f32 v156, v156
    v_exp_f32 v157, v157
    v_exp_f32 v158, v158
    buffer_load_dwordx4 v[44:47], v10, s[4:7], s90 offen offset:1024 sc1
    v_exp_f32 v159, v159
    v_add_f32 v20, v152, v153
    v_add_f32 v20, v20, v154
    v_add_f32 v20, v20, v155
    buffer_load_dwordx4 v[48:51], v10, s[4:7], s90 offen offset:2048 sc1
    v_add_f32 v20, v20, v160
    v_add_f32 v20, v20, v161
    v_add_f32 v20, v20, v156
    v_add_f32 v20, v20, v157
    buffer_load_dwordx4 v[52:55], v10, s[4:7], s90 offen offset:3072 sc1
    v_add_f32 v20, v20, v158
    v_add_f32 v20, v20, v159
    v_mov_b32 v19, v20
    s_nop 1
    v_permlane16_swap_b32 v20, v19
    s_add_u32 s90, s41, 8192
    v_add_f32 v20, v20, v19
    v_mov_b32 v19, v20
    s_nop 1
    v_permlane32_swap_b32 v20, v19
    v_add_f32 v20, v20, v19
    buffer_load_dwordx4 v[56:59], v10, s[4:7], s90 offen offset:0 sc1
    v_rcp_f32 v20, v20
    s_nop 0
    v_mul_f32 v152, v152, v20
    v_mul_f32 v153, v153, v20
    v_mul_f32 v154, v154, v20
    buffer_load_dwordx4 v[60:63], v10, s[4:7], s90 offen offset:1024 sc1
    v_mul_f32 v155, v155, v20
    v_mul_f32 v160, v160, v20
    v_mul_f32 v161, v161, v20
    v_mul_f32 v156, v156, v20
    buffer_load_dwordx4 v[64:67], v10, s[4:7], s90 offen offset:2048 sc1
    v_mul_f32 v157, v157, v20
    v_mul_f32 v158, v158, v20
    v_mul_f32 v159, v159, v20
    v_cvt_pk_bf16_f32 v168, v152, v153
    buffer_load_dwordx4 v[68:71], v10, s[4:7], s90 offen offset:3072 sc1
    v_cvt_pk_bf16_f32 v169, v154, v155
    v_cvt_pk_bf16_f32 v170, v160, v161
    v_cvt_pk_bf16_f32 v172, v156, v157
    v_cvt_pk_bf16_f32 v173, v158, v159
    buffer_store_dwordx4 v[164:167], v12, s[4:7], s43 offen offset:0 sc1
    buffer_store_dwordx4 v[168:171], v12, s[4:7], s43 offen offset:1024 sc1
    buffer_store_dwordx4 v[172:175], v12, s[4:7], s43 offen offset:2048 sc1
    s_waitcnt vmcnt(0)
    buffer_store_dword v17, v15, s[4:7], s38 offen sc1
    s_add_u32 s37, s37, 1
    s_branch L_px_loop_s
L_pxl_122:
    v_max_f32 v18, v144, v145
    v_max3_f32 v18, v18, v146, v147
    v_max3_f32 v18, v18, v148, v149
    v_mov_b32 v19, v18
    s_nop 1
    v_permlane16_swap_b32 v18, v19
    v_max_f32 v18, v18, v19
    v_mov_b32 v19, v18
    s_nop 1
    v_permlane32_swap_b32 v18, v19
    v_max_f32 v18, v18, v19
    v_sub_f32 v144, v144, v18
    v_sub_f32 v145, v145, v18
    v_sub_f32 v146, v146, v18
    v_sub_f32 v147, v147, v18
    v_sub_f32 v148, v148, v18
    v_sub_f32 v149, v149, v18
    v_mul_f32 v144, s44, v144
    v_mul_f32 v145, s44, v145
    v_mul_f32 v146, s44, v146
    v_mul_f32 v147, s44, v147
    v_mul_f32 v148, s44, v148
    v_mul_f32 v149, s44, v149
    v_exp_f32 v144, v144
    v_exp_f32 v145, v145
    v_exp_f32 v146, v146
    v_exp_f32 v147, v147
    v_exp_f32 v148, v148
    v_exp_f32 v149, v149
    v_add_f32 v20, v144, v145
    v_add_f32 v20, v20, v146
    v_add_f32 v20, v20, v147
    v_add_f32 v20, v20, v148
    v_add_f32 v20, v20, v149
    v_mov_b32 v19, v20
    s_nop 1
    v_permlane16_swap_b32 v20, v19
    v_add_f32 v20, v20, v19
    v_mov_b32 v19, v20
    s_nop 1
    v_permlane32_swap_b32 v20, v19
    v_add_f32 v20, v20, v19
    v_rcp_f32 v20, v20
    s_nop 0
    v_mul_f32 v144, v144, v20
    v_mul_f32 v145, v145, v20
    v_mul_f32 v146, v146, v20
    v_mul_f32 v147, v147, v20
    v_mul_f32 v148, v148, v20
    v_mul_f32 v149, v149, v20
    v_cvt_pk_bf16_f32 v164, v144, v145
    v_cvt_pk_bf16_f32 v165, v146, v147
    v_cvt_pk_bf16_f32 v166, v148, v149
    v_max_f32 v18, v152, v153
    v_max3_f32 v18, v18, v154, v155
    v_max3_f32 v18, v18, v160, v161
    v_max3_f32 v18, v18, v156, v157
    v_max3_f32 v18, v18, v158, v159
    v_mov_b32 v19, v18
    s_nop 1
    v_permlane16_swap_b32 v18, v19
    v_max_f32 v18, v18, v19
    v_mov_b32 v19, v18
    s_nop 1
    v_permlane32_swap_b32 v18, v19
    v_max_f32 v18, v18, v19
    v_sub_f32 v152, v152, v18
    v_sub_f32 v153, v153, v18
    v_sub_f32 v154, v154, v18
    v_sub_f32 v155, v155, v18
    v_sub_f32 v160, v160, v18
    v_sub_f32 v161, v161, v18
    v_sub_f32 v156, v156, v18
    v_sub_f32 v157, v157, v18
    v_sub_f32 v158, v158, v18
    v_sub_f32 v159, v159, v18
    v_mul_f32 v152, s44, v152
    v_mul_f32 v153, s44, v153
    v_mul_f32 v154, s44, v154
    v_mul_f32 v155, s44, v155
    v_mul_f32 v160, s44, v160
    v_mul_f32 v161, s44, v161
    v_mul_f32 v156, s44, v156
    v_mul_f32 v157, s44, v157
    v_mul_f32 v158, s44, v158
    v_mul_f32 v159, s44, v159
    v_exp_f32 v152, v152
    v_exp_f32 v153, v153
    v_exp_f32 v154, v154
    v_exp_f32 v155, v155
    v_exp_f32 v160, v160
    v_exp_f32 v161, v161
    v_exp_f32 v156, v156
    v_exp_f32 v157, v157
    v_exp_f32 v158, v158
    v_exp_f32 v159, v159
    v_add_f32 v20, v152, v153
    v_add_f32 v20, v20, v154
    v_add_f32 v20, v20, v155
    v_add_f32 v20, v20, v160
    v_add_f32 v20, v20, v161
    v_add_f32 v20, v20, v156
    v_add_f32 v20, v20, v157
    v_add_f32 v20, v20, v158
    v_add_f32 v20, v20, v159
    v_mov_b32 v19, v20
    s_nop 1
    v_permlane16_swap_b32 v20, v19
    v_add_f32 v20, v20, v19
    v_mov_b32 v19, v20
    s_nop 1
    v_permlane32_swap_b32 v20, v19
    v_add_f32 v20, v20, v19
    v_rcp_f32 v20, v20
    s_nop 0
    v_mul_f32 v152, v152, v20
    v_mul_f32 v153, v153, v20
    v_mul_f32 v154, v154, v20
    v_mul_f32 v155, v155, v20
    v_mul_f32 v160, v160, v20
    v_mul_f32 v161, v161, v20
    v_mul_f32 v156, v156, v20
    v_mul_f32 v157, v157, v20
    v_mul_f32 v158, v158, v20
    v_mul_f32 v159, v159, v20
    v_cvt_pk_bf16_f32 v168, v152, v153
    v_cvt_pk_bf16_f32 v169, v154, v155
    v_cvt_pk_bf16_f32 v170, v160, v161
    v_cvt_pk_bf16_f32 v172, v156, v157
    v_cvt_pk_bf16_f32 v173, v158, v159
    buffer_store_dwordx4 v[164:167], v12, s[4:7], s43 offen offset:0 sc1
    buffer_store_dwordx4 v[168:171], v12, s[4:7], s43 offen offset:1024 sc1
    buffer_store_dwordx4 v[172:175], v12, s[4:7], s43 offen offset:2048 sc1
    s_waitcnt vmcnt(0)
    buffer_store_dword v17, v15, s[4:7], s38 offen sc1
    s_endpgm
L_pa_s:
    v_mov_b32 v1, 196
L_gw_123:
    buffer_load_dword v2, v1, s[8:11], 0 offen sc1
    s_sub_u32 s36, s36, 1
    s_cbranch_scc1 L_exit
    s_waitcnt vmcnt(0)
L_gw_123c:
    v_readfirstlane_b32 s90, v2
    s_nop 0
    s_cmp_eq_u32 s90, 0
    s_cbranch_scc1 L_gw_123
    s_branch L_pa_body
.section .rodata,"a"
.p2align 6
.amdhsa_kernel concat_heads__sliding_local_dilated__memory_aug_recurrent_mem_tr__prompt_kernel
  .amdhsa_next_free_vgpr 512
  .amdhsa_next_free_sgpr 102
  .amdhsa_accum_offset 256
  .amdhsa_group_segment_fixed_size 0
  .amdhsa_kernarg_size 104
  .amdhsa_user_sgpr_count 2
  .amdhsa_user_sgpr_kernarg_segment_ptr 1
  .amdhsa_system_sgpr_workgroup_id_x 1
  .amdhsa_float_denorm_mode_32 3
.end_amdhsa_kernel
```

```asm
; @launch grid=(256,1,1) block=(256,1,1) lds=163840
.amdgcn_target "amdgcn-amd-amdhsa--gfx950"
.text
.globl concat_heads__sliding_local_dilated__memory_aug_recurrent_mem_tr__prompt_kernel
.p2align 8
.type concat_heads__sliding_local_dilated__memory_aug_recurrent_mem_tr__prompt_kernel,@function
concat_heads__sliding_local_dilated__memory_aug_recurrent_mem_tr__prompt_kernel:
    s_cmp_ge_u32 s2, 256
    s_cbranch_scc1 L_exit
    s_load_dwordx16 s[64:79], s[0:1], 0
    s_load_dwordx8 s[80:87], s[0:1], 64
    s_load_dwordx2 s[88:89], s[0:1], 96
    s_getreg_b32 s33, hwreg(HW_REG_XCC_ID, 0, 4)
    v_lshrrev_b32 v1, 6, v0
    v_and_b32 v0, 63, v0
    v_readfirstlane_b32 s32, v1
    s_mov_b32 s36, 0x40000
    s_mov_b32 s96, 0
    s_mov_b32 s97, 0
    s_and_b32 s90, s33, 4
    s_lshl_b32 s90, s90, 5
    s_and_b32 s91, s33, 3
    s_lshl_b32 s91, s91, 2
    s_add_u32 s90, s90, s91
    s_lshr_b32 s91, s33, 3
    s_lshl_b32 s91, s91, 4
    s_add_u32 s90, s90, s91
    v_mov_b32 v1, s90
    v_mov_b32 v2, 1
    v_mov_b32 v3, 0
    s_waitcnt lgkmcnt(0)
    s_mov_b32 s8, s86
    s_and_b32 s9, s87, 0xffff
    s_mov_b32 s10, 256
    s_mov_b32 s11, 0x20000
    s_mov_b32 s4, s88
    s_and_b32 s5, s89, 0xffff
    s_mov_b32 s6, 33554432
    s_mov_b32 s7, 0x20000
    s_mov_b32 s28, s84
    s_and_b32 s29, s85, 0xffff
    s_mov_b32 s30, 5242880
    s_mov_b32 s31, 0x20000
    s_cmp_lg_u32 s32, 0
    s_cbranch_scc1 L_norank
    s_mov_b64 exec, 1
    buffer_atomic_add v2, v1, s[8:11], 0 offen sc0 sc1
    s_waitcnt vmcnt(0)
    ds_write_b32 v3, v2
    s_mov_b64 exec, -1
    s_waitcnt lgkmcnt(0)
    s_branch L_rank
L_norank:
    s_and_b32 s34, s33, 7
    s_lshr_b32 s93, s2, 3
    s_mul_i32 s93, s93, 3
    s_add_u32 s93, s93, s32
    s_sub_u32 s93, s93, 1
    v_add_u32 v4, 0, v0
    v_cmp_le_u32 vcc, 96, v4
    v_subrev_u32 v5, 96, v4
    s_nop 0
    v_cndmask_b32 v4, v4, v5, vcc
    v_lshlrev_b32 v4, 4, v4
    v_mov_b32 v5, 12288
    v_cndmask_b32 v5, 0, v5, vcc
    s_mul_i32 s90, s34, 1536
    v_add3_u32 v6, v4, v5, s90
    v_add_u32 v4, 64, v0
    v_cmp_le_u32 vcc, 96, v4
    v_subrev_u32 v5, 96, v4
    s_nop 0
    v_cndmask_b32 v4, v4, v5, vcc
    v_lshlrev_b32 v4, 4, v4
    v_mov_b32 v5, 12288
    v_cndmask_b32 v5, 0, v5, vcc
    s_mul_i32 s90, s34, 1536
    v_add3_u32 v7, v4, v5, s90
    v_add_u32 v4, 128, v0
    v_cmp_le_u32 vcc, 96, v4
    v_subrev_u32 v5, 96, v4
    s_nop 0
    v_cndmask_b32 v4, v4, v5, vcc
    v_lshlrev_b32 v4, 4, v4
    v_mov_b32 v5, 12288
    v_cndmask_b32 v5, 0, v5, vcc
    s_mul_i32 s90, s34, 1536
    v_add3_u32 v8, v4, v5, s90
    s_cmp_lt_u32 s93, 64
    s_cselect_b32 s12, s78, s76
    s_cselect_b32 s13, s79, s77
    s_cselect_b32 s91, 2, 0
    s_cmp_lt_u32 s93, 32
    s_cselect_b32 s12, s78, s12
    s_cselect_b32 s13, s79, s13
    s_cselect_b32 s91, 2, s91
    s_and_b32 s13, s13, 0xffff
    s_mov_b32 s14, 7864320
    s_mov_b32 s15, 0x20000
    s_mul_i32 s91, s91, 320
    s_mul_i32 s90, s93, 10
    s_add_u32 s90, s90, s91
    s_sub_u32 s90, s90, 640
    s_mul_i32 s90, s90, 12288
    buffer_load_dwordx4 v[248:251], v6, s[12:15], s90 offen
    buffer_load_dwordx4 v[248:251], v7, s[12:15], s90 offen
    buffer_load_dwordx4 v[248:251], v8, s[12:15], s90 offen
    s_add_u32 s90, s90, 24576
    buffer_load_dwordx4 v[248:251], v6, s[12:15], s90 offen
    buffer_load_dwordx4 v[248:251], v7, s[12:15], s90 offen
    buffer_load_dwordx4 v[248:251], v8, s[12:15], s90 offen
    s_add_u32 s90, s90, 24576
    buffer_load_dwordx4 v[248:251], v6, s[12:15], s90 offen
    buffer_load_dwordx4 v[248:251], v7, s[12:15], s90 offen
    buffer_load_dwordx4 v[248:251], v8, s[12:15], s90 offen
    s_add_u32 s90, s90, 24576
    buffer_load_dwordx4 v[248:251], v6, s[12:15], s90 offen
    buffer_load_dwordx4 v[248:251], v7, s[12:15], s90 offen
    buffer_load_dwordx4 v[248:251], v8, s[12:15], s90 offen
    s_add_u32 s90, s90, 24576
    buffer_load_dwordx4 v[248:251], v6, s[12:15], s90 offen
    buffer_load_dwordx4 v[248:251], v7, s[12:15], s90 offen
    buffer_load_dwordx4 v[248:251], v8, s[12:15], s90 offen
    s_add_u32 s90, s90, 24576
L_rank:
    s_barrier
    ds_read_b32 v2, v3
    s_waitcnt lgkmcnt(0)
    v_readfirstlane_b32 s35, v2
    s_mov_b32 s34, s33
    s_barrier
    s_cmp_ge_u32 s33, 8
    s_cbranch_scc1 L_norole
    s_cmp_ge_u32 s35, 32
    s_cbranch_scc1 L_norole
    s_lshl_b32 s38, s34, 21
    s_add_u32 s38, s38, 8388608
    s_cmp_lt_u32 s35, 28
    s_cbranch_scc1 L_noini_1
    v_mov_b32 v240, -1
    v_mov_b32 v241, -1
    v_mov_b32 v242, -1
    v_mov_b32 v243, -1
    v_mov_b32 v244, 0
    v_lshlrev_b32 v4, 4, v0
    v_lshlrev_b32 v5, 2, v0
    s_sub_u32 s93, s35, 28
    s_lshl_b32 s93, s93, 2
    s_add_u32 s93, s93, s32
    s_lshl_b32 s91, s34, 4
    s_add_u32 s91, s91, s93
    s_lshl_b32 s41, s91, 8
    s_add_u32 s41, s41, 1933312
    s_mul_i32 s91, s91, 5120
    s_lshl_b32 s40, s93, 8
    s_add_u32 s40, s40, s38
    s_add_u32 s40, s40, 458752
    s_lshr_b32 s92, s93, 3
    s_mul_i32 s92, s92, 114688
    s_add_u32 s92, s92, s38
    s_and_b32 s93, s93, 7
    s_mul_i32 s93, s93, 5120
    s_add_u32 s92, s92, s93
    buffer_store_dwordx4 v[240:243], v4, s[4:7], s91 offen offset:0 sc1
    buffer_store_dwordx4 v[240:243], v4, s[4:7], s91 offen offset:1024 sc1
    buffer_store_dwordx4 v[240:243], v4, s[4:7], s91 offen offset:2048 sc1
    buffer_store_dwordx4 v[240:243], v4, s[4:7], s91 offen offset:3072 sc1
    s_add_u32 s91, s91, 4096
    buffer_store_dwordx4 v[240:243], v4, s[4:7], s91 offen offset:0 sc1
    buffer_store_dwordx4 v[240:243], v4, s[4:7], s92 offen offset:0 sc1
    buffer_store_dwordx4 v[240:243], v4, s[4:7], s92 offen offset:1024 sc1
    buffer_store_dwordx4 v[240:243], v4, s[4:7], s92 offen offset:2048 sc1
    buffer_store_dwordx4 v[240:243], v4, s[4:7], s92 offen offset:3072 sc1
    s_add_u32 s92, s92, 4096
    buffer_store_dwordx4 v[240:243], v4, s[4:7], s92 offen offset:0 sc1
    buffer_store_dword v244, v5, s[4:7], s40 offen sc1
    buffer_store_dword v244, v5, s[4:7], s41 offen sc1
    s_waitcnt vmcnt(0)
    s_barrier
    s_cmp_lg_u32 s32, 0
    s_cbranch_scc1 L_ini_2
    v_mov_b32 v1, 64
    v_mov_b32 v2, 1
    s_mov_b64 exec, 1
    buffer_atomic_add v2, v1, s[8:11], 0 offen sc0 sc1
    s_waitcnt vmcnt(0)
    v_readfirstlane_b32 s90, v2
    s_mov_b64 exec, -1
    s_cmp_lg_u32 s90, 31
    s_cbranch_scc1 L_ini_2
    v_mov_b32 v1, 192
    v_mov_b32 v2, 1
    s_mov_b64 exec, 1
    buffer_store_dword v2, v1, s[8:11], 0 offen sc1
    s_mov_b64 exec, -1
L_ini_2:
    s_barrier
    s_cmp_eq_u32 s35, 28
    s_cbranch_scc1 L_px_f
L_noini_1:
    s_sub_u32 s93, s35, 12
    s_cmp_lt_u32 s93, 6
    s_cbranch_scc1 L_v_f
    s_cmp_ge_u32 s35, 12
    s_cselect_b32 s92, 6, 0
    s_sub_u32 s93, s35, s92
    s_cmp_gt_u32 s35, 28
    s_subb_u32 s93, s93, 0
    s_lshl_b32 s93, s93, 2
    s_add_u32 s93, s93, s32
    s_cmp_ge_u32 s93, 96
    s_cbranch_scc1 L_pa_f
    v_add_u32 v4, 0, v0
    v_cmp_le_u32 vcc, 96, v4
    v_subrev_u32 v5, 96, v4
    s_nop 0
    v_cndmask_b32 v4, v4, v5, vcc
    v_lshlrev_b32 v4, 4, v4
    v_mov_b32 v5, 12288
    v_cndmask_b32 v5, 0, v5, vcc
    s_mul_i32 s90, s34, 1536
    v_add3_u32 v6, v4, v5, s90
    v_add_u32 v4, 64, v0
    v_cmp_le_u32 vcc, 96, v4
    v_subrev_u32 v5, 96, v4
    s_nop 0
    v_cndmask_b32 v4, v4, v5, vcc
    v_lshlrev_b32 v4, 4, v4
    v_mov_b32 v5, 12288
    v_cndmask_b32 v5, 0, v5, vcc
    s_mul_i32 s90, s34, 1536
    v_add3_u32 v7, v4, v5, s90
    v_add_u32 v4, 128, v0
    v_cmp_le_u32 vcc, 96, v4
    v_subrev_u32 v5, 96, v4
    s_nop 0
    v_cndmask_b32 v4, v4, v5, vcc
    v_lshlrev_b32 v4, 4, v4
    v_mov_b32 v5, 12288
    v_cndmask_b32 v5, 0, v5, vcc
    s_mul_i32 s90, s34, 1536
    v_add3_u32 v8, v4, v5, s90
    s_cmp_lt_u32 s93, 64
    s_cselect_b32 s12, s76, s74
    s_cselect_b32 s13, s77, s75
    s_cselect_b32 s91, 2, 1
    s_cmp_lt_u32 s93, 32
    s_cselect_b32 s12, s74, s12
    s_cselect_b32 s13, s75, s13
    s_cselect_b32 s91, 2, s91
    s_and_b32 s13, s13, 0xffff
    s_mov_b32 s14, 7864320
    s_mov_b32 s15, 0x20000
    s_mul_i32 s91, s91, 320
    s_mul_i32 s90, s93, 10
    s_add_u32 s90, s90, s91
    s_sub_u32 s90, s90, 640
    s_mul_i32 s90, s90, 12288
    buffer_load_dwordx4 v[248:251], v6, s[12:15], s90 offen
    buffer_load_dwordx4 v[248:251], v7, s[12:15], s90 offen
    buffer_load_dwordx4 v[248:251], v8, s[12:15], s90 offen
    s_add_u32 s90, s90, 24576
    buffer_load_dwordx4 v[248:251], v6, s[12:15], s90 offen
    buffer_load_dwordx4 v[248:251], v7, s[12:15], s90 offen
    buffer_load_dwordx4 v[248:251], v8, s[12:15], s90 offen
    s_add_u32 s90, s90, 24576
    buffer_load_dwordx4 v[248:251], v6, s[12:15], s90 offen
    buffer_load_dwordx4 v[248:251], v7, s[12:15], s90 offen
    buffer_load_dwordx4 v[248:251], v8, s[12:15], s90 offen
    s_add_u32 s90, s90, 24576
    buffer_load_dwordx4 v[248:251], v6, s[12:15], s90 offen
    buffer_load_dwordx4 v[248:251], v7, s[12:15], s90 offen
    buffer_load_dwordx4 v[248:251], v8, s[12:15], s90 offen
    s_add_u32 s90, s90, 24576
    buffer_load_dwordx4 v[248:251], v6, s[12:15], s90 offen
    buffer_load_dwordx4 v[248:251], v7, s[12:15], s90 offen
    buffer_load_dwordx4 v[248:251], v8, s[12:15], s90 offen
    s_add_u32 s90, s90, 24576
    s_waitcnt vmcnt(20)
    s_nop 0
    s_cmp_lt_u32 s35, 12
    s_cbranch_scc1 L_qkv_f
    s_cmp_lt_u32 s35, 18
    s_cbranch_scc1 L_v_f
    s_cmp_lt_u32 s35, 28
    s_cbranch_scc1 L_wo_f
    s_cmp_lt_u32 s35, 29
    s_cbranch_scc1 L_px_f
    s_branch L_pa_f
L_norole:
    v_mov_b32 v1, 192
    v_mov_b32 v2, 2
    s_mov_b64 exec, 1
    buffer_store_dword v2, v1, s[8:11], 0 offen sc1
    s_mov_b64 exec, -1
    s_branch L_slow
L_exit:
    s_endpgm
L_qkv_f:
    s_mov_b32 s12, s74
    s_and_b32 s13, s75, 0xffff
    s_mov_b32 s14, 7864320
    s_mov_b32 s15, 0x20000
    s_mov_b32 s16, s76
    s_and_b32 s17, s77, 0xffff
    s_mov_b32 s18, 7864320
    s_mov_b32 s19, 0x20000
    s_mov_b32 s40, s35
    s_mov_b32 s24, s70
    s_and_b32 s25, s71, 0xffff
    s_mov_b32 s26, 2621440
    s_mov_b32 s27, 0x20000
    v_and_b32 v1, 15, v0
    v_lshrrev_b32 v2, 4, v0
    v_lshrrev_b32 v3, 3, v0
    v_and_b32 v4, 7, v0
    s_lshl_b32 s90, s32, 3
    v_add_u32 v5, s90, v3
    s_and_b32 s91, s32, 1
    s_lshl_b32 s91, s91, 2
    v_and_b32 v6, 2, v3
    v_or_b32 v6, s91, v6
    v_xor_b32 v6, v6, v4
    v_lshlrev_b32 v6, 4, v6
    v_mul_u32_u24 v7, 12288, v5
    s_mul_i32 s92, s34, 1536
    s_lshl_b32 s93, s40, 7
    s_add_u32 s92, s92, s93
    v_add3_u32 v124, v6, v7, s92
    v_lshrrev_b32 v6, 1, v3
    v_or_b32 v6, s91, v6
    v_xor_b32 v6, v6, v4
    v_lshlrev_b32 v6, 4, v6
    v_mul_u32_u24 v7, 1280, v5
    v_add_u32 v10, v6, v7
    s_lshl_b32 s90, s32, 10
    s_add_u32 m0, s90, 81920
    s_mov_b32 s91, 0
    buffer_load_dwordx4 v124, s[16:19], s91 offen nt lds
    s_add_u32 m0, m0, 4096
    s_add_u32 s91, s91, 393216
    buffer_load_dwordx4 v124, s[16:19], s91 offen nt lds
    s_add_u32 m0, m0, 4096
    s_add_u32 s91, s91, 393216
    buffer_load_dwordx4 v124, s[16:19], s91 offen nt lds
    s_add_u32 m0, m0, 4096
    s_add_u32 s91, s91, 393216
    buffer_load_dwordx4 v124, s[16:19], s91 offen nt lds
    s_add_u32 m0, m0, 4096
    s_add_u32 s91, s91, 393216
    buffer_load_dwordx4 v124, s[16:19], s91 offen nt lds
    s_add_u32 m0, m0, 4096
    s_add_u32 s91, s91, 393216
    buffer_load_dwordx4 v124, s[16:19], s91 offen nt lds
    s_add_u32 m0, m0, 4096
    s_add_u32 s91, s91, 393216
    buffer_load_dwordx4 v124, s[16:19], s91 offen nt lds
    s_add_u32 m0, m0, 4096
    s_add_u32 s91, s91, 393216
    buffer_load_dwordx4 v124, s[16:19], s91 offen nt lds
    s_add_u32 m0, m0, 4096
    s_add_u32 s91, s91, 393216
    buffer_load_dwordx4 v124, s[16:19], s91 offen nt lds
    s_add_u32 m0, m0, 4096
    s_add_u32 s91, s91, 393216
    buffer_load_dwordx4 v124, s[16:19], s91 offen nt lds
    s_mul_i32 s60, s40, 86
    s_lshr_b32 s60, s60, 8
    s_mul_i32 s61, s60, 3
    s_sub_u32 s61, s40, s61
    s_add_u32 s90, s40, 1
    s_mul_i32 s62, s90, 86
    s_lshr_b32 s62, s62, 8
    s_mul_i32 s63, s62, 3
    s_sub_u32 s63, s90, s63
    v_lshrrev_b32 v3, 1, v2
    v_and_b32 v5, 1, v2
    s_lshl_b32 s90, s32, 9
    v_lshlrev_b32 v6, 4, v1
    v_lshl_add_u32 v6, v3, 8, v6
    v_add_u32 v6, s90, v6
    s_mul_i32 s90, s60, 12288
    s_lshl_b32 s91, s61, 11
    s_add_u32 s90, s90, s91
    v_mul_u32_u24 v7, 6144, v5
    v_add3_u32 v19, v6, v7, s90
    v_mov_b32 v22, -1
    s_mov_b32 s56, 49152
    v_lshl_add_u32 v137, v5, 11, v6
    v_add_u32 v137, 135168, v137
    s_mul_i32 s90, s40, 1280
    s_add_u32 s90, s90, 10240
    v_lshlrev_b32 v6, 1, v5
    v_or_b32 v7, v6, v3
    v_lshl_add_u32 v7, v7, 4, v1
    v_lshlrev_b32 v7, 2, v7
    v_add_u32 v7, 1024, v7
    v_or_b32 v6, v6, v1
    v_lshl_add_u32 v6, v3, 4, v6
    v_lshlrev_b32 v6, 4, v6
    s_sub_u32 s91, s32, 1
    s_lshl_b32 s91, s91, 9
    v_add_u32 v6, s91, v6
    s_cmp_eq_u32 s32, 0
    s_cselect_b64 vcc, -1, 0
    v_cndmask_b32 v6, v6, v7, vcc
    v_add_u32 v135, s90, v6
    s_lshl_b32 s91, s32, 8
    s_add_u32 s91, s91, s90
    v_lshl_add_u32 v150, v0, 2, s91
    v_and_b32 v4, 2, v1
    v_cmp_eq_u32 vcc, 0, v4
    v_mov_b32 v9, 2146435072
    s_nop 0
    v_cndmask_b32 v135, v9, v135, vcc
    s_lshl_b32 s90, s40, 10
    v_lshrrev_b32 v3, 2, v1
    v_lshlrev_b32 v3, 1, v3
    v_and_b32 v6, 1, v1
    v_or_b32 v3, v3, v6
    v_lshl_add_u32 v3, v2, 3, v3
    v_lshl_add_u32 v136, v3, 4, s90
    v_cmp_ne_u32 vcc, 0, v4
    v_mov_b32 v9, 2146435072
    s_nop 0
    v_cndmask_b32 v136, v9, v136, vcc
    v_and_b32 v6, 9, v1
    v_lshl_or_b32 v6, v4, 1, v6
    v_and_b32 v7, 4, v1
    v_lshrrev_b32 v7, 1, v7
    v_or_b32 v6, v6, v7
    v_lshlrev_b32 v6, 4, v6
    v_lshl_add_u32 v6, v2, 8, v6
    s_cmp_eq_u32 s32, 2
    s_cselect_b32 s90, 2048, 0
    s_add_u32 s90, s90, 135168
    v_add_u32 v138, s90, v6
    s_lshl_b32 s90, s60, 7
    s_lshl_b32 s91, s61, 2
    s_add_u32 s91, s91, s90
    s_add_u32 s91, s91, 459264
    s_cmp_eq_u32 s32, 3
    s_cselect_b32 s91, s91, 2146435072
    s_cselect_b32 s55, -1, 0
    v_mov_b32 v139, s91
    v_cmp_eq_u32 vcc, 0, v0
    v_mov_b32 v9, 2146435072
    s_nop 0
    v_cndmask_b32 v139, v9, v139, vcc
    v_add_u32 v21, 3072, v139
    s_mul_i32 s90, s35, 32768
    s_lshl_b32 s91, s32, 11
    s_add_u32 s90, s90, s91
    s_lshl_b32 s92, s35, 10
    s_lshl_b32 s91, s32, 8
    s_add_u32 s92, s92, s91
    s_cmp_lt_u32 s35, 10
    s_cselect_b32 s90, s90, 2146435072
    s_cselect_b32 s92, s92, 2146435072
    s_lshl_b32 s91, s34, 8
    v_lshlrev_b32 v3, 4, v0
    v_xor_b32 v3, s91, v3
    v_add_u32 v142, s90, v3
    v_xor_b32 v3, 1024, v3
    v_add_u32 v143, s90, v3
    s_min_u32 s90, s35, 9
    s_lshl_b32 s90, s90, 7
    s_add_u32 s90, s90, 460800
    s_add_u32 s90, s90, s38
    v_and_b32 v3, 3, v0
    v_lshl_add_u32 v146, v3, 2, s90
    s_add_u32 s90, s38, 460416
    v_mov_b32 v146, s90
    v_lshl_add_u32 v149, v0, 2, s92
    v_lshlrev_b32 v3, 3, v1
    v_lshl_add_u32 v3, v2, 6, v3
    v_add_u32 v148, s92, v3
    v_cmp_gt_u32 vcc, 8, v1
    v_mov_b32 v9, 2146435072
    s_nop 0
    v_cndmask_b32 v148, v9, v148, vcc
    v_lshrrev_b32 v8, 1, v1
    v_and_b32 v7, 2, v8
    v_cmp_ne_u32 vcc, 0, v7
    v_mov_b32 v5, 0x3f80
    v_mov_b32 v6, 0x3f800000
    v_cndmask_b32 v5, v5, v6, vcc
    v_bfe_u32 v6, v8, 2, 1
    v_and_b32 v7, 1, v8
    v_lshl_or_b32 v6, v7, 1, v6
    v_cmp_eq_u32 vcc, 0, v6
    s_nop 1
    v_cndmask_b32 v196, 0, v5, vcc
    v_cmp_eq_u32 vcc, 1, v6
    s_nop 1
    v_cndmask_b32 v197, 0, v5, vcc
    v_cmp_eq_u32 vcc, 2, v6
    s_nop 1
    v_cndmask_b32 v198, 0, v5, vcc
    v_cmp_eq_u32 vcc, 3, v6
    s_nop 1
    v_cndmask_b32 v199, 0, v5, vcc
    s_mov_b32 s58, 0xaaaaaaaa
    s_mov_b32 s59, 0xaaaaaaaa
    v_lshrrev_b32 v3, 2, v1
    v_and_b32 v4, 3, v1
    v_and_b32 v5, 1, v2
    v_lshl_add_u32 v6, v2, 3, v3
    v_lshlrev_b32 v6, 7, v6
    v_and_b32 v7, 2, v3
    v_lshl_or_b32 v7, v5, 2, v7
    v_lshrrev_b32 v8, 1, v4
    s_lshl_b32 s90, s32, 1
    v_or_b32 v8, s90, v8
    v_xor_b32 v7, v7, v8
    v_lshl_add_u32 v6, v7, 4, v6
    v_and_b32 v7, 1, v4
    v_lshl_add_u32 v6, v7, 3, v6
    v_add_u32 v125, 81920, v6
    v_add_u32 v126, 40960, v6
    v_add_u32 v127, 122880, v6
    s_lshl_b32 s90, s32, 9
    s_add_u32 s90, s90, 133120
    v_xor_b32 v6, 0, v5
    v_lshl_add_u32 v6, v6, 2, v3
    v_lshl_add_u32 v6, v2, 3, v6
    v_lshlrev_b32 v6, 5, v6
    v_lshl_or_b32 v7, v5, 1, 0
    v_xor_b32 v7, v7, v4
    v_lshl_add_u32 v6, v7, 3, v6
    v_add_u32 v24, 133120, v6
    v_xor_b32 v6, 1, v5
    v_lshl_add_u32 v6, v6, 2, v3
    v_lshl_add_u32 v6, v2, 3, v6
    v_lshlrev_b32 v6, 5, v6
    v_lshl_or_b32 v7, v5, 1, 1
    v_xor_b32 v7, v7, v4
    v_lshl_add_u32 v6, v7, 3, v6
    v_add_u32 v134, 133120, v6
    v_lshrrev_b32 v6, 3, v1
    v_lshlrev_b32 v6, 2, v6
    v_xor_b32 v6, v6, v1
    v_lshlrev_b32 v6, 5, v6
    v_xor_b32 v7, v2, v3
    v_lshl_add_u32 v6, v7, 3, v6
    v_add_u32 v23, s90, v6
    v_and_b32 v7, 2, v1
    v_cmp_ne_u32 vcc, 0, v7
    v_mov_b32 v6, 0x4444
    v_mov_b32 v8, 0xeeee
    v_cndmask_b32 v17, v6, v8, vcc
    v_lshlrev_b32 v6, 4, v0
    v_add_u32 v16, 122880, v6
    s_mul_i32 s90, s32, 2560
    v_lshl_add_u32 v13, v0, 4, s90
    v_lshl_add_u32 v14, v0, 2, s90
    s_add_u32 s48, s90, 122880
    v_mul_u32_u24 v6, 40, v0
    v_add_u32 v15, s48, v6
    v_mul_u32_u24 v6, 164, v0
    v_min_u32 v6, 10236, v6
    v_add_u32 v25, 122880, v6
    v_lshrrev_b32 v6, 3, v1
    v_lshlrev_b32 v6, 10, v6
    v_and_b32 v7, 7, v1
    v_lshl_add_u32 v6, v7, 7, v6
    v_lshrrev_b32 v7, 1, v1
    v_xor_b32 v7, v7, v2
    v_lshl_add_u32 v11, v7, 4, v6
    v_xor_b32 v12, 64, v11
    s_and_b32 s91, s34, 1
    s_lshl_b32 s91, s91, 12
    s_lshr_b32 s92, s34, 2
    s_lshl_b32 s92, s92, 13
    s_add_u32 s91, s91, s92
    s_and_b32 s92, s34, 2
    s_lshl_b32 s92, s92, 13
    s_add_u32 s91, s91, s92
    s_add_u32 s91, s91, 1933312
    v_lshrrev_b32 v4, 2, v0
    v_lshl_add_u32 v3, v4, 9, s91
    v_cmp_ne_u32 s[92:93], s34, v4
    v_cmp_gt_u32 vcc, 32, v0
    s_nop 0
    s_and_b64 vcc, vcc, s[92:93]
    s_and_b32 vcc_lo, vcc_lo, s55
    v_cndmask_b32 v146, v146, v3, vcc
    v_cndmask_b32 v152, 0, -1, vcc
    s_lshl_b32 s90, s32, 10
    s_add_u32 m0, s90, 40960
    s_mov_b32 s91, 0
    buffer_load_dwordx4 v124, s[12:15], s91 offen nt lds
    s_add_u32 m0, m0, 4096
    s_add_u32 s91, s91, 393216
    buffer_load_dwordx4 v124, s[12:15], s91 offen nt lds
    s_add_u32 m0, m0, 4096
    s_add_u32 s91, s91, 393216
    buffer_load_dwordx4 v124, s[12:15], s91 offen nt lds
    s_add_u32 m0, m0, 4096
    s_add_u32 s91, s91, 393216
    buffer_load_dwordx4 v124, s[12:15], s91 offen nt lds
    s_add_u32 m0, m0, 4096
    s_add_u32 s91, s91, 393216
    buffer_load_dwordx4 v124, s[12:15], s91 offen nt lds
    s_add_u32 m0, m0, 4096
    s_add_u32 s91, s91, 393216
    buffer_load_dwordx4 v124, s[12:15], s91 offen nt lds
    s_add_u32 m0, m0, 4096
    s_add_u32 s91, s91, 393216
    buffer_load_dwordx4 v124, s[12:15], s91 offen nt lds
    s_add_u32 m0, m0, 4096
    s_add_u32 s91, s91, 393216
    buffer_load_dwordx4 v124, s[12:15], s91 offen nt lds
    s_add_u32 m0, m0, 4096
    s_add_u32 s91, s91, 393216
    buffer_load_dwordx4 v124, s[12:15], s91 offen nt lds
    s_add_u32 m0, m0, 4096
    s_add_u32 s91, s91, 393216
    buffer_load_dwordx4 v124, s[12:15], s91 offen nt lds
    s_lshl_b32 s90, s32, 10
    s_add_u32 m0, s90, 122880
    s_mov_b32 s91, 3932160
    buffer_load_dwordx4 v124, s[16:19], s91 offen nt lds
    s_add_u32 m0, m0, 4096
    s_add_u32 s91, s91, 393216
    buffer_load_dwordx4 v124, s[16:19], s91 offen nt lds
    s_add_u32 m0, m0, 4096
    s_add_u32 s91, s91, 393216
    buffer_load_dwordx4 v124, s[16:19], s91 offen nt lds
    s_add_u32 m0, m0, 4096
    s_add_u32 s91, s91, 393216
    buffer_load_dwordx4 v124, s[16:19], s91 offen nt lds
    s_add_u32 m0, m0, 4096
    s_add_u32 s91, s91, 393216
    buffer_load_dwordx4 v124, s[16:19], s91 offen nt lds
    s_add_u32 m0, m0, 4096
    s_add_u32 s91, s91, 393216
    buffer_load_dwordx4 v124, s[16:19], s91 offen nt lds
    s_add_u32 m0, m0, 4096
    s_add_u32 s91, s91, 393216
    buffer_load_dwordx4 v124, s[16:19], s91 offen nt lds
    s_add_u32 m0, m0, 4096
    s_add_u32 s91, s91, 393216
    buffer_load_dwordx4 v124, s[16:19], s91 offen nt lds
    s_add_u32 m0, m0, 4096
    s_add_u32 s91, s91, 393216
    buffer_load_dwordx4 v124, s[16:19], s91 offen nt lds
    s_add_u32 m0, m0, 4096
    s_add_u32 s91, s91, 393216
    buffer_load_dwordx4 v124, s[16:19], s91 offen nt lds
    s_mov_b32 s46, 0
    s_lshl_b32 s90, s32, 10
    s_add_u32 m0, s90, 0
    s_nop 0
    buffer_load_dwordx4 v10, s[24:27], s46 offen offset:0 nt lds
    s_add_u32 m0, m0, 3968
    s_nop 0
    buffer_load_dwordx4 v10, s[24:27], s46 offen offset:128 nt lds
    s_add_u32 m0, m0, 3968
    s_nop 0
    buffer_load_dwordx4 v10, s[24:27], s46 offen offset:256 nt lds
    s_add_u32 m0, m0, 3968
    s_nop 0
    buffer_load_dwordx4 v10, s[24:27], s46 offen offset:384 nt lds
    s_add_u32 m0, m0, 3968
    s_nop 0
    buffer_load_dwordx4 v10, s[24:27], s46 offen offset:512 nt lds
    s_add_u32 m0, m0, 3968
    s_nop 0
    buffer_load_dwordx4 v10, s[24:27], s46 offen offset:640 nt lds
    s_add_u32 m0, m0, 3968
    s_nop 0
    buffer_load_dwordx4 v10, s[24:27], s46 offen offset:768 nt lds
    s_add_u32 m0, m0, 3968
    s_nop 0
    buffer_load_dwordx4 v10, s[24:27], s46 offen offset:896 nt lds
    s_add_u32 m0, m0, 3968
    s_nop 0
    buffer_load_dwordx4 v10, s[24:27], s46 offen offset:1024 nt lds
    s_add_u32 m0, m0, 3968
    s_nop 0
    buffer_load_dwordx4 v10, s[24:27], s46 offen offset:1152 nt lds
    s_waitcnt vmcnt(30)
    s_barrier
    ds_read_b64_tr_b16 a[80:81], v125 offset:0
    ds_read_b64_tr_b16 a[82:83], v125 offset:512
    ds_read_b64_tr_b16 a[84:85], v125 offset:4096
    ds_read_b64_tr_b16 a[86:87], v125 offset:4608
    ds_read_b64_tr_b16 a[88:89], v125 offset:8192
    ds_read_b64_tr_b16 a[90:91], v125 offset:8704
    ds_read_b64_tr_b16 a[92:93], v125 offset:12288
    ds_read_b64_tr_b16 a[94:95], v125 offset:12800
    ds_read_b64_tr_b16 a[96:97], v125 offset:16384
    ds_read_b64_tr_b16 a[98:99], v125 offset:16896
    ds_read_b64_tr_b16 a[100:101], v125 offset:20480
    ds_read_b64_tr_b16 a[102:103], v125 offset:20992
    ds_read_b64_tr_b16 a[104:105], v125 offset:24576
    ds_read_b64_tr_b16 a[106:107], v125 offset:25088
    ds_read_b64_tr_b16 a[108:109], v125 offset:28672
    ds_read_b64_tr_b16 a[110:111], v125 offset:29184
    ds_read_b64_tr_b16 a[112:113], v125 offset:32768
    ds_read_b64_tr_b16 a[114:115], v125 offset:33280
    ds_read_b64_tr_b16 a[116:117], v125 offset:36864
    ds_read_b64_tr_b16 a[118:119], v125 offset:37376
    s_waitcnt lgkmcnt(0)
    s_barrier
    s_lshl_b32 s90, s32, 10
    s_add_u32 m0, s90, 81920
    s_mov_b32 s91, 3932160
    buffer_load_dwordx4 v124, s[12:15], s91 offen nt lds
    s_add_u32 m0, m0, 4096
    s_add_u32 s91, s91, 393216
    buffer_load_dwordx4 v124, s[12:15], s91 offen nt lds
    s_add_u32 m0, m0, 4096
    s_add_u32 s91, s91, 393216
    buffer_load_dwordx4 v124, s[12:15], s91 offen nt lds
    s_add_u32 m0, m0, 4096
    s_add_u32 s91, s91, 393216
    buffer_load_dwordx4 v124, s[12:15], s91 offen nt lds
    s_add_u32 m0, m0, 4096
    s_add_u32 s91, s91, 393216
    buffer_load_dwordx4 v124, s[12:15], s91 offen nt lds
    s_add_u32 m0, m0, 4096
    s_add_u32 s91, s91, 393216
    buffer_load_dwordx4 v124, s[12:15], s91 offen nt lds
    s_add_u32 m0, m0, 4096
    s_add_u32 s91, s91, 393216
    buffer_load_dwordx4 v124, s[12:15], s91 offen nt lds
    s_add_u32 m0, m0, 4096
    s_add_u32 s91, s91, 393216
    buffer_load_dwordx4 v124, s[12:15], s91 offen nt lds
    s_add_u32 m0, m0, 4096
    s_add_u32 s91, s91, 393216
    buffer_load_dwordx4 v124, s[12:15], s91 offen nt lds
    s_add_u32 m0, m0, 4096
    s_add_u32 s91, s91, 393216
    buffer_load_dwordx4 v124, s[12:15], s91 offen nt lds
    s_waitcnt vmcnt(30)
    s_barrier
    ds_read_b64_tr_b16 a[0:1], v126 offset:0
    ds_read_b64_tr_b16 a[2:3], v126 offset:512
    ds_read_b64_tr_b16 a[4:5], v126 offset:4096
    ds_read_b64_tr_b16 a[6:7], v126 offset:4608
    ds_read_b64_tr_b16 a[8:9], v126 offset:8192
    ds_read_b64_tr_b16 a[10:11], v126 offset:8704
    ds_read_b64_tr_b16 a[12:13], v126 offset:12288
    ds_read_b64_tr_b16 a[14:15], v126 offset:12800
    ds_read_b64_tr_b16 a[16:17], v126 offset:16384
    ds_read_b64_tr_b16 a[18:19], v126 offset:16896
    ds_read_b64_tr_b16 a[20:21], v126 offset:20480
    ds_read_b64_tr_b16 a[22:23], v126 offset:20992
    ds_read_b64_tr_b16 a[24:25], v126 offset:24576
    ds_read_b64_tr_b16 a[26:27], v126 offset:25088
    ds_read_b64_tr_b16 a[28:29], v126 offset:28672
    ds_read_b64_tr_b16 a[30:31], v126 offset:29184
    ds_read_b64_tr_b16 a[32:33], v126 offset:32768
    ds_read_b64_tr_b16 a[34:35], v126 offset:33280
    ds_read_b64_tr_b16 a[36:37], v126 offset:36864
    ds_read_b64_tr_b16 a[38:39], v126 offset:37376
    s_waitcnt lgkmcnt(0)
    s_barrier
    s_mov_b32 s46, 40960
    s_lshl_b32 s90, s32, 10
    s_add_u32 m0, s90, 40960
    s_nop 0
    buffer_load_dwordx4 v10, s[24:27], s46 offen offset:0 nt lds
    s_add_u32 m0, m0, 3968
    s_nop 0
    buffer_load_dwordx4 v10, s[24:27], s46 offen offset:128 nt lds
    s_add_u32 m0, m0, 3968
    s_nop 0
    buffer_load_dwordx4 v10, s[24:27], s46 offen offset:256 nt lds
    s_add_u32 m0, m0, 3968
    s_nop 0
    buffer_load_dwordx4 v10, s[24:27], s46 offen offset:384 nt lds
    s_add_u32 m0, m0, 3968
    s_nop 0
    buffer_load_dwordx4 v10, s[24:27], s46 offen offset:512 nt lds
    s_add_u32 m0, m0, 3968
    s_nop 0
    buffer_load_dwordx4 v10, s[24:27], s46 offen offset:640 nt lds
    s_add_u32 m0, m0, 3968
    s_nop 0
    buffer_load_dwordx4 v10, s[24:27], s46 offen offset:768 nt lds
    s_add_u32 m0, m0, 3968
    s_nop 0
    buffer_load_dwordx4 v10, s[24:27], s46 offen offset:896 nt lds
    s_add_u32 m0, m0, 3968
    s_nop 0
    buffer_load_dwordx4 v10, s[24:27], s46 offen offset:1024 nt lds
    s_add_u32 m0, m0, 3968
    s_nop 0
    buffer_load_dwordx4 v10, s[24:27], s46 offen offset:1152 nt lds
    s_waitcnt vmcnt(30)
    s_barrier
    ds_read_b64_tr_b16 a[120:121], v127 offset:0
    ds_read_b64_tr_b16 a[122:123], v127 offset:512
    ds_read_b64_tr_b16 a[124:125], v127 offset:4096
    ds_read_b64_tr_b16 a[126:127], v127 offset:4608
    ds_read_b64_tr_b16 a[128:129], v127 offset:8192
    ds_read_b64_tr_b16 a[130:131], v127 offset:8704
    ds_read_b64_tr_b16 a[132:133], v127 offset:12288
    ds_read_b64_tr_b16 a[134:135], v127 offset:12800
    ds_read_b64_tr_b16 a[136:137], v127 offset:16384
    ds_read_b64_tr_b16 a[138:139], v127 offset:16896
    ds_read_b64_tr_b16 a[140:141], v127 offset:20480
    ds_read_b64_tr_b16 a[142:143], v127 offset:20992
    ds_read_b64_tr_b16 a[144:145], v127 offset:24576
    ds_read_b64_tr_b16 a[146:147], v127 offset:25088
    ds_read_b64_tr_b16 a[148:149], v127 offset:28672
    ds_read_b64_tr_b16 a[150:151], v127 offset:29184
    ds_read_b64_tr_b16 a[152:153], v127 offset:32768
    ds_read_b64_tr_b16 a[154:155], v127 offset:33280
    ds_read_b64_tr_b16 a[156:157], v127 offset:36864
    ds_read_b64_tr_b16 a[158:159], v127 offset:37376
    s_waitcnt lgkmcnt(0)
    s_waitcnt vmcnt(10)
    s_barrier
    ds_read_b64_tr_b16 a[40:41], v125 offset:0
    ds_read_b64_tr_b16 a[42:43], v125 offset:512
    ds_read_b64_tr_b16 a[44:45], v125 offset:4096
    ds_read_b64_tr_b16 a[46:47], v125 offset:4608
    ds_read_b64_tr_b16 a[48:49], v125 offset:8192
    ds_read_b64_tr_b16 a[50:51], v125 offset:8704
    ds_read_b64_tr_b16 a[52:53], v125 offset:12288
    ds_read_b64_tr_b16 a[54:55], v125 offset:12800
    ds_read_b64_tr_b16 a[56:57], v125 offset:16384
    ds_read_b64_tr_b16 a[58:59], v125 offset:16896
    ds_read_b64_tr_b16 a[60:61], v125 offset:20480
    ds_read_b64_tr_b16 a[62:63], v125 offset:20992
    ds_read_b64_tr_b16 a[64:65], v125 offset:24576
    ds_read_b64_tr_b16 a[66:67], v125 offset:25088
    ds_read_b64_tr_b16 a[68:69], v125 offset:28672
    ds_read_b64_tr_b16 a[70:71], v125 offset:29184
    ds_read_b64_tr_b16 a[72:73], v125 offset:32768
    ds_read_b64_tr_b16 a[74:75], v125 offset:33280
    ds_read_b64_tr_b16 a[76:77], v125 offset:36864
    ds_read_b64_tr_b16 a[78:79], v125 offset:37376
    s_waitcnt lgkmcnt(0)
    s_mov_b32 s49, 40960
    s_mov_b32 s47, 40960
    s_mov_b32 s37, -1
    s_add_u32 s44, s38, 475136
    s_add_u32 s45, s44, s56
    s_mov_b32 s46, 40960
    v_add_u32 v140, 0, v137
    v_mov_b32 v1, 192
    buffer_load_dword v2, v1, s[8:11], 0 offen sc1
    ds_read_b128 v[84:87], v11 offset:0
    ds_read_b128 v[88:91], v11 offset:2048
    ds_read_b128 v[92:95], v12 offset:0
    ds_read_b128 v[96:99], v12 offset:2048
    s_waitcnt lgkmcnt(2)
    v_mfma_f32_16x16x32_bf16 v[108:111], a[0:3], v[84:87], 0
    ds_read_b128 v[100:103], v11 offset:4096
    v_mfma_f32_16x16x32_bf16 v[112:115], a[0:3], v[88:91], 0
    ds_read_b128 v[104:107], v11 offset:6144
    v_mfma_f32_16x16x32_bf16 v[116:119], a[80:83], v[84:87], 0
    v_mfma_f32_16x16x32_bf16 v[120:123], a[80:83], v[88:91], 0
    s_waitcnt lgkmcnt(2)
    v_mfma_f32_16x16x32_bf16 v[108:111], a[4:7], v[92:95], v[108:111]
    ds_read_b128 v[84:87], v12 offset:4096
    v_mfma_f32_16x16x32_bf16 v[112:115], a[4:7], v[96:99], v[112:115]
    ds_read_b128 v[88:91], v12 offset:6144
    v_mfma_f32_16x16x32_bf16 v[116:119], a[84:87], v[92:95], v[116:119]
    v_mfma_f32_16x16x32_bf16 v[120:123], a[84:87], v[96:99], v[120:123]
    s_waitcnt lgkmcnt(2)
    v_mfma_f32_16x16x32_bf16 v[108:111], a[8:11], v[100:103], v[108:111]
    ds_read_b128 v[92:95], v11 offset:8192
    v_mfma_f32_16x16x32_bf16 v[112:115], a[8:11], v[104:107], v[112:115]
    ds_read_b128 v[96:99], v11 offset:10240
    v_mfma_f32_16x16x32_bf16 v[116:119], a[88:91], v[100:103], v[116:119]
    v_mfma_f32_16x16x32_bf16 v[120:123], a[88:91], v[104:107], v[120:123]
    s_waitcnt lgkmcnt(2)
    v_mfma_f32_16x16x32_bf16 v[108:111], a[12:15], v[84:87], v[108:111]
    ds_read_b128 v[100:103], v12 offset:8192
    v_mfma_f32_16x16x32_bf16 v[112:115], a[12:15], v[88:91], v[112:115]
    ds_read_b128 v[104:107], v12 offset:10240
    v_mfma_f32_16x16x32_bf16 v[116:119], a[92:95], v[84:87], v[116:119]
    v_mfma_f32_16x16x32_bf16 v[120:123], a[92:95], v[88:91], v[120:123]
    s_waitcnt lgkmcnt(2)
    v_mfma_f32_16x16x32_bf16 v[108:111], a[16:19], v[92:95], v[108:111]
    ds_read_b128 v[84:87], v11 offset:12288
    v_mfma_f32_16x16x32_bf16 v[112:115], a[16:19], v[96:99], v[112:115]
    ds_read_b128 v[88:91], v11 offset:14336
    v_mfma_f32_16x16x32_bf16 v[116:119], a[96:99], v[92:95], v[116:119]
    v_mfma_f32_16x16x32_bf16 v[120:123], a[96:99], v[96:99], v[120:123]
    s_waitcnt lgkmcnt(2)
    v_mfma_f32_16x16x32_bf16 v[108:111], a[20:23], v[100:103], v[108:111]
    ds_read_b128 v[92:95], v12 offset:12288
    v_mfma_f32_16x16x32_bf16 v[112:115], a[20:23], v[104:107], v[112:115]
    ds_read_b128 v[96:99], v12 offset:14336
    v_mfma_f32_16x16x32_bf16 v[116:119], a[100:103], v[100:103], v[116:119]
    v_mfma_f32_16x16x32_bf16 v[120:123], a[100:103], v[104:107], v[120:123]
    s_waitcnt lgkmcnt(2)
    v_mfma_f32_16x16x32_bf16 v[108:111], a[24:27], v[84:87], v[108:111]
    ds_read_b128 v[100:103], v11 offset:16384
    v_mfma_f32_16x16x32_bf16 v[112:115], a[24:27], v[88:91], v[112:115]
    ds_read_b128 v[104:107], v11 offset:18432
    v_mfma_f32_16x16x32_bf16 v[116:119], a[104:107], v[84:87], v[116:119]
    v_mfma_f32_16x16x32_bf16 v[120:123], a[104:107], v[88:91], v[120:123]
    s_waitcnt lgkmcnt(2)
    v_mfma_f32_16x16x32_bf16 v[108:111], a[28:31], v[92:95], v[108:111]
    ds_read_b128 v[84:87], v12 offset:16384
    v_mfma_f32_16x16x32_bf16 v[112:115], a[28:31], v[96:99], v[112:115]
    ds_read_b128 v[88:91], v12 offset:18432
    v_mfma_f32_16x16x32_bf16 v[116:119], a[108:111], v[92:95], v[116:119]
    v_mfma_f32_16x16x32_bf16 v[120:123], a[108:111], v[96:99], v[120:123]
    s_waitcnt lgkmcnt(2)
    v_mfma_f32_16x16x32_bf16 v[108:111], a[32:35], v[100:103], v[108:111]
    ds_read_b128 v[92:95], v11 offset:20480
    v_mfma_f32_16x16x32_bf16 v[112:115], a[32:35], v[104:107], v[112:115]
    ds_read_b128 v[96:99], v11 offset:22528
    v_mfma_f32_16x16x32_bf16 v[116:119], a[112:115], v[100:103], v[116:119]
    v_mfma_f32_16x16x32_bf16 v[120:123], a[112:115], v[104:107], v[120:123]
    s_waitcnt lgkmcnt(2)
    v_mfma_f32_16x16x32_bf16 v[108:111], a[36:39], v[84:87], v[108:111]
    ds_read_b128 v[100:103], v12 offset:20480
    v_mfma_f32_16x16x32_bf16 v[112:115], a[36:39], v[88:91], v[112:115]
    ds_read_b128 v[104:107], v12 offset:22528
    v_mfma_f32_16x16x32_bf16 v[116:119], a[116:119], v[84:87], v[116:119]
    v_mfma_f32_16x16x32_bf16 v[120:123], a[116:119], v[88:91], v[120:123]
    s_waitcnt lgkmcnt(2)
    v_mfma_f32_16x16x32_bf16 v[108:111], a[40:43], v[92:95], v[108:111]
    ds_read_b128 v[84:87], v11 offset:24576
    v_mfma_f32_16x16x32_bf16 v[112:115], a[40:43], v[96:99], v[112:115]
    ds_read_b128 v[88:91], v11 offset:26624
    v_mfma_f32_16x16x32_bf16 v[116:119], a[120:123], v[92:95], v[116:119]
    v_mfma_f32_16x16x32_bf16 v[120:123], a[120:123], v[96:99], v[120:123]
    s_waitcnt lgkmcnt(2)
    v_mfma_f32_16x16x32_bf16 v[108:111], a[44:47], v[100:103], v[108:111]
    ds_read_b128 v[92:95], v12 offset:24576
    v_mfma_f32_16x16x32_bf16 v[112:115], a[44:47], v[104:107], v[112:115]
    ds_read_b128 v[96:99], v12 offset:26624
    v_mfma_f32_16x16x32_bf16 v[116:119], a[124:127], v[100:103], v[116:119]
    v_mfma_f32_16x16x32_bf16 v[120:123], a[124:127], v[104:107], v[120:123]
    s_waitcnt lgkmcnt(2)
    v_mfma_f32_16x16x32_bf16 v[108:111], a[48:51], v[84:87], v[108:111]
    ds_read_b128 v[100:103], v11 offset:28672
    v_mfma_f32_16x16x32_bf16 v[112:115], a[48:51], v[88:91], v[112:115]
    ds_read_b128 v[104:107], v11 offset:30720
    v_mfma_f32_16x16x32_bf16 v[116:119], a[128:131], v[84:87], v[116:119]
    v_mfma_f32_16x16x32_bf16 v[120:123], a[128:131], v[88:91], v[120:123]
    s_waitcnt lgkmcnt(2)
    v_mfma_f32_16x16x32_bf16 v[108:111], a[52:55], v[92:95], v[108:111]
    ds_read_b128 v[84:87], v12 offset:28672
    v_mfma_f32_16x16x32_bf16 v[112:115], a[52:55], v[96:99], v[112:115]
    ds_read_b128 v[88:91], v12 offset:30720
    v_mfma_f32_16x16x32_bf16 v[116:119], a[132:135], v[92:95], v[116:119]
    v_mfma_f32_16x16x32_bf16 v[120:123], a[132:135], v[96:99], v[120:123]
    s_waitcnt lgkmcnt(2)
    v_mfma_f32_16x16x32_bf16 v[108:111], a[56:59], v[100:103], v[108:111]
    ds_read_b128 v[92:95], v11 offset:32768
    v_mfma_f32_16x16x32_bf16 v[112:115], a[56:59], v[104:107], v[112:115]
    ds_read_b128 v[96:99], v11 offset:34816
    v_mfma_f32_16x16x32_bf16 v[116:119], a[136:139], v[100:103], v[116:119]
    v_mfma_f32_16x16x32_bf16 v[120:123], a[136:139], v[104:107], v[120:123]
    s_waitcnt lgkmcnt(2)
    v_mfma_f32_16x16x32_bf16 v[108:111], a[60:63], v[84:87], v[108:111]
    ds_read_b128 v[100:103], v12 offset:32768
    v_mfma_f32_16x16x32_bf16 v[112:115], a[60:63], v[88:91], v[112:115]
    ds_read_b128 v[104:107], v12 offset:34816
    v_mfma_f32_16x16x32_bf16 v[116:119], a[140:143], v[84:87], v[116:119]
    v_mfma_f32_16x16x32_bf16 v[120:123], a[140:143], v[88:91], v[120:123]
    s_waitcnt lgkmcnt(2)
    v_mfma_f32_16x16x32_bf16 v[108:111], a[64:67], v[92:95], v[108:111]
    ds_read_b128 v[84:87], v11 offset:36864
    v_mfma_f32_16x16x32_bf16 v[112:115], a[64:67], v[96:99], v[112:115]
    ds_read_b128 v[88:91], v11 offset:38912
    v_mfma_f32_16x16x32_bf16 v[116:119], a[144:147], v[92:95], v[116:119]
    v_mfma_f32_16x16x32_bf16 v[120:123], a[144:147], v[96:99], v[120:123]
    s_waitcnt lgkmcnt(2)
    v_mfma_f32_16x16x32_bf16 v[108:111], a[68:71], v[100:103], v[108:111]
    ds_read_b128 v[92:95], v12 offset:36864
    v_mfma_f32_16x16x32_bf16 v[112:115], a[68:71], v[104:107], v[112:115]
    ds_read_b128 v[96:99], v12 offset:38912
    v_mfma_f32_16x16x32_bf16 v[116:119], a[148:151], v[100:103], v[116:119]
    v_mfma_f32_16x16x32_bf16 v[120:123], a[148:151], v[104:107], v[120:123]
    s_waitcnt lgkmcnt(0)
    v_mfma_f32_16x16x32_bf16 v[108:111], a[72:75], v[84:87], v[108:111]
    v_add_u32 v11, s49, v11
    v_mfma_f32_16x16x32_bf16 v[112:115], a[72:75], v[88:91], v[112:115]
    v_add_u32 v12, s49, v12
    v_mfma_f32_16x16x32_bf16 v[108:111], a[76:79], v[92:95], v[108:111]
    s_sub_u32 s47, s47, s49
    v_mfma_f32_16x16x32_bf16 v[112:115], a[76:79], v[96:99], v[112:115]
    s_sub_u32 s49, 0, s49
    v_mfma_f32_16x16x32_bf16 v[116:119], a[152:155], v[84:87], v[116:119]
    v_mfma_f32_16x16x32_bf16 v[120:123], a[152:155], v[88:91], v[120:123]
    v_mfma_f32_16x16x32_bf16 v[116:119], a[156:159], v[92:95], v[116:119]
    v_mfma_f32_16x16x32_bf16 v[120:123], a[156:159], v[96:99], v[120:123]
    v_cvt_pk_bf16_f32 v124, v108, v109
    v_cvt_pk_bf16_f32 v125, v110, v111
    v_cvt_pk_bf16_f32 v126, v112, v113
    v_cvt_pk_bf16_f32 v127, v114, v115
    s_nop 0
    v_permlane16_swap_b32 v124, v126
    v_permlane16_swap_b32 v125, v127
    v_cvt_pk_bf16_f32 v128, v116, v117
    v_cvt_pk_bf16_f32 v129, v118, v119
    v_cvt_pk_bf16_f32 v130, v120, v121
    v_cvt_pk_bf16_f32 v131, v122, v123
    s_nop 0
    v_permlane16_swap_b32 v128, v130
    v_permlane16_swap_b32 v129, v131
    ds_write_b128 v140, v[128:131]
    buffer_store_dwordx4 v[124:127], v19, s[4:7], s44 offen
    buffer_store_dwordx4 v[128:131], v19, s[4:7], s45 offen
    s_waitcnt vmcnt(2)
    s_branch L_gw_3c
L_gw_3:
    buffer_load_dword v2, v1, s[8:11], 0 offen sc1
    s_sub_u32 s36, s36, 1
    s_cbranch_scc1 L_exit
    s_waitcnt vmcnt(0)
L_gw_3c:
    v_readfirstlane_b32 s90, v2
    s_nop 0
    s_cmp_eq_u32 s90, 0
    s_cbranch_scc1 L_gw_3
    s_cmp_lg_u32 s90, 1
    s_cbranch_scc1 L_slow
    s_waitcnt vmcnt(2) lgkmcnt(0)
    s_barrier
    s_add_u32 s44, s38, 573440
    s_add_u32 s45, s44, s56
    s_mov_b32 s46, 81920
    v_add_u32 v140, 4096, v137
    ds_read_b128 v[84:87], v11 offset:0
    ds_read_b128 v[88:91], v11 offset:2048
    ds_read_b128 v[92:95], v12 offset:0
    ds_read_b128 v[96:99], v12 offset:2048
    s_lshl_b32 s90, s32, 10
    s_add_u32 m0, s90, s47
    s_waitcnt lgkmcnt(2)
    v_mfma_f32_16x16x32_bf16 v[108:111], a[0:3], v[84:87], 0
    ds_read_b128 v[100:103], v11 offset:4096
    s_and_b32 s50, s37, 3
    v_mfma_f32_16x16x32_bf16 v[112:115], a[0:3], v[88:91], 0
    ds_read_b128 v[104:107], v11 offset:6144
    s_mul_i32 s53, s50, 327680
    v_mfma_f32_16x16x32_bf16 v[116:119], a[80:83], v[84:87], 0
    buffer_load_dwordx4 v10, s[24:27], s46 offen offset:0 nt lds
    s_add_u32 m0, m0, 3968
    v_mfma_f32_16x16x32_bf16 v[120:123], a[80:83], v[88:91], 0
    s_waitcnt lgkmcnt(2)
    s_add_u32 s51, s37, 2
    v_mfma_f32_16x16x32_bf16 v[108:111], a[4:7], v[92:95], v[108:111]
    ds_read_b128 v[84:87], v12 offset:4096
    s_and_b32 s50, s51, 3
    v_mfma_f32_16x16x32_bf16 v[112:115], a[4:7], v[96:99], v[112:115]
    ds_read_b128 v[88:91], v12 offset:6144
    s_mul_i32 s50, s50, 98304
    v_mfma_f32_16x16x32_bf16 v[116:119], a[84:87], v[92:95], v[116:119]
    buffer_load_dwordx4 v10, s[24:27], s46 offen offset:128 nt lds
    s_add_u32 m0, m0, 3968
    v_mfma_f32_16x16x32_bf16 v[120:123], a[84:87], v[96:99], v[120:123]
    s_waitcnt lgkmcnt(2)
    s_add_u32 s50, s50, 475136
    v_mfma_f32_16x16x32_bf16 v[108:111], a[8:11], v[100:103], v[108:111]
    ds_read_b128 v[92:95], v11 offset:8192
    s_add_u32 s44, s38, s50
    v_mfma_f32_16x16x32_bf16 v[112:115], a[8:11], v[104:107], v[112:115]
    ds_read_b128 v[96:99], v11 offset:10240
    s_add_u32 s45, s44, s56
    v_mfma_f32_16x16x32_bf16 v[116:119], a[88:91], v[100:103], v[116:119]
    buffer_load_dwordx4 v10, s[24:27], s46 offen offset:256 nt lds
    s_add_u32 m0, m0, 3968
    v_mfma_f32_16x16x32_bf16 v[120:123], a[88:91], v[104:107], v[120:123]
    s_waitcnt lgkmcnt(2)
    s_and_b32 s50, s51, 3
    v_mfma_f32_16x16x32_bf16 v[108:111], a[12:15], v[84:87], v[108:111]
    ds_read_b128 v[100:103], v12 offset:8192
    s_lshl_b32 s50, s50, 12
    v_mfma_f32_16x16x32_bf16 v[112:115], a[12:15], v[88:91], v[112:115]
    ds_read_b128 v[104:107], v12 offset:10240
    v_add_u32 v140, s50, v137
    v_mfma_f32_16x16x32_bf16 v[116:119], a[92:95], v[84:87], v[116:119]
    buffer_load_dwordx4 v10, s[24:27], s46 offen offset:384 nt lds
    s_add_u32 m0, m0, 3968
    v_mfma_f32_16x16x32_bf16 v[120:123], a[92:95], v[88:91], v[120:123]
    s_waitcnt lgkmcnt(2)
    s_add_u32 s37, s37, 1
    v_mfma_f32_16x16x32_bf16 v[108:111], a[16:19], v[92:95], v[108:111]
    ds_read_b128 v[84:87], v11 offset:12288
    s_mov_b32 s52, 0
    v_mfma_f32_16x16x32_bf16 v[112:115], a[16:19], v[96:99], v[112:115]
    ds_read_b128 v[88:91], v11 offset:14336
    s_and_b32 s50, s37, 3
    v_mfma_f32_16x16x32_bf16 v[116:119], a[96:99], v[92:95], v[116:119]
    buffer_load_dwordx4 v10, s[24:27], s46 offen offset:512 nt lds
    s_add_u32 m0, m0, 3968
    v_mfma_f32_16x16x32_bf16 v[120:123], a[96:99], v[96:99], v[120:123]
    s_waitcnt lgkmcnt(2)
    s_mul_i32 s51, s50, 114688
    v_mfma_f32_16x16x32_bf16 v[108:111], a[20:23], v[100:103], v[108:111]
    ds_read_b128 v[92:95], v12 offset:12288
    s_add_u32 s41, s38, s51
    v_mfma_f32_16x16x32_bf16 v[112:115], a[20:23], v[104:107], v[112:115]
    ds_read_b128 v[96:99], v12 offset:14336
    s_and_b32 s54, s37, s55
    v_mfma_f32_16x16x32_bf16 v[116:119], a[100:103], v[100:103], v[116:119]
    buffer_load_dwordx4 v10, s[24:27], s46 offen offset:640 nt lds
    s_add_u32 m0, m0, 3968
    v_mfma_f32_16x16x32_bf16 v[120:123], a[100:103], v[104:107], v[120:123]
    s_waitcnt lgkmcnt(2)
    s_lshl_b32 s50, s50, 12
    v_mfma_f32_16x16x32_bf16 v[108:111], a[24:27], v[84:87], v[108:111]
    ds_read_b128 v[100:103], v11 offset:16384
    v_add_u32 v141, s50, v138
    v_mfma_f32_16x16x32_bf16 v[112:115], a[24:27], v[88:91], v[112:115]
    ds_read_b128 v[104:107], v11 offset:18432
    s_add_u32 s43, s41, 40960
    v_mfma_f32_16x16x32_bf16 v[116:119], a[104:107], v[84:87], v[116:119]
    buffer_load_dwordx4 v10, s[24:27], s46 offen offset:768 nt lds
    s_add_u32 m0, m0, 3968
    v_mfma_f32_16x16x32_bf16 v[120:123], a[104:107], v[88:91], v[120:123]
    s_waitcnt lgkmcnt(2)
    v_mfma_f32_16x16x32_bf16 v[108:111], a[28:31], v[92:95], v[108:111]
    ds_read_b128 v[84:87], v12 offset:16384
    v_mfma_f32_16x16x32_bf16 v[112:115], a[28:31], v[96:99], v[112:115]
    ds_read_b128 v[88:91], v12 offset:18432
    v_mfma_f32_16x16x32_bf16 v[116:119], a[108:111], v[92:95], v[116:119]
    buffer_load_dwordx4 v10, s[24:27], s46 offen offset:896 nt lds
    s_add_u32 m0, m0, 3968
    v_mfma_f32_16x16x32_bf16 v[120:123], a[108:111], v[96:99], v[120:123]
    s_waitcnt lgkmcnt(2)
    v_mfma_f32_16x16x32_bf16 v[108:111], a[32:35], v[100:103], v[108:111]
    ds_read_b128 v[92:95], v11 offset:20480
    v_mfma_f32_16x16x32_bf16 v[112:115], a[32:35], v[104:107], v[112:115]
    ds_read_b128 v[96:99], v11 offset:22528
    v_mfma_f32_16x16x32_bf16 v[116:119], a[112:115], v[100:103], v[116:119]
    buffer_load_dwordx4 v10, s[24:27], s46 offen offset:1024 nt lds
    s_add_u32 m0, m0, 3968
    v_mfma_f32_16x16x32_bf16 v[120:123], a[112:115], v[104:107], v[120:123]
    s_waitcnt lgkmcnt(2)
    v_mfma_f32_16x16x32_bf16 v[108:111], a[36:39], v[84:87], v[108:111]
    ds_read_b128 v[100:103], v12 offset:20480
    v_mfma_f32_16x16x32_bf16 v[112:115], a[36:39], v[88:91], v[112:115]
    ds_read_b128 v[104:107], v12 offset:22528
    v_mfma_f32_16x16x32_bf16 v[116:119], a[116:119], v[84:87], v[116:119]
    buffer_load_dwordx4 v10, s[24:27], s46 offen offset:1152 nt lds
    v_mfma_f32_16x16x32_bf16 v[120:123], a[116:119], v[88:91], v[120:123]
    s_waitcnt lgkmcnt(2)
    v_mfma_f32_16x16x32_bf16 v[108:111], a[40:43], v[92:95], v[108:111]
    ds_read_b128 v[84:87], v11 offset:24576
    v_mfma_f32_16x16x32_bf16 v[112:115], a[40:43], v[96:99], v[112:115]
    ds_read_b128 v[88:91], v11 offset:26624
    v_mfma_f32_16x16x32_bf16 v[116:119], a[120:123], v[92:95], v[116:119]
    v_mfma_f32_16x16x32_bf16 v[120:123], a[120:123], v[96:99], v[120:123]
    s_waitcnt lgkmcnt(2)
    v_mfma_f32_16x16x32_bf16 v[108:111], a[44:47], v[100:103], v[108:111]
    ds_read_b128 v[92:95], v12 offset:24576
    v_mfma_f32_16x16x32_bf16 v[112:115], a[44:47], v[104:107], v[112:115]
    ds_read_b128 v[96:99], v12 offset:26624
    v_mfma_f32_16x16x32_bf16 v[116:119], a[124:127], v[100:103], v[116:119]
    v_mfma_f32_16x16x32_bf16 v[120:123], a[124:127], v[104:107], v[120:123]
    s_waitcnt lgkmcnt(2)
    v_mfma_f32_16x16x32_bf16 v[108:111], a[48:51], v[84:87], v[108:111]
    ds_read_b128 v[100:103], v11 offset:28672
    v_mfma_f32_16x16x32_bf16 v[112:115], a[48:51], v[88:91], v[112:115]
    ds_read_b128 v[104:107], v11 offset:30720
    v_mfma_f32_16x16x32_bf16 v[116:119], a[128:131], v[84:87], v[116:119]
    v_mfma_f32_16x16x32_bf16 v[120:123], a[128:131], v[88:91], v[120:123]
    s_waitcnt lgkmcnt(2)
    v_mfma_f32_16x16x32_bf16 v[108:111], a[52:55], v[92:95], v[108:111]
    ds_read_b128 v[84:87], v12 offset:28672
    v_mfma_f32_16x16x32_bf16 v[112:115], a[52:55], v[96:99], v[112:115]
    ds_read_b128 v[88:91], v12 offset:30720
    v_mfma_f32_16x16x32_bf16 v[116:119], a[132:135], v[92:95], v[116:119]
    v_mfma_f32_16x16x32_bf16 v[120:123], a[132:135], v[96:99], v[120:123]
    s_waitcnt lgkmcnt(2)
    v_mfma_f32_16x16x32_bf16 v[108:111], a[56:59], v[100:103], v[108:111]
    ds_read_b128 v[92:95], v11 offset:32768
    v_mfma_f32_16x16x32_bf16 v[112:115], a[56:59], v[104:107], v[112:115]
    ds_read_b128 v[96:99], v11 offset:34816
    v_mfma_f32_16x16x32_bf16 v[116:119], a[136:139], v[100:103], v[116:119]
    v_mfma_f32_16x16x32_bf16 v[120:123], a[136:139], v[104:107], v[120:123]
    s_waitcnt lgkmcnt(2)
    v_mfma_f32_16x16x32_bf16 v[108:111], a[60:63], v[84:87], v[108:111]
    ds_read_b128 v[100:103], v12 offset:32768
    v_mfma_f32_16x16x32_bf16 v[112:115], a[60:63], v[88:91], v[112:115]
    ds_read_b128 v[104:107], v12 offset:34816
    v_mfma_f32_16x16x32_bf16 v[116:119], a[140:143], v[84:87], v[116:119]
    v_mfma_f32_16x16x32_bf16 v[120:123], a[140:143], v[88:91], v[120:123]
    s_waitcnt lgkmcnt(2)
    v_mfma_f32_16x16x32_bf16 v[108:111], a[64:67], v[92:95], v[108:111]
    ds_read_b128 v[84:87], v11 offset:36864
    v_mfma_f32_16x16x32_bf16 v[112:115], a[64:67], v[96:99], v[112:115]
    ds_read_b128 v[88:91], v11 offset:38912
    v_mfma_f32_16x16x32_bf16 v[116:119], a[144:147], v[92:95], v[116:119]
    v_mfma_f32_16x16x32_bf16 v[120:123], a[144:147], v[96:99], v[120:123]
    s_waitcnt lgkmcnt(2)
    v_mfma_f32_16x16x32_bf16 v[108:111], a[68:71], v[100:103], v[108:111]
    ds_read_b128 v[92:95], v12 offset:36864
    v_mfma_f32_16x16x32_bf16 v[112:115], a[68:71], v[104:107], v[112:115]
    ds_read_b128 v[96:99], v12 offset:38912
    v_mfma_f32_16x16x32_bf16 v[116:119], a[148:151], v[100:103], v[116:119]
    v_mfma_f32_16x16x32_bf16 v[120:123], a[148:151], v[104:107], v[120:123]
    s_waitcnt lgkmcnt(0)
    v_mfma_f32_16x16x32_bf16 v[108:111], a[72:75], v[84:87], v[108:111]
    v_add_u32 v11, s49, v11
    v_mfma_f32_16x16x32_bf16 v[112:115], a[72:75], v[88:91], v[112:115]
    v_add_u32 v12, s49, v12
    v_mfma_f32_16x16x32_bf16 v[108:111], a[76:79], v[92:95], v[108:111]
    s_sub_u32 s47, s47, s49
    v_mfma_f32_16x16x32_bf16 v[112:115], a[76:79], v[96:99], v[112:115]
    s_sub_u32 s49, 0, s49
    v_mfma_f32_16x16x32_bf16 v[116:119], a[152:155], v[84:87], v[116:119]
    v_mfma_f32_16x16x32_bf16 v[120:123], a[152:155], v[88:91], v[120:123]
    v_mfma_f32_16x16x32_bf16 v[116:119], a[156:159], v[92:95], v[116:119]
    v_mfma_f32_16x16x32_bf16 v[120:123], a[156:159], v[96:99], v[120:123]
    v_cvt_pk_bf16_f32 v124, v108, v109
    v_cvt_pk_bf16_f32 v125, v110, v111
    v_cvt_pk_bf16_f32 v126, v112, v113
    v_cvt_pk_bf16_f32 v127, v114, v115
    s_nop 0
    v_permlane16_swap_b32 v124, v126
    v_permlane16_swap_b32 v125, v127
    v_cvt_pk_bf16_f32 v128, v116, v117
    v_cvt_pk_bf16_f32 v129, v118, v119
    v_cvt_pk_bf16_f32 v130, v120, v121
    v_cvt_pk_bf16_f32 v131, v122, v123
    s_nop 0
    v_permlane16_swap_b32 v128, v130
    v_permlane16_swap_b32 v129, v131
    ds_write_b128 v140, v[128:131]
    buffer_store_dwordx4 v[124:127], v19, s[4:7], s44 offen
    buffer_store_dwordx4 v[128:131], v19, s[4:7], s45 offen
    s_mov_b32 m0, s48
L_qkv_loop_f:
    s_add_u32 s50, s37, 2
    s_and_b32 s50, s50, 3
    s_mul_i32 s50, s50, 114688
    s_add_u32 s42, s38, s50
    s_add_u32 s50, s37, 3
    s_min_u32 s50, s50, 63
    s_mul_i32 s46, s50, 40960
    s_add_u32 s51, s37, 1
    v_mov_b32 v20, s51
    s_mov_b32 m0, s48
    v_mov_b32 v68, 0
    v_mov_b32 v69, 0
    v_mov_b32 v70, 0
    v_mov_b32 v71, 0
    v_mov_b32 v72, 0
    v_mov_b32 v73, 0
    v_mov_b32 v74, 0
    v_mov_b32 v75, 0
    ds_read_b128 v[156:159], v141
    ds_read_b128 v[160:163], v141 offset:1024
    buffer_load_dwordx4 v13, s[4:7], s41 offen sc1 lds
    buffer_load_dwordx4 v13, s[4:7], s41 offen offset:1024 sc1 lds
    buffer_load_dword v14, s[4:7], s41 offen offset:2048 sc1 lds
    buffer_load_dword v14, s[4:7], s41 offen offset:2304 sc1 lds
    s_waitcnt vmcnt(0)
    ds_read_b32 v18, v15
    s_waitcnt lgkmcnt(0)
    v_cmp_eq_u32 vcc, -1, v18
    s_cbranch_vccnz L_poll_5c
L_poll_5x:
    s_barrier
    ds_read_b128 v[28:31], v16 offset:0
    ds_read_b128 v[32:35], v16 offset:1024
    ds_read_b128 v[36:39], v16 offset:2048
    ds_read_b128 v[40:43], v16 offset:3072
    s_waitcnt lgkmcnt(3)
    v_smfmac_f32_16x16x64_bf16 v[68:71], v[28:31], a[0:7], v17
    ds_read_b128 v[44:47], v16 offset:4096
    v_smfmac_f32_16x16x64_bf16 v[72:75], v[28:31], a[80:87], v17
    ds_read_b128 v[48:51], v16 offset:5120
    s_waitcnt lgkmcnt(4)
    v_smfmac_f32_16x16x64_bf16 v[68:71], v[32:35], a[8:15], v17
    ds_read_b128 v[52:55], v16 offset:6144
    v_smfmac_f32_16x16x64_bf16 v[72:75], v[32:35], a[88:95], v17
    ds_read_b128 v[56:59], v16 offset:7168
    s_waitcnt lgkmcnt(5)
    v_smfmac_f32_16x16x64_bf16 v[68:71], v[36:39], a[16:23], v17
    ds_read_b128 v[60:63], v16 offset:8192
    s_waitcnt lgkmcnt(5)
    v_smfmac_f32_16x16x64_bf16 v[68:71], v[40:43], a[24:31], v17
    ds_read_b128 v[64:67], v16 offset:9216
    s_waitcnt lgkmcnt(5)
    v_smfmac_f32_16x16x64_bf16 v[68:71], v[44:47], a[32:39], v17
    s_waitcnt lgkmcnt(4)
    v_smfmac_f32_16x16x64_bf16 v[68:71], v[48:51], a[40:47], v17
    s_waitcnt lgkmcnt(3)
    v_smfmac_f32_16x16x64_bf16 v[68:71], v[52:55], a[48:55], v17
    s_waitcnt lgkmcnt(2)
    v_smfmac_f32_16x16x64_bf16 v[68:71], v[56:59], a[56:63], v17
    s_waitcnt lgkmcnt(1)
    v_smfmac_f32_16x16x64_bf16 v[68:71], v[60:63], a[64:71], v17
    s_waitcnt lgkmcnt(0)
    v_smfmac_f32_16x16x64_bf16 v[68:71], v[64:67], a[72:79], v17
L_redo_4:
    v_smfmac_f32_16x16x64_bf16 v[72:75], v[36:39], a[96:103], v17
    v_smfmac_f32_16x16x64_bf16 v[72:75], v[40:43], a[104:111], v17
    buffer_store_dword v20, v21, s[4:7], s38 offen offset:0
    v_smfmac_f32_16x16x64_bf16 v[72:75], v[44:47], a[112:119], v17
    v_add_f32 v68, v68, v70
    v_add_f32 v69, v69, v71
    v_smfmac_f32_16x16x64_bf16 v[72:75], v[48:51], a[120:127], v17
    v_cvt_pk_bf16_f32 v132, v68, v69
    ds_write_b32 v23, v132
    v_smfmac_f32_16x16x64_bf16 v[72:75], v[52:55], a[128:135], v17
    v_cmp_u_f32 vcc, v68, v69
    v_smfmac_f32_16x16x64_bf16 v[72:75], v[56:59], a[136:143], v17
    v_smfmac_f32_16x16x64_bf16 v[72:75], v[60:63], a[144:151], v17
    s_cbranch_vccnz L_nan_6
L_cont_7:
    v_smfmac_f32_16x16x64_bf16 v[72:75], v[64:67], a[152:159], v17
    s_waitcnt lgkmcnt(0)
    s_barrier
    ds_read_b64_tr_b16 v[76:77], v24 offset:0
    ds_read_b64_tr_b16 v[78:79], v134 offset:0
    ds_read_b64_tr_b16 v[80:81], v24 offset:1024
    ds_read_b64_tr_b16 v[82:83], v134 offset:1024
    s_cmp_eq_u32 s32, 0
    s_cbranch_scc1 L_w0_8
    s_cmp_eq_u32 s32, 3
    s_cbranch_scc1 L_w3_9
    v_pk_add_f32 v[72:73], v[72:73], v[74:75]
    v_cvt_pk_bf16_f32 v133, v72, v73
    ds_write_b32 v23, v133 offset:4
    s_waitcnt lgkmcnt(3)
    v_mfma_f32_16x16x32_bf16 v[164:167], v[156:159], v[76:79], 0
    s_waitcnt lgkmcnt(1)
    v_mfma_f32_16x16x32_bf16 v[164:167], v[160:163], v[80:83], v[164:167]
    s_waitcnt lgkmcnt(0)
    s_barrier
    s_nop 5
    buffer_store_dwordx4 v[164:167], v135, s[4:7], s41 offen
    ds_read_b128 v[84:87], v11 offset:0
    ds_read_b128 v[88:91], v11 offset:2048
    ds_read_b128 v[92:95], v12 offset:0
    ds_read_b128 v[96:99], v12 offset:2048
    s_branch L_join_10
L_w0_8:
    v_pk_add_f32 v[72:73], v[72:73], v[74:75]
    v_cvt_pk_bf16_f32 v133, v72, v73
    ds_write_b32 v23, v133 offset:4
    s_waitcnt lgkmcnt(0)
    s_barrier
    ds_read_b64_tr_b16 v[76:77], v24 offset:0
    ds_read_b64_tr_b16 v[78:79], v134 offset:0
    ds_read_b64_tr_b16 v[80:81], v24 offset:1024
    ds_read_b64_tr_b16 v[82:83], v134 offset:1024
    s_waitcnt lgkmcnt(2)
    v_mfma_f32_16x16x32_bf16 v[164:167], v[76:79], v[76:79], 0
    s_waitcnt lgkmcnt(0)
    v_mfma_f32_16x16x32_bf16 v[164:167], v[80:83], v[80:83], v[164:167]
    ds_read_b128 v[84:87], v11 offset:0
    ds_read_b128 v[88:91], v11 offset:2048
    ds_read_b128 v[92:95], v12 offset:0
    ds_read_b128 v[96:99], v12 offset:2048
    s_nop 3
    buffer_store_dword v166, v135, s[4:7], s41 offen
    buffer_store_dword v167, v135, s[4:7], s41 offen offset:8
    s_branch L_join_10
L_w3_9:
    v_pk_add_f32 v[72:73], v[72:73], v[74:75]
    v_cvt_pk_bf16_f32 v133, v72, v73
    ds_write_b32 v23, v133 offset:4
    s_waitcnt lgkmcnt(0)
    s_barrier
    ds_read_b64_tr_b16 v[76:77], v24 offset:0
    ds_read_b64_tr_b16 v[78:79], v134 offset:0
    ds_read_b64_tr_b16 v[80:81], v24 offset:1024
    ds_read_b64_tr_b16 v[82:83], v134 offset:1024
    s_waitcnt lgkmcnt(0)
    ds_read_b128 v[84:87], v11 offset:0
    ds_read_b128 v[88:91], v11 offset:2048
    ds_read_b128 v[92:95], v12 offset:0
    ds_read_b128 v[96:99], v12 offset:2048
    s_waitcnt lgkmcnt(0)
    buffer_store_dwordx4 v[76:79], v136, s[4:7], s43 offen
    buffer_store_dwordx4 v[80:83], v136, s[4:7], s43 offen offset:512
L_join_10:
    s_cmp_eq_u32 s37, 63
    s_cbranch_scc1 L_end_11
    s_cmp_eq_u32 s37, 0
    s_cbranch_scc1 L_sd_12c
L_sd_12:
    s_lshl_b32 s90, s32, 10
    s_add_u32 m0, s90, s47
    s_waitcnt lgkmcnt(2)
    v_mfma_f32_16x16x32_bf16 v[108:111], a[0:3], v[84:87], 0
    ds_read_b128 v[100:103], v11 offset:4096
    s_and_b32 s50, s37, 3
    v_mfma_f32_16x16x32_bf16 v[112:115], a[0:3], v[88:91], 0
    ds_read_b128 v[104:107], v11 offset:6144
    s_mul_i32 s53, s50, 327680
    v_mfma_f32_16x16x32_bf16 v[116:119], a[80:83], v[84:87], 0
    s_add_u32 s51, s37, 2
    s_and_b32 s50, s51, 3
    v_mfma_f32_16x16x32_bf16 v[120:123], a[80:83], v[88:91], 0
    s_waitcnt lgkmcnt(2)
    s_mul_i32 s50, s50, 98304
    v_mfma_f32_16x16x32_bf16 v[108:111], a[4:7], v[92:95], v[108:111]
    ds_read_b128 v[84:87], v12 offset:4096
    s_add_u32 s50, s50, 475136
    v_mfma_f32_16x16x32_bf16 v[112:115], a[4:7], v[96:99], v[112:115]
    ds_read_b128 v[88:91], v12 offset:6144
    s_add_u32 s44, s38, s50
    v_mfma_f32_16x16x32_bf16 v[116:119], a[84:87], v[92:95], v[116:119]
    s_add_u32 s45, s44, s56
    s_and_b32 s50, s51, 3
    v_mfma_f32_16x16x32_bf16 v[120:123], a[84:87], v[96:99], v[120:123]
    s_waitcnt lgkmcnt(2)
    s_lshl_b32 s50, s50, 12
    v_mfma_f32_16x16x32_bf16 v[108:111], a[8:11], v[100:103], v[108:111]
    ds_read_b128 v[92:95], v11 offset:8192
    v_add_u32 v140, s50, v137
    v_mfma_f32_16x16x32_bf16 v[112:115], a[8:11], v[104:107], v[112:115]
    ds_read_b128 v[96:99], v11 offset:10240
    s_add_u32 s37, s37, 1
    v_mfma_f32_16x16x32_bf16 v[116:119], a[88:91], v[100:103], v[116:119]
    s_mov_b32 s52, 0
    s_and_b32 s50, s37, 3
    v_mfma_f32_16x16x32_bf16 v[120:123], a[88:91], v[104:107], v[120:123]
    s_waitcnt lgkmcnt(2)
    s_mul_i32 s51, s50, 114688
    v_mfma_f32_16x16x32_bf16 v[108:111], a[12:15], v[84:87], v[108:111]
    ds_read_b128 v[100:103], v12 offset:8192
    s_add_u32 s41, s38, s51
    v_mfma_f32_16x16x32_bf16 v[112:115], a[12:15], v[88:91], v[112:115]
    ds_read_b128 v[104:107], v12 offset:10240
    s_and_b32 s54, s37, s55
    v_mfma_f32_16x16x32_bf16 v[116:119], a[92:95], v[84:87], v[116:119]
    buffer_store_dword v22, v150, s[4:7], s42 offen offset:0
    buffer_store_dword v22, v149, s[4:7], s42 offen offset:0
    v_mfma_f32_16x16x32_bf16 v[120:123], a[92:95], v[88:91], v[120:123]
    s_waitcnt lgkmcnt(2)
    s_lshl_b32 s50, s50, 12
    v_mfma_f32_16x16x32_bf16 v[108:111], a[16:19], v[92:95], v[108:111]
    ds_read_b128 v[84:87], v11 offset:12288
    v_add_u32 v141, s50, v138
    v_mfma_f32_16x16x32_bf16 v[112:115], a[16:19], v[96:99], v[112:115]
    ds_read_b128 v[88:91], v11 offset:14336
    s_add_u32 s43, s41, 40960
    v_mfma_f32_16x16x32_bf16 v[116:119], a[96:99], v[92:95], v[116:119]
    buffer_store_dword v22, v150, s[4:7], s42 offen offset:256
    v_mfma_f32_16x16x32_bf16 v[120:123], a[96:99], v[96:99], v[120:123]
    s_waitcnt lgkmcnt(2)
    v_mfma_f32_16x16x32_bf16 v[108:111], a[20:23], v[100:103], v[108:111]
    ds_read_b128 v[92:95], v12 offset:12288
    v_mfma_f32_16x16x32_bf16 v[112:115], a[20:23], v[104:107], v[112:115]
    ds_read_b128 v[96:99], v12 offset:14336
    v_mfma_f32_16x16x32_bf16 v[116:119], a[100:103], v[100:103], v[116:119]
    buffer_load_dwordx4 v10, s[24:27], s46 offen offset:0 nt lds
    s_add_u32 m0, m0, 3968
    v_mfma_f32_16x16x32_bf16 v[120:123], a[100:103], v[104:107], v[120:123]
    s_waitcnt lgkmcnt(2)
    v_mfma_f32_16x16x32_bf16 v[108:111], a[24:27], v[84:87], v[108:111]
    ds_read_b128 v[100:103], v11 offset:16384
    v_mfma_f32_16x16x32_bf16 v[112:115], a[24:27], v[88:91], v[112:115]
    ds_read_b128 v[104:107], v11 offset:18432
    v_mfma_f32_16x16x32_bf16 v[116:119], a[104:107], v[84:87], v[116:119]
    buffer_load_dwordx4 v10, s[24:27], s46 offen offset:128 nt lds
    s_add_u32 m0, m0, 3968
    v_mfma_f32_16x16x32_bf16 v[120:123], a[104:107], v[88:91], v[120:123]
    s_waitcnt lgkmcnt(2)
    v_mfma_f32_16x16x32_bf16 v[108:111], a[28:31], v[92:95], v[108:111]
    ds_read_b128 v[84:87], v12 offset:16384
    v_mfma_f32_16x16x32_bf16 v[112:115], a[28:31], v[96:99], v[112:115]
    ds_read_b128 v[88:91], v12 offset:18432
    v_mfma_f32_16x16x32_bf16 v[116:119], a[108:111], v[92:95], v[116:119]
    buffer_load_dwordx4 v10, s[24:27], s46 offen offset:256 nt lds
    s_add_u32 m0, m0, 3968
    v_mfma_f32_16x16x32_bf16 v[120:123], a[108:111], v[96:99], v[120:123]
    s_waitcnt lgkmcnt(2)
    v_mfma_f32_16x16x32_bf16 v[108:111], a[32:35], v[100:103], v[108:111]
    ds_read_b128 v[92:95], v11 offset:20480
    v_mfma_f32_16x16x32_bf16 v[112:115], a[32:35], v[104:107], v[112:115]
    ds_read_b128 v[96:99], v11 offset:22528
    v_mfma_f32_16x16x32_bf16 v[116:119], a[112:115], v[100:103], v[116:119]
    s_waitcnt vmcnt(6)
    buffer_store_dword v20, v139, s[4:7], s38 offen
    v_mfma_f32_16x16x32_bf16 v[120:123], a[112:115], v[104:107], v[120:123]
    s_waitcnt lgkmcnt(2)
    v_mfma_f32_16x16x32_bf16 v[108:111], a[36:39], v[84:87], v[108:111]
    ds_read_b128 v[100:103], v12 offset:20480
    v_mfma_f32_16x16x32_bf16 v[112:115], a[36:39], v[88:91], v[112:115]
    buffer_load_dword v147, v146, s[4:7], 0 offen sc1
    ds_read_b128 v[104:107], v12 offset:22528
    v_mfma_f32_16x16x32_bf16 v[116:119], a[116:119], v[84:87], v[116:119]
    buffer_load_dwordx4 v10, s[24:27], s46 offen offset:384 nt lds
    s_add_u32 m0, m0, 3968
    v_mfma_f32_16x16x32_bf16 v[120:123], a[116:119], v[88:91], v[120:123]
    s_waitcnt lgkmcnt(2)
    v_mfma_f32_16x16x32_bf16 v[108:111], a[40:43], v[92:95], v[108:111]
    ds_read_b128 v[84:87], v11 offset:24576
    v_mfma_f32_16x16x32_bf16 v[112:115], a[40:43], v[96:99], v[112:115]
    buffer_load_dword v147, v146, s[4:7], 0 offen sc1
    ds_read_b128 v[88:91], v11 offset:26624
    v_mfma_f32_16x16x32_bf16 v[116:119], a[120:123], v[92:95], v[116:119]
    buffer_load_dwordx4 v10, s[24:27], s46 offen offset:512 nt lds
    s_add_u32 m0, m0, 3968
    v_mfma_f32_16x16x32_bf16 v[120:123], a[120:123], v[96:99], v[120:123]
    s_waitcnt lgkmcnt(2)
    v_mfma_f32_16x16x32_bf16 v[108:111], a[44:47], v[100:103], v[108:111]
    ds_read_b128 v[92:95], v12 offset:24576
    v_mfma_f32_16x16x32_bf16 v[112:115], a[44:47], v[104:107], v[112:115]
    buffer_load_dword v147, v146, s[4:7], 0 offen sc1
    ds_read_b128 v[96:99], v12 offset:26624
    v_mfma_f32_16x16x32_bf16 v[116:119], a[124:127], v[100:103], v[116:119]
    buffer_load_dwordx4 v10, s[24:27], s46 offen offset:640 nt lds
    s_add_u32 m0, m0, 3968
    v_mfma_f32_16x16x32_bf16 v[120:123], a[124:127], v[104:107], v[120:123]
    s_waitcnt lgkmcnt(2)
    v_mfma_f32_16x16x32_bf16 v[108:111], a[48:51], v[84:87], v[108:111]
    ds_read_b128 v[100:103], v11 offset:28672
    v_mfma_f32_16x16x32_bf16 v[112:115], a[48:51], v[88:91], v[112:115]
    buffer_load_dword v147, v146, s[4:7], 0 offen sc1
    ds_read_b128 v[104:107], v11 offset:30720
    v_mfma_f32_16x16x32_bf16 v[116:119], a[128:131], v[84:87], v[116:119]
    buffer_load_dwordx4 v10, s[24:27], s46 offen offset:768 nt lds
    s_add_u32 m0, m0, 3968
    v_mfma_f32_16x16x32_bf16 v[120:123], a[128:131], v[88:91], v[120:123]
    s_waitcnt lgkmcnt(2)
    v_mfma_f32_16x16x32_bf16 v[108:111], a[52:55], v[92:95], v[108:111]
    ds_read_b128 v[84:87], v12 offset:28672
    v_mfma_f32_16x16x32_bf16 v[112:115], a[52:55], v[96:99], v[112:115]
    buffer_load_dword v147, v146, s[4:7], 0 offen sc1
    ds_read_b128 v[88:91], v12 offset:30720
    v_mfma_f32_16x16x32_bf16 v[116:119], a[132:135], v[92:95], v[116:119]
    buffer_load_dwordx4 v10, s[24:27], s46 offen offset:896 nt lds
    s_add_u32 m0, m0, 3968
    v_mfma_f32_16x16x32_bf16 v[120:123], a[132:135], v[96:99], v[120:123]
    s_waitcnt lgkmcnt(2)
    v_mfma_f32_16x16x32_bf16 v[108:111], a[56:59], v[100:103], v[108:111]
    ds_read_b128 v[92:95], v11 offset:32768
    v_mfma_f32_16x16x32_bf16 v[112:115], a[56:59], v[104:107], v[112:115]
    buffer_load_dword v147, v146, s[4:7], 0 offen sc1
    ds_read_b128 v[96:99], v11 offset:34816
    v_mfma_f32_16x16x32_bf16 v[116:119], a[136:139], v[100:103], v[116:119]
    buffer_load_dwordx4 v10, s[24:27], s46 offen offset:1024 nt lds
    s_add_u32 m0, m0, 3968
    v_mfma_f32_16x16x32_bf16 v[120:123], a[136:139], v[104:107], v[120:123]
    s_waitcnt lgkmcnt(2)
    v_mfma_f32_16x16x32_bf16 v[108:111], a[60:63], v[84:87], v[108:111]
    ds_read_b128 v[100:103], v12 offset:32768
    v_mfma_f32_16x16x32_bf16 v[112:115], a[60:63], v[88:91], v[112:115]
    buffer_load_dword v147, v146, s[4:7], 0 offen sc1
    ds_read_b128 v[104:107], v12 offset:34816
    v_mfma_f32_16x16x32_bf16 v[116:119], a[140:143], v[84:87], v[116:119]
    buffer_load_dwordx4 v10, s[24:27], s46 offen offset:1152 nt lds
    v_mfma_f32_16x16x32_bf16 v[120:123], a[140:143], v[88:91], v[120:123]
    s_waitcnt lgkmcnt(2)
    v_mfma_f32_16x16x32_bf16 v[108:111], a[64:67], v[92:95], v[108:111]
    ds_read_b128 v[84:87], v11 offset:36864
    v_mfma_f32_16x16x32_bf16 v[112:115], a[64:67], v[96:99], v[112:115]
L_sp_13:
    buffer_load_dword v147, v146, s[4:7], 0 offen sc1
    s_sub_u32 s36, s36, 1
    s_cbranch_scc1 L_exit
    s_waitcnt vmcnt(7)
    v_cmp_gt_u32 vcc, s54, v147
    s_cbranch_vccnz L_sp_13
    s_barrier
    buffer_load_dwordx4 v[168:171], v142, s[4:7], s53 offen sc1
    ds_read_b128 v[88:91], v11 offset:38912
    v_mfma_f32_16x16x32_bf16 v[116:119], a[144:147], v[92:95], v[116:119]
    v_mfma_f32_16x16x32_bf16 v[120:123], a[144:147], v[96:99], v[120:123]
    s_waitcnt lgkmcnt(2)
    v_mfma_f32_16x16x32_bf16 v[108:111], a[68:71], v[100:103], v[108:111]
    ds_read_b128 v[92:95], v12 offset:36864
    v_mfma_f32_16x16x32_bf16 v[112:115], a[68:71], v[104:107], v[112:115]
    ds_read_b128 v[96:99], v12 offset:38912
    v_mfma_f32_16x16x32_bf16 v[116:119], a[148:151], v[100:103], v[116:119]
    v_mfma_f32_16x16x32_bf16 v[120:123], a[148:151], v[104:107], v[120:123]
    buffer_load_dwordx4 v[172:175], v143, s[4:7], s53 offen sc1
    s_waitcnt lgkmcnt(0)
    v_mfma_f32_16x16x32_bf16 v[108:111], a[72:75], v[84:87], v[108:111]
    v_add_u32 v11, s49, v11
    v_mfma_f32_16x16x32_bf16 v[112:115], a[72:75], v[88:91], v[112:115]
    v_add_u32 v12, s49, v12
    v_mfma_f32_16x16x32_bf16 v[108:111], a[76:79], v[92:95], v[108:111]
    s_sub_u32 s47, s47, s49
    v_mfma_f32_16x16x32_bf16 v[112:115], a[76:79], v[96:99], v[112:115]
    s_sub_u32 s49, 0, s49
    v_mfma_f32_16x16x32_bf16 v[116:119], a[152:155], v[84:87], v[116:119]
    v_mfma_f32_16x16x32_bf16 v[120:123], a[152:155], v[88:91], v[120:123]
    v_mfma_f32_16x16x32_bf16 v[116:119], a[156:159], v[92:95], v[116:119]
    v_mfma_f32_16x16x32_bf16 v[120:123], a[156:159], v[96:99], v[120:123]
    v_cvt_pk_bf16_f32 v124, v108, v109
    v_cvt_pk_bf16_f32 v125, v110, v111
    v_cvt_pk_bf16_f32 v126, v112, v113
    v_cvt_pk_bf16_f32 v127, v114, v115
    s_nop 0
    v_permlane16_swap_b32 v124, v126
    v_permlane16_swap_b32 v125, v127
    v_cvt_pk_bf16_f32 v128, v116, v117
    v_cvt_pk_bf16_f32 v129, v118, v119
    v_cvt_pk_bf16_f32 v130, v120, v121
    v_cvt_pk_bf16_f32 v131, v122, v123
    s_nop 0
    v_permlane16_swap_b32 v128, v130
    v_permlane16_swap_b32 v129, v131
    ds_write_b128 v140, v[128:131]
    buffer_store_dwordx4 v[124:127], v19, s[4:7], s44 offen
    buffer_store_dwordx4 v[128:131], v19, s[4:7], s45 offen
    s_mov_b32 m0, s48
    s_waitcnt vmcnt(3)
    v_mfma_f32_16x16x32_bf16 v[184:187], v[168:171], v[196:199], 0
    s_waitcnt vmcnt(2)
    v_mfma_f32_16x16x32_bf16 v[184:187], v[172:175], v[196:199], v[184:187]
    s_nop 7
    v_pk_add_f32 v[188:189], v[184:185], v[186:187]
    v_cmp_u_f32 vcc, v188, v189
    v_cvt_pk_bf16_f32 v192, v184, v185
    v_cvt_pk_bf16_f32 v193, v186, v187
    v_cndmask_b32 v192, v192, v193, s[58:59]
    s_cbranch_vccnz L_pp_14
L_pc_15:
    buffer_store_dword v192, v149, s[4:7], s41 offen
    s_barrier
    s_branch L_qkv_loop_f
L_end_11:
    s_waitcnt vmcnt(0) lgkmcnt(0)
    buffer_store_dword v20, v139, s[4:7], s38 offen
    s_endpgm
L_nan_6:
    s_cmp_eq_u32 s52, 1
    s_cbranch_scc1 L_cont_7
    v_lshlrev_b32 v1, 4, v0
L_nan_6r:
    s_mov_b32 s90, s41
    v_mov_b32 v2, 0
    buffer_load_dwordx4 v[28:31], v1, s[4:7], s90 offen sc1
    s_add_u32 s90, s90, 1024
    buffer_load_dwordx4 v[32:35], v1, s[4:7], s90 offen sc1
    s_add_u32 s90, s90, 1024
    buffer_load_dwordx4 v[36:39], v1, s[4:7], s90 offen sc1
    s_add_u32 s90, s90, 1024
    buffer_load_dwordx4 v[40:43], v1, s[4:7], s90 offen sc1
    s_add_u32 s90, s90, 1024
    buffer_load_dwordx4 v[44:47], v1, s[4:7], s90 offen sc1
    s_add_u32 s90, s90, 1024
    buffer_load_dwordx4 v[48:51], v1, s[4:7], s90 offen sc1
    s_add_u32 s90, s90, 1024
    buffer_load_dwordx4 v[52:55], v1, s[4:7], s90 offen sc1
    s_add_u32 s90, s90, 1024
    buffer_load_dwordx4 v[56:59], v1, s[4:7], s90 offen sc1
    s_add_u32 s90, s90, 1024
    buffer_load_dwordx4 v[60:63], v1, s[4:7], s90 offen sc1
    s_add_u32 s90, s90, 1024
    buffer_load_dwordx4 v[64:67], v1, s[4:7], s90 offen sc1
    s_add_u32 s90, s90, 1024
    s_sub_u32 s36, s36, 1
    s_cbranch_scc1 L_exit
    s_waitcnt vmcnt(0) lgkmcnt(0)
    v_max3_u32 v2, v2, v28, v29
    v_max3_u32 v2, v2, v30, v31
    v_max3_u32 v2, v2, v32, v33
    v_max3_u32 v2, v2, v34, v35
    v_max3_u32 v2, v2, v36, v37
    v_max3_u32 v2, v2, v38, v39
    v_max3_u32 v2, v2, v40, v41
    v_max3_u32 v2, v2, v42, v43
    v_max3_u32 v2, v2, v44, v45
    v_max3_u32 v2, v2, v46, v47
    v_max3_u32 v2, v2, v48, v49
    v_max3_u32 v2, v2, v50, v51
    v_max3_u32 v2, v2, v52, v53
    v_max3_u32 v2, v2, v54, v55
    v_max3_u32 v2, v2, v56, v57
    v_max3_u32 v2, v2, v58, v59
    v_max3_u32 v2, v2, v60, v61
    v_max3_u32 v2, v2, v62, v63
    v_max3_u32 v2, v2, v64, v65
    v_max3_u32 v2, v2, v66, v67
    v_cmp_eq_u32 vcc, -1, v2
    s_cbranch_vccnz L_nan_6r
    s_mov_b32 s52, 1
    v_mov_b32 v68, 0
    v_mov_b32 v69, 0
    v_mov_b32 v70, 0
    v_mov_b32 v71, 0
    v_mov_b32 v72, 0
    v_mov_b32 v73, 0
    v_mov_b32 v74, 0
    v_mov_b32 v75, 0
    v_smfmac_f32_16x16x64_bf16 v[68:71], v[28:31], a[0:7], v17
    s_nop 0
    v_smfmac_f32_16x16x64_bf16 v[72:75], v[28:31], a[80:87], v17
    v_smfmac_f32_16x16x64_bf16 v[68:71], v[32:35], a[8:15], v17
    v_smfmac_f32_16x16x64_bf16 v[72:75], v[32:35], a[88:95], v17
    v_smfmac_f32_16x16x64_bf16 v[68:71], v[36:39], a[16:23], v17
    v_smfmac_f32_16x16x64_bf16 v[68:71], v[40:43], a[24:31], v17
    v_smfmac_f32_16x16x64_bf16 v[68:71], v[44:47], a[32:39], v17
    v_smfmac_f32_16x16x64_bf16 v[68:71], v[48:51], a[40:47], v17
    v_smfmac_f32_16x16x64_bf16 v[68:71], v[52:55], a[48:55], v17
    v_smfmac_f32_16x16x64_bf16 v[68:71], v[56:59], a[56:63], v17
    v_smfmac_f32_16x16x64_bf16 v[68:71], v[60:63], a[64:71], v17
    v_smfmac_f32_16x16x64_bf16 v[68:71], v[64:67], a[72:79], v17
    s_nop 2
    s_branch L_redo_4
L_poll_5c:
L_poll_5:
    buffer_load_dwordx4 v13, s[4:7], s41 offen sc1 lds
    buffer_load_dwordx4 v13, s[4:7], s41 offen offset:1024 sc1 lds
    buffer_load_dword v14, s[4:7], s41 offen offset:2048 sc1 lds
    buffer_load_dword v14, s[4:7], s41 offen offset:2304 sc1 lds
    s_sub_u32 s36, s36, 1
    s_cbranch_scc1 L_exit
    s_waitcnt vmcnt(0)
    ds_read_b32 v18, v15
    s_waitcnt lgkmcnt(0)
    v_cmp_eq_u32 vcc, -1, v18
    s_cbranch_vccnz L_poll_5
    s_branch L_poll_5x
L_sd_12c:
    v_mov_b32 v5, 460288
L_pf_16:
    buffer_load_dword v6, v5, s[4:7], s38 offen sc1
    v_mov_b32 v3, 200
L_p0_17:
    buffer_load_dword v4, v3, s[8:11], 0 offen sc1
    s_sub_u32 s36, s36, 1
    s_cbranch_scc1 L_exit
    s_waitcnt vmcnt(0)
    v_readfirstlane_b32 s90, v4
    s_nop 0
    s_cmp_eq_u32 s90, 0
    s_cbranch_scc1 L_p0_17
    s_and_b32 s90, s90, 2
    s_lshl_b32 s90, s90, 12
    v_readfirstlane_b32 s91, v6
    s_nop 0
    s_cmp_eq_u32 s91, 0
    s_cbranch_scc1 L_pf_16
    s_and_b32 s91, s91, 2
    s_lshl_b32 s91, s91, 12
    v_add_u32 v142, s91, v142
    v_add_u32 v143, s91, v143
    v_and_b32 v3, s90, v152
    v_xor_b32 v146, v3, v146
    s_branch L_sd_12
L_pp_14:
    buffer_load_dwordx4 v[176:179], v142, s[4:7], s53 offen sc1
    buffer_load_dwordx4 v[180:183], v143, s[4:7], s53 offen sc1
    s_sub_u32 s36, s36, 1
    s_cbranch_scc1 L_exit
    v_max_u32 v151, v168, v169
    v_max3_u32 v151, v151, v170, v171
    v_max3_u32 v151, v151, v172, v173
    v_max3_u32 v151, v151, v174, v175
    v_cmp_eq_u32 vcc, -1, v151
    s_cbranch_vccz L_pc_15
    s_waitcnt vmcnt(1)
    v_mfma_f32_16x16x32_bf16 v[184:187], v[176:179], v[196:199], 0
    s_waitcnt vmcnt(0)
    v_mfma_f32_16x16x32_bf16 v[184:187], v[180:183], v[196:199], v[184:187]
    s_nop 7
    v_pk_add_f32 v[188:189], v[184:185], v[186:187]
    v_cmp_u_f32 vcc, v188, v189
    v_cvt_pk_bf16_f32 v192, v184, v185
    v_cvt_pk_bf16_f32 v193, v186, v187
    v_cndmask_b32 v192, v192, v193, s[58:59]
    s_cbranch_vccnz L_pp_14_1
    s_branch L_pc_15
L_pp_14_1:
    buffer_load_dwordx4 v[168:171], v142, s[4:7], s53 offen sc1
    buffer_load_dwordx4 v[172:175], v143, s[4:7], s53 offen sc1
    s_sub_u32 s36, s36, 1
    s_cbranch_scc1 L_exit
    v_max_u32 v151, v176, v177
    v_max3_u32 v151, v151, v178, v179
    v_max3_u32 v151, v151, v180, v181
    v_max3_u32 v151, v151, v182, v183
    v_cmp_eq_u32 vcc, -1, v151
    s_cbranch_vccz L_pc_15
    s_waitcnt vmcnt(1)
    v_mfma_f32_16x16x32_bf16 v[184:187], v[168:171], v[196:199], 0
    s_waitcnt vmcnt(0)
    v_mfma_f32_16x16x32_bf16 v[184:187], v[172:175], v[196:199], v[184:187]
    s_nop 7
    v_pk_add_f32 v[188:189], v[184:185], v[186:187]
    v_cmp_u_f32 vcc, v188, v189
    v_cvt_pk_bf16_f32 v192, v184, v185
    v_cvt_pk_bf16_f32 v193, v186, v187
    v_cndmask_b32 v192, v192, v193, s[58:59]
    s_cbranch_vccnz L_pp_14
    s_branch L_pc_15
L_v_f:
    s_mov_b32 s12, s78
    s_and_b32 s13, s79, 0xffff
    s_mov_b32 s14, 7864320
    s_mov_b32 s15, 0x20000
    s_sub_u32 s40, s35, 12
    s_lshl_b32 s40, s40, 1
    s_mov_b32 s24, s70
    s_and_b32 s25, s71, 0xffff
    s_mov_b32 s26, 2621440
    s_mov_b32 s27, 0x20000
    v_and_b32 v1, 15, v0
    v_lshrrev_b32 v2, 4, v0
    v_lshrrev_b32 v3, 3, v0
    v_and_b32 v4, 7, v0
    s_lshl_b32 s90, s32, 3
    v_add_u32 v5, s90, v3
    s_and_b32 s91, s32, 1
    s_lshl_b32 s91, s91, 2
    v_and_b32 v6, 2, v3
    v_or_b32 v6, s91, v6
    v_xor_b32 v6, v6, v4
    v_lshlrev_b32 v6, 4, v6
    v_mul_u32_u24 v7, 12288, v5
    s_mul_i32 s92, s34, 1536
    s_lshl_b32 s93, s40, 7
    s_add_u32 s92, s92, s93
    v_add3_u32 v124, v6, v7, s92
    v_lshrrev_b32 v6, 1, v3
    v_or_b32 v6, s91, v6
    v_xor_b32 v6, v6, v4
    v_lshlrev_b32 v6, 4, v6
    v_mul_u32_u24 v7, 1280, v5
    v_add_u32 v10, v6, v7
    s_lshl_b32 s90, s32, 10
    s_add_u32 m0, s90, 81920
    s_mov_b32 s91, 128
    buffer_load_dwordx4 v124, s[12:15], s91 offen nt lds
    s_add_u32 m0, m0, 4096
    s_add_u32 s91, s91, 393216
    buffer_load_dwordx4 v124, s[12:15], s91 offen nt lds
    s_add_u32 m0, m0, 4096
    s_add_u32 s91, s91, 393216
    buffer_load_dwordx4 v124, s[12:15], s91 offen nt lds
    s_add_u32 m0, m0, 4096
    s_add_u32 s91, s91, 393216
    buffer_load_dwordx4 v124, s[12:15], s91 offen nt lds
    s_add_u32 m0, m0, 4096
    s_add_u32 s91, s91, 393216
    buffer_load_dwordx4 v124, s[12:15], s91 offen nt lds
    s_add_u32 m0, m0, 4096
    s_add_u32 s91, s91, 393216
    buffer_load_dwordx4 v124, s[12:15], s91 offen nt lds
    s_add_u32 m0, m0, 4096
    s_add_u32 s91, s91, 393216
    buffer_load_dwordx4 v124, s[12:15], s91 offen nt lds
    s_add_u32 m0, m0, 4096
    s_add_u32 s91, s91, 393216
    buffer_load_dwordx4 v124, s[12:15], s91 offen nt lds
    s_add_u32 m0, m0, 4096
    s_add_u32 s91, s91, 393216
    buffer_load_dwordx4 v124, s[12:15], s91 offen nt lds
    s_add_u32 m0, m0, 4096
    s_add_u32 s91, s91, 393216
    buffer_load_dwordx4 v124, s[12:15], s91 offen nt lds
    s_mul_i32 s60, s40, 86
    s_lshr_b32 s60, s60, 8
    s_mul_i32 s61, s60, 3
    s_sub_u32 s61, s40, s61
    s_add_u32 s90, s40, 1
    s_mul_i32 s62, s90, 86
    s_lshr_b32 s62, s62, 8
    s_mul_i32 s63, s62, 3
    s_sub_u32 s63, s90, s63
    v_lshrrev_b32 v3, 1, v2
    v_and_b32 v5, 1, v2
    s_lshl_b32 s90, s32, 9
    v_lshlrev_b32 v6, 4, v1
    v_lshl_add_u32 v6, v3, 8, v6
    v_add_u32 v6, s90, v6
    s_mul_i32 s90, s60, 12288
    s_lshl_b32 s91, s61, 11
    s_add_u32 s90, s90, s91
    v_mul_u32_u24 v7, 6144, v5
    v_add3_u32 v19, v6, v7, s90
    v_mov_b32 v22, -1
    s_mul_i32 s56, s62, 12288
    s_lshl_b32 s91, s63, 11
    s_add_u32 s56, s56, s91
    s_sub_u32 s56, s56, s90
    s_lshl_b32 s90, s40, 10
    s_lshl_b32 s91, s32, 8
    s_add_u32 s91, s91, s90
    s_add_u32 s91, s91, 25600
    v_lshl_add_u32 v135, v0, 2, s91
    v_and_b32 v6, 60, v0
    v_bfe_u32 v7, v0, 1, 1
    v_or_b32 v6, v6, v7
    v_and_b32 v7, 1, v0
    v_lshl_or_b32 v6, v7, 1, v6
    s_and_b32 s90, s32, 1
    s_lshl_b32 s90, s90, 3
    v_xor_b32 v6, s90, v6
    v_lshl_add_u32 v134, v6, 2, s91
    s_lshl_b32 s90, s60, 5
    s_lshl_b32 s91, s62, 5
    v_mov_b32 v3, s90
    v_mov_b32 v4, s91
    v_mov_b32 v6, s61
    v_mov_b32 v7, s63
    v_cmp_eq_u32 vcc, 0, v0
    s_nop 1
    v_cndmask_b32 v3, v4, v3, vcc
    v_cndmask_b32 v6, v7, v6, vcc
    v_add_u32 v4, v3, v6
    s_cmp_eq_u32 s32, 3
    s_cselect_b32 s91, 0, 2146435072
    s_add_u32 s91, s91, 462348
    v_lshl_add_u32 v21, v4, 2, s91
    v_lshl_add_u32 v4, v6, 2, v3
    s_lshl_b32 s91, s32, 2
    s_add_u32 s91, s91, 458752
    v_lshl_add_u32 v136, v4, 2, s91
    v_cmp_gt_u32 vcc, 2, v0
    v_mov_b32 v9, 2146435072
    s_nop 0
    v_cndmask_b32 v21, v9, v21, vcc
    v_cndmask_b32 v136, v9, v136, vcc
    s_lshl_b32 s90, s40, 1
    s_add_u32 s90, s90, s32
    s_sub_u32 s90, s90, 4
    s_lshl_b32 s90, s90, 11
    s_cmp_eq_u32 s40, 0
    s_cselect_b32 s90, 2146435072, s90
    v_lshl_add_u32 v137, v0, 4, s90
    v_mov_b32 v138, 460416
    v_lshrrev_b32 v3, 2, v1
    v_and_b32 v4, 3, v1
    v_and_b32 v5, 1, v2
    v_lshl_add_u32 v6, v2, 3, v3
    v_lshlrev_b32 v6, 7, v6
    v_and_b32 v7, 2, v3
    v_lshl_or_b32 v7, v5, 2, v7
    v_lshrrev_b32 v8, 1, v4
    s_lshl_b32 s90, s32, 1
    v_or_b32 v8, s90, v8
    v_xor_b32 v7, v7, v8
    v_lshl_add_u32 v6, v7, 4, v6
    v_and_b32 v7, 1, v4
    v_lshl_add_u32 v6, v7, 3, v6
    v_add_u32 v125, 81920, v6
    v_add_u32 v126, 40960, v6
    v_add_u32 v127, 122880, v6
    s_lshl_b32 s90, s32, 9
    s_add_u32 s90, s90, 133120
    v_and_b32 v7, 2, v1
    v_cmp_ne_u32 vcc, 0, v7
    v_mov_b32 v6, 0x4444
    v_mov_b32 v8, 0xeeee
    v_cndmask_b32 v17, v6, v8, vcc
    v_lshlrev_b32 v6, 4, v0
    v_add_u32 v16, 122880, v6
    s_mul_i32 s90, s32, 2560
    v_lshl_add_u32 v13, v0, 4, s90
    v_lshl_add_u32 v14, v0, 2, s90
    s_add_u32 s48, s90, 122880
    v_mul_u32_u24 v6, 40, v0
    v_add_u32 v15, s48, v6
    v_mul_u32_u24 v6, 164, v0
    v_min_u32 v6, 10236, v6
    v_add_u32 v25, 122880, v6
    v_lshrrev_b32 v6, 3, v1
    v_lshlrev_b32 v6, 10, v6
    v_and_b32 v7, 7, v1
    v_lshl_add_u32 v6, v7, 7, v6
    v_lshrrev_b32 v7, 1, v1
    v_xor_b32 v7, v7, v2
    v_lshl_add_u32 v11, v7, 4, v6
    v_xor_b32 v12, 64, v11
    v_and_b32 v3, 1, v0
    v_lshlrev_b32 v3, 12, v3
    v_bfe_u32 v5, v0, 2, 1
    v_lshl_add_u32 v3, v5, 13, v3
    v_bfe_u32 v4, v0, 1, 1
    v_lshl_add_u32 v3, v4, 14, v3
    s_lshl_b32 s91, s34, 9
    s_add_u32 s91, s91, 1933312
    s_xor_b32 s55, s32, 3
    s_or_b32 s55, s55, s40
    s_cselect_b32 s91, 2146435072, s91
    s_cselect_b32 s92, 2146435072, 0
    s_add_u32 s92, s92, 460416
    v_mov_b32 v147, s92
    v_add_u32 v140, s91, v3
    v_cmp_eq_u32 vcc, 0, v0
    v_mov_b32 v9, 2146435072
    s_nop 0
    v_cndmask_b32 v147, v9, v147, vcc
    v_cmp_gt_u32 vcc, 8, v0
    v_mov_b32 v9, 2146435072
    s_nop 0
    v_cndmask_b32 v140, v9, v140, vcc
    v_cmp_ne_u32 vcc, s34, v0
    v_mov_b32 v9, 2146435072
    s_nop 0
    v_cndmask_b32 v140, v9, v140, vcc
    s_lshr_b32 s91, s34, 2
    v_cmp_eq_u32 vcc, s91, v5
    s_nop 1
    v_cndmask_b32 v141, v9, v140, vcc
    v_cndmask_b32 v140, v140, v9, vcc
    v_and_b32 v3, 7, v0
    v_min_u32 v3, 5, v3
    v_bfe_u32 v4, v0, 3, 2
    v_lshlrev_b32 v4, 7, v4
    v_lshl_add_u32 v3, v3, 2, v4
    v_add_u32 v142, 462368, v3
    v_min_u32 v3, 39, v0
    v_lshlrev_b32 v3, 2, v3
    v_add_u32 v142, 460544, v3
    s_lshl_b32 s93, s40, 1
    s_add_u32 s93, s93, s32
    s_lshl_b32 s93, s93, 1
    s_sub_u32 s93, s93, 8
    s_nop 0
    s_lshr_b32 s90, s93, 2
    s_lshl_b32 s90, s90, 15
    s_and_b32 s92, s93, 3
    s_lshl_b32 s92, s92, 10
    s_add_u32 s90, s90, s92
    v_mov_b32 v5, s34
    v_and_b32 v6, 7, v1
    v_lshlrev_b32 v6, 4, v6
    v_lshl_add_u32 v6, v5, 7, v6
    v_lshrrev_b32 v7, 3, v1
    v_lshl_add_u32 v6, v7, 12, v6
    v_lshrrev_b32 v5, 1, v2
    v_lshl_add_u32 v6, v5, 13, v6
    v_and_b32 v5, 1, v2
    v_lshl_add_u32 v6, v5, 14, v6
    v_add_u32 v143, s90, v6
    s_and_b32 s91, s34, 1
    s_lshl_b32 s91, s91, 12
    s_add_u32 s90, s90, s91
    s_lshr_b32 s91, s34, 2
    s_lshl_b32 s91, s91, 13
    s_add_u32 s90, s90, s91
    s_and_b32 s91, s34, 2
    s_lshl_b32 s91, s91, 13
    s_add_u32 s90, s90, s91
    v_lshl_add_u32 v144, v0, 4, s90
    s_lshl_b32 s91, s93, 10
    s_add_u32 s91, s91, 884736
    v_lshl_add_u32 v146, v0, 4, s91
    s_lshr_b32 s91, s34, 1
    s_mul_i32 s91, s91, 10240
    s_lshl_b32 s92, s93, 5
    s_add_u32 s91, s91, s92
    s_and_b32 s92, s34, 1
    s_mul_i32 s92, s92, 40960
    s_add_u32 s91, s91, s92
    s_add_u32 s91, s91, 1280
    v_mul_u32_u24 v6, 2560, v2
    v_lshl_add_u32 v6, v1, 1, v6
    v_add_u32 v145, s91, v6
    v_cmp_gt_u32 s[58:59], 8, v1
    v_and_b32 v5, 1, v1
    v_lshrrev_b32 v6, 3, v1
    v_lshl_add_u32 v5, v5, 1, v6
    v_bfe_u32 v6, v1, 2, 1
    v_cmp_ne_u32 vcc, 0, v6
    v_mov_b32 v6, 0x3f80
    v_mov_b32 v7, 0x3f800000
    v_cndmask_b32 v6, v6, v7, vcc
    v_cmp_eq_u32 vcc, 0, v5
    s_nop 1
    v_cndmask_b32 v7, 0, v6, vcc
    v_accvgpr_write_b32 a160, v7
    v_cmp_eq_u32 vcc, 1, v5
    s_nop 1
    v_cndmask_b32 v7, 0, v6, vcc
    v_accvgpr_write_b32 a161, v7
    v_cmp_eq_u32 vcc, 2, v5
    s_nop 1
    v_cndmask_b32 v7, 0, v6, vcc
    v_accvgpr_write_b32 a162, v7
    v_cmp_eq_u32 vcc, 3, v5
    s_nop 1
    v_cndmask_b32 v7, 0, v6, vcc
    v_accvgpr_write_b32 a163, v7
    s_cmp_lg_u32 s40, 0
    s_cselect_b64 vcc, -1, 0
    v_cndmask_b32 v143, v9, v143, vcc
    v_cndmask_b32 v144, v9, v144, vcc
    v_cndmask_b32 v145, v9, v145, vcc
    v_cndmask_b32 v146, v9, v146, vcc
    s_lshl_b32 s90, s32, 10
    s_add_u32 m0, s90, 40960
    s_mov_b32 s91, 0
    buffer_load_dwordx4 v124, s[12:15], s91 offen nt lds
    s_add_u32 m0, m0, 4096
    s_add_u32 s91, s91, 393216
    buffer_load_dwordx4 v124, s[12:15], s91 offen nt lds
    s_add_u32 m0, m0, 4096
    s_add_u32 s91, s91, 393216
    buffer_load_dwordx4 v124, s[12:15], s91 offen nt lds
    s_add_u32 m0, m0, 4096
    s_add_u32 s91, s91, 393216
    buffer_load_dwordx4 v124, s[12:15], s91 offen nt lds
    s_add_u32 m0, m0, 4096
    s_add_u32 s91, s91, 393216
    buffer_load_dwordx4 v124, s[12:15], s91 offen nt lds
    s_add_u32 m0, m0, 4096
    s_add_u32 s91, s91, 393216
    buffer_load_dwordx4 v124, s[12:15], s91 offen nt lds
    s_add_u32 m0, m0, 4096
    s_add_u32 s91, s91, 393216
    buffer_load_dwordx4 v124, s[12:15], s91 offen nt lds
    s_add_u32 m0, m0, 4096
    s_add_u32 s91, s91, 393216
    buffer_load_dwordx4 v124, s[12:15], s91 offen nt lds
    s_add_u32 m0, m0, 4096
    s_add_u32 s91, s91, 393216
    buffer_load_dwordx4 v124, s[12:15], s91 offen nt lds
    s_add_u32 m0, m0, 4096
    s_add_u32 s91, s91, 393216
    buffer_load_dwordx4 v124, s[12:15], s91 offen nt lds
    s_lshl_b32 s90, s32, 10
    s_add_u32 m0, s90, 122880
    s_mov_b32 s91, 3932288
    buffer_load_dwordx4 v124, s[12:15], s91 offen nt lds
    s_add_u32 m0, m0, 4096
    s_add_u32 s91, s91, 393216
    buffer_load_dwordx4 v124, s[12:15], s91 offen nt lds
    s_add_u32 m0, m0, 4096
    s_add_u32 s91, s91, 393216
    buffer_load_dwordx4 v124, s[12:15], s91 offen nt lds
    s_add_u32 m0, m0, 4096
    s_add_u32 s91, s91, 393216
    buffer_load_dwordx4 v124, s[12:15], s91 offen nt lds
    s_add_u32 m0, m0, 4096
    s_add_u32 s91, s91, 393216
    buffer_load_dwordx4 v124, s[12:15], s91 offen nt lds
    s_add_u32 m0, m0, 4096
    s_add_u32 s91, s91, 393216
    buffer_load_dwordx4 v124, s[12:15], s91 offen nt lds
    s_add_u32 m0, m0, 4096
    s_add_u32 s91, s91, 393216
    buffer_load_dwordx4 v124, s[12:15], s91 offen nt lds
    s_add_u32 m0, m0, 4096
    s_add_u32 s91, s91, 393216
    buffer_load_dwordx4 v124, s[12:15], s91 offen nt lds
    s_add_u32 m0, m0, 4096
    s_add_u32 s91, s91, 393216
    buffer_load_dwordx4 v124, s[12:15], s91 offen nt lds
    s_add_u32 m0, m0, 4096
    s_add_u32 s91, s91, 393216
    buffer_load_dwordx4 v124, s[12:15], s91 offen nt lds
    s_mov_b32 s46, 0
    s_lshl_b32 s90, s32, 10
    s_add_u32 m0, s90, 0
    s_nop 0
    buffer_load_dwordx4 v10, s[24:27], s46 offen offset:0 lds
    s_add_u32 m0, m0, 3968
    s_nop 0
    buffer_load_dwordx4 v10, s[24:27], s46 offen offset:128 lds
    s_add_u32 m0, m0, 3968
    s_nop 0
    buffer_load_dwordx4 v10, s[24:27], s46 offen offset:256 lds
    s_add_u32 m0, m0, 3968
    s_nop 0
    buffer_load_dwordx4 v10, s[24:27], s46 offen offset:384 lds
    s_add_u32 m0, m0, 3968
    s_nop 0
    buffer_load_dwordx4 v10, s[24:27], s46 offen offset:512 lds
    s_add_u32 m0, m0, 3968
    s_nop 0
    buffer_load_dwordx4 v10, s[24:27], s46 offen offset:640 lds
    s_add_u32 m0, m0, 3968
    s_nop 0
    buffer_load_dwordx4 v10, s[24:27], s46 offen offset:768 lds
    s_add_u32 m0, m0, 3968
    s_nop 0
    buffer_load_dwordx4 v10, s[24:27], s46 offen offset:896 lds
    s_add_u32 m0, m0, 3968
    s_nop 0
    buffer_load_dwordx4 v10, s[24:27], s46 offen offset:1024 lds
    s_add_u32 m0, m0, 3968
    s_nop 0
    buffer_load_dwordx4 v10, s[24:27], s46 offen offset:1152 lds
    s_waitcnt vmcnt(30)
    s_barrier
    ds_read_b64_tr_b16 a[80:81], v125 offset:0
    ds_read_b64_tr_b16 a[82:83], v125 offset:512
    ds_read_b64_tr_b16 a[84:85], v125 offset:4096
    ds_read_b64_tr_b16 a[86:87], v125 offset:4608
    ds_read_b64_tr_b16 a[88:89], v125 offset:8192
    ds_read_b64_tr_b16 a[90:91], v125 offset:8704
    ds_read_b64_tr_b16 a[92:93], v125 offset:12288
    ds_read_b64_tr_b16 a[94:95], v125 offset:12800
    ds_read_b64_tr_b16 a[96:97], v125 offset:16384
    ds_read_b64_tr_b16 a[98:99], v125 offset:16896
    ds_read_b64_tr_b16 a[100:101], v125 offset:20480
    ds_read_b64_tr_b16 a[102:103], v125 offset:20992
    ds_read_b64_tr_b16 a[104:105], v125 offset:24576
    ds_read_b64_tr_b16 a[106:107], v125 offset:25088
    ds_read_b64_tr_b16 a[108:109], v125 offset:28672
    ds_read_b64_tr_b16 a[110:111], v125 offset:29184
    ds_read_b64_tr_b16 a[112:113], v125 offset:32768
    ds_read_b64_tr_b16 a[114:115], v125 offset:33280
    ds_read_b64_tr_b16 a[116:117], v125 offset:36864
    ds_read_b64_tr_b16 a[118:119], v125 offset:37376
    s_waitcnt lgkmcnt(0)
    s_barrier
    s_lshl_b32 s90, s32, 10
    s_add_u32 m0, s90, 81920
    s_mov_b32 s91, 3932160
    buffer_load_dwordx4 v124, s[12:15], s91 offen nt lds
    s_add_u32 m0, m0, 4096
    s_add_u32 s91, s91, 393216
    buffer_load_dwordx4 v124, s[12:15], s91 offen nt lds
    s_add_u32 m0, m0, 4096
    s_add_u32 s91, s91, 393216
    buffer_load_dwordx4 v124, s[12:15], s91 offen nt lds
    s_add_u32 m0, m0, 4096
    s_add_u32 s91, s91, 393216
    buffer_load_dwordx4 v124, s[12:15], s91 offen nt lds
    s_add_u32 m0, m0, 4096
    s_add_u32 s91, s91, 393216
    buffer_load_dwordx4 v124, s[12:15], s91 offen nt lds
    s_add_u32 m0, m0, 4096
    s_add_u32 s91, s91, 393216
    buffer_load_dwordx4 v124, s[12:15], s91 offen nt lds
    s_add_u32 m0, m0, 4096
    s_add_u32 s91, s91, 393216
    buffer_load_dwordx4 v124, s[12:15], s91 offen nt lds
    s_add_u32 m0, m0, 4096
    s_add_u32 s91, s91, 393216
    buffer_load_dwordx4 v124, s[12:15], s91 offen nt lds
    s_add_u32 m0, m0, 4096
    s_add_u32 s91, s91, 393216
    buffer_load_dwordx4 v124, s[12:15], s91 offen nt lds
    s_add_u32 m0, m0, 4096
    s_add_u32 s91, s91, 393216
    buffer_load_dwordx4 v124, s[12:15], s91 offen nt lds
    s_waitcnt vmcnt(30)
    s_barrier
    ds_read_b64_tr_b16 a[0:1], v126 offset:0
    ds_read_b64_tr_b16 a[2:3], v126 offset:512
    ds_read_b64_tr_b16 a[4:5], v126 offset:4096
    ds_read_b64_tr_b16 a[6:7], v126 offset:4608
    ds_read_b64_tr_b16 a[8:9], v126 offset:8192
    ds_read_b64_tr_b16 a[10:11], v126 offset:8704
    ds_read_b64_tr_b16 a[12:13], v126 offset:12288
    ds_read_b64_tr_b16 a[14:15], v126 offset:12800
    ds_read_b64_tr_b16 a[16:17], v126 offset:16384
    ds_read_b64_tr_b16 a[18:19], v126 offset:16896
    ds_read_b64_tr_b16 a[20:21], v126 offset:20480
    ds_read_b64_tr_b16 a[22:23], v126 offset:20992
    ds_read_b64_tr_b16 a[24:25], v126 offset:24576
    ds_read_b64_tr_b16 a[26:27], v126 offset:25088
    ds_read_b64_tr_b16 a[28:29], v126 offset:28672
    ds_read_b64_tr_b16 a[30:31], v126 offset:29184
    ds_read_b64_tr_b16 a[32:33], v126 offset:32768
    ds_read_b64_tr_b16 a[34:35], v126 offset:33280
    ds_read_b64_tr_b16 a[36:37], v126 offset:36864
    ds_read_b64_tr_b16 a[38:39], v126 offset:37376
    s_waitcnt lgkmcnt(0)
    s_barrier
    s_mov_b32 s46, 40960
    s_lshl_b32 s90, s32, 10
    s_add_u32 m0, s90, 40960
    s_nop 0
    buffer_load_dwordx4 v10, s[24:27], s46 offen offset:0 lds
    s_add_u32 m0, m0, 3968
    s_nop 0
    buffer_load_dwordx4 v10, s[24:27], s46 offen offset:128 lds
    s_add_u32 m0, m0, 3968
    s_nop 0
    buffer_load_dwordx4 v10, s[24:27], s46 offen offset:256 lds
    s_add_u32 m0, m0, 3968
    s_nop 0
    buffer_load_dwordx4 v10, s[24:27], s46 offen offset:384 lds
    s_add_u32 m0, m0, 3968
    s_nop 0
    buffer_load_dwordx4 v10, s[24:27], s46 offen offset:512 lds
    s_add_u32 m0, m0, 3968
    s_nop 0
    buffer_load_dwordx4 v10, s[24:27], s46 offen offset:640 lds
    s_add_u32 m0, m0, 3968
    s_nop 0
    buffer_load_dwordx4 v10, s[24:27], s46 offen offset:768 lds
    s_add_u32 m0, m0, 3968
    s_nop 0
    buffer_load_dwordx4 v10, s[24:27], s46 offen offset:896 lds
    s_add_u32 m0, m0, 3968
    s_nop 0
    buffer_load_dwordx4 v10, s[24:27], s46 offen offset:1024 lds
    s_add_u32 m0, m0, 3968
    s_nop 0
    buffer_load_dwordx4 v10, s[24:27], s46 offen offset:1152 lds
    s_waitcnt vmcnt(30)
    s_barrier
    ds_read_b64_tr_b16 a[120:121], v127 offset:0
    ds_read_b64_tr_b16 a[122:123], v127 offset:512
    ds_read_b64_tr_b16 a[124:125], v127 offset:4096
    ds_read_b64_tr_b16 a[126:127], v127 offset:4608
    ds_read_b64_tr_b16 a[128:129], v127 offset:8192
    ds_read_b64_tr_b16 a[130:131], v127 offset:8704
    ds_read_b64_tr_b16 a[132:133], v127 offset:12288
    ds_read_b64_tr_b16 a[134:135], v127 offset:12800
    ds_read_b64_tr_b16 a[136:137], v127 offset:16384
    ds_read_b64_tr_b16 a[138:139], v127 offset:16896
    ds_read_b64_tr_b16 a[140:141], v127 offset:20480
    ds_read_b64_tr_b16 a[142:143], v127 offset:20992
    ds_read_b64_tr_b16 a[144:145], v127 offset:24576
    ds_read_b64_tr_b16 a[146:147], v127 offset:25088
    ds_read_b64_tr_b16 a[148:149], v127 offset:28672
    ds_read_b64_tr_b16 a[150:151], v127 offset:29184
    ds_read_b64_tr_b16 a[152:153], v127 offset:32768
    ds_read_b64_tr_b16 a[154:155], v127 offset:33280
    ds_read_b64_tr_b16 a[156:157], v127 offset:36864
    ds_read_b64_tr_b16 a[158:159], v127 offset:37376
    s_waitcnt lgkmcnt(0)
    s_waitcnt vmcnt(10)
    s_barrier
    ds_read_b64_tr_b16 a[40:41], v125 offset:0
    ds_read_b64_tr_b16 a[42:43], v125 offset:512
    ds_read_b64_tr_b16 a[44:45], v125 offset:4096
    ds_read_b64_tr_b16 a[46:47], v125 offset:4608
    ds_read_b64_tr_b16 a[48:49], v125 offset:8192
    ds_read_b64_tr_b16 a[50:51], v125 offset:8704
    ds_read_b64_tr_b16 a[52:53], v125 offset:12288
    ds_read_b64_tr_b16 a[54:55], v125 offset:12800
    ds_read_b64_tr_b16 a[56:57], v125 offset:16384
    ds_read_b64_tr_b16 a[58:59], v125 offset:16896
    ds_read_b64_tr_b16 a[60:61], v125 offset:20480
    ds_read_b64_tr_b16 a[62:63], v125 offset:20992
    ds_read_b64_tr_b16 a[64:65], v125 offset:24576
    ds_read_b64_tr_b16 a[66:67], v125 offset:25088
    ds_read_b64_tr_b16 a[68:69], v125 offset:28672
    ds_read_b64_tr_b16 a[70:71], v125 offset:29184
    ds_read_b64_tr_b16 a[72:73], v125 offset:32768
    ds_read_b64_tr_b16 a[74:75], v125 offset:33280
    ds_read_b64_tr_b16 a[76:77], v125 offset:36864
    ds_read_b64_tr_b16 a[78:79], v125 offset:37376
    s_waitcnt lgkmcnt(0)
    s_mov_b32 s49, 40960
    s_mov_b32 s47, 40960
    s_mov_b32 s37, -1
    s_add_u32 s44, s38, 65536
    s_add_u32 s45, s44, s56
    s_mov_b32 s46, 40960
    v_mov_b32 v1, 192
    buffer_load_dword v2, v1, s[8:11], 0 offen sc1
    ds_read_b128 v[84:87], v11 offset:0
    ds_read_b128 v[88:91], v11 offset:2048
    ds_read_b128 v[92:95], v12 offset:0
    ds_read_b128 v[96:99], v12 offset:2048
    s_waitcnt lgkmcnt(2)
    v_mfma_f32_16x16x32_bf16 v[108:111], a[0:3], v[84:87], 0
    ds_read_b128 v[100:103], v11 offset:4096
    v_mfma_f32_16x16x32_bf16 v[112:115], a[0:3], v[88:91], 0
    ds_read_b128 v[104:107], v11 offset:6144
    v_mfma_f32_16x16x32_bf16 v[116:119], a[80:83], v[84:87], 0
    v_mfma_f32_16x16x32_bf16 v[120:123], a[80:83], v[88:91], 0
    s_waitcnt lgkmcnt(2)
    v_mfma_f32_16x16x32_bf16 v[108:111], a[4:7], v[92:95], v[108:111]
    ds_read_b128 v[84:87], v12 offset:4096
    v_mfma_f32_16x16x32_bf16 v[112:115], a[4:7], v[96:99], v[112:115]
    ds_read_b128 v[88:91], v12 offset:6144
    v_mfma_f32_16x16x32_bf16 v[116:119], a[84:87], v[92:95], v[116:119]
    v_mfma_f32_16x16x32_bf16 v[120:123], a[84:87], v[96:99], v[120:123]
    s_waitcnt lgkmcnt(2)
    v_mfma_f32_16x16x32_bf16 v[108:111], a[8:11], v[100:103], v[108:111]
    ds_read_b128 v[92:95], v11 offset:8192
    v_mfma_f32_16x16x32_bf16 v[112:115], a[8:11], v[104:107], v[112:115]
    ds_read_b128 v[96:99], v11 offset:10240
    v_mfma_f32_16x16x32_bf16 v[116:119], a[88:91], v[100:103], v[116:119]
    v_mfma_f32_16x16x32_bf16 v[120:123], a[88:91], v[104:107], v[120:123]
    s_waitcnt lgkmcnt(2)
    v_mfma_f32_16x16x32_bf16 v[108:111], a[12:15], v[84:87], v[108:111]
    ds_read_b128 v[100:103], v12 offset:8192
    v_mfma_f32_16x16x32_bf16 v[112:115], a[12:15], v[88:91], v[112:115]
    ds_read_b128 v[104:107], v12 offset:10240
    v_mfma_f32_16x16x32_bf16 v[116:119], a[92:95], v[84:87], v[116:119]
    v_mfma_f32_16x16x32_bf16 v[120:123], a[92:95], v[88:91], v[120:123]
    s_waitcnt lgkmcnt(2)
    v_mfma_f32_16x16x32_bf16 v[108:111], a[16:19], v[92:95], v[108:111]
    ds_read_b128 v[84:87], v11 offset:12288
    v_mfma_f32_16x16x32_bf16 v[112:115], a[16:19], v[96:99], v[112:115]
    ds_read_b128 v[88:91], v11 offset:14336
    v_mfma_f32_16x16x32_bf16 v[116:119], a[96:99], v[92:95], v[116:119]
    v_mfma_f32_16x16x32_bf16 v[120:123], a[96:99], v[96:99], v[120:123]
    s_waitcnt lgkmcnt(2)
    v_mfma_f32_16x16x32_bf16 v[108:111], a[20:23], v[100:103], v[108:111]
    ds_read_b128 v[92:95], v12 offset:12288
    v_mfma_f32_16x16x32_bf16 v[112:115], a[20:23], v[104:107], v[112:115]
    ds_read_b128 v[96:99], v12 offset:14336
    v_mfma_f32_16x16x32_bf16 v[116:119], a[100:103], v[100:103], v[116:119]
    v_mfma_f32_16x16x32_bf16 v[120:123], a[100:103], v[104:107], v[120:123]
    s_waitcnt lgkmcnt(2)
    v_mfma_f32_16x16x32_bf16 v[108:111], a[24:27], v[84:87], v[108:111]
    ds_read_b128 v[100:103], v11 offset:16384
    v_mfma_f32_16x16x32_bf16 v[112:115], a[24:27], v[88:91], v[112:115]
    ds_read_b128 v[104:107], v11 offset:18432
    v_mfma_f32_16x16x32_bf16 v[116:119], a[104:107], v[84:87], v[116:119]
    v_mfma_f32_16x16x32_bf16 v[120:123], a[104:107], v[88:91], v[120:123]
    s_waitcnt lgkmcnt(2)
    v_mfma_f32_16x16x32_bf16 v[108:111], a[28:31], v[92:95], v[108:111]
    ds_read_b128 v[84:87], v12 offset:16384
    v_mfma_f32_16x16x32_bf16 v[112:115], a[28:31], v[96:99], v[112:115]
    ds_read_b128 v[88:91], v12 offset:18432
    v_mfma_f32_16x16x32_bf16 v[116:119], a[108:111], v[92:95], v[116:119]
    v_mfma_f32_16x16x32_bf16 v[120:123], a[108:111], v[96:99], v[120:123]
    s_waitcnt lgkmcnt(2)
    v_mfma_f32_16x16x32_bf16 v[108:111], a[32:35], v[100:103], v[108:111]
    ds_read_b128 v[92:95], v11 offset:20480
    v_mfma_f32_16x16x32_bf16 v[112:115], a[32:35], v[104:107], v[112:115]
    ds_read_b128 v[96:99], v11 offset:22528
    v_mfma_f32_16x16x32_bf16 v[116:119], a[112:115], v[100:103], v[116:119]
    v_mfma_f32_16x16x32_bf16 v[120:123], a[112:115], v[104:107], v[120:123]
    s_waitcnt lgkmcnt(2)
    v_mfma_f32_16x16x32_bf16 v[108:111], a[36:39], v[84:87], v[108:111]
    ds_read_b128 v[100:103], v12 offset:20480
    v_mfma_f32_16x16x32_bf16 v[112:115], a[36:39], v[88:91], v[112:115]
    ds_read_b128 v[104:107], v12 offset:22528
    v_mfma_f32_16x16x32_bf16 v[116:119], a[116:119], v[84:87], v[116:119]
    v_mfma_f32_16x16x32_bf16 v[120:123], a[116:119], v[88:91], v[120:123]
    s_waitcnt lgkmcnt(2)
    v_mfma_f32_16x16x32_bf16 v[108:111], a[40:43], v[92:95], v[108:111]
    ds_read_b128 v[84:87], v11 offset:24576
    v_mfma_f32_16x16x32_bf16 v[112:115], a[40:43], v[96:99], v[112:115]
    ds_read_b128 v[88:91], v11 offset:26624
    v_mfma_f32_16x16x32_bf16 v[116:119], a[120:123], v[92:95], v[116:119]
    v_mfma_f32_16x16x32_bf16 v[120:123], a[120:123], v[96:99], v[120:123]
    s_waitcnt lgkmcnt(2)
    v_mfma_f32_16x16x32_bf16 v[108:111], a[44:47], v[100:103], v[108:111]
    ds_read_b128 v[92:95], v12 offset:24576
    v_mfma_f32_16x16x32_bf16 v[112:115], a[44:47], v[104:107], v[112:115]
    ds_read_b128 v[96:99], v12 offset:26624
    v_mfma_f32_16x16x32_bf16 v[116:119], a[124:127], v[100:103], v[116:119]
    v_mfma_f32_16x16x32_bf16 v[120:123], a[124:127], v[104:107], v[120:123]
    s_waitcnt lgkmcnt(2)
    v_mfma_f32_16x16x32_bf16 v[108:111], a[48:51], v[84:87], v[108:111]
    ds_read_b128 v[100:103], v11 offset:28672
    v_mfma_f32_16x16x32_bf16 v[112:115], a[48:51], v[88:91], v[112:115]
    ds_read_b128 v[104:107], v11 offset:30720
    v_mfma_f32_16x16x32_bf16 v[116:119], a[128:131], v[84:87], v[116:119]
    v_mfma_f32_16x16x32_bf16 v[120:123], a[128:131], v[88:91], v[120:123]
    s_waitcnt lgkmcnt(2)
    v_mfma_f32_16x16x32_bf16 v[108:111], a[52:55], v[92:95], v[108:111]
    ds_read_b128 v[84:87], v12 offset:28672
    v_mfma_f32_16x16x32_bf16 v[112:115], a[52:55], v[96:99], v[112:115]
    ds_read_b128 v[88:91], v12 offset:30720
    v_mfma_f32_16x16x32_bf16 v[116:119], a[132:135], v[92:95], v[116:119]
    v_mfma_f32_16x16x32_bf16 v[120:123], a[132:135], v[96:99], v[120:123]
    s_waitcnt lgkmcnt(2)
    v_mfma_f32_16x16x32_bf16 v[108:111], a[56:59], v[100:103], v[108:111]
    ds_read_b128 v[92:95], v11 offset:32768
    v_mfma_f32_16x16x32_bf16 v[112:115], a[56:59], v[104:107], v[112:115]
    ds_read_b128 v[96:99], v11 offset:34816
    v_mfma_f32_16x16x32_bf16 v[116:119], a[136:139], v[100:103], v[116:119]
    v_mfma_f32_16x16x32_bf16 v[120:123], a[136:139], v[104:107], v[120:123]
    s_waitcnt lgkmcnt(2)
    v_mfma_f32_16x16x32_bf16 v[108:111], a[60:63], v[84:87], v[108:111]
    ds_read_b128 v[100:103], v12 offset:32768
    v_mfma_f32_16x16x32_bf16 v[112:115], a[60:63], v[88:91], v[112:115]
    ds_read_b128 v[104:107], v12 offset:34816
    v_mfma_f32_16x16x32_bf16 v[116:119], a[140:143], v[84:87], v[116:119]
    v_mfma_f32_16x16x32_bf16 v[120:123], a[140:143], v[88:91], v[120:123]
    s_waitcnt lgkmcnt(2)
    v_mfma_f32_16x16x32_bf16 v[108:111], a[64:67], v[92:95], v[108:111]
    ds_read_b128 v[84:87], v11 offset:36864
    v_mfma_f32_16x16x32_bf16 v[112:115], a[64:67], v[96:99], v[112:115]
    ds_read_b128 v[88:91], v11 offset:38912
    v_mfma_f32_16x16x32_bf16 v[116:119], a[144:147], v[92:95], v[116:119]
    v_mfma_f32_16x16x32_bf16 v[120:123], a[144:147], v[96:99], v[120:123]
    s_waitcnt lgkmcnt(2)
    v_mfma_f32_16x16x32_bf16 v[108:111], a[68:71], v[100:103], v[108:111]
    ds_read_b128 v[92:95], v12 offset:36864
    v_mfma_f32_16x16x32_bf16 v[112:115], a[68:71], v[104:107], v[112:115]
    ds_read_b128 v[96:99], v12 offset:38912
    v_mfma_f32_16x16x32_bf16 v[116:119], a[148:151], v[100:103], v[116:119]
    v_mfma_f32_16x16x32_bf16 v[120:123], a[148:151], v[104:107], v[120:123]
    s_waitcnt lgkmcnt(0)
    v_mfma_f32_16x16x32_bf16 v[108:111], a[72:75], v[84:87], v[108:111]
    v_add_u32 v11, s49, v11
    v_mfma_f32_16x16x32_bf16 v[112:115], a[72:75], v[88:91], v[112:115]
    v_add_u32 v12, s49, v12
    v_mfma_f32_16x16x32_bf16 v[108:111], a[76:79], v[92:95], v[108:111]
    s_sub_u32 s47, s47, s49
    v_mfma_f32_16x16x32_bf16 v[112:115], a[76:79], v[96:99], v[112:115]
    s_sub_u32 s49, 0, s49
    v_mfma_f32_16x16x32_bf16 v[116:119], a[152:155], v[84:87], v[116:119]
    v_mfma_f32_16x16x32_bf16 v[120:123], a[152:155], v[88:91], v[120:123]
    v_mfma_f32_16x16x32_bf16 v[116:119], a[156:159], v[92:95], v[116:119]
    v_mfma_f32_16x16x32_bf16 v[120:123], a[156:159], v[96:99], v[120:123]
    v_cvt_pk_bf16_f32 v124, v108, v109
    v_cvt_pk_bf16_f32 v125, v110, v111
    v_cvt_pk_bf16_f32 v126, v112, v113
    v_cvt_pk_bf16_f32 v127, v114, v115
    s_nop 0
    v_permlane16_swap_b32 v124, v126
    v_permlane16_swap_b32 v125, v127
    v_cvt_pk_bf16_f32 v128, v116, v117
    v_cvt_pk_bf16_f32 v129, v118, v119
    v_cvt_pk_bf16_f32 v130, v120, v121
    v_cvt_pk_bf16_f32 v131, v122, v123
    s_nop 0
    v_permlane16_swap_b32 v128, v130
    v_permlane16_swap_b32 v129, v131
    buffer_store_dwordx4 v[124:127], v19, s[4:7], s44 offen
    buffer_store_dwordx4 v[128:131], v19, s[4:7], s45 offen
    s_waitcnt vmcnt(2)
    s_branch L_gw_18c
L_gw_18:
    buffer_load_dword v2, v1, s[8:11], 0 offen sc1
    s_sub_u32 s36, s36, 1
    s_cbranch_scc1 L_exit
    s_waitcnt vmcnt(0)
L_gw_18c:
    v_readfirstlane_b32 s90, v2
    s_nop 0
    s_cmp_eq_u32 s90, 0
    s_cbranch_scc1 L_gw_18
    s_cmp_lg_u32 s90, 1
    s_cbranch_scc1 L_slow
    s_waitcnt vmcnt(2) lgkmcnt(0)
    s_barrier
    s_add_u32 s44, s38, 180224
    s_add_u32 s45, s44, s56
    s_mov_b32 s46, 81920
    v_mov_b32 v20, 1
    ds_read_b128 v[84:87], v11 offset:0
    ds_read_b128 v[88:91], v11 offset:2048
    ds_read_b128 v[92:95], v12 offset:0
    ds_read_b128 v[96:99], v12 offset:2048
    s_lshl_b32 s90, s32, 10
    s_add_u32 m0, s90, s47
    s_waitcnt lgkmcnt(2)
    v_mfma_f32_16x16x32_bf16 v[108:111], a[0:3], v[84:87], 0
    ds_read_b128 v[100:103], v11 offset:4096
    v_mfma_f32_16x16x32_bf16 v[112:115], a[0:3], v[88:91], 0
    ds_read_b128 v[104:107], v11 offset:6144
    v_mfma_f32_16x16x32_bf16 v[116:119], a[80:83], v[84:87], 0
    buffer_load_dwordx4 v10, s[24:27], s46 offen offset:0 lds
    s_add_u32 m0, m0, 3968
    v_mfma_f32_16x16x32_bf16 v[120:123], a[80:83], v[88:91], 0
    s_waitcnt lgkmcnt(2)
    v_mfma_f32_16x16x32_bf16 v[108:111], a[4:7], v[92:95], v[108:111]
    ds_read_b128 v[84:87], v12 offset:4096
    v_mfma_f32_16x16x32_bf16 v[112:115], a[4:7], v[96:99], v[112:115]
    ds_read_b128 v[88:91], v12 offset:6144
    v_mfma_f32_16x16x32_bf16 v[116:119], a[84:87], v[92:95], v[116:119]
    buffer_load_dwordx4 v10, s[24:27], s46 offen offset:128 lds
    s_add_u32 m0, m0, 3968
    v_mfma_f32_16x16x32_bf16 v[120:123], a[84:87], v[96:99], v[120:123]
    s_waitcnt lgkmcnt(2)
    v_mfma_f32_16x16x32_bf16 v[108:111], a[8:11], v[100:103], v[108:111]
    ds_read_b128 v[92:95], v11 offset:8192
    v_mfma_f32_16x16x32_bf16 v[112:115], a[8:11], v[104:107], v[112:115]
    ds_read_b128 v[96:99], v11 offset:10240
    v_mfma_f32_16x16x32_bf16 v[116:119], a[88:91], v[100:103], v[116:119]
    buffer_load_dwordx4 v10, s[24:27], s46 offen offset:256 lds
    s_add_u32 m0, m0, 3968
    v_mfma_f32_16x16x32_bf16 v[120:123], a[88:91], v[104:107], v[120:123]
    s_waitcnt lgkmcnt(2)
    v_mfma_f32_16x16x32_bf16 v[108:111], a[12:15], v[84:87], v[108:111]
    ds_read_b128 v[100:103], v12 offset:8192
    v_mfma_f32_16x16x32_bf16 v[112:115], a[12:15], v[88:91], v[112:115]
    ds_read_b128 v[104:107], v12 offset:10240
    v_mfma_f32_16x16x32_bf16 v[116:119], a[92:95], v[84:87], v[116:119]
    buffer_load_dwordx4 v10, s[24:27], s46 offen offset:384 lds
    s_add_u32 m0, m0, 3968
    v_mfma_f32_16x16x32_bf16 v[120:123], a[92:95], v[88:91], v[120:123]
    s_waitcnt lgkmcnt(2)
    v_mfma_f32_16x16x32_bf16 v[108:111], a[16:19], v[92:95], v[108:111]
    ds_read_b128 v[84:87], v11 offset:12288
    v_mfma_f32_16x16x32_bf16 v[112:115], a[16:19], v[96:99], v[112:115]
    ds_read_b128 v[88:91], v11 offset:14336
    v_mfma_f32_16x16x32_bf16 v[116:119], a[96:99], v[92:95], v[116:119]
    buffer_load_dwordx4 v10, s[24:27], s46 offen offset:512 lds
    s_add_u32 m0, m0, 3968
    v_mfma_f32_16x16x32_bf16 v[120:123], a[96:99], v[96:99], v[120:123]
    s_waitcnt lgkmcnt(2)
    v_mfma_f32_16x16x32_bf16 v[108:111], a[20:23], v[100:103], v[108:111]
    ds_read_b128 v[92:95], v12 offset:12288
    v_mfma_f32_16x16x32_bf16 v[112:115], a[20:23], v[104:107], v[112:115]
    ds_read_b128 v[96:99], v12 offset:14336
    v_mfma_f32_16x16x32_bf16 v[116:119], a[100:103], v[100:103], v[116:119]
    s_waitcnt vmcnt(5)
    buffer_store_dword v20, v136, s[4:7], s38 offen
    v_mfma_f32_16x16x32_bf16 v[120:123], a[100:103], v[104:107], v[120:123]
    s_waitcnt lgkmcnt(2)
    v_mfma_f32_16x16x32_bf16 v[108:111], a[24:27], v[84:87], v[108:111]
    ds_read_b128 v[100:103], v11 offset:16384
    v_mfma_f32_16x16x32_bf16 v[112:115], a[24:27], v[88:91], v[112:115]
    ds_read_b128 v[104:107], v11 offset:18432
    v_mfma_f32_16x16x32_bf16 v[116:119], a[104:107], v[84:87], v[116:119]
    buffer_load_dwordx4 v10, s[24:27], s46 offen offset:640 lds
    s_add_u32 m0, m0, 3968
    v_mfma_f32_16x16x32_bf16 v[120:123], a[104:107], v[88:91], v[120:123]
    s_waitcnt lgkmcnt(2)
    v_mfma_f32_16x16x32_bf16 v[108:111], a[28:31], v[92:95], v[108:111]
    ds_read_b128 v[84:87], v12 offset:16384
    v_mfma_f32_16x16x32_bf16 v[112:115], a[28:31], v[96:99], v[112:115]
    ds_read_b128 v[88:91], v12 offset:18432
    v_mfma_f32_16x16x32_bf16 v[116:119], a[108:111], v[92:95], v[116:119]
    buffer_load_dwordx4 v10, s[24:27], s46 offen offset:768 lds
    s_add_u32 m0, m0, 3968
    v_mfma_f32_16x16x32_bf16 v[120:123], a[108:111], v[96:99], v[120:123]
    s_waitcnt lgkmcnt(2)
    v_mfma_f32_16x16x32_bf16 v[108:111], a[32:35], v[100:103], v[108:111]
    ds_read_b128 v[92:95], v11 offset:20480
    v_mfma_f32_16x16x32_bf16 v[112:115], a[32:35], v[104:107], v[112:115]
    ds_read_b128 v[96:99], v11 offset:22528
    v_mfma_f32_16x16x32_bf16 v[116:119], a[112:115], v[100:103], v[116:119]
    buffer_load_dwordx4 v10, s[24:27], s46 offen offset:896 lds
    s_add_u32 m0, m0, 3968
    v_mfma_f32_16x16x32_bf16 v[120:123], a[112:115], v[104:107], v[120:123]
    s_waitcnt lgkmcnt(2)
    v_mfma_f32_16x16x32_bf16 v[108:111], a[36:39], v[84:87], v[108:111]
    ds_read_b128 v[100:103], v12 offset:20480
    v_mfma_f32_16x16x32_bf16 v[112:115], a[36:39], v[88:91], v[112:115]
    ds_read_b128 v[104:107], v12 offset:22528
    v_mfma_f32_16x16x32_bf16 v[116:119], a[116:119], v[84:87], v[116:119]
    buffer_load_dwordx4 v10, s[24:27], s46 offen offset:1024 lds
    s_add_u32 m0, m0, 3968
    v_mfma_f32_16x16x32_bf16 v[120:123], a[116:119], v[88:91], v[120:123]
    s_waitcnt lgkmcnt(2)
    v_mfma_f32_16x16x32_bf16 v[108:111], a[40:43], v[92:95], v[108:111]
    ds_read_b128 v[84:87], v11 offset:24576
    v_mfma_f32_16x16x32_bf16 v[112:115], a[40:43], v[96:99], v[112:115]
    ds_read_b128 v[88:91], v11 offset:26624
    v_mfma_f32_16x16x32_bf16 v[116:119], a[120:123], v[92:95], v[116:119]
    buffer_load_dwordx4 v10, s[24:27], s46 offen offset:1152 lds
    v_mfma_f32_16x16x32_bf16 v[120:123], a[120:123], v[96:99], v[120:123]
    s_waitcnt lgkmcnt(2)
    v_mfma_f32_16x16x32_bf16 v[108:111], a[44:47], v[100:103], v[108:111]
    ds_read_b128 v[92:95], v12 offset:24576
    v_mfma_f32_16x16x32_bf16 v[112:115], a[44:47], v[104:107], v[112:115]
    ds_read_b128 v[96:99], v12 offset:26624
    v_mfma_f32_16x16x32_bf16 v[116:119], a[124:127], v[100:103], v[116:119]
    v_mfma_f32_16x16x32_bf16 v[120:123], a[124:127], v[104:107], v[120:123]
    s_waitcnt lgkmcnt(2)
    v_mfma_f32_16x16x32_bf16 v[108:111], a[48:51], v[84:87], v[108:111]
    ds_read_b128 v[100:103], v11 offset:28672
    v_mfma_f32_16x16x32_bf16 v[112:115], a[48:51], v[88:91], v[112:115]
    ds_read_b128 v[104:107], v11 offset:30720
    v_mfma_f32_16x16x32_bf16 v[116:119], a[128:131], v[84:87], v[116:119]
    v_mfma_f32_16x16x32_bf16 v[120:123], a[128:131], v[88:91], v[120:123]
    s_waitcnt lgkmcnt(2)
    v_mfma_f32_16x16x32_bf16 v[108:111], a[52:55], v[92:95], v[108:111]
    ds_read_b128 v[84:87], v12 offset:28672
    v_mfma_f32_16x16x32_bf16 v[112:115], a[52:55], v[96:99], v[112:115]
    ds_read_b128 v[88:91], v12 offset:30720
    v_mfma_f32_16x16x32_bf16 v[116:119], a[132:135], v[92:95], v[116:119]
    v_mfma_f32_16x16x32_bf16 v[120:123], a[132:135], v[96:99], v[120:123]
    s_waitcnt lgkmcnt(2)
    v_mfma_f32_16x16x32_bf16 v[108:111], a[56:59], v[100:103], v[108:111]
    ds_read_b128 v[92:95], v11 offset:32768
    v_mfma_f32_16x16x32_bf16 v[112:115], a[56:59], v[104:107], v[112:115]
    ds_read_b128 v[96:99], v11 offset:34816
    v_mfma_f32_16x16x32_bf16 v[116:119], a[136:139], v[100:103], v[116:119]
    v_mfma_f32_16x16x32_bf16 v[120:123], a[136:139], v[104:107], v[120:123]
    s_waitcnt lgkmcnt(2)
    v_mfma_f32_16x16x32_bf16 v[108:111], a[60:63], v[84:87], v[108:111]
    ds_read_b128 v[100:103], v12 offset:32768
    v_mfma_f32_16x16x32_bf16 v[112:115], a[60:63], v[88:91], v[112:115]
    ds_read_b128 v[104:107], v12 offset:34816
    v_mfma_f32_16x16x32_bf16 v[116:119], a[140:143], v[84:87], v[116:119]
    v_mfma_f32_16x16x32_bf16 v[120:123], a[140:143], v[88:91], v[120:123]
    s_waitcnt lgkmcnt(2)
    v_mfma_f32_16x16x32_bf16 v[108:111], a[64:67], v[92:95], v[108:111]
    ds_read_b128 v[84:87], v11 offset:36864
    v_mfma_f32_16x16x32_bf16 v[112:115], a[64:67], v[96:99], v[112:115]
    ds_read_b128 v[88:91], v11 offset:38912
    v_mfma_f32_16x16x32_bf16 v[116:119], a[144:147], v[92:95], v[116:119]
    v_mfma_f32_16x16x32_bf16 v[120:123], a[144:147], v[96:99], v[120:123]
    s_waitcnt lgkmcnt(2)
    v_mfma_f32_16x16x32_bf16 v[108:111], a[68:71], v[100:103], v[108:111]
    ds_read_b128 v[92:95], v12 offset:36864
    v_mfma_f32_16x16x32_bf16 v[112:115], a[68:71], v[104:107], v[112:115]
    ds_read_b128 v[96:99], v12 offset:38912
    v_mfma_f32_16x16x32_bf16 v[116:119], a[148:151], v[100:103], v[116:119]
    v_mfma_f32_16x16x32_bf16 v[120:123], a[148:151], v[104:107], v[120:123]
    s_waitcnt lgkmcnt(0)
    v_mfma_f32_16x16x32_bf16 v[108:111], a[72:75], v[84:87], v[108:111]
    v_add_u32 v11, s49, v11
    v_mfma_f32_16x16x32_bf16 v[112:115], a[72:75], v[88:91], v[112:115]
    v_add_u32 v12, s49, v12
    v_mfma_f32_16x16x32_bf16 v[108:111], a[76:79], v[92:95], v[108:111]
    s_sub_u32 s47, s47, s49
    v_mfma_f32_16x16x32_bf16 v[112:115], a[76:79], v[96:99], v[112:115]
    s_sub_u32 s49, 0, s49
    v_mfma_f32_16x16x32_bf16 v[116:119], a[152:155], v[84:87], v[116:119]
    v_mfma_f32_16x16x32_bf16 v[120:123], a[152:155], v[88:91], v[120:123]
    v_mfma_f32_16x16x32_bf16 v[116:119], a[156:159], v[92:95], v[116:119]
    v_mfma_f32_16x16x32_bf16 v[120:123], a[156:159], v[96:99], v[120:123]
    v_cvt_pk_bf16_f32 v124, v108, v109
    v_cvt_pk_bf16_f32 v125, v110, v111
    v_cvt_pk_bf16_f32 v126, v112, v113
    v_cvt_pk_bf16_f32 v127, v114, v115
    s_nop 0
    v_permlane16_swap_b32 v124, v126
    v_permlane16_swap_b32 v125, v127
    v_cvt_pk_bf16_f32 v128, v116, v117
    v_cvt_pk_bf16_f32 v129, v118, v119
    v_cvt_pk_bf16_f32 v130, v120, v121
    v_cvt_pk_bf16_f32 v131, v122, v123
    s_nop 0
    v_permlane16_swap_b32 v128, v130
    v_permlane16_swap_b32 v129, v131
    buffer_store_dwordx4 v[124:127], v19, s[4:7], s44 offen
    buffer_store_dwordx4 v[128:131], v19, s[4:7], s45 offen
    s_waitcnt vmcnt(2) lgkmcnt(0)
    s_barrier
    s_add_u32 s44, s38, 294912
    s_add_u32 s45, s44, s56
    s_mov_b32 s46, 122880
    v_mov_b32 v20, 2
    ds_read_b128 v[84:87], v11 offset:0
    ds_read_b128 v[88:91], v11 offset:2048
    ds_read_b128 v[92:95], v12 offset:0
    ds_read_b128 v[96:99], v12 offset:2048
    s_lshl_b32 s90, s32, 10
    s_add_u32 m0, s90, s47
    s_waitcnt lgkmcnt(2)
    v_mfma_f32_16x16x32_bf16 v[108:111], a[0:3], v[84:87], 0
    ds_read_b128 v[100:103], v11 offset:4096
    s_add_u32 s51, s37, 3
    v_mfma_f32_16x16x32_bf16 v[112:115], a[0:3], v[88:91], 0
    ds_read_b128 v[104:107], v11 offset:6144
    s_and_b32 s50, s51, 3
    v_mfma_f32_16x16x32_bf16 v[116:119], a[80:83], v[84:87], 0
    buffer_load_dwordx4 v10, s[24:27], s46 offen offset:0 lds
    s_add_u32 m0, m0, 3968
    v_mfma_f32_16x16x32_bf16 v[120:123], a[80:83], v[88:91], 0
    s_waitcnt lgkmcnt(2)
    s_mul_i32 s50, s50, 114688
    v_mfma_f32_16x16x32_bf16 v[108:111], a[4:7], v[92:95], v[108:111]
    ds_read_b128 v[84:87], v12 offset:4096
    s_add_u32 s50, s50, 65536
    v_mfma_f32_16x16x32_bf16 v[112:115], a[4:7], v[96:99], v[112:115]
    ds_read_b128 v[88:91], v12 offset:6144
    s_add_u32 s44, s38, s50
    v_mfma_f32_16x16x32_bf16 v[116:119], a[84:87], v[92:95], v[116:119]
    buffer_load_dwordx4 v10, s[24:27], s46 offen offset:128 lds
    s_add_u32 m0, m0, 3968
    v_mfma_f32_16x16x32_bf16 v[120:123], a[84:87], v[96:99], v[120:123]
    s_waitcnt lgkmcnt(2)
    s_add_u32 s45, s44, s56
    v_mfma_f32_16x16x32_bf16 v[108:111], a[8:11], v[100:103], v[108:111]
    ds_read_b128 v[92:95], v11 offset:8192
    s_add_u32 s37, s37, 1
    v_mfma_f32_16x16x32_bf16 v[112:115], a[8:11], v[104:107], v[112:115]
    ds_read_b128 v[96:99], v11 offset:10240
    s_mov_b32 s52, 0
    v_mfma_f32_16x16x32_bf16 v[116:119], a[88:91], v[100:103], v[116:119]
    buffer_load_dwordx4 v10, s[24:27], s46 offen offset:256 lds
    s_add_u32 m0, m0, 3968
    v_mfma_f32_16x16x32_bf16 v[120:123], a[88:91], v[104:107], v[120:123]
    s_waitcnt lgkmcnt(2)
    s_and_b32 s50, s37, 3
    v_mfma_f32_16x16x32_bf16 v[108:111], a[12:15], v[84:87], v[108:111]
    ds_read_b128 v[100:103], v12 offset:8192
    s_mul_i32 s51, s50, 114688
    v_mfma_f32_16x16x32_bf16 v[112:115], a[12:15], v[88:91], v[112:115]
    ds_read_b128 v[104:107], v12 offset:10240
    s_add_u32 s41, s38, s51
    v_mfma_f32_16x16x32_bf16 v[116:119], a[92:95], v[84:87], v[116:119]
    buffer_load_dwordx4 v10, s[24:27], s46 offen offset:384 lds
    s_add_u32 m0, m0, 3968
    v_mfma_f32_16x16x32_bf16 v[120:123], a[92:95], v[88:91], v[120:123]
    s_waitcnt lgkmcnt(2)
    v_mfma_f32_16x16x32_bf16 v[108:111], a[16:19], v[92:95], v[108:111]
    ds_read_b128 v[84:87], v11 offset:12288
    v_mfma_f32_16x16x32_bf16 v[112:115], a[16:19], v[96:99], v[112:115]
    ds_read_b128 v[88:91], v11 offset:14336
    v_mfma_f32_16x16x32_bf16 v[116:119], a[96:99], v[92:95], v[116:119]
    buffer_load_dwordx4 v10, s[24:27], s46 offen offset:512 lds
    s_add_u32 m0, m0, 3968
    v_mfma_f32_16x16x32_bf16 v[120:123], a[96:99], v[96:99], v[120:123]
    s_waitcnt lgkmcnt(2)
    v_mfma_f32_16x16x32_bf16 v[108:111], a[20:23], v[100:103], v[108:111]
    ds_read_b128 v[92:95], v12 offset:12288
    v_mfma_f32_16x16x32_bf16 v[112:115], a[20:23], v[104:107], v[112:115]
    ds_read_b128 v[96:99], v12 offset:14336
    v_mfma_f32_16x16x32_bf16 v[116:119], a[100:103], v[100:103], v[116:119]
    s_waitcnt vmcnt(5)
    buffer_store_dword v20, v136, s[4:7], s38 offen
    v_mfma_f32_16x16x32_bf16 v[120:123], a[100:103], v[104:107], v[120:123]
    s_waitcnt lgkmcnt(2)
    v_mfma_f32_16x16x32_bf16 v[108:111], a[24:27], v[84:87], v[108:111]
    ds_read_b128 v[100:103], v11 offset:16384
    v_mfma_f32_16x16x32_bf16 v[112:115], a[24:27], v[88:91], v[112:115]
    ds_read_b128 v[104:107], v11 offset:18432
    v_mfma_f32_16x16x32_bf16 v[116:119], a[104:107], v[84:87], v[116:119]
    buffer_load_dwordx4 v10, s[24:27], s46 offen offset:640 lds
    s_add_u32 m0, m0, 3968
    v_mfma_f32_16x16x32_bf16 v[120:123], a[104:107], v[88:91], v[120:123]
    s_waitcnt lgkmcnt(2)
    v_mfma_f32_16x16x32_bf16 v[108:111], a[28:31], v[92:95], v[108:111]
    ds_read_b128 v[84:87], v12 offset:16384
    v_mfma_f32_16x16x32_bf16 v[112:115], a[28:31], v[96:99], v[112:115]
    ds_read_b128 v[88:91], v12 offset:18432
    v_mfma_f32_16x16x32_bf16 v[116:119], a[108:111], v[92:95], v[116:119]
    buffer_load_dwordx4 v10, s[24:27], s46 offen offset:768 lds
    s_add_u32 m0, m0, 3968
    v_mfma_f32_16x16x32_bf16 v[120:123], a[108:111], v[96:99], v[120:123]
    s_waitcnt lgkmcnt(2)
    v_mfma_f32_16x16x32_bf16 v[108:111], a[32:35], v[100:103], v[108:111]
    ds_read_b128 v[92:95], v11 offset:20480
    v_mfma_f32_16x16x32_bf16 v[112:115], a[32:35], v[104:107], v[112:115]
    ds_read_b128 v[96:99], v11 offset:22528
    v_mfma_f32_16x16x32_bf16 v[116:119], a[112:115], v[100:103], v[116:119]
    buffer_load_dwordx4 v10, s[24:27], s46 offen offset:896 lds
    s_add_u32 m0, m0, 3968
    v_mfma_f32_16x16x32_bf16 v[120:123], a[112:115], v[104:107], v[120:123]
    s_waitcnt lgkmcnt(2)
    v_mfma_f32_16x16x32_bf16 v[108:111], a[36:39], v[84:87], v[108:111]
    ds_read_b128 v[100:103], v12 offset:20480
    v_mfma_f32_16x16x32_bf16 v[112:115], a[36:39], v[88:91], v[112:115]
    ds_read_b128 v[104:107], v12 offset:22528
    v_mfma_f32_16x16x32_bf16 v[116:119], a[116:119], v[84:87], v[116:119]
    buffer_load_dwordx4 v10, s[24:27], s46 offen offset:1024 lds
    s_add_u32 m0, m0, 3968
    v_mfma_f32_16x16x32_bf16 v[120:123], a[116:119], v[88:91], v[120:123]
    s_waitcnt lgkmcnt(2)
    v_mfma_f32_16x16x32_bf16 v[108:111], a[40:43], v[92:95], v[108:111]
    ds_read_b128 v[84:87], v11 offset:24576
    v_mfma_f32_16x16x32_bf16 v[112:115], a[40:43], v[96:99], v[112:115]
    ds_read_b128 v[88:91], v11 offset:26624
    v_mfma_f32_16x16x32_bf16 v[116:119], a[120:123], v[92:95], v[116:119]
    buffer_load_dwordx4 v10, s[24:27], s46 offen offset:1152 lds
    v_mfma_f32_16x16x32_bf16 v[120:123], a[120:123], v[96:99], v[120:123]
    s_waitcnt lgkmcnt(2)
    v_mfma_f32_16x16x32_bf16 v[108:111], a[44:47], v[100:103], v[108:111]
    ds_read_b128 v[92:95], v12 offset:24576
    v_mfma_f32_16x16x32_bf16 v[112:115], a[44:47], v[104:107], v[112:115]
    ds_read_b128 v[96:99], v12 offset:26624
    v_mfma_f32_16x16x32_bf16 v[116:119], a[124:127], v[100:103], v[116:119]
    v_mfma_f32_16x16x32_bf16 v[120:123], a[124:127], v[104:107], v[120:123]
    s_waitcnt lgkmcnt(2)
    v_mfma_f32_16x16x32_bf16 v[108:111], a[48:51], v[84:87], v[108:111]
    ds_read_b128 v[100:103], v11 offset:28672
    v_mfma_f32_16x16x32_bf16 v[112:115], a[48:51], v[88:91], v[112:115]
    ds_read_b128 v[104:107], v11 offset:30720
    v_mfma_f32_16x16x32_bf16 v[116:119], a[128:131], v[84:87], v[116:119]
    v_mfma_f32_16x16x32_bf16 v[120:123], a[128:131], v[88:91], v[120:123]
    s_waitcnt lgkmcnt(2)
    v_mfma_f32_16x16x32_bf16 v[108:111], a[52:55], v[92:95], v[108:111]
    ds_read_b128 v[84:87], v12 offset:28672
    v_mfma_f32_16x16x32_bf16 v[112:115], a[52:55], v[96:99], v[112:115]
    ds_read_b128 v[88:91], v12 offset:30720
    v_mfma_f32_16x16x32_bf16 v[116:119], a[132:135], v[92:95], v[116:119]
    v_mfma_f32_16x16x32_bf16 v[120:123], a[132:135], v[96:99], v[120:123]
    s_waitcnt lgkmcnt(2)
    v_mfma_f32_16x16x32_bf16 v[108:111], a[56:59], v[100:103], v[108:111]
    ds_read_b128 v[92:95], v11 offset:32768
    v_mfma_f32_16x16x32_bf16 v[112:115], a[56:59], v[104:107], v[112:115]
    ds_read_b128 v[96:99], v11 offset:34816
    v_mfma_f32_16x16x32_bf16 v[116:119], a[136:139], v[100:103], v[116:119]
    v_mfma_f32_16x16x32_bf16 v[120:123], a[136:139], v[104:107], v[120:123]
    s_waitcnt lgkmcnt(2)
    v_mfma_f32_16x16x32_bf16 v[108:111], a[60:63], v[84:87], v[108:111]
    ds_read_b128 v[100:103], v12 offset:32768
    v_mfma_f32_16x16x32_bf16 v[112:115], a[60:63], v[88:91], v[112:115]
    ds_read_b128 v[104:107], v12 offset:34816
    v_mfma_f32_16x16x32_bf16 v[116:119], a[140:143], v[84:87], v[116:119]
    v_mfma_f32_16x16x32_bf16 v[120:123], a[140:143], v[88:91], v[120:123]
    s_waitcnt lgkmcnt(2)
    v_mfma_f32_16x16x32_bf16 v[108:111], a[64:67], v[92:95], v[108:111]
    ds_read_b128 v[84:87], v11 offset:36864
    v_mfma_f32_16x16x32_bf16 v[112:115], a[64:67], v[96:99], v[112:115]
    ds_read_b128 v[88:91], v11 offset:38912
    v_mfma_f32_16x16x32_bf16 v[116:119], a[144:147], v[92:95], v[116:119]
    v_mfma_f32_16x16x32_bf16 v[120:123], a[144:147], v[96:99], v[120:123]
    s_waitcnt lgkmcnt(2)
    v_mfma_f32_16x16x32_bf16 v[108:111], a[68:71], v[100:103], v[108:111]
    ds_read_b128 v[92:95], v12 offset:36864
    v_mfma_f32_16x16x32_bf16 v[112:115], a[68:71], v[104:107], v[112:115]
    ds_read_b128 v[96:99], v12 offset:38912
    v_mfma_f32_16x16x32_bf16 v[116:119], a[148:151], v[100:103], v[116:119]
    v_mfma_f32_16x16x32_bf16 v[120:123], a[148:151], v[104:107], v[120:123]
    s_waitcnt lgkmcnt(0)
    v_mfma_f32_16x16x32_bf16 v[108:111], a[72:75], v[84:87], v[108:111]
    v_add_u32 v11, s49, v11
    v_mfma_f32_16x16x32_bf16 v[112:115], a[72:75], v[88:91], v[112:115]
    v_add_u32 v12, s49, v12
    v_mfma_f32_16x16x32_bf16 v[108:111], a[76:79], v[92:95], v[108:111]
    s_sub_u32 s47, s47, s49
    v_mfma_f32_16x16x32_bf16 v[112:115], a[76:79], v[96:99], v[112:115]
    s_sub_u32 s49, 0, s49
    v_mfma_f32_16x16x32_bf16 v[116:119], a[152:155], v[84:87], v[116:119]
    v_mfma_f32_16x16x32_bf16 v[120:123], a[152:155], v[88:91], v[120:123]
    v_mfma_f32_16x16x32_bf16 v[116:119], a[156:159], v[92:95], v[116:119]
    v_mfma_f32_16x16x32_bf16 v[120:123], a[156:159], v[96:99], v[120:123]
    v_cvt_pk_bf16_f32 v124, v108, v109
    v_cvt_pk_bf16_f32 v125, v110, v111
    v_cvt_pk_bf16_f32 v126, v112, v113
    v_cvt_pk_bf16_f32 v127, v114, v115
    s_nop 0
    v_permlane16_swap_b32 v124, v126
    v_permlane16_swap_b32 v125, v127
    v_cvt_pk_bf16_f32 v128, v116, v117
    v_cvt_pk_bf16_f32 v129, v118, v119
    v_cvt_pk_bf16_f32 v130, v120, v121
    v_cvt_pk_bf16_f32 v131, v122, v123
    s_nop 0
    v_permlane16_swap_b32 v128, v130
    v_permlane16_swap_b32 v129, v131
    buffer_store_dwordx4 v[124:127], v19, s[4:7], s44 offen
    buffer_store_dwordx4 v[128:131], v19, s[4:7], s45 offen
    s_add_u32 s50, s37, 2
    s_and_b32 s50, s50, 3
    s_mul_i32 s50, s50, 114688
    s_add_u32 s42, s38, s50
    s_add_u32 s50, s37, 4
    s_min_u32 s50, s50, 63
    s_mul_i32 s46, s50, 40960
    s_add_u32 s51, s37, 1
    v_mov_b32 v20, s51
    s_mov_b32 m0, s48
    v_mov_b32 v68, 0
    v_mov_b32 v69, 0
    v_mov_b32 v70, 0
    v_mov_b32 v71, 0
    v_mov_b32 v72, 0
    v_mov_b32 v73, 0
    v_mov_b32 v74, 0
    v_mov_b32 v75, 0
    s_add_u32 s50, s37, 6
    s_min_u32 s50, s50, 63
    s_mul_i32 s57, s50, 40960
    s_and_b32 s50, s37, 3
    s_mul_i32 s51, s50, 40960
    s_add_u32 s43, s51, s38
    s_mul_i32 s51, s50, 327680
    s_add_u32 s53, s51, 4194304
    s_xor_b32 s50, s50, 2
    s_mul_i32 s51, s50, 327680
    s_add_u32 s54, s51, 4194304
    s_sub_u32 s51, s37, 6
    s_mul_i32 s60, s51, 81920
    s_branch L_v_first_f
L_v_loop_f:
    s_add_u32 s50, s37, 2
    s_and_b32 s50, s50, 3
    s_mul_i32 s50, s50, 114688
    s_add_u32 s42, s38, s50
    s_add_u32 s50, s37, 4
    s_min_u32 s50, s50, 63
    s_mul_i32 s46, s50, 40960
    s_add_u32 s51, s37, 1
    v_mov_b32 v20, s51
    s_mov_b32 m0, s48
    v_mov_b32 v68, 0
    v_mov_b32 v69, 0
    v_mov_b32 v70, 0
    v_mov_b32 v71, 0
    v_mov_b32 v72, 0
    v_mov_b32 v73, 0
    v_mov_b32 v74, 0
    v_mov_b32 v75, 0
    s_add_u32 s50, s37, 6
    s_min_u32 s50, s50, 63
    s_mul_i32 s57, s50, 40960
    s_and_b32 s50, s37, 3
    s_mul_i32 s51, s50, 40960
    s_add_u32 s43, s51, s38
    s_mul_i32 s51, s50, 327680
    s_add_u32 s53, s51, 4194304
    s_xor_b32 s50, s50, 2
    s_mul_i32 s51, s50, 327680
    s_add_u32 s54, s51, 4194304
    s_sub_u32 s51, s37, 6
    s_mul_i32 s60, s51, 81920
L_vg_19:
    buffer_load_dword v139, v138, s[4:7], s38 offen sc1
    s_sub_u32 s36, s36, 1
    s_cbranch_scc1 L_exit
    s_waitcnt vmcnt(0)
    v_cmp_gt_u32 vcc, s37, v139
    s_cbranch_vccnz L_vg_19
L_v_first_f:
    buffer_load_dwordx4 v13, s[4:7], s41 offen sc1 lds
    buffer_load_dwordx4 v13, s[4:7], s41 offen offset:1024 sc1 lds
    buffer_load_dword v14, s[4:7], s41 offen offset:2048 sc1 lds
    buffer_load_dword v14, s[4:7], s41 offen offset:2304 sc1 lds
L_poll_21:
    buffer_load_dwordx4 v13, s[4:7], s41 offen sc1 lds
    buffer_load_dwordx4 v13, s[4:7], s41 offen offset:1024 sc1 lds
    buffer_load_dword v14, s[4:7], s41 offen offset:2048 sc1 lds
    buffer_load_dword v14, s[4:7], s41 offen offset:2304 sc1 lds
    s_sub_u32 s36, s36, 1
    s_cbranch_scc1 L_exit
    s_waitcnt vmcnt(4)
    ds_read_b32 v18, v15
    s_waitcnt lgkmcnt(0)
    v_cmp_eq_u32 vcc, -1, v18
    s_cbranch_vccnz L_poll_21
    s_barrier
    ds_read_b128 v[28:31], v16 offset:0
    ds_read_b128 v[32:35], v16 offset:1024
    ds_read_b128 v[36:39], v16 offset:2048
    ds_read_b128 v[40:43], v16 offset:3072
    s_waitcnt lgkmcnt(3)
    v_smfmac_f32_16x16x64_bf16 v[68:71], v[28:31], a[0:7], v17
    ds_read_b128 v[44:47], v16 offset:4096
    v_smfmac_f32_16x16x64_bf16 v[72:75], v[28:31], a[80:87], v17
    ds_read_b128 v[48:51], v16 offset:5120
    s_waitcnt lgkmcnt(4)
    v_smfmac_f32_16x16x64_bf16 v[68:71], v[32:35], a[8:15], v17
    ds_read_b128 v[52:55], v16 offset:6144
    v_smfmac_f32_16x16x64_bf16 v[72:75], v[32:35], a[88:95], v17
    ds_read_b128 v[56:59], v16 offset:7168
    s_waitcnt lgkmcnt(5)
    v_smfmac_f32_16x16x64_bf16 v[68:71], v[36:39], a[16:23], v17
    ds_read_b128 v[60:63], v16 offset:8192
    v_smfmac_f32_16x16x64_bf16 v[72:75], v[36:39], a[96:103], v17
    ds_read_b128 v[64:67], v16 offset:9216
    s_waitcnt lgkmcnt(6)
    v_smfmac_f32_16x16x64_bf16 v[68:71], v[40:43], a[24:31], v17
    v_smfmac_f32_16x16x64_bf16 v[72:75], v[40:43], a[104:111], v17
    s_waitcnt lgkmcnt(5)
    v_smfmac_f32_16x16x64_bf16 v[68:71], v[44:47], a[32:39], v17
    v_smfmac_f32_16x16x64_bf16 v[72:75], v[44:47], a[112:119], v17
    s_waitcnt lgkmcnt(4)
    v_smfmac_f32_16x16x64_bf16 v[68:71], v[48:51], a[40:47], v17
    s_waitcnt lgkmcnt(3)
    v_smfmac_f32_16x16x64_bf16 v[68:71], v[52:55], a[48:55], v17
    s_waitcnt lgkmcnt(2)
    v_smfmac_f32_16x16x64_bf16 v[68:71], v[56:59], a[56:63], v17
    s_waitcnt lgkmcnt(1)
    v_smfmac_f32_16x16x64_bf16 v[68:71], v[60:63], a[64:71], v17
    s_waitcnt lgkmcnt(0)
    v_smfmac_f32_16x16x64_bf16 v[68:71], v[64:67], a[72:79], v17
L_redo_20:
    v_smfmac_f32_16x16x64_bf16 v[72:75], v[48:51], a[120:127], v17
    v_smfmac_f32_16x16x64_bf16 v[72:75], v[52:55], a[128:135], v17
    buffer_store_dword v20, v21, s[4:7], s38 offen offset:0
    v_smfmac_f32_16x16x64_bf16 v[72:75], v[56:59], a[136:143], v17
    v_add_f32 v68, v68, v70
    v_add_f32 v69, v69, v71
    v_smfmac_f32_16x16x64_bf16 v[72:75], v[60:63], a[144:151], v17
    v_cmp_u_f32 vcc, v68, v69
    v_cvt_pk_bf16_f32 v132, v68, v69
    v_smfmac_f32_16x16x64_bf16 v[72:75], v[64:67], a[152:159], v17
    s_cbranch_vccnz L_nan_22
L_cont_23:
    buffer_store_dword v132, v134, s[4:7], s41 offen offset:0
    s_nop 5
    v_pk_add_f32 v[72:73], v[72:73], v[74:75]
    v_cvt_pk_bf16_f32 v133, v72, v73
    buffer_store_dword v133, v134, s[4:7], s41 offen offset:1024
    ds_read_b128 v[84:87], v11 offset:0
    ds_read_b128 v[88:91], v11 offset:2048
    ds_read_b128 v[92:95], v12 offset:0
    ds_read_b128 v[96:99], v12 offset:2048
    s_cmp_eq_u32 s37, 63
    s_cbranch_scc1 L_end_24
    s_cmp_eq_u32 s37, 0
    s_cbranch_scc1 L_sd_25c
L_sd_25:
    s_cmp_eq_u32 s40, 0
    s_cbranch_scc1 L_an_26
    s_barrier
    s_lshl_b32 s90, s32, 10
    s_add_u32 m0, s90, s47
    s_waitcnt lgkmcnt(2)
    v_mfma_f32_16x16x32_bf16 v[108:111], a[0:3], v[84:87], 0
    ds_read_b128 v[100:103], v11 offset:4096
    s_add_u32 s51, s37, 3
    v_mfma_f32_16x16x32_bf16 v[112:115], a[0:3], v[88:91], 0
    ds_read_b128 v[104:107], v11 offset:6144
    s_and_b32 s50, s51, 3
    v_mfma_f32_16x16x32_bf16 v[116:119], a[80:83], v[84:87], 0
    buffer_load_dwordx4 v[148:151], v146, s[4:7], s43 offen offset:0 sc1
    buffer_load_dwordx4 v[152:155], v146, s[4:7], s43 offen offset:1024 sc1
    v_mfma_f32_16x16x32_bf16 v[120:123], a[80:83], v[88:91], 0
    s_waitcnt lgkmcnt(2)
    s_mul_i32 s50, s50, 114688
    v_mfma_f32_16x16x32_bf16 v[108:111], a[4:7], v[92:95], v[108:111]
    ds_read_b128 v[84:87], v12 offset:4096
    s_add_u32 s50, s50, 65536
    v_mfma_f32_16x16x32_bf16 v[112:115], a[4:7], v[96:99], v[112:115]
    ds_read_b128 v[88:91], v12 offset:6144
    s_add_u32 s44, s38, s50
    v_mfma_f32_16x16x32_bf16 v[116:119], a[84:87], v[92:95], v[116:119]
    s_cmp_lt_i32 s60, 0
    s_cselect_b32 s54, s38, s54
    buffer_load_dwordx4 v[156:159], v144, s[4:7], s54 offen offset:0 sc1
    buffer_load_dwordx4 v[160:163], v144, s[4:7], s54 offen offset:1024 sc1
    v_mfma_f32_16x16x32_bf16 v[120:123], a[84:87], v[96:99], v[120:123]
    s_waitcnt lgkmcnt(2)
    s_add_u32 s45, s44, s56
    v_mfma_f32_16x16x32_bf16 v[108:111], a[8:11], v[100:103], v[108:111]
    ds_read_b128 v[92:95], v11 offset:8192
    s_add_u32 s37, s37, 1
    v_mfma_f32_16x16x32_bf16 v[112:115], a[8:11], v[104:107], v[112:115]
    ds_read_b128 v[96:99], v11 offset:10240
    s_mov_b32 s52, 0
    v_mfma_f32_16x16x32_bf16 v[116:119], a[88:91], v[100:103], v[116:119]
    s_and_b32 s50, s37, 3
    s_mul_i32 s51, s50, 114688
    v_mfma_f32_16x16x32_bf16 v[120:123], a[88:91], v[104:107], v[120:123]
    s_waitcnt lgkmcnt(2)
    s_add_u32 s41, s38, s51
    v_mfma_f32_16x16x32_bf16 v[108:111], a[12:15], v[84:87], v[108:111]
    ds_read_b128 v[100:103], v12 offset:8192
    v_mfma_f32_16x16x32_bf16 v[112:115], a[12:15], v[88:91], v[112:115]
    ds_read_b128 v[104:107], v12 offset:10240
    v_mfma_f32_16x16x32_bf16 v[116:119], a[92:95], v[84:87], v[116:119]
    buffer_load_dwordx4 v[248:251], v137, s[24:27], s57 offen offset:0
    buffer_load_dwordx4 v[248:251], v137, s[24:27], s57 offen offset:1024
    v_mfma_f32_16x16x32_bf16 v[120:123], a[92:95], v[88:91], v[120:123]
    s_waitcnt lgkmcnt(2)
    v_mfma_f32_16x16x32_bf16 v[108:111], a[16:19], v[92:95], v[108:111]
    ds_read_b128 v[84:87], v11 offset:12288
    v_mfma_f32_16x16x32_bf16 v[112:115], a[16:19], v[96:99], v[112:115]
    ds_read_b128 v[88:91], v11 offset:14336
    v_mfma_f32_16x16x32_bf16 v[116:119], a[96:99], v[92:95], v[116:119]
    v_mfma_f32_16x16x32_bf16 v[120:123], a[96:99], v[96:99], v[120:123]
    s_waitcnt lgkmcnt(2)
    v_mfma_f32_16x16x32_bf16 v[108:111], a[20:23], v[100:103], v[108:111]
    ds_read_b128 v[92:95], v12 offset:12288
    v_mfma_f32_16x16x32_bf16 v[112:115], a[20:23], v[104:107], v[112:115]
    ds_read_b128 v[96:99], v12 offset:14336
    v_mfma_f32_16x16x32_bf16 v[116:119], a[100:103], v[100:103], v[116:119]
    s_waitcnt vmcnt(4)
    s_cmp_lt_i32 s60, -245760
    s_cbranch_scc1 L_fw_27c
L_fw_27:
    buffer_store_dwordx4 v[148:151], v143, s[4:7], s53 offen offset:0 sc1
    buffer_store_dwordx4 v[152:155], v143, s[4:7], s53 offen offset:1024 sc1
    v_mfma_f32_16x16x32_bf16 v[120:123], a[100:103], v[104:107], v[120:123]
    s_waitcnt lgkmcnt(2)
    v_mfma_f32_16x16x32_bf16 v[108:111], a[24:27], v[84:87], v[108:111]
    ds_read_b128 v[100:103], v11 offset:16384
    v_mfma_f32_16x16x32_bf16 v[112:115], a[24:27], v[88:91], v[112:115]
    ds_read_b128 v[104:107], v11 offset:18432
    v_mfma_f32_16x16x32_bf16 v[116:119], a[104:107], v[84:87], v[116:119]
    v_mfma_f32_16x16x32_bf16 v[120:123], a[104:107], v[88:91], v[120:123]
    s_waitcnt lgkmcnt(2)
    v_mfma_f32_16x16x32_bf16 v[108:111], a[28:31], v[92:95], v[108:111]
    ds_read_b128 v[84:87], v12 offset:16384
    v_mfma_f32_16x16x32_bf16 v[112:115], a[28:31], v[96:99], v[112:115]
    ds_read_b128 v[88:91], v12 offset:18432
    v_mfma_f32_16x16x32_bf16 v[116:119], a[108:111], v[92:95], v[116:119]
    buffer_store_dword v22, v135, s[4:7], s42 offen offset:0
    buffer_store_dword v22, v135, s[4:7], s42 offen offset:1024
    v_mfma_f32_16x16x32_bf16 v[120:123], a[108:111], v[96:99], v[120:123]
    s_waitcnt lgkmcnt(2)
    v_mfma_f32_16x16x32_bf16 v[108:111], a[32:35], v[100:103], v[108:111]
    ds_read_b128 v[92:95], v11 offset:20480
    v_mfma_f32_16x16x32_bf16 v[112:115], a[32:35], v[104:107], v[112:115]
    ds_read_b128 v[96:99], v11 offset:22528
    v_mfma_f32_16x16x32_bf16 v[116:119], a[112:115], v[100:103], v[116:119]
    buffer_load_dwordx4 v10, s[24:27], s46 offen offset:0 lds
    s_add_u32 m0, m0, 3968
    v_mfma_f32_16x16x32_bf16 v[120:123], a[112:115], v[104:107], v[120:123]
    s_waitcnt lgkmcnt(2)
    v_mfma_f32_16x16x32_bf16 v[108:111], a[36:39], v[84:87], v[108:111]
    ds_read_b128 v[100:103], v12 offset:20480
    v_mfma_f32_16x16x32_bf16 v[112:115], a[36:39], v[88:91], v[112:115]
    ds_read_b128 v[104:107], v12 offset:22528
    v_mfma_f32_16x16x32_bf16 v[116:119], a[116:119], v[84:87], v[116:119]
    buffer_load_dwordx4 v10, s[24:27], s46 offen offset:128 lds
    s_add_u32 m0, m0, 3968
    v_mfma_f32_16x16x32_bf16 v[120:123], a[116:119], v[88:91], v[120:123]
    s_waitcnt lgkmcnt(2)
    v_mfma_f32_16x16x32_bf16 v[108:111], a[40:43], v[92:95], v[108:111]
    ds_read_b128 v[84:87], v11 offset:24576
    v_mfma_f32_16x16x32_bf16 v[112:115], a[40:43], v[96:99], v[112:115]
    ds_read_b128 v[88:91], v11 offset:26624
    v_mfma_f32_16x16x32_bf16 v[116:119], a[120:123], v[92:95], v[116:119]
    buffer_load_dwordx4 v10, s[24:27], s46 offen offset:256 lds
    s_add_u32 m0, m0, 3968
    v_mfma_f32_16x16x32_bf16 v[120:123], a[120:123], v[96:99], v[120:123]
    s_waitcnt lgkmcnt(2)
    v_mfma_f32_16x16x32_bf16 v[108:111], a[44:47], v[100:103], v[108:111]
    ds_read_b128 v[92:95], v12 offset:24576
    v_mfma_f32_16x16x32_bf16 v[112:115], a[44:47], v[104:107], v[112:115]
    ds_read_b128 v[96:99], v12 offset:26624
    v_mfma_f32_16x16x32_bf16 v[116:119], a[124:127], v[100:103], v[116:119]
    buffer_load_dwordx4 v10, s[24:27], s46 offen offset:384 lds
    s_add_u32 m0, m0, 3968
    v_mfma_f32_16x16x32_bf16 v[120:123], a[124:127], v[104:107], v[120:123]
    s_waitcnt lgkmcnt(2)
    v_mfma_f32_16x16x32_bf16 v[108:111], a[48:51], v[84:87], v[108:111]
    ds_read_b128 v[100:103], v11 offset:28672
    v_mfma_f32_16x16x32_bf16 v[112:115], a[48:51], v[88:91], v[112:115]
    ds_read_b128 v[104:107], v11 offset:30720
    v_mfma_f32_16x16x32_bf16 v[116:119], a[128:131], v[84:87], v[116:119]
    buffer_load_dwordx4 v10, s[24:27], s46 offen offset:512 lds
    s_add_u32 m0, m0, 3968
    v_mfma_f32_16x16x32_bf16 v[120:123], a[128:131], v[88:91], v[120:123]
    s_waitcnt lgkmcnt(2)
    v_mfma_f32_16x16x32_bf16 v[108:111], a[52:55], v[92:95], v[108:111]
    ds_read_b128 v[84:87], v12 offset:28672
    v_mfma_f32_16x16x32_bf16 v[112:115], a[52:55], v[96:99], v[112:115]
    ds_read_b128 v[88:91], v12 offset:30720
    v_mfma_f32_16x16x32_bf16 v[116:119], a[132:135], v[92:95], v[116:119]
    buffer_load_dwordx4 v10, s[24:27], s46 offen offset:640 lds
    s_add_u32 m0, m0, 3968
    v_mfma_f32_16x16x32_bf16 v[120:123], a[132:135], v[96:99], v[120:123]
    s_waitcnt lgkmcnt(2)
    v_mfma_f32_16x16x32_bf16 v[108:111], a[56:59], v[100:103], v[108:111]
    ds_read_b128 v[92:95], v11 offset:32768
    v_mfma_f32_16x16x32_bf16 v[112:115], a[56:59], v[104:107], v[112:115]
    ds_read_b128 v[96:99], v11 offset:34816
    v_mfma_f32_16x16x32_bf16 v[116:119], a[136:139], v[100:103], v[116:119]
    buffer_load_dwordx4 v10, s[24:27], s46 offen offset:768 lds
    s_add_u32 m0, m0, 3968
    v_mfma_f32_16x16x32_bf16 v[120:123], a[136:139], v[104:107], v[120:123]
    s_waitcnt lgkmcnt(2)
    v_mfma_f32_16x16x32_bf16 v[108:111], a[60:63], v[84:87], v[108:111]
    ds_read_b128 v[100:103], v12 offset:32768
    v_mfma_f32_16x16x32_bf16 v[112:115], a[60:63], v[88:91], v[112:115]
    ds_read_b128 v[104:107], v12 offset:34816
    v_mfma_f32_16x16x32_bf16 v[116:119], a[140:143], v[84:87], v[116:119]
    buffer_load_dwordx4 v10, s[24:27], s46 offen offset:896 lds
    s_add_u32 m0, m0, 3968
    v_mfma_f32_16x16x32_bf16 v[120:123], a[140:143], v[88:91], v[120:123]
    s_waitcnt lgkmcnt(2)
    v_mfma_f32_16x16x32_bf16 v[108:111], a[64:67], v[92:95], v[108:111]
    ds_read_b128 v[84:87], v11 offset:36864
    v_mfma_f32_16x16x32_bf16 v[112:115], a[64:67], v[96:99], v[112:115]
    ds_read_b128 v[88:91], v11 offset:38912
    v_mfma_f32_16x16x32_bf16 v[116:119], a[144:147], v[92:95], v[116:119]
    buffer_load_dwordx4 v10, s[24:27], s46 offen offset:1024 lds
    s_add_u32 m0, m0, 3968
    v_mfma_f32_16x16x32_bf16 v[120:123], a[144:147], v[96:99], v[120:123]
    s_waitcnt lgkmcnt(2)
    v_mfma_f32_16x16x32_bf16 v[108:111], a[68:71], v[100:103], v[108:111]
    ds_read_b128 v[92:95], v12 offset:36864
    v_mfma_f32_16x16x32_bf16 v[112:115], a[68:71], v[104:107], v[112:115]
    ds_read_b128 v[96:99], v12 offset:38912
    v_mfma_f32_16x16x32_bf16 v[116:119], a[148:151], v[100:103], v[116:119]
    buffer_load_dwordx4 v10, s[24:27], s46 offen offset:1152 lds
    v_mfma_f32_16x16x32_bf16 v[120:123], a[148:151], v[104:107], v[120:123]
    s_waitcnt lgkmcnt(0)
    v_mfma_f32_16x16x32_bf16 v[108:111], a[72:75], v[84:87], v[108:111]
    v_add_u32 v11, s49, v11
    v_mfma_f32_16x16x32_bf16 v[112:115], a[72:75], v[88:91], v[112:115]
    v_add_u32 v12, s49, v12
    v_mfma_f32_16x16x32_bf16 v[108:111], a[76:79], v[92:95], v[108:111]
    s_sub_u32 s47, s47, s49
    v_mfma_f32_16x16x32_bf16 v[112:115], a[76:79], v[96:99], v[112:115]
    s_sub_u32 s49, 0, s49
    v_mfma_f32_16x16x32_bf16 v[116:119], a[152:155], v[84:87], v[116:119]
    v_mfma_f32_16x16x32_bf16 v[120:123], a[152:155], v[88:91], v[120:123]
    v_mfma_f32_16x16x32_bf16 v[116:119], a[156:159], v[92:95], v[116:119]
    v_mfma_f32_16x16x32_bf16 v[120:123], a[156:159], v[96:99], v[120:123]
    v_cvt_pk_bf16_f32 v124, v108, v109
    v_cvt_pk_bf16_f32 v125, v110, v111
    v_cvt_pk_bf16_f32 v126, v112, v113
    v_cvt_pk_bf16_f32 v127, v114, v115
    s_nop 0
    v_permlane16_swap_b32 v124, v126
    v_permlane16_swap_b32 v125, v127
    v_cvt_pk_bf16_f32 v128, v116, v117
    v_cvt_pk_bf16_f32 v129, v118, v119
    v_cvt_pk_bf16_f32 v130, v120, v121
    v_cvt_pk_bf16_f32 v131, v122, v123
    s_nop 0
    v_permlane16_swap_b32 v128, v130
    v_permlane16_swap_b32 v129, v131
    buffer_store_dwordx4 v[124:127], v19, s[4:7], s44 offen
    buffer_store_dwordx4 v[128:131], v19, s[4:7], s45 offen
    s_waitcnt vmcnt(18)
    s_cmp_lt_i32 s60, 0
    s_cbranch_scc1 L_fin_28
    v_mfma_f32_16x16x32_bf16 v[164:167], a[160:163], v[156:159], 0
    v_mfma_f32_16x16x32_bf16 v[168:171], a[160:163], v[160:163], 0
    s_nop 4
    v_cndmask_b32 v166, v164, v165, s[58:59]
    s_nop 1
    v_cndmask_b32 v170, v168, v169, s[58:59]
    v_cndmask_b32 v167, v165, v164, s[58:59]
    v_cndmask_b32 v171, v169, v168, s[58:59]
    s_nop 0
    v_add_f32_dpp v167, v166, v167 row_ror:8 row_mask:0xf bank_mask:0xf
    v_add_f32_dpp v171, v170, v171 row_ror:8 row_mask:0xf bank_mask:0xf
    v_cvt_pk_bf16_f32 v167, v167, v167
    v_cvt_pk_bf16_f32 v171, v171, v171
    buffer_store_short v167, v145, s[28:31], s60 offen offset:0
    buffer_store_short v171, v145, s[28:31], s60 offen offset:32
L_fin_28:
    s_branch L_v_loop_f
L_end_24:
    s_cmp_lt_i32 s60, 0
    s_cselect_b32 s54, s38, s54
    buffer_load_dwordx4 v[156:159], v144, s[4:7], s54 offen offset:0 sc1
    buffer_load_dwordx4 v[160:163], v144, s[4:7], s54 offen offset:1024 sc1
    s_waitcnt vmcnt(0) lgkmcnt(0)
    s_cmp_lt_i32 s60, 0
    s_cbranch_scc1 L_fin_29
    v_mfma_f32_16x16x32_bf16 v[164:167], a[160:163], v[156:159], 0
    v_mfma_f32_16x16x32_bf16 v[168:171], a[160:163], v[160:163], 0
    s_nop 4
    v_cndmask_b32 v166, v164, v165, s[58:59]
    s_nop 1
    v_cndmask_b32 v170, v168, v169, s[58:59]
    v_cndmask_b32 v167, v165, v164, s[58:59]
    v_cndmask_b32 v171, v169, v168, s[58:59]
    s_nop 0
    v_add_f32_dpp v167, v166, v167 row_ror:8 row_mask:0xf bank_mask:0xf
    v_add_f32_dpp v171, v170, v171 row_ror:8 row_mask:0xf bank_mask:0xf
    v_cvt_pk_bf16_f32 v167, v167, v167
    v_cvt_pk_bf16_f32 v171, v171, v171
    buffer_store_short v167, v145, s[28:31], s60 offen offset:0
    buffer_store_short v171, v145, s[28:31], s60 offen offset:32
L_fin_29:
    s_waitcnt vmcnt(0)
    s_cmp_lg_u32 s55, 0
    s_cbranch_scc1 L_wb_30
    buffer_wbl2 sc1
    s_waitcnt vmcnt(0)
L_wb_30:
    s_endpgm
L_nan_22:
    s_cmp_eq_u32 s52, 1
    s_cbranch_scc1 L_cont_23
    v_lshlrev_b32 v1, 4, v0
L_nan_22r:
    s_mov_b32 s90, s41
    v_mov_b32 v2, 0
    buffer_load_dwordx4 v[28:31], v1, s[4:7], s90 offen sc1
    s_add_u32 s90, s90, 1024
    buffer_load_dwordx4 v[32:35], v1, s[4:7], s90 offen sc1
    s_add_u32 s90, s90, 1024
    buffer_load_dwordx4 v[36:39], v1, s[4:7], s90 offen sc1
    s_add_u32 s90, s90, 1024
    buffer_load_dwordx4 v[40:43], v1, s[4:7], s90 offen sc1
    s_add_u32 s90, s90, 1024
    buffer_load_dwordx4 v[44:47], v1, s[4:7], s90 offen sc1
    s_add_u32 s90, s90, 1024
    buffer_load_dwordx4 v[48:51], v1, s[4:7], s90 offen sc1
    s_add_u32 s90, s90, 1024
    buffer_load_dwordx4 v[52:55], v1, s[4:7], s90 offen sc1
    s_add_u32 s90, s90, 1024
    buffer_load_dwordx4 v[56:59], v1, s[4:7], s90 offen sc1
    s_add_u32 s90, s90, 1024
    buffer_load_dwordx4 v[60:63], v1, s[4:7], s90 offen sc1
    s_add_u32 s90, s90, 1024
    buffer_load_dwordx4 v[64:67], v1, s[4:7], s90 offen sc1
    s_add_u32 s90, s90, 1024
    s_sub_u32 s36, s36, 1
    s_cbranch_scc1 L_exit
    s_waitcnt vmcnt(0) lgkmcnt(0)
    v_max3_u32 v2, v2, v28, v29
    v_max3_u32 v2, v2, v30, v31
    v_max3_u32 v2, v2, v32, v33
    v_max3_u32 v2, v2, v34, v35
    v_max3_u32 v2, v2, v36, v37
    v_max3_u32 v2, v2, v38, v39
    v_max3_u32 v2, v2, v40, v41
    v_max3_u32 v2, v2, v42, v43
    v_max3_u32 v2, v2, v44, v45
    v_max3_u32 v2, v2, v46, v47
    v_max3_u32 v2, v2, v48, v49
    v_max3_u32 v2, v2, v50, v51
    v_max3_u32 v2, v2, v52, v53
    v_max3_u32 v2, v2, v54, v55
    v_max3_u32 v2, v2, v56, v57
    v_max3_u32 v2, v2, v58, v59
    v_max3_u32 v2, v2, v60, v61
    v_max3_u32 v2, v2, v62, v63
    v_max3_u32 v2, v2, v64, v65
    v_max3_u32 v2, v2, v66, v67
    v_cmp_eq_u32 vcc, -1, v2
    s_cbranch_vccnz L_nan_22r
    s_mov_b32 s52, 1
    v_mov_b32 v68, 0
    v_mov_b32 v69, 0
    v_mov_b32 v70, 0
    v_mov_b32 v71, 0
    v_mov_b32 v72, 0
    v_mov_b32 v73, 0
    v_mov_b32 v74, 0
    v_mov_b32 v75, 0
    v_smfmac_f32_16x16x64_bf16 v[68:71], v[28:31], a[0:7], v17
    s_nop 0
    v_smfmac_f32_16x16x64_bf16 v[72:75], v[28:31], a[80:87], v17
    v_smfmac_f32_16x16x64_bf16 v[68:71], v[32:35], a[8:15], v17
    v_smfmac_f32_16x16x64_bf16 v[72:75], v[32:35], a[88:95], v17
    v_smfmac_f32_16x16x64_bf16 v[68:71], v[36:39], a[16:23], v17
    v_smfmac_f32_16x16x64_bf16 v[72:75], v[36:39], a[96:103], v17
    v_smfmac_f32_16x16x64_bf16 v[68:71], v[40:43], a[24:31], v17
    v_smfmac_f32_16x16x64_bf16 v[72:75], v[40:43], a[104:111], v17
    v_smfmac_f32_16x16x64_bf16 v[68:71], v[44:47], a[32:39], v17
    v_smfmac_f32_16x16x64_bf16 v[72:75], v[44:47], a[112:119], v17
    v_smfmac_f32_16x16x64_bf16 v[68:71], v[48:51], a[40:47], v17
    v_smfmac_f32_16x16x64_bf16 v[68:71], v[52:55], a[48:55], v17
    v_smfmac_f32_16x16x64_bf16 v[68:71], v[56:59], a[56:63], v17
    v_smfmac_f32_16x16x64_bf16 v[68:71], v[60:63], a[64:71], v17
    v_smfmac_f32_16x16x64_bf16 v[68:71], v[64:67], a[72:79], v17
    s_nop 2
    s_branch L_redo_20
L_sd_25c:
    v_mov_b32 v3, 200
L_p0_31:
    buffer_load_dword v4, v3, s[8:11], 0 offen sc1
    s_sub_u32 s36, s36, 1
    s_cbranch_scc1 L_exit
    s_waitcnt vmcnt(0)
    v_readfirstlane_b32 s90, v4
    s_nop 0
    s_cmp_eq_u32 s90, 0
    s_cbranch_scc1 L_p0_31
    s_and_b32 s90, s90, 2
    s_lshl_b32 s90, s90, 12
    v_xor_b32 v140, s90, v140
    v_xor_b32 v141, s90, v141
    v_xor_b32 v143, s90, v143
    v_xor_b32 v144, s90, v144
    s_branch L_sd_25
L_an_26:
    s_cmp_lg_u32 s55, 0
    s_cbranch_scc1 L_an_26x
    buffer_load_dword v139, v142, s[4:7], s38 offen sc1
    buffer_load_dword v139, v142, s[4:7], s38 offen sc1
    buffer_load_dword v139, v142, s[4:7], s38 offen sc1
L_sp_32:
    buffer_load_dword v139, v142, s[4:7], s38 offen sc1
    s_sub_u32 s36, s36, 1
    s_cbranch_scc1 L_exit
    s_waitcnt vmcnt(3)
    v_cmp_ge_u32 vcc, s37, v139
    s_cbranch_vccnz L_sp_32
L_an_26x:
    s_barrier
    s_lshl_b32 s90, s32, 10
    s_add_u32 m0, s90, s47
    s_waitcnt lgkmcnt(2)
    v_mfma_f32_16x16x32_bf16 v[108:111], a[0:3], v[84:87], 0
    ds_read_b128 v[100:103], v11 offset:4096
    s_add_u32 s51, s37, 3
    v_mfma_f32_16x16x32_bf16 v[112:115], a[0:3], v[88:91], 0
    ds_read_b128 v[104:107], v11 offset:6144
    s_and_b32 s50, s51, 3
    v_mfma_f32_16x16x32_bf16 v[116:119], a[80:83], v[84:87], 0
    s_mul_i32 s50, s50, 114688
    s_add_u32 s50, s50, 65536
    v_mfma_f32_16x16x32_bf16 v[120:123], a[80:83], v[88:91], 0
    s_waitcnt lgkmcnt(2)
    s_add_u32 s44, s38, s50
    v_mfma_f32_16x16x32_bf16 v[108:111], a[4:7], v[92:95], v[108:111]
    ds_read_b128 v[84:87], v12 offset:4096
    s_add_u32 s45, s44, s56
    v_mfma_f32_16x16x32_bf16 v[112:115], a[4:7], v[96:99], v[112:115]
    ds_read_b128 v[88:91], v12 offset:6144
    s_add_u32 s37, s37, 1
    v_mfma_f32_16x16x32_bf16 v[116:119], a[84:87], v[92:95], v[116:119]
    s_mov_b32 s52, 0
    s_and_b32 s50, s37, 3
    v_mfma_f32_16x16x32_bf16 v[120:123], a[84:87], v[96:99], v[120:123]
    s_waitcnt lgkmcnt(2)
    s_mul_i32 s51, s50, 114688
    v_mfma_f32_16x16x32_bf16 v[108:111], a[8:11], v[100:103], v[108:111]
    ds_read_b128 v[92:95], v11 offset:8192
    s_add_u32 s41, s38, s51
    v_mfma_f32_16x16x32_bf16 v[112:115], a[8:11], v[104:107], v[112:115]
    ds_read_b128 v[96:99], v11 offset:10240
    v_mfma_f32_16x16x32_bf16 v[116:119], a[88:91], v[100:103], v[116:119]
    v_mfma_f32_16x16x32_bf16 v[120:123], a[88:91], v[104:107], v[120:123]
    s_waitcnt lgkmcnt(2)
    v_mfma_f32_16x16x32_bf16 v[108:111], a[12:15], v[84:87], v[108:111]
    ds_read_b128 v[100:103], v12 offset:8192
    v_mfma_f32_16x16x32_bf16 v[112:115], a[12:15], v[88:91], v[112:115]
    ds_read_b128 v[104:107], v12 offset:10240
    v_mfma_f32_16x16x32_bf16 v[116:119], a[92:95], v[84:87], v[116:119]
    v_mfma_f32_16x16x32_bf16 v[120:123], a[92:95], v[88:91], v[120:123]
    buffer_store_dword v20, v140, s[4:7], 0 offen sc1
    s_waitcnt lgkmcnt(2)
    v_mfma_f32_16x16x32_bf16 v[108:111], a[16:19], v[92:95], v[108:111]
    ds_read_b128 v[84:87], v11 offset:12288
    v_mfma_f32_16x16x32_bf16 v[112:115], a[16:19], v[96:99], v[112:115]
    ds_read_b128 v[88:91], v11 offset:14336
    v_mfma_f32_16x16x32_bf16 v[116:119], a[96:99], v[92:95], v[116:119]
    v_mfma_f32_16x16x32_bf16 v[120:123], a[96:99], v[96:99], v[120:123]
    buffer_store_dword v20, v141, s[4:7], 0 offen sc1
    s_waitcnt lgkmcnt(2)
    v_mfma_f32_16x16x32_bf16 v[108:111], a[20:23], v[100:103], v[108:111]
    ds_read_b128 v[92:95], v12 offset:12288
    v_mfma_f32_16x16x32_bf16 v[112:115], a[20:23], v[104:107], v[112:115]
    ds_read_b128 v[96:99], v12 offset:14336
    v_mfma_f32_16x16x32_bf16 v[116:119], a[100:103], v[100:103], v[116:119]
    v_mfma_f32_16x16x32_bf16 v[120:123], a[100:103], v[104:107], v[120:123]
    s_waitcnt lgkmcnt(2)
    v_mfma_f32_16x16x32_bf16 v[108:111], a[24:27], v[84:87], v[108:111]
    ds_read_b128 v[100:103], v11 offset:16384
    v_mfma_f32_16x16x32_bf16 v[112:115], a[24:27], v[88:91], v[112:115]
    ds_read_b128 v[104:107], v11 offset:18432
    v_mfma_f32_16x16x32_bf16 v[116:119], a[104:107], v[84:87], v[116:119]
    v_mfma_f32_16x16x32_bf16 v[120:123], a[104:107], v[88:91], v[120:123]
    s_waitcnt lgkmcnt(2)
    v_mfma_f32_16x16x32_bf16 v[108:111], a[28:31], v[92:95], v[108:111]
    ds_read_b128 v[84:87], v12 offset:16384
    v_mfma_f32_16x16x32_bf16 v[112:115], a[28:31], v[96:99], v[112:115]
    ds_read_b128 v[88:91], v12 offset:18432
    v_mfma_f32_16x16x32_bf16 v[116:119], a[108:111], v[92:95], v[116:119]
    v_mfma_f32_16x16x32_bf16 v[120:123], a[108:111], v[96:99], v[120:123]
    s_waitcnt lgkmcnt(2)
    v_mfma_f32_16x16x32_bf16 v[108:111], a[32:35], v[100:103], v[108:111]
    ds_read_b128 v[92:95], v11 offset:20480
    v_mfma_f32_16x16x32_bf16 v[112:115], a[32:35], v[104:107], v[112:115]
    ds_read_b128 v[96:99], v11 offset:22528
    v_mfma_f32_16x16x32_bf16 v[116:119], a[112:115], v[100:103], v[116:119]
    v_mfma_f32_16x16x32_bf16 v[120:123], a[112:115], v[104:107], v[120:123]
    s_waitcnt lgkmcnt(2)
    v_mfma_f32_16x16x32_bf16 v[108:111], a[36:39], v[84:87], v[108:111]
    ds_read_b128 v[100:103], v12 offset:20480
    v_mfma_f32_16x16x32_bf16 v[112:115], a[36:39], v[88:91], v[112:115]
    ds_read_b128 v[104:107], v12 offset:22528
    v_mfma_f32_16x16x32_bf16 v[116:119], a[116:119], v[84:87], v[116:119]
    v_mfma_f32_16x16x32_bf16 v[120:123], a[116:119], v[88:91], v[120:123]
    s_waitcnt lgkmcnt(2)
    v_mfma_f32_16x16x32_bf16 v[108:111], a[40:43], v[92:95], v[108:111]
    ds_read_b128 v[84:87], v11 offset:24576
    v_mfma_f32_16x16x32_bf16 v[112:115], a[40:43], v[96:99], v[112:115]
    ds_read_b128 v[88:91], v11 offset:26624
    v_mfma_f32_16x16x32_bf16 v[116:119], a[120:123], v[92:95], v[116:119]
    v_mfma_f32_16x16x32_bf16 v[120:123], a[120:123], v[96:99], v[120:123]
    s_waitcnt lgkmcnt(2)
    v_mfma_f32_16x16x32_bf16 v[108:111], a[44:47], v[100:103], v[108:111]
    ds_read_b128 v[92:95], v12 offset:24576
    v_mfma_f32_16x16x32_bf16 v[112:115], a[44:47], v[104:107], v[112:115]
    ds_read_b128 v[96:99], v12 offset:26624
    v_mfma_f32_16x16x32_bf16 v[116:119], a[124:127], v[100:103], v[116:119]
    v_mfma_f32_16x16x32_bf16 v[120:123], a[124:127], v[104:107], v[120:123]
    s_waitcnt lgkmcnt(2)
    v_mfma_f32_16x16x32_bf16 v[108:111], a[48:51], v[84:87], v[108:111]
    ds_read_b128 v[100:103], v11 offset:28672
    v_mfma_f32_16x16x32_bf16 v[112:115], a[48:51], v[88:91], v[112:115]
    ds_read_b128 v[104:107], v11 offset:30720
    v_mfma_f32_16x16x32_bf16 v[116:119], a[128:131], v[84:87], v[116:119]
    buffer_store_dword v20, v147, s[4:7], s38 offen
    buffer_store_dword v22, v135, s[4:7], s42 offen offset:0
    buffer_store_dword v22, v135, s[4:7], s42 offen offset:1024
    v_mfma_f32_16x16x32_bf16 v[120:123], a[128:131], v[88:91], v[120:123]
    s_waitcnt lgkmcnt(2)
    v_mfma_f32_16x16x32_bf16 v[108:111], a[52:55], v[92:95], v[108:111]
    ds_read_b128 v[84:87], v12 offset:28672
    v_mfma_f32_16x16x32_bf16 v[112:115], a[52:55], v[96:99], v[112:115]
    ds_read_b128 v[88:91], v12 offset:30720
    v_mfma_f32_16x16x32_bf16 v[116:119], a[132:135], v[92:95], v[116:119]
    buffer_load_dwordx4 v10, s[24:27], s46 offen offset:0 lds
    s_add_u32 m0, m0, 3968
    v_mfma_f32_16x16x32_bf16 v[120:123], a[132:135], v[96:99], v[120:123]
    s_waitcnt lgkmcnt(2)
    v_mfma_f32_16x16x32_bf16 v[108:111], a[56:59], v[100:103], v[108:111]
    ds_read_b128 v[92:95], v11 offset:32768
    v_mfma_f32_16x16x32_bf16 v[112:115], a[56:59], v[104:107], v[112:115]
    ds_read_b128 v[96:99], v11 offset:34816
    v_mfma_f32_16x16x32_bf16 v[116:119], a[136:139], v[100:103], v[116:119]
    buffer_load_dwordx4 v10, s[24:27], s46 offen offset:128 lds
    s_add_u32 m0, m0, 3968
    v_mfma_f32_16x16x32_bf16 v[120:123], a[136:139], v[104:107], v[120:123]
    s_waitcnt lgkmcnt(2)
    v_mfma_f32_16x16x32_bf16 v[108:111], a[60:63], v[84:87], v[108:111]
    ds_read_b128 v[100:103], v12 offset:32768
    v_mfma_f32_16x16x32_bf16 v[112:115], a[60:63], v[88:91], v[112:115]
    ds_read_b128 v[104:107], v12 offset:34816
    v_mfma_f32_16x16x32_bf16 v[116:119], a[140:143], v[84:87], v[116:119]
    buffer_load_dwordx4 v10, s[24:27], s46 offen offset:256 lds
    s_add_u32 m0, m0, 3968
    v_mfma_f32_16x16x32_bf16 v[120:123], a[140:143], v[88:91], v[120:123]
    s_waitcnt lgkmcnt(2)
    v_mfma_f32_16x16x32_bf16 v[108:111], a[64:67], v[92:95], v[108:111]
    ds_read_b128 v[84:87], v11 offset:36864
    v_mfma_f32_16x16x32_bf16 v[112:115], a[64:67], v[96:99], v[112:115]
    ds_read_b128 v[88:91], v11 offset:38912
    v_mfma_f32_16x16x32_bf16 v[116:119], a[144:147], v[92:95], v[116:119]
    buffer_load_dwordx4 v10, s[24:27], s46 offen offset:384 lds
    s_add_u32 m0, m0, 3968
    v_mfma_f32_16x16x32_bf16 v[120:123], a[144:147], v[96:99], v[120:123]
    s_waitcnt lgkmcnt(2)
    v_mfma_f32_16x16x32_bf16 v[108:111], a[68:71], v[100:103], v[108:111]
    ds_read_b128 v[92:95], v12 offset:36864
    v_mfma_f32_16x16x32_bf16 v[112:115], a[68:71], v[104:107], v[112:115]
    ds_read_b128 v[96:99], v12 offset:38912
    v_mfma_f32_16x16x32_bf16 v[116:119], a[148:151], v[100:103], v[116:119]
    buffer_load_dwordx4 v10, s[24:27], s46 offen offset:512 lds
    s_add_u32 m0, m0, 3968
    v_mfma_f32_16x16x32_bf16 v[120:123], a[148:151], v[104:107], v[120:123]
    s_waitcnt lgkmcnt(0)
    buffer_load_dwordx4 v10, s[24:27], s46 offen offset:640 lds
    s_add_u32 m0, m0, 3968
    s_nop 0
    buffer_load_dwordx4 v10, s[24:27], s46 offen offset:768 lds
    s_add_u32 m0, m0, 3968
    s_nop 0
    buffer_load_dwordx4 v10, s[24:27], s46 offen offset:896 lds
    s_add_u32 m0, m0, 3968
    s_nop 0
    buffer_load_dwordx4 v10, s[24:27], s46 offen offset:1024 lds
    s_add_u32 m0, m0, 3968
    s_nop 0
    buffer_load_dwordx4 v10, s[24:27], s46 offen offset:1152 lds
    v_mfma_f32_16x16x32_bf16 v[108:111], a[72:75], v[84:87], v[108:111]
    v_add_u32 v11, s49, v11
    v_mfma_f32_16x16x32_bf16 v[112:115], a[72:75], v[88:91], v[112:115]
    v_add_u32 v12, s49, v12
    v_mfma_f32_16x16x32_bf16 v[108:111], a[76:79], v[92:95], v[108:111]
    s_sub_u32 s47, s47, s49
    v_mfma_f32_16x16x32_bf16 v[112:115], a[76:79], v[96:99], v[112:115]
    s_sub_u32 s49, 0, s49
    v_mfma_f32_16x16x32_bf16 v[116:119], a[152:155], v[84:87], v[116:119]
    v_mfma_f32_16x16x32_bf16 v[120:123], a[152:155], v[88:91], v[120:123]
    v_mfma_f32_16x16x32_bf16 v[116:119], a[156:159], v[92:95], v[116:119]
    v_mfma_f32_16x16x32_bf16 v[120:123], a[156:159], v[96:99], v[120:123]
    v_cvt_pk_bf16_f32 v124, v108, v109
    v_cvt_pk_bf16_f32 v125, v110, v111
    v_cvt_pk_bf16_f32 v126, v112, v113
    v_cvt_pk_bf16_f32 v127, v114, v115
    s_nop 0
    v_permlane16_swap_b32 v124, v126
    v_permlane16_swap_b32 v125, v127
    v_cvt_pk_bf16_f32 v128, v116, v117
    v_cvt_pk_bf16_f32 v129, v118, v119
    v_cvt_pk_bf16_f32 v130, v120, v121
    v_cvt_pk_bf16_f32 v131, v122, v123
    s_nop 0
    v_permlane16_swap_b32 v128, v130
    v_permlane16_swap_b32 v129, v131
    buffer_store_dwordx4 v[124:127], v19, s[4:7], s44 offen
    buffer_store_dwordx4 v[128:131], v19, s[4:7], s45 offen
    s_branch L_v_loop_f
L_fw_27c:
    v_mov_b32 v148, -1
    v_mov_b32 v149, -1
    v_mov_b32 v150, -1
    v_mov_b32 v151, -1
    v_mov_b32 v152, -1
    v_mov_b32 v153, -1
    v_mov_b32 v154, -1
    v_mov_b32 v155, -1
    s_add_u32 s53, s53, 2293760
    buffer_store_dwordx4 v[148:151], v143, s[4:7], s53 offen offset:0 sc1
    buffer_store_dwordx4 v[152:155], v143, s[4:7], s53 offen offset:1024 sc1
    s_sub_u32 s53, s53, 983040
    s_branch L_fw_27
L_wo_f:
    s_mov_b32 s12, s80
    s_and_b32 s13, s81, 0xffff
    s_mov_b32 s14, 7864320
    s_mov_b32 s15, 0x20000
    s_mov_b32 s16, s72
    s_and_b32 s17, s73, 0xffff
    s_mov_b32 s18, 10240
    s_mov_b32 s19, 0x20000
    s_sub_u32 s40, s35, 18
    v_and_b32 v1, 15, v0
    v_lshrrev_b32 v2, 4, v0
    v_lshrrev_b32 v3, 3, v0
    v_and_b32 v4, 7, v0
    v_and_b32 v6, 2, v3
    v_xor_b32 v6, v6, v4
    v_lshlrev_b32 v6, 4, v6
    v_mul_u32_u24 v7, 1280, v3
    s_lshl_b32 s90, s34, 2
    s_add_u32 s90, s90, s32
    s_mul_i32 s90, s90, 245760
    s_lshl_b32 s91, s40, 7
    s_add_u32 s90, s90, s91
    v_add3_u32 v180, v6, v7, s90
    v_xor_b32 v181, 64, v180
    s_mul_i32 s90, s40, 32768
    s_lshl_b32 s91, s32, 11
    s_add_u32 s90, s90, s91
    s_lshl_b32 s91, s34, 8
    s_add_u32 s90, s90, s91
    v_and_b32 v7, 7, v1
    v_lshlrev_b32 v7, 3, v7
    v_lshl_add_u32 v7, v2, 6, v7
    v_lshrrev_b32 v6, 3, v1
    v_lshl_add_u32 v7, v6, 13, v7
    v_add_u32 v14, s90, v7
    v_lshlrev_b32 v6, 4, v1
    v_lshlrev_b32 v12, 4, v0
    v_lshlrev_b32 v13, 2, v0
    v_add_u32 v46, s90, v13
    s_lshl_b32 s92, s40, 7
    s_lshl_b32 s93, s32, 2
    s_add_u32 s92, s92, s93
    s_add_u32 s92, s92, 460800
    v_mov_b32 v244, s92
    v_cmp_eq_u32 vcc, 0, v0
    v_mov_b32 v9, 2146435072
    s_nop 0
    v_cndmask_b32 v244, v9, v244, vcc
    s_lshl_b32 s92, s40, 4
    s_add_u32 s92, s92, s93
    s_add_u32 s92, s92, 460544
    v_mov_b32 v45, s92
    v_cndmask_b32 v45, v9, v45, vcc
    s_lshl_b32 s92, s32, 7
    s_add_u32 s92, s92, 462336
    v_min_u32 v3, 5, v0
    v_lshl_add_u32 v245, v3, 2, s92
    s_lshl_b32 s90, s40, 2
    s_add_u32 s90, s90, s32
    s_lshl_b32 s91, s90, 8
    v_add_u32 v17, s91, v6
    v_cmp_eq_u32 vcc, 0, v2
    v_mov_b32 v9, 2146435072
    s_nop 0
    v_cndmask_b32 v17, v9, v17, vcc
    v_lshrrev_b32 v3, 2, v1
    v_and_b32 v7, 1, v1
    v_lshl_or_b32 v4, v3, 1, v7
    v_mul_u32_u24 v4, 1280, v4
    v_and_b32 v5, 2, v1
    v_lshl_add_u32 v4, v5, 1, v4
    s_lshl_b32 s91, s90, 5
    v_add_u32 v4, s91, v4
    v_lshlrev_b32 v6, 6, v3
    v_lshl_add_u32 v6, v7, 5, v6
    v_lshl_add_u32 v6, v2, 3, v6
    v_lshl_add_u32 v6, v5, 1, v6
    s_mul_i32 s92, s32, 1152
    s_add_u32 s92, s92, 122880
    v_add_u32 v18, s92, v6
    buffer_load_dword v164, v4, s[16:19], 0 offen offset:0
    buffer_load_dword v165, v4, s[16:19], 0 offen offset:8
    buffer_load_dword v166, v4, s[16:19], 0 offen offset:16
    buffer_load_dword v167, v4, s[16:19], 0 offen offset:24
    v_mov_b32 v168, -1
    v_mov_b32 v169, -1
    v_mov_b32 v170, -1
    v_mov_b32 v171, -1
    s_mul_i32 s90, s32, 24576
    s_mov_b32 m0, s90
    s_mov_b32 s91, 0
    buffer_load_dwordx4 v180, s[12:15], s91 offen nt lds
    s_add_u32 m0, m0, 1024
    s_add_u32 s91, s91, 10240
    buffer_load_dwordx4 v181, s[12:15], s91 offen nt lds
    s_add_u32 m0, m0, 1024
    s_add_u32 s91, s91, 10240
    buffer_load_dwordx4 v180, s[12:15], s91 offen nt lds
    s_add_u32 m0, m0, 1024
    s_add_u32 s91, s91, 10240
    buffer_load_dwordx4 v181, s[12:15], s91 offen nt lds
    s_add_u32 m0, m0, 1024
    s_add_u32 s91, s91, 10240
    buffer_load_dwordx4 v180, s[12:15], s91 offen nt lds
    s_add_u32 m0, m0, 1024
    s_add_u32 s91, s91, 10240
    buffer_load_dwordx4 v181, s[12:15], s91 offen nt lds
    s_add_u32 m0, m0, 1024
    s_add_u32 s91, s91, 10240
    buffer_load_dwordx4 v180, s[12:15], s91 offen nt lds
    s_add_u32 m0, m0, 1024
    s_add_u32 s91, s91, 10240
    buffer_load_dwordx4 v181, s[12:15], s91 offen nt lds
    s_add_u32 m0, m0, 1024
    s_add_u32 s91, s91, 10240
    buffer_load_dwordx4 v180, s[12:15], s91 offen nt lds
    s_add_u32 m0, m0, 1024
    s_add_u32 s91, s91, 10240
    buffer_load_dwordx4 v181, s[12:15], s91 offen nt lds
    s_add_u32 m0, m0, 1024
    s_add_u32 s91, s91, 10240
    buffer_load_dwordx4 v180, s[12:15], s91 offen nt lds
    s_add_u32 m0, m0, 1024
    s_add_u32 s91, s91, 10240
    buffer_load_dwordx4 v181, s[12:15], s91 offen nt lds
    s_add_u32 m0, m0, 1024
    s_add_u32 s91, s91, 10240
    buffer_load_dwordx4 v180, s[12:15], s91 offen nt lds
    s_add_u32 m0, m0, 1024
    s_add_u32 s91, s91, 10240
    buffer_load_dwordx4 v181, s[12:15], s91 offen nt lds
    s_add_u32 m0, m0, 1024
    s_add_u32 s91, s91, 10240
    buffer_load_dwordx4 v180, s[12:15], s91 offen nt lds
    s_add_u32 m0, m0, 1024
    s_add_u32 s91, s91, 10240
    buffer_load_dwordx4 v181, s[12:15], s91 offen nt lds
    s_add_u32 m0, m0, 1024
    s_add_u32 s91, s91, 10240
    buffer_load_dwordx4 v180, s[12:15], s91 offen nt lds
    s_add_u32 m0, m0, 1024
    s_add_u32 s91, s91, 10240
    buffer_load_dwordx4 v181, s[12:15], s91 offen nt lds
    s_add_u32 m0, m0, 1024
    s_add_u32 s91, s91, 10240
    buffer_load_dwordx4 v180, s[12:15], s91 offen nt lds
    s_add_u32 m0, m0, 1024
    s_add_u32 s91, s91, 10240
    buffer_load_dwordx4 v181, s[12:15], s91 offen nt lds
    s_add_u32 m0, m0, 1024
    s_add_u32 s91, s91, 10240
    buffer_load_dwordx4 v180, s[12:15], s91 offen nt lds
    s_add_u32 m0, m0, 1024
    s_add_u32 s91, s91, 10240
    buffer_load_dwordx4 v181, s[12:15], s91 offen nt lds
    s_add_u32 m0, m0, 1024
    s_add_u32 s91, s91, 10240
    buffer_load_dwordx4 v180, s[12:15], s91 offen nt lds
    s_add_u32 m0, m0, 1024
    s_add_u32 s91, s91, 10240
    buffer_load_dwordx4 v181, s[12:15], s91 offen nt lds
    s_waitcnt vmcnt(24)
    v_min_u32 v164, -2, v164
    v_min_u32 v165, -2, v165
    v_min_u32 v166, -2, v166
    v_min_u32 v167, -2, v167
    v_and_b32 v7, 2, v1
    v_cmp_ne_u32 vcc, 0, v7
    v_mov_b32 v5, 0x4444
    v_mov_b32 v6, 0xeeee
    v_cndmask_b32 v10, v5, v6, vcc
    v_mov_b32 v5, 0xe484
    v_mov_b32 v6, 0xee9e
    v_cndmask_b32 v7, v5, v6, vcc
    v_mov_b32 v5, 0x84e4
    v_mov_b32 v6, 0x9eee
    v_cndmask_b32 v8, v5, v6, vcc
    v_cmp_gt_u32 vcc, 2, v2
    s_nop 1
    v_cndmask_b32 v11, v8, v7, vcc
    v_mov_b32 v84, 1065369472
    v_mov_b32 v85, 1065369472
    v_mov_b32 v86, 1065369472
    v_mov_b32 v87, 0
    v_mov_b32 v88, 1065369472
    v_mov_b32 v89, 1065369472
    v_mov_b32 v90, 1065369472
    v_mov_b32 v91, 0
    v_mov_b32 v51, 0
    v_mov_b32 v55, 0
    v_mov_b32 v59, 0
    v_mov_b32 v63, 0
    v_mov_b32 v67, 0
    v_mov_b32 v71, 0
    v_mov_b32 v75, 0
    v_mov_b32 v79, 0
    v_mov_b32 v210, 0
    v_mov_b32 v211, 0
    v_mov_b32 v218, 0
    v_mov_b32 v219, 0
    v_lshrrev_b32 v8, 1, v1
    v_and_b32 v7, 2, v8
    v_cmp_ne_u32 vcc, 0, v7
    v_mov_b32 v5, 0x3f80
    v_mov_b32 v6, 0x3f800000
    v_cndmask_b32 v5, v5, v6, vcc
    v_bfe_u32 v6, v8, 2, 1
    v_and_b32 v7, 1, v8
    v_lshl_or_b32 v6, v7, 1, v6
    v_cmp_eq_u32 vcc, 0, v6
    s_nop 1
    v_cndmask_b32 v108, 0, v5, vcc
    v_cmp_eq_u32 vcc, 1, v6
    s_nop 1
    v_cndmask_b32 v109, 0, v5, vcc
    v_cmp_eq_u32 vcc, 2, v6
    s_nop 1
    v_cndmask_b32 v110, 0, v5, vcc
    v_cmp_eq_u32 vcc, 3, v6
    s_nop 1
    v_cndmask_b32 v111, 0, v5, vcc
    s_mov_b32 s60, 0xaaaaaaaa
    s_mov_b32 s61, 0xaaaaaaaa
    v_add_u32 v14, 8192, v46
    v_mov_b32 v240, 0x3dd53b95
    v_mov_b32 v241, 0x3dd53b95
    s_lshl_b32 s90, s32, 8
    s_add_u32 s90, s90, 122880
    v_mul_u32_u24 v6, 1152, v2
    v_lshl_add_u32 v6, v1, 3, v6
    v_add_u32 v19, s90, v6
    s_mul_i32 s90, s32, 1536
    v_add_u32 v20, s90, v12
    s_add_u32 s90, s90, 1024
    v_lshl_add_u32 v21, v0, 3, s90
    s_mul_i32 s90, s32, 6144
    v_add_u32 v22, s90, v12
    s_add_u32 s90, s90, 1024
    v_lshl_add_u32 v23, v0, 3, s90
    v_add_u32 v28, 98304, v12
    s_mul_i32 s90, s32, 3072
    v_add_u32 v37, s90, v12
    v_add_u32 v44, 25600, v37
    s_add_u32 s54, s90, 98304
    s_mul_i32 s90, s32, 3840
    s_add_u32 s90, s90, 10240
    v_add_u32 v38, s90, v12
    s_add_u32 s90, s90, 1024
    v_add_u32 v39, s90, v13
    s_mul_i32 s90, s32, 12288
    v_add_u32 v40, s90, v12
    s_lshl_b32 s93, s40, 2
    s_add_u32 s93, s93, s32
    s_nop 0
    s_lshr_b32 s90, s93, 2
    s_lshl_b32 s90, s90, 15
    s_and_b32 s92, s93, 3
    s_lshl_b32 s92, s92, 10
    s_add_u32 s90, s90, s92
    v_mov_b32 v5, s34
    v_and_b32 v6, 7, v1
    v_lshlrev_b32 v6, 4, v6
    v_lshl_add_u32 v6, v5, 7, v6
    v_lshrrev_b32 v7, 3, v1
    v_lshl_add_u32 v6, v7, 12, v6
    v_lshrrev_b32 v5, 1, v2
    v_lshl_add_u32 v6, v5, 13, v6
    v_and_b32 v5, 1, v2
    v_lshl_add_u32 v6, v5, 14, v6
    v_add_u32 v30, s90, v6
    s_and_b32 s91, s34, 1
    s_lshl_b32 s91, s91, 12
    s_add_u32 s90, s90, s91
    s_lshr_b32 s91, s34, 2
    s_lshl_b32 s91, s91, 13
    s_add_u32 s90, s90, s91
    s_and_b32 s91, s34, 2
    s_lshl_b32 s91, s91, 13
    s_add_u32 s90, s90, s91
    v_lshl_add_u32 v31, v0, 4, s90
    s_lshl_b32 s91, s93, 10
    s_add_u32 s91, s91, 884736
    v_lshl_add_u32 v15, v0, 4, s91
    s_lshr_b32 s91, s34, 1
    s_mul_i32 s91, s91, 10240
    s_lshl_b32 s92, s93, 5
    s_add_u32 s91, s91, s92
    s_and_b32 s92, s34, 1
    s_mul_i32 s92, s92, 40960
    s_add_u32 s91, s91, s92
    s_add_u32 s91, s91, 1280
    v_mul_u32_u24 v6, 2560, v2
    v_lshl_add_u32 v6, v1, 1, v6
    v_add_u32 v32, s91, v6
    v_cmp_gt_u32 s[58:59], 8, v1
    v_and_b32 v5, 1, v1
    v_lshrrev_b32 v6, 3, v1
    v_lshl_add_u32 v5, v5, 1, v6
    v_bfe_u32 v6, v1, 2, 1
    v_cmp_ne_u32 vcc, 0, v6
    v_mov_b32 v6, 0x3f80
    v_mov_b32 v7, 0x3f800000
    v_cndmask_b32 v6, v6, v7, vcc
    v_cmp_eq_u32 vcc, 0, v5
    s_nop 1
    v_cndmask_b32 v7, 0, v6, vcc
    v_accvgpr_write_b32 a144, v7
    v_cmp_eq_u32 vcc, 1, v5
    s_nop 1
    v_cndmask_b32 v7, 0, v6, vcc
    v_accvgpr_write_b32 a145, v7
    v_cmp_eq_u32 vcc, 2, v5
    s_nop 1
    v_cndmask_b32 v7, 0, v6, vcc
    v_accvgpr_write_b32 a146, v7
    v_cmp_eq_u32 vcc, 3, v5
    s_nop 1
    v_cndmask_b32 v7, 0, v6, vcc
    v_accvgpr_write_b32 a147, v7
    s_lshl_b32 s90, s32, 7
    v_add_u32 v5, s90, v13
    v_add_u32 v6, 458752, v5
    v_add_u32 v7, 459728, v5
    v_cmp_gt_u32 vcc, 12, v0
    s_nop 1
    v_cndmask_b32 v33, v7, v6, vcc
    v_mov_b32 v5, -2
    v_cndmask_b32 v34, v5, 3, vcc
    v_cmp_gt_u32 vcc, 14, v0
    v_mov_b32 v9, 2146435072
    s_nop 0
    v_cndmask_b32 v33, v9, v33, vcc
    v_mov_b32 v5, -1000
    v_cndmask_b32 v34, v5, v34, vcc
    v_and_b32 v4, 3, v1
    v_lshlrev_b32 v6, 6, v4
    v_lshl_add_u32 v6, v3, 3, v6
    v_lshl_add_u32 v6, v2, 8, v6
    v_and_b32 v5, 1, v2
    v_lshl_add_u32 v6, v5, 5, v6
    s_mul_i32 s90, s32, 3072
    s_add_u32 s53, s90, 131072
    v_add_u32 v16, s53, v6
    v_xor_b32 v13, 32, v16
    v_and_b32 v4, 3, v1
    v_and_b32 v5, 1, v2
    v_lshl_add_u32 v6, v2, 3, v3
    v_lshlrev_b32 v6, 7, v6
    v_and_b32 v7, 2, v3
    v_lshl_or_b32 v7, v5, 2, v7
    v_lshrrev_b32 v8, 1, v4
    v_xor_b32 v7, v7, v8
    v_lshl_add_u32 v6, v7, 4, v6
    v_and_b32 v7, 1, v4
    v_lshl_add_u32 v6, v7, 3, v6
    s_mul_i32 s90, s32, 24576
    v_add_u32 v6, s90, v6
    v_xor_b32 v182, 0, v6
    v_xor_b32 v183, 32, v6
    v_xor_b32 v184, 64, v6
    v_xor_b32 v185, 96, v6
    s_waitcnt vmcnt(0)
    ds_read_b64_tr_b16 a[0:1], v182 offset:0
    ds_read_b64_tr_b16 a[2:3], v182 offset:512
    ds_read_b64_tr_b16 a[4:5], v182 offset:4096
    ds_read_b64_tr_b16 a[6:7], v182 offset:4608
    ds_read_b64_tr_b16 a[8:9], v182 offset:8192
    ds_read_b64_tr_b16 a[10:11], v182 offset:8704
    ds_read_b64_tr_b16 a[12:13], v182 offset:12288
    ds_read_b64_tr_b16 a[14:15], v182 offset:12800
    ds_read_b64_tr_b16 a[16:17], v182 offset:16384
    ds_read_b64_tr_b16 a[18:19], v182 offset:16896
    ds_read_b64_tr_b16 a[20:21], v182 offset:20480
    ds_read_b64_tr_b16 a[22:23], v182 offset:20992
    ds_read_b64_tr_b16 a[24:25], v183 offset:0
    ds_read_b64_tr_b16 a[26:27], v183 offset:512
    ds_read_b64_tr_b16 a[28:29], v183 offset:4096
    ds_read_b64_tr_b16 a[30:31], v183 offset:4608
    ds_read_b64_tr_b16 a[32:33], v183 offset:8192
    ds_read_b64_tr_b16 a[34:35], v183 offset:8704
    ds_read_b64_tr_b16 a[36:37], v183 offset:12288
    ds_read_b64_tr_b16 a[38:39], v183 offset:12800
    ds_read_b64_tr_b16 a[40:41], v183 offset:16384
    ds_read_b64_tr_b16 a[42:43], v183 offset:16896
    ds_read_b64_tr_b16 a[44:45], v183 offset:20480
    ds_read_b64_tr_b16 a[46:47], v183 offset:20992
    ds_read_b64_tr_b16 a[48:49], v184 offset:0
    ds_read_b64_tr_b16 a[50:51], v184 offset:512
    ds_read_b64_tr_b16 a[52:53], v184 offset:4096
    ds_read_b64_tr_b16 a[54:55], v184 offset:4608
    ds_read_b64_tr_b16 a[56:57], v184 offset:8192
    ds_read_b64_tr_b16 a[58:59], v184 offset:8704
    ds_read_b64_tr_b16 a[60:61], v184 offset:12288
    ds_read_b64_tr_b16 a[62:63], v184 offset:12800
    ds_read_b64_tr_b16 a[64:65], v184 offset:16384
    ds_read_b64_tr_b16 a[66:67], v184 offset:16896
    ds_read_b64_tr_b16 a[68:69], v184 offset:20480
    ds_read_b64_tr_b16 a[70:71], v184 offset:20992
    ds_read_b64_tr_b16 a[72:73], v185 offset:0
    ds_read_b64_tr_b16 a[74:75], v185 offset:512
    ds_read_b64_tr_b16 a[76:77], v185 offset:4096
    ds_read_b64_tr_b16 a[78:79], v185 offset:4608
    ds_read_b64_tr_b16 a[80:81], v185 offset:8192
    ds_read_b64_tr_b16 a[82:83], v185 offset:8704
    ds_read_b64_tr_b16 a[84:85], v185 offset:12288
    ds_read_b64_tr_b16 a[86:87], v185 offset:12800
    ds_read_b64_tr_b16 a[88:89], v185 offset:16384
    ds_read_b64_tr_b16 a[90:91], v185 offset:16896
    ds_read_b64_tr_b16 a[92:93], v185 offset:20480
    ds_read_b64_tr_b16 a[94:95], v185 offset:20992
    s_waitcnt lgkmcnt(0)
    s_barrier
    v_mov_b32 v1, 192
L_gw_33:
    buffer_load_dword v2, v1, s[8:11], 0 offen sc1
    s_sub_u32 s36, s36, 1
    s_cbranch_scc1 L_exit
    s_waitcnt vmcnt(0)
L_gw_33c:
    v_readfirstlane_b32 s90, v2
    s_nop 0
    s_cmp_eq_u32 s90, 0
    s_cbranch_scc1 L_gw_33
    s_cmp_lg_u32 s90, 1
    s_cbranch_scc1 L_slow
    buffer_store_dwordx4 v[164:167], v17, s[4:7], s38 offen
    s_mov_b32 s57, -1
    s_mov_b32 s37, -1
    v_add_u32 v35, -2, v34
    s_add_u32 s45, s38, 65536
    s_add_u32 s46, s45, 4096
    s_add_u32 s47, s45, 8192
    v_mov_b32 v24, v20
    v_mov_b32 v25, v21
    buffer_load_dword v36, v33, s[4:7], s38 offen sc1
    s_waitcnt vmcnt(0)
    v_cmp_lt_i32 vcc, v36, v35
    s_cbranch_vccz L_fok_35
L_fw_34:
    buffer_load_dword v36, v33, s[4:7], s38 offen sc1
    s_sub_u32 s36, s36, 1
    s_cbranch_scc1 L_exit
    s_waitcnt vmcnt(0)
    v_cmp_lt_i32 vcc, v36, v35
    s_cbranch_vccnz L_fw_34
L_fok_35:
    buffer_load_dwordx4 a[96:99], v40, s[4:7], s45 offen offset:0 sc1
    buffer_load_dwordx4 a[100:103], v40, s[4:7], s45 offen offset:1024 sc1
    buffer_load_dwordx4 a[104:107], v40, s[4:7], s45 offen offset:2048 sc1
    buffer_load_dwordx4 a[108:111], v40, s[4:7], s45 offen offset:3072 sc1
    buffer_load_dwordx4 a[112:115], v40, s[4:7], s46 offen offset:0 sc1
    buffer_load_dwordx4 a[116:119], v40, s[4:7], s46 offen offset:1024 sc1
    buffer_load_dwordx4 a[120:123], v40, s[4:7], s46 offen offset:2048 sc1
    buffer_load_dwordx4 a[124:127], v40, s[4:7], s46 offen offset:3072 sc1
    buffer_load_dwordx4 a[128:131], v40, s[4:7], s47 offen offset:0 sc1
    buffer_load_dwordx4 a[132:135], v40, s[4:7], s47 offen offset:1024 sc1
    buffer_load_dwordx4 a[136:139], v40, s[4:7], s47 offen offset:2048 sc1
    buffer_load_dwordx4 a[140:143], v40, s[4:7], s47 offen offset:3072 sc1
    s_waitcnt vmcnt(0)
    v_mfma_f32_16x16x32_bf16 v[148:151], a[96:99], a[0:3], 0
    v_mfma_f32_16x16x32_bf16 v[152:155], a[120:123], a[0:3], 0
    v_mfma_f32_16x16x32_bf16 v[156:159], a[96:99], a[24:27], 0
    v_mfma_f32_16x16x32_bf16 v[160:163], a[120:123], a[24:27], 0
    v_mfma_f32_16x16x32_bf16 v[180:183], a[96:99], a[48:51], 0
    v_mfma_f32_16x16x32_bf16 v[184:187], a[120:123], a[48:51], 0
    v_mfma_f32_16x16x32_bf16 v[188:191], a[96:99], a[72:75], 0
    v_mfma_f32_16x16x32_bf16 v[192:195], a[120:123], a[72:75], 0
    v_mfma_f32_16x16x32_bf16 v[148:151], a[100:103], a[4:7], v[148:151]
    v_mfma_f32_16x16x32_bf16 v[152:155], a[124:127], a[4:7], v[152:155]
    v_mfma_f32_16x16x32_bf16 v[156:159], a[100:103], a[28:31], v[156:159]
    v_mfma_f32_16x16x32_bf16 v[160:163], a[124:127], a[28:31], v[160:163]
    v_mfma_f32_16x16x32_bf16 v[180:183], a[100:103], a[52:55], v[180:183]
    v_mfma_f32_16x16x32_bf16 v[184:187], a[124:127], a[52:55], v[184:187]
    v_mfma_f32_16x16x32_bf16 v[188:191], a[100:103], a[76:79], v[188:191]
    v_mfma_f32_16x16x32_bf16 v[192:195], a[124:127], a[76:79], v[192:195]
    v_mfma_f32_16x16x32_bf16 v[148:151], a[104:107], a[8:11], v[148:151]
    v_mfma_f32_16x16x32_bf16 v[152:155], a[128:131], a[8:11], v[152:155]
    v_mfma_f32_16x16x32_bf16 v[156:159], a[104:107], a[32:35], v[156:159]
    v_mfma_f32_16x16x32_bf16 v[160:163], a[128:131], a[32:35], v[160:163]
    v_mfma_f32_16x16x32_bf16 v[180:183], a[104:107], a[56:59], v[180:183]
    v_mfma_f32_16x16x32_bf16 v[184:187], a[128:131], a[56:59], v[184:187]
    v_mfma_f32_16x16x32_bf16 v[188:191], a[104:107], a[80:83], v[188:191]
    v_mfma_f32_16x16x32_bf16 v[192:195], a[128:131], a[80:83], v[192:195]
    v_mfma_f32_16x16x32_bf16 v[148:151], a[108:111], a[12:15], v[148:151]
    v_mfma_f32_16x16x32_bf16 v[152:155], a[132:135], a[12:15], v[152:155]
    v_mfma_f32_16x16x32_bf16 v[156:159], a[108:111], a[36:39], v[156:159]
    v_mfma_f32_16x16x32_bf16 v[160:163], a[132:135], a[36:39], v[160:163]
    v_mfma_f32_16x16x32_bf16 v[180:183], a[108:111], a[60:63], v[180:183]
    v_mfma_f32_16x16x32_bf16 v[184:187], a[132:135], a[60:63], v[184:187]
    v_mfma_f32_16x16x32_bf16 v[188:191], a[108:111], a[84:87], v[188:191]
    v_mfma_f32_16x16x32_bf16 v[192:195], a[132:135], a[84:87], v[192:195]
    v_mfma_f32_16x16x32_bf16 v[148:151], a[112:115], a[16:19], v[148:151]
    v_mfma_f32_16x16x32_bf16 v[152:155], a[136:139], a[16:19], v[152:155]
    v_mfma_f32_16x16x32_bf16 v[156:159], a[112:115], a[40:43], v[156:159]
    v_mfma_f32_16x16x32_bf16 v[160:163], a[136:139], a[40:43], v[160:163]
    v_mfma_f32_16x16x32_bf16 v[180:183], a[112:115], a[64:67], v[180:183]
    v_mfma_f32_16x16x32_bf16 v[184:187], a[136:139], a[64:67], v[184:187]
    v_mfma_f32_16x16x32_bf16 v[188:191], a[112:115], a[88:91], v[188:191]
    v_mfma_f32_16x16x32_bf16 v[192:195], a[136:139], a[88:91], v[192:195]
    v_mfma_f32_16x16x32_bf16 v[148:151], a[116:119], a[20:23], v[148:151]
    v_mfma_f32_16x16x32_bf16 v[152:155], a[140:143], a[20:23], v[152:155]
    v_mfma_f32_16x16x32_bf16 v[156:159], a[116:119], a[44:47], v[156:159]
    v_mfma_f32_16x16x32_bf16 v[160:163], a[140:143], a[44:47], v[160:163]
    v_mfma_f32_16x16x32_bf16 v[180:183], a[116:119], a[68:71], v[180:183]
    v_mfma_f32_16x16x32_bf16 v[184:187], a[140:143], a[68:71], v[184:187]
    v_mfma_f32_16x16x32_bf16 v[188:191], a[116:119], a[92:95], v[188:191]
    v_mfma_f32_16x16x32_bf16 v[192:195], a[140:143], a[92:95], v[192:195]
    v_cvt_pk_bf16_f32 v64, v180, v181
    v_cvt_pk_bf16_f32 v65, v182, v183
    ds_write_b64 v24, v[64:65] offset:12288
    v_cvt_pk_bf16_f32 v68, v184, v185
    v_cvt_pk_bf16_f32 v69, v186, v187
    ds_write_b64 v25, v[68:69] offset:12288
    v_cvt_pk_bf16_f32 v72, v188, v189
    v_cvt_pk_bf16_f32 v73, v190, v191
    ds_write_b64 v24, v[72:73] offset:18432
    v_cvt_pk_bf16_f32 v76, v192, v193
    v_cvt_pk_bf16_f32 v77, v194, v195
    ds_write_b64 v25, v[76:77] offset:18432
    v_cvt_pk_bf16_f32 v48, v148, v149
    v_cvt_pk_bf16_f32 v49, v150, v151
    ds_write_b64 v24, v[48:49] offset:0
    v_cvt_pk_bf16_f32 v52, v152, v153
    v_cvt_pk_bf16_f32 v53, v154, v155
    ds_write_b64 v25, v[52:53] offset:0
    v_cvt_pk_bf16_f32 v56, v156, v157
    v_cvt_pk_bf16_f32 v57, v158, v159
    ds_write_b64 v24, v[56:57] offset:6144
    v_cvt_pk_bf16_f32 v60, v160, v161
    v_cvt_pk_bf16_f32 v61, v162, v163
    ds_write_b64 v25, v[60:61] offset:6144
    s_add_u32 s56, s37, 2
    s_and_b32 s55, s56, 3
    s_mul_i32 s55, s55, 114688
    s_add_u32 s55, s55, 65536
    s_add_u32 s45, s38, s55
    s_add_u32 s46, s45, 4096
    s_add_u32 s47, s45, 8192
    s_add_u32 s56, s37, -1
    s_and_b32 s55, s56, 3
    s_mul_i32 s55, s55, 114688
    s_add_u32 s55, s55, 53248
    s_add_u32 s48, s38, s55
    s_and_b32 s55, s56, 1
    s_add_u32 s56, s56, 1
    v_mov_b32 v35, -16
    v_writelane_b32 v35, s56, 12
    s_mul_i32 s55, s55, 12288
    s_add_u32 m0, s54, s55
    v_add_u32 v35, -1, v34
    buffer_load_dword v36, v33, s[4:7], s38 offen sc1
    s_waitcnt vmcnt(0)
    v_cmp_lt_i32 vcc, v36, v35
    s_cbranch_vccz L_fok_37
L_fw_36:
    buffer_load_dword v36, v33, s[4:7], s38 offen sc1
    s_sub_u32 s36, s36, 1
    s_cbranch_scc1 L_exit
    s_waitcnt vmcnt(0)
    v_cmp_lt_i32 vcc, v36, v35
    s_cbranch_vccnz L_fw_36
L_fok_37:
    buffer_load_dwordx4 a[96:99], v40, s[4:7], s45 offen offset:0 sc1
    buffer_load_dwordx4 a[100:103], v40, s[4:7], s45 offen offset:1024 sc1
    buffer_load_dwordx4 a[104:107], v40, s[4:7], s45 offen offset:2048 sc1
    buffer_load_dwordx4 a[108:111], v40, s[4:7], s45 offen offset:3072 sc1
    buffer_load_dwordx4 a[112:115], v40, s[4:7], s46 offen offset:0 sc1
    buffer_load_dwordx4 a[116:119], v40, s[4:7], s46 offen offset:1024 sc1
    buffer_load_dwordx4 a[120:123], v40, s[4:7], s46 offen offset:2048 sc1
    buffer_load_dwordx4 a[124:127], v40, s[4:7], s46 offen offset:3072 sc1
    buffer_load_dwordx4 a[128:131], v40, s[4:7], s47 offen offset:0 sc1
    buffer_load_dwordx4 a[132:135], v40, s[4:7], s47 offen offset:1024 sc1
    buffer_load_dwordx4 a[136:139], v40, s[4:7], s47 offen offset:2048 sc1
    buffer_load_dwordx4 a[140:143], v40, s[4:7], s47 offen offset:3072 sc1
    s_mov_b32 s50, s42
    s_add_u32 s56, s37, 1
    v_mov_b32 v47, v24
    s_and_b32 s55, s56, 3
    s_mul_i32 s41, s55, 327680
    s_mul_i32 s56, s55, 114688
    s_add_u32 s43, s38, s56
    s_xor_b32 s55, s55, 2
    s_mul_i32 s42, s55, 327680
    s_add_u32 s56, s37, 2
    v_mov_b32 v107, s56
    s_and_b32 s55, s56, 3
    s_mul_i32 s44, s55, 24576
    s_add_u32 s56, s37, -1
    s_and_b32 s55, s56, 3
    s_mul_i32 s55, s55, 40960
    s_add_u32 s49, s55, s38
    s_add_u32 s56, s37, -1
    s_and_b32 s55, s56, 3
    s_mul_i32 s55, s55, 24576
    v_add_u32 v26, s55, v22
    v_add_u32 v27, s55, v23
    s_and_b32 s55, s56, 1
    s_mul_i32 s55, s55, 12288
    v_add_u32 v29, s55, v28
    s_add_u32 s37, s37, 1
    s_mov_b32 m0, s53
    v_add_u32 v24, s44, v20
    v_add_u32 v25, s44, v21
    v_pk_mul_f32 v[148:149], v[210:211], v[210:211]
    v_pk_mul_f32 v[150:151], v[210:211], v[210:211]
    v_pk_mul_f32 v[152:153], v[210:211], v[210:211]
    v_pk_mul_f32 v[154:155], v[210:211], v[210:211]
    v_pk_mul_f32 v[156:157], v[210:211], v[210:211]
    v_pk_mul_f32 v[158:159], v[210:211], v[210:211]
    v_pk_mul_f32 v[160:161], v[210:211], v[210:211]
    v_pk_mul_f32 v[162:163], v[210:211], v[210:211]
    v_mov_b32 v120, 0
    v_mov_b32 v121, 0
    v_mov_b32 v122, 0
    v_mov_b32 v123, 0
    v_mov_b32 v124, 0
    v_mov_b32 v125, 0
    v_mov_b32 v126, 0
    v_mov_b32 v127, 0
    v_mov_b32 v128, 0
    v_mov_b32 v129, 0
    v_mov_b32 v130, 0
    v_mov_b32 v131, 0
    v_mov_b32 v132, 0
    v_mov_b32 v133, 0
    v_mov_b32 v134, 0
    v_mov_b32 v135, 0
    v_mov_b32 v116, 0
    v_mov_b32 v117, 0
    v_mov_b32 v118, 0
    v_mov_b32 v119, 0
L_wo_loop_f:
    buffer_load_dword v41, v245, s[4:7], s38 offen sc1
    buffer_load_dword v41, v245, s[4:7], s38 offen sc1
    buffer_load_dword v41, v245, s[4:7], s38 offen sc1
    buffer_load_dword v41, v245, s[4:7], s38 offen sc1
    buffer_load_dword v41, v245, s[4:7], s38 offen sc1
    buffer_load_dword v41, v245, s[4:7], s38 offen sc1
L_sp_41:
    s_waitcnt vmcnt(5)
    v_cmp_ge_u32 vcc, s37, v41
    buffer_load_dword v41, v245, s[4:7], s38 offen sc1
    s_sub_u32 s36, s36, 1
    s_cbranch_scc1 L_exit
    s_cbranch_vccz L_sp_41x
    s_waitcnt vmcnt(5)
    v_cmp_ge_u32 vcc, s37, v41
    buffer_load_dword v41, v245, s[4:7], s38 offen sc1
    s_cbranch_vccz L_sp_41x
    s_waitcnt vmcnt(5)
    v_cmp_ge_u32 vcc, s37, v41
    buffer_load_dword v41, v245, s[4:7], s38 offen sc1
    s_cbranch_vccz L_sp_41x
    s_waitcnt vmcnt(5)
    v_cmp_ge_u32 vcc, s37, v41
    buffer_load_dword v41, v245, s[4:7], s38 offen sc1
    s_cbranch_vccnz L_sp_41
L_sp_41x:
    buffer_store_dword v107, v45, s[4:7], s38 offen
    buffer_load_dwordx4 v44, s[4:7], s43 offen offset:0 sc1 lds
    buffer_load_dwordx4 v44, s[4:7], s43 offen offset:1024 sc1 lds
    buffer_load_dwordx4 v44, s[4:7], s43 offen offset:2048 sc1 lds
    s_cmp_eq_u32 s37, 63
    s_cbranch_scc1 L_wo_tail_f
    s_waitcnt vmcnt(2)
    ds_read_b64_tr_b16 v[136:137], v16 offset:0
    ds_read_b64_tr_b16 v[138:139], v13 offset:0
    buffer_load_dwordx4 v[92:95], v38, s[4:7], s43 offen offset:0 sc1
    buffer_load_dwordx4 v[96:99], v38, s[4:7], s43 offen offset:1280 sc1
    buffer_load_dwordx4 v[100:103], v38, s[4:7], s43 offen offset:2560 sc1
    s_waitcnt vmcnt(4)
    ds_read_b64_tr_b16 v[140:141], v16 offset:1024
    ds_read_b64_tr_b16 v[142:143], v13 offset:1024
    s_waitcnt vmcnt(3)
    ds_read_b64_tr_b16 v[144:145], v16 offset:2048
    ds_read_b64_tr_b16 v[146:147], v13 offset:2048
    s_waitcnt lgkmcnt(4)
    v_smfmac_f32_16x16x64_bf16 v[148:151], v[136:139], a[0:7], v10
    buffer_load_dword v104, v39, s[4:7], s43 offen offset:0 sc1
    v_smfmac_f32_16x16x64_bf16 v[152:155], v[136:139], a[24:31], v10
    buffer_load_dword v105, v39, s[4:7], s43 offen offset:1280 sc1
    v_smfmac_f32_16x16x64_bf16 v[156:159], v[136:139], a[48:55], v10
    buffer_load_dword v106, v39, s[4:7], s43 offen offset:2560 sc1
    v_smfmac_f32_16x16x64_bf16 v[160:163], v[136:139], a[72:79], v10
    s_waitcnt lgkmcnt(2)
    v_smfmac_f32_16x16x64_bf16 v[148:151], v[140:143], a[8:15], v10
    v_smfmac_f32_16x16x64_bf16 v[152:155], v[140:143], a[32:39], v10
    v_smfmac_f32_16x16x64_bf16 v[156:159], v[140:143], a[56:63], v10
    v_smfmac_f32_16x16x64_bf16 v[160:163], v[140:143], a[80:87], v10
    s_waitcnt lgkmcnt(0)
    v_smfmac_f32_16x16x64_bf16 v[148:151], v[144:147], a[16:23], v10
    v_smfmac_f32_16x16x64_bf16 v[152:155], v[144:147], a[40:47], v10
    v_smfmac_f32_16x16x64_bf16 v[156:159], v[144:147], a[64:71], v10
    v_smfmac_f32_16x16x64_bf16 v[160:163], v[144:147], a[88:95], v10
L_sc_42:
    v_pk_add_f32 v[148:149], v[148:149], v[150:151]
    v_cvt_pk_bf16_f32 v50, v148, v149
    v_cvt_pk_bf16_f32 v54, v148, v149
    v_pk_add_f32 v[152:153], v[152:153], v[154:155]
    v_cvt_pk_bf16_f32 v58, v152, v153
    v_cvt_pk_bf16_f32 v62, v152, v153
    v_pk_add_f32 v[156:157], v[156:157], v[158:159]
    v_cvt_pk_bf16_f32 v66, v156, v157
    v_cvt_pk_bf16_f32 v70, v156, v157
    s_waitcnt vmcnt(4)
    v_pk_add_f32 v[236:237], v[92:93], v[96:97]
    v_pk_add_f32 v[238:239], v[94:95], v[98:99]
    s_waitcnt vmcnt(3)
    v_pk_add_f32 v[236:237], v[236:237], v[100:101]
    v_pk_add_f32 v[238:239], v[238:239], v[102:103]
    v_pk_mul_f32 v[236:237], v[236:237], v[240:241]
    v_pk_mul_f32 v[238:239], v[238:239], v[240:241]
    v_max3_f32 v41, v236, v237, v238
    s_waitcnt vmcnt(0)
    v_add_f32 v43, v104, v105
    v_add_f32 v43, v43, v106
    v_mul_f32 v43, v43, v240
    v_max3_f32 v41, v41, v239, v43
    v_pk_add_f32 v[160:161], v[160:161], v[162:163]
    v_cvt_pk_bf16_f32 v74, v160, v161
    v_max_f32_dpp v42, v41, v41 quad_perm:[2,3,0,1] row_mask:0xf bank_mask:0xf
    v_max_f32_dpp v41, v41, v41 quad_perm:[2,3,0,1] row_mask:0xf bank_mask:0xf
    v_cvt_pk_bf16_f32 v78, v160, v161
    s_nop 0
    v_permlane16_swap_b32 v41, v42
    v_max_f32 v41, v41, v42
    v_mov_b32 v42, v41
    s_nop 1
    v_permlane32_swap_b32 v41, v42
    v_max_f32 v242, v41, v42
    v_pk_add_f32 v[236:237], v[236:237], v[242:243] op_sel_hi:[1,0] neg_lo:[0,1] neg_hi:[0,1]
    v_pk_add_f32 v[238:239], v[238:239], v[242:243] op_sel_hi:[1,0] neg_lo:[0,1] neg_hi:[0,1]
    v_sub_f32 v43, v43, v242
    v_exp_f32 v236, v236
    v_exp_f32 v237, v237
    v_exp_f32 v238, v238
    v_exp_f32 v239, v239
    v_exp_f32 v43, v43
    v_cvt_pk_bf16_f32 v80, v236, v237
    v_cvt_pk_bf16_f32 v82, v238, v239
    v_cvt_pk_bf16_f32 v81, v43, 0
    v_cvt_pk_bf16_f32 v83, v43, 0
    s_nop 1
    v_smfmac_f32_16x16x64_bf16 v[116:119], v[80:83], v[84:91], v11
    v_smfmac_f32_16x16x64_bf16 v[120:123], v[80:83], v[48:55], v11
    v_smfmac_f32_16x16x64_bf16 v[124:127], v[80:83], v[56:63], v11
    v_smfmac_f32_16x16x64_bf16 v[128:131], v[80:83], v[64:71], v11
    v_add_f32 v116, v116, v118
    v_add_f32 v117, v117, v119
    v_smfmac_f32_16x16x64_bf16 v[132:135], v[80:83], v[72:79], v11
    v_rcp_f32 v116, v116
    v_rcp_f32 v117, v117
    v_pk_add_f32 v[120:121], v[120:121], v[122:123]
    v_pk_mul_f32 v[120:121], v[120:121], v[116:117]
    v_cvt_pk_bf16_f32 v236, v120, v121
    v_pk_add_f32 v[124:125], v[124:125], v[126:127]
    v_pk_mul_f32 v[124:125], v[124:125], v[116:117]
    v_cvt_pk_bf16_f32 v237, v124, v125
    ds_write2st64_b32 v18, v236, v237 offset0:0 offset1:1
    v_pk_add_f32 v[128:129], v[128:129], v[130:131]
    v_pk_mul_f32 v[128:129], v[128:129], v[116:117]
    v_cvt_pk_bf16_f32 v238, v128, v129
    v_pk_add_f32 v[132:133], v[132:133], v[134:135]
    v_pk_mul_f32 v[132:133], v[132:133], v[116:117]
    v_cvt_pk_bf16_f32 v239, v132, v133
    ds_write2st64_b32 v18, v238, v239 offset0:2 offset1:3
    v_cmp_u_f32 vcc, v120, v121
    v_mov_b32 v120, 0
    v_mov_b32 v121, 0
    v_mov_b32 v122, 0
    v_mov_b32 v123, 0
    v_mov_b32 v124, 0
    v_mov_b32 v125, 0
    v_mov_b32 v126, 0
    v_mov_b32 v127, 0
    v_mov_b32 v128, 0
    s_cbranch_vccnz L_sp_43
L_sg_44:
    s_waitcnt lgkmcnt(0)
    s_barrier
    ds_read_b64_tr_b16 v[80:81], v19
    ds_read_b64_tr_b16 v[82:83], v19 offset:128
    v_mov_b32 v129, 0
    v_mov_b32 v130, 0
    v_mov_b32 v131, 0
    v_mov_b32 v132, 0
    v_mov_b32 v133, 0
    v_mov_b32 v134, 0
    v_mov_b32 v135, 0
    v_mov_b32 v116, 0
    v_mov_b32 v117, 0
    v_mov_b32 v118, 0
    v_mov_b32 v119, 0
    s_waitcnt lgkmcnt(0)
    v_mfma_f32_16x16x32_bf16 v[172:175], v[80:83], v[108:111], 0
    buffer_load_dword v36, v33, s[4:7], s38 offen sc1
    s_nop 6
    v_cvt_pk_bf16_f32 v236, v172, v173
    v_cvt_pk_bf16_f32 v237, v174, v175
    v_cndmask_b32 v236, v236, v237, s[60:61]
    buffer_store_dword v236, v46, s[4:7], s41 offen sc1
    buffer_store_dword v236, v14, s[4:7], s41 offen sc1
    ds_write_b32 v47, v50 offset:8
    ds_write_b32 v47, v58 offset:6152
    ds_write_b32 v47, v66 offset:12296
    ds_write_b32 v47, v74 offset:18440
    ds_read_b128 v[204:207], v26 offset:0
    ds_read_b128 v[180:183], v29 offset:0
    ds_read_b128 v[184:187], v29 offset:1024
    ds_read_b64 v[208:209], v27 offset:0
    ds_read_b128 v[188:191], v29 offset:2048
    ds_read_b128 v[212:215], v26 offset:1536
    ds_read_b128 v[192:195], v29 offset:3072
    ds_read_b128 v[196:199], v29 offset:4096
    ds_read_b64 v[216:217], v27 offset:1536
    ds_read_b128 v[200:203], v29 offset:5120
    s_add_u32 s55, s42, 0
    buffer_store_dword v168, v46, s[4:7], s55 offen sc1
    s_add_u32 s55, s42, 8192
    buffer_store_dword v168, v46, s[4:7], s55 offen sc1
    s_waitcnt lgkmcnt(5)
    v_mfma_f32_16x16x32_bf16 v[220:223], v[180:183], v[204:207], 0
    v_mfma_f32_16x16x32_bf16 v[224:227], v[184:187], v[204:207], 0
    v_mfma_f32_16x16x32_bf16 v[224:227], v[188:191], v[208:211], v[224:227]
    ds_read_b128 v[204:207], v26 offset:3072
    ds_read_b128 v[180:183], v29 offset:6144
    ds_read_b128 v[184:187], v29 offset:7168
    ds_read_b64 v[208:209], v27 offset:3072
    ds_read_b128 v[188:191], v29 offset:8192
    s_add_u32 s56, s37, 2
    s_and_b32 s55, s56, 3
    s_mul_i32 s55, s55, 114688
    s_add_u32 s55, s55, 65536
    s_add_u32 s45, s38, s55
    s_add_u32 s46, s45, 4096
    s_add_u32 s47, s45, 8192
    s_add_u32 s56, s37, -1
    s_and_b32 s55, s56, 3
    s_mul_i32 s55, s55, 114688
    s_add_u32 s55, s55, 53248
    s_add_u32 s48, s38, s55
    s_and_b32 s55, s56, 1
    s_add_u32 s56, s56, 1
    v_mov_b32 v35, -16
    v_writelane_b32 v35, s56, 12
    s_mul_i32 s55, s55, 12288
    s_add_u32 m0, s54, s55
    s_waitcnt lgkmcnt(5)
    v_mfma_f32_16x16x32_bf16 v[220:223], v[192:195], v[212:215], v[220:223]
    v_mfma_f32_16x16x32_bf16 v[224:227], v[196:199], v[212:215], v[224:227]
    v_mfma_f32_16x16x32_bf16 v[224:227], v[200:203], v[216:219], v[224:227]
    ds_read_b128 v[212:215], v26 offset:4608
    ds_read_b128 v[192:195], v29 offset:9216
    ds_read_b128 v[196:199], v29 offset:10240
    ds_read_b64 v[216:217], v27 offset:4608
    ds_read_b128 v[200:203], v29 offset:11264
    s_waitcnt lgkmcnt(5)
    v_mfma_f32_16x16x32_bf16 v[220:223], v[180:183], v[204:207], v[220:223]
    v_mfma_f32_16x16x32_bf16 v[224:227], v[184:187], v[204:207], v[224:227]
    v_mfma_f32_16x16x32_bf16 v[224:227], v[188:191], v[208:211], v[224:227]
    s_waitcnt lgkmcnt(0)
    v_mfma_f32_16x16x32_bf16 v[220:223], v[192:195], v[212:215], v[220:223]
    v_mfma_f32_16x16x32_bf16 v[224:227], v[196:199], v[212:215], v[224:227]
    v_mfma_f32_16x16x32_bf16 v[224:227], v[200:203], v[216:219], v[224:227]
    s_waitcnt vmcnt(4)
    v_cmp_lt_i32 vcc, v36, v35
    s_cbranch_vccz L_fok_47
L_fw_46:
    buffer_load_dword v36, v33, s[4:7], s38 offen sc1
    s_sub_u32 s36, s36, 1
    s_cbranch_scc1 L_exit
    s_waitcnt vmcnt(0)
    v_cmp_lt_i32 vcc, v36, v35
    s_cbranch_vccnz L_fw_46
L_fok_47:
    buffer_load_dwordx4 v37, s[4:7], s48 offen offset:0 sc1 lds
    buffer_load_dwordx4 v37, s[4:7], s48 offen offset:1024 sc1 lds
    buffer_load_dwordx4 v37, s[4:7], s48 offen offset:2048 sc1 lds
    v_cvt_pk_bf16_f32 v220, v220, v221
    v_cvt_pk_bf16_f32 v221, v222, v223
    v_cvt_pk_bf16_f32 v222, v224, v225
    v_cvt_pk_bf16_f32 v223, v226, v227
    v_mov_b32 v224, v220
    v_mov_b32 v225, v221
    v_mov_b32_dpp v220, v222 row_ror:8 row_mask:0xf bank_mask:0xc
    v_mov_b32_dpp v221, v223 row_ror:8 row_mask:0xf bank_mask:0xc
    v_mov_b32_dpp v222, v224 row_ror:8 row_mask:0xf bank_mask:0x3
    v_mov_b32_dpp v223, v225 row_ror:8 row_mask:0xf bank_mask:0x3
    buffer_store_dwordx4 v[220:223], v15, s[4:7], s49 offen
    v_mfma_f32_16x16x32_bf16 v[148:151], a[96:99], a[0:3], 0
    s_mov_b32 s50, s42
    s_add_u32 s56, s37, 1
    v_mov_b32 v47, v24
    v_mfma_f32_16x16x32_bf16 v[152:155], a[120:123], a[0:3], 0
    s_and_b32 s55, s56, 3
    s_mul_i32 s41, s55, 327680
    s_mul_i32 s56, s55, 114688
    v_mfma_f32_16x16x32_bf16 v[156:159], a[96:99], a[24:27], 0
    s_add_u32 s43, s38, s56
    s_xor_b32 s55, s55, 2
    s_mul_i32 s42, s55, 327680
    v_mfma_f32_16x16x32_bf16 v[160:163], a[120:123], a[24:27], 0
    s_add_u32 s56, s37, 2
    v_mov_b32 v107, s56
    s_and_b32 s55, s56, 3
    v_mfma_f32_16x16x32_bf16 v[180:183], a[96:99], a[48:51], 0
    s_mul_i32 s44, s55, 24576
    s_add_u32 s56, s37, -1
    s_and_b32 s55, s56, 3
    v_mfma_f32_16x16x32_bf16 v[184:187], a[120:123], a[48:51], 0
    s_mul_i32 s55, s55, 40960
    s_add_u32 s49, s55, s38
    s_add_u32 s56, s37, -1
    v_mfma_f32_16x16x32_bf16 v[188:191], a[96:99], a[72:75], 0
    s_and_b32 s55, s56, 3
    s_mul_i32 s55, s55, 24576
    v_add_u32 v26, s55, v22
    v_mfma_f32_16x16x32_bf16 v[192:195], a[120:123], a[72:75], 0
    buffer_load_dwordx4 a[96:99], v40, s[4:7], s45 offen offset:0 sc1
    v_mfma_f32_16x16x32_bf16 v[148:151], a[100:103], a[4:7], v[148:151]
    v_add_u32 v27, s55, v23
    s_and_b32 s55, s56, 1
    s_mul_i32 s55, s55, 12288
    v_mfma_f32_16x16x32_bf16 v[152:155], a[124:127], a[4:7], v[152:155]
    buffer_load_dwordx4 a[120:123], v40, s[4:7], s46 offen offset:2048 sc1
    v_mfma_f32_16x16x32_bf16 v[156:159], a[100:103], a[28:31], v[156:159]
    v_add_u32 v29, s55, v28
    v_mfma_f32_16x16x32_bf16 v[160:163], a[124:127], a[28:31], v[160:163]
    v_mfma_f32_16x16x32_bf16 v[180:183], a[100:103], a[52:55], v[180:183]
    v_mfma_f32_16x16x32_bf16 v[184:187], a[124:127], a[52:55], v[184:187]
    v_mfma_f32_16x16x32_bf16 v[188:191], a[100:103], a[76:79], v[188:191]
    v_mfma_f32_16x16x32_bf16 v[192:195], a[124:127], a[76:79], v[192:195]
    buffer_load_dwordx4 a[100:103], v40, s[4:7], s45 offen offset:1024 sc1
    v_mfma_f32_16x16x32_bf16 v[148:151], a[104:107], a[8:11], v[148:151]
    v_mfma_f32_16x16x32_bf16 v[152:155], a[128:131], a[8:11], v[152:155]
    buffer_load_dwordx4 a[124:127], v40, s[4:7], s46 offen offset:3072 sc1
    v_mfma_f32_16x16x32_bf16 v[156:159], a[104:107], a[32:35], v[156:159]
    v_mfma_f32_16x16x32_bf16 v[160:163], a[128:131], a[32:35], v[160:163]
    v_mfma_f32_16x16x32_bf16 v[180:183], a[104:107], a[56:59], v[180:183]
    v_mfma_f32_16x16x32_bf16 v[184:187], a[128:131], a[56:59], v[184:187]
    v_mfma_f32_16x16x32_bf16 v[188:191], a[104:107], a[80:83], v[188:191]
    v_mfma_f32_16x16x32_bf16 v[192:195], a[128:131], a[80:83], v[192:195]
    buffer_load_dwordx4 a[104:107], v40, s[4:7], s45 offen offset:2048 sc1
    v_mfma_f32_16x16x32_bf16 v[148:151], a[108:111], a[12:15], v[148:151]
    v_mfma_f32_16x16x32_bf16 v[152:155], a[132:135], a[12:15], v[152:155]
    buffer_load_dwordx4 a[128:131], v40, s[4:7], s47 offen offset:0 sc1
    v_mfma_f32_16x16x32_bf16 v[156:159], a[108:111], a[36:39], v[156:159]
    v_mfma_f32_16x16x32_bf16 v[160:163], a[132:135], a[36:39], v[160:163]
    v_mfma_f32_16x16x32_bf16 v[180:183], a[108:111], a[60:63], v[180:183]
    v_mfma_f32_16x16x32_bf16 v[184:187], a[132:135], a[60:63], v[184:187]
    v_mfma_f32_16x16x32_bf16 v[188:191], a[108:111], a[84:87], v[188:191]
    v_mfma_f32_16x16x32_bf16 v[192:195], a[132:135], a[84:87], v[192:195]
    buffer_load_dwordx4 a[108:111], v40, s[4:7], s45 offen offset:3072 sc1
    v_mfma_f32_16x16x32_bf16 v[148:151], a[112:115], a[16:19], v[148:151]
    v_mfma_f32_16x16x32_bf16 v[152:155], a[136:139], a[16:19], v[152:155]
    buffer_load_dwordx4 a[132:135], v40, s[4:7], s47 offen offset:1024 sc1
    v_mfma_f32_16x16x32_bf16 v[156:159], a[112:115], a[40:43], v[156:159]
    v_mfma_f32_16x16x32_bf16 v[160:163], a[136:139], a[40:43], v[160:163]
    v_mfma_f32_16x16x32_bf16 v[180:183], a[112:115], a[64:67], v[180:183]
    v_mfma_f32_16x16x32_bf16 v[184:187], a[136:139], a[64:67], v[184:187]
    v_mfma_f32_16x16x32_bf16 v[188:191], a[112:115], a[88:91], v[188:191]
    v_mfma_f32_16x16x32_bf16 v[192:195], a[136:139], a[88:91], v[192:195]
    buffer_load_dwordx4 a[112:115], v40, s[4:7], s46 offen offset:0 sc1
    v_mfma_f32_16x16x32_bf16 v[148:151], a[116:119], a[20:23], v[148:151]
    v_mfma_f32_16x16x32_bf16 v[152:155], a[140:143], a[20:23], v[152:155]
    v_mfma_f32_16x16x32_bf16 v[156:159], a[116:119], a[44:47], v[156:159]
    v_mfma_f32_16x16x32_bf16 v[160:163], a[140:143], a[44:47], v[160:163]
    v_mfma_f32_16x16x32_bf16 v[180:183], a[116:119], a[68:71], v[180:183]
    v_mfma_f32_16x16x32_bf16 v[184:187], a[140:143], a[68:71], v[184:187]
    v_mfma_f32_16x16x32_bf16 v[188:191], a[116:119], a[92:95], v[188:191]
    v_mfma_f32_16x16x32_bf16 v[192:195], a[140:143], a[92:95], v[192:195]
    v_cvt_pk_bf16_f32 v64, v180, v181
    v_cvt_pk_bf16_f32 v65, v182, v183
    ds_write_b64 v24, v[64:65] offset:12288
    v_cvt_pk_bf16_f32 v68, v184, v185
    v_cvt_pk_bf16_f32 v69, v186, v187
    ds_write_b64 v25, v[68:69] offset:12288
    v_cvt_pk_bf16_f32 v72, v188, v189
    v_cvt_pk_bf16_f32 v73, v190, v191
    ds_write_b64 v24, v[72:73] offset:18432
    v_cvt_pk_bf16_f32 v76, v192, v193
    v_cvt_pk_bf16_f32 v77, v194, v195
    ds_write_b64 v25, v[76:77] offset:18432
    v_cvt_pk_bf16_f32 v48, v148, v149
    v_cvt_pk_bf16_f32 v49, v150, v151
    ds_write_b64 v24, v[48:49] offset:0
    v_cvt_pk_bf16_f32 v52, v152, v153
    v_cvt_pk_bf16_f32 v53, v154, v155
    ds_write_b64 v25, v[52:53] offset:0
    v_cvt_pk_bf16_f32 v56, v156, v157
    v_cvt_pk_bf16_f32 v57, v158, v159
    ds_write_b64 v24, v[56:57] offset:6144
    v_cvt_pk_bf16_f32 v60, v160, v161
    v_cvt_pk_bf16_f32 v61, v162, v163
    ds_write_b64 v25, v[60:61] offset:6144
    s_add_u32 s37, s37, 1
    s_mov_b32 m0, s53
    v_add_u32 v24, s44, v20
    v_add_u32 v25, s44, v21
    v_pk_mul_f32 v[148:149], v[210:211], v[210:211]
    v_pk_mul_f32 v[150:151], v[210:211], v[210:211]
    v_pk_mul_f32 v[152:153], v[210:211], v[210:211]
    v_pk_mul_f32 v[154:155], v[210:211], v[210:211]
    v_pk_mul_f32 v[156:157], v[210:211], v[210:211]
    v_pk_mul_f32 v[158:159], v[210:211], v[210:211]
    v_pk_mul_f32 v[160:161], v[210:211], v[210:211]
    v_pk_mul_f32 v[162:163], v[210:211], v[210:211]
    buffer_load_dwordx4 a[136:139], v40, s[4:7], s47 offen offset:2048 sc1
    buffer_load_dwordx4 a[116:119], v40, s[4:7], s46 offen offset:1024 sc1
    buffer_load_dwordx4 a[140:143], v40, s[4:7], s47 offen offset:3072 sc1
    s_branch L_wo_loop_f
L_wo_tail_f:
L_tv_48:
    buffer_load_dwordx4 v44, s[4:7], s43 offen offset:0 sc1 lds
    buffer_load_dwordx4 v44, s[4:7], s43 offen offset:1024 sc1 lds
    buffer_load_dwordx4 v44, s[4:7], s43 offen offset:2048 sc1 lds
    s_sub_u32 s36, s36, 1
    s_cbranch_scc1 L_exit
    v_add_u32 v5, s53, v12
    s_waitcnt vmcnt(0)
    ds_read_b128 v[136:139], v5 offset:0
    ds_read_b128 v[140:143], v5 offset:1024
    ds_read_b128 v[144:147], v5 offset:2048
    s_waitcnt lgkmcnt(0)
    v_max_u32 v4, v136, v137
    v_max3_u32 v4, v4, v138, v139
    v_max3_u32 v4, v4, v140, v141
    v_max3_u32 v4, v4, v142, v143
    v_max3_u32 v4, v4, v144, v145
    v_max3_u32 v4, v4, v146, v147
    v_cmp_eq_u32 vcc, -1, v4
    s_cbranch_vccnz L_tv_48
    ds_read_b64_tr_b16 v[136:137], v16 offset:0
    ds_read_b64_tr_b16 v[138:139], v13 offset:0
    ds_read_b64_tr_b16 v[140:141], v16 offset:1024
    ds_read_b64_tr_b16 v[142:143], v13 offset:1024
    ds_read_b64_tr_b16 v[144:145], v16 offset:2048
    ds_read_b64_tr_b16 v[146:147], v13 offset:2048
    v_mov_b32 v148, 0
    v_mov_b32 v149, 0
    v_mov_b32 v150, 0
    v_mov_b32 v151, 0
    v_mov_b32 v152, 0
    v_mov_b32 v153, 0
    v_mov_b32 v154, 0
    v_mov_b32 v155, 0
    v_mov_b32 v156, 0
    v_mov_b32 v157, 0
    v_mov_b32 v158, 0
    v_mov_b32 v159, 0
    v_mov_b32 v160, 0
    v_mov_b32 v161, 0
    v_mov_b32 v162, 0
    v_mov_b32 v163, 0
    s_waitcnt lgkmcnt(0)
    v_smfmac_f32_16x16x64_bf16 v[148:151], v[136:139], a[0:7], v10
    v_smfmac_f32_16x16x64_bf16 v[152:155], v[136:139], a[24:31], v10
    v_smfmac_f32_16x16x64_bf16 v[156:159], v[136:139], a[48:55], v10
    v_smfmac_f32_16x16x64_bf16 v[160:163], v[136:139], a[72:79], v10
    v_smfmac_f32_16x16x64_bf16 v[148:151], v[140:143], a[8:15], v10
    v_smfmac_f32_16x16x64_bf16 v[152:155], v[140:143], a[32:39], v10
    v_smfmac_f32_16x16x64_bf16 v[156:159], v[140:143], a[56:63], v10
    v_smfmac_f32_16x16x64_bf16 v[160:163], v[140:143], a[80:87], v10
    v_smfmac_f32_16x16x64_bf16 v[148:151], v[144:147], a[16:23], v10
    v_smfmac_f32_16x16x64_bf16 v[152:155], v[144:147], a[40:47], v10
    v_smfmac_f32_16x16x64_bf16 v[156:159], v[144:147], a[64:71], v10
    v_smfmac_f32_16x16x64_bf16 v[160:163], v[144:147], a[88:95], v10
    v_pk_add_f32 v[148:149], v[148:149], v[150:151]
    v_cvt_pk_bf16_f32 v50, v148, v149
    v_cvt_pk_bf16_f32 v54, v148, v149
    v_pk_add_f32 v[152:153], v[152:153], v[154:155]
    v_cvt_pk_bf16_f32 v58, v152, v153
    v_cvt_pk_bf16_f32 v62, v152, v153
    v_pk_add_f32 v[156:157], v[156:157], v[158:159]
    v_cvt_pk_bf16_f32 v66, v156, v157
    v_cvt_pk_bf16_f32 v70, v156, v157
    v_pk_add_f32 v[160:161], v[160:161], v[162:163]
    v_cvt_pk_bf16_f32 v74, v160, v161
    v_cvt_pk_bf16_f32 v78, v160, v161
    ds_write_b32 v47, v50 offset:8
    ds_write_b32 v47, v58 offset:6152
    ds_write_b32 v47, v66 offset:12296
    ds_write_b32 v47, v74 offset:18440
    s_add_u32 s91, s38, 81920
    buffer_load_dwordx4 v[120:123], v15, s[4:7], s91 offen sc1
    s_add_u32 s91, s38, 122880
    buffer_load_dwordx4 v[124:127], v15, s[4:7], s91 offen sc1
    s_add_u32 s56, s37, -1
    s_and_b32 s55, s56, 3
    s_mul_i32 s55, s55, 114688
    s_add_u32 s55, s55, 53248
    s_add_u32 s48, s38, s55
    s_and_b32 s55, s56, 1
    s_add_u32 s56, s56, 1
    v_mov_b32 v35, -16
    v_writelane_b32 v35, s56, 12
    s_mul_i32 s55, s55, 12288
    s_add_u32 m0, s54, s55
    buffer_load_dword v36, v33, s[4:7], s38 offen sc1
    v_mov_b32 v3, 200
L_p0_49:
    buffer_load_dword v4, v3, s[8:11], 0 offen sc1
    s_sub_u32 s36, s36, 1
    s_cbranch_scc1 L_exit
    s_waitcnt vmcnt(0)
    v_readfirstlane_b32 s90, v4
    s_nop 0
    s_cmp_eq_u32 s90, 0
    s_cbranch_scc1 L_p0_49
    s_and_b32 s90, s90, 2
    s_lshl_b32 s90, s90, 12
    v_xor_b32 v30, s90, v30
    v_xor_b32 v31, s90, v31
    s_waitcnt lgkmcnt(0)
    s_barrier
    v_cmp_lt_i32 vcc, v36, v35
    s_cbranch_vccz L_fok_51
L_fw_50:
    buffer_load_dword v36, v33, s[4:7], s38 offen sc1
    s_sub_u32 s36, s36, 1
    s_cbranch_scc1 L_exit
    s_waitcnt vmcnt(0)
    v_cmp_lt_i32 vcc, v36, v35
    s_cbranch_vccnz L_fw_50
L_fok_51:
    buffer_load_dwordx4 v37, s[4:7], s48 offen offset:0 sc1 lds
    buffer_load_dwordx4 v37, s[4:7], s48 offen offset:1024 sc1 lds
    buffer_load_dwordx4 v37, s[4:7], s48 offen offset:2048 sc1 lds
    v_mov_b32 v128, v220
    v_mov_b32 v129, v221
    v_mov_b32 v130, v222
    v_mov_b32 v131, v223
    s_add_u32 s56, s37, -2
    s_and_b32 s55, s56, 3
    s_mul_i32 s55, s55, 24576
    v_add_u32 v26, s55, v22
    v_add_u32 v27, s55, v23
    s_and_b32 s55, s56, 1
    s_mul_i32 s55, s55, 12288
    v_add_u32 v29, s55, v28
    ds_read_b128 v[204:207], v26 offset:0
    ds_read_b128 v[180:183], v29 offset:0
    ds_read_b128 v[184:187], v29 offset:1024
    ds_read_b64 v[208:209], v27 offset:0
    ds_read_b128 v[188:191], v29 offset:2048
    ds_read_b128 v[212:215], v26 offset:1536
    ds_read_b128 v[192:195], v29 offset:3072
    ds_read_b128 v[196:199], v29 offset:4096
    ds_read_b64 v[216:217], v27 offset:1536
    ds_read_b128 v[200:203], v29 offset:5120
    s_waitcnt lgkmcnt(5)
    v_mfma_f32_16x16x32_bf16 v[220:223], v[180:183], v[204:207], 0
    v_mfma_f32_16x16x32_bf16 v[224:227], v[184:187], v[204:207], 0
    v_mfma_f32_16x16x32_bf16 v[224:227], v[188:191], v[208:211], v[224:227]
    ds_read_b128 v[204:207], v26 offset:3072
    ds_read_b128 v[180:183], v29 offset:6144
    ds_read_b128 v[184:187], v29 offset:7168
    ds_read_b64 v[208:209], v27 offset:3072
    ds_read_b128 v[188:191], v29 offset:8192
    s_waitcnt lgkmcnt(5)
    v_mfma_f32_16x16x32_bf16 v[220:223], v[192:195], v[212:215], v[220:223]
    v_mfma_f32_16x16x32_bf16 v[224:227], v[196:199], v[212:215], v[224:227]
    v_mfma_f32_16x16x32_bf16 v[224:227], v[200:203], v[216:219], v[224:227]
    ds_read_b128 v[212:215], v26 offset:4608
    ds_read_b128 v[192:195], v29 offset:9216
    ds_read_b128 v[196:199], v29 offset:10240
    ds_read_b64 v[216:217], v27 offset:4608
    ds_read_b128 v[200:203], v29 offset:11264
    s_waitcnt lgkmcnt(5)
    v_mfma_f32_16x16x32_bf16 v[220:223], v[180:183], v[204:207], v[220:223]
    v_mfma_f32_16x16x32_bf16 v[224:227], v[184:187], v[204:207], v[224:227]
    v_mfma_f32_16x16x32_bf16 v[224:227], v[188:191], v[208:211], v[224:227]
    s_waitcnt lgkmcnt(0)
    v_mfma_f32_16x16x32_bf16 v[220:223], v[192:195], v[212:215], v[220:223]
    v_mfma_f32_16x16x32_bf16 v[224:227], v[196:199], v[212:215], v[224:227]
    v_mfma_f32_16x16x32_bf16 v[224:227], v[200:203], v[216:219], v[224:227]
    s_nop 0
    v_cvt_pk_bf16_f32 v220, v220, v221
    v_cvt_pk_bf16_f32 v221, v222, v223
    s_nop 4
    v_cvt_pk_bf16_f32 v222, v224, v225
    v_cvt_pk_bf16_f32 v223, v226, v227
    v_mov_b32 v224, v220
    v_mov_b32 v225, v221
    v_mov_b32_dpp v220, v222 row_ror:8 row_mask:0xf bank_mask:0xc
    v_mov_b32_dpp v221, v223 row_ror:8 row_mask:0xf bank_mask:0xc
    v_mov_b32_dpp v222, v224 row_ror:8 row_mask:0xf bank_mask:0x3
    v_mov_b32_dpp v223, v225 row_ror:8 row_mask:0xf bank_mask:0x3
    v_mov_b32 v132, v220
    v_mov_b32 v133, v221
    v_mov_b32 v134, v222
    v_mov_b32 v135, v223
    s_waitcnt vmcnt(0)
    s_barrier
    s_add_u32 s56, s37, -1
    s_and_b32 s55, s56, 3
    s_mul_i32 s55, s55, 24576
    v_add_u32 v26, s55, v22
    v_add_u32 v27, s55, v23
    s_and_b32 s55, s56, 1
    s_mul_i32 s55, s55, 12288
    v_add_u32 v29, s55, v28
    ds_read_b128 v[204:207], v26 offset:0
    ds_read_b128 v[180:183], v29 offset:0
    ds_read_b128 v[184:187], v29 offset:1024
    ds_read_b64 v[208:209], v27 offset:0
    ds_read_b128 v[188:191], v29 offset:2048
    ds_read_b128 v[212:215], v26 offset:1536
    ds_read_b128 v[192:195], v29 offset:3072
    ds_read_b128 v[196:199], v29 offset:4096
    ds_read_b64 v[216:217], v27 offset:1536
    ds_read_b128 v[200:203], v29 offset:5120
    s_waitcnt lgkmcnt(5)
    v_mfma_f32_16x16x32_bf16 v[220:223], v[180:183], v[204:207], 0
    v_mfma_f32_16x16x32_bf16 v[224:227], v[184:187], v[204:207], 0
    v_mfma_f32_16x16x32_bf16 v[224:227], v[188:191], v[208:211], v[224:227]
    ds_read_b128 v[204:207], v26 offset:3072
    ds_read_b128 v[180:183], v29 offset:6144
    ds_read_b128 v[184:187], v29 offset:7168
    ds_read_b64 v[208:209], v27 offset:3072
    ds_read_b128 v[188:191], v29 offset:8192
    s_waitcnt lgkmcnt(5)
    v_mfma_f32_16x16x32_bf16 v[220:223], v[192:195], v[212:215], v[220:223]
    v_mfma_f32_16x16x32_bf16 v[224:227], v[196:199], v[212:215], v[224:227]
    v_mfma_f32_16x16x32_bf16 v[224:227], v[200:203], v[216:219], v[224:227]
    ds_read_b128 v[212:215], v26 offset:4608
    ds_read_b128 v[192:195], v29 offset:9216
    ds_read_b128 v[196:199], v29 offset:10240
    ds_read_b64 v[216:217], v27 offset:4608
    ds_read_b128 v[200:203], v29 offset:11264
    s_waitcnt lgkmcnt(5)
    v_mfma_f32_16x16x32_bf16 v[220:223], v[180:183], v[204:207], v[220:223]
    v_mfma_f32_16x16x32_bf16 v[224:227], v[184:187], v[204:207], v[224:227]
    v_mfma_f32_16x16x32_bf16 v[224:227], v[188:191], v[208:211], v[224:227]
    s_waitcnt lgkmcnt(0)
    v_mfma_f32_16x16x32_bf16 v[220:223], v[192:195], v[212:215], v[220:223]
    v_mfma_f32_16x16x32_bf16 v[224:227], v[196:199], v[212:215], v[224:227]
    v_mfma_f32_16x16x32_bf16 v[224:227], v[200:203], v[216:219], v[224:227]
    s_nop 0
    v_cvt_pk_bf16_f32 v220, v220, v221
    v_cvt_pk_bf16_f32 v221, v222, v223
    s_nop 4
    v_cvt_pk_bf16_f32 v222, v224, v225
    v_cvt_pk_bf16_f32 v223, v226, v227
    v_mov_b32 v224, v220
    v_mov_b32 v225, v221
    v_mov_b32_dpp v220, v222 row_ror:8 row_mask:0xf bank_mask:0xc
    v_mov_b32_dpp v221, v223 row_ror:8 row_mask:0xf bank_mask:0xc
    v_mov_b32_dpp v222, v224 row_ror:8 row_mask:0xf bank_mask:0x3
    v_mov_b32_dpp v223, v225 row_ror:8 row_mask:0xf bank_mask:0x3
    v_mov_b32 v80, v220
    v_mov_b32 v81, v221
    v_mov_b32 v82, v222
    v_mov_b32 v83, v223
    s_add_u32 s56, s37, 0
    s_and_b32 s55, s56, 3
    s_mul_i32 s55, s55, 114688
    s_add_u32 s55, s55, 53248
    s_add_u32 s48, s38, s55
    s_and_b32 s55, s56, 1
    s_add_u32 s56, s56, 1
    v_mov_b32 v35, -16
    v_writelane_b32 v35, s56, 12
    s_mul_i32 s55, s55, 12288
    s_add_u32 m0, s54, s55
    s_add_u32 s56, s37, 0
    s_and_b32 s55, s56, 3
    s_mul_i32 s55, s55, 24576
    v_add_u32 v26, s55, v22
    v_add_u32 v27, s55, v23
    s_and_b32 s55, s56, 1
    s_mul_i32 s55, s55, 12288
    v_add_u32 v29, s55, v28
    buffer_load_dword v36, v33, s[4:7], s38 offen sc1
    buffer_load_dword v36, v33, s[4:7], s38 offen sc1
    buffer_load_dword v36, v33, s[4:7], s38 offen sc1
    buffer_load_dword v36, v33, s[4:7], s38 offen sc1
    buffer_load_dword v36, v33, s[4:7], s38 offen sc1
L_sp_52:
    s_waitcnt vmcnt(4)
    v_cmp_lt_i32 vcc, v36, v35
    buffer_load_dword v36, v33, s[4:7], s38 offen sc1
    s_sub_u32 s36, s36, 1
    s_cbranch_scc1 L_exit
    s_cbranch_vccz L_sp_52x
    s_waitcnt vmcnt(4)
    v_cmp_lt_i32 vcc, v36, v35
    buffer_load_dword v36, v33, s[4:7], s38 offen sc1
    s_cbranch_vccz L_sp_52x
    s_waitcnt vmcnt(4)
    v_cmp_lt_i32 vcc, v36, v35
    buffer_load_dword v36, v33, s[4:7], s38 offen sc1
    s_cbranch_vccz L_sp_52x
    s_waitcnt vmcnt(4)
    v_cmp_lt_i32 vcc, v36, v35
    buffer_load_dword v36, v33, s[4:7], s38 offen sc1
    s_cbranch_vccnz L_sp_52
L_sp_52x:
    buffer_load_dwordx4 v37, s[4:7], s48 offen offset:0 sc1 lds
    buffer_load_dwordx4 v37, s[4:7], s48 offen offset:1024 sc1 lds
    buffer_load_dwordx4 v37, s[4:7], s48 offen offset:2048 sc1 lds
    s_waitcnt vmcnt(0)
    s_barrier
    s_mov_b32 s49, 7143424
    buffer_store_dwordx4 v[120:123], v30, s[4:7], s49 offen sc1
    s_mov_b32 s49, 6815744
    buffer_store_dwordx4 v[124:127], v30, s[4:7], s49 offen sc1
    s_mov_b32 s49, 6488064
    buffer_store_dwordx4 v[128:131], v30, s[4:7], s49 offen sc1
    s_mov_b32 s49, 6160384
    buffer_store_dwordx4 v[132:135], v30, s[4:7], s49 offen sc1
    s_mov_b32 s49, 5832704
    buffer_store_dwordx4 v[80:83], v30, s[4:7], s49 offen sc1
    ds_read_b128 v[204:207], v26 offset:0
    ds_read_b128 v[180:183], v29 offset:0
    ds_read_b128 v[184:187], v29 offset:1024
    ds_read_b64 v[208:209], v27 offset:0
    ds_read_b128 v[188:191], v29 offset:2048
    ds_read_b128 v[212:215], v26 offset:1536
    ds_read_b128 v[192:195], v29 offset:3072
    ds_read_b128 v[196:199], v29 offset:4096
    ds_read_b64 v[216:217], v27 offset:1536
    ds_read_b128 v[200:203], v29 offset:5120
    s_waitcnt lgkmcnt(5)
    v_mfma_f32_16x16x32_bf16 v[220:223], v[180:183], v[204:207], 0
    v_mfma_f32_16x16x32_bf16 v[224:227], v[184:187], v[204:207], 0
    v_mfma_f32_16x16x32_bf16 v[224:227], v[188:191], v[208:211], v[224:227]
    ds_read_b128 v[204:207], v26 offset:3072
    ds_read_b128 v[180:183], v29 offset:6144
    ds_read_b128 v[184:187], v29 offset:7168
    ds_read_b64 v[208:209], v27 offset:3072
    ds_read_b128 v[188:191], v29 offset:8192
    s_waitcnt lgkmcnt(5)
    v_mfma_f32_16x16x32_bf16 v[220:223], v[192:195], v[212:215], v[220:223]
    v_mfma_f32_16x16x32_bf16 v[224:227], v[196:199], v[212:215], v[224:227]
    v_mfma_f32_16x16x32_bf16 v[224:227], v[200:203], v[216:219], v[224:227]
    ds_read_b128 v[212:215], v26 offset:4608
    ds_read_b128 v[192:195], v29 offset:9216
    ds_read_b128 v[196:199], v29 offset:10240
    ds_read_b64 v[216:217], v27 offset:4608
    ds_read_b128 v[200:203], v29 offset:11264
    s_waitcnt lgkmcnt(5)
    v_mfma_f32_16x16x32_bf16 v[220:223], v[180:183], v[204:207], v[220:223]
    v_mfma_f32_16x16x32_bf16 v[224:227], v[184:187], v[204:207], v[224:227]
    v_mfma_f32_16x16x32_bf16 v[224:227], v[188:191], v[208:211], v[224:227]
    s_waitcnt lgkmcnt(0)
    v_mfma_f32_16x16x32_bf16 v[220:223], v[192:195], v[212:215], v[220:223]
    v_mfma_f32_16x16x32_bf16 v[224:227], v[196:199], v[212:215], v[224:227]
    v_mfma_f32_16x16x32_bf16 v[224:227], v[200:203], v[216:219], v[224:227]
    s_nop 0
    v_cvt_pk_bf16_f32 v220, v220, v221
    v_cvt_pk_bf16_f32 v221, v222, v223
    s_nop 4
    v_cvt_pk_bf16_f32 v222, v224, v225
    v_cvt_pk_bf16_f32 v223, v226, v227
    v_mov_b32 v224, v220
    v_mov_b32 v225, v221
    v_mov_b32_dpp v220, v222 row_ror:8 row_mask:0xf bank_mask:0xc
    v_mov_b32_dpp v221, v223 row_ror:8 row_mask:0xf bank_mask:0xc
    v_mov_b32_dpp v222, v224 row_ror:8 row_mask:0xf bank_mask:0x3
    v_mov_b32_dpp v223, v225 row_ror:8 row_mask:0xf bank_mask:0x3
    s_mov_b32 s49, 5505024
    buffer_store_dwordx4 v[220:223], v30, s[4:7], s49 offen sc1
    s_waitcnt vmcnt(0)
L_fp_53:
    s_mov_b32 s51, 5505024
    buffer_load_dwordx4 v[96:99], v31, s[4:7], s51 offen sc1
    s_mov_b32 s51, 7143424
    buffer_load_dwordx4 v[148:151], v31, s[4:7], s51 offen sc1
    s_mov_b32 s51, 6815744
    buffer_load_dwordx4 v[152:155], v31, s[4:7], s51 offen sc1
    s_mov_b32 s51, 6488064
    buffer_load_dwordx4 v[156:159], v31, s[4:7], s51 offen sc1
    s_mov_b32 s51, 6160384
    buffer_load_dwordx4 v[160:163], v31, s[4:7], s51 offen sc1
    s_mov_b32 s51, 5832704
    buffer_load_dwordx4 v[92:95], v31, s[4:7], s51 offen sc1
    s_sub_u32 s36, s36, 1
    s_cbranch_scc1 L_exit
    s_waitcnt vmcnt(0)
L_fp_53c:
    v_mov_b32 v41, 0
    v_max3_u32 v41, v41, v96, v97
    v_max3_u32 v41, v41, v98, v99
    v_max3_u32 v41, v41, v148, v149
    v_max3_u32 v41, v41, v150, v151
    v_max3_u32 v41, v41, v152, v153
    v_max3_u32 v41, v41, v154, v155
    v_max3_u32 v41, v41, v156, v157
    v_max3_u32 v41, v41, v158, v159
    v_max3_u32 v41, v41, v160, v161
    v_max3_u32 v41, v41, v162, v163
    v_max3_u32 v41, v41, v92, v93
    v_max3_u32 v41, v41, v94, v95
    v_cmp_eq_u32 vcc, -1, v41
    s_cbranch_vccnz L_fp_53
    s_mov_b32 s52, 5160960
    v_mfma_f32_16x16x32_bf16 v[232:235], a[144:147], v[96:99], 0
    s_nop 7
    v_cndmask_b32 v234, v232, v233, s[58:59]
    v_cndmask_b32 v235, v233, v232, s[58:59]
    s_nop 1
    v_add_f32_dpp v235, v234, v235 row_ror:8 row_mask:0xf bank_mask:0xf
    v_cvt_pk_bf16_f32 v235, v235, v235
    buffer_store_short v235, v32, s[28:31], s52 offen offset:0
    s_mov_b32 s52, 4751360
    v_mfma_f32_16x16x32_bf16 v[232:235], a[144:147], v[148:151], 0
    s_nop 7
    v_cndmask_b32 v234, v232, v233, s[58:59]
    v_cndmask_b32 v235, v233, v232, s[58:59]
    s_nop 1
    v_add_f32_dpp v235, v234, v235 row_ror:8 row_mask:0xf bank_mask:0xf
    v_cvt_pk_bf16_f32 v235, v235, v235
    buffer_store_short v235, v32, s[28:31], s52 offen offset:0
    s_mov_b32 s52, 4833280
    v_mfma_f32_16x16x32_bf16 v[232:235], a[144:147], v[152:155], 0
    s_nop 7
    v_cndmask_b32 v234, v232, v233, s[58:59]
    v_cndmask_b32 v235, v233, v232, s[58:59]
    s_nop 1
    v_add_f32_dpp v235, v234, v235 row_ror:8 row_mask:0xf bank_mask:0xf
    v_cvt_pk_bf16_f32 v235, v235, v235
    buffer_store_short v235, v32, s[28:31], s52 offen offset:0
    s_mov_b32 s52, 4915200
    v_mfma_f32_16x16x32_bf16 v[232:235], a[144:147], v[156:159], 0
    s_nop 7
    v_cndmask_b32 v234, v232, v233, s[58:59]
    v_cndmask_b32 v235, v233, v232, s[58:59]
    s_nop 1
    v_add_f32_dpp v235, v234, v235 row_ror:8 row_mask:0xf bank_mask:0xf
    v_cvt_pk_bf16_f32 v235, v235, v235
    buffer_store_short v235, v32, s[28:31], s52 offen offset:0
    s_mov_b32 s52, 4997120
    v_mfma_f32_16x16x32_bf16 v[232:235], a[144:147], v[160:163], 0
    s_nop 7
    v_cndmask_b32 v234, v232, v233, s[58:59]
    v_cndmask_b32 v235, v233, v232, s[58:59]
    s_nop 1
    v_add_f32_dpp v235, v234, v235 row_ror:8 row_mask:0xf bank_mask:0xf
    v_cvt_pk_bf16_f32 v235, v235, v235
    buffer_store_short v235, v32, s[28:31], s52 offen offset:0
    s_mov_b32 s52, 5079040
    v_mfma_f32_16x16x32_bf16 v[232:235], a[144:147], v[92:95], 0
    s_nop 7
    v_cndmask_b32 v234, v232, v233, s[58:59]
    v_cndmask_b32 v235, v233, v232, s[58:59]
    s_nop 1
    v_add_f32_dpp v235, v234, v235 row_ror:8 row_mask:0xf bank_mask:0xf
    v_cvt_pk_bf16_f32 v235, v235, v235
    buffer_store_short v235, v32, s[28:31], s52 offen offset:0
    s_endpgm
L_sp_43:
    s_cmp_eq_u32 s57, s37
    s_cbranch_scc1 L_sg_44
    s_mov_b32 s57, s37
L_sp_43s:
    buffer_load_dwordx4 v[92:95], v38, s[4:7], s43 offen offset:0 sc1
    buffer_load_dwordx4 v[96:99], v38, s[4:7], s43 offen offset:1280 sc1
    buffer_load_dwordx4 v[100:103], v38, s[4:7], s43 offen offset:2560 sc1
    buffer_load_dword v104, v39, s[4:7], s43 offen offset:0 sc1
    buffer_load_dword v105, v39, s[4:7], s43 offen offset:1280 sc1
    buffer_load_dword v106, v39, s[4:7], s43 offen offset:2560 sc1
    s_sub_u32 s36, s36, 1
    s_cbranch_scc1 L_exit
    s_waitcnt vmcnt(0)
    v_max3_u32 v4, v104, v105, v106
    v_max3_u32 v4, v4, v92, v93
    v_max3_u32 v4, v4, v94, v95
    v_max3_u32 v4, v4, v96, v97
    v_max3_u32 v4, v4, v98, v99
    v_max3_u32 v4, v4, v100, v101
    v_max3_u32 v4, v4, v102, v103
    v_cmp_eq_u32 vcc, -1, v4
    s_cbranch_vccnz L_sp_43s
    v_mov_b32 v129, 0
    v_mov_b32 v130, 0
    v_mov_b32 v131, 0
    v_mov_b32 v132, 0
    v_mov_b32 v133, 0
    v_mov_b32 v134, 0
    v_mov_b32 v135, 0
    v_mov_b32 v116, 0
    v_mov_b32 v117, 0
    v_mov_b32 v118, 0
    v_mov_b32 v119, 0
L_sp_43v:
    buffer_load_dwordx4 v44, s[4:7], s43 offen offset:0 sc1 lds
    buffer_load_dwordx4 v44, s[4:7], s43 offen offset:1024 sc1 lds
    buffer_load_dwordx4 v44, s[4:7], s43 offen offset:2048 sc1 lds
    s_sub_u32 s36, s36, 1
    s_cbranch_scc1 L_exit
    v_add_u32 v5, s53, v12
    s_waitcnt vmcnt(0)
    ds_read_b128 v[136:139], v5 offset:0
    ds_read_b128 v[140:143], v5 offset:1024
    ds_read_b128 v[144:147], v5 offset:2048
    s_waitcnt lgkmcnt(0)
    v_max_u32 v4, v136, v137
    v_max3_u32 v4, v4, v138, v139
    v_max3_u32 v4, v4, v140, v141
    v_max3_u32 v4, v4, v142, v143
    v_max3_u32 v4, v4, v144, v145
    v_max3_u32 v4, v4, v146, v147
    v_cmp_eq_u32 vcc, -1, v4
    s_cbranch_vccnz L_sp_43v
    ds_read_b64_tr_b16 v[136:137], v16 offset:0
    ds_read_b64_tr_b16 v[138:139], v13 offset:0
    ds_read_b64_tr_b16 v[140:141], v16 offset:1024
    ds_read_b64_tr_b16 v[142:143], v13 offset:1024
    ds_read_b64_tr_b16 v[144:145], v16 offset:2048
    ds_read_b64_tr_b16 v[146:147], v13 offset:2048
    v_mov_b32 v148, 0
    v_mov_b32 v149, 0
    v_mov_b32 v150, 0
    v_mov_b32 v151, 0
    v_mov_b32 v152, 0
    v_mov_b32 v153, 0
    v_mov_b32 v154, 0
    v_mov_b32 v155, 0
    v_mov_b32 v156, 0
    v_mov_b32 v157, 0
    v_mov_b32 v158, 0
    v_mov_b32 v159, 0
    v_mov_b32 v160, 0
    v_mov_b32 v161, 0
    v_mov_b32 v162, 0
    v_mov_b32 v163, 0
    s_waitcnt lgkmcnt(0)
    v_smfmac_f32_16x16x64_bf16 v[148:151], v[136:139], a[0:7], v10
    v_smfmac_f32_16x16x64_bf16 v[152:155], v[136:139], a[24:31], v10
    v_smfmac_f32_16x16x64_bf16 v[156:159], v[136:139], a[48:55], v10
    v_smfmac_f32_16x16x64_bf16 v[160:163], v[136:139], a[72:79], v10
    v_smfmac_f32_16x16x64_bf16 v[148:151], v[140:143], a[8:15], v10
    v_smfmac_f32_16x16x64_bf16 v[152:155], v[140:143], a[32:39], v10
    v_smfmac_f32_16x16x64_bf16 v[156:159], v[140:143], a[56:63], v10
    v_smfmac_f32_16x16x64_bf16 v[160:163], v[140:143], a[80:87], v10
    v_smfmac_f32_16x16x64_bf16 v[148:151], v[144:147], a[16:23], v10
    v_smfmac_f32_16x16x64_bf16 v[152:155], v[144:147], a[40:47], v10
    v_smfmac_f32_16x16x64_bf16 v[156:159], v[144:147], a[64:71], v10
    v_smfmac_f32_16x16x64_bf16 v[160:163], v[144:147], a[88:95], v10
    s_nop 3
    s_branch L_sc_42
L_px_f:
    v_and_b32 v1, 15, v0
    v_lshrrev_b32 v2, 4, v0
    s_mul_i32 s90, s32, 12288
    v_lshl_add_u32 v10, v0, 4, s90
    s_mul_i32 s90, s32, 3072
    v_lshl_add_u32 v12, v0, 4, s90
    v_lshrrev_b32 v3, 2, v1
    v_lshlrev_b32 v3, 1, v3
    v_and_b32 v4, 1, v1
    v_or_b32 v3, v3, v4
    v_lshl_add_u32 v3, v2, 3, v3
    v_lshl_add_u32 v11, v3, 4, s90
    s_lshl_b32 s90, s32, 7
    v_min_u32 v3, 11, v0
    v_lshl_add_u32 v3, v3, 2, s90
    v_add_u32 v13, 458752, v3
    v_min_u32 v3, 2, v0
    v_lshl_add_u32 v3, v3, 2, s90
    v_add_u32 v14, 459264, v3
    v_add_u32 v22, 462336, v3
    s_add_u32 s90, s90, 459776
    v_mov_b32 v15, s90
    v_cmp_eq_u32 vcc, 0, v0
    v_mov_b32 v9, 2146435072
    s_nop 0
    v_cndmask_b32 v15, v9, v15, vcc
    s_nop 0
    v_mov_b32 v21, 0xd04e79ff
    s_mov_b32 s44, 0x3dd53b95
    v_lshl_add_u32 v3, v2, 2, 0
    v_cmp_le_u32 s[48:49], v3, v1
    v_lshl_add_u32 v3, v2, 2, 1
    v_cmp_le_u32 s[50:51], v3, v1
    v_lshl_add_u32 v3, v2, 2, 2
    v_cmp_le_u32 s[52:53], v3, v1
    v_lshl_add_u32 v3, v2, 2, 3
    v_cmp_le_u32 s[54:55], v3, v1
    v_mov_b32 v167, 0
    v_mov_b32 v171, 0
    v_mov_b32 v174, 0
    v_mov_b32 v175, 0
    s_mov_b32 s37, 0
    v_mov_b32 v1, 192
L_gw_55:
    buffer_load_dword v2, v1, s[8:11], 0 offen sc1
    s_sub_u32 s36, s36, 1
    s_cbranch_scc1 L_exit
    s_waitcnt vmcnt(0)
L_gw_55c:
    v_readfirstlane_b32 s90, v2
    s_nop 0
    s_cmp_eq_u32 s90, 0
    s_cbranch_scc1 L_gw_55
    s_cmp_lg_u32 s90, 1
    s_cbranch_scc1 L_slow
    s_cmp_lg_u32 s32, 0
    s_cbranch_scc1 L_xg_54
    s_lshl_b32 s92, s34, 14
    s_add_u32 s92, s92, 1966080
    s_add_u32 s93, s92, 8192
    v_lshlrev_b32 v3, 4, v0
    buffer_store_dwordx4 v[24:27], v3, s[4:7], s92 offen offset:0 sc1
    buffer_store_dwordx4 v[24:27], v3, s[4:7], s93 offen offset:0 sc1
    buffer_store_dwordx4 v[24:27], v3, s[4:7], s92 offen offset:1024 sc1
    buffer_store_dwordx4 v[24:27], v3, s[4:7], s93 offen offset:1024 sc1
    buffer_store_dwordx4 v[24:27], v3, s[4:7], s92 offen offset:2048 sc1
    buffer_store_dwordx4 v[24:27], v3, s[4:7], s93 offen offset:2048 sc1
    buffer_store_dwordx4 v[24:27], v3, s[4:7], s92 offen offset:3072 sc1
    buffer_store_dwordx4 v[24:27], v3, s[4:7], s93 offen offset:3072 sc1
    v_mov_b32 v3, 0
    s_mov_b32 s56, -1
    s_mov_b32 s57, -1
    s_mov_b32 s62, 0
    s_mov_b32 s63, 0
    s_waitcnt vmcnt(0)
L_pr_56:
    s_memtime s[58:59]
    s_waitcnt lgkmcnt(0)
    buffer_load_dword v4, v3, s[4:7], s92 offen sc1
    s_waitcnt vmcnt(0)
    s_memtime s[60:61]
    s_waitcnt lgkmcnt(0)
    s_sub_u32 s60, s60, s58
    s_min_u32 s56, s56, s60
    s_memtime s[58:59]
    s_waitcnt lgkmcnt(0)
    buffer_load_dword v4, v3, s[4:7], s93 offen sc1
    s_waitcnt vmcnt(0)
    s_memtime s[60:61]
    s_waitcnt lgkmcnt(0)
    s_sub_u32 s60, s60, s58
    s_min_u32 s57, s57, s60
    buffer_load_dword v4, v13, s[4:7], s38 offen sc1
    v_add_u32 v3, 128, v3
    s_add_u32 s62, s62, 1
    s_waitcnt vmcnt(0)
    v_cmp_eq_u32 vcc, 0, v4
    s_nop 0
    s_cmp_eq_u64 vcc, 0
    s_addc_u32 s63, s63, 0
    s_cmp_ge_u32 s63, 2
    s_cselect_b32 s62, 32, s62
    s_min_u32 s58, s56, s57
    s_max_u32 s59, s56, s57
    s_sub_u32 s59, s59, s58
    s_cmp_ge_u32 s59, 150
    s_cselect_b32 s58, s58, -1
    s_cmp_le_u32 s58, 540
    s_cselect_b32 s62, 32, s62
    s_cmp_lt_u32 s62, 32
    s_cbranch_scc1 L_pr_56
    s_cmp_lt_u32 s57, s56
    s_cselect_b32 s62, 2, 1
    s_nop 0
    v_mov_b32 v3, 460288
    v_mov_b32 v4, s62
    buffer_store_dword v4, v3, s[4:7], s38 offen
    s_cmp_lg_u32 s34, 0
    s_cbranch_scc1 L_xg_54
    v_mov_b32 v3, 200
    buffer_store_dword v4, v3, s[8:11], 0 offen sc1
L_xg_54:
    s_barrier
    s_add_u32 s41, s38, 475136
    buffer_load_dword v16, v22, s[4:7], s38 offen sc1
    buffer_load_dword v16, v22, s[4:7], s38 offen sc1
L_sp_57:
    buffer_load_dword v16, v22, s[4:7], s38 offen sc1
    s_sub_u32 s36, s36, 1
    s_cbranch_scc1 L_exit
    s_waitcnt vmcnt(2)
    v_cmp_ge_u32 vcc, s37, v16
    s_cbranch_vccnz L_sp_57
    s_add_u32 s90, s41, 49152
    buffer_load_dwordx4 v[72:75], v10, s[4:7], s90 offen offset:0 sc1
    buffer_load_dwordx4 v[76:79], v10, s[4:7], s90 offen offset:1024 sc1
    buffer_load_dwordx4 v[80:83], v10, s[4:7], s90 offen offset:2048 sc1
    buffer_load_dwordx4 v[84:87], v10, s[4:7], s90 offen offset:3072 sc1
    s_add_u32 s90, s41, 53248
    buffer_load_dwordx4 v[88:91], v10, s[4:7], s90 offen offset:0 sc1
    buffer_load_dwordx4 v[92:95], v10, s[4:7], s90 offen offset:1024 sc1
    buffer_load_dwordx4 v[96:99], v10, s[4:7], s90 offen offset:2048 sc1
    buffer_load_dwordx4 v[100:103], v10, s[4:7], s90 offen offset:3072 sc1
    s_add_u32 s90, s41, 57344
    buffer_load_dwordx4 v[104:107], v10, s[4:7], s90 offen offset:0 sc1
    buffer_load_dwordx4 v[108:111], v10, s[4:7], s90 offen offset:1024 sc1
    buffer_load_dwordx4 v[112:115], v10, s[4:7], s90 offen offset:2048 sc1
    buffer_load_dwordx4 v[116:119], v10, s[4:7], s90 offen offset:3072 sc1
    s_add_u32 s90, s41, 0
    buffer_load_dwordx4 v[24:27], v10, s[4:7], s90 offen offset:0 sc1
    buffer_load_dwordx4 v[28:31], v10, s[4:7], s90 offen offset:1024 sc1
    buffer_load_dwordx4 v[32:35], v10, s[4:7], s90 offen offset:2048 sc1
    buffer_load_dwordx4 v[36:39], v10, s[4:7], s90 offen offset:3072 sc1
    s_add_u32 s90, s41, 4096
    buffer_load_dwordx4 v[40:43], v10, s[4:7], s90 offen offset:0 sc1
    buffer_load_dwordx4 v[44:47], v10, s[4:7], s90 offen offset:1024 sc1
    buffer_load_dwordx4 v[48:51], v10, s[4:7], s90 offen offset:2048 sc1
    buffer_load_dwordx4 v[52:55], v10, s[4:7], s90 offen offset:3072 sc1
    s_add_u32 s90, s41, 8192
    buffer_load_dwordx4 v[56:59], v10, s[4:7], s90 offen offset:0 sc1
    buffer_load_dwordx4 v[60:63], v10, s[4:7], s90 offen offset:1024 sc1
    buffer_load_dwordx4 v[64:67], v10, s[4:7], s90 offen offset:2048 sc1
    buffer_load_dwordx4 v[68:71], v10, s[4:7], s90 offen offset:3072 sc1
    s_waitcnt vmcnt(0)
L_px_loop_f:
    s_and_b32 s90, s37, 3
    s_mul_i32 s91, s90, 114688
    s_add_u32 s91, s91, s38
    s_add_u32 s42, s91, 40960
    s_add_u32 s43, s91, 53248
    s_add_u32 s90, s37, 1
    v_mov_b32 v17, s90
    s_and_b32 s90, s90, 3
    s_mul_i32 s91, s90, 98304
    s_add_u32 s91, s91, 475136
    s_add_u32 s41, s38, s91
    v_mfma_f32_16x16x32_bf16 v[144:147], v[72:75], v[24:27], 0
    v_mfma_f32_16x16x32_bf16 v[152:155], v[72:75], v[48:51], 0
    v_mfma_f32_16x16x32_bf16 v[156:159], v[96:99], v[48:51], 0
    v_mfma_f32_16x16x32_bf16 v[144:147], v[76:79], v[28:31], v[144:147]
    v_mfma_f32_16x16x32_bf16 v[152:155], v[76:79], v[52:55], v[152:155]
    v_mfma_f32_16x16x32_bf16 v[156:159], v[100:103], v[52:55], v[156:159]
    v_mfma_f32_16x16x32_bf16 v[144:147], v[80:83], v[32:35], v[144:147]
    v_mfma_f32_16x16x32_bf16 v[152:155], v[80:83], v[56:59], v[152:155]
    v_mfma_f32_16x16x32_bf16 v[156:159], v[104:107], v[56:59], v[156:159]
    v_mfma_f32_16x16x32_bf16 v[144:147], v[84:87], v[36:39], v[144:147]
    v_mfma_f32_16x16x32_bf16 v[152:155], v[84:87], v[60:63], v[152:155]
    v_mfma_f32_16x16x32_bf16 v[156:159], v[108:111], v[60:63], v[156:159]
    v_mfma_f32_16x16x32_bf16 v[144:147], v[88:91], v[40:43], v[144:147]
    v_mfma_f32_16x16x32_bf16 v[152:155], v[88:91], v[64:67], v[152:155]
    v_mfma_f32_16x16x32_bf16 v[156:159], v[112:115], v[64:67], v[156:159]
    v_mfma_f32_16x16x32_bf16 v[144:147], v[92:95], v[44:47], v[144:147]
    v_mfma_f32_16x16x32_bf16 v[152:155], v[92:95], v[68:71], v[152:155]
    v_mfma_f32_16x16x32_bf16 v[156:159], v[116:119], v[68:71], v[156:159]
    s_nop 0
    v_cndmask_b32 v144, v21, v144, s[48:49]
    v_cndmask_b32 v145, v21, v145, s[50:51]
    v_cndmask_b32 v146, v21, v146, s[52:53]
    v_cndmask_b32 v147, v21, v147, s[54:55]
    s_nop 2
    v_cndmask_b32 v156, v21, v156, s[48:49]
    v_cndmask_b32 v157, v21, v157, s[50:51]
    v_cndmask_b32 v158, v21, v158, s[52:53]
    v_cndmask_b32 v159, v21, v159, s[54:55]
    buffer_load_dword v16, v14, s[4:7], s38 offen sc1
    buffer_load_dword v16, v14, s[4:7], s38 offen sc1
L_sp_58:
    buffer_load_dword v16, v14, s[4:7], s38 offen sc1
    s_sub_u32 s36, s36, 1
    s_cbranch_scc1 L_exit
    s_waitcnt vmcnt(2)
    v_cmp_ge_u32 vcc, s37, v16
    s_cbranch_vccnz L_sp_58
    buffer_load_dwordx4 v[120:123], v11, s[4:7], s42 offen offset:0 sc1
    buffer_load_dwordx4 v[124:127], v11, s[4:7], s42 offen offset:512 sc1
    buffer_load_dwordx4 v[128:131], v11, s[4:7], s42 offen offset:1024 sc1
    buffer_load_dwordx4 v[132:135], v11, s[4:7], s42 offen offset:1536 sc1
    buffer_load_dwordx4 v[136:139], v11, s[4:7], s42 offen offset:2048 sc1
    buffer_load_dwordx4 v[140:143], v11, s[4:7], s42 offen offset:2560 sc1
    s_waitcnt vmcnt(5)
    v_mfma_f32_16x16x32_bf16 v[148:151], v[120:123], v[24:27], 0
    v_mfma_f32_16x16x32_bf16 v[160:163], v[120:123], v[48:51], 0
    s_waitcnt vmcnt(4)
    v_mfma_f32_16x16x32_bf16 v[148:151], v[124:127], v[28:31], v[148:151]
    v_mfma_f32_16x16x32_bf16 v[160:163], v[124:127], v[52:55], v[160:163]
    s_waitcnt vmcnt(3)
    v_mfma_f32_16x16x32_bf16 v[148:151], v[128:131], v[32:35], v[148:151]
    v_mfma_f32_16x16x32_bf16 v[160:163], v[128:131], v[56:59], v[160:163]
    s_waitcnt vmcnt(2)
    v_mfma_f32_16x16x32_bf16 v[148:151], v[132:135], v[36:39], v[148:151]
    v_mfma_f32_16x16x32_bf16 v[160:163], v[132:135], v[60:63], v[160:163]
    s_waitcnt vmcnt(1)
    v_mfma_f32_16x16x32_bf16 v[148:151], v[136:139], v[40:43], v[148:151]
    v_mfma_f32_16x16x32_bf16 v[160:163], v[136:139], v[64:67], v[160:163]
    s_waitcnt vmcnt(0)
    v_mfma_f32_16x16x32_bf16 v[148:151], v[140:143], v[44:47], v[148:151]
    v_mfma_f32_16x16x32_bf16 v[160:163], v[140:143], v[68:71], v[160:163]
    s_cmp_eq_u32 s37, 63
    s_nop 2
    s_cbranch_scc1 L_pxl_59
    s_add_u32 s90, s41, 49152
    v_max_f32 v18, v144, v145
    v_max3_f32 v18, v18, v146, v147
    v_max3_f32 v18, v18, v148, v149
    v_mov_b32 v19, v18
    buffer_load_dwordx4 v[72:75], v10, s[4:7], s90 offen offset:0 sc1
    s_nop 0
    v_permlane16_swap_b32 v18, v19
    v_max_f32 v18, v18, v19
    v_mov_b32 v19, v18
    s_nop 1
    v_permlane32_swap_b32 v18, v19
    buffer_load_dwordx4 v[76:79], v10, s[4:7], s90 offen offset:1024 sc1
    v_max_f32 v18, v18, v19
    v_sub_f32 v144, v144, v18
    v_sub_f32 v145, v145, v18
    v_sub_f32 v146, v146, v18
    buffer_load_dwordx4 v[80:83], v10, s[4:7], s90 offen offset:2048 sc1
    v_sub_f32 v147, v147, v18
    v_sub_f32 v148, v148, v18
    v_sub_f32 v149, v149, v18
    v_mul_f32 v144, s44, v144
    buffer_load_dwordx4 v[84:87], v10, s[4:7], s90 offen offset:3072 sc1
    v_mul_f32 v145, s44, v145
    v_mul_f32 v146, s44, v146
    v_mul_f32 v147, s44, v147
    v_mul_f32 v148, s44, v148
    s_add_u32 s90, s41, 53248
    v_mul_f32 v149, s44, v149
    v_exp_f32 v144, v144
    v_exp_f32 v145, v145
    v_exp_f32 v146, v146
    buffer_load_dwordx4 v[88:91], v10, s[4:7], s90 offen offset:0 sc1
    v_exp_f32 v147, v147
    v_exp_f32 v148, v148
    v_exp_f32 v149, v149
    v_add_f32 v20, v144, v145
    buffer_load_dwordx4 v[92:95], v10, s[4:7], s90 offen offset:1024 sc1
    v_add_f32 v20, v20, v146
    v_add_f32 v20, v20, v147
    v_add_f32 v20, v20, v148
    v_add_f32 v20, v20, v149
    buffer_load_dwordx4 v[96:99], v10, s[4:7], s90 offen offset:2048 sc1
    v_mov_b32 v19, v20
    s_nop 1
    v_permlane16_swap_b32 v20, v19
    v_add_f32 v20, v20, v19
    v_mov_b32 v19, v20
    buffer_load_dwordx4 v[100:103], v10, s[4:7], s90 offen offset:3072 sc1
    s_nop 0
    v_permlane32_swap_b32 v20, v19
    v_add_f32 v20, v20, v19
    v_rcp_f32 v20, v20
    s_nop 0
    v_mul_f32 v144, v144, v20
    s_add_u32 s90, s41, 57344
    v_mul_f32 v145, v145, v20
    v_mul_f32 v146, v146, v20
    v_mul_f32 v147, v147, v20
    v_mul_f32 v148, v148, v20
    buffer_load_dwordx4 v[104:107], v10, s[4:7], s90 offen offset:0 sc1
    v_mul_f32 v149, v149, v20
    v_cvt_pk_bf16_f32 v164, v144, v145
    v_cvt_pk_bf16_f32 v165, v146, v147
    v_cvt_pk_bf16_f32 v166, v148, v149
    buffer_load_dwordx4 v[108:111], v10, s[4:7], s90 offen offset:1024 sc1
    v_max_f32 v18, v152, v153
    v_max3_f32 v18, v18, v154, v155
    v_max3_f32 v18, v18, v160, v161
    v_max3_f32 v18, v18, v156, v157
    buffer_load_dwordx4 v[112:115], v10, s[4:7], s90 offen offset:2048 sc1
    v_max3_f32 v18, v18, v158, v159
    v_mov_b32 v19, v18
    s_nop 1
    v_permlane16_swap_b32 v18, v19
    v_max_f32 v18, v18, v19
    buffer_load_dwordx4 v[116:119], v10, s[4:7], s90 offen offset:3072 sc1
    v_mov_b32 v19, v18
    s_nop 1
    v_permlane32_swap_b32 v18, v19
    v_max_f32 v18, v18, v19
    v_sub_f32 v152, v152, v18
    s_add_u32 s90, s41, 0
    v_sub_f32 v153, v153, v18
    v_sub_f32 v154, v154, v18
    v_sub_f32 v155, v155, v18
    v_sub_f32 v160, v160, v18
    buffer_load_dwordx4 v[24:27], v10, s[4:7], s90 offen offset:0 sc1
    v_sub_f32 v161, v161, v18
    v_sub_f32 v156, v156, v18
    v_sub_f32 v157, v157, v18
    v_sub_f32 v158, v158, v18
    buffer_load_dwordx4 v[28:31], v10, s[4:7], s90 offen offset:1024 sc1
    v_sub_f32 v159, v159, v18
    v_mul_f32 v152, s44, v152
    v_mul_f32 v153, s44, v153
    v_mul_f32 v154, s44, v154
    buffer_load_dwordx4 v[32:35], v10, s[4:7], s90 offen offset:2048 sc1
    v_mul_f32 v155, s44, v155
    v_mul_f32 v160, s44, v160
    v_mul_f32 v161, s44, v161
    v_mul_f32 v156, s44, v156
    buffer_load_dwordx4 v[36:39], v10, s[4:7], s90 offen offset:3072 sc1
    v_mul_f32 v157, s44, v157
    v_mul_f32 v158, s44, v158
    v_mul_f32 v159, s44, v159
    v_exp_f32 v152, v152
    s_add_u32 s90, s41, 4096
    v_exp_f32 v153, v153
    v_exp_f32 v154, v154
    v_exp_f32 v155, v155
    v_exp_f32 v160, v160
    buffer_load_dwordx4 v[40:43], v10, s[4:7], s90 offen offset:0 sc1
    v_exp_f32 v161, v161
    v_exp_f32 v156, v156
    v_exp_f32 v157, v157
    v_exp_f32 v158, v158
    buffer_load_dwordx4 v[44:47], v10, s[4:7], s90 offen offset:1024 sc1
    v_exp_f32 v159, v159
    v_add_f32 v20, v152, v153
    v_add_f32 v20, v20, v154
    v_add_f32 v20, v20, v155
    buffer_load_dwordx4 v[48:51], v10, s[4:7], s90 offen offset:2048 sc1
    v_add_f32 v20, v20, v160
    v_add_f32 v20, v20, v161
    v_add_f32 v20, v20, v156
    v_add_f32 v20, v20, v157
    buffer_load_dwordx4 v[52:55], v10, s[4:7], s90 offen offset:3072 sc1
    v_add_f32 v20, v20, v158
    v_add_f32 v20, v20, v159
    v_mov_b32 v19, v20
    s_nop 1
    v_permlane16_swap_b32 v20, v19
    s_add_u32 s90, s41, 8192
    v_add_f32 v20, v20, v19
    v_mov_b32 v19, v20
    s_nop 1
    v_permlane32_swap_b32 v20, v19
    v_add_f32 v20, v20, v19
    buffer_load_dwordx4 v[56:59], v10, s[4:7], s90 offen offset:0 sc1
    v_rcp_f32 v20, v20
    s_nop 0
    v_mul_f32 v152, v152, v20
    v_mul_f32 v153, v153, v20
    v_mul_f32 v154, v154, v20
    buffer_load_dwordx4 v[60:63], v10, s[4:7], s90 offen offset:1024 sc1
    v_mul_f32 v155, v155, v20
    v_mul_f32 v160, v160, v20
    v_mul_f32 v161, v161, v20
    v_mul_f32 v156, v156, v20
    buffer_load_dwordx4 v[64:67], v10, s[4:7], s90 offen offset:2048 sc1
    v_mul_f32 v157, v157, v20
    v_mul_f32 v158, v158, v20
    v_mul_f32 v159, v159, v20
    v_cvt_pk_bf16_f32 v168, v152, v153
    buffer_load_dwordx4 v[68:71], v10, s[4:7], s90 offen offset:3072 sc1
    v_cvt_pk_bf16_f32 v169, v154, v155
    v_cvt_pk_bf16_f32 v170, v160, v161
    v_cvt_pk_bf16_f32 v172, v156, v157
    v_cvt_pk_bf16_f32 v173, v158, v159
    buffer_store_dwordx4 v[164:167], v12, s[4:7], s43 offen offset:0
    buffer_store_dwordx4 v[168:171], v12, s[4:7], s43 offen offset:1024
    buffer_store_dwordx4 v[172:175], v12, s[4:7], s43 offen offset:2048
    s_waitcnt vmcnt(0)
    buffer_store_dword v17, v15, s[4:7], s38 offen
    s_add_u32 s37, s37, 1
    s_branch L_px_loop_f
L_pxl_59:
    v_max_f32 v18, v144, v145
    v_max3_f32 v18, v18, v146, v147
    v_max3_f32 v18, v18, v148, v149
    v_mov_b32 v19, v18
    s_nop 1
    v_permlane16_swap_b32 v18, v19
    v_max_f32 v18, v18, v19
    v_mov_b32 v19, v18
    s_nop 1
    v_permlane32_swap_b32 v18, v19
    v_max_f32 v18, v18, v19
    v_sub_f32 v144, v144, v18
    v_sub_f32 v145, v145, v18
    v_sub_f32 v146, v146, v18
    v_sub_f32 v147, v147, v18
    v_sub_f32 v148, v148, v18
    v_sub_f32 v149, v149, v18
    v_mul_f32 v144, s44, v144
    v_mul_f32 v145, s44, v145
    v_mul_f32 v146, s44, v146
    v_mul_f32 v147, s44, v147
    v_mul_f32 v148, s44, v148
    v_mul_f32 v149, s44, v149
    v_exp_f32 v144, v144
    v_exp_f32 v145, v145
    v_exp_f32 v146, v146
    v_exp_f32 v147, v147
    v_exp_f32 v148, v148
    v_exp_f32 v149, v149
    v_add_f32 v20, v144, v145
    v_add_f32 v20, v20, v146
    v_add_f32 v20, v20, v147
    v_add_f32 v20, v20, v148
    v_add_f32 v20, v20, v149
    v_mov_b32 v19, v20
    s_nop 1
    v_permlane16_swap_b32 v20, v19
    v_add_f32 v20, v20, v19
    v_mov_b32 v19, v20
    s_nop 1
    v_permlane32_swap_b32 v20, v19
    v_add_f32 v20, v20, v19
    v_rcp_f32 v20, v20
    s_nop 0
    v_mul_f32 v144, v144, v20
    v_mul_f32 v145, v145, v20
    v_mul_f32 v146, v146, v20
    v_mul_f32 v147, v147, v20
    v_mul_f32 v148, v148, v20
    v_mul_f32 v149, v149, v20
    v_cvt_pk_bf16_f32 v164, v144, v145
    v_cvt_pk_bf16_f32 v165, v146, v147
    v_cvt_pk_bf16_f32 v166, v148, v149
    v_max_f32 v18, v152, v153
    v_max3_f32 v18, v18, v154, v155
    v_max3_f32 v18, v18, v160, v161
    v_max3_f32 v18, v18, v156, v157
    v_max3_f32 v18, v18, v158, v159
    v_mov_b32 v19, v18
    s_nop 1
    v_permlane16_swap_b32 v18, v19
    v_max_f32 v18, v18, v19
    v_mov_b32 v19, v18
    s_nop 1
    v_permlane32_swap_b32 v18, v19
    v_max_f32 v18, v18, v19
    v_sub_f32 v152, v152, v18
    v_sub_f32 v153, v153, v18
    v_sub_f32 v154, v154, v18
    v_sub_f32 v155, v155, v18
    v_sub_f32 v160, v160, v18
    v_sub_f32 v161, v161, v18
    v_sub_f32 v156, v156, v18
    v_sub_f32 v157, v157, v18
    v_sub_f32 v158, v158, v18
    v_sub_f32 v159, v159, v18
    v_mul_f32 v152, s44, v152
    v_mul_f32 v153, s44, v153
    v_mul_f32 v154, s44, v154
    v_mul_f32 v155, s44, v155
    v_mul_f32 v160, s44, v160
    v_mul_f32 v161, s44, v161
    v_mul_f32 v156, s44, v156
    v_mul_f32 v157, s44, v157
    v_mul_f32 v158, s44, v158
    v_mul_f32 v159, s44, v159
    v_exp_f32 v152, v152
    v_exp_f32 v153, v153
    v_exp_f32 v154, v154
    v_exp_f32 v155, v155
    v_exp_f32 v160, v160
    v_exp_f32 v161, v161
    v_exp_f32 v156, v156
    v_exp_f32 v157, v157
    v_exp_f32 v158, v158
    v_exp_f32 v159, v159
    v_add_f32 v20, v152, v153
    v_add_f32 v20, v20, v154
    v_add_f32 v20, v20, v155
    v_add_f32 v20, v20, v160
    v_add_f32 v20, v20, v161
    v_add_f32 v20, v20, v156
    v_add_f32 v20, v20, v157
    v_add_f32 v20, v20, v158
    v_add_f32 v20, v20, v159
    v_mov_b32 v19, v20
    s_nop 1
    v_permlane16_swap_b32 v20, v19
    v_add_f32 v20, v20, v19
    v_mov_b32 v19, v20
    s_nop 1
    v_permlane32_swap_b32 v20, v19
    v_add_f32 v20, v20, v19
    v_rcp_f32 v20, v20
    s_nop 0
    v_mul_f32 v152, v152, v20
    v_mul_f32 v153, v153, v20
    v_mul_f32 v154, v154, v20
    v_mul_f32 v155, v155, v20
    v_mul_f32 v160, v160, v20
    v_mul_f32 v161, v161, v20
    v_mul_f32 v156, v156, v20
    v_mul_f32 v157, v157, v20
    v_mul_f32 v158, v158, v20
    v_mul_f32 v159, v159, v20
    v_cvt_pk_bf16_f32 v168, v152, v153
    v_cvt_pk_bf16_f32 v169, v154, v155
    v_cvt_pk_bf16_f32 v170, v160, v161
    v_cvt_pk_bf16_f32 v172, v156, v157
    v_cvt_pk_bf16_f32 v173, v158, v159
    buffer_store_dwordx4 v[164:167], v12, s[4:7], s43 offen offset:0
    buffer_store_dwordx4 v[168:171], v12, s[4:7], s43 offen offset:1024
    buffer_store_dwordx4 v[172:175], v12, s[4:7], s43 offen offset:2048
    s_waitcnt vmcnt(0)
    buffer_store_dword v17, v15, s[4:7], s38 offen
    s_endpgm
L_pa_f:
    s_mov_b32 s24, s70
    s_and_b32 s25, s71, 0xffff
    s_mov_b32 s26, 2621440
    s_mov_b32 s27, 0x20000
    s_sub_u32 s93, s35, 29
    s_lshl_b32 s93, s93, 2
    s_add_u32 s93, s93, s32
    s_lshl_b32 s93, s93, 11
    v_lshl_add_u32 v4, v0, 4, s93
    v_mov_b32 v1, 192
L_gw_60:
    buffer_load_dword v2, v1, s[8:11], 0 offen sc1
    s_sub_u32 s36, s36, 1
    s_cbranch_scc1 L_exit
    s_waitcnt vmcnt(0)
L_gw_60c:
    v_readfirstlane_b32 s90, v2
    s_nop 0
    s_cmp_eq_u32 s90, 0
    s_cbranch_scc1 L_gw_60
    s_cmp_lg_u32 s90, 1
    s_cbranch_scc1 L_slow
    s_mov_b32 s92, 0
L_tch_61:
    s_add_u32 s91, s92, s38
    buffer_load_dwordx4 v[248:251], v4, s[4:7], s91 offen
    buffer_load_dwordx4 v[248:251], v4, s[4:7], s91 offen offset:1024
    s_add_u32 s92, s92, 24576
    s_waitcnt vmcnt(24)
    s_cmp_lt_u32 s92, 475136
    s_cbranch_scc1 L_tch_61
    s_mov_b32 s92, 81920
L_tch_62:
    s_add_u32 s91, s92, 0
    buffer_load_dwordx4 v[248:251], v4, s[24:27], s91 offen
    buffer_load_dwordx4 v[248:251], v4, s[24:27], s91 offen offset:1024
    s_add_u32 s92, s92, 24576
    s_waitcnt vmcnt(24)
    s_cmp_lt_u32 s92, 245760
    s_cbranch_scc1 L_tch_62
    s_mov_b32 s92, 475136
L_tch_63:
    s_add_u32 s91, s92, s38
    buffer_load_dwordx4 v[248:251], v4, s[4:7], s91 offen
    buffer_load_dwordx4 v[248:251], v4, s[4:7], s91 offen offset:1024
    s_add_u32 s92, s92, 24576
    s_waitcnt vmcnt(24)
    s_cmp_lt_u32 s92, 1048576
    s_cbranch_scc1 L_tch_63
    s_waitcnt vmcnt(0)
    s_branch L_pa_body
L_pa_body:
    s_sub_u32 s90, s35, 29
    s_cmp_ge_u32 s90, 3
    s_cbranch_scc1 L_pa_end
    s_mul_i32 s52, s90, 3
    s_add_u32 s52, s52, s34
    s_and_b32 s52, s52, 7
    s_cmp_eq_u32 s90, 0
    s_cselect_b32 s91, 0x76543210, 0
    s_cmp_eq_u32 s90, 1
    s_cselect_b32 s91, 0x54c321b0, s91
    s_cmp_eq_u32 s90, 2
    s_cselect_b32 s91, 0xf9ea87d6, s91
    s_lshl_b32 s92, s34, 2
    s_lshr_b32 s91, s91, s92
    s_and_b32 s91, s91, 15
    s_min_u32 s90, s90, 1
    s_lshl_b32 s90, s90, 3
    s_add_u32 s54, s90, s91
    s_mul_i32 s40, s54, 112
    s_lshl_b32 s90, s32, 5
    s_add_u32 s40, s40, s90
    s_sub_u32 s40, s40, 16
    s_mov_b32 s12, s64
    s_and_b32 s13, s65, 0xffff
    s_mov_b32 s14, 2621440
    s_mov_b32 s15, 0x20000
    s_mov_b32 s16, s66
    s_and_b32 s17, s67, 0xffff
    s_mov_b32 s18, 2457600
    s_mov_b32 s19, 0x20000
    s_mov_b32 s20, s68
    s_and_b32 s21, s69, 0xffff
    s_mov_b32 s22, 819200
    s_mov_b32 s23, 0x20000
    v_and_b32 v1, 15, v0
    v_lshrrev_b32 v2, 4, v0
    s_add_u32 s90, s40, 0
    v_add_u32 v3, s90, v1
    v_cmp_gt_u32 vcc, 2048, v3
    v_mul_u32_u24 v3, 1280, v3
    v_lshl_add_u32 v3, v2, 4, v3
    v_mov_b32 v4, 2146435072
    v_cndmask_b32 v3, v4, v3, vcc
    buffer_load_dwordx4 a[0:3], v3, s[12:15], 0 offen offset:0
    buffer_load_dwordx4 a[4:7], v3, s[12:15], 0 offen offset:64
    buffer_load_dwordx4 a[8:11], v3, s[12:15], 0 offen offset:128
    buffer_load_dwordx4 a[12:15], v3, s[12:15], 0 offen offset:192
    buffer_load_dwordx4 a[16:19], v3, s[12:15], 0 offen offset:256
    buffer_load_dwordx4 a[20:23], v3, s[12:15], 0 offen offset:320
    buffer_load_dwordx4 a[24:27], v3, s[12:15], 0 offen offset:384
    buffer_load_dwordx4 a[28:31], v3, s[12:15], 0 offen offset:448
    buffer_load_dwordx4 a[32:35], v3, s[12:15], 0 offen offset:512
    buffer_load_dwordx4 a[36:39], v3, s[12:15], 0 offen offset:576
    buffer_load_dwordx4 a[40:43], v3, s[12:15], 0 offen offset:640
    buffer_load_dwordx4 a[44:47], v3, s[12:15], 0 offen offset:704
    buffer_load_dwordx4 a[48:51], v3, s[12:15], 0 offen offset:768
    buffer_load_dwordx4 a[52:55], v3, s[12:15], 0 offen offset:832
    buffer_load_dwordx4 a[56:59], v3, s[12:15], 0 offen offset:896
    buffer_load_dwordx4 a[60:63], v3, s[12:15], 0 offen offset:960
    buffer_load_dwordx4 a[64:67], v3, s[12:15], 0 offen offset:1024
    buffer_load_dwordx4 a[68:71], v3, s[12:15], 0 offen offset:1088
    buffer_load_dwordx4 a[72:75], v3, s[12:15], 0 offen offset:1152
    buffer_load_dwordx4 a[76:79], v3, s[12:15], 0 offen offset:1216
    s_add_u32 s90, s40, 16
    v_add_u32 v3, s90, v1
    v_cmp_gt_u32 vcc, 2048, v3
    v_mul_u32_u24 v3, 1280, v3
    v_lshl_add_u32 v3, v2, 4, v3
    v_mov_b32 v4, 2146435072
    v_cndmask_b32 v3, v4, v3, vcc
    buffer_load_dwordx4 a[80:83], v3, s[12:15], 0 offen offset:0
    buffer_load_dwordx4 a[84:87], v3, s[12:15], 0 offen offset:64
    buffer_load_dwordx4 a[88:91], v3, s[12:15], 0 offen offset:128
    buffer_load_dwordx4 a[92:95], v3, s[12:15], 0 offen offset:192
    buffer_load_dwordx4 a[96:99], v3, s[12:15], 0 offen offset:256
    buffer_load_dwordx4 a[100:103], v3, s[12:15], 0 offen offset:320
    buffer_load_dwordx4 a[104:107], v3, s[12:15], 0 offen offset:384
    buffer_load_dwordx4 a[108:111], v3, s[12:15], 0 offen offset:448
    buffer_load_dwordx4 a[112:115], v3, s[12:15], 0 offen offset:512
    buffer_load_dwordx4 a[116:119], v3, s[12:15], 0 offen offset:576
    buffer_load_dwordx4 a[120:123], v3, s[12:15], 0 offen offset:640
    buffer_load_dwordx4 a[124:127], v3, s[12:15], 0 offen offset:704
    buffer_load_dwordx4 a[128:131], v3, s[12:15], 0 offen offset:768
    buffer_load_dwordx4 a[132:135], v3, s[12:15], 0 offen offset:832
    buffer_load_dwordx4 a[136:139], v3, s[12:15], 0 offen offset:896
    buffer_load_dwordx4 a[140:143], v3, s[12:15], 0 offen offset:960
    buffer_load_dwordx4 a[144:147], v3, s[12:15], 0 offen offset:1024
    buffer_load_dwordx4 a[148:151], v3, s[12:15], 0 offen offset:1088
    buffer_load_dwordx4 a[152:155], v3, s[12:15], 0 offen offset:1152
    buffer_load_dwordx4 a[156:159], v3, s[12:15], 0 offen offset:1216
    v_add_u32 v3, 0, v0
    v_mul_u32_u24 v4, 6554, v3
    v_lshrrev_b32 v4, 16, v4
    v_mul_u32_u24 v5, 10, v4
    v_sub_u32 v5, v3, v5
    v_and_b32 v6, 19, v4
    v_and_b32 v7, 4, v4
    v_lshl_or_b32 v6, v7, 1, v6
    v_and_b32 v7, 8, v4
    v_lshrrev_b32 v7, 1, v7
    v_or_b32 v6, v6, v7
    s_lshl_b32 s90, s32, 5
    v_add_u32 v6, s90, v6
    v_mul_u32_u24 v6, 3840, v6
    v_lshl_add_u32 v10, v5, 4, v6
    v_add_u32 v3, 64, v0
    v_mul_u32_u24 v4, 6554, v3
    v_lshrrev_b32 v4, 16, v4
    v_mul_u32_u24 v5, 10, v4
    v_sub_u32 v5, v3, v5
    v_and_b32 v6, 19, v4
    v_and_b32 v7, 4, v4
    v_lshl_or_b32 v6, v7, 1, v6
    v_and_b32 v7, 8, v4
    v_lshrrev_b32 v7, 1, v7
    v_or_b32 v6, v6, v7
    s_lshl_b32 s90, s32, 5
    v_add_u32 v6, s90, v6
    v_mul_u32_u24 v6, 3840, v6
    v_lshl_add_u32 v11, v5, 4, v6
    v_add_u32 v3, 128, v0
    v_mul_u32_u24 v4, 6554, v3
    v_lshrrev_b32 v4, 16, v4
    v_mul_u32_u24 v5, 10, v4
    v_sub_u32 v5, v3, v5
    v_and_b32 v6, 19, v4
    v_and_b32 v7, 4, v4
    v_lshl_or_b32 v6, v7, 1, v6
    v_and_b32 v7, 8, v4
    v_lshrrev_b32 v7, 1, v7
    v_or_b32 v6, v6, v7
    s_lshl_b32 s90, s32, 5
    v_add_u32 v6, s90, v6
    v_mul_u32_u24 v6, 3840, v6
    v_lshl_add_u32 v12, v5, 4, v6
    v_add_u32 v3, 192, v0
    v_mul_u32_u24 v4, 6554, v3
    v_lshrrev_b32 v4, 16, v4
    v_mul_u32_u24 v5, 10, v4
    v_sub_u32 v5, v3, v5
    v_and_b32 v6, 19, v4
    v_and_b32 v7, 4, v4
    v_lshl_or_b32 v6, v7, 1, v6
    v_and_b32 v7, 8, v4
    v_lshrrev_b32 v7, 1, v7
    v_or_b32 v6, v6, v7
    s_lshl_b32 s90, s32, 5
    v_add_u32 v6, s90, v6
    v_mul_u32_u24 v6, 3840, v6
    v_lshl_add_u32 v13, v5, 4, v6
    v_add_u32 v3, 256, v0
    v_mul_u32_u24 v4, 6554, v3
    v_lshrrev_b32 v4, 16, v4
    v_mul_u32_u24 v5, 10, v4
    v_sub_u32 v5, v3, v5
    v_and_b32 v6, 19, v4
    v_and_b32 v7, 4, v4
    v_lshl_or_b32 v6, v7, 1, v6
    v_and_b32 v7, 8, v4
    v_lshrrev_b32 v7, 1, v7
    v_or_b32 v6, v6, v7
    s_lshl_b32 s90, s32, 5
    v_add_u32 v6, s90, v6
    v_mul_u32_u24 v6, 3840, v6
    v_lshl_add_u32 v14, v5, 4, v6
    v_lshrrev_b32 v3, 2, v1
    v_and_b32 v4, 3, v1
    v_and_b32 v5, 1, v2
    v_lshl_add_u32 v3, v5, 2, v3
    v_lshrrev_b32 v6, 1, v2
    v_lshl_add_u32 v3, v6, 4, v3
    v_mul_u32_u24 v3, 160, v3
    v_lshl_add_u32 v15, v4, 3, v3
    s_lshl_b32 s90, s32, 5
    v_add_u32 v3, s90, v1
    v_mul_u32_u24 v3, 168, v3
    v_add_u32 v3, 81920, v3
    v_lshl_add_u32 v17, v2, 3, v3
    v_lshl_add_u32 v28, v2, 4, v3
    v_add_u32 v28, -32, v28
    v_lshl_add_u32 v3, v5, 4, v1
    v_add_u32 v4, s90, v3
    v_add_u32 v3, s40, v3
    v_cmp_le_u32 s[92:93], 16, v4
    v_cmp_gt_u32 vcc, 2048, v3
    s_nop 0
    s_and_b64 vcc, vcc, s[92:93]
    v_mul_u32_u24 v3, 2560, v3
    v_lshl_add_u32 v3, v6, 4, v3
    v_mov_b32 v4, 2146435072
    v_cndmask_b32 v19, v4, v3, vcc
    v_and_b32 v3, 31, v0
    v_add_u32 v24, s40, v3
    v_add_u32 v3, s90, v3
    v_mul_u32_u24 v3, 168, v3
    v_lshrrev_b32 v4, 5, v0
    v_mul_u32_u24 v4, 40, v4
    v_add_u32 v3, v3, v4
    v_add_u32 v20, 81920, v3
    v_add_u32 v21, 101072, v3
    v_mov_b32 v27, 0xcf8547b1
    s_mov_b32 s49, 0x3ea52b5c
    s_cmp_lt_u32 s54, 19
    s_cbranch_scc1 L_pa_rows
    s_mov_b32 s24, s70
    s_and_b32 s25, s71, 0xffff
    s_mov_b32 s26, 2621440
    s_mov_b32 s27, 0x20000
    s_sub_u32 s90, s54, 19
    s_lshl_b32 s90, s90, 2
    s_add_u32 s90, s90, s32
    s_lshl_b32 s90, s90, 11
    v_lshl_add_u32 v3, v0, 4, s90
    s_mov_b32 s91, 245760
L_pa_xw:
    buffer_load_dwordx4 v[248:251], v3, s[24:27], s91 offen
    buffer_load_dwordx4 v[248:251], v3, s[24:27], s91 offen offset:1024
    s_add_u32 s91, s91, 40960
    s_waitcnt vmcnt(20)
    s_cmp_lt_u32 s91, 2621440
    s_cbranch_scc1 L_pa_xw
    s_branch L_pa_end
    s_mov_b32 s46, 0
    s_mov_b32 s47, 0
    s_mul_i32 s43, s52, 160
    s_mov_b32 s44, 0
    s_mov_b32 s45, 0
    s_mov_b32 s51, 45
    s_mov_b32 s48, s52
    s_mov_b32 s53, 0
L_pa_pf_64:
    s_mul_i32 s90, s32, 5120
    s_add_u32 m0, s90, s47
    s_mul_i32 s91, s44, 491520
    s_add_u32 s91, s91, s43
    buffer_load_dwordx4 v[248:251], v10, s[16:19], s91 offen
    s_add_u32 s47, s47, 20480
    s_cmp_eq_u32 s47, 81920
    s_cselect_b32 s47, 0, s47
    s_cmp_lg_u32 s51, 0
    s_cselect_b32 s90, 1, 0
    s_sub_u32 s51, s51, s90
    s_add_u32 s44, s44, s90
    s_cmp_eq_u32 s44, 5
    s_cselect_b32 s44, 0, s44
    s_cselect_b32 s90, 1280, 0
    s_addc_u32 s45, s45, 0
    s_add_u32 s43, s43, s90
    s_cmp_eq_u32 s45, 3
    s_cselect_b32 s45, 0, s45
    s_cselect_b32 s90, 3680, 0
    s_cmp_eq_u32 s43, 4960
    s_cselect_b32 s90, s43, s90
    s_sub_u32 s43, s43, s90
    s_add_u32 m0, m0, 1024
    buffer_load_dwordx4 v[248:251], v11, s[16:19], s91 offen
    s_add_u32 m0, m0, 1024
    buffer_load_dwordx4 v[248:251], v12, s[16:19], s91 offen
    s_add_u32 m0, m0, 1024
    buffer_load_dwordx4 v[248:251], v13, s[16:19], s91 offen
    s_add_u32 m0, m0, 1024
    buffer_load_dwordx4 v[248:251], v14, s[16:19], s91 offen
    s_waitcnt vmcnt(20)
    s_cmp_lg_u32 s51, 0
    s_cbranch_scc1 L_pa_pf_64
    v_add_u32 v3, 0, v0
    v_mul_u32_u24 v4, 6554, v3
    v_lshrrev_b32 v4, 16, v4
    v_mul_u32_u24 v5, 10, v4
    v_sub_u32 v5, v3, v5
    v_and_b32 v6, 19, v4
    v_and_b32 v7, 4, v4
    v_lshl_or_b32 v6, v7, 1, v6
    v_and_b32 v7, 8, v4
    v_lshrrev_b32 v7, 1, v7
    v_or_b32 v6, v6, v7
    s_lshl_b32 s90, s32, 5
    v_add_u32 v6, s90, v6
    v_mul_u32_u24 v6, 1280, v6
    v_lshl_add_u32 v10, v5, 4, v6
    v_add_u32 v3, 64, v0
    v_mul_u32_u24 v4, 6554, v3
    v_lshrrev_b32 v4, 16, v4
    v_mul_u32_u24 v5, 10, v4
    v_sub_u32 v5, v3, v5
    v_and_b32 v6, 19, v4
    v_and_b32 v7, 4, v4
    v_lshl_or_b32 v6, v7, 1, v6
    v_and_b32 v7, 8, v4
    v_lshrrev_b32 v7, 1, v7
    v_or_b32 v6, v6, v7
    s_lshl_b32 s90, s32, 5
    v_add_u32 v6, s90, v6
    v_mul_u32_u24 v6, 1280, v6
    v_lshl_add_u32 v11, v5, 4, v6
    v_add_u32 v3, 128, v0
    v_mul_u32_u24 v4, 6554, v3
    v_lshrrev_b32 v4, 16, v4
    v_mul_u32_u24 v5, 10, v4
    v_sub_u32 v5, v3, v5
    v_and_b32 v6, 19, v4
    v_and_b32 v7, 4, v4
    v_lshl_or_b32 v6, v7, 1, v6
    v_and_b32 v7, 8, v4
    v_lshrrev_b32 v7, 1, v7
    v_or_b32 v6, v6, v7
    s_lshl_b32 s90, s32, 5
    v_add_u32 v6, s90, v6
    v_mul_u32_u24 v6, 1280, v6
    v_lshl_add_u32 v12, v5, 4, v6
    v_add_u32 v3, 192, v0
    v_mul_u32_u24 v4, 6554, v3
    v_lshrrev_b32 v4, 16, v4
    v_mul_u32_u24 v5, 10, v4
    v_sub_u32 v5, v3, v5
    v_and_b32 v6, 19, v4
    v_and_b32 v7, 4, v4
    v_lshl_or_b32 v6, v7, 1, v6
    v_and_b32 v7, 8, v4
    v_lshrrev_b32 v7, 1, v7
    v_or_b32 v6, v6, v7
    s_lshl_b32 s90, s32, 5
    v_add_u32 v6, s90, v6
    v_mul_u32_u24 v6, 1280, v6
    v_lshl_add_u32 v13, v5, 4, v6
    v_add_u32 v3, 256, v0
    v_mul_u32_u24 v4, 6554, v3
    v_lshrrev_b32 v4, 16, v4
    v_mul_u32_u24 v5, 10, v4
    v_sub_u32 v5, v3, v5
    v_and_b32 v6, 19, v4
    v_and_b32 v7, 4, v4
    v_lshl_or_b32 v6, v7, 1, v6
    v_and_b32 v7, 8, v4
    v_lshrrev_b32 v7, 1, v7
    v_or_b32 v6, v6, v7
    s_lshl_b32 s90, s32, 5
    v_add_u32 v6, s90, v6
    v_mul_u32_u24 v6, 1280, v6
    v_lshl_add_u32 v14, v5, 4, v6
    s_mov_b32 s46, 0
    s_mov_b32 s47, 0
    s_mul_i32 s43, s52, 160
    s_mov_b32 s44, 0
    s_mov_b32 s45, 0
    s_mov_b32 s51, 40
    s_mov_b32 s48, s52
    s_mov_b32 s53, 0
L_pa_pf_65:
    s_mul_i32 s90, s32, 5120
    s_add_u32 m0, s90, s47
    s_mul_i32 s91, s44, 163840
    s_add_u32 s91, s91, s43
    buffer_load_dwordx4 v[248:251], v10, s[20:23], s91 offen
    s_add_u32 s47, s47, 20480
    s_cmp_eq_u32 s47, 81920
    s_cselect_b32 s47, 0, s47
    s_cmp_lg_u32 s51, 0
    s_cselect_b32 s90, 1, 0
    s_sub_u32 s51, s51, s90
    s_add_u32 s44, s44, s90
    s_cmp_eq_u32 s44, 5
    s_cselect_b32 s44, 0, s44
    s_cselect_b32 s90, 160, 0
    s_add_u32 s43, s43, s90
    s_cmp_eq_u32 s43, 1280
    s_cselect_b32 s43, 0, s43
    s_add_u32 m0, m0, 1024
    buffer_load_dwordx4 v[248:251], v11, s[20:23], s91 offen
    s_add_u32 m0, m0, 1024
    buffer_load_dwordx4 v[248:251], v12, s[20:23], s91 offen
    s_add_u32 m0, m0, 1024
    buffer_load_dwordx4 v[248:251], v13, s[20:23], s91 offen
    s_add_u32 m0, m0, 1024
    buffer_load_dwordx4 v[248:251], v14, s[20:23], s91 offen
    s_waitcnt vmcnt(20)
    s_cmp_lg_u32 s51, 0
    s_cbranch_scc1 L_pa_pf_65
    s_branch L_pa_end
L_pa_rows:
    s_mov_b32 s46, 0
    s_mov_b32 s47, 0
    s_mul_i32 s43, s52, 160
    s_mov_b32 s44, 0
    s_mov_b32 s45, 0
    s_mov_b32 s51, 119
    s_mov_b32 s48, s52
    s_mov_b32 s53, 0
    s_mul_i32 s90, s32, 5120
    s_add_u32 m0, s90, s47
    s_mul_i32 s91, s44, 491520
    s_add_u32 s91, s91, s43
    buffer_load_dwordx4 v10, s[16:19], s91 offen lds
    s_add_u32 s47, s47, 20480
    s_cmp_eq_u32 s47, 81920
    s_cselect_b32 s47, 0, s47
    s_cmp_lg_u32 s51, 0
    s_cselect_b32 s90, 1, 0
    s_sub_u32 s51, s51, s90
    s_add_u32 s44, s44, s90
    s_cmp_eq_u32 s44, 5
    s_cselect_b32 s44, 0, s44
    s_cselect_b32 s90, 1280, 0
    s_addc_u32 s45, s45, 0
    s_add_u32 s43, s43, s90
    s_cmp_eq_u32 s45, 3
    s_cselect_b32 s45, 0, s45
    s_cselect_b32 s90, 3680, 0
    s_cmp_eq_u32 s43, 4960
    s_cselect_b32 s90, s43, s90
    s_sub_u32 s43, s43, s90
    s_add_u32 m0, m0, 1024
    s_nop 0
    buffer_load_dwordx4 v11, s[16:19], s91 offen lds
    s_add_u32 m0, m0, 1024
    s_nop 0
    buffer_load_dwordx4 v12, s[16:19], s91 offen lds
    s_add_u32 m0, m0, 1024
    s_nop 0
    buffer_load_dwordx4 v13, s[16:19], s91 offen lds
    s_add_u32 m0, m0, 1024
    s_nop 0
    buffer_load_dwordx4 v14, s[16:19], s91 offen lds
    s_mul_i32 s90, s32, 5120
    s_add_u32 m0, s90, s47
    s_mul_i32 s91, s44, 491520
    s_add_u32 s91, s91, s43
    buffer_load_dwordx4 v10, s[16:19], s91 offen lds
    s_add_u32 s47, s47, 20480
    s_cmp_eq_u32 s47, 81920
    s_cselect_b32 s47, 0, s47
    s_cmp_lg_u32 s51, 0
    s_cselect_b32 s90, 1, 0
    s_sub_u32 s51, s51, s90
    s_add_u32 s44, s44, s90
    s_cmp_eq_u32 s44, 5
    s_cselect_b32 s44, 0, s44
    s_cselect_b32 s90, 1280, 0
    s_addc_u32 s45, s45, 0
    s_add_u32 s43, s43, s90
    s_cmp_eq_u32 s45, 3
    s_cselect_b32 s45, 0, s45
    s_cselect_b32 s90, 3680, 0
    s_cmp_eq_u32 s43, 4960
    s_cselect_b32 s90, s43, s90
    s_sub_u32 s43, s43, s90
    s_add_u32 m0, m0, 1024
    s_nop 0
    buffer_load_dwordx4 v11, s[16:19], s91 offen lds
    s_add_u32 m0, m0, 1024
    s_nop 0
    buffer_load_dwordx4 v12, s[16:19], s91 offen lds
    s_add_u32 m0, m0, 1024
    s_nop 0
    buffer_load_dwordx4 v13, s[16:19], s91 offen lds
    s_add_u32 m0, m0, 1024
    s_nop 0
    buffer_load_dwordx4 v14, s[16:19], s91 offen lds
    s_mul_i32 s90, s32, 5120
    s_add_u32 m0, s90, s47
    s_mul_i32 s91, s44, 491520
    s_add_u32 s91, s91, s43
    buffer_load_dwordx4 v10, s[16:19], s91 offen lds
    s_add_u32 s47, s47, 20480
    s_cmp_eq_u32 s47, 81920
    s_cselect_b32 s47, 0, s47
    s_cmp_lg_u32 s51, 0
    s_cselect_b32 s90, 1, 0
    s_sub_u32 s51, s51, s90
    s_add_u32 s44, s44, s90
    s_cmp_eq_u32 s44, 5
    s_cselect_b32 s44, 0, s44
    s_cselect_b32 s90, 1280, 0
    s_addc_u32 s45, s45, 0
    s_add_u32 s43, s43, s90
    s_cmp_eq_u32 s45, 3
    s_cselect_b32 s45, 0, s45
    s_cselect_b32 s90, 3680, 0
    s_cmp_eq_u32 s43, 4960
    s_cselect_b32 s90, s43, s90
    s_sub_u32 s43, s43, s90
    s_add_u32 m0, m0, 1024
    s_nop 0
    buffer_load_dwordx4 v11, s[16:19], s91 offen lds
    s_add_u32 m0, m0, 1024
    s_nop 0
    buffer_load_dwordx4 v12, s[16:19], s91 offen lds
    s_add_u32 m0, m0, 1024
    s_nop 0
    buffer_load_dwordx4 v13, s[16:19], s91 offen lds
    s_add_u32 m0, m0, 1024
    s_nop 0
    buffer_load_dwordx4 v14, s[16:19], s91 offen lds
    v_add_u32 v16, s46, v15
    s_waitcnt vmcnt(10) lgkmcnt(0)
    s_barrier
    ds_read_b64_tr_b16 v[96:97], v16 offset:0
    ds_read_b64_tr_b16 v[98:99], v16 offset:1280
    ds_read_b64_tr_b16 v[100:101], v16 offset:32
    ds_read_b64_tr_b16 v[102:103], v16 offset:1312
    ds_read_b64_tr_b16 v[104:105], v16 offset:64
    ds_read_b64_tr_b16 v[106:107], v16 offset:1344
    ds_read_b64_tr_b16 v[108:109], v16 offset:96
    ds_read_b64_tr_b16 v[110:111], v16 offset:1376
    ds_read_b64_tr_b16 v[112:113], v16 offset:128
    ds_read_b64_tr_b16 v[114:115], v16 offset:1408
L_pa_grp:
    s_mov_b32 s41, 0
L_pa_blk:
    s_waitcnt lgkmcnt(8)
    v_mfma_f32_16x16x32_bf16 v[136:139], v[96:99], a[0:3], 0
    ds_read_b64_tr_b16 v[116:117], v16 offset:5120
    s_add_u32 s46, s46, 20480
    s_cmp_eq_u32 s46, 81920
    v_mfma_f32_16x16x32_bf16 v[140:143], v[96:99], a[80:83], 0
    ds_read_b64_tr_b16 v[118:119], v16 offset:6400
    s_cselect_b32 s46, 0, s46
    s_mul_i32 s90, s32, 5120
    s_waitcnt lgkmcnt(8)
    v_mfma_f32_16x16x32_bf16 v[144:147], v[100:103], a[0:3], 0
    ds_read_b64_tr_b16 v[120:121], v16 offset:5152
    s_add_u32 m0, s90, s47
    s_mul_i32 s91, s44, 491520
    v_mfma_f32_16x16x32_bf16 v[148:151], v[100:103], a[80:83], 0
    ds_read_b64_tr_b16 v[122:123], v16 offset:6432
    s_add_u32 s91, s91, s43
    buffer_load_dwordx4 v10, s[16:19], s91 offen lds
    s_waitcnt lgkmcnt(8)
    v_mfma_f32_16x16x32_bf16 v[152:155], v[104:107], a[0:3], 0
    ds_read_b64_tr_b16 v[124:125], v16 offset:5184
    s_add_u32 s47, s47, 20480
    s_cmp_eq_u32 s47, 81920
    v_mfma_f32_16x16x32_bf16 v[156:159], v[104:107], a[80:83], 0
    ds_read_b64_tr_b16 v[126:127], v16 offset:6464
    s_cselect_b32 s47, 0, s47
    s_cmp_lg_u32 s51, 0
    s_waitcnt lgkmcnt(8)
    v_mfma_f32_16x16x32_bf16 v[160:163], v[108:111], a[0:3], 0
    ds_read_b64_tr_b16 v[128:129], v16 offset:5216
    s_cselect_b32 s90, 1, 0
    s_sub_u32 s51, s51, s90
    v_mfma_f32_16x16x32_bf16 v[164:167], v[108:111], a[80:83], 0
    ds_read_b64_tr_b16 v[130:131], v16 offset:6496
    s_add_u32 s44, s44, s90
    s_cmp_eq_u32 s44, 5
    s_waitcnt lgkmcnt(8)
    v_mfma_f32_16x16x32_bf16 v[168:171], v[112:115], a[0:3], 0
    ds_read_b64_tr_b16 v[132:133], v16 offset:5248
    s_cselect_b32 s44, 0, s44
    s_cselect_b32 s90, 1280, 0
    v_mfma_f32_16x16x32_bf16 v[172:175], v[112:115], a[80:83], 0
    ds_read_b64_tr_b16 v[134:135], v16 offset:6528
    s_addc_u32 s45, s45, 0
    s_add_u32 s43, s43, s90
    s_waitcnt lgkmcnt(8)
    v_mfma_f32_16x16x32_bf16 v[136:139], v[116:119], a[4:7], v[136:139]
    ds_read_b64_tr_b16 v[96:97], v16 offset:10240
    s_cmp_eq_u32 s45, 3
    s_cselect_b32 s45, 0, s45
    v_mfma_f32_16x16x32_bf16 v[140:143], v[116:119], a[84:87], v[140:143]
    ds_read_b64_tr_b16 v[98:99], v16 offset:11520
    s_cselect_b32 s90, 3680, 0
    s_cmp_eq_u32 s43, 4960
    s_waitcnt lgkmcnt(8)
    v_mfma_f32_16x16x32_bf16 v[144:147], v[120:123], a[4:7], v[144:147]
    ds_read_b64_tr_b16 v[100:101], v16 offset:10272
    s_cselect_b32 s90, s43, s90
    s_sub_u32 s43, s43, s90
    v_mfma_f32_16x16x32_bf16 v[148:151], v[120:123], a[84:87], v[148:151]
    ds_read_b64_tr_b16 v[102:103], v16 offset:11552
    s_add_u32 m0, m0, 1024
    s_nop 0
    buffer_load_dwordx4 v11, s[16:19], s91 offen lds
    s_waitcnt lgkmcnt(8)
    v_mfma_f32_16x16x32_bf16 v[152:155], v[124:127], a[4:7], v[152:155]
    ds_read_b64_tr_b16 v[104:105], v16 offset:10304
    s_add_u32 m0, m0, 1024
    v_mfma_f32_16x16x32_bf16 v[156:159], v[124:127], a[84:87], v[156:159]
    ds_read_b64_tr_b16 v[106:107], v16 offset:11584
    s_waitcnt lgkmcnt(8)
    v_mfma_f32_16x16x32_bf16 v[160:163], v[128:131], a[4:7], v[160:163]
    ds_read_b64_tr_b16 v[108:109], v16 offset:10336
    v_mfma_f32_16x16x32_bf16 v[164:167], v[128:131], a[84:87], v[164:167]
    ds_read_b64_tr_b16 v[110:111], v16 offset:11616
    s_waitcnt lgkmcnt(8)
    v_mfma_f32_16x16x32_bf16 v[168:171], v[132:135], a[4:7], v[168:171]
    ds_read_b64_tr_b16 v[112:113], v16 offset:10368
    buffer_load_dwordx4 v12, s[16:19], s91 offen lds
    s_add_u32 m0, m0, 1024
    v_mfma_f32_16x16x32_bf16 v[172:175], v[132:135], a[84:87], v[172:175]
    ds_read_b64_tr_b16 v[114:115], v16 offset:11648
    s_waitcnt lgkmcnt(8)
    v_mfma_f32_16x16x32_bf16 v[136:139], v[96:99], a[8:11], v[136:139]
    ds_read_b64_tr_b16 v[116:117], v16 offset:15360
    v_mfma_f32_16x16x32_bf16 v[140:143], v[96:99], a[88:91], v[140:143]
    ds_read_b64_tr_b16 v[118:119], v16 offset:16640
    s_waitcnt lgkmcnt(8)
    v_mfma_f32_16x16x32_bf16 v[144:147], v[100:103], a[8:11], v[144:147]
    ds_read_b64_tr_b16 v[120:121], v16 offset:15392
    v_mfma_f32_16x16x32_bf16 v[148:151], v[100:103], a[88:91], v[148:151]
    ds_read_b64_tr_b16 v[122:123], v16 offset:16672
    buffer_load_dwordx4 v13, s[16:19], s91 offen lds
    s_add_u32 m0, m0, 1024
    s_waitcnt lgkmcnt(8)
    v_mfma_f32_16x16x32_bf16 v[152:155], v[104:107], a[8:11], v[152:155]
    ds_read_b64_tr_b16 v[124:125], v16 offset:15424
    v_mfma_f32_16x16x32_bf16 v[156:159], v[104:107], a[88:91], v[156:159]
    ds_read_b64_tr_b16 v[126:127], v16 offset:16704
    s_waitcnt lgkmcnt(8)
    v_mfma_f32_16x16x32_bf16 v[160:163], v[108:111], a[8:11], v[160:163]
    ds_read_b64_tr_b16 v[128:129], v16 offset:15456
    v_mfma_f32_16x16x32_bf16 v[164:167], v[108:111], a[88:91], v[164:167]
    ds_read_b64_tr_b16 v[130:131], v16 offset:16736
    s_waitcnt lgkmcnt(8)
    v_mfma_f32_16x16x32_bf16 v[168:171], v[112:115], a[8:11], v[168:171]
    ds_read_b64_tr_b16 v[132:133], v16 offset:15488
    buffer_load_dwordx4 v14, s[16:19], s91 offen lds
    v_mfma_f32_16x16x32_bf16 v[172:175], v[112:115], a[88:91], v[172:175]
    ds_read_b64_tr_b16 v[134:135], v16 offset:16768
    s_waitcnt lgkmcnt(8)
    v_mfma_f32_16x16x32_bf16 v[136:139], v[116:119], a[12:15], v[136:139]
    v_mfma_f32_16x16x32_bf16 v[140:143], v[116:119], a[92:95], v[140:143]
    s_waitcnt lgkmcnt(6)
    v_mfma_f32_16x16x32_bf16 v[144:147], v[120:123], a[12:15], v[144:147]
    v_mfma_f32_16x16x32_bf16 v[148:151], v[120:123], a[92:95], v[148:151]
    v_add_u32 v16, s46, v15
    s_waitcnt vmcnt(10) lgkmcnt(0)
    s_barrier
    v_mfma_f32_16x16x32_bf16 v[152:155], v[124:127], a[12:15], v[152:155]
    ds_read_b64_tr_b16 v[96:97], v16 offset:0
    ds_read_b64_tr_b16 v[98:99], v16 offset:1280
    v_mfma_f32_16x16x32_bf16 v[156:159], v[124:127], a[92:95], v[156:159]
    ds_read_b64_tr_b16 v[100:101], v16 offset:32
    ds_read_b64_tr_b16 v[102:103], v16 offset:1312
    v_mfma_f32_16x16x32_bf16 v[160:163], v[128:131], a[12:15], v[160:163]
    ds_read_b64_tr_b16 v[104:105], v16 offset:64
    ds_read_b64_tr_b16 v[106:107], v16 offset:1344
    v_mfma_f32_16x16x32_bf16 v[164:167], v[128:131], a[92:95], v[164:167]
    ds_read_b64_tr_b16 v[108:109], v16 offset:96
    ds_read_b64_tr_b16 v[110:111], v16 offset:1376
    v_mfma_f32_16x16x32_bf16 v[168:171], v[132:135], a[12:15], v[168:171]
    ds_read_b64_tr_b16 v[112:113], v16 offset:128
    ds_read_b64_tr_b16 v[114:115], v16 offset:1408
    v_mfma_f32_16x16x32_bf16 v[172:175], v[132:135], a[92:95], v[172:175]
    s_waitcnt lgkmcnt(8)
    v_mfma_f32_16x16x32_bf16 v[136:139], v[96:99], a[16:19], v[136:139]
    ds_read_b64_tr_b16 v[116:117], v16 offset:5120
    s_add_u32 s46, s46, 20480
    s_cmp_eq_u32 s46, 81920
    v_mfma_f32_16x16x32_bf16 v[140:143], v[96:99], a[96:99], v[140:143]
    ds_read_b64_tr_b16 v[118:119], v16 offset:6400
    s_cselect_b32 s46, 0, s46
    s_mul_i32 s90, s32, 5120
    s_waitcnt lgkmcnt(8)
    v_mfma_f32_16x16x32_bf16 v[144:147], v[100:103], a[16:19], v[144:147]
    ds_read_b64_tr_b16 v[120:121], v16 offset:5152
    s_add_u32 m0, s90, s47
    s_mul_i32 s91, s44, 491520
    v_mfma_f32_16x16x32_bf16 v[148:151], v[100:103], a[96:99], v[148:151]
    ds_read_b64_tr_b16 v[122:123], v16 offset:6432
    s_add_u32 s91, s91, s43
    buffer_load_dwordx4 v10, s[16:19], s91 offen lds
    s_waitcnt lgkmcnt(8)
    v_mfma_f32_16x16x32_bf16 v[152:155], v[104:107], a[16:19], v[152:155]
    ds_read_b64_tr_b16 v[124:125], v16 offset:5184
    s_add_u32 s47, s47, 20480
    s_cmp_eq_u32 s47, 81920
    v_mfma_f32_16x16x32_bf16 v[156:159], v[104:107], a[96:99], v[156:159]
    ds_read_b64_tr_b16 v[126:127], v16 offset:6464
    s_cselect_b32 s47, 0, s47
    s_cmp_lg_u32 s51, 0
    s_waitcnt lgkmcnt(8)
    v_mfma_f32_16x16x32_bf16 v[160:163], v[108:111], a[16:19], v[160:163]
    ds_read_b64_tr_b16 v[128:129], v16 offset:5216
    s_cselect_b32 s90, 1, 0
    s_sub_u32 s51, s51, s90
    v_mfma_f32_16x16x32_bf16 v[164:167], v[108:111], a[96:99], v[164:167]
    ds_read_b64_tr_b16 v[130:131], v16 offset:6496
    s_add_u32 s44, s44, s90
    s_cmp_eq_u32 s44, 5
    s_waitcnt lgkmcnt(8)
    v_mfma_f32_16x16x32_bf16 v[168:171], v[112:115], a[16:19], v[168:171]
    ds_read_b64_tr_b16 v[132:133], v16 offset:5248
    s_cselect_b32 s44, 0, s44
    s_cselect_b32 s90, 1280, 0
    v_mfma_f32_16x16x32_bf16 v[172:175], v[112:115], a[96:99], v[172:175]
    ds_read_b64_tr_b16 v[134:135], v16 offset:6528
    s_addc_u32 s45, s45, 0
    s_add_u32 s43, s43, s90
    s_waitcnt lgkmcnt(8)
    v_mfma_f32_16x16x32_bf16 v[136:139], v[116:119], a[20:23], v[136:139]
    ds_read_b64_tr_b16 v[96:97], v16 offset:10240
    s_cmp_eq_u32 s45, 3
    s_cselect_b32 s45, 0, s45
    v_mfma_f32_16x16x32_bf16 v[140:143], v[116:119], a[100:103], v[140:143]
    ds_read_b64_tr_b16 v[98:99], v16 offset:11520
    s_cselect_b32 s90, 3680, 0
    s_cmp_eq_u32 s43, 4960
    s_waitcnt lgkmcnt(8)
    v_mfma_f32_16x16x32_bf16 v[144:147], v[120:123], a[20:23], v[144:147]
    ds_read_b64_tr_b16 v[100:101], v16 offset:10272
    s_cselect_b32 s90, s43, s90
    s_sub_u32 s43, s43, s90
    v_mfma_f32_16x16x32_bf16 v[148:151], v[120:123], a[100:103], v[148:151]
    ds_read_b64_tr_b16 v[102:103], v16 offset:11552
    s_add_u32 m0, m0, 1024
    s_nop 0
    buffer_load_dwordx4 v11, s[16:19], s91 offen lds
    s_waitcnt lgkmcnt(8)
    v_mfma_f32_16x16x32_bf16 v[152:155], v[124:127], a[20:23], v[152:155]
    ds_read_b64_tr_b16 v[104:105], v16 offset:10304
    s_add_u32 m0, m0, 1024
    v_mfma_f32_16x16x32_bf16 v[156:159], v[124:127], a[100:103], v[156:159]
    ds_read_b64_tr_b16 v[106:107], v16 offset:11584
    s_waitcnt lgkmcnt(8)
    v_mfma_f32_16x16x32_bf16 v[160:163], v[128:131], a[20:23], v[160:163]
    ds_read_b64_tr_b16 v[108:109], v16 offset:10336
    v_mfma_f32_16x16x32_bf16 v[164:167], v[128:131], a[100:103], v[164:167]
    ds_read_b64_tr_b16 v[110:111], v16 offset:11616
    s_waitcnt lgkmcnt(8)
    v_mfma_f32_16x16x32_bf16 v[168:171], v[132:135], a[20:23], v[168:171]
    ds_read_b64_tr_b16 v[112:113], v16 offset:10368
    buffer_load_dwordx4 v12, s[16:19], s91 offen lds
    s_add_u32 m0, m0, 1024
    v_mfma_f32_16x16x32_bf16 v[172:175], v[132:135], a[100:103], v[172:175]
    ds_read_b64_tr_b16 v[114:115], v16 offset:11648
    s_waitcnt lgkmcnt(8)
    v_mfma_f32_16x16x32_bf16 v[136:139], v[96:99], a[24:27], v[136:139]
    ds_read_b64_tr_b16 v[116:117], v16 offset:15360
    v_mfma_f32_16x16x32_bf16 v[140:143], v[96:99], a[104:107], v[140:143]
    ds_read_b64_tr_b16 v[118:119], v16 offset:16640
    s_waitcnt lgkmcnt(8)
    v_mfma_f32_16x16x32_bf16 v[144:147], v[100:103], a[24:27], v[144:147]
    ds_read_b64_tr_b16 v[120:121], v16 offset:15392
    v_mfma_f32_16x16x32_bf16 v[148:151], v[100:103], a[104:107], v[148:151]
    ds_read_b64_tr_b16 v[122:123], v16 offset:16672
    buffer_load_dwordx4 v13, s[16:19], s91 offen lds
    s_add_u32 m0, m0, 1024
    s_waitcnt lgkmcnt(8)
    v_mfma_f32_16x16x32_bf16 v[152:155], v[104:107], a[24:27], v[152:155]
    ds_read_b64_tr_b16 v[124:125], v16 offset:15424
    v_mfma_f32_16x16x32_bf16 v[156:159], v[104:107], a[104:107], v[156:159]
    ds_read_b64_tr_b16 v[126:127], v16 offset:16704
    s_waitcnt lgkmcnt(8)
    v_mfma_f32_16x16x32_bf16 v[160:163], v[108:111], a[24:27], v[160:163]
    ds_read_b64_tr_b16 v[128:129], v16 offset:15456
    v_mfma_f32_16x16x32_bf16 v[164:167], v[108:111], a[104:107], v[164:167]
    ds_read_b64_tr_b16 v[130:131], v16 offset:16736
    s_waitcnt lgkmcnt(8)
    v_mfma_f32_16x16x32_bf16 v[168:171], v[112:115], a[24:27], v[168:171]
    ds_read_b64_tr_b16 v[132:133], v16 offset:15488
    buffer_load_dwordx4 v14, s[16:19], s91 offen lds
    v_mfma_f32_16x16x32_bf16 v[172:175], v[112:115], a[104:107], v[172:175]
    ds_read_b64_tr_b16 v[134:135], v16 offset:16768
    s_waitcnt lgkmcnt(8)
    v_mfma_f32_16x16x32_bf16 v[136:139], v[116:119], a[28:31], v[136:139]
    v_mfma_f32_16x16x32_bf16 v[140:143], v[116:119], a[108:111], v[140:143]
    s_waitcnt lgkmcnt(6)
    v_mfma_f32_16x16x32_bf16 v[144:147], v[120:123], a[28:31], v[144:147]
    v_mfma_f32_16x16x32_bf16 v[148:151], v[120:123], a[108:111], v[148:151]
    v_add_u32 v16, s46, v15
    s_waitcnt vmcnt(10) lgkmcnt(0)
    s_barrier
    v_mfma_f32_16x16x32_bf16 v[152:155], v[124:127], a[28:31], v[152:155]
    ds_read_b64_tr_b16 v[96:97], v16 offset:0
    ds_read_b64_tr_b16 v[98:99], v16 offset:1280
    v_mfma_f32_16x16x32_bf16 v[156:159], v[124:127], a[108:111], v[156:159]
    ds_read_b64_tr_b16 v[100:101], v16 offset:32
    ds_read_b64_tr_b16 v[102:103], v16 offset:1312
    v_mfma_f32_16x16x32_bf16 v[160:163], v[128:131], a[28:31], v[160:163]
    ds_read_b64_tr_b16 v[104:105], v16 offset:64
    ds_read_b64_tr_b16 v[106:107], v16 offset:1344
    v_mfma_f32_16x16x32_bf16 v[164:167], v[128:131], a[108:111], v[164:167]
    ds_read_b64_tr_b16 v[108:109], v16 offset:96
    ds_read_b64_tr_b16 v[110:111], v16 offset:1376
    v_mfma_f32_16x16x32_bf16 v[168:171], v[132:135], a[28:31], v[168:171]
    ds_read_b64_tr_b16 v[112:113], v16 offset:128
    ds_read_b64_tr_b16 v[114:115], v16 offset:1408
    v_mfma_f32_16x16x32_bf16 v[172:175], v[132:135], a[108:111], v[172:175]
    s_waitcnt lgkmcnt(8)
    v_mfma_f32_16x16x32_bf16 v[136:139], v[96:99], a[32:35], v[136:139]
    ds_read_b64_tr_b16 v[116:117], v16 offset:5120
    s_add_u32 s46, s46, 20480
    s_cmp_eq_u32 s46, 81920
    v_mfma_f32_16x16x32_bf16 v[140:143], v[96:99], a[112:115], v[140:143]
    ds_read_b64_tr_b16 v[118:119], v16 offset:6400
    s_cselect_b32 s46, 0, s46
    s_mul_i32 s90, s32, 5120
    s_waitcnt lgkmcnt(8)
    v_mfma_f32_16x16x32_bf16 v[144:147], v[100:103], a[32:35], v[144:147]
    ds_read_b64_tr_b16 v[120:121], v16 offset:5152
    s_add_u32 m0, s90, s47
    s_mul_i32 s91, s44, 491520
    v_mfma_f32_16x16x32_bf16 v[148:151], v[100:103], a[112:115], v[148:151]
    ds_read_b64_tr_b16 v[122:123], v16 offset:6432
    s_add_u32 s91, s91, s43
    buffer_load_dwordx4 v10, s[16:19], s91 offen lds
    s_waitcnt lgkmcnt(8)
    v_mfma_f32_16x16x32_bf16 v[152:155], v[104:107], a[32:35], v[152:155]
    ds_read_b64_tr_b16 v[124:125], v16 offset:5184
    s_add_u32 s47, s47, 20480
    s_cmp_eq_u32 s47, 81920
    v_mfma_f32_16x16x32_bf16 v[156:159], v[104:107], a[112:115], v[156:159]
    ds_read_b64_tr_b16 v[126:127], v16 offset:6464
    s_cselect_b32 s47, 0, s47
    s_cmp_lg_u32 s51, 0
    s_waitcnt lgkmcnt(8)
    v_mfma_f32_16x16x32_bf16 v[160:163], v[108:111], a[32:35], v[160:163]
    ds_read_b64_tr_b16 v[128:129], v16 offset:5216
    s_cselect_b32 s90, 1, 0
    s_sub_u32 s51, s51, s90
    v_mfma_f32_16x16x32_bf16 v[164:167], v[108:111], a[112:115], v[164:167]
    ds_read_b64_tr_b16 v[130:131], v16 offset:6496
    s_add_u32 s44, s44, s90
    s_cmp_eq_u32 s44, 5
    s_waitcnt lgkmcnt(8)
    v_mfma_f32_16x16x32_bf16 v[168:171], v[112:115], a[32:35], v[168:171]
    ds_read_b64_tr_b16 v[132:133], v16 offset:5248
    s_cselect_b32 s44, 0, s44
    s_cselect_b32 s90, 1280, 0
    v_mfma_f32_16x16x32_bf16 v[172:175], v[112:115], a[112:115], v[172:175]
    ds_read_b64_tr_b16 v[134:135], v16 offset:6528
    s_addc_u32 s45, s45, 0
    s_add_u32 s43, s43, s90
    s_waitcnt lgkmcnt(8)
    v_mfma_f32_16x16x32_bf16 v[136:139], v[116:119], a[36:39], v[136:139]
    ds_read_b64_tr_b16 v[96:97], v16 offset:10240
    s_cmp_eq_u32 s45, 3
    s_cselect_b32 s45, 0, s45
    v_mfma_f32_16x16x32_bf16 v[140:143], v[116:119], a[116:119], v[140:143]
    ds_read_b64_tr_b16 v[98:99], v16 offset:11520
    s_cselect_b32 s90, 3680, 0
    s_cmp_eq_u32 s43, 4960
    s_waitcnt lgkmcnt(8)
    v_mfma_f32_16x16x32_bf16 v[144:147], v[120:123], a[36:39], v[144:147]
    ds_read_b64_tr_b16 v[100:101], v16 offset:10272
    s_cselect_b32 s90, s43, s90
    s_sub_u32 s43, s43, s90
    v_mfma_f32_16x16x32_bf16 v[148:151], v[120:123], a[116:119], v[148:151]
    ds_read_b64_tr_b16 v[102:103], v16 offset:11552
    s_add_u32 m0, m0, 1024
    s_nop 0
    buffer_load_dwordx4 v11, s[16:19], s91 offen lds
    s_waitcnt lgkmcnt(8)
    v_mfma_f32_16x16x32_bf16 v[152:155], v[124:127], a[36:39], v[152:155]
    ds_read_b64_tr_b16 v[104:105], v16 offset:10304
    s_add_u32 m0, m0, 1024
    v_mfma_f32_16x16x32_bf16 v[156:159], v[124:127], a[116:119], v[156:159]
    ds_read_b64_tr_b16 v[106:107], v16 offset:11584
    s_waitcnt lgkmcnt(8)
    v_mfma_f32_16x16x32_bf16 v[160:163], v[128:131], a[36:39], v[160:163]
    ds_read_b64_tr_b16 v[108:109], v16 offset:10336
    v_mfma_f32_16x16x32_bf16 v[164:167], v[128:131], a[116:119], v[164:167]
    ds_read_b64_tr_b16 v[110:111], v16 offset:11616
    s_waitcnt lgkmcnt(8)
    v_mfma_f32_16x16x32_bf16 v[168:171], v[132:135], a[36:39], v[168:171]
    ds_read_b64_tr_b16 v[112:113], v16 offset:10368
    buffer_load_dwordx4 v12, s[16:19], s91 offen lds
    s_add_u32 m0, m0, 1024
    v_mfma_f32_16x16x32_bf16 v[172:175], v[132:135], a[116:119], v[172:175]
    ds_read_b64_tr_b16 v[114:115], v16 offset:11648
    s_waitcnt lgkmcnt(8)
    v_mfma_f32_16x16x32_bf16 v[136:139], v[96:99], a[40:43], v[136:139]
    ds_read_b64_tr_b16 v[116:117], v16 offset:15360
    v_mfma_f32_16x16x32_bf16 v[140:143], v[96:99], a[120:123], v[140:143]
    ds_read_b64_tr_b16 v[118:119], v16 offset:16640
    s_waitcnt lgkmcnt(8)
    v_mfma_f32_16x16x32_bf16 v[144:147], v[100:103], a[40:43], v[144:147]
    ds_read_b64_tr_b16 v[120:121], v16 offset:15392
    v_mfma_f32_16x16x32_bf16 v[148:151], v[100:103], a[120:123], v[148:151]
    ds_read_b64_tr_b16 v[122:123], v16 offset:16672
    buffer_load_dwordx4 v13, s[16:19], s91 offen lds
    s_add_u32 m0, m0, 1024
    s_waitcnt lgkmcnt(8)
    v_mfma_f32_16x16x32_bf16 v[152:155], v[104:107], a[40:43], v[152:155]
    ds_read_b64_tr_b16 v[124:125], v16 offset:15424
    v_mfma_f32_16x16x32_bf16 v[156:159], v[104:107], a[120:123], v[156:159]
    ds_read_b64_tr_b16 v[126:127], v16 offset:16704
    s_waitcnt lgkmcnt(8)
    v_mfma_f32_16x16x32_bf16 v[160:163], v[108:111], a[40:43], v[160:163]
    ds_read_b64_tr_b16 v[128:129], v16 offset:15456
    v_mfma_f32_16x16x32_bf16 v[164:167], v[108:111], a[120:123], v[164:167]
    ds_read_b64_tr_b16 v[130:131], v16 offset:16736
    s_waitcnt lgkmcnt(8)
    v_mfma_f32_16x16x32_bf16 v[168:171], v[112:115], a[40:43], v[168:171]
    ds_read_b64_tr_b16 v[132:133], v16 offset:15488
    buffer_load_dwordx4 v14, s[16:19], s91 offen lds
    v_mfma_f32_16x16x32_bf16 v[172:175], v[112:115], a[120:123], v[172:175]
    ds_read_b64_tr_b16 v[134:135], v16 offset:16768
    s_waitcnt lgkmcnt(8)
    v_mfma_f32_16x16x32_bf16 v[136:139], v[116:119], a[44:47], v[136:139]
    v_mfma_f32_16x16x32_bf16 v[140:143], v[116:119], a[124:127], v[140:143]
    s_waitcnt lgkmcnt(6)
    v_mfma_f32_16x16x32_bf16 v[144:147], v[120:123], a[44:47], v[144:147]
    v_mfma_f32_16x16x32_bf16 v[148:151], v[120:123], a[124:127], v[148:151]
    v_add_u32 v16, s46, v15
    s_waitcnt vmcnt(10) lgkmcnt(0)
    s_barrier
    v_mfma_f32_16x16x32_bf16 v[152:155], v[124:127], a[44:47], v[152:155]
    ds_read_b64_tr_b16 v[96:97], v16 offset:0
    ds_read_b64_tr_b16 v[98:99], v16 offset:1280
    v_mfma_f32_16x16x32_bf16 v[156:159], v[124:127], a[124:127], v[156:159]
    ds_read_b64_tr_b16 v[100:101], v16 offset:32
    ds_read_b64_tr_b16 v[102:103], v16 offset:1312
    v_mfma_f32_16x16x32_bf16 v[160:163], v[128:131], a[44:47], v[160:163]
    ds_read_b64_tr_b16 v[104:105], v16 offset:64
    ds_read_b64_tr_b16 v[106:107], v16 offset:1344
    v_mfma_f32_16x16x32_bf16 v[164:167], v[128:131], a[124:127], v[164:167]
    ds_read_b64_tr_b16 v[108:109], v16 offset:96
    ds_read_b64_tr_b16 v[110:111], v16 offset:1376
    v_mfma_f32_16x16x32_bf16 v[168:171], v[132:135], a[44:47], v[168:171]
    ds_read_b64_tr_b16 v[112:113], v16 offset:128
    ds_read_b64_tr_b16 v[114:115], v16 offset:1408
    v_mfma_f32_16x16x32_bf16 v[172:175], v[132:135], a[124:127], v[172:175]
    s_waitcnt lgkmcnt(8)
    v_mfma_f32_16x16x32_bf16 v[136:139], v[96:99], a[48:51], v[136:139]
    ds_read_b64_tr_b16 v[116:117], v16 offset:5120
    s_add_u32 s46, s46, 20480
    s_cmp_eq_u32 s46, 81920
    v_mfma_f32_16x16x32_bf16 v[140:143], v[96:99], a[128:131], v[140:143]
    ds_read_b64_tr_b16 v[118:119], v16 offset:6400
    s_cselect_b32 s46, 0, s46
    s_mul_i32 s90, s32, 5120
    s_waitcnt lgkmcnt(8)
    v_mfma_f32_16x16x32_bf16 v[144:147], v[100:103], a[48:51], v[144:147]
    ds_read_b64_tr_b16 v[120:121], v16 offset:5152
    s_add_u32 m0, s90, s47
    s_mul_i32 s91, s44, 491520
    v_mfma_f32_16x16x32_bf16 v[148:151], v[100:103], a[128:131], v[148:151]
    ds_read_b64_tr_b16 v[122:123], v16 offset:6432
    s_add_u32 s91, s91, s43
    buffer_load_dwordx4 v10, s[16:19], s91 offen lds
    s_waitcnt lgkmcnt(8)
    v_mfma_f32_16x16x32_bf16 v[152:155], v[104:107], a[48:51], v[152:155]
    ds_read_b64_tr_b16 v[124:125], v16 offset:5184
    s_add_u32 s47, s47, 20480
    s_cmp_eq_u32 s47, 81920
    v_mfma_f32_16x16x32_bf16 v[156:159], v[104:107], a[128:131], v[156:159]
    ds_read_b64_tr_b16 v[126:127], v16 offset:6464
    s_cselect_b32 s47, 0, s47
    s_cmp_lg_u32 s51, 0
    s_waitcnt lgkmcnt(8)
    v_mfma_f32_16x16x32_bf16 v[160:163], v[108:111], a[48:51], v[160:163]
    ds_read_b64_tr_b16 v[128:129], v16 offset:5216
    s_cselect_b32 s90, 1, 0
    s_sub_u32 s51, s51, s90
    v_mfma_f32_16x16x32_bf16 v[164:167], v[108:111], a[128:131], v[164:167]
    ds_read_b64_tr_b16 v[130:131], v16 offset:6496
    s_add_u32 s44, s44, s90
    s_cmp_eq_u32 s44, 5
    s_waitcnt lgkmcnt(8)
    v_mfma_f32_16x16x32_bf16 v[168:171], v[112:115], a[48:51], v[168:171]
    ds_read_b64_tr_b16 v[132:133], v16 offset:5248
    s_cselect_b32 s44, 0, s44
    s_cselect_b32 s90, 1280, 0
    v_mfma_f32_16x16x32_bf16 v[172:175], v[112:115], a[128:131], v[172:175]
    ds_read_b64_tr_b16 v[134:135], v16 offset:6528
    s_addc_u32 s45, s45, 0
    s_add_u32 s43, s43, s90
    s_waitcnt lgkmcnt(8)
    v_mfma_f32_16x16x32_bf16 v[136:139], v[116:119], a[52:55], v[136:139]
    ds_read_b64_tr_b16 v[96:97], v16 offset:10240
    s_cmp_eq_u32 s45, 3
    s_cselect_b32 s45, 0, s45
    v_mfma_f32_16x16x32_bf16 v[140:143], v[116:119], a[132:135], v[140:143]
    ds_read_b64_tr_b16 v[98:99], v16 offset:11520
    s_cselect_b32 s90, 3680, 0
    s_cmp_eq_u32 s43, 4960
    s_waitcnt lgkmcnt(8)
    v_mfma_f32_16x16x32_bf16 v[144:147], v[120:123], a[52:55], v[144:147]
    ds_read_b64_tr_b16 v[100:101], v16 offset:10272
    s_cselect_b32 s90, s43, s90
    s_sub_u32 s43, s43, s90
    v_mfma_f32_16x16x32_bf16 v[148:151], v[120:123], a[132:135], v[148:151]
    ds_read_b64_tr_b16 v[102:103], v16 offset:11552
    s_add_u32 m0, m0, 1024
    s_nop 0
    buffer_load_dwordx4 v11, s[16:19], s91 offen lds
    s_waitcnt lgkmcnt(8)
    v_mfma_f32_16x16x32_bf16 v[152:155], v[124:127], a[52:55], v[152:155]
    ds_read_b64_tr_b16 v[104:105], v16 offset:10304
    s_add_u32 m0, m0, 1024
    v_mfma_f32_16x16x32_bf16 v[156:159], v[124:127], a[132:135], v[156:159]
    ds_read_b64_tr_b16 v[106:107], v16 offset:11584
    s_waitcnt lgkmcnt(8)
    v_mfma_f32_16x16x32_bf16 v[160:163], v[128:131], a[52:55], v[160:163]
    ds_read_b64_tr_b16 v[108:109], v16 offset:10336
    v_mfma_f32_16x16x32_bf16 v[164:167], v[128:131], a[132:135], v[164:167]
    ds_read_b64_tr_b16 v[110:111], v16 offset:11616
    s_waitcnt lgkmcnt(8)
    v_mfma_f32_16x16x32_bf16 v[168:171], v[132:135], a[52:55], v[168:171]
    ds_read_b64_tr_b16 v[112:113], v16 offset:10368
    buffer_load_dwordx4 v12, s[16:19], s91 offen lds
    s_add_u32 m0, m0, 1024
    v_mfma_f32_16x16x32_bf16 v[172:175], v[132:135], a[132:135], v[172:175]
    ds_read_b64_tr_b16 v[114:115], v16 offset:11648
    s_waitcnt lgkmcnt(8)
    v_mfma_f32_16x16x32_bf16 v[136:139], v[96:99], a[56:59], v[136:139]
    ds_read_b64_tr_b16 v[116:117], v16 offset:15360
    v_mfma_f32_16x16x32_bf16 v[140:143], v[96:99], a[136:139], v[140:143]
    ds_read_b64_tr_b16 v[118:119], v16 offset:16640
    s_waitcnt lgkmcnt(8)
    v_mfma_f32_16x16x32_bf16 v[144:147], v[100:103], a[56:59], v[144:147]
    ds_read_b64_tr_b16 v[120:121], v16 offset:15392
    v_mfma_f32_16x16x32_bf16 v[148:151], v[100:103], a[136:139], v[148:151]
    ds_read_b64_tr_b16 v[122:123], v16 offset:16672
    buffer_load_dwordx4 v13, s[16:19], s91 offen lds
    s_add_u32 m0, m0, 1024
    s_waitcnt lgkmcnt(8)
    v_mfma_f32_16x16x32_bf16 v[152:155], v[104:107], a[56:59], v[152:155]
    ds_read_b64_tr_b16 v[124:125], v16 offset:15424
    v_mfma_f32_16x16x32_bf16 v[156:159], v[104:107], a[136:139], v[156:159]
    ds_read_b64_tr_b16 v[126:127], v16 offset:16704
    s_waitcnt lgkmcnt(8)
    v_mfma_f32_16x16x32_bf16 v[160:163], v[108:111], a[56:59], v[160:163]
    ds_read_b64_tr_b16 v[128:129], v16 offset:15456
    v_mfma_f32_16x16x32_bf16 v[164:167], v[108:111], a[136:139], v[164:167]
    ds_read_b64_tr_b16 v[130:131], v16 offset:16736
    s_waitcnt lgkmcnt(8)
    v_mfma_f32_16x16x32_bf16 v[168:171], v[112:115], a[56:59], v[168:171]
    ds_read_b64_tr_b16 v[132:133], v16 offset:15488
    buffer_load_dwordx4 v14, s[16:19], s91 offen lds
    v_mfma_f32_16x16x32_bf16 v[172:175], v[112:115], a[136:139], v[172:175]
    ds_read_b64_tr_b16 v[134:135], v16 offset:16768
    s_waitcnt lgkmcnt(8)
    v_mfma_f32_16x16x32_bf16 v[136:139], v[116:119], a[60:63], v[136:139]
    v_mfma_f32_16x16x32_bf16 v[140:143], v[116:119], a[140:143], v[140:143]
    s_waitcnt lgkmcnt(6)
    v_mfma_f32_16x16x32_bf16 v[144:147], v[120:123], a[60:63], v[144:147]
    v_mfma_f32_16x16x32_bf16 v[148:151], v[120:123], a[140:143], v[148:151]
    v_add_u32 v16, s46, v15
    s_waitcnt vmcnt(10) lgkmcnt(0)
    s_barrier
    v_mfma_f32_16x16x32_bf16 v[152:155], v[124:127], a[60:63], v[152:155]
    ds_read_b64_tr_b16 v[96:97], v16 offset:0
    ds_read_b64_tr_b16 v[98:99], v16 offset:1280
    v_mfma_f32_16x16x32_bf16 v[156:159], v[124:127], a[140:143], v[156:159]
    ds_read_b64_tr_b16 v[100:101], v16 offset:32
    ds_read_b64_tr_b16 v[102:103], v16 offset:1312
    v_mfma_f32_16x16x32_bf16 v[160:163], v[128:131], a[60:63], v[160:163]
    ds_read_b64_tr_b16 v[104:105], v16 offset:64
    ds_read_b64_tr_b16 v[106:107], v16 offset:1344
    v_mfma_f32_16x16x32_bf16 v[164:167], v[128:131], a[140:143], v[164:167]
    ds_read_b64_tr_b16 v[108:109], v16 offset:96
    ds_read_b64_tr_b16 v[110:111], v16 offset:1376
    v_mfma_f32_16x16x32_bf16 v[168:171], v[132:135], a[60:63], v[168:171]
    ds_read_b64_tr_b16 v[112:113], v16 offset:128
    ds_read_b64_tr_b16 v[114:115], v16 offset:1408
    v_mfma_f32_16x16x32_bf16 v[172:175], v[132:135], a[140:143], v[172:175]
    s_waitcnt lgkmcnt(8)
    v_mfma_f32_16x16x32_bf16 v[136:139], v[96:99], a[64:67], v[136:139]
    ds_read_b64_tr_b16 v[116:117], v16 offset:5120
    s_add_u32 s46, s46, 20480
    s_cmp_eq_u32 s46, 81920
    v_mfma_f32_16x16x32_bf16 v[140:143], v[96:99], a[144:147], v[140:143]
    ds_read_b64_tr_b16 v[118:119], v16 offset:6400
    s_cselect_b32 s46, 0, s46
    s_mul_i32 s90, s32, 5120
    s_waitcnt lgkmcnt(8)
    v_mfma_f32_16x16x32_bf16 v[144:147], v[100:103], a[64:67], v[144:147]
    ds_read_b64_tr_b16 v[120:121], v16 offset:5152
    s_add_u32 m0, s90, s47
    s_mul_i32 s91, s44, 491520
    v_mfma_f32_16x16x32_bf16 v[148:151], v[100:103], a[144:147], v[148:151]
    ds_read_b64_tr_b16 v[122:123], v16 offset:6432
    s_add_u32 s91, s91, s43
    buffer_load_dwordx4 v10, s[16:19], s91 offen lds
    s_waitcnt lgkmcnt(8)
    v_mfma_f32_16x16x32_bf16 v[152:155], v[104:107], a[64:67], v[152:155]
    ds_read_b64_tr_b16 v[124:125], v16 offset:5184
    s_add_u32 s47, s47, 20480
    s_cmp_eq_u32 s47, 81920
    v_mfma_f32_16x16x32_bf16 v[156:159], v[104:107], a[144:147], v[156:159]
    ds_read_b64_tr_b16 v[126:127], v16 offset:6464
    s_cselect_b32 s47, 0, s47
    s_cmp_lg_u32 s51, 0
    s_waitcnt lgkmcnt(8)
    v_mfma_f32_16x16x32_bf16 v[160:163], v[108:111], a[64:67], v[160:163]
    ds_read_b64_tr_b16 v[128:129], v16 offset:5216
    s_cselect_b32 s90, 1, 0
    s_sub_u32 s51, s51, s90
    v_mfma_f32_16x16x32_bf16 v[164:167], v[108:111], a[144:147], v[164:167]
    ds_read_b64_tr_b16 v[130:131], v16 offset:6496
    s_add_u32 s44, s44, s90
    s_cmp_eq_u32 s44, 5
    s_waitcnt lgkmcnt(8)
    v_mfma_f32_16x16x32_bf16 v[168:171], v[112:115], a[64:67], v[168:171]
    ds_read_b64_tr_b16 v[132:133], v16 offset:5248
    s_cselect_b32 s44, 0, s44
    s_cselect_b32 s90, 1280, 0
    v_mfma_f32_16x16x32_bf16 v[172:175], v[112:115], a[144:147], v[172:175]
    ds_read_b64_tr_b16 v[134:135], v16 offset:6528
    s_addc_u32 s45, s45, 0
    s_add_u32 s43, s43, s90
    s_waitcnt lgkmcnt(8)
    v_mfma_f32_16x16x32_bf16 v[136:139], v[116:119], a[68:71], v[136:139]
    ds_read_b64_tr_b16 v[96:97], v16 offset:10240
    s_cmp_eq_u32 s45, 3
    s_cselect_b32 s45, 0, s45
    v_mfma_f32_16x16x32_bf16 v[140:143], v[116:119], a[148:151], v[140:143]
    ds_read_b64_tr_b16 v[98:99], v16 offset:11520
    s_cselect_b32 s90, 3680, 0
    s_cmp_eq_u32 s43, 4960
    s_waitcnt lgkmcnt(8)
    v_mfma_f32_16x16x32_bf16 v[144:147], v[120:123], a[68:71], v[144:147]
    ds_read_b64_tr_b16 v[100:101], v16 offset:10272
    s_cselect_b32 s90, s43, s90
    s_sub_u32 s43, s43, s90
    v_mfma_f32_16x16x32_bf16 v[148:151], v[120:123], a[148:151], v[148:151]
    ds_read_b64_tr_b16 v[102:103], v16 offset:11552
    s_add_u32 m0, m0, 1024
    s_nop 0
    buffer_load_dwordx4 v11, s[16:19], s91 offen lds
    s_waitcnt lgkmcnt(8)
    v_mfma_f32_16x16x32_bf16 v[152:155], v[124:127], a[68:71], v[152:155]
    ds_read_b64_tr_b16 v[104:105], v16 offset:10304
    s_add_u32 m0, m0, 1024
    v_mfma_f32_16x16x32_bf16 v[156:159], v[124:127], a[148:151], v[156:159]
    ds_read_b64_tr_b16 v[106:107], v16 offset:11584
    s_waitcnt lgkmcnt(8)
    v_mfma_f32_16x16x32_bf16 v[160:163], v[128:131], a[68:71], v[160:163]
    ds_read_b64_tr_b16 v[108:109], v16 offset:10336
    v_mfma_f32_16x16x32_bf16 v[164:167], v[128:131], a[148:151], v[164:167]
    ds_read_b64_tr_b16 v[110:111], v16 offset:11616
    s_waitcnt lgkmcnt(8)
    v_mfma_f32_16x16x32_bf16 v[168:171], v[132:135], a[68:71], v[168:171]
    ds_read_b64_tr_b16 v[112:113], v16 offset:10368
    buffer_load_dwordx4 v12, s[16:19], s91 offen lds
    s_add_u32 m0, m0, 1024
    v_mfma_f32_16x16x32_bf16 v[172:175], v[132:135], a[148:151], v[172:175]
    ds_read_b64_tr_b16 v[114:115], v16 offset:11648
    s_waitcnt lgkmcnt(8)
    v_mfma_f32_16x16x32_bf16 v[136:139], v[96:99], a[72:75], v[136:139]
    ds_read_b64_tr_b16 v[116:117], v16 offset:15360
    v_mfma_f32_16x16x32_bf16 v[140:143], v[96:99], a[152:155], v[140:143]
    ds_read_b64_tr_b16 v[118:119], v16 offset:16640
    s_waitcnt lgkmcnt(8)
    v_mfma_f32_16x16x32_bf16 v[144:147], v[100:103], a[72:75], v[144:147]
    ds_read_b64_tr_b16 v[120:121], v16 offset:15392
    v_mfma_f32_16x16x32_bf16 v[148:151], v[100:103], a[152:155], v[148:151]
    ds_read_b64_tr_b16 v[122:123], v16 offset:16672
    buffer_load_dwordx4 v13, s[16:19], s91 offen lds
    s_add_u32 m0, m0, 1024
    s_waitcnt lgkmcnt(8)
    v_mfma_f32_16x16x32_bf16 v[152:155], v[104:107], a[72:75], v[152:155]
    ds_read_b64_tr_b16 v[124:125], v16 offset:15424
    v_mfma_f32_16x16x32_bf16 v[156:159], v[104:107], a[152:155], v[156:159]
    ds_read_b64_tr_b16 v[126:127], v16 offset:16704
    s_waitcnt lgkmcnt(8)
    v_mfma_f32_16x16x32_bf16 v[160:163], v[108:111], a[72:75], v[160:163]
    ds_read_b64_tr_b16 v[128:129], v16 offset:15456
    v_mfma_f32_16x16x32_bf16 v[164:167], v[108:111], a[152:155], v[164:167]
    ds_read_b64_tr_b16 v[130:131], v16 offset:16736
    s_waitcnt lgkmcnt(8)
    v_mfma_f32_16x16x32_bf16 v[168:171], v[112:115], a[72:75], v[168:171]
    ds_read_b64_tr_b16 v[132:133], v16 offset:15488
    buffer_load_dwordx4 v14, s[16:19], s91 offen lds
    v_mfma_f32_16x16x32_bf16 v[172:175], v[112:115], a[152:155], v[172:175]
    ds_read_b64_tr_b16 v[134:135], v16 offset:16768
    s_waitcnt lgkmcnt(8)
    v_mfma_f32_16x16x32_bf16 v[136:139], v[116:119], a[76:79], v[136:139]
    v_mfma_f32_16x16x32_bf16 v[140:143], v[116:119], a[156:159], v[140:143]
    s_waitcnt lgkmcnt(6)
    v_mfma_f32_16x16x32_bf16 v[144:147], v[120:123], a[76:79], v[144:147]
    v_mfma_f32_16x16x32_bf16 v[148:151], v[120:123], a[156:159], v[148:151]
    v_add_u32 v16, s46, v15
    s_waitcnt vmcnt(10) lgkmcnt(0)
    s_barrier
    v_mfma_f32_16x16x32_bf16 v[152:155], v[124:127], a[76:79], v[152:155]
    ds_read_b64_tr_b16 v[96:97], v16 offset:0
    ds_read_b64_tr_b16 v[98:99], v16 offset:1280
    v_mfma_f32_16x16x32_bf16 v[156:159], v[124:127], a[156:159], v[156:159]
    ds_read_b64_tr_b16 v[100:101], v16 offset:32
    ds_read_b64_tr_b16 v[102:103], v16 offset:1312
    v_mfma_f32_16x16x32_bf16 v[160:163], v[128:131], a[76:79], v[160:163]
    ds_read_b64_tr_b16 v[104:105], v16 offset:64
    ds_read_b64_tr_b16 v[106:107], v16 offset:1344
    v_mfma_f32_16x16x32_bf16 v[164:167], v[128:131], a[156:159], v[164:167]
    ds_read_b64_tr_b16 v[108:109], v16 offset:96
    ds_read_b64_tr_b16 v[110:111], v16 offset:1376
    v_mfma_f32_16x16x32_bf16 v[168:171], v[132:135], a[76:79], v[168:171]
    ds_read_b64_tr_b16 v[112:113], v16 offset:128
    ds_read_b64_tr_b16 v[114:115], v16 offset:1408
    v_mfma_f32_16x16x32_bf16 v[172:175], v[132:135], a[156:159], v[172:175]
    v_add_u32 v18, s41, v17
    v_cvt_pk_bf16_f32 v176, v136, v137
    v_cvt_pk_bf16_f32 v177, v138, v139
    v_cvt_pk_bf16_f32 v178, v140, v141
    v_cvt_pk_bf16_f32 v179, v142, v143
    ds_write_b64 v18, v[176:177] offset:0
    ds_write_b64 v18, v[178:179] offset:2688
    v_cvt_pk_bf16_f32 v176, v144, v145
    v_cvt_pk_bf16_f32 v177, v146, v147
    v_cvt_pk_bf16_f32 v178, v148, v149
    v_cvt_pk_bf16_f32 v179, v150, v151
    ds_write_b64 v18, v[176:177] offset:32
    ds_write_b64 v18, v[178:179] offset:2720
    v_cvt_pk_bf16_f32 v176, v152, v153
    v_cvt_pk_bf16_f32 v177, v154, v155
    v_cvt_pk_bf16_f32 v178, v156, v157
    v_cvt_pk_bf16_f32 v179, v158, v159
    ds_write_b64 v18, v[176:177] offset:64
    ds_write_b64 v18, v[178:179] offset:2752
    v_cvt_pk_bf16_f32 v176, v160, v161
    v_cvt_pk_bf16_f32 v177, v162, v163
    v_cvt_pk_bf16_f32 v178, v164, v165
    v_cvt_pk_bf16_f32 v179, v166, v167
    ds_write_b64 v18, v[176:177] offset:96
    ds_write_b64 v18, v[178:179] offset:2784
    v_cvt_pk_bf16_f32 v176, v168, v169
    v_cvt_pk_bf16_f32 v177, v170, v171
    v_cvt_pk_bf16_f32 v178, v172, v173
    v_cvt_pk_bf16_f32 v179, v174, v175
    ds_write_b64 v18, v[176:177] offset:128
    ds_write_b64 v18, v[178:179] offset:2816
    s_waitcnt lgkmcnt(0)
    s_add_u32 s41, s41, 21504
    s_cmp_lt_u32 s41, 64512
    s_cbranch_scc1 L_pa_blk
    s_barrier
    s_mov_b32 s50, 0
L_pa_att:
    v_add_u32 v23, s50, v21
    v_add_u32 v22, s50, v20
    ds_read_b64 v[116:117], v22 offset:0
    ds_read_b64 v[118:119], v22 offset:8
    ds_read_b64 v[120:121], v22 offset:16
    ds_read_b64 v[122:123], v22 offset:24
    ds_read_b64 v[124:125], v22 offset:32
    ds_read_b64 v[126:127], v23 offset:2352
    ds_read_b64 v[128:129], v23 offset:2360
    ds_read_b64 v[130:131], v23 offset:2368
    ds_read_b64 v[132:133], v23 offset:2376
    ds_read_b64 v[134:135], v23 offset:2384
    ds_read_b64 v[136:137], v23 offset:2016
    ds_read_b64 v[138:139], v23 offset:2024
    ds_read_b64 v[140:141], v23 offset:2032
    ds_read_b64 v[142:143], v23 offset:2040
    ds_read_b64 v[144:145], v23 offset:2048
    s_waitcnt lgkmcnt(5)
    v_dot2_f32_bf16 v146, v116, v126, 0
    v_dot2_f32_bf16 v146, v117, v127, v146
    v_dot2_f32_bf16 v146, v118, v128, v146
    v_dot2_f32_bf16 v146, v119, v129, v146
    v_dot2_f32_bf16 v146, v120, v130, v146
    v_dot2_f32_bf16 v146, v121, v131, v146
    v_dot2_f32_bf16 v146, v122, v132, v146
    v_dot2_f32_bf16 v146, v123, v133, v146
    v_dot2_f32_bf16 v146, v124, v134, v146
    v_dot2_f32_bf16 v146, v125, v135, v146
    ds_read_b64 v[126:127], v23 offset:1680
    ds_read_b64 v[128:129], v23 offset:1688
    ds_read_b64 v[130:131], v23 offset:1696
    ds_read_b64 v[132:133], v23 offset:1704
    ds_read_b64 v[134:135], v23 offset:1712
    s_waitcnt lgkmcnt(5)
    v_dot2_f32_bf16 v147, v116, v136, 0
    v_dot2_f32_bf16 v147, v117, v137, v147
    v_dot2_f32_bf16 v147, v118, v138, v147
    v_dot2_f32_bf16 v147, v119, v139, v147
    v_dot2_f32_bf16 v147, v120, v140, v147
    v_dot2_f32_bf16 v147, v121, v141, v147
    v_dot2_f32_bf16 v147, v122, v142, v147
    v_dot2_f32_bf16 v147, v123, v143, v147
    v_dot2_f32_bf16 v147, v124, v144, v147
    v_dot2_f32_bf16 v147, v125, v145, v147
    ds_read_b64 v[136:137], v23 offset:1344
    ds_read_b64 v[138:139], v23 offset:1352
    ds_read_b64 v[140:141], v23 offset:1360
    ds_read_b64 v[142:143], v23 offset:1368
    ds_read_b64 v[144:145], v23 offset:1376
    s_waitcnt lgkmcnt(5)
    v_dot2_f32_bf16 v148, v116, v126, 0
    v_dot2_f32_bf16 v148, v117, v127, v148
    v_dot2_f32_bf16 v148, v118, v128, v148
    v_dot2_f32_bf16 v148, v119, v129, v148
    v_dot2_f32_bf16 v148, v120, v130, v148
    v_dot2_f32_bf16 v148, v121, v131, v148
    v_dot2_f32_bf16 v148, v122, v132, v148
    v_dot2_f32_bf16 v148, v123, v133, v148
    v_dot2_f32_bf16 v148, v124, v134, v148
    v_dot2_f32_bf16 v148, v125, v135, v148
    ds_read_b64 v[126:127], v23 offset:1008
    ds_read_b64 v[128:129], v23 offset:1016
    ds_read_b64 v[130:131], v23 offset:1024
    ds_read_b64 v[132:133], v23 offset:1032
    ds_read_b64 v[134:135], v23 offset:1040
    s_waitcnt lgkmcnt(5)
    v_dot2_f32_bf16 v149, v116, v136, 0
    v_dot2_f32_bf16 v149, v117, v137, v149
    v_dot2_f32_bf16 v149, v118, v138, v149
    v_dot2_f32_bf16 v149, v119, v139, v149
    v_dot2_f32_bf16 v149, v120, v140, v149
    v_dot2_f32_bf16 v149, v121, v141, v149
    v_dot2_f32_bf16 v149, v122, v142, v149
    v_dot2_f32_bf16 v149, v123, v143, v149
    v_dot2_f32_bf16 v149, v124, v144, v149
    v_dot2_f32_bf16 v149, v125, v145, v149
    ds_read_b64 v[136:137], v23 offset:672
    ds_read_b64 v[138:139], v23 offset:680
    ds_read_b64 v[140:141], v23 offset:688
    ds_read_b64 v[142:143], v23 offset:696
    ds_read_b64 v[144:145], v23 offset:704
    s_waitcnt lgkmcnt(5)
    v_dot2_f32_bf16 v150, v116, v126, 0
    v_dot2_f32_bf16 v150, v117, v127, v150
    v_dot2_f32_bf16 v150, v118, v128, v150
    v_dot2_f32_bf16 v150, v119, v129, v150
    v_dot2_f32_bf16 v150, v120, v130, v150
    v_dot2_f32_bf16 v150, v121, v131, v150
    v_dot2_f32_bf16 v150, v122, v132, v150
    v_dot2_f32_bf16 v150, v123, v133, v150
    v_dot2_f32_bf16 v150, v124, v134, v150
    v_dot2_f32_bf16 v150, v125, v135, v150
    ds_read_b64 v[126:127], v23 offset:336
    ds_read_b64 v[128:129], v23 offset:344
    ds_read_b64 v[130:131], v23 offset:352
    ds_read_b64 v[132:133], v23 offset:360
    ds_read_b64 v[134:135], v23 offset:368
    s_waitcnt lgkmcnt(5)
    v_dot2_f32_bf16 v151, v116, v136, 0
    v_dot2_f32_bf16 v151, v117, v137, v151
    v_dot2_f32_bf16 v151, v118, v138, v151
    v_dot2_f32_bf16 v151, v119, v139, v151
    v_dot2_f32_bf16 v151, v120, v140, v151
    v_dot2_f32_bf16 v151, v121, v141, v151
    v_dot2_f32_bf16 v151, v122, v142, v151
    v_dot2_f32_bf16 v151, v123, v143, v151
    v_dot2_f32_bf16 v151, v124, v144, v151
    v_dot2_f32_bf16 v151, v125, v145, v151
    ds_read_b64 v[136:137], v23 offset:0
    ds_read_b64 v[138:139], v23 offset:8
    ds_read_b64 v[140:141], v23 offset:16
    ds_read_b64 v[142:143], v23 offset:24
    ds_read_b64 v[144:145], v23 offset:32
    s_waitcnt lgkmcnt(5)
    v_dot2_f32_bf16 v152, v116, v126, 0
    v_dot2_f32_bf16 v152, v117, v127, v152
    v_dot2_f32_bf16 v152, v118, v128, v152
    v_dot2_f32_bf16 v152, v119, v129, v152
    v_dot2_f32_bf16 v152, v120, v130, v152
    v_dot2_f32_bf16 v152, v121, v131, v152
    v_dot2_f32_bf16 v152, v122, v132, v152
    v_dot2_f32_bf16 v152, v123, v133, v152
    v_dot2_f32_bf16 v152, v124, v134, v152
    v_dot2_f32_bf16 v152, v125, v135, v152
    ds_read_b64 v[126:127], v23 offset:23856
    ds_read_b64 v[128:129], v23 offset:23864
    ds_read_b64 v[130:131], v23 offset:23872
    ds_read_b64 v[132:133], v23 offset:23880
    ds_read_b64 v[134:135], v23 offset:23888
    s_waitcnt lgkmcnt(5)
    v_dot2_f32_bf16 v153, v116, v136, 0
    v_dot2_f32_bf16 v153, v117, v137, v153
    v_dot2_f32_bf16 v153, v118, v138, v153
    v_dot2_f32_bf16 v153, v119, v139, v153
    v_dot2_f32_bf16 v153, v120, v140, v153
    v_dot2_f32_bf16 v153, v121, v141, v153
    v_dot2_f32_bf16 v153, v122, v142, v153
    v_dot2_f32_bf16 v153, v123, v143, v153
    v_dot2_f32_bf16 v153, v124, v144, v153
    v_dot2_f32_bf16 v153, v125, v145, v153
    v_cmp_le_i32 vcc, 2, v24
    s_nop 1
    v_cndmask_b32 v147, v27, v147, vcc
    v_cmp_le_i32 vcc, 4, v24
    s_nop 1
    v_cndmask_b32 v148, v27, v148, vcc
    v_cmp_le_i32 vcc, 6, v24
    s_nop 1
    v_cndmask_b32 v149, v27, v149, vcc
    v_cmp_le_i32 vcc, 8, v24
    s_nop 1
    v_cndmask_b32 v150, v27, v150, vcc
    v_cmp_le_i32 vcc, 10, v24
    s_nop 1
    v_cndmask_b32 v151, v27, v151, vcc
    v_cmp_le_i32 vcc, 12, v24
    s_nop 1
    v_cndmask_b32 v152, v27, v152, vcc
    v_cmp_le_i32 vcc, 14, v24
    s_nop 1
    v_cndmask_b32 v153, v27, v153, vcc
    v_max_f32 v25, v146, v147
    v_max3_f32 v25, v25, v148, v149
    v_max3_f32 v25, v25, v150, v151
    v_max3_f32 v25, v25, v152, v153
    v_sub_f32 v146, v146, v25
    v_sub_f32 v147, v147, v25
    v_sub_f32 v148, v148, v25
    v_sub_f32 v149, v149, v25
    v_sub_f32 v150, v150, v25
    v_sub_f32 v151, v151, v25
    v_sub_f32 v152, v152, v25
    v_sub_f32 v153, v153, v25
    v_mul_f32 v146, s49, v146
    v_mul_f32 v147, s49, v147
    v_mul_f32 v148, s49, v148
    v_mul_f32 v149, s49, v149
    v_mul_f32 v150, s49, v150
    v_mul_f32 v151, s49, v151
    v_mul_f32 v152, s49, v152
    v_mul_f32 v153, s49, v153
    v_exp_f32 v146, v146
    v_exp_f32 v147, v147
    v_exp_f32 v148, v148
    v_exp_f32 v149, v149
    v_exp_f32 v150, v150
    v_exp_f32 v151, v151
    v_exp_f32 v152, v152
    v_exp_f32 v153, v153
    v_add_f32 v26, v146, v147
    v_add_f32 v26, v26, v148
    v_add_f32 v26, v26, v149
    v_add_f32 v26, v26, v150
    v_add_f32 v26, v26, v151
    v_add_f32 v26, v26, v152
    v_add_f32 v26, v26, v153
    v_rcp_f32 v26, v26
    s_nop 0
    v_mul_f32 v146, v146, v26
    v_cvt_pk_bf16_f32 v154, v146, 0
    v_cvt_pk_bf16_f32 v155, 0, v146
    v_mul_f32 v147, v147, v26
    v_cvt_pk_bf16_f32 v156, v147, 0
    v_cvt_pk_bf16_f32 v157, 0, v147
    v_mul_f32 v148, v148, v26
    v_cvt_pk_bf16_f32 v158, v148, 0
    v_cvt_pk_bf16_f32 v159, 0, v148
    v_mul_f32 v149, v149, v26
    v_cvt_pk_bf16_f32 v160, v149, 0
    v_cvt_pk_bf16_f32 v161, 0, v149
    v_mul_f32 v150, v150, v26
    v_cvt_pk_bf16_f32 v162, v150, 0
    v_cvt_pk_bf16_f32 v163, 0, v150
    v_mul_f32 v151, v151, v26
    v_cvt_pk_bf16_f32 v164, v151, 0
    v_cvt_pk_bf16_f32 v165, 0, v151
    v_mul_f32 v152, v152, v26
    v_cvt_pk_bf16_f32 v166, v152, 0
    v_cvt_pk_bf16_f32 v167, 0, v152
    v_mul_f32 v153, v153, v26
    v_cvt_pk_bf16_f32 v168, v153, 0
    v_cvt_pk_bf16_f32 v169, 0, v153
    ds_read_b64 v[136:137], v23 offset:23520
    ds_read_b64 v[138:139], v23 offset:23528
    ds_read_b64 v[140:141], v23 offset:23536
    ds_read_b64 v[142:143], v23 offset:23544
    ds_read_b64 v[144:145], v23 offset:23552
    s_waitcnt lgkmcnt(5)
    v_dot2_f32_bf16 v170, v126, v154, 0
    v_dot2_f32_bf16 v171, v126, v155, 0
    v_dot2_f32_bf16 v172, v127, v154, 0
    v_dot2_f32_bf16 v173, v127, v155, 0
    v_dot2_f32_bf16 v174, v128, v154, 0
    v_dot2_f32_bf16 v175, v128, v155, 0
    v_dot2_f32_bf16 v176, v129, v154, 0
    v_dot2_f32_bf16 v177, v129, v155, 0
    v_dot2_f32_bf16 v178, v130, v154, 0
    v_dot2_f32_bf16 v179, v130, v155, 0
    v_dot2_f32_bf16 v180, v131, v154, 0
    v_dot2_f32_bf16 v181, v131, v155, 0
    v_dot2_f32_bf16 v182, v132, v154, 0
    v_dot2_f32_bf16 v183, v132, v155, 0
    v_dot2_f32_bf16 v184, v133, v154, 0
    v_dot2_f32_bf16 v185, v133, v155, 0
    v_dot2_f32_bf16 v186, v134, v154, 0
    v_dot2_f32_bf16 v187, v134, v155, 0
    v_dot2_f32_bf16 v188, v135, v154, 0
    v_dot2_f32_bf16 v189, v135, v155, 0
    ds_read_b64 v[126:127], v23 offset:23184
    ds_read_b64 v[128:129], v23 offset:23192
    ds_read_b64 v[130:131], v23 offset:23200
    ds_read_b64 v[132:133], v23 offset:23208
    ds_read_b64 v[134:135], v23 offset:23216
    s_waitcnt lgkmcnt(5)
    v_dot2_f32_bf16 v170, v136, v156, v170
    v_dot2_f32_bf16 v171, v136, v157, v171
    v_dot2_f32_bf16 v172, v137, v156, v172
    v_dot2_f32_bf16 v173, v137, v157, v173
    v_dot2_f32_bf16 v174, v138, v156, v174
    v_dot2_f32_bf16 v175, v138, v157, v175
    v_dot2_f32_bf16 v176, v139, v156, v176
    v_dot2_f32_bf16 v177, v139, v157, v177
    v_dot2_f32_bf16 v178, v140, v156, v178
    v_dot2_f32_bf16 v179, v140, v157, v179
    v_dot2_f32_bf16 v180, v141, v156, v180
    v_dot2_f32_bf16 v181, v141, v157, v181
    v_dot2_f32_bf16 v182, v142, v156, v182
    v_dot2_f32_bf16 v183, v142, v157, v183
    v_dot2_f32_bf16 v184, v143, v156, v184
    v_dot2_f32_bf16 v185, v143, v157, v185
    v_dot2_f32_bf16 v186, v144, v156, v186
    v_dot2_f32_bf16 v187, v144, v157, v187
    v_dot2_f32_bf16 v188, v145, v156, v188
    v_dot2_f32_bf16 v189, v145, v157, v189
    ds_read_b64 v[136:137], v23 offset:22848
    ds_read_b64 v[138:139], v23 offset:22856
    ds_read_b64 v[140:141], v23 offset:22864
    ds_read_b64 v[142:143], v23 offset:22872
    ds_read_b64 v[144:145], v23 offset:22880
    s_waitcnt lgkmcnt(5)
    v_dot2_f32_bf16 v170, v126, v158, v170
    v_dot2_f32_bf16 v171, v126, v159, v171
    v_dot2_f32_bf16 v172, v127, v158, v172
    v_dot2_f32_bf16 v173, v127, v159, v173
    v_dot2_f32_bf16 v174, v128, v158, v174
    v_dot2_f32_bf16 v175, v128, v159, v175
    v_dot2_f32_bf16 v176, v129, v158, v176
    v_dot2_f32_bf16 v177, v129, v159, v177
    v_dot2_f32_bf16 v178, v130, v158, v178
    v_dot2_f32_bf16 v179, v130, v159, v179
    v_dot2_f32_bf16 v180, v131, v158, v180
    v_dot2_f32_bf16 v181, v131, v159, v181
    v_dot2_f32_bf16 v182, v132, v158, v182
    v_dot2_f32_bf16 v183, v132, v159, v183
    v_dot2_f32_bf16 v184, v133, v158, v184
    v_dot2_f32_bf16 v185, v133, v159, v185
    v_dot2_f32_bf16 v186, v134, v158, v186
    v_dot2_f32_bf16 v187, v134, v159, v187
    v_dot2_f32_bf16 v188, v135, v158, v188
    v_dot2_f32_bf16 v189, v135, v159, v189
    ds_read_b64 v[126:127], v23 offset:22512
    ds_read_b64 v[128:129], v23 offset:22520
    ds_read_b64 v[130:131], v23 offset:22528
    ds_read_b64 v[132:133], v23 offset:22536
    ds_read_b64 v[134:135], v23 offset:22544
    s_waitcnt lgkmcnt(5)
    v_dot2_f32_bf16 v170, v136, v160, v170
    v_dot2_f32_bf16 v171, v136, v161, v171
    v_dot2_f32_bf16 v172, v137, v160, v172
    v_dot2_f32_bf16 v173, v137, v161, v173
    v_dot2_f32_bf16 v174, v138, v160, v174
    v_dot2_f32_bf16 v175, v138, v161, v175
    v_dot2_f32_bf16 v176, v139, v160, v176
    v_dot2_f32_bf16 v177, v139, v161, v177
    v_dot2_f32_bf16 v178, v140, v160, v178
    v_dot2_f32_bf16 v179, v140, v161, v179
    v_dot2_f32_bf16 v180, v141, v160, v180
    v_dot2_f32_bf16 v181, v141, v161, v181
    v_dot2_f32_bf16 v182, v142, v160, v182
    v_dot2_f32_bf16 v183, v142, v161, v183
    v_dot2_f32_bf16 v184, v143, v160, v184
    v_dot2_f32_bf16 v185, v143, v161, v185
    v_dot2_f32_bf16 v186, v144, v160, v186
    v_dot2_f32_bf16 v187, v144, v161, v187
    v_dot2_f32_bf16 v188, v145, v160, v188
    v_dot2_f32_bf16 v189, v145, v161, v189
    ds_read_b64 v[136:137], v23 offset:22176
    ds_read_b64 v[138:139], v23 offset:22184
    ds_read_b64 v[140:141], v23 offset:22192
    ds_read_b64 v[142:143], v23 offset:22200
    ds_read_b64 v[144:145], v23 offset:22208
    s_waitcnt lgkmcnt(5)
    v_dot2_f32_bf16 v170, v126, v162, v170
    v_dot2_f32_bf16 v171, v126, v163, v171
    v_dot2_f32_bf16 v172, v127, v162, v172
    v_dot2_f32_bf16 v173, v127, v163, v173
    v_dot2_f32_bf16 v174, v128, v162, v174
    v_dot2_f32_bf16 v175, v128, v163, v175
    v_dot2_f32_bf16 v176, v129, v162, v176
    v_dot2_f32_bf16 v177, v129, v163, v177
    v_dot2_f32_bf16 v178, v130, v162, v178
    v_dot2_f32_bf16 v179, v130, v163, v179
    v_dot2_f32_bf16 v180, v131, v162, v180
    v_dot2_f32_bf16 v181, v131, v163, v181
    v_dot2_f32_bf16 v182, v132, v162, v182
    v_dot2_f32_bf16 v183, v132, v163, v183
    v_dot2_f32_bf16 v184, v133, v162, v184
    v_dot2_f32_bf16 v185, v133, v163, v185
    v_dot2_f32_bf16 v186, v134, v162, v186
    v_dot2_f32_bf16 v187, v134, v163, v187
    v_dot2_f32_bf16 v188, v135, v162, v188
    v_dot2_f32_bf16 v189, v135, v163, v189
    ds_read_b64 v[126:127], v23 offset:21840
    ds_read_b64 v[128:129], v23 offset:21848
    ds_read_b64 v[130:131], v23 offset:21856
    ds_read_b64 v[132:133], v23 offset:21864
    ds_read_b64 v[134:135], v23 offset:21872
    s_waitcnt lgkmcnt(5)
    v_dot2_f32_bf16 v170, v136, v164, v170
    v_dot2_f32_bf16 v171, v136, v165, v171
    v_dot2_f32_bf16 v172, v137, v164, v172
    v_dot2_f32_bf16 v173, v137, v165, v173
    v_dot2_f32_bf16 v174, v138, v164, v174
    v_dot2_f32_bf16 v175, v138, v165, v175
    v_dot2_f32_bf16 v176, v139, v164, v176
    v_dot2_f32_bf16 v177, v139, v165, v177
    v_dot2_f32_bf16 v178, v140, v164, v178
    v_dot2_f32_bf16 v179, v140, v165, v179
    v_dot2_f32_bf16 v180, v141, v164, v180
    v_dot2_f32_bf16 v181, v141, v165, v181
    v_dot2_f32_bf16 v182, v142, v164, v182
    v_dot2_f32_bf16 v183, v142, v165, v183
    v_dot2_f32_bf16 v184, v143, v164, v184
    v_dot2_f32_bf16 v185, v143, v165, v185
    v_dot2_f32_bf16 v186, v144, v164, v186
    v_dot2_f32_bf16 v187, v144, v165, v187
    v_dot2_f32_bf16 v188, v145, v164, v188
    v_dot2_f32_bf16 v189, v145, v165, v189
    ds_read_b64 v[136:137], v23 offset:21504
    ds_read_b64 v[138:139], v23 offset:21512
    ds_read_b64 v[140:141], v23 offset:21520
    ds_read_b64 v[142:143], v23 offset:21528
    ds_read_b64 v[144:145], v23 offset:21536
    s_waitcnt lgkmcnt(5)
    v_dot2_f32_bf16 v170, v126, v166, v170
    v_dot2_f32_bf16 v171, v126, v167, v171
    v_dot2_f32_bf16 v172, v127, v166, v172
    v_dot2_f32_bf16 v173, v127, v167, v173
    v_dot2_f32_bf16 v174, v128, v166, v174
    v_dot2_f32_bf16 v175, v128, v167, v175
    v_dot2_f32_bf16 v176, v129, v166, v176
    v_dot2_f32_bf16 v177, v129, v167, v177
    v_dot2_f32_bf16 v178, v130, v166, v178
    v_dot2_f32_bf16 v179, v130, v167, v179
    v_dot2_f32_bf16 v180, v131, v166, v180
    v_dot2_f32_bf16 v181, v131, v167, v181
    v_dot2_f32_bf16 v182, v132, v166, v182
    v_dot2_f32_bf16 v183, v132, v167, v183
    v_dot2_f32_bf16 v184, v133, v166, v184
    v_dot2_f32_bf16 v185, v133, v167, v185
    v_dot2_f32_bf16 v186, v134, v166, v186
    v_dot2_f32_bf16 v187, v134, v167, v187
    v_dot2_f32_bf16 v188, v135, v166, v188
    v_dot2_f32_bf16 v189, v135, v167, v189
    s_waitcnt lgkmcnt(0)
    v_dot2_f32_bf16 v170, v136, v168, v170
    v_dot2_f32_bf16 v171, v136, v169, v171
    v_dot2_f32_bf16 v172, v137, v168, v172
    v_dot2_f32_bf16 v173, v137, v169, v173
    v_dot2_f32_bf16 v174, v138, v168, v174
    v_dot2_f32_bf16 v175, v138, v169, v175
    v_dot2_f32_bf16 v176, v139, v168, v176
    v_dot2_f32_bf16 v177, v139, v169, v177
    v_dot2_f32_bf16 v178, v140, v168, v178
    v_dot2_f32_bf16 v179, v140, v169, v179
    v_dot2_f32_bf16 v180, v141, v168, v180
    v_dot2_f32_bf16 v181, v141, v169, v181
    v_dot2_f32_bf16 v182, v142, v168, v182
    v_dot2_f32_bf16 v183, v142, v169, v183
    v_dot2_f32_bf16 v184, v143, v168, v184
    v_dot2_f32_bf16 v185, v143, v169, v185
    v_dot2_f32_bf16 v186, v144, v168, v186
    v_dot2_f32_bf16 v187, v144, v169, v187
    v_dot2_f32_bf16 v188, v145, v168, v188
    v_dot2_f32_bf16 v189, v145, v169, v189
    v_cvt_pk_bf16_f32 v116, v170, v171
    v_cvt_pk_bf16_f32 v117, v172, v173
    v_cvt_pk_bf16_f32 v118, v174, v175
    v_cvt_pk_bf16_f32 v119, v176, v177
    v_cvt_pk_bf16_f32 v120, v178, v179
    v_cvt_pk_bf16_f32 v121, v180, v181
    v_cvt_pk_bf16_f32 v122, v182, v183
    v_cvt_pk_bf16_f32 v123, v184, v185
    v_cvt_pk_bf16_f32 v124, v186, v187
    v_cvt_pk_bf16_f32 v125, v188, v189
    ds_write_b64 v22, v[116:117] offset:0
    ds_write_b64 v22, v[118:119] offset:8
    ds_write_b64 v22, v[120:121] offset:16
    ds_write_b64 v22, v[122:123] offset:24
    ds_write_b64 v22, v[124:125] offset:32
    s_waitcnt lgkmcnt(0)
    s_add_u32 s50, s50, 80
    s_cmp_lt_u32 s50, 160
    s_cbranch_scc1 L_pa_att
    s_cmp_lg_u32 s48, 0
    s_cbranch_scc1 L_pa_o1
    ds_read_b64 a[160:161], v28 offset:32
    ds_read_b64 a[162:163], v28 offset:40
    ds_read_b64 a[240:241], v28 offset:2720
    ds_read_b64 a[242:243], v28 offset:2728
    ds_read_b64 a[164:165], v28 offset:96
    ds_read_b64 a[166:167], v28 offset:104
    ds_read_b64 a[244:245], v28 offset:2784
    ds_read_b64 a[246:247], v28 offset:2792
    s_mov_b32 exec_hi, 0
    ds_read_b64 a[168:169], v28 offset:160
    ds_read_b64 a[170:171], v28 offset:168
    ds_read_b64 a[248:249], v28 offset:2848
    ds_read_b64 a[250:251], v28 offset:2856
    s_mov_b64 exec, -1
    s_branch L_pa_oe
L_pa_o1:
    s_cmp_lg_u32 s48, 1
    s_cbranch_scc1 L_pa_o2
    s_mov_b32 exec_lo, 0
    ds_read_b64 a[168:169], v28 offset:0
    ds_read_b64 a[170:171], v28 offset:8
    ds_read_b64 a[248:249], v28 offset:2688
    ds_read_b64 a[250:251], v28 offset:2696
    s_mov_b64 exec, -1
    ds_read_b64 a[172:173], v28 offset:64
    ds_read_b64 a[174:175], v28 offset:72
    ds_read_b64 a[252:253], v28 offset:2752
    ds_read_b64 a[254:255], v28 offset:2760
    ds_read_b64 a[176:177], v28 offset:128
    ds_read_b64 a[178:179], v28 offset:136
    ds_read_b64 v[32:33], v28 offset:2816
    ds_read_b64 v[34:35], v28 offset:2824
    s_branch L_pa_oe
L_pa_o2:
    s_cmp_lg_u32 s48, 2
    s_cbranch_scc1 L_pa_o3
    ds_read_b64 a[180:181], v28 offset:32
    ds_read_b64 a[182:183], v28 offset:40
    ds_read_b64 v[36:37], v28 offset:2720
    ds_read_b64 v[38:39], v28 offset:2728
    ds_read_b64 a[184:185], v28 offset:96
    ds_read_b64 a[186:187], v28 offset:104
    ds_read_b64 v[40:41], v28 offset:2784
    ds_read_b64 v[42:43], v28 offset:2792
    s_mov_b32 exec_hi, 0
    ds_read_b64 a[188:189], v28 offset:160
    ds_read_b64 a[190:191], v28 offset:168
    ds_read_b64 v[44:45], v28 offset:2848
    ds_read_b64 v[46:47], v28 offset:2856
    s_mov_b64 exec, -1
    s_branch L_pa_oe
L_pa_o3:
    s_cmp_lg_u32 s48, 3
    s_cbranch_scc1 L_pa_o4
    s_mov_b32 exec_lo, 0
    ds_read_b64 a[188:189], v28 offset:0
    ds_read_b64 a[190:191], v28 offset:8
    ds_read_b64 v[44:45], v28 offset:2688
    ds_read_b64 v[46:47], v28 offset:2696
    s_mov_b64 exec, -1
    ds_read_b64 a[192:193], v28 offset:64
    ds_read_b64 a[194:195], v28 offset:72
    ds_read_b64 v[48:49], v28 offset:2752
    ds_read_b64 v[50:51], v28 offset:2760
    ds_read_b64 a[196:197], v28 offset:128
    ds_read_b64 a[198:199], v28 offset:136
    ds_read_b64 v[52:53], v28 offset:2816
    ds_read_b64 v[54:55], v28 offset:2824
    s_branch L_pa_oe
L_pa_o4:
    s_cmp_lg_u32 s48, 4
    s_cbranch_scc1 L_pa_o5
    ds_read_b64 a[200:201], v28 offset:32
    ds_read_b64 a[202:203], v28 offset:40
    ds_read_b64 v[56:57], v28 offset:2720
    ds_read_b64 v[58:59], v28 offset:2728
    ds_read_b64 a[204:205], v28 offset:96
    ds_read_b64 a[206:207], v28 offset:104
    ds_read_b64 v[60:61], v28 offset:2784
    ds_read_b64 v[62:63], v28 offset:2792
    s_mov_b32 exec_hi, 0
    ds_read_b64 a[208:209], v28 offset:160
    ds_read_b64 a[210:211], v28 offset:168
    ds_read_b64 v[64:65], v28 offset:2848
    ds_read_b64 v[66:67], v28 offset:2856
    s_mov_b64 exec, -1
    s_branch L_pa_oe
L_pa_o5:
    s_cmp_lg_u32 s48, 5
    s_cbranch_scc1 L_pa_o6
    s_mov_b32 exec_lo, 0
    ds_read_b64 a[208:209], v28 offset:0
    ds_read_b64 a[210:211], v28 offset:8
    ds_read_b64 v[64:65], v28 offset:2688
    ds_read_b64 v[66:67], v28 offset:2696
    s_mov_b64 exec, -1
    ds_read_b64 a[212:213], v28 offset:64
    ds_read_b64 a[214:215], v28 offset:72
    ds_read_b64 v[68:69], v28 offset:2752
    ds_read_b64 v[70:71], v28 offset:2760
    ds_read_b64 a[216:217], v28 offset:128
    ds_read_b64 a[218:219], v28 offset:136
    ds_read_b64 v[72:73], v28 offset:2816
    ds_read_b64 v[74:75], v28 offset:2824
    s_branch L_pa_oe
L_pa_o6:
    s_cmp_lg_u32 s48, 6
    s_cbranch_scc1 L_pa_o7
    ds_read_b64 a[220:221], v28 offset:32
    ds_read_b64 a[222:223], v28 offset:40
    ds_read_b64 v[76:77], v28 offset:2720
    ds_read_b64 v[78:79], v28 offset:2728
    ds_read_b64 a[224:225], v28 offset:96
    ds_read_b64 a[226:227], v28 offset:104
    ds_read_b64 v[80:81], v28 offset:2784
    ds_read_b64 v[82:83], v28 offset:2792
    s_mov_b32 exec_hi, 0
    ds_read_b64 a[228:229], v28 offset:160
    ds_read_b64 a[230:231], v28 offset:168
    ds_read_b64 v[84:85], v28 offset:2848
    ds_read_b64 v[86:87], v28 offset:2856
    s_mov_b64 exec, -1
    s_branch L_pa_oe
L_pa_o7:
    s_mov_b32 exec_lo, 0
    ds_read_b64 a[228:229], v28 offset:0
    ds_read_b64 a[230:231], v28 offset:8
    ds_read_b64 v[84:85], v28 offset:2688
    ds_read_b64 v[86:87], v28 offset:2696
    s_mov_b64 exec, -1
    ds_read_b64 a[232:233], v28 offset:64
    ds_read_b64 a[234:235], v28 offset:72
    ds_read_b64 v[88:89], v28 offset:2752
    ds_read_b64 v[90:91], v28 offset:2760
    ds_read_b64 a[236:237], v28 offset:128
    ds_read_b64 a[238:239], v28 offset:136
    ds_read_b64 v[92:93], v28 offset:2816
    ds_read_b64 v[94:95], v28 offset:2824
L_pa_oe:
    s_waitcnt lgkmcnt(0)
    s_add_u32 s48, s48, 1
    s_and_b32 s48, s48, 7
    s_cmp_lg_u32 s48, s52
    s_cbranch_scc1 L_pa_grp
    v_add_u32 v3, 0, v0
    v_mul_u32_u24 v4, 6554, v3
    v_lshrrev_b32 v4, 16, v4
    v_mul_u32_u24 v5, 10, v4
    v_sub_u32 v5, v3, v5
    v_and_b32 v6, 19, v4
    v_and_b32 v7, 4, v4
    v_lshl_or_b32 v6, v7, 1, v6
    v_and_b32 v7, 8, v4
    v_lshrrev_b32 v7, 1, v7
    v_or_b32 v6, v6, v7
    s_lshl_b32 s90, s32, 5
    v_add_u32 v6, s90, v6
    v_mul_u32_u24 v6, 1280, v6
    v_lshl_add_u32 v10, v5, 4, v6
    v_add_u32 v3, 64, v0
    v_mul_u32_u24 v4, 6554, v3
    v_lshrrev_b32 v4, 16, v4
    v_mul_u32_u24 v5, 10, v4
    v_sub_u32 v5, v3, v5
    v_and_b32 v6, 19, v4
    v_and_b32 v7, 4, v4
    v_lshl_or_b32 v6, v7, 1, v6
    v_and_b32 v7, 8, v4
    v_lshrrev_b32 v7, 1, v7
    v_or_b32 v6, v6, v7
    s_lshl_b32 s90, s32, 5
    v_add_u32 v6, s90, v6
    v_mul_u32_u24 v6, 1280, v6
    v_lshl_add_u32 v11, v5, 4, v6
    v_add_u32 v3, 128, v0
    v_mul_u32_u24 v4, 6554, v3
    v_lshrrev_b32 v4, 16, v4
    v_mul_u32_u24 v5, 10, v4
    v_sub_u32 v5, v3, v5
    v_and_b32 v6, 19, v4
    v_and_b32 v7, 4, v4
    v_lshl_or_b32 v6, v7, 1, v6
    v_and_b32 v7, 8, v4
    v_lshrrev_b32 v7, 1, v7
    v_or_b32 v6, v6, v7
    s_lshl_b32 s90, s32, 5
    v_add_u32 v6, s90, v6
    v_mul_u32_u24 v6, 1280, v6
    v_lshl_add_u32 v12, v5, 4, v6
    v_add_u32 v3, 192, v0
    v_mul_u32_u24 v4, 6554, v3
    v_lshrrev_b32 v4, 16, v4
    v_mul_u32_u24 v5, 10, v4
    v_sub_u32 v5, v3, v5
    v_and_b32 v6, 19, v4
    v_and_b32 v7, 4, v4
    v_lshl_or_b32 v6, v7, 1, v6
    v_and_b32 v7, 8, v4
    v_lshrrev_b32 v7, 1, v7
    v_or_b32 v6, v6, v7
    s_lshl_b32 s90, s32, 5
    v_add_u32 v6, s90, v6
    v_mul_u32_u24 v6, 1280, v6
    v_lshl_add_u32 v13, v5, 4, v6
    v_add_u32 v3, 256, v0
    v_mul_u32_u24 v4, 6554, v3
    v_lshrrev_b32 v4, 16, v4
    v_mul_u32_u24 v5, 10, v4
    v_sub_u32 v5, v3, v5
    v_and_b32 v6, 19, v4
    v_and_b32 v7, 4, v4
    v_lshl_or_b32 v6, v7, 1, v6
    v_and_b32 v7, 8, v4
    v_lshrrev_b32 v7, 1, v7
    v_or_b32 v6, v6, v7
    s_lshl_b32 s90, s32, 5
    v_add_u32 v6, s90, v6
    v_mul_u32_u24 v6, 1280, v6
    v_lshl_add_u32 v14, v5, 4, v6
    s_waitcnt vmcnt(0) lgkmcnt(0)
    s_barrier
    s_mov_b32 s46, 0
    s_mov_b32 s47, 0
    s_mul_i32 s43, s52, 160
    s_mov_b32 s44, 0
    s_mov_b32 s45, 0
    s_mov_b32 s51, 39
    s_mov_b32 s48, s52
    s_mov_b32 s53, 0
    s_mul_i32 s90, s32, 5120
    s_add_u32 m0, s90, s47
    s_mul_i32 s91, s44, 163840
    s_add_u32 s91, s91, s43
    buffer_load_dwordx4 v10, s[20:23], s91 offen lds
    s_add_u32 s47, s47, 20480
    s_cmp_eq_u32 s47, 81920
    s_cselect_b32 s47, 0, s47
    s_cmp_lg_u32 s51, 0
    s_cselect_b32 s90, 1, 0
    s_sub_u32 s51, s51, s90
    s_add_u32 s44, s44, s90
    s_cmp_eq_u32 s44, 5
    s_cselect_b32 s44, 0, s44
    s_cselect_b32 s90, 160, 0
    s_add_u32 s43, s43, s90
    s_cmp_eq_u32 s43, 1280
    s_cselect_b32 s43, 0, s43
    s_add_u32 m0, m0, 1024
    s_nop 0
    buffer_load_dwordx4 v11, s[20:23], s91 offen lds
    s_add_u32 m0, m0, 1024
    s_nop 0
    buffer_load_dwordx4 v12, s[20:23], s91 offen lds
    s_add_u32 m0, m0, 1024
    s_nop 0
    buffer_load_dwordx4 v13, s[20:23], s91 offen lds
    s_add_u32 m0, m0, 1024
    s_nop 0
    buffer_load_dwordx4 v14, s[20:23], s91 offen lds
    s_mul_i32 s90, s32, 5120
    s_add_u32 m0, s90, s47
    s_mul_i32 s91, s44, 163840
    s_add_u32 s91, s91, s43
    buffer_load_dwordx4 v10, s[20:23], s91 offen lds
    s_add_u32 s47, s47, 20480
    s_cmp_eq_u32 s47, 81920
    s_cselect_b32 s47, 0, s47
    s_cmp_lg_u32 s51, 0
    s_cselect_b32 s90, 1, 0
    s_sub_u32 s51, s51, s90
    s_add_u32 s44, s44, s90
    s_cmp_eq_u32 s44, 5
    s_cselect_b32 s44, 0, s44
    s_cselect_b32 s90, 160, 0
    s_add_u32 s43, s43, s90
    s_cmp_eq_u32 s43, 1280
    s_cselect_b32 s43, 0, s43
    s_add_u32 m0, m0, 1024
    s_nop 0
    buffer_load_dwordx4 v11, s[20:23], s91 offen lds
    s_add_u32 m0, m0, 1024
    s_nop 0
    buffer_load_dwordx4 v12, s[20:23], s91 offen lds
    s_add_u32 m0, m0, 1024
    s_nop 0
    buffer_load_dwordx4 v13, s[20:23], s91 offen lds
    s_add_u32 m0, m0, 1024
    s_nop 0
    buffer_load_dwordx4 v14, s[20:23], s91 offen lds
    s_mul_i32 s90, s32, 5120
    s_add_u32 m0, s90, s47
    s_mul_i32 s91, s44, 163840
    s_add_u32 s91, s91, s43
    buffer_load_dwordx4 v10, s[20:23], s91 offen lds
    s_add_u32 s47, s47, 20480
    s_cmp_eq_u32 s47, 81920
    s_cselect_b32 s47, 0, s47
    s_cmp_lg_u32 s51, 0
    s_cselect_b32 s90, 1, 0
    s_sub_u32 s51, s51, s90
    s_add_u32 s44, s44, s90
    s_cmp_eq_u32 s44, 5
    s_cselect_b32 s44, 0, s44
    s_cselect_b32 s90, 160, 0
    s_add_u32 s43, s43, s90
    s_cmp_eq_u32 s43, 1280
    s_cselect_b32 s43, 0, s43
    s_add_u32 m0, m0, 1024
    s_nop 0
    buffer_load_dwordx4 v11, s[20:23], s91 offen lds
    s_add_u32 m0, m0, 1024
    s_nop 0
    buffer_load_dwordx4 v12, s[20:23], s91 offen lds
    s_add_u32 m0, m0, 1024
    s_nop 0
    buffer_load_dwordx4 v13, s[20:23], s91 offen lds
    s_add_u32 m0, m0, 1024
    s_nop 0
    buffer_load_dwordx4 v14, s[20:23], s91 offen lds
    v_add_u32 v16, s46, v15
    s_waitcnt vmcnt(10) lgkmcnt(0)
    s_barrier
    ds_read_b64_tr_b16 v[96:97], v16 offset:0
    ds_read_b64_tr_b16 v[98:99], v16 offset:1280
    ds_read_b64_tr_b16 v[100:101], v16 offset:32
    ds_read_b64_tr_b16 v[102:103], v16 offset:1312
    ds_read_b64_tr_b16 v[104:105], v16 offset:64
    ds_read_b64_tr_b16 v[106:107], v16 offset:1344
    ds_read_b64_tr_b16 v[108:109], v16 offset:96
    ds_read_b64_tr_b16 v[110:111], v16 offset:1376
    ds_read_b64_tr_b16 v[112:113], v16 offset:128
    ds_read_b64_tr_b16 v[114:115], v16 offset:1408
    s_mul_i32 s42, s52, 160
L_pa_oblk:
    s_waitcnt lgkmcnt(8)
    v_mfma_f32_16x16x32_bf16 v[136:139], v[96:99], a[160:163], 0
    ds_read_b64_tr_b16 v[116:117], v16 offset:5120
    s_add_u32 s46, s46, 20480
    s_cmp_eq_u32 s46, 81920
    v_mfma_f32_16x16x32_bf16 v[140:143], v[96:99], a[240:243], 0
    ds_read_b64_tr_b16 v[118:119], v16 offset:6400
    s_cselect_b32 s46, 0, s46
    s_mul_i32 s90, s32, 5120
    s_waitcnt lgkmcnt(8)
    v_mfma_f32_16x16x32_bf16 v[144:147], v[100:103], a[160:163], 0
    ds_read_b64_tr_b16 v[120:121], v16 offset:5152
    s_add_u32 m0, s90, s47
    s_mul_i32 s91, s44, 163840
    v_mfma_f32_16x16x32_bf16 v[148:151], v[100:103], a[240:243], 0
    ds_read_b64_tr_b16 v[122:123], v16 offset:6432
    s_add_u32 s91, s91, s43
    buffer_load_dwordx4 v10, s[20:23], s91 offen lds
    s_waitcnt lgkmcnt(8)
    v_mfma_f32_16x16x32_bf16 v[152:155], v[104:107], a[160:163], 0
    ds_read_b64_tr_b16 v[124:125], v16 offset:5184
    s_add_u32 s47, s47, 20480
    s_cmp_eq_u32 s47, 81920
    v_mfma_f32_16x16x32_bf16 v[156:159], v[104:107], a[240:243], 0
    ds_read_b64_tr_b16 v[126:127], v16 offset:6464
    s_cselect_b32 s47, 0, s47
    s_cmp_lg_u32 s51, 0
    s_waitcnt lgkmcnt(8)
    v_mfma_f32_16x16x32_bf16 v[160:163], v[108:111], a[160:163], 0
    ds_read_b64_tr_b16 v[128:129], v16 offset:5216
    s_cselect_b32 s90, 1, 0
    s_sub_u32 s51, s51, s90
    v_mfma_f32_16x16x32_bf16 v[164:167], v[108:111], a[240:243], 0
    ds_read_b64_tr_b16 v[130:131], v16 offset:6496
    s_add_u32 s44, s44, s90
    s_cmp_eq_u32 s44, 5
    s_waitcnt lgkmcnt(8)
    v_mfma_f32_16x16x32_bf16 v[168:171], v[112:115], a[160:163], 0
    ds_read_b64_tr_b16 v[132:133], v16 offset:5248
    s_cselect_b32 s44, 0, s44
    s_cselect_b32 s90, 160, 0
    v_mfma_f32_16x16x32_bf16 v[172:175], v[112:115], a[240:243], 0
    ds_read_b64_tr_b16 v[134:135], v16 offset:6528
    s_add_u32 s43, s43, s90
    s_cmp_eq_u32 s43, 1280
    s_waitcnt lgkmcnt(8)
    v_mfma_f32_16x16x32_bf16 v[136:139], v[116:119], a[164:167], v[136:139]
    ds_read_b64_tr_b16 v[96:97], v16 offset:10240
    s_cselect_b32 s43, 0, s43
    s_add_u32 m0, m0, 1024
    v_mfma_f32_16x16x32_bf16 v[140:143], v[116:119], a[244:247], v[140:143]
    ds_read_b64_tr_b16 v[98:99], v16 offset:11520
    buffer_load_dwordx4 v11, s[20:23], s91 offen lds
    s_add_u32 m0, m0, 1024
    s_waitcnt lgkmcnt(8)
    v_mfma_f32_16x16x32_bf16 v[144:147], v[120:123], a[164:167], v[144:147]
    ds_read_b64_tr_b16 v[100:101], v16 offset:10272
    v_mfma_f32_16x16x32_bf16 v[148:151], v[120:123], a[244:247], v[148:151]
    ds_read_b64_tr_b16 v[102:103], v16 offset:11552
    s_waitcnt lgkmcnt(8)
    v_mfma_f32_16x16x32_bf16 v[152:155], v[124:127], a[164:167], v[152:155]
    ds_read_b64_tr_b16 v[104:105], v16 offset:10304
    v_mfma_f32_16x16x32_bf16 v[156:159], v[124:127], a[244:247], v[156:159]
    ds_read_b64_tr_b16 v[106:107], v16 offset:11584
    s_waitcnt lgkmcnt(8)
    v_mfma_f32_16x16x32_bf16 v[160:163], v[128:131], a[164:167], v[160:163]
    ds_read_b64_tr_b16 v[108:109], v16 offset:10336
    buffer_load_dwordx4 v12, s[20:23], s91 offen lds
    s_add_u32 m0, m0, 1024
    v_mfma_f32_16x16x32_bf16 v[164:167], v[128:131], a[244:247], v[164:167]
    ds_read_b64_tr_b16 v[110:111], v16 offset:11616
    s_waitcnt lgkmcnt(8)
    v_mfma_f32_16x16x32_bf16 v[168:171], v[132:135], a[164:167], v[168:171]
    ds_read_b64_tr_b16 v[112:113], v16 offset:10368
    v_mfma_f32_16x16x32_bf16 v[172:175], v[132:135], a[244:247], v[172:175]
    ds_read_b64_tr_b16 v[114:115], v16 offset:11648
    s_waitcnt lgkmcnt(8)
    v_mfma_f32_16x16x32_bf16 v[136:139], v[96:99], a[168:171], v[136:139]
    ds_read_b64_tr_b16 v[116:117], v16 offset:15360
    v_mfma_f32_16x16x32_bf16 v[140:143], v[96:99], a[248:251], v[140:143]
    ds_read_b64_tr_b16 v[118:119], v16 offset:16640
    buffer_load_dwordx4 v13, s[20:23], s91 offen lds
    s_add_u32 m0, m0, 1024
    s_waitcnt lgkmcnt(8)
    v_mfma_f32_16x16x32_bf16 v[144:147], v[100:103], a[168:171], v[144:147]
    ds_read_b64_tr_b16 v[120:121], v16 offset:15392
    v_mfma_f32_16x16x32_bf16 v[148:151], v[100:103], a[248:251], v[148:151]
    ds_read_b64_tr_b16 v[122:123], v16 offset:16672
    s_waitcnt lgkmcnt(8)
    v_mfma_f32_16x16x32_bf16 v[152:155], v[104:107], a[168:171], v[152:155]
    ds_read_b64_tr_b16 v[124:125], v16 offset:15424
    v_mfma_f32_16x16x32_bf16 v[156:159], v[104:107], a[248:251], v[156:159]
    ds_read_b64_tr_b16 v[126:127], v16 offset:16704
    s_waitcnt lgkmcnt(8)
    v_mfma_f32_16x16x32_bf16 v[160:163], v[108:111], a[168:171], v[160:163]
    ds_read_b64_tr_b16 v[128:129], v16 offset:15456
    buffer_load_dwordx4 v14, s[20:23], s91 offen lds
    v_mfma_f32_16x16x32_bf16 v[164:167], v[108:111], a[248:251], v[164:167]
    ds_read_b64_tr_b16 v[130:131], v16 offset:16736
    s_waitcnt lgkmcnt(8)
    v_mfma_f32_16x16x32_bf16 v[168:171], v[112:115], a[168:171], v[168:171]
    ds_read_b64_tr_b16 v[132:133], v16 offset:15488
    v_mfma_f32_16x16x32_bf16 v[172:175], v[112:115], a[248:251], v[172:175]
    ds_read_b64_tr_b16 v[134:135], v16 offset:16768
    s_waitcnt lgkmcnt(8)
    v_mfma_f32_16x16x32_bf16 v[136:139], v[116:119], a[172:175], v[136:139]
    v_mfma_f32_16x16x32_bf16 v[140:143], v[116:119], a[252:255], v[140:143]
    s_waitcnt lgkmcnt(6)
    v_mfma_f32_16x16x32_bf16 v[144:147], v[120:123], a[172:175], v[144:147]
    v_mfma_f32_16x16x32_bf16 v[148:151], v[120:123], a[252:255], v[148:151]
    v_add_u32 v16, s46, v15
    s_waitcnt vmcnt(10) lgkmcnt(0)
    s_barrier
    v_mfma_f32_16x16x32_bf16 v[152:155], v[124:127], a[172:175], v[152:155]
    ds_read_b64_tr_b16 v[96:97], v16 offset:0
    ds_read_b64_tr_b16 v[98:99], v16 offset:1280
    v_mfma_f32_16x16x32_bf16 v[156:159], v[124:127], a[252:255], v[156:159]
    ds_read_b64_tr_b16 v[100:101], v16 offset:32
    ds_read_b64_tr_b16 v[102:103], v16 offset:1312
    v_mfma_f32_16x16x32_bf16 v[160:163], v[128:131], a[172:175], v[160:163]
    ds_read_b64_tr_b16 v[104:105], v16 offset:64
    ds_read_b64_tr_b16 v[106:107], v16 offset:1344
    v_mfma_f32_16x16x32_bf16 v[164:167], v[128:131], a[252:255], v[164:167]
    ds_read_b64_tr_b16 v[108:109], v16 offset:96
    ds_read_b64_tr_b16 v[110:111], v16 offset:1376
    v_mfma_f32_16x16x32_bf16 v[168:171], v[132:135], a[172:175], v[168:171]
    ds_read_b64_tr_b16 v[112:113], v16 offset:128
    ds_read_b64_tr_b16 v[114:115], v16 offset:1408
    v_mfma_f32_16x16x32_bf16 v[172:175], v[132:135], a[252:255], v[172:175]
    s_waitcnt lgkmcnt(8)
    v_mfma_f32_16x16x32_bf16 v[136:139], v[96:99], a[176:179], v[136:139]
    ds_read_b64_tr_b16 v[116:117], v16 offset:5120
    s_add_u32 s46, s46, 20480
    s_cmp_eq_u32 s46, 81920
    v_mfma_f32_16x16x32_bf16 v[140:143], v[96:99], v[32:35], v[140:143]
    ds_read_b64_tr_b16 v[118:119], v16 offset:6400
    s_cselect_b32 s46, 0, s46
    s_mul_i32 s90, s32, 5120
    s_waitcnt lgkmcnt(8)
    v_mfma_f32_16x16x32_bf16 v[144:147], v[100:103], a[176:179], v[144:147]
    ds_read_b64_tr_b16 v[120:121], v16 offset:5152
    s_add_u32 m0, s90, s47
    s_mul_i32 s91, s44, 163840
    v_mfma_f32_16x16x32_bf16 v[148:151], v[100:103], v[32:35], v[148:151]
    ds_read_b64_tr_b16 v[122:123], v16 offset:6432
    s_add_u32 s91, s91, s43
    buffer_load_dwordx4 v10, s[20:23], s91 offen lds
    s_waitcnt lgkmcnt(8)
    v_mfma_f32_16x16x32_bf16 v[152:155], v[104:107], a[176:179], v[152:155]
    ds_read_b64_tr_b16 v[124:125], v16 offset:5184
    s_add_u32 s47, s47, 20480
    s_cmp_eq_u32 s47, 81920
    v_mfma_f32_16x16x32_bf16 v[156:159], v[104:107], v[32:35], v[156:159]
    ds_read_b64_tr_b16 v[126:127], v16 offset:6464
    s_cselect_b32 s47, 0, s47
    s_cmp_lg_u32 s51, 0
    s_waitcnt lgkmcnt(8)
    v_mfma_f32_16x16x32_bf16 v[160:163], v[108:111], a[176:179], v[160:163]
    ds_read_b64_tr_b16 v[128:129], v16 offset:5216
    s_cselect_b32 s90, 1, 0
    s_sub_u32 s51, s51, s90
    v_mfma_f32_16x16x32_bf16 v[164:167], v[108:111], v[32:35], v[164:167]
    ds_read_b64_tr_b16 v[130:131], v16 offset:6496
    s_add_u32 s44, s44, s90
    s_cmp_eq_u32 s44, 5
    s_waitcnt lgkmcnt(8)
    v_mfma_f32_16x16x32_bf16 v[168:171], v[112:115], a[176:179], v[168:171]
    ds_read_b64_tr_b16 v[132:133], v16 offset:5248
    s_cselect_b32 s44, 0, s44
    s_cselect_b32 s90, 160, 0
    v_mfma_f32_16x16x32_bf16 v[172:175], v[112:115], v[32:35], v[172:175]
    ds_read_b64_tr_b16 v[134:135], v16 offset:6528
    s_add_u32 s43, s43, s90
    s_cmp_eq_u32 s43, 1280
    s_waitcnt lgkmcnt(8)
    v_mfma_f32_16x16x32_bf16 v[136:139], v[116:119], a[180:183], v[136:139]
    ds_read_b64_tr_b16 v[96:97], v16 offset:10240
    s_cselect_b32 s43, 0, s43
    s_add_u32 m0, m0, 1024
    v_mfma_f32_16x16x32_bf16 v[140:143], v[116:119], v[36:39], v[140:143]
    ds_read_b64_tr_b16 v[98:99], v16 offset:11520
    buffer_load_dwordx4 v11, s[20:23], s91 offen lds
    s_add_u32 m0, m0, 1024
    s_waitcnt lgkmcnt(8)
    v_mfma_f32_16x16x32_bf16 v[144:147], v[120:123], a[180:183], v[144:147]
    ds_read_b64_tr_b16 v[100:101], v16 offset:10272
    v_mfma_f32_16x16x32_bf16 v[148:151], v[120:123], v[36:39], v[148:151]
    ds_read_b64_tr_b16 v[102:103], v16 offset:11552
    s_waitcnt lgkmcnt(8)
    v_mfma_f32_16x16x32_bf16 v[152:155], v[124:127], a[180:183], v[152:155]
    ds_read_b64_tr_b16 v[104:105], v16 offset:10304
    v_mfma_f32_16x16x32_bf16 v[156:159], v[124:127], v[36:39], v[156:159]
    ds_read_b64_tr_b16 v[106:107], v16 offset:11584
    s_waitcnt lgkmcnt(8)
    v_mfma_f32_16x16x32_bf16 v[160:163], v[128:131], a[180:183], v[160:163]
    ds_read_b64_tr_b16 v[108:109], v16 offset:10336
    buffer_load_dwordx4 v12, s[20:23], s91 offen lds
    s_add_u32 m0, m0, 1024
    v_mfma_f32_16x16x32_bf16 v[164:167], v[128:131], v[36:39], v[164:167]
    ds_read_b64_tr_b16 v[110:111], v16 offset:11616
    s_waitcnt lgkmcnt(8)
    v_mfma_f32_16x16x32_bf16 v[168:171], v[132:135], a[180:183], v[168:171]
    ds_read_b64_tr_b16 v[112:113], v16 offset:10368
    v_mfma_f32_16x16x32_bf16 v[172:175], v[132:135], v[36:39], v[172:175]
    ds_read_b64_tr_b16 v[114:115], v16 offset:11648
    s_waitcnt lgkmcnt(8)
    v_mfma_f32_16x16x32_bf16 v[136:139], v[96:99], a[184:187], v[136:139]
    ds_read_b64_tr_b16 v[116:117], v16 offset:15360
    v_mfma_f32_16x16x32_bf16 v[140:143], v[96:99], v[40:43], v[140:143]
    ds_read_b64_tr_b16 v[118:119], v16 offset:16640
    buffer_load_dwordx4 v13, s[20:23], s91 offen lds
    s_add_u32 m0, m0, 1024
    s_waitcnt lgkmcnt(8)
    v_mfma_f32_16x16x32_bf16 v[144:147], v[100:103], a[184:187], v[144:147]
    ds_read_b64_tr_b16 v[120:121], v16 offset:15392
    v_mfma_f32_16x16x32_bf16 v[148:151], v[100:103], v[40:43], v[148:151]
    ds_read_b64_tr_b16 v[122:123], v16 offset:16672
    s_waitcnt lgkmcnt(8)
    v_mfma_f32_16x16x32_bf16 v[152:155], v[104:107], a[184:187], v[152:155]
    ds_read_b64_tr_b16 v[124:125], v16 offset:15424
    v_mfma_f32_16x16x32_bf16 v[156:159], v[104:107], v[40:43], v[156:159]
    ds_read_b64_tr_b16 v[126:127], v16 offset:16704
    s_waitcnt lgkmcnt(8)
    v_mfma_f32_16x16x32_bf16 v[160:163], v[108:111], a[184:187], v[160:163]
    ds_read_b64_tr_b16 v[128:129], v16 offset:15456
    buffer_load_dwordx4 v14, s[20:23], s91 offen lds
    v_mfma_f32_16x16x32_bf16 v[164:167], v[108:111], v[40:43], v[164:167]
    ds_read_b64_tr_b16 v[130:131], v16 offset:16736
    s_waitcnt lgkmcnt(8)
    v_mfma_f32_16x16x32_bf16 v[168:171], v[112:115], a[184:187], v[168:171]
    ds_read_b64_tr_b16 v[132:133], v16 offset:15488
    v_mfma_f32_16x16x32_bf16 v[172:175], v[112:115], v[40:43], v[172:175]
    ds_read_b64_tr_b16 v[134:135], v16 offset:16768
    s_waitcnt lgkmcnt(8)
    v_mfma_f32_16x16x32_bf16 v[136:139], v[116:119], a[188:191], v[136:139]
    v_mfma_f32_16x16x32_bf16 v[140:143], v[116:119], v[44:47], v[140:143]
    s_waitcnt lgkmcnt(6)
    v_mfma_f32_16x16x32_bf16 v[144:147], v[120:123], a[188:191], v[144:147]
    v_mfma_f32_16x16x32_bf16 v[148:151], v[120:123], v[44:47], v[148:151]
    v_add_u32 v16, s46, v15
    s_waitcnt vmcnt(10) lgkmcnt(0)
    s_barrier
    v_mfma_f32_16x16x32_bf16 v[152:155], v[124:127], a[188:191], v[152:155]
    ds_read_b64_tr_b16 v[96:97], v16 offset:0
    ds_read_b64_tr_b16 v[98:99], v16 offset:1280
    v_mfma_f32_16x16x32_bf16 v[156:159], v[124:127], v[44:47], v[156:159]
    ds_read_b64_tr_b16 v[100:101], v16 offset:32
    ds_read_b64_tr_b16 v[102:103], v16 offset:1312
    v_mfma_f32_16x16x32_bf16 v[160:163], v[128:131], a[188:191], v[160:163]
    ds_read_b64_tr_b16 v[104:105], v16 offset:64
    ds_read_b64_tr_b16 v[106:107], v16 offset:1344
    v_mfma_f32_16x16x32_bf16 v[164:167], v[128:131], v[44:47], v[164:167]
    ds_read_b64_tr_b16 v[108:109], v16 offset:96
    ds_read_b64_tr_b16 v[110:111], v16 offset:1376
    v_mfma_f32_16x16x32_bf16 v[168:171], v[132:135], a[188:191], v[168:171]
    ds_read_b64_tr_b16 v[112:113], v16 offset:128
    ds_read_b64_tr_b16 v[114:115], v16 offset:1408
    v_mfma_f32_16x16x32_bf16 v[172:175], v[132:135], v[44:47], v[172:175]
    s_waitcnt lgkmcnt(8)
    v_mfma_f32_16x16x32_bf16 v[136:139], v[96:99], a[192:195], v[136:139]
    ds_read_b64_tr_b16 v[116:117], v16 offset:5120
    s_add_u32 s46, s46, 20480
    s_cmp_eq_u32 s46, 81920
    v_mfma_f32_16x16x32_bf16 v[140:143], v[96:99], v[48:51], v[140:143]
    ds_read_b64_tr_b16 v[118:119], v16 offset:6400
    s_cselect_b32 s46, 0, s46
    s_mul_i32 s90, s32, 5120
    s_waitcnt lgkmcnt(8)
    v_mfma_f32_16x16x32_bf16 v[144:147], v[100:103], a[192:195], v[144:147]
    ds_read_b64_tr_b16 v[120:121], v16 offset:5152
    s_add_u32 m0, s90, s47
    s_mul_i32 s91, s44, 163840
    v_mfma_f32_16x16x32_bf16 v[148:151], v[100:103], v[48:51], v[148:151]
    ds_read_b64_tr_b16 v[122:123], v16 offset:6432
    s_add_u32 s91, s91, s43
    buffer_load_dwordx4 v10, s[20:23], s91 offen lds
    s_waitcnt lgkmcnt(8)
    v_mfma_f32_16x16x32_bf16 v[152:155], v[104:107], a[192:195], v[152:155]
    ds_read_b64_tr_b16 v[124:125], v16 offset:5184
    s_add_u32 s47, s47, 20480
    s_cmp_eq_u32 s47, 81920
    v_mfma_f32_16x16x32_bf16 v[156:159], v[104:107], v[48:51], v[156:159]
    ds_read_b64_tr_b16 v[126:127], v16 offset:6464
    s_cselect_b32 s47, 0, s47
    s_cmp_lg_u32 s51, 0
    s_waitcnt lgkmcnt(8)
    v_mfma_f32_16x16x32_bf16 v[160:163], v[108:111], a[192:195], v[160:163]
    ds_read_b64_tr_b16 v[128:129], v16 offset:5216
    s_cselect_b32 s90, 1, 0
    s_sub_u32 s51, s51, s90
    v_mfma_f32_16x16x32_bf16 v[164:167], v[108:111], v[48:51], v[164:167]
    ds_read_b64_tr_b16 v[130:131], v16 offset:6496
    s_add_u32 s44, s44, s90
    s_cmp_eq_u32 s44, 5
    s_waitcnt lgkmcnt(8)
    v_mfma_f32_16x16x32_bf16 v[168:171], v[112:115], a[192:195], v[168:171]
    ds_read_b64_tr_b16 v[132:133], v16 offset:5248
    s_cselect_b32 s44, 0, s44
    s_cselect_b32 s90, 160, 0
    v_mfma_f32_16x16x32_bf16 v[172:175], v[112:115], v[48:51], v[172:175]
    ds_read_b64_tr_b16 v[134:135], v16 offset:6528
    s_add_u32 s43, s43, s90
    s_cmp_eq_u32 s43, 1280
    s_waitcnt lgkmcnt(8)
    v_mfma_f32_16x16x32_bf16 v[136:139], v[116:119], a[196:199], v[136:139]
    ds_read_b64_tr_b16 v[96:97], v16 offset:10240
    s_cselect_b32 s43, 0, s43
    s_add_u32 m0, m0, 1024
    v_mfma_f32_16x16x32_bf16 v[140:143], v[116:119], v[52:55], v[140:143]
    ds_read_b64_tr_b16 v[98:99], v16 offset:11520
    buffer_load_dwordx4 v11, s[20:23], s91 offen lds
    s_add_u32 m0, m0, 1024
    s_waitcnt lgkmcnt(8)
    v_mfma_f32_16x16x32_bf16 v[144:147], v[120:123], a[196:199], v[144:147]
    ds_read_b64_tr_b16 v[100:101], v16 offset:10272
    v_mfma_f32_16x16x32_bf16 v[148:151], v[120:123], v[52:55], v[148:151]
    ds_read_b64_tr_b16 v[102:103], v16 offset:11552
    s_waitcnt lgkmcnt(8)
    v_mfma_f32_16x16x32_bf16 v[152:155], v[124:127], a[196:199], v[152:155]
    ds_read_b64_tr_b16 v[104:105], v16 offset:10304
    v_mfma_f32_16x16x32_bf16 v[156:159], v[124:127], v[52:55], v[156:159]
    ds_read_b64_tr_b16 v[106:107], v16 offset:11584
    s_waitcnt lgkmcnt(8)
    v_mfma_f32_16x16x32_bf16 v[160:163], v[128:131], a[196:199], v[160:163]
    ds_read_b64_tr_b16 v[108:109], v16 offset:10336
    buffer_load_dwordx4 v12, s[20:23], s91 offen lds
    s_add_u32 m0, m0, 1024
    v_mfma_f32_16x16x32_bf16 v[164:167], v[128:131], v[52:55], v[164:167]
    ds_read_b64_tr_b16 v[110:111], v16 offset:11616
    s_waitcnt lgkmcnt(8)
    v_mfma_f32_16x16x32_bf16 v[168:171], v[132:135], a[196:199], v[168:171]
    ds_read_b64_tr_b16 v[112:113], v16 offset:10368
    v_mfma_f32_16x16x32_bf16 v[172:175], v[132:135], v[52:55], v[172:175]
    ds_read_b64_tr_b16 v[114:115], v16 offset:11648
    s_waitcnt lgkmcnt(8)
    v_mfma_f32_16x16x32_bf16 v[136:139], v[96:99], a[200:203], v[136:139]
    ds_read_b64_tr_b16 v[116:117], v16 offset:15360
    v_mfma_f32_16x16x32_bf16 v[140:143], v[96:99], v[56:59], v[140:143]
    ds_read_b64_tr_b16 v[118:119], v16 offset:16640
    buffer_load_dwordx4 v13, s[20:23], s91 offen lds
    s_add_u32 m0, m0, 1024
    s_waitcnt lgkmcnt(8)
    v_mfma_f32_16x16x32_bf16 v[144:147], v[100:103], a[200:203], v[144:147]
    ds_read_b64_tr_b16 v[120:121], v16 offset:15392
    v_mfma_f32_16x16x32_bf16 v[148:151], v[100:103], v[56:59], v[148:151]
    ds_read_b64_tr_b16 v[122:123], v16 offset:16672
    s_waitcnt lgkmcnt(8)
    v_mfma_f32_16x16x32_bf16 v[152:155], v[104:107], a[200:203], v[152:155]
    ds_read_b64_tr_b16 v[124:125], v16 offset:15424
    v_mfma_f32_16x16x32_bf16 v[156:159], v[104:107], v[56:59], v[156:159]
    ds_read_b64_tr_b16 v[126:127], v16 offset:16704
    s_waitcnt lgkmcnt(8)
    v_mfma_f32_16x16x32_bf16 v[160:163], v[108:111], a[200:203], v[160:163]
    ds_read_b64_tr_b16 v[128:129], v16 offset:15456
    buffer_load_dwordx4 v14, s[20:23], s91 offen lds
    v_mfma_f32_16x16x32_bf16 v[164:167], v[108:111], v[56:59], v[164:167]
    ds_read_b64_tr_b16 v[130:131], v16 offset:16736
    s_waitcnt lgkmcnt(8)
    v_mfma_f32_16x16x32_bf16 v[168:171], v[112:115], a[200:203], v[168:171]
    ds_read_b64_tr_b16 v[132:133], v16 offset:15488
    v_mfma_f32_16x16x32_bf16 v[172:175], v[112:115], v[56:59], v[172:175]
    ds_read_b64_tr_b16 v[134:135], v16 offset:16768
    s_waitcnt lgkmcnt(8)
    v_mfma_f32_16x16x32_bf16 v[136:139], v[116:119], a[204:207], v[136:139]
    v_mfma_f32_16x16x32_bf16 v[140:143], v[116:119], v[60:63], v[140:143]
    s_waitcnt lgkmcnt(6)
    v_mfma_f32_16x16x32_bf16 v[144:147], v[120:123], a[204:207], v[144:147]
    v_mfma_f32_16x16x32_bf16 v[148:151], v[120:123], v[60:63], v[148:151]
    v_add_u32 v16, s46, v15
    s_waitcnt vmcnt(10) lgkmcnt(0)
    s_barrier
    v_mfma_f32_16x16x32_bf16 v[152:155], v[124:127], a[204:207], v[152:155]
    ds_read_b64_tr_b16 v[96:97], v16 offset:0
    ds_read_b64_tr_b16 v[98:99], v16 offset:1280
    v_mfma_f32_16x16x32_bf16 v[156:159], v[124:127], v[60:63], v[156:159]
    ds_read_b64_tr_b16 v[100:101], v16 offset:32
    ds_read_b64_tr_b16 v[102:103], v16 offset:1312
    v_mfma_f32_16x16x32_bf16 v[160:163], v[128:131], a[204:207], v[160:163]
    ds_read_b64_tr_b16 v[104:105], v16 offset:64
    ds_read_b64_tr_b16 v[106:107], v16 offset:1344
    v_mfma_f32_16x16x32_bf16 v[164:167], v[128:131], v[60:63], v[164:167]
    ds_read_b64_tr_b16 v[108:109], v16 offset:96
    ds_read_b64_tr_b16 v[110:111], v16 offset:1376
    v_mfma_f32_16x16x32_bf16 v[168:171], v[132:135], a[204:207], v[168:171]
    ds_read_b64_tr_b16 v[112:113], v16 offset:128
    ds_read_b64_tr_b16 v[114:115], v16 offset:1408
    v_mfma_f32_16x16x32_bf16 v[172:175], v[132:135], v[60:63], v[172:175]
    s_waitcnt lgkmcnt(8)
    v_mfma_f32_16x16x32_bf16 v[136:139], v[96:99], a[208:211], v[136:139]
    ds_read_b64_tr_b16 v[116:117], v16 offset:5120
    s_add_u32 s46, s46, 20480
    s_cmp_eq_u32 s46, 81920
    v_mfma_f32_16x16x32_bf16 v[140:143], v[96:99], v[64:67], v[140:143]
    ds_read_b64_tr_b16 v[118:119], v16 offset:6400
    s_cselect_b32 s46, 0, s46
    s_mul_i32 s90, s32, 5120
    s_waitcnt lgkmcnt(8)
    v_mfma_f32_16x16x32_bf16 v[144:147], v[100:103], a[208:211], v[144:147]
    ds_read_b64_tr_b16 v[120:121], v16 offset:5152
    s_add_u32 m0, s90, s47
    s_mul_i32 s91, s44, 163840
    v_mfma_f32_16x16x32_bf16 v[148:151], v[100:103], v[64:67], v[148:151]
    ds_read_b64_tr_b16 v[122:123], v16 offset:6432
    s_add_u32 s91, s91, s43
    buffer_load_dwordx4 v10, s[20:23], s91 offen lds
    s_waitcnt lgkmcnt(8)
    v_mfma_f32_16x16x32_bf16 v[152:155], v[104:107], a[208:211], v[152:155]
    ds_read_b64_tr_b16 v[124:125], v16 offset:5184
    s_add_u32 s47, s47, 20480
    s_cmp_eq_u32 s47, 81920
    v_mfma_f32_16x16x32_bf16 v[156:159], v[104:107], v[64:67], v[156:159]
    ds_read_b64_tr_b16 v[126:127], v16 offset:6464
    s_cselect_b32 s47, 0, s47
    s_cmp_lg_u32 s51, 0
    s_waitcnt lgkmcnt(8)
    v_mfma_f32_16x16x32_bf16 v[160:163], v[108:111], a[208:211], v[160:163]
    ds_read_b64_tr_b16 v[128:129], v16 offset:5216
    s_cselect_b32 s90, 1, 0
    s_sub_u32 s51, s51, s90
    v_mfma_f32_16x16x32_bf16 v[164:167], v[108:111], v[64:67], v[164:167]
    ds_read_b64_tr_b16 v[130:131], v16 offset:6496
    s_add_u32 s44, s44, s90
    s_cmp_eq_u32 s44, 5
    s_waitcnt lgkmcnt(8)
    v_mfma_f32_16x16x32_bf16 v[168:171], v[112:115], a[208:211], v[168:171]
    ds_read_b64_tr_b16 v[132:133], v16 offset:5248
    s_cselect_b32 s44, 0, s44
    s_cselect_b32 s90, 160, 0
    v_mfma_f32_16x16x32_bf16 v[172:175], v[112:115], v[64:67], v[172:175]
    ds_read_b64_tr_b16 v[134:135], v16 offset:6528
    s_add_u32 s43, s43, s90
    s_cmp_eq_u32 s43, 1280
    s_waitcnt lgkmcnt(8)
    v_mfma_f32_16x16x32_bf16 v[136:139], v[116:119], a[212:215], v[136:139]
    ds_read_b64_tr_b16 v[96:97], v16 offset:10240
    s_cselect_b32 s43, 0, s43
    s_add_u32 m0, m0, 1024
    v_mfma_f32_16x16x32_bf16 v[140:143], v[116:119], v[68:71], v[140:143]
    ds_read_b64_tr_b16 v[98:99], v16 offset:11520
    buffer_load_dwordx4 v11, s[20:23], s91 offen lds
    s_add_u32 m0, m0, 1024
    s_waitcnt lgkmcnt(8)
    v_mfma_f32_16x16x32_bf16 v[144:147], v[120:123], a[212:215], v[144:147]
    ds_read_b64_tr_b16 v[100:101], v16 offset:10272
    v_mfma_f32_16x16x32_bf16 v[148:151], v[120:123], v[68:71], v[148:151]
    ds_read_b64_tr_b16 v[102:103], v16 offset:11552
    s_waitcnt lgkmcnt(8)
    v_mfma_f32_16x16x32_bf16 v[152:155], v[124:127], a[212:215], v[152:155]
    ds_read_b64_tr_b16 v[104:105], v16 offset:10304
    v_mfma_f32_16x16x32_bf16 v[156:159], v[124:127], v[68:71], v[156:159]
    ds_read_b64_tr_b16 v[106:107], v16 offset:11584
    s_waitcnt lgkmcnt(8)
    v_mfma_f32_16x16x32_bf16 v[160:163], v[128:131], a[212:215], v[160:163]
    ds_read_b64_tr_b16 v[108:109], v16 offset:10336
    buffer_load_dwordx4 v12, s[20:23], s91 offen lds
    s_add_u32 m0, m0, 1024
    v_mfma_f32_16x16x32_bf16 v[164:167], v[128:131], v[68:71], v[164:167]
    ds_read_b64_tr_b16 v[110:111], v16 offset:11616
    s_waitcnt lgkmcnt(8)
    v_mfma_f32_16x16x32_bf16 v[168:171], v[132:135], a[212:215], v[168:171]
    ds_read_b64_tr_b16 v[112:113], v16 offset:10368
    v_mfma_f32_16x16x32_bf16 v[172:175], v[132:135], v[68:71], v[172:175]
    ds_read_b64_tr_b16 v[114:115], v16 offset:11648
    s_waitcnt lgkmcnt(8)
    v_mfma_f32_16x16x32_bf16 v[136:139], v[96:99], a[216:219], v[136:139]
    ds_read_b64_tr_b16 v[116:117], v16 offset:15360
    v_mfma_f32_16x16x32_bf16 v[140:143], v[96:99], v[72:75], v[140:143]
    ds_read_b64_tr_b16 v[118:119], v16 offset:16640
    buffer_load_dwordx4 v13, s[20:23], s91 offen lds
    s_add_u32 m0, m0, 1024
    s_waitcnt lgkmcnt(8)
    v_mfma_f32_16x16x32_bf16 v[144:147], v[100:103], a[216:219], v[144:147]
    ds_read_b64_tr_b16 v[120:121], v16 offset:15392
    v_mfma_f32_16x16x32_bf16 v[148:151], v[100:103], v[72:75], v[148:151]
    ds_read_b64_tr_b16 v[122:123], v16 offset:16672
    s_waitcnt lgkmcnt(8)
    v_mfma_f32_16x16x32_bf16 v[152:155], v[104:107], a[216:219], v[152:155]
    ds_read_b64_tr_b16 v[124:125], v16 offset:15424
    v_mfma_f32_16x16x32_bf16 v[156:159], v[104:107], v[72:75], v[156:159]
    ds_read_b64_tr_b16 v[126:127], v16 offset:16704
    s_waitcnt lgkmcnt(8)
    v_mfma_f32_16x16x32_bf16 v[160:163], v[108:111], a[216:219], v[160:163]
    ds_read_b64_tr_b16 v[128:129], v16 offset:15456
    buffer_load_dwordx4 v14, s[20:23], s91 offen lds
    v_mfma_f32_16x16x32_bf16 v[164:167], v[108:111], v[72:75], v[164:167]
    ds_read_b64_tr_b16 v[130:131], v16 offset:16736
    s_waitcnt lgkmcnt(8)
    v_mfma_f32_16x16x32_bf16 v[168:171], v[112:115], a[216:219], v[168:171]
    ds_read_b64_tr_b16 v[132:133], v16 offset:15488
    v_mfma_f32_16x16x32_bf16 v[172:175], v[112:115], v[72:75], v[172:175]
    ds_read_b64_tr_b16 v[134:135], v16 offset:16768
    s_waitcnt lgkmcnt(8)
    v_mfma_f32_16x16x32_bf16 v[136:139], v[116:119], a[220:223], v[136:139]
    v_mfma_f32_16x16x32_bf16 v[140:143], v[116:119], v[76:79], v[140:143]
    s_waitcnt lgkmcnt(6)
    v_mfma_f32_16x16x32_bf16 v[144:147], v[120:123], a[220:223], v[144:147]
    v_mfma_f32_16x16x32_bf16 v[148:151], v[120:123], v[76:79], v[148:151]
    v_add_u32 v16, s46, v15
    s_waitcnt vmcnt(10) lgkmcnt(0)
    s_barrier
    v_mfma_f32_16x16x32_bf16 v[152:155], v[124:127], a[220:223], v[152:155]
    ds_read_b64_tr_b16 v[96:97], v16 offset:0
    ds_read_b64_tr_b16 v[98:99], v16 offset:1280
    v_mfma_f32_16x16x32_bf16 v[156:159], v[124:127], v[76:79], v[156:159]
    ds_read_b64_tr_b16 v[100:101], v16 offset:32
    ds_read_b64_tr_b16 v[102:103], v16 offset:1312
    v_mfma_f32_16x16x32_bf16 v[160:163], v[128:131], a[220:223], v[160:163]
    ds_read_b64_tr_b16 v[104:105], v16 offset:64
    ds_read_b64_tr_b16 v[106:107], v16 offset:1344
    v_mfma_f32_16x16x32_bf16 v[164:167], v[128:131], v[76:79], v[164:167]
    ds_read_b64_tr_b16 v[108:109], v16 offset:96
    ds_read_b64_tr_b16 v[110:111], v16 offset:1376
    v_mfma_f32_16x16x32_bf16 v[168:171], v[132:135], a[220:223], v[168:171]
    ds_read_b64_tr_b16 v[112:113], v16 offset:128
    ds_read_b64_tr_b16 v[114:115], v16 offset:1408
    v_mfma_f32_16x16x32_bf16 v[172:175], v[132:135], v[76:79], v[172:175]
    s_waitcnt lgkmcnt(8)
    v_mfma_f32_16x16x32_bf16 v[136:139], v[96:99], a[224:227], v[136:139]
    ds_read_b64_tr_b16 v[116:117], v16 offset:5120
    s_add_u32 s46, s46, 20480
    s_cmp_eq_u32 s46, 81920
    v_mfma_f32_16x16x32_bf16 v[140:143], v[96:99], v[80:83], v[140:143]
    ds_read_b64_tr_b16 v[118:119], v16 offset:6400
    s_cselect_b32 s46, 0, s46
    s_mul_i32 s90, s32, 5120
    s_waitcnt lgkmcnt(8)
    v_mfma_f32_16x16x32_bf16 v[144:147], v[100:103], a[224:227], v[144:147]
    ds_read_b64_tr_b16 v[120:121], v16 offset:5152
    s_add_u32 m0, s90, s47
    s_mul_i32 s91, s44, 163840
    v_mfma_f32_16x16x32_bf16 v[148:151], v[100:103], v[80:83], v[148:151]
    ds_read_b64_tr_b16 v[122:123], v16 offset:6432
    s_add_u32 s91, s91, s43
    buffer_load_dwordx4 v10, s[20:23], s91 offen lds
    s_waitcnt lgkmcnt(8)
    v_mfma_f32_16x16x32_bf16 v[152:155], v[104:107], a[224:227], v[152:155]
    ds_read_b64_tr_b16 v[124:125], v16 offset:5184
    s_add_u32 s47, s47, 20480
    s_cmp_eq_u32 s47, 81920
    v_mfma_f32_16x16x32_bf16 v[156:159], v[104:107], v[80:83], v[156:159]
    ds_read_b64_tr_b16 v[126:127], v16 offset:6464
    s_cselect_b32 s47, 0, s47
    s_cmp_lg_u32 s51, 0
    s_waitcnt lgkmcnt(8)
    v_mfma_f32_16x16x32_bf16 v[160:163], v[108:111], a[224:227], v[160:163]
    ds_read_b64_tr_b16 v[128:129], v16 offset:5216
    s_cselect_b32 s90, 1, 0
    s_sub_u32 s51, s51, s90
    v_mfma_f32_16x16x32_bf16 v[164:167], v[108:111], v[80:83], v[164:167]
    ds_read_b64_tr_b16 v[130:131], v16 offset:6496
    s_add_u32 s44, s44, s90
    s_cmp_eq_u32 s44, 5
    s_waitcnt lgkmcnt(8)
    v_mfma_f32_16x16x32_bf16 v[168:171], v[112:115], a[224:227], v[168:171]
    ds_read_b64_tr_b16 v[132:133], v16 offset:5248
    s_cselect_b32 s44, 0, s44
    s_cselect_b32 s90, 160, 0
    v_mfma_f32_16x16x32_bf16 v[172:175], v[112:115], v[80:83], v[172:175]
    ds_read_b64_tr_b16 v[134:135], v16 offset:6528
    s_add_u32 s43, s43, s90
    s_cmp_eq_u32 s43, 1280
    s_waitcnt lgkmcnt(8)
    v_mfma_f32_16x16x32_bf16 v[136:139], v[116:119], a[228:231], v[136:139]
    ds_read_b64_tr_b16 v[96:97], v16 offset:10240
    s_cselect_b32 s43, 0, s43
    s_add_u32 m0, m0, 1024
    v_mfma_f32_16x16x32_bf16 v[140:143], v[116:119], v[84:87], v[140:143]
    ds_read_b64_tr_b16 v[98:99], v16 offset:11520
    buffer_load_dwordx4 v11, s[20:23], s91 offen lds
    s_add_u32 m0, m0, 1024
    s_waitcnt lgkmcnt(8)
    v_mfma_f32_16x16x32_bf16 v[144:147], v[120:123], a[228:231], v[144:147]
    ds_read_b64_tr_b16 v[100:101], v16 offset:10272
    v_mfma_f32_16x16x32_bf16 v[148:151], v[120:123], v[84:87], v[148:151]
    ds_read_b64_tr_b16 v[102:103], v16 offset:11552
    s_waitcnt lgkmcnt(8)
    v_mfma_f32_16x16x32_bf16 v[152:155], v[124:127], a[228:231], v[152:155]
    ds_read_b64_tr_b16 v[104:105], v16 offset:10304
    v_mfma_f32_16x16x32_bf16 v[156:159], v[124:127], v[84:87], v[156:159]
    ds_read_b64_tr_b16 v[106:107], v16 offset:11584
    s_waitcnt lgkmcnt(8)
    v_mfma_f32_16x16x32_bf16 v[160:163], v[128:131], a[228:231], v[160:163]
    ds_read_b64_tr_b16 v[108:109], v16 offset:10336
    buffer_load_dwordx4 v12, s[20:23], s91 offen lds
    s_add_u32 m0, m0, 1024
    v_mfma_f32_16x16x32_bf16 v[164:167], v[128:131], v[84:87], v[164:167]
    ds_read_b64_tr_b16 v[110:111], v16 offset:11616
    s_waitcnt lgkmcnt(8)
    v_mfma_f32_16x16x32_bf16 v[168:171], v[132:135], a[228:231], v[168:171]
    ds_read_b64_tr_b16 v[112:113], v16 offset:10368
    v_mfma_f32_16x16x32_bf16 v[172:175], v[132:135], v[84:87], v[172:175]
    ds_read_b64_tr_b16 v[114:115], v16 offset:11648
    s_waitcnt lgkmcnt(8)
    v_mfma_f32_16x16x32_bf16 v[136:139], v[96:99], a[232:235], v[136:139]
    ds_read_b64_tr_b16 v[116:117], v16 offset:15360
    v_mfma_f32_16x16x32_bf16 v[140:143], v[96:99], v[88:91], v[140:143]
    ds_read_b64_tr_b16 v[118:119], v16 offset:16640
    buffer_load_dwordx4 v13, s[20:23], s91 offen lds
    s_add_u32 m0, m0, 1024
    s_waitcnt lgkmcnt(8)
    v_mfma_f32_16x16x32_bf16 v[144:147], v[100:103], a[232:235], v[144:147]
    ds_read_b64_tr_b16 v[120:121], v16 offset:15392
    v_mfma_f32_16x16x32_bf16 v[148:151], v[100:103], v[88:91], v[148:151]
    ds_read_b64_tr_b16 v[122:123], v16 offset:16672
    s_waitcnt lgkmcnt(8)
    v_mfma_f32_16x16x32_bf16 v[152:155], v[104:107], a[232:235], v[152:155]
    ds_read_b64_tr_b16 v[124:125], v16 offset:15424
    v_mfma_f32_16x16x32_bf16 v[156:159], v[104:107], v[88:91], v[156:159]
    ds_read_b64_tr_b16 v[126:127], v16 offset:16704
    s_waitcnt lgkmcnt(8)
    v_mfma_f32_16x16x32_bf16 v[160:163], v[108:111], a[232:235], v[160:163]
    ds_read_b64_tr_b16 v[128:129], v16 offset:15456
    buffer_load_dwordx4 v14, s[20:23], s91 offen lds
    v_mfma_f32_16x16x32_bf16 v[164:167], v[108:111], v[88:91], v[164:167]
    ds_read_b64_tr_b16 v[130:131], v16 offset:16736
    s_waitcnt lgkmcnt(8)
    v_mfma_f32_16x16x32_bf16 v[168:171], v[112:115], a[232:235], v[168:171]
    ds_read_b64_tr_b16 v[132:133], v16 offset:15488
    v_mfma_f32_16x16x32_bf16 v[172:175], v[112:115], v[88:91], v[172:175]
    ds_read_b64_tr_b16 v[134:135], v16 offset:16768
    s_waitcnt lgkmcnt(8)
    v_mfma_f32_16x16x32_bf16 v[136:139], v[116:119], a[236:239], v[136:139]
    v_mfma_f32_16x16x32_bf16 v[140:143], v[116:119], v[92:95], v[140:143]
    s_waitcnt lgkmcnt(6)
    v_mfma_f32_16x16x32_bf16 v[144:147], v[120:123], a[236:239], v[144:147]
    v_mfma_f32_16x16x32_bf16 v[148:151], v[120:123], v[92:95], v[148:151]
    v_add_u32 v16, s46, v15
    s_waitcnt vmcnt(10) lgkmcnt(0)
    s_barrier
    v_mfma_f32_16x16x32_bf16 v[152:155], v[124:127], a[236:239], v[152:155]
    ds_read_b64_tr_b16 v[96:97], v16 offset:0
    ds_read_b64_tr_b16 v[98:99], v16 offset:1280
    v_mfma_f32_16x16x32_bf16 v[156:159], v[124:127], v[92:95], v[156:159]
    ds_read_b64_tr_b16 v[100:101], v16 offset:32
    ds_read_b64_tr_b16 v[102:103], v16 offset:1312
    v_mfma_f32_16x16x32_bf16 v[160:163], v[128:131], a[236:239], v[160:163]
    ds_read_b64_tr_b16 v[104:105], v16 offset:64
    ds_read_b64_tr_b16 v[106:107], v16 offset:1344
    v_mfma_f32_16x16x32_bf16 v[164:167], v[128:131], v[92:95], v[164:167]
    ds_read_b64_tr_b16 v[108:109], v16 offset:96
    ds_read_b64_tr_b16 v[110:111], v16 offset:1376
    v_mfma_f32_16x16x32_bf16 v[168:171], v[132:135], a[236:239], v[168:171]
    ds_read_b64_tr_b16 v[112:113], v16 offset:128
    ds_read_b64_tr_b16 v[114:115], v16 offset:1408
    v_mfma_f32_16x16x32_bf16 v[172:175], v[132:135], v[92:95], v[172:175]
    v_cvt_pk_bf16_f32 v176, v136, v137
    v_cvt_pk_bf16_f32 v177, v138, v139
    v_cvt_pk_bf16_f32 v178, v140, v141
    v_cvt_pk_bf16_f32 v179, v142, v143
    s_nop 0
    v_permlane16_swap_b32 v176, v178
    v_permlane16_swap_b32 v177, v179
    buffer_store_dwordx4 v[176:179], v19, s[28:31], s42 offen offset:0
    s_nop 1
    v_cvt_pk_bf16_f32 v176, v144, v145
    v_cvt_pk_bf16_f32 v177, v146, v147
    v_cvt_pk_bf16_f32 v178, v148, v149
    v_cvt_pk_bf16_f32 v179, v150, v151
    s_nop 0
    v_permlane16_swap_b32 v176, v178
    v_permlane16_swap_b32 v177, v179
    buffer_store_dwordx4 v[176:179], v19, s[28:31], s42 offen offset:32
    s_nop 1
    v_cvt_pk_bf16_f32 v176, v152, v153
    v_cvt_pk_bf16_f32 v177, v154, v155
    v_cvt_pk_bf16_f32 v178, v156, v157
    v_cvt_pk_bf16_f32 v179, v158, v159
    s_nop 0
    v_permlane16_swap_b32 v176, v178
    v_permlane16_swap_b32 v177, v179
    buffer_store_dwordx4 v[176:179], v19, s[28:31], s42 offen offset:64
    s_nop 1
    v_cvt_pk_bf16_f32 v176, v160, v161
    v_cvt_pk_bf16_f32 v177, v162, v163
    v_cvt_pk_bf16_f32 v178, v164, v165
    v_cvt_pk_bf16_f32 v179, v166, v167
    s_nop 0
    v_permlane16_swap_b32 v176, v178
    v_permlane16_swap_b32 v177, v179
    buffer_store_dwordx4 v[176:179], v19, s[28:31], s42 offen offset:96
    s_nop 1
    v_cvt_pk_bf16_f32 v176, v168, v169
    v_cvt_pk_bf16_f32 v177, v170, v171
    v_cvt_pk_bf16_f32 v178, v172, v173
    v_cvt_pk_bf16_f32 v179, v174, v175
    s_nop 0
    v_permlane16_swap_b32 v176, v178
    v_permlane16_swap_b32 v177, v179
    buffer_store_dwordx4 v[176:179], v19, s[28:31], s42 offen offset:128
    s_add_u32 s42, s42, 160
    s_cmp_eq_u32 s42, 1280
    s_cselect_b32 s42, 0, s42
    s_add_u32 s53, s53, 1
    s_cmp_lt_u32 s53, 8
    s_cbranch_scc1 L_pa_oblk
L_pa_end:
    s_waitcnt vmcnt(0)
    s_endpgm
L_slow:
    s_waitcnt vmcnt(0) lgkmcnt(0)
    s_barrier
    s_and_b32 s34, s2, 7
    s_lshr_b32 s35, s2, 3
    s_add_u32 s4, s88, 33554432
    s_addc_u32 s5, s89, 0
    s_and_b32 s5, s5, 0xffff
    s_lshl_b32 s38, s34, 21
    s_add_u32 s38, s38, 8388608
    s_cmp_lt_u32 s35, 28
    s_cbranch_scc1 L_noini_66
    v_mov_b32 v240, -1
    v_mov_b32 v241, -1
    v_mov_b32 v242, -1
    v_mov_b32 v243, -1
    v_mov_b32 v244, 0
    v_lshlrev_b32 v4, 4, v0
    v_lshlrev_b32 v5, 2, v0
    s_sub_u32 s93, s35, 28
    s_lshl_b32 s93, s93, 2
    s_add_u32 s93, s93, s32
    s_lshl_b32 s91, s34, 4
    s_add_u32 s91, s91, s93
    s_lshl_b32 s41, s91, 8
    s_add_u32 s41, s41, 1933312
    s_mul_i32 s91, s91, 5120
    s_lshl_b32 s40, s93, 8
    s_add_u32 s40, s40, s38
    s_add_u32 s40, s40, 458752
    s_lshr_b32 s92, s93, 3
    s_mul_i32 s92, s92, 114688
    s_add_u32 s92, s92, s38
    s_and_b32 s93, s93, 7
    s_mul_i32 s93, s93, 5120
    s_add_u32 s92, s92, s93
    buffer_store_dwordx4 v[240:243], v4, s[4:7], s91 offen offset:0 sc1
    buffer_store_dwordx4 v[240:243], v4, s[4:7], s91 offen offset:1024 sc1
    buffer_store_dwordx4 v[240:243], v4, s[4:7], s91 offen offset:2048 sc1
    buffer_store_dwordx4 v[240:243], v4, s[4:7], s91 offen offset:3072 sc1
    s_add_u32 s91, s91, 4096
    buffer_store_dwordx4 v[240:243], v4, s[4:7], s91 offen offset:0 sc1
    buffer_store_dwordx4 v[240:243], v4, s[4:7], s92 offen offset:0 sc1
    buffer_store_dwordx4 v[240:243], v4, s[4:7], s92 offen offset:1024 sc1
    buffer_store_dwordx4 v[240:243], v4, s[4:7], s92 offen offset:2048 sc1
    buffer_store_dwordx4 v[240:243], v4, s[4:7], s92 offen offset:3072 sc1
    s_add_u32 s92, s92, 4096
    buffer_store_dwordx4 v[240:243], v4, s[4:7], s92 offen offset:0 sc1
    buffer_store_dword v244, v5, s[4:7], s40 offen sc1
    buffer_store_dword v244, v5, s[4:7], s41 offen sc1
    s_waitcnt vmcnt(0)
    s_barrier
    s_cmp_lg_u32 s32, 0
    s_cbranch_scc1 L_ini_67
    v_mov_b32 v1, 68
    v_mov_b32 v2, 1
    s_mov_b64 exec, 1
    buffer_atomic_add v2, v1, s[8:11], 0 offen sc0 sc1
    s_waitcnt vmcnt(0)
    v_readfirstlane_b32 s90, v2
    s_mov_b64 exec, -1
    s_cmp_lg_u32 s90, 31
    s_cbranch_scc1 L_ini_67
    v_mov_b32 v1, 196
    v_mov_b32 v2, 1
    s_mov_b64 exec, 1
    buffer_store_dword v2, v1, s[8:11], 0 offen sc1
    s_mov_b64 exec, -1
L_ini_67:
    s_barrier
    s_cmp_eq_u32 s35, 28
    s_cbranch_scc1 L_px_s
L_noini_66:
    s_nop 0
    s_cmp_lt_u32 s35, 12
    s_cbranch_scc1 L_qkv_s
    s_cmp_lt_u32 s35, 18
    s_cbranch_scc1 L_v_s
    s_cmp_lt_u32 s35, 28
    s_cbranch_scc1 L_wo_s
    s_cmp_lt_u32 s35, 29
    s_cbranch_scc1 L_px_s
    s_branch L_pa_s
L_qkv_s:
    s_mov_b32 s12, s74
    s_and_b32 s13, s75, 0xffff
    s_mov_b32 s14, 7864320
    s_mov_b32 s15, 0x20000
    s_mov_b32 s16, s76
    s_and_b32 s17, s77, 0xffff
    s_mov_b32 s18, 7864320
    s_mov_b32 s19, 0x20000
    s_mov_b32 s40, s35
    s_mov_b32 s24, s70
    s_and_b32 s25, s71, 0xffff
    s_mov_b32 s26, 2621440
    s_mov_b32 s27, 0x20000
    v_and_b32 v1, 15, v0
    v_lshrrev_b32 v2, 4, v0
    v_lshrrev_b32 v3, 3, v0
    v_and_b32 v4, 7, v0
    s_lshl_b32 s90, s32, 3
    v_add_u32 v5, s90, v3
    s_and_b32 s91, s32, 1
    s_lshl_b32 s91, s91, 2
    v_and_b32 v6, 2, v3
    v_or_b32 v6, s91, v6
    v_xor_b32 v6, v6, v4
    v_lshlrev_b32 v6, 4, v6
    v_mul_u32_u24 v7, 12288, v5
    s_mul_i32 s92, s34, 1536
    s_lshl_b32 s93, s40, 7
    s_add_u32 s92, s92, s93
    v_add3_u32 v124, v6, v7, s92
    v_lshrrev_b32 v6, 1, v3
    v_or_b32 v6, s91, v6
    v_xor_b32 v6, v6, v4
    v_lshlrev_b32 v6, 4, v6
    v_mul_u32_u24 v7, 1280, v5
    v_add_u32 v10, v6, v7
    s_lshl_b32 s90, s32, 10
    s_add_u32 m0, s90, 81920
    s_mov_b32 s91, 0
    buffer_load_dwordx4 v124, s[16:19], s91 offen nt lds
    s_add_u32 m0, m0, 4096
    s_add_u32 s91, s91, 393216
    buffer_load_dwordx4 v124, s[16:19], s91 offen nt lds
    s_add_u32 m0, m0, 4096
    s_add_u32 s91, s91, 393216
    buffer_load_dwordx4 v124, s[16:19], s91 offen nt lds
    s_add_u32 m0, m0, 4096
    s_add_u32 s91, s91, 393216
    buffer_load_dwordx4 v124, s[16:19], s91 offen nt lds
    s_add_u32 m0, m0, 4096
    s_add_u32 s91, s91, 393216
    buffer_load_dwordx4 v124, s[16:19], s91 offen nt lds
    s_add_u32 m0, m0, 4096
    s_add_u32 s91, s91, 393216
    buffer_load_dwordx4 v124, s[16:19], s91 offen nt lds
    s_add_u32 m0, m0, 4096
    s_add_u32 s91, s91, 393216
    buffer_load_dwordx4 v124, s[16:19], s91 offen nt lds
    s_add_u32 m0, m0, 4096
    s_add_u32 s91, s91, 393216
    buffer_load_dwordx4 v124, s[16:19], s91 offen nt lds
    s_add_u32 m0, m0, 4096
    s_add_u32 s91, s91, 393216
    buffer_load_dwordx4 v124, s[16:19], s91 offen nt lds
    s_add_u32 m0, m0, 4096
    s_add_u32 s91, s91, 393216
    buffer_load_dwordx4 v124, s[16:19], s91 offen nt lds
    s_mul_i32 s60, s40, 86
    s_lshr_b32 s60, s60, 8
    s_mul_i32 s61, s60, 3
    s_sub_u32 s61, s40, s61
    s_add_u32 s90, s40, 1
    s_mul_i32 s62, s90, 86
    s_lshr_b32 s62, s62, 8
    s_mul_i32 s63, s62, 3
    s_sub_u32 s63, s90, s63
    v_lshrrev_b32 v3, 1, v2
    v_and_b32 v5, 1, v2
    s_lshl_b32 s90, s32, 9
    v_lshlrev_b32 v6, 4, v1
    v_lshl_add_u32 v6, v3, 8, v6
    v_add_u32 v6, s90, v6
    s_mul_i32 s90, s60, 12288
    s_lshl_b32 s91, s61, 11
    s_add_u32 s90, s90, s91
    v_mul_u32_u24 v7, 6144, v5
    v_add3_u32 v19, v6, v7, s90
    v_mov_b32 v22, -1
    s_mov_b32 s56, 49152
    v_lshl_add_u32 v137, v5, 11, v6
    v_add_u32 v137, 135168, v137
    s_mul_i32 s90, s40, 1280
    s_add_u32 s90, s90, 10240
    v_lshlrev_b32 v6, 1, v5
    v_or_b32 v7, v6, v3
    v_lshl_add_u32 v7, v7, 4, v1
    v_lshlrev_b32 v7, 2, v7
    v_add_u32 v7, 1024, v7
    v_or_b32 v6, v6, v1
    v_lshl_add_u32 v6, v3, 4, v6
    v_lshlrev_b32 v6, 4, v6
    s_sub_u32 s91, s32, 1
    s_lshl_b32 s91, s91, 9
    v_add_u32 v6, s91, v6
    s_cmp_eq_u32 s32, 0
    s_cselect_b64 vcc, -1, 0
    v_cndmask_b32 v6, v6, v7, vcc
    v_add_u32 v135, s90, v6
    s_lshl_b32 s91, s32, 8
    s_add_u32 s91, s91, s90
    v_lshl_add_u32 v150, v0, 2, s91
    v_and_b32 v4, 2, v1
    v_cmp_eq_u32 vcc, 0, v4
    v_mov_b32 v9, 2146435072
    s_nop 0
    v_cndmask_b32 v135, v9, v135, vcc
    s_lshl_b32 s90, s40, 10
    v_lshrrev_b32 v3, 2, v1
    v_lshlrev_b32 v3, 1, v3
    v_and_b32 v6, 1, v1
    v_or_b32 v3, v3, v6
    v_lshl_add_u32 v3, v2, 3, v3
    v_lshl_add_u32 v136, v3, 4, s90
    v_cmp_ne_u32 vcc, 0, v4
    v_mov_b32 v9, 2146435072
    s_nop 0
    v_cndmask_b32 v136, v9, v136, vcc
    v_and_b32 v6, 9, v1
    v_lshl_or_b32 v6, v4, 1, v6
    v_and_b32 v7, 4, v1
    v_lshrrev_b32 v7, 1, v7
    v_or_b32 v6, v6, v7
    v_lshlrev_b32 v6, 4, v6
    v_lshl_add_u32 v6, v2, 8, v6
    s_cmp_eq_u32 s32, 2
    s_cselect_b32 s90, 2048, 0
    s_add_u32 s90, s90, 135168
    v_add_u32 v138, s90, v6
    s_lshl_b32 s90, s60, 7
    s_lshl_b32 s91, s61, 2
    s_add_u32 s91, s91, s90
    s_add_u32 s91, s91, 459264
    s_cmp_eq_u32 s32, 3
    s_cselect_b32 s91, s91, 2146435072
    s_cselect_b32 s55, -1, 0
    v_mov_b32 v139, s91
    v_cmp_eq_u32 vcc, 0, v0
    v_mov_b32 v9, 2146435072
    s_nop 0
    v_cndmask_b32 v139, v9, v139, vcc
    v_add_u32 v21, 3072, v139
    s_mul_i32 s90, s35, 32768
    s_lshl_b32 s91, s32, 11
    s_add_u32 s90, s90, s91
    s_lshl_b32 s92, s35, 10
    s_lshl_b32 s91, s32, 8
    s_add_u32 s92, s92, s91
    s_cmp_lt_u32 s35, 10
    s_cselect_b32 s90, s90, 2146435072
    s_cselect_b32 s92, s92, 2146435072
    s_lshl_b32 s91, s34, 8
    v_lshlrev_b32 v3, 4, v0
    v_xor_b32 v3, s91, v3
    v_add_u32 v142, s90, v3
    v_xor_b32 v3, 1024, v3
    v_add_u32 v143, s90, v3
    s_min_u32 s90, s35, 9
    s_lshl_b32 s90, s90, 7
    s_add_u32 s90, s90, 460800
    s_add_u32 s90, s90, s38
    v_and_b32 v3, 3, v0
    v_lshl_add_u32 v146, v3, 2, s90
    s_add_u32 s90, s38, 460416
    v_mov_b32 v146, s90
    v_lshl_add_u32 v149, v0, 2, s92
    v_lshlrev_b32 v3, 3, v1
    v_lshl_add_u32 v3, v2, 6, v3
    v_add_u32 v148, s92, v3
    v_cmp_gt_u32 vcc, 8, v1
    v_mov_b32 v9, 2146435072
    s_nop 0
    v_cndmask_b32 v148, v9, v148, vcc
    v_lshrrev_b32 v8, 1, v1
    v_and_b32 v7, 2, v8
    v_cmp_ne_u32 vcc, 0, v7
    v_mov_b32 v5, 0x3f80
    v_mov_b32 v6, 0x3f800000
    v_cndmask_b32 v5, v5, v6, vcc
    v_bfe_u32 v6, v8, 2, 1
    v_and_b32 v7, 1, v8
    v_lshl_or_b32 v6, v7, 1, v6
    v_cmp_eq_u32 vcc, 0, v6
    s_nop 1
    v_cndmask_b32 v196, 0, v5, vcc
    v_cmp_eq_u32 vcc, 1, v6
    s_nop 1
    v_cndmask_b32 v197, 0, v5, vcc
    v_cmp_eq_u32 vcc, 2, v6
    s_nop 1
    v_cndmask_b32 v198, 0, v5, vcc
    v_cmp_eq_u32 vcc, 3, v6
    s_nop 1
    v_cndmask_b32 v199, 0, v5, vcc
    s_mov_b32 s58, 0xaaaaaaaa
    s_mov_b32 s59, 0xaaaaaaaa
    v_lshrrev_b32 v3, 2, v1
    v_and_b32 v4, 3, v1
    v_and_b32 v5, 1, v2
    v_lshl_add_u32 v6, v2, 3, v3
    v_lshlrev_b32 v6, 7, v6
    v_and_b32 v7, 2, v3
    v_lshl_or_b32 v7, v5, 2, v7
    v_lshrrev_b32 v8, 1, v4
    s_lshl_b32 s90, s32, 1
    v_or_b32 v8, s90, v8
    v_xor_b32 v7, v7, v8
    v_lshl_add_u32 v6, v7, 4, v6
    v_and_b32 v7, 1, v4
    v_lshl_add_u32 v6, v7, 3, v6
    v_add_u32 v125, 81920, v6
    v_add_u32 v126, 40960, v6
    v_add_u32 v127, 122880, v6
    s_lshl_b32 s90, s32, 9
    s_add_u32 s90, s90, 133120
    v_xor_b32 v6, 0, v5
    v_lshl_add_u32 v6, v6, 2, v3
    v_lshl_add_u32 v6, v2, 3, v6
    v_lshlrev_b32 v6, 5, v6
    v_lshl_or_b32 v7, v5, 1, 0
    v_xor_b32 v7, v7, v4
    v_lshl_add_u32 v6, v7, 3, v6
    v_add_u32 v24, 133120, v6
    v_xor_b32 v6, 1, v5
    v_lshl_add_u32 v6, v6, 2, v3
    v_lshl_add_u32 v6, v2, 3, v6
    v_lshlrev_b32 v6, 5, v6
    v_lshl_or_b32 v7, v5, 1, 1
    v_xor_b32 v7, v7, v4
    v_lshl_add_u32 v6, v7, 3, v6
    v_add_u32 v134, 133120, v6
    v_lshrrev_b32 v6, 3, v1
    v_lshlrev_b32 v6, 2, v6
    v_xor_b32 v6, v6, v1
    v_lshlrev_b32 v6, 5, v6
    v_xor_b32 v7, v2, v3
    v_lshl_add_u32 v6, v7, 3, v6
    v_add_u32 v23, s90, v6
    v_and_b32 v7, 2, v1
    v_cmp_ne_u32 vcc, 0, v7
    v_mov_b32 v6, 0x4444
    v_mov_b32 v8, 0xeeee
    v_cndmask_b32 v17, v6, v8, vcc
    v_lshlrev_b32 v6, 4, v0
    v_add_u32 v16, 122880, v6
    s_mul_i32 s90, s32, 2560
    v_lshl_add_u32 v13, v0, 4, s90
    v_lshl_add_u32 v14, v0, 2, s90
    s_add_u32 s48, s90, 122880
    v_mul_u32_u24 v6, 40, v0
    v_add_u32 v15, s48, v6
    v_mul_u32_u24 v6, 164, v0
    v_min_u32 v6, 10236, v6
    v_add_u32 v25, 122880, v6
    v_lshrrev_b32 v6, 3, v1
    v_lshlrev_b32 v6, 10, v6
    v_and_b32 v7, 7, v1
    v_lshl_add_u32 v6, v7, 7, v6
    v_lshrrev_b32 v7, 1, v1
    v_xor_b32 v7, v7, v2
    v_lshl_add_u32 v11, v7, 4, v6
    v_xor_b32 v12, 64, v11
    s_and_b32 s91, s34, 1
    s_lshl_b32 s91, s91, 12
    s_lshr_b32 s92, s34, 2
    s_lshl_b32 s92, s92, 13
    s_add_u32 s91, s91, s92
    s_and_b32 s92, s34, 2
    s_lshl_b32 s92, s92, 13
    s_add_u32 s91, s91, s92
    s_add_u32 s91, s91, 1933312
    v_lshrrev_b32 v4, 2, v0
    v_lshl_add_u32 v3, v4, 9, s91
    v_cmp_ne_u32 s[92:93], s34, v4
    v_cmp_gt_u32 vcc, 32, v0
    s_nop 0
    s_and_b64 vcc, vcc, s[92:93]
    s_and_b32 vcc_lo, vcc_lo, s55
    v_cndmask_b32 v146, v146, v3, vcc
    v_cndmask_b32 v152, 0, -1, vcc
    s_lshl_b32 s90, s32, 10
    s_add_u32 m0, s90, 40960
    s_mov_b32 s91, 0
    buffer_load_dwordx4 v124, s[12:15], s91 offen nt lds
    s_add_u32 m0, m0, 4096
    s_add_u32 s91, s91, 393216
    buffer_load_dwordx4 v124, s[12:15], s91 offen nt lds
    s_add_u32 m0, m0, 4096
    s_add_u32 s91, s91, 393216
    buffer_load_dwordx4 v124, s[12:15], s91 offen nt lds
    s_add_u32 m0, m0, 4096
    s_add_u32 s91, s91, 393216
    buffer_load_dwordx4 v124, s[12:15], s91 offen nt lds
    s_add_u32 m0, m0, 4096
    s_add_u32 s91, s91, 393216
    buffer_load_dwordx4 v124, s[12:15], s91 offen nt lds
    s_add_u32 m0, m0, 4096
    s_add_u32 s91, s91, 393216
    buffer_load_dwordx4 v124, s[12:15], s91 offen nt lds
    s_add_u32 m0, m0, 4096
    s_add_u32 s91, s91, 393216
    buffer_load_dwordx4 v124, s[12:15], s91 offen nt lds
    s_add_u32 m0, m0, 4096
    s_add_u32 s91, s91, 393216
    buffer_load_dwordx4 v124, s[12:15], s91 offen nt lds
    s_add_u32 m0, m0, 4096
    s_add_u32 s91, s91, 393216
    buffer_load_dwordx4 v124, s[12:15], s91 offen nt lds
    s_add_u32 m0, m0, 4096
    s_add_u32 s91, s91, 393216
    buffer_load_dwordx4 v124, s[12:15], s91 offen nt lds
    s_lshl_b32 s90, s32, 10
    s_add_u32 m0, s90, 122880
    s_mov_b32 s91, 3932160
    buffer_load_dwordx4 v124, s[16:19], s91 offen nt lds
    s_add_u32 m0, m0, 4096
    s_add_u32 s91, s91, 393216
    buffer_load_dwordx4 v124, s[16:19], s91 offen nt lds
    s_add_u32 m0, m0, 4096
    s_add_u32 s91, s91, 393216
    buffer_load_dwordx4 v124, s[16:19], s91 offen nt lds
    s_add_u32 m0, m0, 4096
    s_add_u32 s91, s91, 393216
    buffer_load_dwordx4 v124, s[16:19], s91 offen nt lds
    s_add_u32 m0, m0, 4096
    s_add_u32 s91, s91, 393216
    buffer_load_dwordx4 v124, s[16:19], s91 offen nt lds
    s_add_u32 m0, m0, 4096
    s_add_u32 s91, s91, 393216
    buffer_load_dwordx4 v124, s[16:19], s91 offen nt lds
    s_add_u32 m0, m0, 4096
    s_add_u32 s91, s91, 393216
    buffer_load_dwordx4 v124, s[16:19], s91 offen nt lds
    s_add_u32 m0, m0, 4096
    s_add_u32 s91, s91, 393216
    buffer_load_dwordx4 v124, s[16:19], s91 offen nt lds
    s_add_u32 m0, m0, 4096
    s_add_u32 s91, s91, 393216
    buffer_load_dwordx4 v124, s[16:19], s91 offen nt lds
    s_add_u32 m0, m0, 4096
    s_add_u32 s91, s91, 393216
    buffer_load_dwordx4 v124, s[16:19], s91 offen nt lds
    s_mov_b32 s46, 0
    s_lshl_b32 s90, s32, 10
    s_add_u32 m0, s90, 0
    s_nop 0
    buffer_load_dwordx4 v10, s[24:27], s46 offen offset:0 nt lds
    s_add_u32 m0, m0, 3968
    s_nop 0
    buffer_load_dwordx4 v10, s[24:27], s46 offen offset:128 nt lds
    s_add_u32 m0, m0, 3968
    s_nop 0
    buffer_load_dwordx4 v10, s[24:27], s46 offen offset:256 nt lds
    s_add_u32 m0, m0, 3968
    s_nop 0
    buffer_load_dwordx4 v10, s[24:27], s46 offen offset:384 nt lds
    s_add_u32 m0, m0, 3968
    s_nop 0
    buffer_load_dwordx4 v10, s[24:27], s46 offen offset:512 nt lds
    s_add_u32 m0, m0, 3968
    s_nop 0
    buffer_load_dwordx4 v10, s[24:27], s46 offen offset:640 nt lds
    s_add_u32 m0, m0, 3968
    s_nop 0
    buffer_load_dwordx4 v10, s[24:27], s46 offen offset:768 nt lds
    s_add_u32 m0, m0, 3968
    s_nop 0
    buffer_load_dwordx4 v10, s[24:27], s46 offen offset:896 nt lds
    s_add_u32 m0, m0, 3968
    s_nop 0
    buffer_load_dwordx4 v10, s[24:27], s46 offen offset:1024 nt lds
    s_add_u32 m0, m0, 3968
    s_nop 0
    buffer_load_dwordx4 v10, s[24:27], s46 offen offset:1152 nt lds
    s_waitcnt vmcnt(30)
    s_barrier
    ds_read_b64_tr_b16 a[80:81], v125 offset:0
    ds_read_b64_tr_b16 a[82:83], v125 offset:512
    ds_read_b64_tr_b16 a[84:85], v125 offset:4096
    ds_read_b64_tr_b16 a[86:87], v125 offset:4608
    ds_read_b64_tr_b16 a[88:89], v125 offset:8192
    ds_read_b64_tr_b16 a[90:91], v125 offset:8704
    ds_read_b64_tr_b16 a[92:93], v125 offset:12288
    ds_read_b64_tr_b16 a[94:95], v125 offset:12800
    ds_read_b64_tr_b16 a[96:97], v125 offset:16384
    ds_read_b64_tr_b16 a[98:99], v125 offset:16896
    ds_read_b64_tr_b16 a[100:101], v125 offset:20480
    ds_read_b64_tr_b16 a[102:103], v125 offset:20992
    ds_read_b64_tr_b16 a[104:105], v125 offset:24576
    ds_read_b64_tr_b16 a[106:107], v125 offset:25088
    ds_read_b64_tr_b16 a[108:109], v125 offset:28672
    ds_read_b64_tr_b16 a[110:111], v125 offset:29184
    ds_read_b64_tr_b16 a[112:113], v125 offset:32768
    ds_read_b64_tr_b16 a[114:115], v125 offset:33280
    ds_read_b64_tr_b16 a[116:117], v125 offset:36864
    ds_read_b64_tr_b16 a[118:119], v125 offset:37376
    s_waitcnt lgkmcnt(0)
    s_barrier
    s_lshl_b32 s90, s32, 10
    s_add_u32 m0, s90, 81920
    s_mov_b32 s91, 3932160
    buffer_load_dwordx4 v124, s[12:15], s91 offen nt lds
    s_add_u32 m0, m0, 4096
    s_add_u32 s91, s91, 393216
    buffer_load_dwordx4 v124, s[12:15], s91 offen nt lds
    s_add_u32 m0, m0, 4096
    s_add_u32 s91, s91, 393216
    buffer_load_dwordx4 v124, s[12:15], s91 offen nt lds
    s_add_u32 m0, m0, 4096
    s_add_u32 s91, s91, 393216
    buffer_load_dwordx4 v124, s[12:15], s91 offen nt lds
    s_add_u32 m0, m0, 4096
    s_add_u32 s91, s91, 393216
    buffer_load_dwordx4 v124, s[12:15], s91 offen nt lds
    s_add_u32 m0, m0, 4096
    s_add_u32 s91, s91, 393216
    buffer_load_dwordx4 v124, s[12:15], s91 offen nt lds
    s_add_u32 m0, m0, 4096
    s_add_u32 s91, s91, 393216
    buffer_load_dwordx4 v124, s[12:15], s91 offen nt lds
    s_add_u32 m0, m0, 4096
    s_add_u32 s91, s91, 393216
    buffer_load_dwordx4 v124, s[12:15], s91 offen nt lds
    s_add_u32 m0, m0, 4096
    s_add_u32 s91, s91, 393216
    buffer_load_dwordx4 v124, s[12:15], s91 offen nt lds
    s_add_u32 m0, m0, 4096
    s_add_u32 s91, s91, 393216
    buffer_load_dwordx4 v124, s[12:15], s91 offen nt lds
    s_waitcnt vmcnt(30)
    s_barrier
    ds_read_b64_tr_b16 a[0:1], v126 offset:0
    ds_read_b64_tr_b16 a[2:3], v126 offset:512
    ds_read_b64_tr_b16 a[4:5], v126 offset:4096
    ds_read_b64_tr_b16 a[6:7], v126 offset:4608
    ds_read_b64_tr_b16 a[8:9], v126 offset:8192
    ds_read_b64_tr_b16 a[10:11], v126 offset:8704
    ds_read_b64_tr_b16 a[12:13], v126 offset:12288
    ds_read_b64_tr_b16 a[14:15], v126 offset:12800
    ds_read_b64_tr_b16 a[16:17], v126 offset:16384
    ds_read_b64_tr_b16 a[18:19], v126 offset:16896
    ds_read_b64_tr_b16 a[20:21], v126 offset:20480
    ds_read_b64_tr_b16 a[22:23], v126 offset:20992
    ds_read_b64_tr_b16 a[24:25], v126 offset:24576
    ds_read_b64_tr_b16 a[26:27], v126 offset:25088
    ds_read_b64_tr_b16 a[28:29], v126 offset:28672
    ds_read_b64_tr_b16 a[30:31], v126 offset:29184
    ds_read_b64_tr_b16 a[32:33], v126 offset:32768
    ds_read_b64_tr_b16 a[34:35], v126 offset:33280
    ds_read_b64_tr_b16 a[36:37], v126 offset:36864
    ds_read_b64_tr_b16 a[38:39], v126 offset:37376
    s_waitcnt lgkmcnt(0)
    s_barrier
    s_mov_b32 s46, 40960
    s_lshl_b32 s90, s32, 10
    s_add_u32 m0, s90, 40960
    s_nop 0
    buffer_load_dwordx4 v10, s[24:27], s46 offen offset:0 nt lds
    s_add_u32 m0, m0, 3968
    s_nop 0
    buffer_load_dwordx4 v10, s[24:27], s46 offen offset:128 nt lds
    s_add_u32 m0, m0, 3968
    s_nop 0
    buffer_load_dwordx4 v10, s[24:27], s46 offen offset:256 nt lds
    s_add_u32 m0, m0, 3968
    s_nop 0
    buffer_load_dwordx4 v10, s[24:27], s46 offen offset:384 nt lds
    s_add_u32 m0, m0, 3968
    s_nop 0
    buffer_load_dwordx4 v10, s[24:27], s46 offen offset:512 nt lds
    s_add_u32 m0, m0, 3968
    s_nop 0
    buffer_load_dwordx4 v10, s[24:27], s46 offen offset:640 nt lds
    s_add_u32 m0, m0, 3968
    s_nop 0
    buffer_load_dwordx4 v10, s[24:27], s46 offen offset:768 nt lds
    s_add_u32 m0, m0, 3968
    s_nop 0
    buffer_load_dwordx4 v10, s[24:27], s46 offen offset:896 nt lds
    s_add_u32 m0, m0, 3968
    s_nop 0
    buffer_load_dwordx4 v10, s[24:27], s46 offen offset:1024 nt lds
    s_add_u32 m0, m0, 3968
    s_nop 0
    buffer_load_dwordx4 v10, s[24:27], s46 offen offset:1152 nt lds
    s_waitcnt vmcnt(30)
    s_barrier
    ds_read_b64_tr_b16 a[120:121], v127 offset:0
    ds_read_b64_tr_b16 a[122:123], v127 offset:512
    ds_read_b64_tr_b16 a[124:125], v127 offset:4096
    ds_read_b64_tr_b16 a[126:127], v127 offset:4608
    ds_read_b64_tr_b16 a[128:129], v127 offset:8192
    ds_read_b64_tr_b16 a[130:131], v127 offset:8704
    ds_read_b64_tr_b16 a[132:133], v127 offset:12288
    ds_read_b64_tr_b16 a[134:135], v127 offset:12800
    ds_read_b64_tr_b16 a[136:137], v127 offset:16384
    ds_read_b64_tr_b16 a[138:139], v127 offset:16896
    ds_read_b64_tr_b16 a[140:141], v127 offset:20480
    ds_read_b64_tr_b16 a[142:143], v127 offset:20992
    ds_read_b64_tr_b16 a[144:145], v127 offset:24576
    ds_read_b64_tr_b16 a[146:147], v127 offset:25088
    ds_read_b64_tr_b16 a[148:149], v127 offset:28672
    ds_read_b64_tr_b16 a[150:151], v127 offset:29184
    ds_read_b64_tr_b16 a[152:153], v127 offset:32768
    ds_read_b64_tr_b16 a[154:155], v127 offset:33280
    ds_read_b64_tr_b16 a[156:157], v127 offset:36864
    ds_read_b64_tr_b16 a[158:159], v127 offset:37376
    s_waitcnt lgkmcnt(0)
    s_waitcnt vmcnt(10)
    s_barrier
    ds_read_b64_tr_b16 a[40:41], v125 offset:0
    ds_read_b64_tr_b16 a[42:43], v125 offset:512
    ds_read_b64_tr_b16 a[44:45], v125 offset:4096
    ds_read_b64_tr_b16 a[46:47], v125 offset:4608
    ds_read_b64_tr_b16 a[48:49], v125 offset:8192
    ds_read_b64_tr_b16 a[50:51], v125 offset:8704
    ds_read_b64_tr_b16 a[52:53], v125 offset:12288
    ds_read_b64_tr_b16 a[54:55], v125 offset:12800
    ds_read_b64_tr_b16 a[56:57], v125 offset:16384
    ds_read_b64_tr_b16 a[58:59], v125 offset:16896
    ds_read_b64_tr_b16 a[60:61], v125 offset:20480
    ds_read_b64_tr_b16 a[62:63], v125 offset:20992
    ds_read_b64_tr_b16 a[64:65], v125 offset:24576
    ds_read_b64_tr_b16 a[66:67], v125 offset:25088
    ds_read_b64_tr_b16 a[68:69], v125 offset:28672
    ds_read_b64_tr_b16 a[70:71], v125 offset:29184
    ds_read_b64_tr_b16 a[72:73], v125 offset:32768
    ds_read_b64_tr_b16 a[74:75], v125 offset:33280
    ds_read_b64_tr_b16 a[76:77], v125 offset:36864
    ds_read_b64_tr_b16 a[78:79], v125 offset:37376
    s_waitcnt lgkmcnt(0)
    s_mov_b32 s49, 40960
    s_mov_b32 s47, 40960
    s_mov_b32 s37, -1
    s_add_u32 s44, s38, 475136
    s_add_u32 s45, s44, s56
    s_mov_b32 s46, 40960
    v_add_u32 v140, 0, v137
    v_mov_b32 v1, 196
    buffer_load_dword v2, v1, s[8:11], 0 offen sc1
    ds_read_b128 v[84:87], v11 offset:0
    ds_read_b128 v[88:91], v11 offset:2048
    ds_read_b128 v[92:95], v12 offset:0
    ds_read_b128 v[96:99], v12 offset:2048
    s_waitcnt lgkmcnt(2)
    v_mfma_f32_16x16x32_bf16 v[108:111], a[0:3], v[84:87], 0
    ds_read_b128 v[100:103], v11 offset:4096
    v_mfma_f32_16x16x32_bf16 v[112:115], a[0:3], v[88:91], 0
    ds_read_b128 v[104:107], v11 offset:6144
    v_mfma_f32_16x16x32_bf16 v[116:119], a[80:83], v[84:87], 0
    v_mfma_f32_16x16x32_bf16 v[120:123], a[80:83], v[88:91], 0
    s_waitcnt lgkmcnt(2)
    v_mfma_f32_16x16x32_bf16 v[108:111], a[4:7], v[92:95], v[108:111]
    ds_read_b128 v[84:87], v12 offset:4096
    v_mfma_f32_16x16x32_bf16 v[112:115], a[4:7], v[96:99], v[112:115]
    ds_read_b128 v[88:91], v12 offset:6144
    v_mfma_f32_16x16x32_bf16 v[116:119], a[84:87], v[92:95], v[116:119]
    v_mfma_f32_16x16x32_bf16 v[120:123], a[84:87], v[96:99], v[120:123]
    s_waitcnt lgkmcnt(2)
    v_mfma_f32_16x16x32_bf16 v[108:111], a[8:11], v[100:103], v[108:111]
    ds_read_b128 v[92:95], v11 offset:8192
    v_mfma_f32_16x16x32_bf16 v[112:115], a[8:11], v[104:107], v[112:115]
    ds_read_b128 v[96:99], v11 offset:10240
    v_mfma_f32_16x16x32_bf16 v[116:119], a[88:91], v[100:103], v[116:119]
    v_mfma_f32_16x16x32_bf16 v[120:123], a[88:91], v[104:107], v[120:123]
    s_waitcnt lgkmcnt(2)
    v_mfma_f32_16x16x32_bf16 v[108:111], a[12:15], v[84:87], v[108:111]
    ds_read_b128 v[100:103], v12 offset:8192
    v_mfma_f32_16x16x32_bf16 v[112:115], a[12:15], v[88:91], v[112:115]
    ds_read_b128 v[104:107], v12 offset:10240
    v_mfma_f32_16x16x32_bf16 v[116:119], a[92:95], v[84:87], v[116:119]
    v_mfma_f32_16x16x32_bf16 v[120:123], a[92:95], v[88:91], v[120:123]
    s_waitcnt lgkmcnt(2)
    v_mfma_f32_16x16x32_bf16 v[108:111], a[16:19], v[92:95], v[108:111]
    ds_read_b128 v[84:87], v11 offset:12288
    v_mfma_f32_16x16x32_bf16 v[112:115], a[16:19], v[96:99], v[112:115]
    ds_read_b128 v[88:91], v11 offset:14336
    v_mfma_f32_16x16x32_bf16 v[116:119], a[96:99], v[92:95], v[116:119]
    v_mfma_f32_16x16x32_bf16 v[120:123], a[96:99], v[96:99], v[120:123]
    s_waitcnt lgkmcnt(2)
    v_mfma_f32_16x16x32_bf16 v[108:111], a[20:23], v[100:103], v[108:111]
    ds_read_b128 v[92:95], v12 offset:12288
    v_mfma_f32_16x16x32_bf16 v[112:115], a[20:23], v[104:107], v[112:115]
    ds_read_b128 v[96:99], v12 offset:14336
    v_mfma_f32_16x16x32_bf16 v[116:119], a[100:103], v[100:103], v[116:119]
    v_mfma_f32_16x16x32_bf16 v[120:123], a[100:103], v[104:107], v[120:123]
    s_waitcnt lgkmcnt(2)
    v_mfma_f32_16x16x32_bf16 v[108:111], a[24:27], v[84:87], v[108:111]
    ds_read_b128 v[100:103], v11 offset:16384
    v_mfma_f32_16x16x32_bf16 v[112:115], a[24:27], v[88:91], v[112:115]
    ds_read_b128 v[104:107], v11 offset:18432
    v_mfma_f32_16x16x32_bf16 v[116:119], a[104:107], v[84:87], v[116:119]
    v_mfma_f32_16x16x32_bf16 v[120:123], a[104:107], v[88:91], v[120:123]
    s_waitcnt lgkmcnt(2)
    v_mfma_f32_16x16x32_bf16 v[108:111], a[28:31], v[92:95], v[108:111]
    ds_read_b128 v[84:87], v12 offset:16384
    v_mfma_f32_16x16x32_bf16 v[112:115], a[28:31], v[96:99], v[112:115]
    ds_read_b128 v[88:91], v12 offset:18432
    v_mfma_f32_16x16x32_bf16 v[116:119], a[108:111], v[92:95], v[116:119]
    v_mfma_f32_16x16x32_bf16 v[120:123], a[108:111], v[96:99], v[120:123]
    s_waitcnt lgkmcnt(2)
    v_mfma_f32_16x16x32_bf16 v[108:111], a[32:35], v[100:103], v[108:111]
    ds_read_b128 v[92:95], v11 offset:20480
    v_mfma_f32_16x16x32_bf16 v[112:115], a[32:35], v[104:107], v[112:115]
    ds_read_b128 v[96:99], v11 offset:22528
    v_mfma_f32_16x16x32_bf16 v[116:119], a[112:115], v[100:103], v[116:119]
    v_mfma_f32_16x16x32_bf16 v[120:123], a[112:115], v[104:107], v[120:123]
    s_waitcnt lgkmcnt(2)
    v_mfma_f32_16x16x32_bf16 v[108:111], a[36:39], v[84:87], v[108:111]
    ds_read_b128 v[100:103], v12 offset:20480
    v_mfma_f32_16x16x32_bf16 v[112:115], a[36:39], v[88:91], v[112:115]
    ds_read_b128 v[104:107], v12 offset:22528
    v_mfma_f32_16x16x32_bf16 v[116:119], a[116:119], v[84:87], v[116:119]
    v_mfma_f32_16x16x32_bf16 v[120:123], a[116:119], v[88:91], v[120:123]
    s_waitcnt lgkmcnt(2)
    v_mfma_f32_16x16x32_bf16 v[108:111], a[40:43], v[92:95], v[108:111]
    ds_read_b128 v[84:87], v11 offset:24576
    v_mfma_f32_16x16x32_bf16 v[112:115], a[40:43], v[96:99], v[112:115]
    ds_read_b128 v[88:91], v11 offset:26624
    v_mfma_f32_16x16x32_bf16 v[116:119], a[120:123], v[92:95], v[116:119]
    v_mfma_f32_16x16x32_bf16 v[120:123], a[120:123], v[96:99], v[120:123]
    s_waitcnt lgkmcnt(2)
    v_mfma_f32_16x16x32_bf16 v[108:111], a[44:47], v[100:103], v[108:111]
    ds_read_b128 v[92:95], v12 offset:24576
    v_mfma_f32_16x16x32_bf16 v[112:115], a[44:47], v[104:107], v[112:115]
    ds_read_b128 v[96:99], v12 offset:26624
    v_mfma_f32_16x16x32_bf16 v[116:119], a[124:127], v[100:103], v[116:119]
    v_mfma_f32_16x16x32_bf16 v[120:123], a[124:127], v[104:107], v[120:123]
    s_waitcnt lgkmcnt(2)
    v_mfma_f32_16x16x32_bf16 v[108:111], a[48:51], v[84:87], v[108:111]
    ds_read_b128 v[100:103], v11 offset:28672
    v_mfma_f32_16x16x32_bf16 v[112:115], a[48:51], v[88:91], v[112:115]
    ds_read_b128 v[104:107], v11 offset:30720
    v_mfma_f32_16x16x32_bf16 v[116:119], a[128:131], v[84:87], v[116:119]
    v_mfma_f32_16x16x32_bf16 v[120:123], a[128:131], v[88:91], v[120:123]
    s_waitcnt lgkmcnt(2)
    v_mfma_f32_16x16x32_bf16 v[108:111], a[52:55], v[92:95], v[108:111]
    ds_read_b128 v[84:87], v12 offset:28672
    v_mfma_f32_16x16x32_bf16 v[112:115], a[52:55], v[96:99], v[112:115]
    ds_read_b128 v[88:91], v12 offset:30720
    v_mfma_f32_16x16x32_bf16 v[116:119], a[132:135], v[92:95], v[116:119]
    v_mfma_f32_16x16x32_bf16 v[120:123], a[132:135], v[96:99], v[120:123]
    s_waitcnt lgkmcnt(2)
    v_mfma_f32_16x16x32_bf16 v[108:111], a[56:59], v[100:103], v[108:111]
    ds_read_b128 v[92:95], v11 offset:32768
    v_mfma_f32_16x16x32_bf16 v[112:115], a[56:59], v[104:107], v[112:115]
    ds_read_b128 v[96:99], v11 offset:34816
    v_mfma_f32_16x16x32_bf16 v[116:119], a[136:139], v[100:103], v[116:119]
    v_mfma_f32_16x16x32_bf16 v[120:123], a[136:139], v[104:107], v[120:123]
    s_waitcnt lgkmcnt(2)
    v_mfma_f32_16x16x32_bf16 v[108:111], a[60:63], v[84:87], v[108:111]
    ds_read_b128 v[100:103], v12 offset:32768
    v_mfma_f32_16x16x32_bf16 v[112:115], a[60:63], v[88:91], v[112:115]
    ds_read_b128 v[104:107], v12 offset:34816
    v_mfma_f32_16x16x32_bf16 v[116:119], a[140:143], v[84:87], v[116:119]
    v_mfma_f32_16x16x32_bf16 v[120:123], a[140:143], v[88:91], v[120:123]
    s_waitcnt lgkmcnt(2)
    v_mfma_f32_16x16x32_bf16 v[108:111], a[64:67], v[92:95], v[108:111]
    ds_read_b128 v[84:87], v11 offset:36864
    v_mfma_f32_16x16x32_bf16 v[112:115], a[64:67], v[96:99], v[112:115]
    ds_read_b128 v[88:91], v11 offset:38912
    v_mfma_f32_16x16x32_bf16 v[116:119], a[144:147], v[92:95], v[116:119]
    v_mfma_f32_16x16x32_bf16 v[120:123], a[144:147], v[96:99], v[120:123]
    s_waitcnt lgkmcnt(2)
    v_mfma_f32_16x16x32_bf16 v[108:111], a[68:71], v[100:103], v[108:111]
    ds_read_b128 v[92:95], v12 offset:36864
    v_mfma_f32_16x16x32_bf16 v[112:115], a[68:71], v[104:107], v[112:115]
    ds_read_b128 v[96:99], v12 offset:38912
    v_mfma_f32_16x16x32_bf16 v[116:119], a[148:151], v[100:103], v[116:119]
    v_mfma_f32_16x16x32_bf16 v[120:123], a[148:151], v[104:107], v[120:123]
    s_waitcnt lgkmcnt(0)
    v_mfma_f32_16x16x32_bf16 v[108:111], a[72:75], v[84:87], v[108:111]
    v_add_u32 v11, s49, v11
    v_mfma_f32_16x16x32_bf16 v[112:115], a[72:75], v[88:91], v[112:115]
    v_add_u32 v12, s49, v12
    v_mfma_f32_16x16x32_bf16 v[108:111], a[76:79], v[92:95], v[108:111]
    s_sub_u32 s47, s47, s49
    v_mfma_f32_16x16x32_bf16 v[112:115], a[76:79], v[96:99], v[112:115]
    s_sub_u32 s49, 0, s49
    v_mfma_f32_16x16x32_bf16 v[116:119], a[152:155], v[84:87], v[116:119]
    v_mfma_f32_16x16x32_bf16 v[120:123], a[152:155], v[88:91], v[120:123]
    v_mfma_f32_16x16x32_bf16 v[116:119], a[156:159], v[92:95], v[116:119]
    v_mfma_f32_16x16x32_bf16 v[120:123], a[156:159], v[96:99], v[120:123]
    v_cvt_pk_bf16_f32 v124, v108, v109
    v_cvt_pk_bf16_f32 v125, v110, v111
    v_cvt_pk_bf16_f32 v126, v112, v113
    v_cvt_pk_bf16_f32 v127, v114, v115
    s_nop 0
    v_permlane16_swap_b32 v124, v126
    v_permlane16_swap_b32 v125, v127
    v_cvt_pk_bf16_f32 v128, v116, v117
    v_cvt_pk_bf16_f32 v129, v118, v119
    v_cvt_pk_bf16_f32 v130, v120, v121
    v_cvt_pk_bf16_f32 v131, v122, v123
    s_nop 0
    v_permlane16_swap_b32 v128, v130
    v_permlane16_swap_b32 v129, v131
    ds_write_b128 v140, v[128:131]
    buffer_store_dwordx4 v[124:127], v19, s[4:7], s44 offen sc1
    buffer_store_dwordx4 v[128:131], v19, s[4:7], s45 offen sc1
    s_waitcnt vmcnt(2)
    s_branch L_gw_68c
L_gw_68:
    buffer_load_dword v2, v1, s[8:11], 0 offen sc1
    s_sub_u32 s36, s36, 1
    s_cbranch_scc1 L_exit
    s_waitcnt vmcnt(0)
L_gw_68c:
    v_readfirstlane_b32 s90, v2
    s_nop 0
    s_cmp_eq_u32 s90, 0
    s_cbranch_scc1 L_gw_68
    s_waitcnt vmcnt(2) lgkmcnt(0)
    s_barrier
    s_add_u32 s44, s38, 573440
    s_add_u32 s45, s44, s56
    s_mov_b32 s46, 81920
    v_add_u32 v140, 4096, v137
    ds_read_b128 v[84:87], v11 offset:0
    ds_read_b128 v[88:91], v11 offset:2048
    ds_read_b128 v[92:95], v12 offset:0
    ds_read_b128 v[96:99], v12 offset:2048
    s_lshl_b32 s90, s32, 10
    s_add_u32 m0, s90, s47
    s_waitcnt lgkmcnt(2)
    v_mfma_f32_16x16x32_bf16 v[108:111], a[0:3], v[84:87], 0
    ds_read_b128 v[100:103], v11 offset:4096
    s_and_b32 s50, s37, 3
    v_mfma_f32_16x16x32_bf16 v[112:115], a[0:3], v[88:91], 0
    ds_read_b128 v[104:107], v11 offset:6144
    s_mul_i32 s53, s50, 327680
    v_mfma_f32_16x16x32_bf16 v[116:119], a[80:83], v[84:87], 0
    buffer_load_dwordx4 v10, s[24:27], s46 offen offset:0 nt lds
    s_add_u32 m0, m0, 3968
    v_mfma_f32_16x16x32_bf16 v[120:123], a[80:83], v[88:91], 0
    s_waitcnt lgkmcnt(2)
    s_add_u32 s51, s37, 2
    v_mfma_f32_16x16x32_bf16 v[108:111], a[4:7], v[92:95], v[108:111]
    ds_read_b128 v[84:87], v12 offset:4096
    s_and_b32 s50, s51, 3
    v_mfma_f32_16x16x32_bf16 v[112:115], a[4:7], v[96:99], v[112:115]
    ds_read_b128 v[88:91], v12 offset:6144
    s_mul_i32 s50, s50, 98304
    v_mfma_f32_16x16x32_bf16 v[116:119], a[84:87], v[92:95], v[116:119]
    buffer_load_dwordx4 v10, s[24:27], s46 offen offset:128 nt lds
    s_add_u32 m0, m0, 3968
    v_mfma_f32_16x16x32_bf16 v[120:123], a[84:87], v[96:99], v[120:123]
    s_waitcnt lgkmcnt(2)
    s_add_u32 s50, s50, 475136
    v_mfma_f32_16x16x32_bf16 v[108:111], a[8:11], v[100:103], v[108:111]
    ds_read_b128 v[92:95], v11 offset:8192
    s_add_u32 s44, s38, s50
    v_mfma_f32_16x16x32_bf16 v[112:115], a[8:11], v[104:107], v[112:115]
    ds_read_b128 v[96:99], v11 offset:10240
    s_add_u32 s45, s44, s56
    v_mfma_f32_16x16x32_bf16 v[116:119], a[88:91], v[100:103], v[116:119]
    buffer_load_dwordx4 v10, s[24:27], s46 offen offset:256 nt lds
    s_add_u32 m0, m0, 3968
    v_mfma_f32_16x16x32_bf16 v[120:123], a[88:91], v[104:107], v[120:123]
    s_waitcnt lgkmcnt(2)
    s_and_b32 s50, s51, 3
    v_mfma_f32_16x16x32_bf16 v[108:111], a[12:15], v[84:87], v[108:111]
    ds_read_b128 v[100:103], v12 offset:8192
    s_lshl_b32 s50, s50, 12
    v_mfma_f32_16x16x32_bf16 v[112:115], a[12:15], v[88:91], v[112:115]
    ds_read_b128 v[104:107], v12 offset:10240
    v_add_u32 v140, s50, v137
    v_mfma_f32_16x16x32_bf16 v[116:119], a[92:95], v[84:87], v[116:119]
    buffer_load_dwordx4 v10, s[24:27], s46 offen offset:384 nt lds
    s_add_u32 m0, m0, 3968
    v_mfma_f32_16x16x32_bf16 v[120:123], a[92:95], v[88:91], v[120:123]
    s_waitcnt lgkmcnt(2)
    s_add_u32 s37, s37, 1
    v_mfma_f32_16x16x32_bf16 v[108:111], a[16:19], v[92:95], v[108:111]
    ds_read_b128 v[84:87], v11 offset:12288
    s_mov_b32 s52, 0
    v_mfma_f32_16x16x32_bf16 v[112:115], a[16:19], v[96:99], v[112:115]
    ds_read_b128 v[88:91], v11 offset:14336
    s_and_b32 s50, s37, 3
    v_mfma_f32_16x16x32_bf16 v[116:119], a[96:99], v[92:95], v[116:119]
    buffer_load_dwordx4 v10, s[24:27], s46 offen offset:512 nt lds
    s_add_u32 m0, m0, 3968
    v_mfma_f32_16x16x32_bf16 v[120:123], a[96:99], v[96:99], v[120:123]
    s_waitcnt lgkmcnt(2)
    s_mul_i32 s51, s50, 114688
    v_mfma_f32_16x16x32_bf16 v[108:111], a[20:23], v[100:103], v[108:111]
    ds_read_b128 v[92:95], v12 offset:12288
    s_add_u32 s41, s38, s51
    v_mfma_f32_16x16x32_bf16 v[112:115], a[20:23], v[104:107], v[112:115]
    ds_read_b128 v[96:99], v12 offset:14336
    s_and_b32 s54, s37, s55
    v_mfma_f32_16x16x32_bf16 v[116:119], a[100:103], v[100:103], v[116:119]
    buffer_load_dwordx4 v10, s[24:27], s46 offen offset:640 nt lds
    s_add_u32 m0, m0, 3968
    v_mfma_f32_16x16x32_bf16 v[120:123], a[100:103], v[104:107], v[120:123]
    s_waitcnt lgkmcnt(2)
    s_lshl_b32 s50, s50, 12
    v_mfma_f32_16x16x32_bf16 v[108:111], a[24:27], v[84:87], v[108:111]
    ds_read_b128 v[100:103], v11 offset:16384
    v_add_u32 v141, s50, v138
    v_mfma_f32_16x16x32_bf16 v[112:115], a[24:27], v[88:91], v[112:115]
    ds_read_b128 v[104:107], v11 offset:18432
    s_add_u32 s43, s41, 40960
    v_mfma_f32_16x16x32_bf16 v[116:119], a[104:107], v[84:87], v[116:119]
    buffer_load_dwordx4 v10, s[24:27], s46 offen offset:768 nt lds
    s_add_u32 m0, m0, 3968
    v_mfma_f32_16x16x32_bf16 v[120:123], a[104:107], v[88:91], v[120:123]
    s_waitcnt lgkmcnt(2)
    v_mfma_f32_16x16x32_bf16 v[108:111], a[28:31], v[92:95], v[108:111]
    ds_read_b128 v[84:87], v12 offset:16384
    v_mfma_f32_16x16x32_bf16 v[112:115], a[28:31], v[96:99], v[112:115]
    ds_read_b128 v[88:91], v12 offset:18432
    v_mfma_f32_16x16x32_bf16 v[116:119], a[108:111], v[92:95], v[116:119]
    buffer_load_dwordx4 v10, s[24:27], s46 offen offset:896 nt lds
    s_add_u32 m0, m0, 3968
    v_mfma_f32_16x16x32_bf16 v[120:123], a[108:111], v[96:99], v[120:123]
    s_waitcnt lgkmcnt(2)
    v_mfma_f32_16x16x32_bf16 v[108:111], a[32:35], v[100:103], v[108:111]
    ds_read_b128 v[92:95], v11 offset:20480
    v_mfma_f32_16x16x32_bf16 v[112:115], a[32:35], v[104:107], v[112:115]
    ds_read_b128 v[96:99], v11 offset:22528
    v_mfma_f32_16x16x32_bf16 v[116:119], a[112:115], v[100:103], v[116:119]
    buffer_load_dwordx4 v10, s[24:27], s46 offen offset:1024 nt lds
    s_add_u32 m0, m0, 3968
    v_mfma_f32_16x16x32_bf16 v[120:123], a[112:115], v[104:107], v[120:123]
    s_waitcnt lgkmcnt(2)
    v_mfma_f32_16x16x32_bf16 v[108:111], a[36:39], v[84:87], v[108:111]
    ds_read_b128 v[100:103], v12 offset:20480
    v_mfma_f32_16x16x32_bf16 v[112:115], a[36:39], v[88:91], v[112:115]
    ds_read_b128 v[104:107], v12 offset:22528
    v_mfma_f32_16x16x32_bf16 v[116:119], a[116:119], v[84:87], v[116:119]
    buffer_load_dwordx4 v10, s[24:27], s46 offen offset:1152 nt lds
    v_mfma_f32_16x16x32_bf16 v[120:123], a[116:119], v[88:91], v[120:123]
    s_waitcnt lgkmcnt(2)
    v_mfma_f32_16x16x32_bf16 v[108:111], a[40:43], v[92:95], v[108:111]
    ds_read_b128 v[84:87], v11 offset:24576
    v_mfma_f32_16x16x32_bf16 v[112:115], a[40:43], v[96:99], v[112:115]
    ds_read_b128 v[88:91], v11 offset:26624
    v_mfma_f32_16x16x32_bf16 v[116:119], a[120:123], v[92:95], v[116:119]
    v_mfma_f32_16x16x32_bf16 v[120:123], a[120:123], v[96:99], v[120:123]
    s_waitcnt lgkmcnt(2)
    v_mfma_f32_16x16x32_bf16 v[108:111], a[44:47], v[100:103], v[108:111]
    ds_read_b128 v[92:95], v12 offset:24576
    v_mfma_f32_16x16x32_bf16 v[112:115], a[44:47], v[104:107], v[112:115]
    ds_read_b128 v[96:99], v12 offset:26624
    v_mfma_f32_16x16x32_bf16 v[116:119], a[124:127], v[100:103], v[116:119]
    v_mfma_f32_16x16x32_bf16 v[120:123], a[124:127], v[104:107], v[120:123]
    s_waitcnt lgkmcnt(2)
    v_mfma_f32_16x16x32_bf16 v[108:111], a[48:51], v[84:87], v[108:111]
    ds_read_b128 v[100:103], v11 offset:28672
    v_mfma_f32_16x16x32_bf16 v[112:115], a[48:51], v[88:91], v[112:115]
    ds_read_b128 v[104:107], v11 offset:30720
    v_mfma_f32_16x16x32_bf16 v[116:119], a[128:131], v[84:87], v[116:119]
    v_mfma_f32_16x16x32_bf16 v[120:123], a[128:131], v[88:91], v[120:123]
    s_waitcnt lgkmcnt(2)
    v_mfma_f32_16x16x32_bf16 v[108:111], a[52:55], v[92:95], v[108:111]
    ds_read_b128 v[84:87], v12 offset:28672
    v_mfma_f32_16x16x32_bf16 v[112:115], a[52:55], v[96:99], v[112:115]
    ds_read_b128 v[88:91], v12 offset:30720
    v_mfma_f32_16x16x32_bf16 v[116:119], a[132:135], v[92:95], v[116:119]
    v_mfma_f32_16x16x32_bf16 v[120:123], a[132:135], v[96:99], v[120:123]
    s_waitcnt lgkmcnt(2)
    v_mfma_f32_16x16x32_bf16 v[108:111], a[56:59], v[100:103], v[108:111]
    ds_read_b128 v[92:95], v11 offset:32768
    v_mfma_f32_16x16x32_bf16 v[112:115], a[56:59], v[104:107], v[112:115]
    ds_read_b128 v[96:99], v11 offset:34816
    v_mfma_f32_16x16x32_bf16 v[116:119], a[136:139], v[100:103], v[116:119]
    v_mfma_f32_16x16x32_bf16 v[120:123], a[136:139], v[104:107], v[120:123]
    s_waitcnt lgkmcnt(2)
    v_mfma_f32_16x16x32_bf16 v[108:111], a[60:63], v[84:87], v[108:111]
    ds_read_b128 v[100:103], v12 offset:32768
    v_mfma_f32_16x16x32_bf16 v[112:115], a[60:63], v[88:91], v[112:115]
    ds_read_b128 v[104:107], v12 offset:34816
    v_mfma_f32_16x16x32_bf16 v[116:119], a[140:143], v[84:87], v[116:119]
    v_mfma_f32_16x16x32_bf16 v[120:123], a[140:143], v[88:91], v[120:123]
    s_waitcnt lgkmcnt(2)
    v_mfma_f32_16x16x32_bf16 v[108:111], a[64:67], v[92:95], v[108:111]
    ds_read_b128 v[84:87], v11 offset:36864
    v_mfma_f32_16x16x32_bf16 v[112:115], a[64:67], v[96:99], v[112:115]
    ds_read_b128 v[88:91], v11 offset:38912
    v_mfma_f32_16x16x32_bf16 v[116:119], a[144:147], v[92:95], v[116:119]
    v_mfma_f32_16x16x32_bf16 v[120:123], a[144:147], v[96:99], v[120:123]
    s_waitcnt lgkmcnt(2)
    v_mfma_f32_16x16x32_bf16 v[108:111], a[68:71], v[100:103], v[108:111]
    ds_read_b128 v[92:95], v12 offset:36864
    v_mfma_f32_16x16x32_bf16 v[112:115], a[68:71], v[104:107], v[112:115]
    ds_read_b128 v[96:99], v12 offset:38912
    v_mfma_f32_16x16x32_bf16 v[116:119], a[148:151], v[100:103], v[116:119]
    v_mfma_f32_16x16x32_bf16 v[120:123], a[148:151], v[104:107], v[120:123]
    s_waitcnt lgkmcnt(0)
    v_mfma_f32_16x16x32_bf16 v[108:111], a[72:75], v[84:87], v[108:111]
    v_add_u32 v11, s49, v11
    v_mfma_f32_16x16x32_bf16 v[112:115], a[72:75], v[88:91], v[112:115]
    v_add_u32 v12, s49, v12
    v_mfma_f32_16x16x32_bf16 v[108:111], a[76:79], v[92:95], v[108:111]
    s_sub_u32 s47, s47, s49
    v_mfma_f32_16x16x32_bf16 v[112:115], a[76:79], v[96:99], v[112:115]
    s_sub_u32 s49, 0, s49
    v_mfma_f32_16x16x32_bf16 v[116:119], a[152:155], v[84:87], v[116:119]
    v_mfma_f32_16x16x32_bf16 v[120:123], a[152:155], v[88:91], v[120:123]
    v_mfma_f32_16x16x32_bf16 v[116:119], a[156:159], v[92:95], v[116:119]
    v_mfma_f32_16x16x32_bf16 v[120:123], a[156:159], v[96:99], v[120:123]
    v_cvt_pk_bf16_f32 v124, v108, v109
    v_cvt_pk_bf16_f32 v125, v110, v111
    v_cvt_pk_bf16_f32 v126, v112, v113
    v_cvt_pk_bf16_f32 v127, v114, v115
    s_nop 0
    v_permlane16_swap_b32 v124, v126
    v_permlane16_swap_b32 v125, v127
    v_cvt_pk_bf16_f32 v128, v116, v117
    v_cvt_pk_bf16_f32 v129, v118, v119
    v_cvt_pk_bf16_f32 v130, v120, v121
    v_cvt_pk_bf16_f32 v131, v122, v123
    s_nop 0
    v_permlane16_swap_b32 v128, v130
    v_permlane16_swap_b32 v129, v131
    ds_write_b128 v140, v[128:131]
    buffer_store_dwordx4 v[124:127], v19, s[4:7], s44 offen sc1
    buffer_store_dwordx4 v[128:131], v19, s[4:7], s45 offen sc1
    s_mov_b32 m0, s48
L_qkv_loop_s:
    s_add_u32 s50, s37, 2
    s_and_b32 s50, s50, 3
    s_mul_i32 s50, s50, 114688
    s_add_u32 s42, s38, s50
    s_add_u32 s50, s37, 3
    s_min_u32 s50, s50, 63
    s_mul_i32 s46, s50, 40960
    s_add_u32 s51, s37, 1
    v_mov_b32 v20, s51
    s_mov_b32 m0, s48
    v_mov_b32 v68, 0
    v_mov_b32 v69, 0
    v_mov_b32 v70, 0
    v_mov_b32 v71, 0
    v_mov_b32 v72, 0
    v_mov_b32 v73, 0
    v_mov_b32 v74, 0
    v_mov_b32 v75, 0
    ds_read_b128 v[156:159], v141
    ds_read_b128 v[160:163], v141 offset:1024
    buffer_load_dwordx4 v13, s[4:7], s41 offen sc1 lds
    buffer_load_dwordx4 v13, s[4:7], s41 offen offset:1024 sc1 lds
    buffer_load_dword v14, s[4:7], s41 offen offset:2048 sc1 lds
    buffer_load_dword v14, s[4:7], s41 offen offset:2304 sc1 lds
    s_waitcnt vmcnt(0)
    ds_read_b32 v18, v15
    s_waitcnt lgkmcnt(0)
    v_cmp_eq_u32 vcc, -1, v18
    s_cbranch_vccnz L_poll_70c
L_poll_70x:
    s_barrier
    ds_read_b128 v[28:31], v16 offset:0
    ds_read_b128 v[32:35], v16 offset:1024
    ds_read_b128 v[36:39], v16 offset:2048
    ds_read_b128 v[40:43], v16 offset:3072
    s_waitcnt lgkmcnt(3)
    v_smfmac_f32_16x16x64_bf16 v[68:71], v[28:31], a[0:7], v17
    ds_read_b128 v[44:47], v16 offset:4096
    v_smfmac_f32_16x16x64_bf16 v[72:75], v[28:31], a[80:87], v17
    ds_read_b128 v[48:51], v16 offset:5120
    s_waitcnt lgkmcnt(4)
    v_smfmac_f32_16x16x64_bf16 v[68:71], v[32:35], a[8:15], v17
    ds_read_b128 v[52:55], v16 offset:6144
    v_smfmac_f32_16x16x64_bf16 v[72:75], v[32:35], a[88:95], v17
    ds_read_b128 v[56:59], v16 offset:7168
    s_waitcnt lgkmcnt(5)
    v_smfmac_f32_16x16x64_bf16 v[68:71], v[36:39], a[16:23], v17
    ds_read_b128 v[60:63], v16 offset:8192
    s_waitcnt lgkmcnt(5)
    v_smfmac_f32_16x16x64_bf16 v[68:71], v[40:43], a[24:31], v17
    ds_read_b128 v[64:67], v16 offset:9216
    s_waitcnt lgkmcnt(5)
    v_smfmac_f32_16x16x64_bf16 v[68:71], v[44:47], a[32:39], v17
    s_waitcnt lgkmcnt(4)
    v_smfmac_f32_16x16x64_bf16 v[68:71], v[48:51], a[40:47], v17
    s_waitcnt lgkmcnt(3)
    v_smfmac_f32_16x16x64_bf16 v[68:71], v[52:55], a[48:55], v17
    s_waitcnt lgkmcnt(2)
    v_smfmac_f32_16x16x64_bf16 v[68:71], v[56:59], a[56:63], v17
    s_waitcnt lgkmcnt(1)
    v_smfmac_f32_16x16x64_bf16 v[68:71], v[60:63], a[64:71], v17
    s_waitcnt lgkmcnt(0)
    v_smfmac_f32_16x16x64_bf16 v[68:71], v[64:67], a[72:79], v17
L_redo_69:
    v_smfmac_f32_16x16x64_bf16 v[72:75], v[36:39], a[96:103], v17
    v_smfmac_f32_16x16x64_bf16 v[72:75], v[40:43], a[104:111], v17
    buffer_store_dword v20, v21, s[4:7], s38 offen offset:0 sc1
    v_smfmac_f32_16x16x64_bf16 v[72:75], v[44:47], a[112:119], v17
    v_add_f32 v68, v68, v70
    v_add_f32 v69, v69, v71
    v_smfmac_f32_16x16x64_bf16 v[72:75], v[48:51], a[120:127], v17
    v_cvt_pk_bf16_f32 v132, v68, v69
    ds_write_b32 v23, v132
    v_smfmac_f32_16x16x64_bf16 v[72:75], v[52:55], a[128:135], v17
    v_cmp_u_f32 vcc, v68, v69
    v_smfmac_f32_16x16x64_bf16 v[72:75], v[56:59], a[136:143], v17
    v_smfmac_f32_16x16x64_bf16 v[72:75], v[60:63], a[144:151], v17
    s_cbranch_vccnz L_nan_71
L_cont_72:
    v_smfmac_f32_16x16x64_bf16 v[72:75], v[64:67], a[152:159], v17
    s_waitcnt lgkmcnt(0)
    s_barrier
    ds_read_b64_tr_b16 v[76:77], v24 offset:0
    ds_read_b64_tr_b16 v[78:79], v134 offset:0
    ds_read_b64_tr_b16 v[80:81], v24 offset:1024
    ds_read_b64_tr_b16 v[82:83], v134 offset:1024
    s_cmp_eq_u32 s32, 0
    s_cbranch_scc1 L_w0_73
    s_cmp_eq_u32 s32, 3
    s_cbranch_scc1 L_w3_74
    v_pk_add_f32 v[72:73], v[72:73], v[74:75]
    v_cvt_pk_bf16_f32 v133, v72, v73
    ds_write_b32 v23, v133 offset:4
    s_waitcnt lgkmcnt(3)
    v_mfma_f32_16x16x32_bf16 v[164:167], v[156:159], v[76:79], 0
    s_waitcnt lgkmcnt(1)
    v_mfma_f32_16x16x32_bf16 v[164:167], v[160:163], v[80:83], v[164:167]
    s_waitcnt lgkmcnt(0)
    s_barrier
    s_nop 5
    buffer_store_dwordx4 v[164:167], v135, s[4:7], s41 offen sc1
    ds_read_b128 v[84:87], v11 offset:0
    ds_read_b128 v[88:91], v11 offset:2048
    ds_read_b128 v[92:95], v12 offset:0
    ds_read_b128 v[96:99], v12 offset:2048
    s_branch L_join_75
L_w0_73:
    v_pk_add_f32 v[72:73], v[72:73], v[74:75]
    v_cvt_pk_bf16_f32 v133, v72, v73
    ds_write_b32 v23, v133 offset:4
    s_waitcnt lgkmcnt(0)
    s_barrier
    ds_read_b64_tr_b16 v[76:77], v24 offset:0
    ds_read_b64_tr_b16 v[78:79], v134 offset:0
    ds_read_b64_tr_b16 v[80:81], v24 offset:1024
    ds_read_b64_tr_b16 v[82:83], v134 offset:1024
    s_waitcnt lgkmcnt(2)
    v_mfma_f32_16x16x32_bf16 v[164:167], v[76:79], v[76:79], 0
    s_waitcnt lgkmcnt(0)
    v_mfma_f32_16x16x32_bf16 v[164:167], v[80:83], v[80:83], v[164:167]
    ds_read_b128 v[84:87], v11 offset:0
    ds_read_b128 v[88:91], v11 offset:2048
    ds_read_b128 v[92:95], v12 offset:0
    ds_read_b128 v[96:99], v12 offset:2048
    s_nop 3
    buffer_store_dword v166, v135, s[4:7], s41 offen sc1
    buffer_store_dword v167, v135, s[4:7], s41 offen offset:8 sc1
    s_branch L_join_75
L_w3_74:
    v_pk_add_f32 v[72:73], v[72:73], v[74:75]
    v_cvt_pk_bf16_f32 v133, v72, v73
    ds_write_b32 v23, v133 offset:4
    s_waitcnt lgkmcnt(0)
    s_barrier
    ds_read_b64_tr_b16 v[76:77], v24 offset:0
    ds_read_b64_tr_b16 v[78:79], v134 offset:0
    ds_read_b64_tr_b16 v[80:81], v24 offset:1024
    ds_read_b64_tr_b16 v[82:83], v134 offset:1024
    s_waitcnt lgkmcnt(0)
    ds_read_b128 v[84:87], v11 offset:0
    ds_read_b128 v[88:91], v11 offset:2048
    ds_read_b128 v[92:95], v12 offset:0
    ds_read_b128 v[96:99], v12 offset:2048
    s_waitcnt lgkmcnt(0)
    buffer_store_dwordx4 v[76:79], v136, s[4:7], s43 offen sc1
    buffer_store_dwordx4 v[80:83], v136, s[4:7], s43 offen offset:512 sc1
L_join_75:
    s_cmp_eq_u32 s37, 63
    s_cbranch_scc1 L_end_76
    s_cmp_eq_u32 s37, 0
    s_cbranch_scc1 L_sd_77c
L_sd_77:
    s_lshl_b32 s90, s32, 10
    s_add_u32 m0, s90, s47
    s_waitcnt lgkmcnt(2)
    v_mfma_f32_16x16x32_bf16 v[108:111], a[0:3], v[84:87], 0
    ds_read_b128 v[100:103], v11 offset:4096
    s_and_b32 s50, s37, 3
    v_mfma_f32_16x16x32_bf16 v[112:115], a[0:3], v[88:91], 0
    ds_read_b128 v[104:107], v11 offset:6144
    s_mul_i32 s53, s50, 327680
    v_mfma_f32_16x16x32_bf16 v[116:119], a[80:83], v[84:87], 0
    s_add_u32 s51, s37, 2
    s_and_b32 s50, s51, 3
    v_mfma_f32_16x16x32_bf16 v[120:123], a[80:83], v[88:91], 0
    s_waitcnt lgkmcnt(2)
    s_mul_i32 s50, s50, 98304
    v_mfma_f32_16x16x32_bf16 v[108:111], a[4:7], v[92:95], v[108:111]
    ds_read_b128 v[84:87], v12 offset:4096
    s_add_u32 s50, s50, 475136
    v_mfma_f32_16x16x32_bf16 v[112:115], a[4:7], v[96:99], v[112:115]
    ds_read_b128 v[88:91], v12 offset:6144
    s_add_u32 s44, s38, s50
    v_mfma_f32_16x16x32_bf16 v[116:119], a[84:87], v[92:95], v[116:119]
    s_add_u32 s45, s44, s56
    s_and_b32 s50, s51, 3
    v_mfma_f32_16x16x32_bf16 v[120:123], a[84:87], v[96:99], v[120:123]
    s_waitcnt lgkmcnt(2)
    s_lshl_b32 s50, s50, 12
    v_mfma_f32_16x16x32_bf16 v[108:111], a[8:11], v[100:103], v[108:111]
    ds_read_b128 v[92:95], v11 offset:8192
    v_add_u32 v140, s50, v137
    v_mfma_f32_16x16x32_bf16 v[112:115], a[8:11], v[104:107], v[112:115]
    ds_read_b128 v[96:99], v11 offset:10240
    s_add_u32 s37, s37, 1
    v_mfma_f32_16x16x32_bf16 v[116:119], a[88:91], v[100:103], v[116:119]
    s_mov_b32 s52, 0
    s_and_b32 s50, s37, 3
    v_mfma_f32_16x16x32_bf16 v[120:123], a[88:91], v[104:107], v[120:123]
    s_waitcnt lgkmcnt(2)
    s_mul_i32 s51, s50, 114688
    v_mfma_f32_16x16x32_bf16 v[108:111], a[12:15], v[84:87], v[108:111]
    ds_read_b128 v[100:103], v12 offset:8192
    s_add_u32 s41, s38, s51
    v_mfma_f32_16x16x32_bf16 v[112:115], a[12:15], v[88:91], v[112:115]
    ds_read_b128 v[104:107], v12 offset:10240
    s_and_b32 s54, s37, s55
    v_mfma_f32_16x16x32_bf16 v[116:119], a[92:95], v[84:87], v[116:119]
    buffer_store_dword v22, v150, s[4:7], s42 offen offset:0 sc1
    buffer_store_dword v22, v149, s[4:7], s42 offen offset:0 sc1
    v_mfma_f32_16x16x32_bf16 v[120:123], a[92:95], v[88:91], v[120:123]
    s_waitcnt lgkmcnt(2)
    s_lshl_b32 s50, s50, 12
    v_mfma_f32_16x16x32_bf16 v[108:111], a[16:19], v[92:95], v[108:111]
    ds_read_b128 v[84:87], v11 offset:12288
    v_add_u32 v141, s50, v138
    v_mfma_f32_16x16x32_bf16 v[112:115], a[16:19], v[96:99], v[112:115]
    ds_read_b128 v[88:91], v11 offset:14336
    s_add_u32 s43, s41, 40960
    v_mfma_f32_16x16x32_bf16 v[116:119], a[96:99], v[92:95], v[116:119]
    buffer_store_dword v22, v150, s[4:7], s42 offen offset:256 sc1
    v_mfma_f32_16x16x32_bf16 v[120:123], a[96:99], v[96:99], v[120:123]
    s_waitcnt lgkmcnt(2)
    v_mfma_f32_16x16x32_bf16 v[108:111], a[20:23], v[100:103], v[108:111]
    ds_read_b128 v[92:95], v12 offset:12288
    v_mfma_f32_16x16x32_bf16 v[112:115], a[20:23], v[104:107], v[112:115]
    ds_read_b128 v[96:99], v12 offset:14336
    v_mfma_f32_16x16x32_bf16 v[116:119], a[100:103], v[100:103], v[116:119]
    buffer_load_dwordx4 v10, s[24:27], s46 offen offset:0 nt lds
    s_add_u32 m0, m0, 3968
    v_mfma_f32_16x16x32_bf16 v[120:123], a[100:103], v[104:107], v[120:123]
    s_waitcnt lgkmcnt(2)
    v_mfma_f32_16x16x32_bf16 v[108:111], a[24:27], v[84:87], v[108:111]
    ds_read_b128 v[100:103], v11 offset:16384
    v_mfma_f32_16x16x32_bf16 v[112:115], a[24:27], v[88:91], v[112:115]
    ds_read_b128 v[104:107], v11 offset:18432
    v_mfma_f32_16x16x32_bf16 v[116:119], a[104:107], v[84:87], v[116:119]
    buffer_load_dwordx4 v10, s[24:27], s46 offen offset:128 nt lds
    s_add_u32 m0, m0, 3968
    v_mfma_f32_16x16x32_bf16 v[120:123], a[104:107], v[88:91], v[120:123]
    s_waitcnt lgkmcnt(2)
    v_mfma_f32_16x16x32_bf16 v[108:111], a[28:31], v[92:95], v[108:111]
    ds_read_b128 v[84:87], v12 offset:16384
    v_mfma_f32_16x16x32_bf16 v[112:115], a[28:31], v[96:99], v[112:115]
    ds_read_b128 v[88:91], v12 offset:18432
    v_mfma_f32_16x16x32_bf16 v[116:119], a[108:111], v[92:95], v[116:119]
    buffer_load_dwordx4 v10, s[24:27], s46 offen offset:256 nt lds
    s_add_u32 m0, m0, 3968
    v_mfma_f32_16x16x32_bf16 v[120:123], a[108:111], v[96:99], v[120:123]
    s_waitcnt lgkmcnt(2)
    v_mfma_f32_16x16x32_bf16 v[108:111], a[32:35], v[100:103], v[108:111]
    ds_read_b128 v[92:95], v11 offset:20480
    v_mfma_f32_16x16x32_bf16 v[112:115], a[32:35], v[104:107], v[112:115]
    ds_read_b128 v[96:99], v11 offset:22528
    v_mfma_f32_16x16x32_bf16 v[116:119], a[112:115], v[100:103], v[116:119]
    s_waitcnt vmcnt(6)
    buffer_store_dword v20, v139, s[4:7], s38 offen sc1
    v_mfma_f32_16x16x32_bf16 v[120:123], a[112:115], v[104:107], v[120:123]
    s_waitcnt lgkmcnt(2)
    v_mfma_f32_16x16x32_bf16 v[108:111], a[36:39], v[84:87], v[108:111]
    ds_read_b128 v[100:103], v12 offset:20480
    v_mfma_f32_16x16x32_bf16 v[112:115], a[36:39], v[88:91], v[112:115]
    buffer_load_dword v147, v146, s[4:7], 0 offen sc1
    ds_read_b128 v[104:107], v12 offset:22528
    v_mfma_f32_16x16x32_bf16 v[116:119], a[116:119], v[84:87], v[116:119]
    buffer_load_dwordx4 v10, s[24:27], s46 offen offset:384 nt lds
    s_add_u32 m0, m0, 3968
    v_mfma_f32_16x16x32_bf16 v[120:123], a[116:119], v[88:91], v[120:123]
    s_waitcnt lgkmcnt(2)
    v_mfma_f32_16x16x32_bf16 v[108:111], a[40:43], v[92:95], v[108:111]
    ds_read_b128 v[84:87], v11 offset:24576
    v_mfma_f32_16x16x32_bf16 v[112:115], a[40:43], v[96:99], v[112:115]
    buffer_load_dword v147, v146, s[4:7], 0 offen sc1
    ds_read_b128 v[88:91], v11 offset:26624
    v_mfma_f32_16x16x32_bf16 v[116:119], a[120:123], v[92:95], v[116:119]
    buffer_load_dwordx4 v10, s[24:27], s46 offen offset:512 nt lds
    s_add_u32 m0, m0, 3968
    v_mfma_f32_16x16x32_bf16 v[120:123], a[120:123], v[96:99], v[120:123]
    s_waitcnt lgkmcnt(2)
    v_mfma_f32_16x16x32_bf16 v[108:111], a[44:47], v[100:103], v[108:111]
    ds_read_b128 v[92:95], v12 offset:24576
    v_mfma_f32_16x16x32_bf16 v[112:115], a[44:47], v[104:107], v[112:115]
    buffer_load_dword v147, v146, s[4:7], 0 offen sc1
    ds_read_b128 v[96:99], v12 offset:26624
    v_mfma_f32_16x16x32_bf16 v[116:119], a[124:127], v[100:103], v[116:119]
    buffer_load_dwordx4 v10, s[24:27], s46 offen offset:640 nt lds
    s_add_u32 m0, m0, 3968
    v_mfma_f32_16x16x32_bf16 v[120:123], a[124:127], v[104:107], v[120:123]
    s_waitcnt lgkmcnt(2)
    v_mfma_f32_16x16x32_bf16 v[108:111], a[48:51], v[84:87], v[108:111]
    ds_read_b128 v[100:103], v11 offset:28672
    v_mfma_f32_16x16x32_bf16 v[112:115], a[48:51], v[88:91], v[112:115]
    buffer_load_dword v147, v146, s[4:7], 0 offen sc1
    ds_read_b128 v[104:107], v11 offset:30720
    v_mfma_f32_16x16x32_bf16 v[116:119], a[128:131], v[84:87], v[116:119]
    buffer_load_dwordx4 v10, s[24:27], s46 offen offset:768 nt lds
    s_add_u32 m0, m0, 3968
    v_mfma_f32_16x16x32_bf16 v[120:123], a[128:131], v[88:91], v[120:123]
    s_waitcnt lgkmcnt(2)
    v_mfma_f32_16x16x32_bf16 v[108:111], a[52:55], v[92:95], v[108:111]
    ds_read_b128 v[84:87], v12 offset:28672
    v_mfma_f32_16x16x32_bf16 v[112:115], a[52:55], v[96:99], v[112:115]
    buffer_load_dword v147, v146, s[4:7], 0 offen sc1
    ds_read_b128 v[88:91], v12 offset:30720
    v_mfma_f32_16x16x32_bf16 v[116:119], a[132:135], v[92:95], v[116:119]
    buffer_load_dwordx4 v10, s[24:27], s46 offen offset:896 nt lds
    s_add_u32 m0, m0, 3968
    v_mfma_f32_16x16x32_bf16 v[120:123], a[132:135], v[96:99], v[120:123]
    s_waitcnt lgkmcnt(2)
    v_mfma_f32_16x16x32_bf16 v[108:111], a[56:59], v[100:103], v[108:111]
    ds_read_b128 v[92:95], v11 offset:32768
    v_mfma_f32_16x16x32_bf16 v[112:115], a[56:59], v[104:107], v[112:115]
    buffer_load_dword v147, v146, s[4:7], 0 offen sc1
    ds_read_b128 v[96:99], v11 offset:34816
    v_mfma_f32_16x16x32_bf16 v[116:119], a[136:139], v[100:103], v[116:119]
    buffer_load_dwordx4 v10, s[24:27], s46 offen offset:1024 nt lds
    s_add_u32 m0, m0, 3968
    v_mfma_f32_16x16x32_bf16 v[120:123], a[136:139], v[104:107], v[120:123]
    s_waitcnt lgkmcnt(2)
    v_mfma_f32_16x16x32_bf16 v[108:111], a[60:63], v[84:87], v[108:111]
    ds_read_b128 v[100:103], v12 offset:32768
    v_mfma_f32_16x16x32_bf16 v[112:115], a[60:63], v[88:91], v[112:115]
    buffer_load_dword v147, v146, s[4:7], 0 offen sc1
    ds_read_b128 v[104:107], v12 offset:34816
    v_mfma_f32_16x16x32_bf16 v[116:119], a[140:143], v[84:87], v[116:119]
    buffer_load_dwordx4 v10, s[24:27], s46 offen offset:1152 nt lds
    v_mfma_f32_16x16x32_bf16 v[120:123], a[140:143], v[88:91], v[120:123]
    s_waitcnt lgkmcnt(2)
    v_mfma_f32_16x16x32_bf16 v[108:111], a[64:67], v[92:95], v[108:111]
    ds_read_b128 v[84:87], v11 offset:36864
    v_mfma_f32_16x16x32_bf16 v[112:115], a[64:67], v[96:99], v[112:115]
L_sp_78:
    buffer_load_dword v147, v146, s[4:7], 0 offen sc1
    s_sub_u32 s36, s36, 1
    s_cbranch_scc1 L_exit
    s_waitcnt vmcnt(7)
    v_cmp_gt_u32 vcc, s54, v147
    s_cbranch_vccnz L_sp_78
    s_barrier
    buffer_load_dwordx4 v[168:171], v142, s[4:7], s53 offen sc1
    ds_read_b128 v[88:91], v11 offset:38912
    v_mfma_f32_16x16x32_bf16 v[116:119], a[144:147], v[92:95], v[116:119]
    v_mfma_f32_16x16x32_bf16 v[120:123], a[144:147], v[96:99], v[120:123]
    s_waitcnt lgkmcnt(2)
    v_mfma_f32_16x16x32_bf16 v[108:111], a[68:71], v[100:103], v[108:111]
    ds_read_b128 v[92:95], v12 offset:36864
    v_mfma_f32_16x16x32_bf16 v[112:115], a[68:71], v[104:107], v[112:115]
    ds_read_b128 v[96:99], v12 offset:38912
    v_mfma_f32_16x16x32_bf16 v[116:119], a[148:151], v[100:103], v[116:119]
    v_mfma_f32_16x16x32_bf16 v[120:123], a[148:151], v[104:107], v[120:123]
    buffer_load_dwordx4 v[172:175], v143, s[4:7], s53 offen sc1
    s_waitcnt lgkmcnt(0)
    v_mfma_f32_16x16x32_bf16 v[108:111], a[72:75], v[84:87], v[108:111]
    v_add_u32 v11, s49, v11
    v_mfma_f32_16x16x32_bf16 v[112:115], a[72:75], v[88:91], v[112:115]
    v_add_u32 v12, s49, v12
    v_mfma_f32_16x16x32_bf16 v[108:111], a[76:79], v[92:95], v[108:111]
    s_sub_u32 s47, s47, s49
    v_mfma_f32_16x16x32_bf16 v[112:115], a[76:79], v[96:99], v[112:115]
    s_sub_u32 s49, 0, s49
    v_mfma_f32_16x16x32_bf16 v[116:119], a[152:155], v[84:87], v[116:119]
    v_mfma_f32_16x16x32_bf16 v[120:123], a[152:155], v[88:91], v[120:123]
    v_mfma_f32_16x16x32_bf16 v[116:119], a[156:159], v[92:95], v[116:119]
    v_mfma_f32_16x16x32_bf16 v[120:123], a[156:159], v[96:99], v[120:123]
    v_cvt_pk_bf16_f32 v124, v108, v109
    v_cvt_pk_bf16_f32 v125, v110, v111
    v_cvt_pk_bf16_f32 v126, v112, v113
    v_cvt_pk_bf16_f32 v127, v114, v115
    s_nop 0
    v_permlane16_swap_b32 v124, v126
    v_permlane16_swap_b32 v125, v127
    v_cvt_pk_bf16_f32 v128, v116, v117
    v_cvt_pk_bf16_f32 v129, v118, v119
    v_cvt_pk_bf16_f32 v130, v120, v121
    v_cvt_pk_bf16_f32 v131, v122, v123
    s_nop 0
    v_permlane16_swap_b32 v128, v130
    v_permlane16_swap_b32 v129, v131
    ds_write_b128 v140, v[128:131]
    buffer_store_dwordx4 v[124:127], v19, s[4:7], s44 offen sc1
    buffer_store_dwordx4 v[128:131], v19, s[4:7], s45 offen sc1
    s_mov_b32 m0, s48
    s_waitcnt vmcnt(3)
    v_mfma_f32_16x16x32_bf16 v[184:187], v[168:171], v[196:199], 0
    s_waitcnt vmcnt(2)
    v_mfma_f32_16x16x32_bf16 v[184:187], v[172:175], v[196:199], v[184:187]
    s_nop 7
    v_pk_add_f32 v[188:189], v[184:185], v[186:187]
    v_cmp_u_f32 vcc, v188, v189
    v_cvt_pk_bf16_f32 v192, v184, v185
    v_cvt_pk_bf16_f32 v193, v186, v187
    v_cndmask_b32 v192, v192, v193, s[58:59]
    s_cbranch_vccnz L_pp_79
L_pc_80:
    buffer_store_dword v192, v149, s[4:7], s41 offen sc1
    s_barrier
    s_branch L_qkv_loop_s
L_end_76:
    s_waitcnt vmcnt(0) lgkmcnt(0)
    buffer_store_dword v20, v139, s[4:7], s38 offen sc1
    s_endpgm
L_nan_71:
    s_cmp_eq_u32 s52, 1
    s_cbranch_scc1 L_cont_72
    v_lshlrev_b32 v1, 4, v0
L_nan_71r:
    s_mov_b32 s90, s41
    v_mov_b32 v2, 0
    buffer_load_dwordx4 v[28:31], v1, s[4:7], s90 offen sc1
    s_add_u32 s90, s90, 1024
    buffer_load_dwordx4 v[32:35], v1, s[4:7], s90 offen sc1
    s_add_u32 s90, s90, 1024
    buffer_load_dwordx4 v[36:39], v1, s[4:7], s90 offen sc1
    s_add_u32 s90, s90, 1024
    buffer_load_dwordx4 v[40:43], v1, s[4:7], s90 offen sc1
    s_add_u32 s90, s90, 1024
    buffer_load_dwordx4 v[44:47], v1, s[4:7], s90 offen sc1
    s_add_u32 s90, s90, 1024
    buffer_load_dwordx4 v[48:51], v1, s[4:7], s90 offen sc1
    s_add_u32 s90, s90, 1024
    buffer_load_dwordx4 v[52:55], v1, s[4:7], s90 offen sc1
    s_add_u32 s90, s90, 1024
    buffer_load_dwordx4 v[56:59], v1, s[4:7], s90 offen sc1
    s_add_u32 s90, s90, 1024
    buffer_load_dwordx4 v[60:63], v1, s[4:7], s90 offen sc1
    s_add_u32 s90, s90, 1024
    buffer_load_dwordx4 v[64:67], v1, s[4:7], s90 offen sc1
    s_add_u32 s90, s90, 1024
    s_sub_u32 s36, s36, 1
    s_cbranch_scc1 L_exit
    s_waitcnt vmcnt(0) lgkmcnt(0)
    v_max3_u32 v2, v2, v28, v29
    v_max3_u32 v2, v2, v30, v31
    v_max3_u32 v2, v2, v32, v33
    v_max3_u32 v2, v2, v34, v35
    v_max3_u32 v2, v2, v36, v37
    v_max3_u32 v2, v2, v38, v39
    v_max3_u32 v2, v2, v40, v41
    v_max3_u32 v2, v2, v42, v43
    v_max3_u32 v2, v2, v44, v45
    v_max3_u32 v2, v2, v46, v47
    v_max3_u32 v2, v2, v48, v49
    v_max3_u32 v2, v2, v50, v51
    v_max3_u32 v2, v2, v52, v53
    v_max3_u32 v2, v2, v54, v55
    v_max3_u32 v2, v2, v56, v57
    v_max3_u32 v2, v2, v58, v59
    v_max3_u32 v2, v2, v60, v61
    v_max3_u32 v2, v2, v62, v63
    v_max3_u32 v2, v2, v64, v65
    v_max3_u32 v2, v2, v66, v67
    v_cmp_eq_u32 vcc, -1, v2
    s_cbranch_vccnz L_nan_71r
    s_mov_b32 s52, 1
    v_mov_b32 v68, 0
    v_mov_b32 v69, 0
    v_mov_b32 v70, 0
    v_mov_b32 v71, 0
    v_mov_b32 v72, 0
    v_mov_b32 v73, 0
    v_mov_b32 v74, 0
    v_mov_b32 v75, 0
    v_smfmac_f32_16x16x64_bf16 v[68:71], v[28:31], a[0:7], v17
    s_nop 0
    v_smfmac_f32_16x16x64_bf16 v[72:75], v[28:31], a[80:87], v17
    v_smfmac_f32_16x16x64_bf16 v[68:71], v[32:35], a[8:15], v17
    v_smfmac_f32_16x16x64_bf16 v[72:75], v[32:35], a[88:95], v17
    v_smfmac_f32_16x16x64_bf16 v[68:71], v[36:39], a[16:23], v17
    v_smfmac_f32_16x16x64_bf16 v[68:71], v[40:43], a[24:31], v17
    v_smfmac_f32_16x16x64_bf16 v[68:71], v[44:47], a[32:39], v17
    v_smfmac_f32_16x16x64_bf16 v[68:71], v[48:51], a[40:47], v17
    v_smfmac_f32_16x16x64_bf16 v[68:71], v[52:55], a[48:55], v17
    v_smfmac_f32_16x16x64_bf16 v[68:71], v[56:59], a[56:63], v17
    v_smfmac_f32_16x16x64_bf16 v[68:71], v[60:63], a[64:71], v17
    v_smfmac_f32_16x16x64_bf16 v[68:71], v[64:67], a[72:79], v17
    s_nop 2
    s_branch L_redo_69
L_poll_70c:
L_poll_70:
    buffer_load_dwordx4 v13, s[4:7], s41 offen sc1 lds
    buffer_load_dwordx4 v13, s[4:7], s41 offen offset:1024 sc1 lds
    buffer_load_dword v14, s[4:7], s41 offen offset:2048 sc1 lds
    buffer_load_dword v14, s[4:7], s41 offen offset:2304 sc1 lds
    s_sub_u32 s36, s36, 1
    s_cbranch_scc1 L_exit
    s_waitcnt vmcnt(0)
    ds_read_b32 v18, v15
    s_waitcnt lgkmcnt(0)
    v_cmp_eq_u32 vcc, -1, v18
    s_cbranch_vccnz L_poll_70
    s_branch L_poll_70x
L_sd_77c:
    v_mov_b32 v5, 460288
L_pf_81:
    buffer_load_dword v6, v5, s[4:7], s38 offen sc1
    v_mov_b32 v3, 204
L_p0_82:
    buffer_load_dword v4, v3, s[8:11], 0 offen sc1
    s_sub_u32 s36, s36, 1
    s_cbranch_scc1 L_exit
    s_waitcnt vmcnt(0)
    v_readfirstlane_b32 s90, v4
    s_nop 0
    s_cmp_eq_u32 s90, 0
    s_cbranch_scc1 L_p0_82
    s_and_b32 s90, s90, 2
    s_lshl_b32 s90, s90, 12
    v_readfirstlane_b32 s91, v6
    s_nop 0
    s_cmp_eq_u32 s91, 0
    s_cbranch_scc1 L_pf_81
    s_and_b32 s91, s91, 2
    s_lshl_b32 s91, s91, 12
    v_add_u32 v142, s91, v142
    v_add_u32 v143, s91, v143
    v_and_b32 v3, s90, v152
    v_xor_b32 v146, v3, v146
    s_branch L_sd_77
L_pp_79:
    buffer_load_dwordx4 v[176:179], v142, s[4:7], s53 offen sc1
    buffer_load_dwordx4 v[180:183], v143, s[4:7], s53 offen sc1
    s_sub_u32 s36, s36, 1
    s_cbranch_scc1 L_exit
    v_max_u32 v151, v168, v169
    v_max3_u32 v151, v151, v170, v171
    v_max3_u32 v151, v151, v172, v173
    v_max3_u32 v151, v151, v174, v175
    v_cmp_eq_u32 vcc, -1, v151
    s_cbranch_vccz L_pc_80
    s_waitcnt vmcnt(1)
    v_mfma_f32_16x16x32_bf16 v[184:187], v[176:179], v[196:199], 0
    s_waitcnt vmcnt(0)
    v_mfma_f32_16x16x32_bf16 v[184:187], v[180:183], v[196:199], v[184:187]
    s_nop 7
    v_pk_add_f32 v[188:189], v[184:185], v[186:187]
    v_cmp_u_f32 vcc, v188, v189
    v_cvt_pk_bf16_f32 v192, v184, v185
    v_cvt_pk_bf16_f32 v193, v186, v187
    v_cndmask_b32 v192, v192, v193, s[58:59]
    s_cbranch_vccnz L_pp_79_1
    s_branch L_pc_80
L_pp_79_1:
    buffer_load_dwordx4 v[168:171], v142, s[4:7], s53 offen sc1
    buffer_load_dwordx4 v[172:175], v143, s[4:7], s53 offen sc1
    s_sub_u32 s36, s36, 1
    s_cbranch_scc1 L_exit
    v_max_u32 v151, v176, v177
    v_max3_u32 v151, v151, v178, v179
    v_max3_u32 v151, v151, v180, v181
    v_max3_u32 v151, v151, v182, v183
    v_cmp_eq_u32 vcc, -1, v151
    s_cbranch_vccz L_pc_80
    s_waitcnt vmcnt(1)
    v_mfma_f32_16x16x32_bf16 v[184:187], v[168:171], v[196:199], 0
    s_waitcnt vmcnt(0)
    v_mfma_f32_16x16x32_bf16 v[184:187], v[172:175], v[196:199], v[184:187]
    s_nop 7
    v_pk_add_f32 v[188:189], v[184:185], v[186:187]
    v_cmp_u_f32 vcc, v188, v189
    v_cvt_pk_bf16_f32 v192, v184, v185
    v_cvt_pk_bf16_f32 v193, v186, v187
    v_cndmask_b32 v192, v192, v193, s[58:59]
    s_cbranch_vccnz L_pp_79
    s_branch L_pc_80
L_v_s:
    s_mov_b32 s12, s78
    s_and_b32 s13, s79, 0xffff
    s_mov_b32 s14, 7864320
    s_mov_b32 s15, 0x20000
    s_sub_u32 s40, s35, 12
    s_lshl_b32 s40, s40, 1
    s_mov_b32 s24, s70
    s_and_b32 s25, s71, 0xffff
    s_mov_b32 s26, 2621440
    s_mov_b32 s27, 0x20000
    v_and_b32 v1, 15, v0
    v_lshrrev_b32 v2, 4, v0
    v_lshrrev_b32 v3, 3, v0
    v_and_b32 v4, 7, v0
    s_lshl_b32 s90, s32, 3
    v_add_u32 v5, s90, v3
    s_and_b32 s91, s32, 1
    s_lshl_b32 s91, s91, 2
    v_and_b32 v6, 2, v3
    v_or_b32 v6, s91, v6
    v_xor_b32 v6, v6, v4
    v_lshlrev_b32 v6, 4, v6
    v_mul_u32_u24 v7, 12288, v5
    s_mul_i32 s92, s34, 1536
    s_lshl_b32 s93, s40, 7
    s_add_u32 s92, s92, s93
    v_add3_u32 v124, v6, v7, s92
    v_lshrrev_b32 v6, 1, v3
    v_or_b32 v6, s91, v6
    v_xor_b32 v6, v6, v4
    v_lshlrev_b32 v6, 4, v6
    v_mul_u32_u24 v7, 1280, v5
    v_add_u32 v10, v6, v7
    s_lshl_b32 s90, s32, 10
    s_add_u32 m0, s90, 81920
    s_mov_b32 s91, 128
    buffer_load_dwordx4 v124, s[12:15], s91 offen nt lds
    s_add_u32 m0, m0, 4096
    s_add_u32 s91, s91, 393216
    buffer_load_dwordx4 v124, s[12:15], s91 offen nt lds
    s_add_u32 m0, m0, 4096
    s_add_u32 s91, s91, 393216
    buffer_load_dwordx4 v124, s[12:15], s91 offen nt lds
    s_add_u32 m0, m0, 4096
    s_add_u32 s91, s91, 393216
    buffer_load_dwordx4 v124, s[12:15], s91 offen nt lds
    s_add_u32 m0, m0, 4096
    s_add_u32 s91, s91, 393216
    buffer_load_dwordx4 v124, s[12:15], s91 offen nt lds
    s_add_u32 m0, m0, 4096
    s_add_u32 s91, s91, 393216
    buffer_load_dwordx4 v124, s[12:15], s91 offen nt lds
    s_add_u32 m0, m0, 4096
    s_add_u32 s91, s91, 393216
    buffer_load_dwordx4 v124, s[12:15], s91 offen nt lds
    s_add_u32 m0, m0, 4096
    s_add_u32 s91, s91, 393216
    buffer_load_dwordx4 v124, s[12:15], s91 offen nt lds
    s_add_u32 m0, m0, 4096
    s_add_u32 s91, s91, 393216
    buffer_load_dwordx4 v124, s[12:15], s91 offen nt lds
    s_add_u32 m0, m0, 4096
    s_add_u32 s91, s91, 393216
    buffer_load_dwordx4 v124, s[12:15], s91 offen nt lds
    s_mul_i32 s60, s40, 86
    s_lshr_b32 s60, s60, 8
    s_mul_i32 s61, s60, 3
    s_sub_u32 s61, s40, s61
    s_add_u32 s90, s40, 1
    s_mul_i32 s62, s90, 86
    s_lshr_b32 s62, s62, 8
    s_mul_i32 s63, s62, 3
    s_sub_u32 s63, s90, s63
    v_lshrrev_b32 v3, 1, v2
    v_and_b32 v5, 1, v2
    s_lshl_b32 s90, s32, 9
    v_lshlrev_b32 v6, 4, v1
    v_lshl_add_u32 v6, v3, 8, v6
    v_add_u32 v6, s90, v6
    s_mul_i32 s90, s60, 12288
    s_lshl_b32 s91, s61, 11
    s_add_u32 s90, s90, s91
    v_mul_u32_u24 v7, 6144, v5
    v_add3_u32 v19, v6, v7, s90
    v_mov_b32 v22, -1
    s_mul_i32 s56, s62, 12288
    s_lshl_b32 s91, s63, 11
    s_add_u32 s56, s56, s91
    s_sub_u32 s56, s56, s90
    s_lshl_b32 s90, s40, 10
    s_lshl_b32 s91, s32, 8
    s_add_u32 s91, s91, s90
    s_add_u32 s91, s91, 25600
    v_lshl_add_u32 v135, v0, 2, s91
    v_and_b32 v6, 60, v0
    v_bfe_u32 v7, v0, 1, 1
    v_or_b32 v6, v6, v7
    v_and_b32 v7, 1, v0
    v_lshl_or_b32 v6, v7, 1, v6
    s_and_b32 s90, s32, 1
    s_lshl_b32 s90, s90, 3
    v_xor_b32 v6, s90, v6
    v_lshl_add_u32 v134, v6, 2, s91
    s_lshl_b32 s90, s60, 5
    s_lshl_b32 s91, s62, 5
    v_mov_b32 v3, s90
    v_mov_b32 v4, s91
    v_mov_b32 v6, s61
    v_mov_b32 v7, s63
    v_cmp_eq_u32 vcc, 0, v0
    s_nop 1
    v_cndmask_b32 v3, v4, v3, vcc
    v_cndmask_b32 v6, v7, v6, vcc
    v_add_u32 v4, v3, v6
    s_cmp_eq_u32 s32, 3
    s_cselect_b32 s91, 0, 2146435072
    s_add_u32 s91, s91, 462348
    v_lshl_add_u32 v21, v4, 2, s91
    v_lshl_add_u32 v4, v6, 2, v3
    s_lshl_b32 s91, s32, 2
    s_add_u32 s91, s91, 458752
    v_lshl_add_u32 v136, v4, 2, s91
    v_cmp_gt_u32 vcc, 2, v0
    v_mov_b32 v9, 2146435072
    s_nop 0
    v_cndmask_b32 v21, v9, v21, vcc
    v_cndmask_b32 v136, v9, v136, vcc
    s_lshl_b32 s90, s40, 1
    s_add_u32 s90, s90, s32
    s_sub_u32 s90, s90, 4
    s_lshl_b32 s90, s90, 11
    s_cmp_eq_u32 s40, 0
    s_cselect_b32 s90, 2146435072, s90
    v_lshl_add_u32 v137, v0, 4, s90
    v_mov_b32 v138, 460416
    v_lshrrev_b32 v3, 2, v1
    v_and_b32 v4, 3, v1
    v_and_b32 v5, 1, v2
    v_lshl_add_u32 v6, v2, 3, v3
    v_lshlrev_b32 v6, 7, v6
    v_and_b32 v7, 2, v3
    v_lshl_or_b32 v7, v5, 2, v7
    v_lshrrev_b32 v8, 1, v4
    s_lshl_b32 s90, s32, 1
    v_or_b32 v8, s90, v8
    v_xor_b32 v7, v7, v8
    v_lshl_add_u32 v6, v7, 4, v6
    v_and_b32 v7, 1, v4
    v_lshl_add_u32 v6, v7, 3, v6
    v_add_u32 v125, 81920, v6
    v_add_u32 v126, 40960, v6
    v_add_u32 v127, 122880, v6
    s_lshl_b32 s90, s32, 9
    s_add_u32 s90, s90, 133120
    v_and_b32 v7, 2, v1
    v_cmp_ne_u32 vcc, 0, v7
    v_mov_b32 v6, 0x4444
    v_mov_b32 v8, 0xeeee
    v_cndmask_b32 v17, v6, v8, vcc
    v_lshlrev_b32 v6, 4, v0
    v_add_u32 v16, 122880, v6
    s_mul_i32 s90, s32, 2560
    v_lshl_add_u32 v13, v0, 4, s90
    v_lshl_add_u32 v14, v0, 2, s90
    s_add_u32 s48, s90, 122880
    v_mul_u32_u24 v6, 40, v0
    v_add_u32 v15, s48, v6
    v_mul_u32_u24 v6, 164, v0
    v_min_u32 v6, 10236, v6
    v_add_u32 v25, 122880, v6
    v_lshrrev_b32 v6, 3, v1
    v_lshlrev_b32 v6, 10, v6
    v_and_b32 v7, 7, v1
    v_lshl_add_u32 v6, v7, 7, v6
    v_lshrrev_b32 v7, 1, v1
    v_xor_b32 v7, v7, v2
    v_lshl_add_u32 v11, v7, 4, v6
    v_xor_b32 v12, 64, v11
    v_and_b32 v3, 1, v0
    v_lshlrev_b32 v3, 12, v3
    v_bfe_u32 v5, v0, 2, 1
    v_lshl_add_u32 v3, v5, 13, v3
    v_bfe_u32 v4, v0, 1, 1
    v_lshl_add_u32 v3, v4, 14, v3
    s_lshl_b32 s91, s34, 9
    s_add_u32 s91, s91, 1933312
    s_xor_b32 s55, s32, 3
    s_or_b32 s55, s55, s40
    s_cselect_b32 s91, 2146435072, s91
    s_cselect_b32 s92, 2146435072, 0
    s_add_u32 s92, s92, 460416
    v_mov_b32 v147, s92
    v_add_u32 v140, s91, v3
    v_cmp_eq_u32 vcc, 0, v0
    v_mov_b32 v9, 2146435072
    s_nop 0
    v_cndmask_b32 v147, v9, v147, vcc
    v_cmp_gt_u32 vcc, 8, v0
    v_mov_b32 v9, 2146435072
    s_nop 0
    v_cndmask_b32 v140, v9, v140, vcc
    v_cmp_ne_u32 vcc, s34, v0
    v_mov_b32 v9, 2146435072
    s_nop 0
    v_cndmask_b32 v140, v9, v140, vcc
    s_lshr_b32 s91, s34, 2
    v_cmp_eq_u32 vcc, s91, v5
    s_nop 1
    v_cndmask_b32 v141, v9, v140, vcc
    v_cndmask_b32 v140, v140, v9, vcc
    v_and_b32 v3, 7, v0
    v_min_u32 v3, 5, v3
    v_bfe_u32 v4, v0, 3, 2
    v_lshlrev_b32 v4, 7, v4
    v_lshl_add_u32 v3, v3, 2, v4
    v_add_u32 v142, 462368, v3
    v_min_u32 v3, 39, v0
    v_lshlrev_b32 v3, 2, v3
    v_add_u32 v142, 460544, v3
    s_lshl_b32 s93, s40, 1
    s_add_u32 s93, s93, s32
    s_lshl_b32 s93, s93, 1
    s_sub_u32 s93, s93, 8
    s_nop 0
    s_lshr_b32 s90, s93, 2
    s_lshl_b32 s90, s90, 15
    s_and_b32 s92, s93, 3
    s_lshl_b32 s92, s92, 10
    s_add_u32 s90, s90, s92
    v_mov_b32 v5, s34
    v_and_b32 v6, 7, v1
    v_lshlrev_b32 v6, 4, v6
    v_lshl_add_u32 v6, v5, 7, v6
    v_lshrrev_b32 v7, 3, v1
    v_lshl_add_u32 v6, v7, 12, v6
    v_lshrrev_b32 v5, 1, v2
    v_lshl_add_u32 v6, v5, 13, v6
    v_and_b32 v5, 1, v2
    v_lshl_add_u32 v6, v5, 14, v6
    v_add_u32 v143, s90, v6
    s_and_b32 s91, s34, 1
    s_lshl_b32 s91, s91, 12
    s_add_u32 s90, s90, s91
    s_lshr_b32 s91, s34, 2
    s_lshl_b32 s91, s91, 13
    s_add_u32 s90, s90, s91
    s_and_b32 s91, s34, 2
    s_lshl_b32 s91, s91, 13
    s_add_u32 s90, s90, s91
    v_lshl_add_u32 v144, v0, 4, s90
    s_lshl_b32 s91, s93, 10
    s_add_u32 s91, s91, 884736
    v_lshl_add_u32 v146, v0, 4, s91
    s_lshr_b32 s91, s34, 1
    s_mul_i32 s91, s91, 10240
    s_lshl_b32 s92, s93, 5
    s_add_u32 s91, s91, s92
    s_and_b32 s92, s34, 1
    s_mul_i32 s92, s92, 40960
    s_add_u32 s91, s91, s92
    s_add_u32 s91, s91, 1280
    v_mul_u32_u24 v6, 2560, v2
    v_lshl_add_u32 v6, v1, 1, v6
    v_add_u32 v145, s91, v6
    v_cmp_gt_u32 s[58:59], 8, v1
    v_and_b32 v5, 1, v1
    v_lshrrev_b32 v6, 3, v1
    v_lshl_add_u32 v5, v5, 1, v6
    v_bfe_u32 v6, v1, 2, 1
    v_cmp_ne_u32 vcc, 0, v6
    v_mov_b32 v6, 0x3f80
    v_mov_b32 v7, 0x3f800000
    v_cndmask_b32 v6, v6, v7, vcc
    v_cmp_eq_u32 vcc, 0, v5
    s_nop 1
    v_cndmask_b32 v7, 0, v6, vcc
    v_accvgpr_write_b32 a160, v7
    v_cmp_eq_u32 vcc, 1, v5
    s_nop 1
    v_cndmask_b32 v7, 0, v6, vcc
    v_accvgpr_write_b32 a161, v7
    v_cmp_eq_u32 vcc, 2, v5
    s_nop 1
    v_cndmask_b32 v7, 0, v6, vcc
    v_accvgpr_write_b32 a162, v7
    v_cmp_eq_u32 vcc, 3, v5
    s_nop 1
    v_cndmask_b32 v7, 0, v6, vcc
    v_accvgpr_write_b32 a163, v7
    s_cmp_lg_u32 s40, 0
    s_cselect_b64 vcc, -1, 0
    v_cndmask_b32 v143, v9, v143, vcc
    v_cndmask_b32 v144, v9, v144, vcc
    v_cndmask_b32 v145, v9, v145, vcc
    v_cndmask_b32 v146, v9, v146, vcc
    s_lshl_b32 s90, s32, 10
    s_add_u32 m0, s90, 40960
    s_mov_b32 s91, 0
    buffer_load_dwordx4 v124, s[12:15], s91 offen nt lds
    s_add_u32 m0, m0, 4096
    s_add_u32 s91, s91, 393216
    buffer_load_dwordx4 v124, s[12:15], s91 offen nt lds
    s_add_u32 m0, m0, 4096
    s_add_u32 s91, s91, 393216
    buffer_load_dwordx4 v124, s[12:15], s91 offen nt lds
    s_add_u32 m0, m0, 4096
    s_add_u32 s91, s91, 393216
    buffer_load_dwordx4 v124, s[12:15], s91 offen nt lds
    s_add_u32 m0, m0, 4096
    s_add_u32 s91, s91, 393216
    buffer_load_dwordx4 v124, s[12:15], s91 offen nt lds
    s_add_u32 m0, m0, 4096
    s_add_u32 s91, s91, 393216
    buffer_load_dwordx4 v124, s[12:15], s91 offen nt lds
    s_add_u32 m0, m0, 4096
    s_add_u32 s91, s91, 393216
    buffer_load_dwordx4 v124, s[12:15], s91 offen nt lds
    s_add_u32 m0, m0, 4096
    s_add_u32 s91, s91, 393216
    buffer_load_dwordx4 v124, s[12:15], s91 offen nt lds
    s_add_u32 m0, m0, 4096
    s_add_u32 s91, s91, 393216
    buffer_load_dwordx4 v124, s[12:15], s91 offen nt lds
    s_add_u32 m0, m0, 4096
    s_add_u32 s91, s91, 393216
    buffer_load_dwordx4 v124, s[12:15], s91 offen nt lds
    s_lshl_b32 s90, s32, 10
    s_add_u32 m0, s90, 122880
    s_mov_b32 s91, 3932288
    buffer_load_dwordx4 v124, s[12:15], s91 offen nt lds
    s_add_u32 m0, m0, 4096
    s_add_u32 s91, s91, 393216
    buffer_load_dwordx4 v124, s[12:15], s91 offen nt lds
    s_add_u32 m0, m0, 4096
    s_add_u32 s91, s91, 393216
    buffer_load_dwordx4 v124, s[12:15], s91 offen nt lds
    s_add_u32 m0, m0, 4096
    s_add_u32 s91, s91, 393216
    buffer_load_dwordx4 v124, s[12:15], s91 offen nt lds
    s_add_u32 m0, m0, 4096
    s_add_u32 s91, s91, 393216
    buffer_load_dwordx4 v124, s[12:15], s91 offen nt lds
    s_add_u32 m0, m0, 4096
    s_add_u32 s91, s91, 393216
    buffer_load_dwordx4 v124, s[12:15], s91 offen nt lds
    s_add_u32 m0, m0, 4096
    s_add_u32 s91, s91, 393216
    buffer_load_dwordx4 v124, s[12:15], s91 offen nt lds
    s_add_u32 m0, m0, 4096
    s_add_u32 s91, s91, 393216
    buffer_load_dwordx4 v124, s[12:15], s91 offen nt lds
    s_add_u32 m0, m0, 4096
    s_add_u32 s91, s91, 393216
    buffer_load_dwordx4 v124, s[12:15], s91 offen nt lds
    s_add_u32 m0, m0, 4096
    s_add_u32 s91, s91, 393216
    buffer_load_dwordx4 v124, s[12:15], s91 offen nt lds
    s_mov_b32 s46, 0
    s_lshl_b32 s90, s32, 10
    s_add_u32 m0, s90, 0
    s_nop 0
    buffer_load_dwordx4 v10, s[24:27], s46 offen offset:0 lds
    s_add_u32 m0, m0, 3968
    s_nop 0
    buffer_load_dwordx4 v10, s[24:27], s46 offen offset:128 lds
    s_add_u32 m0, m0, 3968
    s_nop 0
    buffer_load_dwordx4 v10, s[24:27], s46 offen offset:256 lds
    s_add_u32 m0, m0, 3968
    s_nop 0
    buffer_load_dwordx4 v10, s[24:27], s46 offen offset:384 lds
    s_add_u32 m0, m0, 3968
    s_nop 0
    buffer_load_dwordx4 v10, s[24:27], s46 offen offset:512 lds
    s_add_u32 m0, m0, 3968
    s_nop 0
    buffer_load_dwordx4 v10, s[24:27], s46 offen offset:640 lds
    s_add_u32 m0, m0, 3968
    s_nop 0
    buffer_load_dwordx4 v10, s[24:27], s46 offen offset:768 lds
    s_add_u32 m0, m0, 3968
    s_nop 0
    buffer_load_dwordx4 v10, s[24:27], s46 offen offset:896 lds
    s_add_u32 m0, m0, 3968
    s_nop 0
    buffer_load_dwordx4 v10, s[24:27], s46 offen offset:1024 lds
    s_add_u32 m0, m0, 3968
    s_nop 0
    buffer_load_dwordx4 v10, s[24:27], s46 offen offset:1152 lds
    s_waitcnt vmcnt(30)
    s_barrier
    ds_read_b64_tr_b16 a[80:81], v125 offset:0
    ds_read_b64_tr_b16 a[82:83], v125 offset:512
    ds_read_b64_tr_b16 a[84:85], v125 offset:4096
    ds_read_b64_tr_b16 a[86:87], v125 offset:4608
    ds_read_b64_tr_b16 a[88:89], v125 offset:8192
    ds_read_b64_tr_b16 a[90:91], v125 offset:8704
    ds_read_b64_tr_b16 a[92:93], v125 offset:12288
    ds_read_b64_tr_b16 a[94:95], v125 offset:12800
    ds_read_b64_tr_b16 a[96:97], v125 offset:16384
    ds_read_b64_tr_b16 a[98:99], v125 offset:16896
    ds_read_b64_tr_b16 a[100:101], v125 offset:20480
    ds_read_b64_tr_b16 a[102:103], v125 offset:20992
    ds_read_b64_tr_b16 a[104:105], v125 offset:24576
    ds_read_b64_tr_b16 a[106:107], v125 offset:25088
    ds_read_b64_tr_b16 a[108:109], v125 offset:28672
    ds_read_b64_tr_b16 a[110:111], v125 offset:29184
    ds_read_b64_tr_b16 a[112:113], v125 offset:32768
    ds_read_b64_tr_b16 a[114:115], v125 offset:33280
    ds_read_b64_tr_b16 a[116:117], v125 offset:36864
    ds_read_b64_tr_b16 a[118:119], v125 offset:37376
    s_waitcnt lgkmcnt(0)
    s_barrier
    s_lshl_b32 s90, s32, 10
    s_add_u32 m0, s90, 81920
    s_mov_b32 s91, 3932160
    buffer_load_dwordx4 v124, s[12:15], s91 offen nt lds
    s_add_u32 m0, m0, 4096
    s_add_u32 s91, s91, 393216
    buffer_load_dwordx4 v124, s[12:15], s91 offen nt lds
    s_add_u32 m0, m0, 4096
    s_add_u32 s91, s91, 393216
    buffer_load_dwordx4 v124, s[12:15], s91 offen nt lds
    s_add_u32 m0, m0, 4096
    s_add_u32 s91, s91, 393216
    buffer_load_dwordx4 v124, s[12:15], s91 offen nt lds
    s_add_u32 m0, m0, 4096
    s_add_u32 s91, s91, 393216
    buffer_load_dwordx4 v124, s[12:15], s91 offen nt lds
    s_add_u32 m0, m0, 4096
    s_add_u32 s91, s91, 393216
    buffer_load_dwordx4 v124, s[12:15], s91 offen nt lds
    s_add_u32 m0, m0, 4096
    s_add_u32 s91, s91, 393216
    buffer_load_dwordx4 v124, s[12:15], s91 offen nt lds
    s_add_u32 m0, m0, 4096
    s_add_u32 s91, s91, 393216
    buffer_load_dwordx4 v124, s[12:15], s91 offen nt lds
    s_add_u32 m0, m0, 4096
    s_add_u32 s91, s91, 393216
    buffer_load_dwordx4 v124, s[12:15], s91 offen nt lds
    s_add_u32 m0, m0, 4096
    s_add_u32 s91, s91, 393216
    buffer_load_dwordx4 v124, s[12:15], s91 offen nt lds
    s_waitcnt vmcnt(30)
    s_barrier
    ds_read_b64_tr_b16 a[0:1], v126 offset:0
    ds_read_b64_tr_b16 a[2:3], v126 offset:512
    ds_read_b64_tr_b16 a[4:5], v126 offset:4096
    ds_read_b64_tr_b16 a[6:7], v126 offset:4608
    ds_read_b64_tr_b16 a[8:9], v126 offset:8192
    ds_read_b64_tr_b16 a[10:11], v126 offset:8704
    ds_read_b64_tr_b16 a[12:13], v126 offset:12288
    ds_read_b64_tr_b16 a[14:15], v126 offset:12800
    ds_read_b64_tr_b16 a[16:17], v126 offset:16384
    ds_read_b64_tr_b16 a[18:19], v126 offset:16896
    ds_read_b64_tr_b16 a[20:21], v126 offset:20480
    ds_read_b64_tr_b16 a[22:23], v126 offset:20992
    ds_read_b64_tr_b16 a[24:25], v126 offset:24576
    ds_read_b64_tr_b16 a[26:27], v126 offset:25088
    ds_read_b64_tr_b16 a[28:29], v126 offset:28672
    ds_read_b64_tr_b16 a[30:31], v126 offset:29184
    ds_read_b64_tr_b16 a[32:33], v126 offset:32768
    ds_read_b64_tr_b16 a[34:35], v126 offset:33280
    ds_read_b64_tr_b16 a[36:37], v126 offset:36864
    ds_read_b64_tr_b16 a[38:39], v126 offset:37376
    s_waitcnt lgkmcnt(0)
    s_barrier
    s_mov_b32 s46, 40960
    s_lshl_b32 s90, s32, 10
    s_add_u32 m0, s90, 40960
    s_nop 0
    buffer_load_dwordx4 v10, s[24:27], s46 offen offset:0 lds
    s_add_u32 m0, m0, 3968
    s_nop 0
    buffer_load_dwordx4 v10, s[24:27], s46 offen offset:128 lds
    s_add_u32 m0, m0, 3968
    s_nop 0
    buffer_load_dwordx4 v10, s[24:27], s46 offen offset:256 lds
    s_add_u32 m0, m0, 3968
    s_nop 0
    buffer_load_dwordx4 v10, s[24:27], s46 offen offset:384 lds
    s_add_u32 m0, m0, 3968
    s_nop 0
    buffer_load_dwordx4 v10, s[24:27], s46 offen offset:512 lds
    s_add_u32 m0, m0, 3968
    s_nop 0
    buffer_load_dwordx4 v10, s[24:27], s46 offen offset:640 lds
    s_add_u32 m0, m0, 3968
    s_nop 0
    buffer_load_dwordx4 v10, s[24:27], s46 offen offset:768 lds
    s_add_u32 m0, m0, 3968
    s_nop 0
    buffer_load_dwordx4 v10, s[24:27], s46 offen offset:896 lds
    s_add_u32 m0, m0, 3968
    s_nop 0
    buffer_load_dwordx4 v10, s[24:27], s46 offen offset:1024 lds
    s_add_u32 m0, m0, 3968
    s_nop 0
    buffer_load_dwordx4 v10, s[24:27], s46 offen offset:1152 lds
    s_waitcnt vmcnt(30)
    s_barrier
    ds_read_b64_tr_b16 a[120:121], v127 offset:0
    ds_read_b64_tr_b16 a[122:123], v127 offset:512
    ds_read_b64_tr_b16 a[124:125], v127 offset:4096
    ds_read_b64_tr_b16 a[126:127], v127 offset:4608
    ds_read_b64_tr_b16 a[128:129], v127 offset:8192
    ds_read_b64_tr_b16 a[130:131], v127 offset:8704
    ds_read_b64_tr_b16 a[132:133], v127 offset:12288
    ds_read_b64_tr_b16 a[134:135], v127 offset:12800
    ds_read_b64_tr_b16 a[136:137], v127 offset:16384
    ds_read_b64_tr_b16 a[138:139], v127 offset:16896
    ds_read_b64_tr_b16 a[140:141], v127 offset:20480
    ds_read_b64_tr_b16 a[142:143], v127 offset:20992
    ds_read_b64_tr_b16 a[144:145], v127 offset:24576
    ds_read_b64_tr_b16 a[146:147], v127 offset:25088
    ds_read_b64_tr_b16 a[148:149], v127 offset:28672
    ds_read_b64_tr_b16 a[150:151], v127 offset:29184
    ds_read_b64_tr_b16 a[152:153], v127 offset:32768
    ds_read_b64_tr_b16 a[154:155], v127 offset:33280
    ds_read_b64_tr_b16 a[156:157], v127 offset:36864
    ds_read_b64_tr_b16 a[158:159], v127 offset:37376
    s_waitcnt lgkmcnt(0)
    s_waitcnt vmcnt(10)
    s_barrier
    ds_read_b64_tr_b16 a[40:41], v125 offset:0
    ds_read_b64_tr_b16 a[42:43], v125 offset:512
    ds_read_b64_tr_b16 a[44:45], v125 offset:4096
    ds_read_b64_tr_b16 a[46:47], v125 offset:4608
    ds_read_b64_tr_b16 a[48:49], v125 offset:8192
    ds_read_b64_tr_b16 a[50:51], v125 offset:8704
    ds_read_b64_tr_b16 a[52:53], v125 offset:12288
    ds_read_b64_tr_b16 a[54:55], v125 offset:12800
    ds_read_b64_tr_b16 a[56:57], v125 offset:16384
    ds_read_b64_tr_b16 a[58:59], v125 offset:16896
    ds_read_b64_tr_b16 a[60:61], v125 offset:20480
    ds_read_b64_tr_b16 a[62:63], v125 offset:20992
    ds_read_b64_tr_b16 a[64:65], v125 offset:24576
    ds_read_b64_tr_b16 a[66:67], v125 offset:25088
    ds_read_b64_tr_b16 a[68:69], v125 offset:28672
    ds_read_b64_tr_b16 a[70:71], v125 offset:29184
    ds_read_b64_tr_b16 a[72:73], v125 offset:32768
    ds_read_b64_tr_b16 a[74:75], v125 offset:33280
    ds_read_b64_tr_b16 a[76:77], v125 offset:36864
    ds_read_b64_tr_b16 a[78:79], v125 offset:37376
    s_waitcnt lgkmcnt(0)
    s_mov_b32 s49, 40960
    s_mov_b32 s47, 40960
    s_mov_b32 s37, -1
    s_add_u32 s44, s38, 65536
    s_add_u32 s45, s44, s56
    s_mov_b32 s46, 40960
    v_mov_b32 v1, 196
    buffer_load_dword v2, v1, s[8:11], 0 offen sc1
    ds_read_b128 v[84:87], v11 offset:0
    ds_read_b128 v[88:91], v11 offset:2048
    ds_read_b128 v[92:95], v12 offset:0
    ds_read_b128 v[96:99], v12 offset:2048
    s_waitcnt lgkmcnt(2)
    v_mfma_f32_16x16x32_bf16 v[108:111], a[0:3], v[84:87], 0
    ds_read_b128 v[100:103], v11 offset:4096
    v_mfma_f32_16x16x32_bf16 v[112:115], a[0:3], v[88:91], 0
    ds_read_b128 v[104:107], v11 offset:6144
    v_mfma_f32_16x16x32_bf16 v[116:119], a[80:83], v[84:87], 0
    v_mfma_f32_16x16x32_bf16 v[120:123], a[80:83], v[88:91], 0
    s_waitcnt lgkmcnt(2)
    v_mfma_f32_16x16x32_bf16 v[108:111], a[4:7], v[92:95], v[108:111]
    ds_read_b128 v[84:87], v12 offset:4096
    v_mfma_f32_16x16x32_bf16 v[112:115], a[4:7], v[96:99], v[112:115]
    ds_read_b128 v[88:91], v12 offset:6144
    v_mfma_f32_16x16x32_bf16 v[116:119], a[84:87], v[92:95], v[116:119]
    v_mfma_f32_16x16x32_bf16 v[120:123], a[84:87], v[96:99], v[120:123]
    s_waitcnt lgkmcnt(2)
    v_mfma_f32_16x16x32_bf16 v[108:111], a[8:11], v[100:103], v[108:111]
    ds_read_b128 v[92:95], v11 offset:8192
    v_mfma_f32_16x16x32_bf16 v[112:115], a[8:11], v[104:107], v[112:115]
    ds_read_b128 v[96:99], v11 offset:10240
    v_mfma_f32_16x16x32_bf16 v[116:119], a[88:91], v[100:103], v[116:119]
    v_mfma_f32_16x16x32_bf16 v[120:123], a[88:91], v[104:107], v[120:123]
    s_waitcnt lgkmcnt(2)
    v_mfma_f32_16x16x32_bf16 v[108:111], a[12:15], v[84:87], v[108:111]
    ds_read_b128 v[100:103], v12 offset:8192
    v_mfma_f32_16x16x32_bf16 v[112:115], a[12:15], v[88:91], v[112:115]
    ds_read_b128 v[104:107], v12 offset:10240
    v_mfma_f32_16x16x32_bf16 v[116:119], a[92:95], v[84:87], v[116:119]
    v_mfma_f32_16x16x32_bf16 v[120:123], a[92:95], v[88:91], v[120:123]
    s_waitcnt lgkmcnt(2)
    v_mfma_f32_16x16x32_bf16 v[108:111], a[16:19], v[92:95], v[108:111]
    ds_read_b128 v[84:87], v11 offset:12288
    v_mfma_f32_16x16x32_bf16 v[112:115], a[16:19], v[96:99], v[112:115]
    ds_read_b128 v[88:91], v11 offset:14336
    v_mfma_f32_16x16x32_bf16 v[116:119], a[96:99], v[92:95], v[116:119]
    v_mfma_f32_16x16x32_bf16 v[120:123], a[96:99], v[96:99], v[120:123]
    s_waitcnt lgkmcnt(2)
    v_mfma_f32_16x16x32_bf16 v[108:111], a[20:23], v[100:103], v[108:111]
    ds_read_b128 v[92:95], v12 offset:12288
    v_mfma_f32_16x16x32_bf16 v[112:115], a[20:23], v[104:107], v[112:115]
    ds_read_b128 v[96:99], v12 offset:14336
    v_mfma_f32_16x16x32_bf16 v[116:119], a[100:103], v[100:103], v[116:119]
    v_mfma_f32_16x16x32_bf16 v[120:123], a[100:103], v[104:107], v[120:123]
    s_waitcnt lgkmcnt(2)
    v_mfma_f32_16x16x32_bf16 v[108:111], a[24:27], v[84:87], v[108:111]
    ds_read_b128 v[100:103], v11 offset:16384
    v_mfma_f32_16x16x32_bf16 v[112:115], a[24:27], v[88:91], v[112:115]
    ds_read_b128 v[104:107], v11 offset:18432
    v_mfma_f32_16x16x32_bf16 v[116:119], a[104:107], v[84:87], v[116:119]
    v_mfma_f32_16x16x32_bf16 v[120:123], a[104:107], v[88:91], v[120:123]
    s_waitcnt lgkmcnt(2)
    v_mfma_f32_16x16x32_bf16 v[108:111], a[28:31], v[92:95], v[108:111]
    ds_read_b128 v[84:87], v12 offset:16384
    v_mfma_f32_16x16x32_bf16 v[112:115], a[28:31], v[96:99], v[112:115]
    ds_read_b128 v[88:91], v12 offset:18432
    v_mfma_f32_16x16x32_bf16 v[116:119], a[108:111], v[92:95], v[116:119]
    v_mfma_f32_16x16x32_bf16 v[120:123], a[108:111], v[96:99], v[120:123]
    s_waitcnt lgkmcnt(2)
    v_mfma_f32_16x16x32_bf16 v[108:111], a[32:35], v[100:103], v[108:111]
    ds_read_b128 v[92:95], v11 offset:20480
    v_mfma_f32_16x16x32_bf16 v[112:115], a[32:35], v[104:107], v[112:115]
    ds_read_b128 v[96:99], v11 offset:22528
    v_mfma_f32_16x16x32_bf16 v[116:119], a[112:115], v[100:103], v[116:119]
    v_mfma_f32_16x16x32_bf16 v[120:123], a[112:115], v[104:107], v[120:123]
    s_waitcnt lgkmcnt(2)
    v_mfma_f32_16x16x32_bf16 v[108:111], a[36:39], v[84:87], v[108:111]
    ds_read_b128 v[100:103], v12 offset:20480
    v_mfma_f32_16x16x32_bf16 v[112:115], a[36:39], v[88:91], v[112:115]
    ds_read_b128 v[104:107], v12 offset:22528
    v_mfma_f32_16x16x32_bf16 v[116:119], a[116:119], v[84:87], v[116:119]
    v_mfma_f32_16x16x32_bf16 v[120:123], a[116:119], v[88:91], v[120:123]
    s_waitcnt lgkmcnt(2)
    v_mfma_f32_16x16x32_bf16 v[108:111], a[40:43], v[92:95], v[108:111]
    ds_read_b128 v[84:87], v11 offset:24576
    v_mfma_f32_16x16x32_bf16 v[112:115], a[40:43], v[96:99], v[112:115]
    ds_read_b128 v[88:91], v11 offset:26624
    v_mfma_f32_16x16x32_bf16 v[116:119], a[120:123], v[92:95], v[116:119]
    v_mfma_f32_16x16x32_bf16 v[120:123], a[120:123], v[96:99], v[120:123]
    s_waitcnt lgkmcnt(2)
    v_mfma_f32_16x16x32_bf16 v[108:111], a[44:47], v[100:103], v[108:111]
    ds_read_b128 v[92:95], v12 offset:24576
    v_mfma_f32_16x16x32_bf16 v[112:115], a[44:47], v[104:107], v[112:115]
    ds_read_b128 v[96:99], v12 offset:26624
    v_mfma_f32_16x16x32_bf16 v[116:119], a[124:127], v[100:103], v[116:119]
    v_mfma_f32_16x16x32_bf16 v[120:123], a[124:127], v[104:107], v[120:123]
    s_waitcnt lgkmcnt(2)
    v_mfma_f32_16x16x32_bf16 v[108:111], a[48:51], v[84:87], v[108:111]
    ds_read_b128 v[100:103], v11 offset:28672
    v_mfma_f32_16x16x32_bf16 v[112:115], a[48:51], v[88:91], v[112:115]
    ds_read_b128 v[104:107], v11 offset:30720
    v_mfma_f32_16x16x32_bf16 v[116:119], a[128:131], v[84:87], v[116:119]
    v_mfma_f32_16x16x32_bf16 v[120:123], a[128:131], v[88:91], v[120:123]
    s_waitcnt lgkmcnt(2)
    v_mfma_f32_16x16x32_bf16 v[108:111], a[52:55], v[92:95], v[108:111]
    ds_read_b128 v[84:87], v12 offset:28672
    v_mfma_f32_16x16x32_bf16 v[112:115], a[52:55], v[96:99], v[112:115]
    ds_read_b128 v[88:91], v12 offset:30720
    v_mfma_f32_16x16x32_bf16 v[116:119], a[132:135], v[92:95], v[116:119]
    v_mfma_f32_16x16x32_bf16 v[120:123], a[132:135], v[96:99], v[120:123]
    s_waitcnt lgkmcnt(2)
    v_mfma_f32_16x16x32_bf16 v[108:111], a[56:59], v[100:103], v[108:111]
    ds_read_b128 v[92:95], v11 offset:32768
    v_mfma_f32_16x16x32_bf16 v[112:115], a[56:59], v[104:107], v[112:115]
    ds_read_b128 v[96:99], v11 offset:34816
    v_mfma_f32_16x16x32_bf16 v[116:119], a[136:139], v[100:103], v[116:119]
    v_mfma_f32_16x16x32_bf16 v[120:123], a[136:139], v[104:107], v[120:123]
    s_waitcnt lgkmcnt(2)
    v_mfma_f32_16x16x32_bf16 v[108:111], a[60:63], v[84:87], v[108:111]
    ds_read_b128 v[100:103], v12 offset:32768
    v_mfma_f32_16x16x32_bf16 v[112:115], a[60:63], v[88:91], v[112:115]
    ds_read_b128 v[104:107], v12 offset:34816
    v_mfma_f32_16x16x32_bf16 v[116:119], a[140:143], v[84:87], v[116:119]
    v_mfma_f32_16x16x32_bf16 v[120:123], a[140:143], v[88:91], v[120:123]
    s_waitcnt lgkmcnt(2)
    v_mfma_f32_16x16x32_bf16 v[108:111], a[64:67], v[92:95], v[108:111]
    ds_read_b128 v[84:87], v11 offset:36864
    v_mfma_f32_16x16x32_bf16 v[112:115], a[64:67], v[96:99], v[112:115]
    ds_read_b128 v[88:91], v11 offset:38912
    v_mfma_f32_16x16x32_bf16 v[116:119], a[144:147], v[92:95], v[116:119]
    v_mfma_f32_16x16x32_bf16 v[120:123], a[144:147], v[96:99], v[120:123]
    s_waitcnt lgkmcnt(2)
    v_mfma_f32_16x16x32_bf16 v[108:111], a[68:71], v[100:103], v[108:111]
    ds_read_b128 v[92:95], v12 offset:36864
    v_mfma_f32_16x16x32_bf16 v[112:115], a[68:71], v[104:107], v[112:115]
    ds_read_b128 v[96:99], v12 offset:38912
    v_mfma_f32_16x16x32_bf16 v[116:119], a[148:151], v[100:103], v[116:119]
    v_mfma_f32_16x16x32_bf16 v[120:123], a[148:151], v[104:107], v[120:123]
    s_waitcnt lgkmcnt(0)
    v_mfma_f32_16x16x32_bf16 v[108:111], a[72:75], v[84:87], v[108:111]
    v_add_u32 v11, s49, v11
    v_mfma_f32_16x16x32_bf16 v[112:115], a[72:75], v[88:91], v[112:115]
    v_add_u32 v12, s49, v12
    v_mfma_f32_16x16x32_bf16 v[108:111], a[76:79], v[92:95], v[108:111]
    s_sub_u32 s47, s47, s49
    v_mfma_f32_16x16x32_bf16 v[112:115], a[76:79], v[96:99], v[112:115]
    s_sub_u32 s49, 0, s49
    v_mfma_f32_16x16x32_bf16 v[116:119], a[152:155], v[84:87], v[116:119]
    v_mfma_f32_16x16x32_bf16 v[120:123], a[152:155], v[88:91], v[120:123]
    v_mfma_f32_16x16x32_bf16 v[116:119], a[156:159], v[92:95], v[116:119]
    v_mfma_f32_16x16x32_bf16 v[120:123], a[156:159], v[96:99], v[120:123]
    v_cvt_pk_bf16_f32 v124, v108, v109
    v_cvt_pk_bf16_f32 v125, v110, v111
    v_cvt_pk_bf16_f32 v126, v112, v113
    v_cvt_pk_bf16_f32 v127, v114, v115
    s_nop 0
    v_permlane16_swap_b32 v124, v126
    v_permlane16_swap_b32 v125, v127
    v_cvt_pk_bf16_f32 v128, v116, v117
    v_cvt_pk_bf16_f32 v129, v118, v119
    v_cvt_pk_bf16_f32 v130, v120, v121
    v_cvt_pk_bf16_f32 v131, v122, v123
    s_nop 0
    v_permlane16_swap_b32 v128, v130
    v_permlane16_swap_b32 v129, v131
    buffer_store_dwordx4 v[124:127], v19, s[4:7], s44 offen sc1
    buffer_store_dwordx4 v[128:131], v19, s[4:7], s45 offen sc1
    s_waitcnt vmcnt(2)
    s_branch L_gw_83c
L_gw_83:
    buffer_load_dword v2, v1, s[8:11], 0 offen sc1
    s_sub_u32 s36, s36, 1
    s_cbranch_scc1 L_exit
    s_waitcnt vmcnt(0)
L_gw_83c:
    v_readfirstlane_b32 s90, v2
    s_nop 0
    s_cmp_eq_u32 s90, 0
    s_cbranch_scc1 L_gw_83
    s_waitcnt vmcnt(2) lgkmcnt(0)
    s_barrier
    s_add_u32 s44, s38, 180224
    s_add_u32 s45, s44, s56
    s_mov_b32 s46, 81920
    v_mov_b32 v20, 1
    ds_read_b128 v[84:87], v11 offset:0
    ds_read_b128 v[88:91], v11 offset:2048
    ds_read_b128 v[92:95], v12 offset:0
    ds_read_b128 v[96:99], v12 offset:2048
    s_lshl_b32 s90, s32, 10
    s_add_u32 m0, s90, s47
    s_waitcnt lgkmcnt(2)
    v_mfma_f32_16x16x32_bf16 v[108:111], a[0:3], v[84:87], 0
    ds_read_b128 v[100:103], v11 offset:4096
    v_mfma_f32_16x16x32_bf16 v[112:115], a[0:3], v[88:91], 0
    ds_read_b128 v[104:107], v11 offset:6144
    v_mfma_f32_16x16x32_bf16 v[116:119], a[80:83], v[84:87], 0
    buffer_load_dwordx4 v10, s[24:27], s46 offen offset:0 lds
    s_add_u32 m0, m0, 3968
    v_mfma_f32_16x16x32_bf16 v[120:123], a[80:83], v[88:91], 0
    s_waitcnt lgkmcnt(2)
    v_mfma_f32_16x16x32_bf16 v[108:111], a[4:7], v[92:95], v[108:111]
    ds_read_b128 v[84:87], v12 offset:4096
    v_mfma_f32_16x16x32_bf16 v[112:115], a[4:7], v[96:99], v[112:115]
    ds_read_b128 v[88:91], v12 offset:6144
    v_mfma_f32_16x16x32_bf16 v[116:119], a[84:87], v[92:95], v[116:119]
    buffer_load_dwordx4 v10, s[24:27], s46 offen offset:128 lds
    s_add_u32 m0, m0, 3968
    v_mfma_f32_16x16x32_bf16 v[120:123], a[84:87], v[96:99], v[120:123]
    s_waitcnt lgkmcnt(2)
    v_mfma_f32_16x16x32_bf16 v[108:111], a[8:11], v[100:103], v[108:111]
    ds_read_b128 v[92:95], v11 offset:8192
    v_mfma_f32_16x16x32_bf16 v[112:115], a[8:11], v[104:107], v[112:115]
    ds_read_b128 v[96:99], v11 offset:10240
    v_mfma_f32_16x16x32_bf16 v[116:119], a[88:91], v[100:103], v[116:119]
    buffer_load_dwordx4 v10, s[24:27], s46 offen offset:256 lds
    s_add_u32 m0, m0, 3968
    v_mfma_f32_16x16x32_bf16 v[120:123], a[88:91], v[104:107], v[120:123]
    s_waitcnt lgkmcnt(2)
    v_mfma_f32_16x16x32_bf16 v[108:111], a[12:15], v[84:87], v[108:111]
    ds_read_b128 v[100:103], v12 offset:8192
    v_mfma_f32_16x16x32_bf16 v[112:115], a[12:15], v[88:91], v[112:115]
    ds_read_b128 v[104:107], v12 offset:10240
    v_mfma_f32_16x16x32_bf16 v[116:119], a[92:95], v[84:87], v[116:119]
    buffer_load_dwordx4 v10, s[24:27], s46 offen offset:384 lds
    s_add_u32 m0, m0, 3968
    v_mfma_f32_16x16x32_bf16 v[120:123], a[92:95], v[88:91], v[120:123]
    s_waitcnt lgkmcnt(2)
    v_mfma_f32_16x16x32_bf16 v[108:111], a[16:19], v[92:95], v[108:111]
    ds_read_b128 v[84:87], v11 offset:12288
    v_mfma_f32_16x16x32_bf16 v[112:115], a[16:19], v[96:99], v[112:115]
    ds_read_b128 v[88:91], v11 offset:14336
    v_mfma_f32_16x16x32_bf16 v[116:119], a[96:99], v[92:95], v[116:119]
    buffer_load_dwordx4 v10, s[24:27], s46 offen offset:512 lds
    s_add_u32 m0, m0, 3968
    v_mfma_f32_16x16x32_bf16 v[120:123], a[96:99], v[96:99], v[120:123]
    s_waitcnt lgkmcnt(2)
    v_mfma_f32_16x16x32_bf16 v[108:111], a[20:23], v[100:103], v[108:111]
    ds_read_b128 v[92:95], v12 offset:12288
    v_mfma_f32_16x16x32_bf16 v[112:115], a[20:23], v[104:107], v[112:115]
    ds_read_b128 v[96:99], v12 offset:14336
    v_mfma_f32_16x16x32_bf16 v[116:119], a[100:103], v[100:103], v[116:119]
    s_waitcnt vmcnt(5)
    buffer_store_dword v20, v136, s[4:7], s38 offen sc1
    v_mfma_f32_16x16x32_bf16 v[120:123], a[100:103], v[104:107], v[120:123]
    s_waitcnt lgkmcnt(2)
    v_mfma_f32_16x16x32_bf16 v[108:111], a[24:27], v[84:87], v[108:111]
    ds_read_b128 v[100:103], v11 offset:16384
    v_mfma_f32_16x16x32_bf16 v[112:115], a[24:27], v[88:91], v[112:115]
    ds_read_b128 v[104:107], v11 offset:18432
    v_mfma_f32_16x16x32_bf16 v[116:119], a[104:107], v[84:87], v[116:119]
    buffer_load_dwordx4 v10, s[24:27], s46 offen offset:640 lds
    s_add_u32 m0, m0, 3968
    v_mfma_f32_16x16x32_bf16 v[120:123], a[104:107], v[88:91], v[120:123]
    s_waitcnt lgkmcnt(2)
    v_mfma_f32_16x16x32_bf16 v[108:111], a[28:31], v[92:95], v[108:111]
    ds_read_b128 v[84:87], v12 offset:16384
    v_mfma_f32_16x16x32_bf16 v[112:115], a[28:31], v[96:99], v[112:115]
    ds_read_b128 v[88:91], v12 offset:18432
    v_mfma_f32_16x16x32_bf16 v[116:119], a[108:111], v[92:95], v[116:119]
    buffer_load_dwordx4 v10, s[24:27], s46 offen offset:768 lds
    s_add_u32 m0, m0, 3968
    v_mfma_f32_16x16x32_bf16 v[120:123], a[108:111], v[96:99], v[120:123]
    s_waitcnt lgkmcnt(2)
    v_mfma_f32_16x16x32_bf16 v[108:111], a[32:35], v[100:103], v[108:111]
    ds_read_b128 v[92:95], v11 offset:20480
    v_mfma_f32_16x16x32_bf16 v[112:115], a[32:35], v[104:107], v[112:115]
    ds_read_b128 v[96:99], v11 offset:22528
    v_mfma_f32_16x16x32_bf16 v[116:119], a[112:115], v[100:103], v[116:119]
    buffer_load_dwordx4 v10, s[24:27], s46 offen offset:896 lds
    s_add_u32 m0, m0, 3968
    v_mfma_f32_16x16x32_bf16 v[120:123], a[112:115], v[104:107], v[120:123]
    s_waitcnt lgkmcnt(2)
    v_mfma_f32_16x16x32_bf16 v[108:111], a[36:39], v[84:87], v[108:111]
    ds_read_b128 v[100:103], v12 offset:20480
    v_mfma_f32_16x16x32_bf16 v[112:115], a[36:39], v[88:91], v[112:115]
    ds_read_b128 v[104:107], v12 offset:22528
    v_mfma_f32_16x16x32_bf16 v[116:119], a[116:119], v[84:87], v[116:119]
    buffer_load_dwordx4 v10, s[24:27], s46 offen offset:1024 lds
    s_add_u32 m0, m0, 3968
    v_mfma_f32_16x16x32_bf16 v[120:123], a[116:119], v[88:91], v[120:123]
    s_waitcnt lgkmcnt(2)
    v_mfma_f32_16x16x32_bf16 v[108:111], a[40:43], v[92:95], v[108:111]
    ds_read_b128 v[84:87], v11 offset:24576
    v_mfma_f32_16x16x32_bf16 v[112:115], a[40:43], v[96:99], v[112:115]
    ds_read_b128 v[88:91], v11 offset:26624
    v_mfma_f32_16x16x32_bf16 v[116:119], a[120:123], v[92:95], v[116:119]
    buffer_load_dwordx4 v10, s[24:27], s46 offen offset:1152 lds
    v_mfma_f32_16x16x32_bf16 v[120:123], a[120:123], v[96:99], v[120:123]
    s_waitcnt lgkmcnt(2)
    v_mfma_f32_16x16x32_bf16 v[108:111], a[44:47], v[100:103], v[108:111]
    ds_read_b128 v[92:95], v12 offset:24576
    v_mfma_f32_16x16x32_bf16 v[112:115], a[44:47], v[104:107], v[112:115]
    ds_read_b128 v[96:99], v12 offset:26624
    v_mfma_f32_16x16x32_bf16 v[116:119], a[124:127], v[100:103], v[116:119]
    v_mfma_f32_16x16x32_bf16 v[120:123], a[124:127], v[104:107], v[120:123]
    s_waitcnt lgkmcnt(2)
    v_mfma_f32_16x16x32_bf16 v[108:111], a[48:51], v[84:87], v[108:111]
    ds_read_b128 v[100:103], v11 offset:28672
    v_mfma_f32_16x16x32_bf16 v[112:115], a[48:51], v[88:91], v[112:115]
    ds_read_b128 v[104:107], v11 offset:30720
    v_mfma_f32_16x16x32_bf16 v[116:119], a[128:131], v[84:87], v[116:119]
    v_mfma_f32_16x16x32_bf16 v[120:123], a[128:131], v[88:91], v[120:123]
    s_waitcnt lgkmcnt(2)
    v_mfma_f32_16x16x32_bf16 v[108:111], a[52:55], v[92:95], v[108:111]
    ds_read_b128 v[84:87], v12 offset:28672
    v_mfma_f32_16x16x32_bf16 v[112:115], a[52:55], v[96:99], v[112:115]
    ds_read_b128 v[88:91], v12 offset:30720
    v_mfma_f32_16x16x32_bf16 v[116:119], a[132:135], v[92:95], v[116:119]
    v_mfma_f32_16x16x32_bf16 v[120:123], a[132:135], v[96:99], v[120:123]
    s_waitcnt lgkmcnt(2)
    v_mfma_f32_16x16x32_bf16 v[108:111], a[56:59], v[100:103], v[108:111]
    ds_read_b128 v[92:95], v11 offset:32768
    v_mfma_f32_16x16x32_bf16 v[112:115], a[56:59], v[104:107], v[112:115]
    ds_read_b128 v[96:99], v11 offset:34816
    v_mfma_f32_16x16x32_bf16 v[116:119], a[136:139], v[100:103], v[116:119]
    v_mfma_f32_16x16x32_bf16 v[120:123], a[136:139], v[104:107], v[120:123]
    s_waitcnt lgkmcnt(2)
    v_mfma_f32_16x16x32_bf16 v[108:111], a[60:63], v[84:87], v[108:111]
    ds_read_b128 v[100:103], v12 offset:32768
    v_mfma_f32_16x16x32_bf16 v[112:115], a[60:63], v[88:91], v[112:115]
    ds_read_b128 v[104:107], v12 offset:34816
    v_mfma_f32_16x16x32_bf16 v[116:119], a[140:143], v[84:87], v[116:119]
    v_mfma_f32_16x16x32_bf16 v[120:123], a[140:143], v[88:91], v[120:123]
    s_waitcnt lgkmcnt(2)
    v_mfma_f32_16x16x32_bf16 v[108:111], a[64:67], v[92:95], v[108:111]
    ds_read_b128 v[84:87], v11 offset:36864
    v_mfma_f32_16x16x32_bf16 v[112:115], a[64:67], v[96:99], v[112:115]
    ds_read_b128 v[88:91], v11 offset:38912
    v_mfma_f32_16x16x32_bf16 v[116:119], a[144:147], v[92:95], v[116:119]
    v_mfma_f32_16x16x32_bf16 v[120:123], a[144:147], v[96:99], v[120:123]
    s_waitcnt lgkmcnt(2)
    v_mfma_f32_16x16x32_bf16 v[108:111], a[68:71], v[100:103], v[108:111]
    ds_read_b128 v[92:95], v12 offset:36864
    v_mfma_f32_16x16x32_bf16 v[112:115], a[68:71], v[104:107], v[112:115]
    ds_read_b128 v[96:99], v12 offset:38912
    v_mfma_f32_16x16x32_bf16 v[116:119], a[148:151], v[100:103], v[116:119]
    v_mfma_f32_16x16x32_bf16 v[120:123], a[148:151], v[104:107], v[120:123]
    s_waitcnt lgkmcnt(0)
    v_mfma_f32_16x16x32_bf16 v[108:111], a[72:75], v[84:87], v[108:111]
    v_add_u32 v11, s49, v11
    v_mfma_f32_16x16x32_bf16 v[112:115], a[72:75], v[88:91], v[112:115]
    v_add_u32 v12, s49, v12
    v_mfma_f32_16x16x32_bf16 v[108:111], a[76:79], v[92:95], v[108:111]
    s_sub_u32 s47, s47, s49
    v_mfma_f32_16x16x32_bf16 v[112:115], a[76:79], v[96:99], v[112:115]
    s_sub_u32 s49, 0, s49
    v_mfma_f32_16x16x32_bf16 v[116:119], a[152:155], v[84:87], v[116:119]
    v_mfma_f32_16x16x32_bf16 v[120:123], a[152:155], v[88:91], v[120:123]
    v_mfma_f32_16x16x32_bf16 v[116:119], a[156:159], v[92:95], v[116:119]
    v_mfma_f32_16x16x32_bf16 v[120:123], a[156:159], v[96:99], v[120:123]
    v_cvt_pk_bf16_f32 v124, v108, v109
    v_cvt_pk_bf16_f32 v125, v110, v111
    v_cvt_pk_bf16_f32 v126, v112, v113
    v_cvt_pk_bf16_f32 v127, v114, v115
    s_nop 0
    v_permlane16_swap_b32 v124, v126
    v_permlane16_swap_b32 v125, v127
    v_cvt_pk_bf16_f32 v128, v116, v117
    v_cvt_pk_bf16_f32 v129, v118, v119
    v_cvt_pk_bf16_f32 v130, v120, v121
    v_cvt_pk_bf16_f32 v131, v122, v123
    s_nop 0
    v_permlane16_swap_b32 v128, v130
    v_permlane16_swap_b32 v129, v131
    buffer_store_dwordx4 v[124:127], v19, s[4:7], s44 offen sc1
    buffer_store_dwordx4 v[128:131], v19, s[4:7], s45 offen sc1
    s_waitcnt vmcnt(2) lgkmcnt(0)
    s_barrier
    s_add_u32 s44, s38, 294912
    s_add_u32 s45, s44, s56
    s_mov_b32 s46, 122880
    v_mov_b32 v20, 2
    ds_read_b128 v[84:87], v11 offset:0
    ds_read_b128 v[88:91], v11 offset:2048
    ds_read_b128 v[92:95], v12 offset:0
    ds_read_b128 v[96:99], v12 offset:2048
    s_lshl_b32 s90, s32, 10
    s_add_u32 m0, s90, s47
    s_waitcnt lgkmcnt(2)
    v_mfma_f32_16x16x32_bf16 v[108:111], a[0:3], v[84:87], 0
    ds_read_b128 v[100:103], v11 offset:4096
    s_add_u32 s51, s37, 3
    v_mfma_f32_16x16x32_bf16 v[112:115], a[0:3], v[88:91], 0
    ds_read_b128 v[104:107], v11 offset:6144
    s_and_b32 s50, s51, 3
    v_mfma_f32_16x16x32_bf16 v[116:119], a[80:83], v[84:87], 0
    buffer_load_dwordx4 v10, s[24:27], s46 offen offset:0 lds
    s_add_u32 m0, m0, 3968
    v_mfma_f32_16x16x32_bf16 v[120:123], a[80:83], v[88:91], 0
    s_waitcnt lgkmcnt(2)
    s_mul_i32 s50, s50, 114688
    v_mfma_f32_16x16x32_bf16 v[108:111], a[4:7], v[92:95], v[108:111]
    ds_read_b128 v[84:87], v12 offset:4096
    s_add_u32 s50, s50, 65536
    v_mfma_f32_16x16x32_bf16 v[112:115], a[4:7], v[96:99], v[112:115]
    ds_read_b128 v[88:91], v12 offset:6144
    s_add_u32 s44, s38, s50
    v_mfma_f32_16x16x32_bf16 v[116:119], a[84:87], v[92:95], v[116:119]
    buffer_load_dwordx4 v10, s[24:27], s46 offen offset:128 lds
    s_add_u32 m0, m0, 3968
    v_mfma_f32_16x16x32_bf16 v[120:123], a[84:87], v[96:99], v[120:123]
    s_waitcnt lgkmcnt(2)
    s_add_u32 s45, s44, s56
    v_mfma_f32_16x16x32_bf16 v[108:111], a[8:11], v[100:103], v[108:111]
    ds_read_b128 v[92:95], v11 offset:8192
    s_add_u32 s37, s37, 1
    v_mfma_f32_16x16x32_bf16 v[112:115], a[8:11], v[104:107], v[112:115]
    ds_read_b128 v[96:99], v11 offset:10240
    s_mov_b32 s52, 0
    v_mfma_f32_16x16x32_bf16 v[116:119], a[88:91], v[100:103], v[116:119]
    buffer_load_dwordx4 v10, s[24:27], s46 offen offset:256 lds
    s_add_u32 m0, m0, 3968
    v_mfma_f32_16x16x32_bf16 v[120:123], a[88:91], v[104:107], v[120:123]
    s_waitcnt lgkmcnt(2)
    s_and_b32 s50, s37, 3
    v_mfma_f32_16x16x32_bf16 v[108:111], a[12:15], v[84:87], v[108:111]
    ds_read_b128 v[100:103], v12 offset:8192
    s_mul_i32 s51, s50, 114688
    v_mfma_f32_16x16x32_bf16 v[112:115], a[12:15], v[88:91], v[112:115]
    ds_read_b128 v[104:107], v12 offset:10240
    s_add_u32 s41, s38, s51
    v_mfma_f32_16x16x32_bf16 v[116:119], a[92:95], v[84:87], v[116:119]
    buffer_load_dwordx4 v10, s[24:27], s46 offen offset:384 lds
    s_add_u32 m0, m0, 3968
    v_mfma_f32_16x16x32_bf16 v[120:123], a[92:95], v[88:91], v[120:123]
    s_waitcnt lgkmcnt(2)
    v_mfma_f32_16x16x32_bf16 v[108:111], a[16:19], v[92:95], v[108:111]
    ds_read_b128 v[84:87], v11 offset:12288
    v_mfma_f32_16x16x32_bf16 v[112:115], a[16:19], v[96:99], v[112:115]
    ds_read_b128 v[88:91], v11 offset:14336
    v_mfma_f32_16x16x32_bf16 v[116:119], a[96:99], v[92:95], v[116:119]
    buffer_load_dwordx4 v10, s[24:27], s46 offen offset:512 lds
    s_add_u32 m0, m0, 3968
    v_mfma_f32_16x16x32_bf16 v[120:123], a[96:99], v[96:99], v[120:123]
    s_waitcnt lgkmcnt(2)
    v_mfma_f32_16x16x32_bf16 v[108:111], a[20:23], v[100:103], v[108:111]
    ds_read_b128 v[92:95], v12 offset:12288
    v_mfma_f32_16x16x32_bf16 v[112:115], a[20:23], v[104:107], v[112:115]
    ds_read_b128 v[96:99], v12 offset:14336
    v_mfma_f32_16x16x32_bf16 v[116:119], a[100:103], v[100:103], v[116:119]
    s_waitcnt vmcnt(5)
    buffer_store_dword v20, v136, s[4:7], s38 offen sc1
    v_mfma_f32_16x16x32_bf16 v[120:123], a[100:103], v[104:107], v[120:123]
    s_waitcnt lgkmcnt(2)
    v_mfma_f32_16x16x32_bf16 v[108:111], a[24:27], v[84:87], v[108:111]
    ds_read_b128 v[100:103], v11 offset:16384
    v_mfma_f32_16x16x32_bf16 v[112:115], a[24:27], v[88:91], v[112:115]
    ds_read_b128 v[104:107], v11 offset:18432
    v_mfma_f32_16x16x32_bf16 v[116:119], a[104:107], v[84:87], v[116:119]
    buffer_load_dwordx4 v10, s[24:27], s46 offen offset:640 lds
    s_add_u32 m0, m0, 3968
    v_mfma_f32_16x16x32_bf16 v[120:123], a[104:107], v[88:91], v[120:123]
    s_waitcnt lgkmcnt(2)
    v_mfma_f32_16x16x32_bf16 v[108:111], a[28:31], v[92:95], v[108:111]
    ds_read_b128 v[84:87], v12 offset:16384
    v_mfma_f32_16x16x32_bf16 v[112:115], a[28:31], v[96:99], v[112:115]
    ds_read_b128 v[88:91], v12 offset:18432
    v_mfma_f32_16x16x32_bf16 v[116:119], a[108:111], v[92:95], v[116:119]
    buffer_load_dwordx4 v10, s[24:27], s46 offen offset:768 lds
    s_add_u32 m0, m0, 3968
    v_mfma_f32_16x16x32_bf16 v[120:123], a[108:111], v[96:99], v[120:123]
    s_waitcnt lgkmcnt(2)
    v_mfma_f32_16x16x32_bf16 v[108:111], a[32:35], v[100:103], v[108:111]
    ds_read_b128 v[92:95], v11 offset:20480
    v_mfma_f32_16x16x32_bf16 v[112:115], a[32:35], v[104:107], v[112:115]
    ds_read_b128 v[96:99], v11 offset:22528
    v_mfma_f32_16x16x32_bf16 v[116:119], a[112:115], v[100:103], v[116:119]
    buffer_load_dwordx4 v10, s[24:27], s46 offen offset:896 lds
    s_add_u32 m0, m0, 3968
    v_mfma_f32_16x16x32_bf16 v[120:123], a[112:115], v[104:107], v[120:123]
    s_waitcnt lgkmcnt(2)
    v_mfma_f32_16x16x32_bf16 v[108:111], a[36:39], v[84:87], v[108:111]
    ds_read_b128 v[100:103], v12 offset:20480
    v_mfma_f32_16x16x32_bf16 v[112:115], a[36:39], v[88:91], v[112:115]
    ds_read_b128 v[104:107], v12 offset:22528
    v_mfma_f32_16x16x32_bf16 v[116:119], a[116:119], v[84:87], v[116:119]
    buffer_load_dwordx4 v10, s[24:27], s46 offen offset:1024 lds
    s_add_u32 m0, m0, 3968
    v_mfma_f32_16x16x32_bf16 v[120:123], a[116:119], v[88:91], v[120:123]
    s_waitcnt lgkmcnt(2)
    v_mfma_f32_16x16x32_bf16 v[108:111], a[40:43], v[92:95], v[108:111]
    ds_read_b128 v[84:87], v11 offset:24576
    v_mfma_f32_16x16x32_bf16 v[112:115], a[40:43], v[96:99], v[112:115]
    ds_read_b128 v[88:91], v11 offset:26624
    v_mfma_f32_16x16x32_bf16 v[116:119], a[120:123], v[92:95], v[116:119]
    buffer_load_dwordx4 v10, s[24:27], s46 offen offset:1152 lds
    v_mfma_f32_16x16x32_bf16 v[120:123], a[120:123], v[96:99], v[120:123]
    s_waitcnt lgkmcnt(2)
    v_mfma_f32_16x16x32_bf16 v[108:111], a[44:47], v[100:103], v[108:111]
    ds_read_b128 v[92:95], v12 offset:24576
    v_mfma_f32_16x16x32_bf16 v[112:115], a[44:47], v[104:107], v[112:115]
    ds_read_b128 v[96:99], v12 offset:26624
    v_mfma_f32_16x16x32_bf16 v[116:119], a[124:127], v[100:103], v[116:119]
    v_mfma_f32_16x16x32_bf16 v[120:123], a[124:127], v[104:107], v[120:123]
    s_waitcnt lgkmcnt(2)
    v_mfma_f32_16x16x32_bf16 v[108:111], a[48:51], v[84:87], v[108:111]
    ds_read_b128 v[100:103], v11 offset:28672
    v_mfma_f32_16x16x32_bf16 v[112:115], a[48:51], v[88:91], v[112:115]
    ds_read_b128 v[104:107], v11 offset:30720
    v_mfma_f32_16x16x32_bf16 v[116:119], a[128:131], v[84:87], v[116:119]
    v_mfma_f32_16x16x32_bf16 v[120:123], a[128:131], v[88:91], v[120:123]
    s_waitcnt lgkmcnt(2)
    v_mfma_f32_16x16x32_bf16 v[108:111], a[52:55], v[92:95], v[108:111]
    ds_read_b128 v[84:87], v12 offset:28672
    v_mfma_f32_16x16x32_bf16 v[112:115], a[52:55], v[96:99], v[112:115]
    ds_read_b128 v[88:91], v12 offset:30720
    v_mfma_f32_16x16x32_bf16 v[116:119], a[132:135], v[92:95], v[116:119]
    v_mfma_f32_16x16x32_bf16 v[120:123], a[132:135], v[96:99], v[120:123]
    s_waitcnt lgkmcnt(2)
    v_mfma_f32_16x16x32_bf16 v[108:111], a[56:59], v[100:103], v[108:111]
    ds_read_b128 v[92:95], v11 offset:32768
    v_mfma_f32_16x16x32_bf16 v[112:115], a[56:59], v[104:107], v[112:115]
    ds_read_b128 v[96:99], v11 offset:34816
    v_mfma_f32_16x16x32_bf16 v[116:119], a[136:139], v[100:103], v[116:119]
    v_mfma_f32_16x16x32_bf16 v[120:123], a[136:139], v[104:107], v[120:123]
    s_waitcnt lgkmcnt(2)
    v_mfma_f32_16x16x32_bf16 v[108:111], a[60:63], v[84:87], v[108:111]
    ds_read_b128 v[100:103], v12 offset:32768
    v_mfma_f32_16x16x32_bf16 v[112:115], a[60:63], v[88:91], v[112:115]
    ds_read_b128 v[104:107], v12 offset:34816
    v_mfma_f32_16x16x32_bf16 v[116:119], a[140:143], v[84:87], v[116:119]
    v_mfma_f32_16x16x32_bf16 v[120:123], a[140:143], v[88:91], v[120:123]
    s_waitcnt lgkmcnt(2)
    v_mfma_f32_16x16x32_bf16 v[108:111], a[64:67], v[92:95], v[108:111]
    ds_read_b128 v[84:87], v11 offset:36864
    v_mfma_f32_16x16x32_bf16 v[112:115], a[64:67], v[96:99], v[112:115]
    ds_read_b128 v[88:91], v11 offset:38912
    v_mfma_f32_16x16x32_bf16 v[116:119], a[144:147], v[92:95], v[116:119]
    v_mfma_f32_16x16x32_bf16 v[120:123], a[144:147], v[96:99], v[120:123]
    s_waitcnt lgkmcnt(2)
    v_mfma_f32_16x16x32_bf16 v[108:111], a[68:71], v[100:103], v[108:111]
    ds_read_b128 v[92:95], v12 offset:36864
    v_mfma_f32_16x16x32_bf16 v[112:115], a[68:71], v[104:107], v[112:115]
    ds_read_b128 v[96:99], v12 offset:38912
    v_mfma_f32_16x16x32_bf16 v[116:119], a[148:151], v[100:103], v[116:119]
    v_mfma_f32_16x16x32_bf16 v[120:123], a[148:151], v[104:107], v[120:123]
    s_waitcnt lgkmcnt(0)
    v_mfma_f32_16x16x32_bf16 v[108:111], a[72:75], v[84:87], v[108:111]
    v_add_u32 v11, s49, v11
    v_mfma_f32_16x16x32_bf16 v[112:115], a[72:75], v[88:91], v[112:115]
    v_add_u32 v12, s49, v12
    v_mfma_f32_16x16x32_bf16 v[108:111], a[76:79], v[92:95], v[108:111]
    s_sub_u32 s47, s47, s49
    v_mfma_f32_16x16x32_bf16 v[112:115], a[76:79], v[96:99], v[112:115]
    s_sub_u32 s49, 0, s49
    v_mfma_f32_16x16x32_bf16 v[116:119], a[152:155], v[84:87], v[116:119]
    v_mfma_f32_16x16x32_bf16 v[120:123], a[152:155], v[88:91], v[120:123]
    v_mfma_f32_16x16x32_bf16 v[116:119], a[156:159], v[92:95], v[116:119]
    v_mfma_f32_16x16x32_bf16 v[120:123], a[156:159], v[96:99], v[120:123]
    v_cvt_pk_bf16_f32 v124, v108, v109
    v_cvt_pk_bf16_f32 v125, v110, v111
    v_cvt_pk_bf16_f32 v126, v112, v113
    v_cvt_pk_bf16_f32 v127, v114, v115
    s_nop 0
    v_permlane16_swap_b32 v124, v126
    v_permlane16_swap_b32 v125, v127
    v_cvt_pk_bf16_f32 v128, v116, v117
    v_cvt_pk_bf16_f32 v129, v118, v119
    v_cvt_pk_bf16_f32 v130, v120, v121
    v_cvt_pk_bf16_f32 v131, v122, v123
    s_nop 0
    v_permlane16_swap_b32 v128, v130
    v_permlane16_swap_b32 v129, v131
    buffer_store_dwordx4 v[124:127], v19, s[4:7], s44 offen sc1
    buffer_store_dwordx4 v[128:131], v19, s[4:7], s45 offen sc1
    s_add_u32 s50, s37, 2
    s_and_b32 s50, s50, 3
    s_mul_i32 s50, s50, 114688
    s_add_u32 s42, s38, s50
    s_add_u32 s50, s37, 4
    s_min_u32 s50, s50, 63
    s_mul_i32 s46, s50, 40960
    s_add_u32 s51, s37, 1
    v_mov_b32 v20, s51
    s_mov_b32 m0, s48
    v_mov_b32 v68, 0
    v_mov_b32 v69, 0
    v_mov_b32 v70, 0
    v_mov_b32 v71, 0
    v_mov_b32 v72, 0
    v_mov_b32 v73, 0
    v_mov_b32 v74, 0
    v_mov_b32 v75, 0
    s_add_u32 s50, s37, 6
    s_min_u32 s50, s50, 63
    s_mul_i32 s57, s50, 40960
    s_and_b32 s50, s37, 3
    s_mul_i32 s51, s50, 40960
    s_add_u32 s43, s51, s38
    s_mul_i32 s51, s50, 327680
    s_add_u32 s53, s51, 4194304
    s_xor_b32 s50, s50, 2
    s_mul_i32 s51, s50, 327680
    s_add_u32 s54, s51, 4194304
    s_sub_u32 s51, s37, 6
    s_mul_i32 s60, s51, 81920
    s_branch L_v_first_s
L_v_loop_s:
    s_add_u32 s50, s37, 2
    s_and_b32 s50, s50, 3
    s_mul_i32 s50, s50, 114688
    s_add_u32 s42, s38, s50
    s_add_u32 s50, s37, 4
    s_min_u32 s50, s50, 63
    s_mul_i32 s46, s50, 40960
    s_add_u32 s51, s37, 1
    v_mov_b32 v20, s51
    s_mov_b32 m0, s48
    v_mov_b32 v68, 0
    v_mov_b32 v69, 0
    v_mov_b32 v70, 0
    v_mov_b32 v71, 0
    v_mov_b32 v72, 0
    v_mov_b32 v73, 0
    v_mov_b32 v74, 0
    v_mov_b32 v75, 0
    s_add_u32 s50, s37, 6
    s_min_u32 s50, s50, 63
    s_mul_i32 s57, s50, 40960
    s_and_b32 s50, s37, 3
    s_mul_i32 s51, s50, 40960
    s_add_u32 s43, s51, s38
    s_mul_i32 s51, s50, 327680
    s_add_u32 s53, s51, 4194304
    s_xor_b32 s50, s50, 2
    s_mul_i32 s51, s50, 327680
    s_add_u32 s54, s51, 4194304
    s_sub_u32 s51, s37, 6
    s_mul_i32 s60, s51, 81920
L_vg_84:
    buffer_load_dword v139, v138, s[4:7], s38 offen sc1
    s_sub_u32 s36, s36, 1
    s_cbranch_scc1 L_exit
    s_waitcnt vmcnt(0)
    v_cmp_gt_u32 vcc, s37, v139
    s_cbranch_vccnz L_vg_84
L_v_first_s:
    buffer_load_dwordx4 v13, s[4:7], s41 offen sc1 lds
    buffer_load_dwordx4 v13, s[4:7], s41 offen offset:1024 sc1 lds
    buffer_load_dword v14, s[4:7], s41 offen offset:2048 sc1 lds
    buffer_load_dword v14, s[4:7], s41 offen offset:2304 sc1 lds
L_poll_86:
    buffer_load_dwordx4 v13, s[4:7], s41 offen sc1 lds
    buffer_load_dwordx4 v13, s[4:7], s41 offen offset:1024 sc1 lds
    buffer_load_dword v14, s[4:7], s41 offen offset:2048 sc1 lds
    buffer_load_dword v14, s[4:7], s41 offen offset:2304 sc1 lds
    s_sub_u32 s36, s36, 1
    s_cbranch_scc1 L_exit
    s_waitcnt vmcnt(4)
    ds_read_b32 v18, v15
    s_waitcnt lgkmcnt(0)
    v_cmp_eq_u32 vcc, -1, v18
    s_cbranch_vccnz L_poll_86
    s_barrier
    ds_read_b128 v[28:31], v16 offset:0
    ds_read_b128 v[32:35], v16 offset:1024
    ds_read_b128 v[36:39], v16 offset:2048
    ds_read_b128 v[40:43], v16 offset:3072
    s_waitcnt lgkmcnt(3)
    v_smfmac_f32_16x16x64_bf16 v[68:71], v[28:31], a[0:7], v17
    ds_read_b128 v[44:47], v16 offset:4096
    v_smfmac_f32_16x16x64_bf16 v[72:75], v[28:31], a[80:87], v17
    ds_read_b128 v[48:51], v16 offset:5120
    s_waitcnt lgkmcnt(4)
    v_smfmac_f32_16x16x64_bf16 v[68:71], v[32:35], a[8:15], v17
    ds_read_b128 v[52:55], v16 offset:6144
    v_smfmac_f32_16x16x64_bf16 v[72:75], v[32:35], a[88:95], v17
    ds_read_b128 v[56:59], v16 offset:7168
    s_waitcnt lgkmcnt(5)
    v_smfmac_f32_16x16x64_bf16 v[68:71], v[36:39], a[16:23], v17
    ds_read_b128 v[60:63], v16 offset:8192
    v_smfmac_f32_16x16x64_bf16 v[72:75], v[36:39], a[96:103], v17
    ds_read_b128 v[64:67], v16 offset:9216
    s_waitcnt lgkmcnt(6)
    v_smfmac_f32_16x16x64_bf16 v[68:71], v[40:43], a[24:31], v17
    v_smfmac_f32_16x16x64_bf16 v[72:75], v[40:43], a[104:111], v17
    s_waitcnt lgkmcnt(5)
    v_smfmac_f32_16x16x64_bf16 v[68:71], v[44:47], a[32:39], v17
    v_smfmac_f32_16x16x64_bf16 v[72:75], v[44:47], a[112:119], v17
    s_waitcnt lgkmcnt(4)
    v_smfmac_f32_16x16x64_bf16 v[68:71], v[48:51], a[40:47], v17
    s_waitcnt lgkmcnt(3)
    v_smfmac_f32_16x16x64_bf16 v[68:71], v[52:55], a[48:55], v17
    s_waitcnt lgkmcnt(2)
    v_smfmac_f32_16x16x64_bf16 v[68:71], v[56:59], a[56:63], v17
    s_waitcnt lgkmcnt(1)
    v_smfmac_f32_16x16x64_bf16 v[68:71], v[60:63], a[64:71], v17
    s_waitcnt lgkmcnt(0)
    v_smfmac_f32_16x16x64_bf16 v[68:71], v[64:67], a[72:79], v17
L_redo_85:
    v_smfmac_f32_16x16x64_bf16 v[72:75], v[48:51], a[120:127], v17
    v_smfmac_f32_16x16x64_bf16 v[72:75], v[52:55], a[128:135], v17
    buffer_store_dword v20, v21, s[4:7], s38 offen offset:0 sc1
    v_smfmac_f32_16x16x64_bf16 v[72:75], v[56:59], a[136:143], v17
    v_add_f32 v68, v68, v70
    v_add_f32 v69, v69, v71
    v_smfmac_f32_16x16x64_bf16 v[72:75], v[60:63], a[144:151], v17
    v_cmp_u_f32 vcc, v68, v69
    v_cvt_pk_bf16_f32 v132, v68, v69
    v_smfmac_f32_16x16x64_bf16 v[72:75], v[64:67], a[152:159], v17
    s_cbranch_vccnz L_nan_87
L_cont_88:
    buffer_store_dword v132, v134, s[4:7], s41 offen offset:0 sc1
    s_nop 5
    v_pk_add_f32 v[72:73], v[72:73], v[74:75]
    v_cvt_pk_bf16_f32 v133, v72, v73
    buffer_store_dword v133, v134, s[4:7], s41 offen offset:1024 sc1
    ds_read_b128 v[84:87], v11 offset:0
    ds_read_b128 v[88:91], v11 offset:2048
    ds_read_b128 v[92:95], v12 offset:0
    ds_read_b128 v[96:99], v12 offset:2048
    s_cmp_eq_u32 s37, 63
    s_cbranch_scc1 L_end_89
    s_cmp_eq_u32 s37, 0
    s_cbranch_scc1 L_sd_90c
L_sd_90:
    s_cmp_eq_u32 s40, 0
    s_cbranch_scc1 L_an_91
    s_barrier
    s_lshl_b32 s90, s32, 10
    s_add_u32 m0, s90, s47
    s_waitcnt lgkmcnt(2)
    v_mfma_f32_16x16x32_bf16 v[108:111], a[0:3], v[84:87], 0
    ds_read_b128 v[100:103], v11 offset:4096
    s_add_u32 s51, s37, 3
    v_mfma_f32_16x16x32_bf16 v[112:115], a[0:3], v[88:91], 0
    ds_read_b128 v[104:107], v11 offset:6144
    s_and_b32 s50, s51, 3
    v_mfma_f32_16x16x32_bf16 v[116:119], a[80:83], v[84:87], 0
    buffer_load_dwordx4 v[148:151], v146, s[4:7], s43 offen offset:0 sc1
    buffer_load_dwordx4 v[152:155], v146, s[4:7], s43 offen offset:1024 sc1
    v_mfma_f32_16x16x32_bf16 v[120:123], a[80:83], v[88:91], 0
    s_waitcnt lgkmcnt(2)
    s_mul_i32 s50, s50, 114688
    v_mfma_f32_16x16x32_bf16 v[108:111], a[4:7], v[92:95], v[108:111]
    ds_read_b128 v[84:87], v12 offset:4096
    s_add_u32 s50, s50, 65536
    v_mfma_f32_16x16x32_bf16 v[112:115], a[4:7], v[96:99], v[112:115]
    ds_read_b128 v[88:91], v12 offset:6144
    s_add_u32 s44, s38, s50
    v_mfma_f32_16x16x32_bf16 v[116:119], a[84:87], v[92:95], v[116:119]
    s_cmp_lt_i32 s60, 0
    s_cselect_b32 s54, s38, s54
    buffer_load_dwordx4 v[156:159], v144, s[4:7], s54 offen offset:0 sc1
    buffer_load_dwordx4 v[160:163], v144, s[4:7], s54 offen offset:1024 sc1
    v_mfma_f32_16x16x32_bf16 v[120:123], a[84:87], v[96:99], v[120:123]
    s_waitcnt lgkmcnt(2)
    s_add_u32 s45, s44, s56
    v_mfma_f32_16x16x32_bf16 v[108:111], a[8:11], v[100:103], v[108:111]
    ds_read_b128 v[92:95], v11 offset:8192
    s_add_u32 s37, s37, 1
    v_mfma_f32_16x16x32_bf16 v[112:115], a[8:11], v[104:107], v[112:115]
    ds_read_b128 v[96:99], v11 offset:10240
    s_mov_b32 s52, 0
    v_mfma_f32_16x16x32_bf16 v[116:119], a[88:91], v[100:103], v[116:119]
    s_and_b32 s50, s37, 3
    s_mul_i32 s51, s50, 114688
    v_mfma_f32_16x16x32_bf16 v[120:123], a[88:91], v[104:107], v[120:123]
    s_waitcnt lgkmcnt(2)
    s_add_u32 s41, s38, s51
    v_mfma_f32_16x16x32_bf16 v[108:111], a[12:15], v[84:87], v[108:111]
    ds_read_b128 v[100:103], v12 offset:8192
    v_mfma_f32_16x16x32_bf16 v[112:115], a[12:15], v[88:91], v[112:115]
    ds_read_b128 v[104:107], v12 offset:10240
    v_mfma_f32_16x16x32_bf16 v[116:119], a[92:95], v[84:87], v[116:119]
    buffer_load_dwordx4 v[248:251], v137, s[24:27], s57 offen offset:0
    buffer_load_dwordx4 v[248:251], v137, s[24:27], s57 offen offset:1024
    v_mfma_f32_16x16x32_bf16 v[120:123], a[92:95], v[88:91], v[120:123]
    s_waitcnt lgkmcnt(2)
    v_mfma_f32_16x16x32_bf16 v[108:111], a[16:19], v[92:95], v[108:111]
    ds_read_b128 v[84:87], v11 offset:12288
    v_mfma_f32_16x16x32_bf16 v[112:115], a[16:19], v[96:99], v[112:115]
    ds_read_b128 v[88:91], v11 offset:14336
    v_mfma_f32_16x16x32_bf16 v[116:119], a[96:99], v[92:95], v[116:119]
    v_mfma_f32_16x16x32_bf16 v[120:123], a[96:99], v[96:99], v[120:123]
    s_waitcnt lgkmcnt(2)
    v_mfma_f32_16x16x32_bf16 v[108:111], a[20:23], v[100:103], v[108:111]
    ds_read_b128 v[92:95], v12 offset:12288
    v_mfma_f32_16x16x32_bf16 v[112:115], a[20:23], v[104:107], v[112:115]
    ds_read_b128 v[96:99], v12 offset:14336
    v_mfma_f32_16x16x32_bf16 v[116:119], a[100:103], v[100:103], v[116:119]
    s_waitcnt vmcnt(4)
    s_cmp_lt_i32 s60, -245760
    s_cbranch_scc1 L_fw_92c
L_fw_92:
    buffer_store_dwordx4 v[148:151], v143, s[4:7], s53 offen offset:0 sc1
    buffer_store_dwordx4 v[152:155], v143, s[4:7], s53 offen offset:1024 sc1
    v_mfma_f32_16x16x32_bf16 v[120:123], a[100:103], v[104:107], v[120:123]
    s_waitcnt lgkmcnt(2)
    v_mfma_f32_16x16x32_bf16 v[108:111], a[24:27], v[84:87], v[108:111]
    ds_read_b128 v[100:103], v11 offset:16384
    v_mfma_f32_16x16x32_bf16 v[112:115], a[24:27], v[88:91], v[112:115]
    ds_read_b128 v[104:107], v11 offset:18432
    v_mfma_f32_16x16x32_bf16 v[116:119], a[104:107], v[84:87], v[116:119]
    v_mfma_f32_16x16x32_bf16 v[120:123], a[104:107], v[88:91], v[120:123]
    s_waitcnt lgkmcnt(2)
    v_mfma_f32_16x16x32_bf16 v[108:111], a[28:31], v[92:95], v[108:111]
    ds_read_b128 v[84:87], v12 offset:16384
    v_mfma_f32_16x16x32_bf16 v[112:115], a[28:31], v[96:99], v[112:115]
    ds_read_b128 v[88:91], v12 offset:18432
    v_mfma_f32_16x16x32_bf16 v[116:119], a[108:111], v[92:95], v[116:119]
    buffer_store_dword v22, v135, s[4:7], s42 offen offset:0 sc1
    buffer_store_dword v22, v135, s[4:7], s42 offen offset:1024 sc1
    v_mfma_f32_16x16x32_bf16 v[120:123], a[108:111], v[96:99], v[120:123]
    s_waitcnt lgkmcnt(2)
    v_mfma_f32_16x16x32_bf16 v[108:111], a[32:35], v[100:103], v[108:111]
    ds_read_b128 v[92:95], v11 offset:20480
    v_mfma_f32_16x16x32_bf16 v[112:115], a[32:35], v[104:107], v[112:115]
    ds_read_b128 v[96:99], v11 offset:22528
    v_mfma_f32_16x16x32_bf16 v[116:119], a[112:115], v[100:103], v[116:119]
    buffer_load_dwordx4 v10, s[24:27], s46 offen offset:0 lds
    s_add_u32 m0, m0, 3968
    v_mfma_f32_16x16x32_bf16 v[120:123], a[112:115], v[104:107], v[120:123]
    s_waitcnt lgkmcnt(2)
    v_mfma_f32_16x16x32_bf16 v[108:111], a[36:39], v[84:87], v[108:111]
    ds_read_b128 v[100:103], v12 offset:20480
    v_mfma_f32_16x16x32_bf16 v[112:115], a[36:39], v[88:91], v[112:115]
    ds_read_b128 v[104:107], v12 offset:22528
    v_mfma_f32_16x16x32_bf16 v[116:119], a[116:119], v[84:87], v[116:119]
    buffer_load_dwordx4 v10, s[24:27], s46 offen offset:128 lds
    s_add_u32 m0, m0, 3968
    v_mfma_f32_16x16x32_bf16 v[120:123], a[116:119], v[88:91], v[120:123]
    s_waitcnt lgkmcnt(2)
    v_mfma_f32_16x16x32_bf16 v[108:111], a[40:43], v[92:95], v[108:111]
    ds_read_b128 v[84:87], v11 offset:24576
    v_mfma_f32_16x16x32_bf16 v[112:115], a[40:43], v[96:99], v[112:115]
    ds_read_b128 v[88:91], v11 offset:26624
    v_mfma_f32_16x16x32_bf16 v[116:119], a[120:123], v[92:95], v[116:119]
    buffer_load_dwordx4 v10, s[24:27], s46 offen offset:256 lds
    s_add_u32 m0, m0, 3968
    v_mfma_f32_16x16x32_bf16 v[120:123], a[120:123], v[96:99], v[120:123]
    s_waitcnt lgkmcnt(2)
    v_mfma_f32_16x16x32_bf16 v[108:111], a[44:47], v[100:103], v[108:111]
    ds_read_b128 v[92:95], v12 offset:24576
    v_mfma_f32_16x16x32_bf16 v[112:115], a[44:47], v[104:107], v[112:115]
    ds_read_b128 v[96:99], v12 offset:26624
    v_mfma_f32_16x16x32_bf16 v[116:119], a[124:127], v[100:103], v[116:119]
    buffer_load_dwordx4 v10, s[24:27], s46 offen offset:384 lds
    s_add_u32 m0, m0, 3968
    v_mfma_f32_16x16x32_bf16 v[120:123], a[124:127], v[104:107], v[120:123]
    s_waitcnt lgkmcnt(2)
    v_mfma_f32_16x16x32_bf16 v[108:111], a[48:51], v[84:87], v[108:111]
    ds_read_b128 v[100:103], v11 offset:28672
    v_mfma_f32_16x16x32_bf16 v[112:115], a[48:51], v[88:91], v[112:115]
    ds_read_b128 v[104:107], v11 offset:30720
    v_mfma_f32_16x16x32_bf16 v[116:119], a[128:131], v[84:87], v[116:119]
    buffer_load_dwordx4 v10, s[24:27], s46 offen offset:512 lds
    s_add_u32 m0, m0, 3968
    v_mfma_f32_16x16x32_bf16 v[120:123], a[128:131], v[88:91], v[120:123]
    s_waitcnt lgkmcnt(2)
    v_mfma_f32_16x16x32_bf16 v[108:111], a[52:55], v[92:95], v[108:111]
    ds_read_b128 v[84:87], v12 offset:28672
    v_mfma_f32_16x16x32_bf16 v[112:115], a[52:55], v[96:99], v[112:115]
    ds_read_b128 v[88:91], v12 offset:30720
    v_mfma_f32_16x16x32_bf16 v[116:119], a[132:135], v[92:95], v[116:119]
    buffer_load_dwordx4 v10, s[24:27], s46 offen offset:640 lds
    s_add_u32 m0, m0, 3968
    v_mfma_f32_16x16x32_bf16 v[120:123], a[132:135], v[96:99], v[120:123]
    s_waitcnt lgkmcnt(2)
    v_mfma_f32_16x16x32_bf16 v[108:111], a[56:59], v[100:103], v[108:111]
    ds_read_b128 v[92:95], v11 offset:32768
    v_mfma_f32_16x16x32_bf16 v[112:115], a[56:59], v[104:107], v[112:115]
    ds_read_b128 v[96:99], v11 offset:34816
    v_mfma_f32_16x16x32_bf16 v[116:119], a[136:139], v[100:103], v[116:119]
    buffer_load_dwordx4 v10, s[24:27], s46 offen offset:768 lds
    s_add_u32 m0, m0, 3968
    v_mfma_f32_16x16x32_bf16 v[120:123], a[136:139], v[104:107], v[120:123]
    s_waitcnt lgkmcnt(2)
    v_mfma_f32_16x16x32_bf16 v[108:111], a[60:63], v[84:87], v[108:111]
    ds_read_b128 v[100:103], v12 offset:32768
    v_mfma_f32_16x16x32_bf16 v[112:115], a[60:63], v[88:91], v[112:115]
    ds_read_b128 v[104:107], v12 offset:34816
    v_mfma_f32_16x16x32_bf16 v[116:119], a[140:143], v[84:87], v[116:119]
    buffer_load_dwordx4 v10, s[24:27], s46 offen offset:896 lds
    s_add_u32 m0, m0, 3968
    v_mfma_f32_16x16x32_bf16 v[120:123], a[140:143], v[88:91], v[120:123]
    s_waitcnt lgkmcnt(2)
    v_mfma_f32_16x16x32_bf16 v[108:111], a[64:67], v[92:95], v[108:111]
    ds_read_b128 v[84:87], v11 offset:36864
    v_mfma_f32_16x16x32_bf16 v[112:115], a[64:67], v[96:99], v[112:115]
    ds_read_b128 v[88:91], v11 offset:38912
    v_mfma_f32_16x16x32_bf16 v[116:119], a[144:147], v[92:95], v[116:119]
    buffer_load_dwordx4 v10, s[24:27], s46 offen offset:1024 lds
    s_add_u32 m0, m0, 3968
    v_mfma_f32_16x16x32_bf16 v[120:123], a[144:147], v[96:99], v[120:123]
    s_waitcnt lgkmcnt(2)
    v_mfma_f32_16x16x32_bf16 v[108:111], a[68:71], v[100:103], v[108:111]
    ds_read_b128 v[92:95], v12 offset:36864
    v_mfma_f32_16x16x32_bf16 v[112:115], a[68:71], v[104:107], v[112:115]
    ds_read_b128 v[96:99], v12 offset:38912
    v_mfma_f32_16x16x32_bf16 v[116:119], a[148:151], v[100:103], v[116:119]
    buffer_load_dwordx4 v10, s[24:27], s46 offen offset:1152 lds
    v_mfma_f32_16x16x32_bf16 v[120:123], a[148:151], v[104:107], v[120:123]
    s_waitcnt lgkmcnt(0)
    v_mfma_f32_16x16x32_bf16 v[108:111], a[72:75], v[84:87], v[108:111]
    v_add_u32 v11, s49, v11
    v_mfma_f32_16x16x32_bf16 v[112:115], a[72:75], v[88:91], v[112:115]
    v_add_u32 v12, s49, v12
    v_mfma_f32_16x16x32_bf16 v[108:111], a[76:79], v[92:95], v[108:111]
    s_sub_u32 s47, s47, s49
    v_mfma_f32_16x16x32_bf16 v[112:115], a[76:79], v[96:99], v[112:115]
    s_sub_u32 s49, 0, s49
    v_mfma_f32_16x16x32_bf16 v[116:119], a[152:155], v[84:87], v[116:119]
    v_mfma_f32_16x16x32_bf16 v[120:123], a[152:155], v[88:91], v[120:123]
    v_mfma_f32_16x16x32_bf16 v[116:119], a[156:159], v[92:95], v[116:119]
    v_mfma_f32_16x16x32_bf16 v[120:123], a[156:159], v[96:99], v[120:123]
    v_cvt_pk_bf16_f32 v124, v108, v109
    v_cvt_pk_bf16_f32 v125, v110, v111
    v_cvt_pk_bf16_f32 v126, v112, v113
    v_cvt_pk_bf16_f32 v127, v114, v115
    s_nop 0
    v_permlane16_swap_b32 v124, v126
    v_permlane16_swap_b32 v125, v127
    v_cvt_pk_bf16_f32 v128, v116, v117
    v_cvt_pk_bf16_f32 v129, v118, v119
    v_cvt_pk_bf16_f32 v130, v120, v121
    v_cvt_pk_bf16_f32 v131, v122, v123
    s_nop 0
    v_permlane16_swap_b32 v128, v130
    v_permlane16_swap_b32 v129, v131
    buffer_store_dwordx4 v[124:127], v19, s[4:7], s44 offen sc1
    buffer_store_dwordx4 v[128:131], v19, s[4:7], s45 offen sc1
    s_waitcnt vmcnt(18)
    s_cmp_lt_i32 s60, 0
    s_cbranch_scc1 L_fin_93
    v_mfma_f32_16x16x32_bf16 v[164:167], a[160:163], v[156:159], 0
    v_mfma_f32_16x16x32_bf16 v[168:171], a[160:163], v[160:163], 0
    s_nop 4
    v_cndmask_b32 v166, v164, v165, s[58:59]
    s_nop 1
    v_cndmask_b32 v170, v168, v169, s[58:59]
    v_cndmask_b32 v167, v165, v164, s[58:59]
    v_cndmask_b32 v171, v169, v168, s[58:59]
    s_nop 0
    v_add_f32_dpp v167, v166, v167 row_ror:8 row_mask:0xf bank_mask:0xf
    v_add_f32_dpp v171, v170, v171 row_ror:8 row_mask:0xf bank_mask:0xf
    v_cvt_pk_bf16_f32 v167, v167, v167
    v_cvt_pk_bf16_f32 v171, v171, v171
    buffer_store_short v167, v145, s[28:31], s60 offen offset:0
    buffer_store_short v171, v145, s[28:31], s60 offen offset:32
L_fin_93:
    s_branch L_v_loop_s
L_end_89:
    s_cmp_lt_i32 s60, 0
    s_cselect_b32 s54, s38, s54
    buffer_load_dwordx4 v[156:159], v144, s[4:7], s54 offen offset:0 sc1
    buffer_load_dwordx4 v[160:163], v144, s[4:7], s54 offen offset:1024 sc1
    s_waitcnt vmcnt(0) lgkmcnt(0)
    s_cmp_lt_i32 s60, 0
    s_cbranch_scc1 L_fin_94
    v_mfma_f32_16x16x32_bf16 v[164:167], a[160:163], v[156:159], 0
    v_mfma_f32_16x16x32_bf16 v[168:171], a[160:163], v[160:163], 0
    s_nop 4
    v_cndmask_b32 v166, v164, v165, s[58:59]
    s_nop 1
    v_cndmask_b32 v170, v168, v169, s[58:59]
    v_cndmask_b32 v167, v165, v164, s[58:59]
    v_cndmask_b32 v171, v169, v168, s[58:59]
    s_nop 0
    v_add_f32_dpp v167, v166, v167 row_ror:8 row_mask:0xf bank_mask:0xf
    v_add_f32_dpp v171, v170, v171 row_ror:8 row_mask:0xf bank_mask:0xf
    v_cvt_pk_bf16_f32 v167, v167, v167
    v_cvt_pk_bf16_f32 v171, v171, v171
    buffer_store_short v167, v145, s[28:31], s60 offen offset:0
    buffer_store_short v171, v145, s[28:31], s60 offen offset:32
L_fin_94:
    s_waitcnt vmcnt(0)
    s_cmp_lg_u32 s55, 0
    s_cbranch_scc1 L_wb_95
    buffer_wbl2 sc1
    s_waitcnt vmcnt(0)
L_wb_95:
    s_endpgm
L_nan_87:
    s_cmp_eq_u32 s52, 1
    s_cbranch_scc1 L_cont_88
    v_lshlrev_b32 v1, 4, v0
L_nan_87r:
    s_mov_b32 s90, s41
    v_mov_b32 v2, 0
    buffer_load_dwordx4 v[28:31], v1, s[4:7], s90 offen sc1
    s_add_u32 s90, s90, 1024
    buffer_load_dwordx4 v[32:35], v1, s[4:7], s90 offen sc1
    s_add_u32 s90, s90, 1024
    buffer_load_dwordx4 v[36:39], v1, s[4:7], s90 offen sc1
    s_add_u32 s90, s90, 1024
    buffer_load_dwordx4 v[40:43], v1, s[4:7], s90 offen sc1
    s_add_u32 s90, s90, 1024
    buffer_load_dwordx4 v[44:47], v1, s[4:7], s90 offen sc1
    s_add_u32 s90, s90, 1024
    buffer_load_dwordx4 v[48:51], v1, s[4:7], s90 offen sc1
    s_add_u32 s90, s90, 1024
    buffer_load_dwordx4 v[52:55], v1, s[4:7], s90 offen sc1
    s_add_u32 s90, s90, 1024
    buffer_load_dwordx4 v[56:59], v1, s[4:7], s90 offen sc1
    s_add_u32 s90, s90, 1024
    buffer_load_dwordx4 v[60:63], v1, s[4:7], s90 offen sc1
    s_add_u32 s90, s90, 1024
    buffer_load_dwordx4 v[64:67], v1, s[4:7], s90 offen sc1
    s_add_u32 s90, s90, 1024
    s_sub_u32 s36, s36, 1
    s_cbranch_scc1 L_exit
    s_waitcnt vmcnt(0) lgkmcnt(0)
    v_max3_u32 v2, v2, v28, v29
    v_max3_u32 v2, v2, v30, v31
    v_max3_u32 v2, v2, v32, v33
    v_max3_u32 v2, v2, v34, v35
    v_max3_u32 v2, v2, v36, v37
    v_max3_u32 v2, v2, v38, v39
    v_max3_u32 v2, v2, v40, v41
    v_max3_u32 v2, v2, v42, v43
    v_max3_u32 v2, v2, v44, v45
    v_max3_u32 v2, v2, v46, v47
    v_max3_u32 v2, v2, v48, v49
    v_max3_u32 v2, v2, v50, v51
    v_max3_u32 v2, v2, v52, v53
    v_max3_u32 v2, v2, v54, v55
    v_max3_u32 v2, v2, v56, v57
    v_max3_u32 v2, v2, v58, v59
    v_max3_u32 v2, v2, v60, v61
    v_max3_u32 v2, v2, v62, v63
    v_max3_u32 v2, v2, v64, v65
    v_max3_u32 v2, v2, v66, v67
    v_cmp_eq_u32 vcc, -1, v2
    s_cbranch_vccnz L_nan_87r
    s_mov_b32 s52, 1
    v_mov_b32 v68, 0
    v_mov_b32 v69, 0
    v_mov_b32 v70, 0
    v_mov_b32 v71, 0
    v_mov_b32 v72, 0
    v_mov_b32 v73, 0
    v_mov_b32 v74, 0
    v_mov_b32 v75, 0
    v_smfmac_f32_16x16x64_bf16 v[68:71], v[28:31], a[0:7], v17
    s_nop 0
    v_smfmac_f32_16x16x64_bf16 v[72:75], v[28:31], a[80:87], v17
    v_smfmac_f32_16x16x64_bf16 v[68:71], v[32:35], a[8:15], v17
    v_smfmac_f32_16x16x64_bf16 v[72:75], v[32:35], a[88:95], v17
    v_smfmac_f32_16x16x64_bf16 v[68:71], v[36:39], a[16:23], v17
    v_smfmac_f32_16x16x64_bf16 v[72:75], v[36:39], a[96:103], v17
    v_smfmac_f32_16x16x64_bf16 v[68:71], v[40:43], a[24:31], v17
    v_smfmac_f32_16x16x64_bf16 v[72:75], v[40:43], a[104:111], v17
    v_smfmac_f32_16x16x64_bf16 v[68:71], v[44:47], a[32:39], v17
    v_smfmac_f32_16x16x64_bf16 v[72:75], v[44:47], a[112:119], v17
    v_smfmac_f32_16x16x64_bf16 v[68:71], v[48:51], a[40:47], v17
    v_smfmac_f32_16x16x64_bf16 v[68:71], v[52:55], a[48:55], v17
    v_smfmac_f32_16x16x64_bf16 v[68:71], v[56:59], a[56:63], v17
    v_smfmac_f32_16x16x64_bf16 v[68:71], v[60:63], a[64:71], v17
    v_smfmac_f32_16x16x64_bf16 v[68:71], v[64:67], a[72:79], v17
    s_nop 2
    s_branch L_redo_85
L_wo_s:
    s_mov_b32 s12, s80
    s_and_b32 s13, s81, 0xffff
    s_mov_b32 s14, 7864320
    s_mov_b32 s15, 0x20000
    s_mov_b32 s16, s72
    s_and_b32 s17, s73, 0xffff
    s_mov_b32 s18, 10240
    s_mov_b32 s19, 0x20000
    s_sub_u32 s40, s35, 18
    v_and_b32 v1, 15, v0
    v_lshrrev_b32 v2, 4, v0
    v_lshrrev_b32 v3, 3, v0
    v_and_b32 v4, 7, v0
    v_and_b32 v6, 2, v3
    v_xor_b32 v6, v6, v4
    v_lshlrev_b32 v6, 4, v6
    v_mul_u32_u24 v7, 1280, v3
    s_lshl_b32 s90, s34, 2
    s_add_u32 s90, s90, s32
    s_mul_i32 s90, s90, 245760
    s_lshl_b32 s91, s40, 7
    s_add_u32 s90, s90, s91
    v_add3_u32 v180, v6, v7, s90
    v_xor_b32 v181, 64, v180
    s_mul_i32 s90, s40, 32768
    s_lshl_b32 s91, s32, 11
    s_add_u32 s90, s90, s91
    s_lshl_b32 s91, s34, 8
    s_add_u32 s90, s90, s91
    v_and_b32 v7, 7, v1
    v_lshlrev_b32 v7, 3, v7
    v_lshl_add_u32 v7, v2, 6, v7
    v_lshrrev_b32 v6, 3, v1
    v_lshl_add_u32 v7, v6, 13, v7
    v_add_u32 v14, s90, v7
    v_lshlrev_b32 v6, 4, v1
    v_lshlrev_b32 v12, 4, v0
    v_lshlrev_b32 v13, 2, v0
    v_add_u32 v46, s90, v13
    s_lshl_b32 s92, s40, 7
    s_lshl_b32 s93, s32, 2
    s_add_u32 s92, s92, s93
    s_add_u32 s92, s92, 460800
    v_mov_b32 v244, s92
    v_cmp_eq_u32 vcc, 0, v0
    v_mov_b32 v9, 2146435072
    s_nop 0
    v_cndmask_b32 v244, v9, v244, vcc
    s_lshl_b32 s92, s40, 4
    s_add_u32 s92, s92, s93
    s_add_u32 s92, s92, 460544
    v_mov_b32 v45, s92
    v_cndmask_b32 v45, v9, v45, vcc
    s_lshl_b32 s92, s32, 7
    s_add_u32 s92, s92, 462336
    v_min_u32 v3, 5, v0
    v_lshl_add_u32 v245, v3, 2, s92
    s_lshl_b32 s90, s40, 2
    s_add_u32 s90, s90, s32
    s_lshl_b32 s91, s90, 8
    v_add_u32 v17, s91, v6
    v_cmp_eq_u32 vcc, 0, v2
    v_mov_b32 v9, 2146435072
    s_nop 0
    v_cndmask_b32 v17, v9, v17, vcc
    v_lshrrev_b32 v3, 2, v1
    v_and_b32 v7, 1, v1
    v_lshl_or_b32 v4, v3, 1, v7
    v_mul_u32_u24 v4, 1280, v4
    v_and_b32 v5, 2, v1
    v_lshl_add_u32 v4, v5, 1, v4
    s_lshl_b32 s91, s90, 5
    v_add_u32 v4, s91, v4
    v_lshlrev_b32 v6, 6, v3
    v_lshl_add_u32 v6, v7, 5, v6
    v_lshl_add_u32 v6, v2, 3, v6
    v_lshl_add_u32 v6, v5, 1, v6
    s_mul_i32 s92, s32, 1152
    s_add_u32 s92, s92, 122880
    v_add_u32 v18, s92, v6
    buffer_load_dword v164, v4, s[16:19], 0 offen offset:0
    buffer_load_dword v165, v4, s[16:19], 0 offen offset:8
    buffer_load_dword v166, v4, s[16:19], 0 offen offset:16
    buffer_load_dword v167, v4, s[16:19], 0 offen offset:24
    v_mov_b32 v168, -1
    v_mov_b32 v169, -1
    v_mov_b32 v170, -1
    v_mov_b32 v171, -1
    s_mul_i32 s90, s32, 24576
    s_mov_b32 m0, s90
    s_mov_b32 s91, 0
    buffer_load_dwordx4 v180, s[12:15], s91 offen nt lds
    s_add_u32 m0, m0, 1024
    s_add_u32 s91, s91, 10240
    buffer_load_dwordx4 v181, s[12:15], s91 offen nt lds
    s_add_u32 m0, m0, 1024
    s_add_u32 s91, s91, 10240
    buffer_load_dwordx4 v180, s[12:15], s91 offen nt lds
    s_add_u32 m0, m0, 1024
    s_add_u32 s91, s91, 10240
    buffer_load_dwordx4 v181, s[12:15], s91 offen nt lds
    s_add_u32 m0, m0, 1024
    s_add_u32 s91, s91, 10240
    buffer_load_dwordx4 v180, s[12:15], s91 offen nt lds
    s_add_u32 m0, m0, 1024
    s_add_u32 s91, s91, 10240
    buffer_load_dwordx4 v181, s[12:15], s91 offen nt lds
    s_add_u32 m0, m0, 1024
    s_add_u32 s91, s91, 10240
    buffer_load_dwordx4 v180, s[12:15], s91 offen nt lds
    s_add_u32 m0, m0, 1024
    s_add_u32 s91, s91, 10240
    buffer_load_dwordx4 v181, s[12:15], s91 offen nt lds
    s_add_u32 m0, m0, 1024
    s_add_u32 s91, s91, 10240
    buffer_load_dwordx4 v180, s[12:15], s91 offen nt lds
    s_add_u32 m0, m0, 1024
    s_add_u32 s91, s91, 10240
    buffer_load_dwordx4 v181, s[12:15], s91 offen nt lds
    s_add_u32 m0, m0, 1024
    s_add_u32 s91, s91, 10240
    buffer_load_dwordx4 v180, s[12:15], s91 offen nt lds
    s_add_u32 m0, m0, 1024
    s_add_u32 s91, s91, 10240
    buffer_load_dwordx4 v181, s[12:15], s91 offen nt lds
    s_add_u32 m0, m0, 1024
    s_add_u32 s91, s91, 10240
    buffer_load_dwordx4 v180, s[12:15], s91 offen nt lds
    s_add_u32 m0, m0, 1024
    s_add_u32 s91, s91, 10240
    buffer_load_dwordx4 v181, s[12:15], s91 offen nt lds
    s_add_u32 m0, m0, 1024
    s_add_u32 s91, s91, 10240
    buffer_load_dwordx4 v180, s[12:15], s91 offen nt lds
    s_add_u32 m0, m0, 1024
    s_add_u32 s91, s91, 10240
    buffer_load_dwordx4 v181, s[12:15], s91 offen nt lds
    s_add_u32 m0, m0, 1024
    s_add_u32 s91, s91, 10240
    buffer_load_dwordx4 v180, s[12:15], s91 offen nt lds
    s_add_u32 m0, m0, 1024
    s_add_u32 s91, s91, 10240
    buffer_load_dwordx4 v181, s[12:15], s91 offen nt lds
    s_add_u32 m0, m0, 1024
    s_add_u32 s91, s91, 10240
    buffer_load_dwordx4 v180, s[12:15], s91 offen nt lds
    s_add_u32 m0, m0, 1024
    s_add_u32 s91, s91, 10240
    buffer_load_dwordx4 v181, s[12:15], s91 offen nt lds
    s_add_u32 m0, m0, 1024
    s_add_u32 s91, s91, 10240
    buffer_load_dwordx4 v180, s[12:15], s91 offen nt lds
    s_add_u32 m0, m0, 1024
    s_add_u32 s91, s91, 10240
    buffer_load_dwordx4 v181, s[12:15], s91 offen nt lds
    s_add_u32 m0, m0, 1024
    s_add_u32 s91, s91, 10240
    buffer_load_dwordx4 v180, s[12:15], s91 offen nt lds
    s_add_u32 m0, m0, 1024
    s_add_u32 s91, s91, 10240
    buffer_load_dwordx4 v181, s[12:15], s91 offen nt lds
    s_waitcnt vmcnt(24)
    v_min_u32 v164, -2, v164
    v_min_u32 v165, -2, v165
    v_min_u32 v166, -2, v166
    v_min_u32 v167, -2, v167
    v_and_b32 v7, 2, v1
    v_cmp_ne_u32 vcc, 0, v7
    v_mov_b32 v5, 0x4444
    v_mov_b32 v6, 0xeeee
    v_cndmask_b32 v10, v5, v6, vcc
    v_mov_b32 v5, 0xe484
    v_mov_b32 v6, 0xee9e
    v_cndmask_b32 v7, v5, v6, vcc
    v_mov_b32 v5, 0x84e4
    v_mov_b32 v6, 0x9eee
    v_cndmask_b32 v8, v5, v6, vcc
    v_cmp_gt_u32 vcc, 2, v2
    s_nop 1
    v_cndmask_b32 v11, v8, v7, vcc
    v_mov_b32 v84, 1065369472
    v_mov_b32 v85, 1065369472
    v_mov_b32 v86, 1065369472
    v_mov_b32 v87, 0
    v_mov_b32 v88, 1065369472
    v_mov_b32 v89, 1065369472
    v_mov_b32 v90, 1065369472
    v_mov_b32 v91, 0
    v_mov_b32 v51, 0
    v_mov_b32 v55, 0
    v_mov_b32 v59, 0
    v_mov_b32 v63, 0
    v_mov_b32 v67, 0
    v_mov_b32 v71, 0
    v_mov_b32 v75, 0
    v_mov_b32 v79, 0
    v_mov_b32 v210, 0
    v_mov_b32 v211, 0
    v_mov_b32 v218, 0
    v_mov_b32 v219, 0
    v_lshrrev_b32 v8, 1, v1
    v_and_b32 v7, 2, v8
    v_cmp_ne_u32 vcc, 0, v7
    v_mov_b32 v5, 0x3f80
    v_mov_b32 v6, 0x3f800000
    v_cndmask_b32 v5, v5, v6, vcc
    v_bfe_u32 v6, v8, 2, 1
    v_and_b32 v7, 1, v8
    v_lshl_or_b32 v6, v7, 1, v6
    v_cmp_eq_u32 vcc, 0, v6
    s_nop 1
    v_cndmask_b32 v108, 0, v5, vcc
    v_cmp_eq_u32 vcc, 1, v6
    s_nop 1
    v_cndmask_b32 v109, 0, v5, vcc
    v_cmp_eq_u32 vcc, 2, v6
    s_nop 1
    v_cndmask_b32 v110, 0, v5, vcc
    v_cmp_eq_u32 vcc, 3, v6
    s_nop 1
    v_cndmask_b32 v111, 0, v5, vcc
    s_mov_b32 s60, 0xaaaaaaaa
    s_mov_b32 s61, 0xaaaaaaaa
    v_add_u32 v14, 8192, v46
    v_mov_b32 v240, 0x3dd53b95
    v_mov_b32 v241, 0x3dd53b95
    s_lshl_b32 s90, s32, 8
    s_add_u32 s90, s90, 122880
    v_mul_u32_u24 v6, 1152, v2
    v_lshl_add_u32 v6, v1, 3, v6
    v_add_u32 v19, s90, v6
    s_mul_i32 s90, s32, 1536
    v_add_u32 v20, s90, v12
    s_add_u32 s90, s90, 1024
    v_lshl_add_u32 v21, v0, 3, s90
    s_mul_i32 s90, s32, 6144
    v_add_u32 v22, s90, v12
    s_add_u32 s90, s90, 1024
    v_lshl_add_u32 v23, v0, 3, s90
    v_add_u32 v28, 98304, v12
    s_mul_i32 s90, s32, 3072
    v_add_u32 v37, s90, v12
    v_add_u32 v44, 25600, v37
    s_add_u32 s54, s90, 98304
    s_mul_i32 s90, s32, 3840
    s_add_u32 s90, s90, 10240
    v_add_u32 v38, s90, v12
    s_add_u32 s90, s90, 1024
    v_add_u32 v39, s90, v13
    s_mul_i32 s90, s32, 12288
    v_add_u32 v40, s90, v12
    s_lshl_b32 s93, s40, 2
    s_add_u32 s93, s93, s32
    s_nop 0
    s_lshr_b32 s90, s93, 2
    s_lshl_b32 s90, s90, 15
    s_and_b32 s92, s93, 3
    s_lshl_b32 s92, s92, 10
    s_add_u32 s90, s90, s92
    v_mov_b32 v5, s34
    v_and_b32 v6, 7, v1
    v_lshlrev_b32 v6, 4, v6
    v_lshl_add_u32 v6, v5, 7, v6
    v_lshrrev_b32 v7, 3, v1
    v_lshl_add_u32 v6, v7, 12, v6
    v_lshrrev_b32 v5, 1, v2
    v_lshl_add_u32 v6, v5, 13, v6
    v_and_b32 v5, 1, v2
    v_lshl_add_u32 v6, v5, 14, v6
    v_add_u32 v30, s90, v6
    s_and_b32 s91, s34, 1
    s_lshl_b32 s91, s91, 12
    s_add_u32 s90, s90, s91
    s_lshr_b32 s91, s34, 2
    s_lshl_b32 s91, s91, 13
    s_add_u32 s90, s90, s91
    s_and_b32 s91, s34, 2
    s_lshl_b32 s91, s91, 13
    s_add_u32 s90, s90, s91
    v_lshl_add_u32 v31, v0, 4, s90
    s_lshl_b32 s91, s93, 10
    s_add_u32 s91, s91, 884736
    v_lshl_add_u32 v15, v0, 4, s91
    s_lshr_b32 s91, s34, 1
    s_mul_i32 s91, s91, 10240
    s_lshl_b32 s92, s93, 5
    s_add_u32 s91, s91, s92
    s_and_b32 s92, s34, 1
    s_mul_i32 s92, s92, 40960
    s_add_u32 s91, s91, s92
    s_add_u32 s91, s91, 1280
    v_mul_u32_u24 v6, 2560, v2
    v_lshl_add_u32 v6, v1, 1, v6
    v_add_u32 v32, s91, v6
    v_cmp_gt_u32 s[58:59], 8, v1
    v_and_b32 v5, 1, v1
    v_lshrrev_b32 v6, 3, v1
    v_lshl_add_u32 v5, v5, 1, v6
    v_bfe_u32 v6, v1, 2, 1
    v_cmp_ne_u32 vcc, 0, v6
    v_mov_b32 v6, 0x3f80
    v_mov_b32 v7, 0x3f800000
    v_cndmask_b32 v6, v6, v7, vcc
    v_cmp_eq_u32 vcc, 0, v5
    s_nop 1
    v_cndmask_b32 v7, 0, v6, vcc
    v_accvgpr_write_b32 a144, v7
    v_cmp_eq_u32 vcc, 1, v5
    s_nop 1
    v_cndmask_b32 v7, 0, v6, vcc
    v_accvgpr_write_b32 a145, v7
    v_cmp_eq_u32 vcc, 2, v5
    s_nop 1
    v_cndmask_b32 v7, 0, v6, vcc
    v_accvgpr_write_b32 a146, v7
    v_cmp_eq_u32 vcc, 3, v5
    s_nop 1
    v_cndmask_b32 v7, 0, v6, vcc
    v_accvgpr_write_b32 a147, v7
    s_lshl_b32 s90, s32, 7
    v_add_u32 v5, s90, v13
    v_add_u32 v6, 458752, v5
    v_add_u32 v7, 459728, v5
    v_cmp_gt_u32 vcc, 12, v0
    s_nop 1
    v_cndmask_b32 v33, v7, v6, vcc
    v_mov_b32 v5, -2
    v_cndmask_b32 v34, v5, 3, vcc
    v_cmp_gt_u32 vcc, 14, v0
    v_mov_b32 v9, 2146435072
    s_nop 0
    v_cndmask_b32 v33, v9, v33, vcc
    v_mov_b32 v5, -1000
    v_cndmask_b32 v34, v5, v34, vcc
    v_and_b32 v4, 3, v1
    v_lshlrev_b32 v6, 6, v4
    v_lshl_add_u32 v6, v3, 3, v6
    v_lshl_add_u32 v6, v2, 8, v6
    v_and_b32 v5, 1, v2
    v_lshl_add_u32 v6, v5, 5, v6
    s_mul_i32 s90, s32, 3072
    s_add_u32 s53, s90, 131072
    v_add_u32 v16, s53, v6
    v_xor_b32 v13, 32, v16
    v_and_b32 v4, 3, v1
    v_and_b32 v5, 1, v2
    v_lshl_add_u32 v6, v2, 3, v3
    v_lshlrev_b32 v6, 7, v6
    v_and_b32 v7, 2, v3
    v_lshl_or_b32 v7, v5, 2, v7
    v_lshrrev_b32 v8, 1, v4
    v_xor_b32 v7, v7, v8
    v_lshl_add_u32 v6, v7, 4, v6
    v_and_b32 v7, 1, v4
    v_lshl_add_u32 v6, v7, 3, v6
    s_mul_i32 s90, s32, 24576
    v_add_u32 v6, s90, v6
    v_xor_b32 v182, 0, v6
    v_xor_b32 v183, 32, v6
    v_xor_b32 v184, 64, v6
    v_xor_b32 v185, 96, v6
    s_waitcnt vmcnt(0)
    ds_read_b64_tr_b16 a[0:1], v182 offset:0
    ds_read_b64_tr_b16 a[2:3], v182 offset:512
    ds_read_b64_tr_b16 a[4:5], v182 offset:4096
    ds_read_b64_tr_b16 a[6:7], v182 offset:4608
    ds_read_b64_tr_b16 a[8:9], v182 offset:8192
    ds_read_b64_tr_b16 a[10:11], v182 offset:8704
    ds_read_b64_tr_b16 a[12:13], v182 offset:12288
    ds_read_b64_tr_b16 a[14:15], v182 offset:12800
    ds_read_b64_tr_b16 a[16:17], v182 offset:16384
    ds_read_b64_tr_b16 a[18:19], v182 offset:16896
    ds_read_b64_tr_b16 a[20:21], v182 offset:20480
    ds_read_b64_tr_b16 a[22:23], v182 offset:20992
    ds_read_b64_tr_b16 a[24:25], v183 offset:0
    ds_read_b64_tr_b16 a[26:27], v183 offset:512
    ds_read_b64_tr_b16 a[28:29], v183 offset:4096
    ds_read_b64_tr_b16 a[30:31], v183 offset:4608
    ds_read_b64_tr_b16 a[32:33], v183 offset:8192
    ds_read_b64_tr_b16 a[34:35], v183 offset:8704
    ds_read_b64_tr_b16 a[36:37], v183 offset:12288
    ds_read_b64_tr_b16 a[38:39], v183 offset:12800
    ds_read_b64_tr_b16 a[40:41], v183 offset:16384
    ds_read_b64_tr_b16 a[42:43], v183 offset:16896
    ds_read_b64_tr_b16 a[44:45], v183 offset:20480
    ds_read_b64_tr_b16 a[46:47], v183 offset:20992
    ds_read_b64_tr_b16 a[48:49], v184 offset:0
    ds_read_b64_tr_b16 a[50:51], v184 offset:512
    ds_read_b64_tr_b16 a[52:53], v184 offset:4096
    ds_read_b64_tr_b16 a[54:55], v184 offset:4608
    ds_read_b64_tr_b16 a[56:57], v184 offset:8192
    ds_read_b64_tr_b16 a[58:59], v184 offset:8704
    ds_read_b64_tr_b16 a[60:61], v184 offset:12288
    ds_read_b64_tr_b16 a[62:63], v184 offset:12800
    ds_read_b64_tr_b16 a[64:65], v184 offset:16384
    ds_read_b64_tr_b16 a[66:67], v184 offset:16896
    ds_read_b64_tr_b16 a[68:69], v184 offset:20480
    ds_read_b64_tr_b16 a[70:71], v184 offset:20992
    ds_read_b64_tr_b16 a[72:73], v185 offset:0
    ds_read_b64_tr_b16 a[74:75], v185 offset:512
    ds_read_b64_tr_b16 a[76:77], v185 offset:4096
    ds_read_b64_tr_b16 a[78:79], v185 offset:4608
    ds_read_b64_tr_b16 a[80:81], v185 offset:8192
    ds_read_b64_tr_b16 a[82:83], v185 offset:8704
    ds_read_b64_tr_b16 a[84:85], v185 offset:12288
    ds_read_b64_tr_b16 a[86:87], v185 offset:12800
    ds_read_b64_tr_b16 a[88:89], v185 offset:16384
    ds_read_b64_tr_b16 a[90:91], v185 offset:16896
    ds_read_b64_tr_b16 a[92:93], v185 offset:20480
    ds_read_b64_tr_b16 a[94:95], v185 offset:20992
    s_waitcnt lgkmcnt(0)
    s_barrier
    v_mov_b32 v1, 196
L_gw_96:
    buffer_load_dword v2, v1, s[8:11], 0 offen sc1
    s_sub_u32 s36, s36, 1
    s_cbranch_scc1 L_exit
    s_waitcnt vmcnt(0)
L_gw_96c:
    v_readfirstlane_b32 s90, v2
    s_nop 0
    s_cmp_eq_u32 s90, 0
    s_cbranch_scc1 L_gw_96
    buffer_store_dwordx4 v[164:167], v17, s[4:7], s38 offen sc1
    s_mov_b32 s57, -1
    s_mov_b32 s37, -1
    v_add_u32 v35, -2, v34
    s_add_u32 s45, s38, 65536
    s_add_u32 s46, s45, 4096
    s_add_u32 s47, s45, 8192
    v_mov_b32 v24, v20
    v_mov_b32 v25, v21
    buffer_load_dword v36, v33, s[4:7], s38 offen sc1
    s_waitcnt vmcnt(0)
    v_cmp_lt_i32 vcc, v36, v35
    s_cbranch_vccz L_fok_98
L_fw_97:
    buffer_load_dword v36, v33, s[4:7], s38 offen sc1
    s_sub_u32 s36, s36, 1
    s_cbranch_scc1 L_exit
    s_waitcnt vmcnt(0)
    v_cmp_lt_i32 vcc, v36, v35
    s_cbranch_vccnz L_fw_97
L_fok_98:
    buffer_load_dwordx4 a[96:99], v40, s[4:7], s45 offen offset:0 sc1
    buffer_load_dwordx4 a[100:103], v40, s[4:7], s45 offen offset:1024 sc1
    buffer_load_dwordx4 a[104:107], v40, s[4:7], s45 offen offset:2048 sc1
    buffer_load_dwordx4 a[108:111], v40, s[4:7], s45 offen offset:3072 sc1
    buffer_load_dwordx4 a[112:115], v40, s[4:7], s46 offen offset:0 sc1
    buffer_load_dwordx4 a[116:119], v40, s[4:7], s46 offen offset:1024 sc1
    buffer_load_dwordx4 a[120:123], v40, s[4:7], s46 offen offset:2048 sc1
    buffer_load_dwordx4 a[124:127], v40, s[4:7], s46 offen offset:3072 sc1
    buffer_load_dwordx4 a[128:131], v40, s[4:7], s47 offen offset:0 sc1
    buffer_load_dwordx4 a[132:135], v40, s[4:7], s47 offen offset:1024 sc1
    buffer_load_dwordx4 a[136:139], v40, s[4:7], s47 offen offset:2048 sc1
    buffer_load_dwordx4 a[140:143], v40, s[4:7], s47 offen offset:3072 sc1
    s_waitcnt vmcnt(0)
    v_mfma_f32_16x16x32_bf16 v[148:151], a[96:99], a[0:3], 0
    v_mfma_f32_16x16x32_bf16 v[152:155], a[120:123], a[0:3], 0
    v_mfma_f32_16x16x32_bf16 v[156:159], a[96:99], a[24:27], 0
    v_mfma_f32_16x16x32_bf16 v[160:163], a[120:123], a[24:27], 0
    v_mfma_f32_16x16x32_bf16 v[180:183], a[96:99], a[48:51], 0
    v_mfma_f32_16x16x32_bf16 v[184:187], a[120:123], a[48:51], 0
    v_mfma_f32_16x16x32_bf16 v[188:191], a[96:99], a[72:75], 0
    v_mfma_f32_16x16x32_bf16 v[192:195], a[120:123], a[72:75], 0
    v_mfma_f32_16x16x32_bf16 v[148:151], a[100:103], a[4:7], v[148:151]
    v_mfma_f32_16x16x32_bf16 v[152:155], a[124:127], a[4:7], v[152:155]
    v_mfma_f32_16x16x32_bf16 v[156:159], a[100:103], a[28:31], v[156:159]
    v_mfma_f32_16x16x32_bf16 v[160:163], a[124:127], a[28:31], v[160:163]
    v_mfma_f32_16x16x32_bf16 v[180:183], a[100:103], a[52:55], v[180:183]
    v_mfma_f32_16x16x32_bf16 v[184:187], a[124:127], a[52:55], v[184:187]
    v_mfma_f32_16x16x32_bf16 v[188:191], a[100:103], a[76:79], v[188:191]
    v_mfma_f32_16x16x32_bf16 v[192:195], a[124:127], a[76:79], v[192:195]
    v_mfma_f32_16x16x32_bf16 v[148:151], a[104:107], a[8:11], v[148:151]
    v_mfma_f32_16x16x32_bf16 v[152:155], a[128:131], a[8:11], v[152:155]
    v_mfma_f32_16x16x32_bf16 v[156:159], a[104:107], a[32:35], v[156:159]
    v_mfma_f32_16x16x32_bf16 v[160:163], a[128:131], a[32:35], v[160:163]
    v_mfma_f32_16x16x32_bf16 v[180:183], a[104:107], a[56:59], v[180:183]
    v_mfma_f32_16x16x32_bf16 v[184:187], a[128:131], a[56:59], v[184:187]
    v_mfma_f32_16x16x32_bf16 v[188:191], a[104:107], a[80:83], v[188:191]
    v_mfma_f32_16x16x32_bf16 v[192:195], a[128:131], a[80:83], v[192:195]
    v_mfma_f32_16x16x32_bf16 v[148:151], a[108:111], a[12:15], v[148:151]
    v_mfma_f32_16x16x32_bf16 v[152:155], a[132:135], a[12:15], v[152:155]
    v_mfma_f32_16x16x32_bf16 v[156:159], a[108:111], a[36:39], v[156:159]
    v_mfma_f32_16x16x32_bf16 v[160:163], a[132:135], a[36:39], v[160:163]
    v_mfma_f32_16x16x32_bf16 v[180:183], a[108:111], a[60:63], v[180:183]
    v_mfma_f32_16x16x32_bf16 v[184:187], a[132:135], a[60:63], v[184:187]
    v_mfma_f32_16x16x32_bf16 v[188:191], a[108:111], a[84:87], v[188:191]
    v_mfma_f32_16x16x32_bf16 v[192:195], a[132:135], a[84:87], v[192:195]
    v_mfma_f32_16x16x32_bf16 v[148:151], a[112:115], a[16:19], v[148:151]
    v_mfma_f32_16x16x32_bf16 v[152:155], a[136:139], a[16:19], v[152:155]
    v_mfma_f32_16x16x32_bf16 v[156:159], a[112:115], a[40:43], v[156:159]
    v_mfma_f32_16x16x32_bf16 v[160:163], a[136:139], a[40:43], v[160:163]
    v_mfma_f32_16x16x32_bf16 v[180:183], a[112:115], a[64:67], v[180:183]
    v_mfma_f32_16x16x32_bf16 v[184:187], a[136:139], a[64:67], v[184:187]
    v_mfma_f32_16x16x32_bf16 v[188:191], a[112:115], a[88:91], v[188:191]
    v_mfma_f32_16x16x32_bf16 v[192:195], a[136:139], a[88:91], v[192:195]
    v_mfma_f32_16x16x32_bf16 v[148:151], a[116:119], a[20:23], v[148:151]
    v_mfma_f32_16x16x32_bf16 v[152:155], a[140:143], a[20:23], v[152:155]
    v_mfma_f32_16x16x32_bf16 v[156:159], a[116:119], a[44:47], v[156:159]
    v_mfma_f32_16x16x32_bf16 v[160:163], a[140:143], a[44:47], v[160:163]
    v_mfma_f32_16x16x32_bf16 v[180:183], a[116:119], a[68:71], v[180:183]
    v_mfma_f32_16x16x32_bf16 v[184:187], a[140:143], a[68:71], v[184:187]
    v_mfma_f32_16x16x32_bf16 v[188:191], a[116:119], a[92:95], v[188:191]
    v_mfma_f32_16x16x32_bf16 v[192:195], a[140:143], a[92:95], v[192:195]
    v_cvt_pk_bf16_f32 v64, v180, v181
    v_cvt_pk_bf16_f32 v65, v182, v183
    ds_write_b64 v24, v[64:65] offset:12288
    v_cvt_pk_bf16_f32 v68, v184, v185
    v_cvt_pk_bf16_f32 v69, v186, v187
    ds_write_b64 v25, v[68:69] offset:12288
    v_cvt_pk_bf16_f32 v72, v188, v189
    v_cvt_pk_bf16_f32 v73, v190, v191
    ds_write_b64 v24, v[72:73] offset:18432
    v_cvt_pk_bf16_f32 v76, v192, v193
    v_cvt_pk_bf16_f32 v77, v194, v195
    ds_write_b64 v25, v[76:77] offset:18432
    v_cvt_pk_bf16_f32 v48, v148, v149
    v_cvt_pk_bf16_f32 v49, v150, v151
    ds_write_b64 v24, v[48:49] offset:0
    v_cvt_pk_bf16_f32 v52, v152, v153
    v_cvt_pk_bf16_f32 v53, v154, v155
    ds_write_b64 v25, v[52:53] offset:0
    v_cvt_pk_bf16_f32 v56, v156, v157
    v_cvt_pk_bf16_f32 v57, v158, v159
    ds_write_b64 v24, v[56:57] offset:6144
    v_cvt_pk_bf16_f32 v60, v160, v161
    v_cvt_pk_bf16_f32 v61, v162, v163
    ds_write_b64 v25, v[60:61] offset:6144
    s_add_u32 s56, s37, 2
    s_and_b32 s55, s56, 3
    s_mul_i32 s55, s55, 114688
    s_add_u32 s55, s55, 65536
    s_add_u32 s45, s38, s55
    s_add_u32 s46, s45, 4096
    s_add_u32 s47, s45, 8192
    s_add_u32 s56, s37, -1
    s_and_b32 s55, s56, 3
    s_mul_i32 s55, s55, 114688
    s_add_u32 s55, s55, 53248
    s_add_u32 s48, s38, s55
    s_and_b32 s55, s56, 1
    s_add_u32 s56, s56, 1
    v_mov_b32 v35, -16
    v_writelane_b32 v35, s56, 12
    s_mul_i32 s55, s55, 12288
    s_add_u32 m0, s54, s55
    v_add_u32 v35, -1, v34
    buffer_load_dword v36, v33, s[4:7], s38 offen sc1
    s_waitcnt vmcnt(0)
    v_cmp_lt_i32 vcc, v36, v35
    s_cbranch_vccz L_fok_100
L_fw_99:
    buffer_load_dword v36, v33, s[4:7], s38 offen sc1
    s_sub_u32 s36, s36, 1
    s_cbranch_scc1 L_exit
    s_waitcnt vmcnt(0)
    v_cmp_lt_i32 vcc, v36, v35
    s_cbranch_vccnz L_fw_99
L_fok_100:
    buffer_load_dwordx4 a[96:99], v40, s[4:7], s45 offen offset:0 sc1
    buffer_load_dwordx4 a[100:103], v40, s[4:7], s45 offen offset:1024 sc1
    buffer_load_dwordx4 a[104:107], v40, s[4:7], s45 offen offset:2048 sc1
    buffer_load_dwordx4 a[108:111], v40, s[4:7], s45 offen offset:3072 sc1
    buffer_load_dwordx4 a[112:115], v40, s[4:7], s46 offen offset:0 sc1
    buffer_load_dwordx4 a[116:119], v40, s[4:7], s46 offen offset:1024 sc1
    buffer_load_dwordx4 a[120:123], v40, s[4:7], s46 offen offset:2048 sc1
    buffer_load_dwordx4 a[124:127], v40, s[4:7], s46 offen offset:3072 sc1
    buffer_load_dwordx4 a[128:131], v40, s[4:7], s47 offen offset:0 sc1
    buffer_load_dwordx4 a[132:135], v40, s[4:7], s47 offen offset:1024 sc1
    buffer_load_dwordx4 a[136:139], v40, s[4:7], s47 offen offset:2048 sc1
    buffer_load_dwordx4 a[140:143], v40, s[4:7], s47 offen offset:3072 sc1
    s_mov_b32 s50, s42
    s_add_u32 s56, s37, 1
    v_mov_b32 v47, v24
    s_and_b32 s55, s56, 3
    s_mul_i32 s41, s55, 327680
    s_mul_i32 s56, s55, 114688
    s_add_u32 s43, s38, s56
    s_xor_b32 s55, s55, 2
    s_mul_i32 s42, s55, 327680
    s_add_u32 s56, s37, 2
    v_mov_b32 v107, s56
    s_and_b32 s55, s56, 3
    s_mul_i32 s44, s55, 24576
    s_add_u32 s56, s37, -1
    s_and_b32 s55, s56, 3
    s_mul_i32 s55, s55, 40960
    s_add_u32 s49, s55, s38
    s_add_u32 s56, s37, -1
    s_and_b32 s55, s56, 3
    s_mul_i32 s55, s55, 24576
    v_add_u32 v26, s55, v22
    v_add_u32 v27, s55, v23
    s_and_b32 s55, s56, 1
    s_mul_i32 s55, s55, 12288
    v_add_u32 v29, s55, v28
    s_add_u32 s37, s37, 1
    s_mov_b32 m0, s53
    v_add_u32 v24, s44, v20
    v_add_u32 v25, s44, v21
    v_pk_mul_f32 v[148:149], v[210:211], v[210:211]
    v_pk_mul_f32 v[150:151], v[210:211], v[210:211]
    v_pk_mul_f32 v[152:153], v[210:211], v[210:211]
    v_pk_mul_f32 v[154:155], v[210:211], v[210:211]
    v_pk_mul_f32 v[156:157], v[210:211], v[210:211]
    v_pk_mul_f32 v[158:159], v[210:211], v[210:211]
    v_pk_mul_f32 v[160:161], v[210:211], v[210:211]
    v_pk_mul_f32 v[162:163], v[210:211], v[210:211]
    v_mov_b32 v120, 0
    v_mov_b32 v121, 0
    v_mov_b32 v122, 0
    v_mov_b32 v123, 0
    v_mov_b32 v124, 0
    v_mov_b32 v125, 0
    v_mov_b32 v126, 0
    v_mov_b32 v127, 0
    v_mov_b32 v128, 0
    v_mov_b32 v129, 0
    v_mov_b32 v130, 0
    v_mov_b32 v131, 0
    v_mov_b32 v132, 0
    v_mov_b32 v133, 0
    v_mov_b32 v134, 0
    v_mov_b32 v135, 0
    v_mov_b32 v116, 0
    v_mov_b32 v117, 0
    v_mov_b32 v118, 0
    v_mov_b32 v119, 0
L_wo_loop_s:
    buffer_load_dword v41, v245, s[4:7], s38 offen sc1
    buffer_load_dword v41, v245, s[4:7], s38 offen sc1
    buffer_load_dword v41, v245, s[4:7], s38 offen sc1
    buffer_load_dword v41, v245, s[4:7], s38 offen sc1
    buffer_load_dword v41, v245, s[4:7], s38 offen sc1
    buffer_load_dword v41, v245, s[4:7], s38 offen sc1
L_sp_104:
    s_waitcnt vmcnt(5)
    v_cmp_ge_u32 vcc, s37, v41
    buffer_load_dword v41, v245, s[4:7], s38 offen sc1
    s_sub_u32 s36, s36, 1
    s_cbranch_scc1 L_exit
    s_cbranch_vccz L_sp_104x
    s_waitcnt vmcnt(5)
    v_cmp_ge_u32 vcc, s37, v41
    buffer_load_dword v41, v245, s[4:7], s38 offen sc1
    s_cbranch_vccz L_sp_104x
    s_waitcnt vmcnt(5)
    v_cmp_ge_u32 vcc, s37, v41
    buffer_load_dword v41, v245, s[4:7], s38 offen sc1
    s_cbranch_vccz L_sp_104x
    s_waitcnt vmcnt(5)
    v_cmp_ge_u32 vcc, s37, v41
    buffer_load_dword v41, v245, s[4:7], s38 offen sc1
    s_cbranch_vccnz L_sp_104
L_sp_104x:
    buffer_store_dword v107, v45, s[4:7], s38 offen sc1
    buffer_load_dwordx4 v44, s[4:7], s43 offen offset:0 sc1 lds
    buffer_load_dwordx4 v44, s[4:7], s43 offen offset:1024 sc1 lds
    buffer_load_dwordx4 v44, s[4:7], s43 offen offset:2048 sc1 lds
    s_cmp_eq_u32 s37, 63
    s_cbranch_scc1 L_wo_tail_s
    s_waitcnt vmcnt(2)
    ds_read_b64_tr_b16 v[136:137], v16 offset:0
    ds_read_b64_tr_b16 v[138:139], v13 offset:0
    buffer_load_dwordx4 v[92:95], v38, s[4:7], s43 offen offset:0 sc1
    buffer_load_dwordx4 v[96:99], v38, s[4:7], s43 offen offset:1280 sc1
    buffer_load_dwordx4 v[100:103], v38, s[4:7], s43 offen offset:2560 sc1
    s_waitcnt vmcnt(4)
    ds_read_b64_tr_b16 v[140:141], v16 offset:1024
    ds_read_b64_tr_b16 v[142:143], v13 offset:1024
    s_waitcnt vmcnt(3)
    ds_read_b64_tr_b16 v[144:145], v16 offset:2048
    ds_read_b64_tr_b16 v[146:147], v13 offset:2048
    s_waitcnt lgkmcnt(4)
    v_smfmac_f32_16x16x64_bf16 v[148:151], v[136:139], a[0:7], v10
    buffer_load_dword v104, v39, s[4:7], s43 offen offset:0 sc1
    v_smfmac_f32_16x16x64_bf16 v[152:155], v[136:139], a[24:31], v10
    buffer_load_dword v105, v39, s[4:7], s43 offen offset:1280 sc1
    v_smfmac_f32_16x16x64_bf16 v[156:159], v[136:139], a[48:55], v10
    buffer_load_dword v106, v39, s[4:7], s43 offen offset:2560 sc1
    v_smfmac_f32_16x16x64_bf16 v[160:163], v[136:139], a[72:79], v10
    s_waitcnt lgkmcnt(2)
    v_smfmac_f32_16x16x64_bf16 v[148:151], v[140:143], a[8:15], v10
    v_smfmac_f32_16x16x64_bf16 v[152:155], v[140:143], a[32:39], v10
    v_smfmac_f32_16x16x64_bf16 v[156:159], v[140:143], a[56:63], v10
    v_smfmac_f32_16x16x64_bf16 v[160:163], v[140:143], a[80:87], v10
    s_waitcnt lgkmcnt(0)
    v_smfmac_f32_16x16x64_bf16 v[148:151], v[144:147], a[16:23], v10
    v_smfmac_f32_16x16x64_bf16 v[152:155], v[144:147], a[40:47], v10
    v_smfmac_f32_16x16x64_bf16 v[156:159], v[144:147], a[64:71], v10
    v_smfmac_f32_16x16x64_bf16 v[160:163], v[144:147], a[88:95], v10
L_sc_105:
    v_pk_add_f32 v[148:149], v[148:149], v[150:151]
    v_cvt_pk_bf16_f32 v50, v148, v149
    v_cvt_pk_bf16_f32 v54, v148, v149
    v_pk_add_f32 v[152:153], v[152:153], v[154:155]
    v_cvt_pk_bf16_f32 v58, v152, v153
    v_cvt_pk_bf16_f32 v62, v152, v153
    v_pk_add_f32 v[156:157], v[156:157], v[158:159]
    v_cvt_pk_bf16_f32 v66, v156, v157
    v_cvt_pk_bf16_f32 v70, v156, v157
    s_waitcnt vmcnt(4)
    v_pk_add_f32 v[236:237], v[92:93], v[96:97]
    v_pk_add_f32 v[238:239], v[94:95], v[98:99]
    s_waitcnt vmcnt(3)
    v_pk_add_f32 v[236:237], v[236:237], v[100:101]
    v_pk_add_f32 v[238:239], v[238:239], v[102:103]
    v_pk_mul_f32 v[236:237], v[236:237], v[240:241]
    v_pk_mul_f32 v[238:239], v[238:239], v[240:241]
    v_max3_f32 v41, v236, v237, v238
    s_waitcnt vmcnt(0)
    v_add_f32 v43, v104, v105
    v_add_f32 v43, v43, v106
    v_mul_f32 v43, v43, v240
    v_max3_f32 v41, v41, v239, v43
    v_pk_add_f32 v[160:161], v[160:161], v[162:163]
    v_cvt_pk_bf16_f32 v74, v160, v161
    v_max_f32_dpp v42, v41, v41 quad_perm:[2,3,0,1] row_mask:0xf bank_mask:0xf
    v_max_f32_dpp v41, v41, v41 quad_perm:[2,3,0,1] row_mask:0xf bank_mask:0xf
    v_cvt_pk_bf16_f32 v78, v160, v161
    s_nop 0
    v_permlane16_swap_b32 v41, v42
    v_max_f32 v41, v41, v42
    v_mov_b32 v42, v41
    s_nop 1
    v_permlane32_swap_b32 v41, v42
    v_max_f32 v242, v41, v42
    v_pk_add_f32 v[236:237], v[236:237], v[242:243] op_sel_hi:[1,0] neg_lo:[0,1] neg_hi:[0,1]
    v_pk_add_f32 v[238:239], v[238:239], v[242:243] op_sel_hi:[1,0] neg_lo:[0,1] neg_hi:[0,1]
    v_sub_f32 v43, v43, v242
    v_exp_f32 v236, v236
    v_exp_f32 v237, v237
    v_exp_f32 v238, v238
    v_exp_f32 v239, v239
    v_exp_f32 v43, v43
    v_cvt_pk_bf16_f32 v80, v236, v237
    v_cvt_pk_bf16_f32 v82, v238, v239
    v_cvt_pk_bf16_f32 v81, v43, 0
    v_cvt_pk_bf16_f32 v83, v43, 0
    s_nop 1
    v_smfmac_f32_16x16x64_bf16 v[116:119], v[80:83], v[84:91], v11
    v_smfmac_f32_16x16x64_bf16 v[120:123], v[80:83], v[48:55], v11
    v_smfmac_f32_16x16x64_bf16 v[124:127], v[80:83], v[56:63], v11
    v_smfmac_f32_16x16x64_bf16 v[128:131], v[80:83], v[64:71], v11
    v_add_f32 v116, v116, v118
    v_add_f32 v117, v117, v119
    v_smfmac_f32_16x16x64_bf16 v[132:135], v[80:83], v[72:79], v11
    v_rcp_f32 v116, v116
    v_rcp_f32 v117, v117
    v_pk_add_f32 v[120:121], v[120:121], v[122:123]
    v_pk_mul_f32 v[120:121], v[120:121], v[116:117]
    v_cvt_pk_bf16_f32 v236, v120, v121
    v_pk_add_f32 v[124:125], v[124:125], v[126:127]
    v_pk_mul_f32 v[124:125], v[124:125], v[116:117]
    v_cvt_pk_bf16_f32 v237, v124, v125
    ds_write2st64_b32 v18, v236, v237 offset0:0 offset1:1
    v_pk_add_f32 v[128:129], v[128:129], v[130:131]
    v_pk_mul_f32 v[128:129], v[128:129], v[116:117]
    v_cvt_pk_bf16_f32 v238, v128, v129
    v_pk_add_f32 v[132:133], v[132:133], v[134:135]
    v_pk_mul_f32 v[132:133], v[132:133], v[116:117]
    v_cvt_pk_bf16_f32 v239, v132, v133
    ds_write2st64_b32 v18, v238, v239 offset0:2 offset1:3
    v_cmp_u_f32 vcc, v120, v121
    v_mov_b32 v120, 0
    v_mov_b32 v121, 0
    v_mov_b32 v122, 0
    v_mov_b32 v123, 0
    v_mov_b32 v124, 0
    v_mov_b32 v125, 0
    v_mov_b32 v126, 0
    v_mov_b32 v127, 0
    v_mov_b32 v128, 0
    s_cbranch_vccnz L_sp_106
L_sg_107:
    s_waitcnt lgkmcnt(0)
    s_barrier
    ds_read_b64_tr_b16 v[80:81], v19
    ds_read_b64_tr_b16 v[82:83], v19 offset:128
    v_mov_b32 v129, 0
    v_mov_b32 v130, 0
    v_mov_b32 v131, 0
    v_mov_b32 v132, 0
    v_mov_b32 v133, 0
    v_mov_b32 v134, 0
    v_mov_b32 v135, 0
    v_mov_b32 v116, 0
    v_mov_b32 v117, 0
    v_mov_b32 v118, 0
    v_mov_b32 v119, 0
    s_waitcnt lgkmcnt(0)
    v_mfma_f32_16x16x32_bf16 v[172:175], v[80:83], v[108:111], 0
    buffer_load_dword v36, v33, s[4:7], s38 offen sc1
    s_nop 6
    v_cvt_pk_bf16_f32 v236, v172, v173
    v_cvt_pk_bf16_f32 v237, v174, v175
    v_cndmask_b32 v236, v236, v237, s[60:61]
    buffer_store_dword v236, v46, s[4:7], s41 offen sc1
    buffer_store_dword v236, v14, s[4:7], s41 offen sc1
    ds_write_b32 v47, v50 offset:8
    ds_write_b32 v47, v58 offset:6152
    ds_write_b32 v47, v66 offset:12296
    ds_write_b32 v47, v74 offset:18440
    ds_read_b128 v[204:207], v26 offset:0
    ds_read_b128 v[180:183], v29 offset:0
    ds_read_b128 v[184:187], v29 offset:1024
    ds_read_b64 v[208:209], v27 offset:0
    ds_read_b128 v[188:191], v29 offset:2048
    ds_read_b128 v[212:215], v26 offset:1536
    ds_read_b128 v[192:195], v29 offset:3072
    ds_read_b128 v[196:199], v29 offset:4096
    ds_read_b64 v[216:217], v27 offset:1536
    ds_read_b128 v[200:203], v29 offset:5120
    s_add_u32 s55, s42, 0
    buffer_store_dword v168, v46, s[4:7], s55 offen sc1
    s_add_u32 s55, s42, 8192
    buffer_store_dword v168, v46, s[4:7], s55 offen sc1
    s_waitcnt lgkmcnt(5)
    v_mfma_f32_16x16x32_bf16 v[220:223], v[180:183], v[204:207], 0
    v_mfma_f32_16x16x32_bf16 v[224:227], v[184:187], v[204:207], 0
    v_mfma_f32_16x16x32_bf16 v[224:227], v[188:191], v[208:211], v[224:227]
    ds_read_b128 v[204:207], v26 offset:3072
    ds_read_b128 v[180:183], v29 offset:6144
    ds_read_b128 v[184:187], v29 offset:7168
    ds_read_b64 v[208:209], v27 offset:3072
    ds_read_b128 v[188:191], v29 offset:8192
    s_add_u32 s56, s37, 2
    s_and_b32 s55, s56, 3
    s_mul_i32 s55, s55, 114688
    s_add_u32 s55, s55, 65536
    s_add_u32 s45, s38, s55
    s_add_u32 s46, s45, 4096
    s_add_u32 s47, s45, 8192
    s_add_u32 s56, s37, -1
    s_and_b32 s55, s56, 3
    s_mul_i32 s55, s55, 114688
    s_add_u32 s55, s55, 53248
    s_add_u32 s48, s38, s55
    s_and_b32 s55, s56, 1
    s_add_u32 s56, s56, 1
    v_mov_b32 v35, -16
    v_writelane_b32 v35, s56, 12
    s_mul_i32 s55, s55, 12288
    s_add_u32 m0, s54, s55
    s_waitcnt lgkmcnt(5)
    v_mfma_f32_16x16x32_bf16 v[220:223], v[192:195], v[212:215], v[220:223]
    v_mfma_f32_16x16x32_bf16 v[224:227], v[196:199], v[212:215], v[224:227]
    v_mfma_f32_16x16x32_bf16 v[224:227], v[200:203], v[216:219], v[224:227]
    ds_read_b128 v[212:215], v26 offset:4608
    ds_read_b128 v[192:195], v29 offset:9216
    ds_read_b128 v[196:199], v29 offset:10240
    ds_read_b64 v[216:217], v27 offset:4608
    ds_read_b128 v[200:203], v29 offset:11264
    s_waitcnt lgkmcnt(5)
    v_mfma_f32_16x16x32_bf16 v[220:223], v[180:183], v[204:207], v[220:223]
    v_mfma_f32_16x16x32_bf16 v[224:227], v[184:187], v[204:207], v[224:227]
    v_mfma_f32_16x16x32_bf16 v[224:227], v[188:191], v[208:211], v[224:227]
    s_waitcnt lgkmcnt(0)
    v_mfma_f32_16x16x32_bf16 v[220:223], v[192:195], v[212:215], v[220:223]
    v_mfma_f32_16x16x32_bf16 v[224:227], v[196:199], v[212:215], v[224:227]
    v_mfma_f32_16x16x32_bf16 v[224:227], v[200:203], v[216:219], v[224:227]
    s_waitcnt vmcnt(4)
    v_cmp_lt_i32 vcc, v36, v35
    s_cbranch_vccz L_fok_110
L_fw_109:
    buffer_load_dword v36, v33, s[4:7], s38 offen sc1
    s_sub_u32 s36, s36, 1
    s_cbranch_scc1 L_exit
    s_waitcnt vmcnt(0)
    v_cmp_lt_i32 vcc, v36, v35
    s_cbranch_vccnz L_fw_109
L_fok_110:
    buffer_load_dwordx4 v37, s[4:7], s48 offen offset:0 sc1 lds
    buffer_load_dwordx4 v37, s[4:7], s48 offen offset:1024 sc1 lds
    buffer_load_dwordx4 v37, s[4:7], s48 offen offset:2048 sc1 lds
    v_cvt_pk_bf16_f32 v220, v220, v221
    v_cvt_pk_bf16_f32 v221, v222, v223
    v_cvt_pk_bf16_f32 v222, v224, v225
    v_cvt_pk_bf16_f32 v223, v226, v227
    v_mov_b32 v224, v220
    v_mov_b32 v225, v221
    v_mov_b32_dpp v220, v222 row_ror:8 row_mask:0xf bank_mask:0xc
    v_mov_b32_dpp v221, v223 row_ror:8 row_mask:0xf bank_mask:0xc
    v_mov_b32_dpp v222, v224 row_ror:8 row_mask:0xf bank_mask:0x3
    v_mov_b32_dpp v223, v225 row_ror:8 row_mask:0xf bank_mask:0x3
    buffer_store_dwordx4 v[220:223], v15, s[4:7], s49 offen sc1
    v_mfma_f32_16x16x32_bf16 v[148:151], a[96:99], a[0:3], 0
    s_mov_b32 s50, s42
    s_add_u32 s56, s37, 1
    v_mov_b32 v47, v24
    v_mfma_f32_16x16x32_bf16 v[152:155], a[120:123], a[0:3], 0
    s_and_b32 s55, s56, 3
    s_mul_i32 s41, s55, 327680
    s_mul_i32 s56, s55, 114688
    v_mfma_f32_16x16x32_bf16 v[156:159], a[96:99], a[24:27], 0
    s_add_u32 s43, s38, s56
    s_xor_b32 s55, s55, 2
    s_mul_i32 s42, s55, 327680
    v_mfma_f32_16x16x32_bf16 v[160:163], a[120:123], a[24:27], 0
    s_add_u32 s56, s37, 2
    v_mov_b32 v107, s56
    s_and_b32 s55, s56, 3
    v_mfma_f32_16x16x32_bf16 v[180:183], a[96:99], a[48:51], 0
    s_mul_i32 s44, s55, 24576
    s_add_u32 s56, s37, -1
    s_and_b32 s55, s56, 3
    v_mfma_f32_16x16x32_bf16 v[184:187], a[120:123], a[48:51], 0
    s_mul_i32 s55, s55, 40960
    s_add_u32 s49, s55, s38
    s_add_u32 s56, s37, -1
    v_mfma_f32_16x16x32_bf16 v[188:191], a[96:99], a[72:75], 0
    s_and_b32 s55, s56, 3
    s_mul_i32 s55, s55, 24576
    v_add_u32 v26, s55, v22
    v_mfma_f32_16x16x32_bf16 v[192:195], a[120:123], a[72:75], 0
    buffer_load_dwordx4 a[96:99], v40, s[4:7], s45 offen offset:0 sc1
    v_mfma_f32_16x16x32_bf16 v[148:151], a[100:103], a[4:7], v[148:151]
    v_add_u32 v27, s55, v23
    s_and_b32 s55, s56, 1
    s_mul_i32 s55, s55, 12288
    v_mfma_f32_16x16x32_bf16 v[152:155], a[124:127], a[4:7], v[152:155]
    buffer_load_dwordx4 a[120:123], v40, s[4:7], s46 offen offset:2048 sc1
    v_mfma_f32_16x16x32_bf16 v[156:159], a[100:103], a[28:31], v[156:159]
    v_add_u32 v29, s55, v28
    v_mfma_f32_16x16x32_bf16 v[160:163], a[124:127], a[28:31], v[160:163]
    v_mfma_f32_16x16x32_bf16 v[180:183], a[100:103], a[52:55], v[180:183]
    v_mfma_f32_16x16x32_bf16 v[184:187], a[124:127], a[52:55], v[184:187]
    v_mfma_f32_16x16x32_bf16 v[188:191], a[100:103], a[76:79], v[188:191]
    v_mfma_f32_16x16x32_bf16 v[192:195], a[124:127], a[76:79], v[192:195]
    buffer_load_dwordx4 a[100:103], v40, s[4:7], s45 offen offset:1024 sc1
    v_mfma_f32_16x16x32_bf16 v[148:151], a[104:107], a[8:11], v[148:151]
    v_mfma_f32_16x16x32_bf16 v[152:155], a[128:131], a[8:11], v[152:155]
    buffer_load_dwordx4 a[124:127], v40, s[4:7], s46 offen offset:3072 sc1
    v_mfma_f32_16x16x32_bf16 v[156:159], a[104:107], a[32:35], v[156:159]
    v_mfma_f32_16x16x32_bf16 v[160:163], a[128:131], a[32:35], v[160:163]
    v_mfma_f32_16x16x32_bf16 v[180:183], a[104:107], a[56:59], v[180:183]
    v_mfma_f32_16x16x32_bf16 v[184:187], a[128:131], a[56:59], v[184:187]
    v_mfma_f32_16x16x32_bf16 v[188:191], a[104:107], a[80:83], v[188:191]
    v_mfma_f32_16x16x32_bf16 v[192:195], a[128:131], a[80:83], v[192:195]
    buffer_load_dwordx4 a[104:107], v40, s[4:7], s45 offen offset:2048 sc1
    v_mfma_f32_16x16x32_bf16 v[148:151], a[108:111], a[12:15], v[148:151]
    v_mfma_f32_16x16x32_bf16 v[152:155], a[132:135], a[12:15], v[152:155]
    buffer_load_dwordx4 a[128:131], v40, s[4:7], s47 offen offset:0 sc1
    v_mfma_f32_16x16x32_bf16 v[156:159], a[108:111], a[36:39], v[156:159]
    v_mfma_f32_16x16x32_bf16 v[160:163], a[132:135], a[36:39], v[160:163]
    v_mfma_f32_16x16x32_bf16 v[180:183], a[108:111], a[60:63], v[180:183]
    v_mfma_f32_16x16x32_bf16 v[184:187], a[132:135], a[60:63], v[184:187]
    v_mfma_f32_16x16x32_bf16 v[188:191], a[108:111], a[84:87], v[188:191]
    v_mfma_f32_16x16x32_bf16 v[192:195], a[132:135], a[84:87], v[192:195]
    buffer_load_dwordx4 a[108:111], v40, s[4:7], s45 offen offset:3072 sc1
    v_mfma_f32_16x16x32_bf16 v[148:151], a[112:115], a[16:19], v[148:151]
    v_mfma_f32_16x16x32_bf16 v[152:155], a[136:139], a[16:19], v[152:155]
    buffer_load_dwordx4 a[132:135], v40, s[4:7], s47 offen offset:1024 sc1
    v_mfma_f32_16x16x32_bf16 v[156:159], a[112:115], a[40:43], v[156:159]
    v_mfma_f32_16x16x32_bf16 v[160:163], a[136:139], a[40:43], v[160:163]
    v_mfma_f32_16x16x32_bf16 v[180:183], a[112:115], a[64:67], v[180:183]
    v_mfma_f32_16x16x32_bf16 v[184:187], a[136:139], a[64:67], v[184:187]
    v_mfma_f32_16x16x32_bf16 v[188:191], a[112:115], a[88:91], v[188:191]
    v_mfma_f32_16x16x32_bf16 v[192:195], a[136:139], a[88:91], v[192:195]
    buffer_load_dwordx4 a[112:115], v40, s[4:7], s46 offen offset:0 sc1
    v_mfma_f32_16x16x32_bf16 v[148:151], a[116:119], a[20:23], v[148:151]
    v_mfma_f32_16x16x32_bf16 v[152:155], a[140:143], a[20:23], v[152:155]
    v_mfma_f32_16x16x32_bf16 v[156:159], a[116:119], a[44:47], v[156:159]
    v_mfma_f32_16x16x32_bf16 v[160:163], a[140:143], a[44:47], v[160:163]
    v_mfma_f32_16x16x32_bf16 v[180:183], a[116:119], a[68:71], v[180:183]
    v_mfma_f32_16x16x32_bf16 v[184:187], a[140:143], a[68:71], v[184:187]
    v_mfma_f32_16x16x32_bf16 v[188:191], a[116:119], a[92:95], v[188:191]
    v_mfma_f32_16x16x32_bf16 v[192:195], a[140:143], a[92:95], v[192:195]
    v_cvt_pk_bf16_f32 v64, v180, v181
    v_cvt_pk_bf16_f32 v65, v182, v183
    ds_write_b64 v24, v[64:65] offset:12288
    v_cvt_pk_bf16_f32 v68, v184, v185
    v_cvt_pk_bf16_f32 v69, v186, v187
    ds_write_b64 v25, v[68:69] offset:12288
    v_cvt_pk_bf16_f32 v72, v188, v189
    v_cvt_pk_bf16_f32 v73, v190, v191
    ds_write_b64 v24, v[72:73] offset:18432
    v_cvt_pk_bf16_f32 v76, v192, v193
    v_cvt_pk_bf16_f32 v77, v194, v195
    ds_write_b64 v25, v[76:77] offset:18432
    v_cvt_pk_bf16_f32 v48, v148, v149
    v_cvt_pk_bf16_f32 v49, v150, v151
    ds_write_b64 v24, v[48:49] offset:0
    v_cvt_pk_bf16_f32 v52, v152, v153
    v_cvt_pk_bf16_f32 v53, v154, v155
    ds_write_b64 v25, v[52:53] offset:0
    v_cvt_pk_bf16_f32 v56, v156, v157
    v_cvt_pk_bf16_f32 v57, v158, v159
    ds_write_b64 v24, v[56:57] offset:6144
    v_cvt_pk_bf16_f32 v60, v160, v161
    v_cvt_pk_bf16_f32 v61, v162, v163
    ds_write_b64 v25, v[60:61] offset:6144
    s_add_u32 s37, s37, 1
    s_mov_b32 m0, s53
    v_add_u32 v24, s44, v20
    v_add_u32 v25, s44, v21
    v_pk_mul_f32 v[148:149], v[210:211], v[210:211]
    v_pk_mul_f32 v[150:151], v[210:211], v[210:211]
    v_pk_mul_f32 v[152:153], v[210:211], v[210:211]
    v_pk_mul_f32 v[154:155], v[210:211], v[210:211]
    v_pk_mul_f32 v[156:157], v[210:211], v[210:211]
    v_pk_mul_f32 v[158:159], v[210:211], v[210:211]
    v_pk_mul_f32 v[160:161], v[210:211], v[210:211]
    v_pk_mul_f32 v[162:163], v[210:211], v[210:211]
    buffer_load_dwordx4 a[136:139], v40, s[4:7], s47 offen offset:2048 sc1
    buffer_load_dwordx4 a[116:119], v40, s[4:7], s46 offen offset:1024 sc1
    buffer_load_dwordx4 a[140:143], v40, s[4:7], s47 offen offset:3072 sc1
    s_branch L_wo_loop_s
L_wo_tail_s:
L_tv_111:
    buffer_load_dwordx4 v44, s[4:7], s43 offen offset:0 sc1 lds
    buffer_load_dwordx4 v44, s[4:7], s43 offen offset:1024 sc1 lds
    buffer_load_dwordx4 v44, s[4:7], s43 offen offset:2048 sc1 lds
    s_sub_u32 s36, s36, 1
    s_cbranch_scc1 L_exit
    v_add_u32 v5, s53, v12
    s_waitcnt vmcnt(0)
    ds_read_b128 v[136:139], v5 offset:0
    ds_read_b128 v[140:143], v5 offset:1024
    ds_read_b128 v[144:147], v5 offset:2048
    s_waitcnt lgkmcnt(0)
    v_max_u32 v4, v136, v137
    v_max3_u32 v4, v4, v138, v139
    v_max3_u32 v4, v4, v140, v141
    v_max3_u32 v4, v4, v142, v143
    v_max3_u32 v4, v4, v144, v145
    v_max3_u32 v4, v4, v146, v147
    v_cmp_eq_u32 vcc, -1, v4
    s_cbranch_vccnz L_tv_111
    ds_read_b64_tr_b16 v[136:137], v16 offset:0
    ds_read_b64_tr_b16 v[138:139], v13 offset:0
    ds_read_b64_tr_b16 v[140:141], v16 offset:1024
    ds_read_b64_tr_b16 v[142:143], v13 offset:1024
    ds_read_b64_tr_b16 v[144:145], v16 offset:2048
    ds_read_b64_tr_b16 v[146:147], v13 offset:2048
    v_mov_b32 v148, 0
    v_mov_b32 v149, 0
    v_mov_b32 v150, 0
    v_mov_b32 v151, 0
    v_mov_b32 v152, 0
    v_mov_b32 v153, 0
    v_mov_b32 v154, 0
    v_mov_b32 v155, 0
    v_mov_b32 v156, 0
    v_mov_b32 v157, 0
    v_mov_b32 v158, 0
    v_mov_b32 v159, 0
    v_mov_b32 v160, 0
    v_mov_b32 v161, 0
    v_mov_b32 v162, 0
    v_mov_b32 v163, 0
    s_waitcnt lgkmcnt(0)
    v_smfmac_f32_16x16x64_bf16 v[148:151], v[136:139], a[0:7], v10
    v_smfmac_f32_16x16x64_bf16 v[152:155], v[136:139], a[24:31], v10
    v_smfmac_f32_16x16x64_bf16 v[156:159], v[136:139], a[48:55], v10
    v_smfmac_f32_16x16x64_bf16 v[160:163], v[136:139], a[72:79], v10
    v_smfmac_f32_16x16x64_bf16 v[148:151], v[140:143], a[8:15], v10
    v_smfmac_f32_16x16x64_bf16 v[152:155], v[140:143], a[32:39], v10
    v_smfmac_f32_16x16x64_bf16 v[156:159], v[140:143], a[56:63], v10
    v_smfmac_f32_16x16x64_bf16 v[160:163], v[140:143], a[80:87], v10
    v_smfmac_f32_16x16x64_bf16 v[148:151], v[144:147], a[16:23], v10
    v_smfmac_f32_16x16x64_bf16 v[152:155], v[144:147], a[40:47], v10
    v_smfmac_f32_16x16x64_bf16 v[156:159], v[144:147], a[64:71], v10
    v_smfmac_f32_16x16x64_bf16 v[160:163], v[144:147], a[88:95], v10
    v_pk_add_f32 v[148:149], v[148:149], v[150:151]
    v_cvt_pk_bf16_f32 v50, v148, v149
    v_cvt_pk_bf16_f32 v54, v148, v149
    v_pk_add_f32 v[152:153], v[152:153], v[154:155]
    v_cvt_pk_bf16_f32 v58, v152, v153
    v_cvt_pk_bf16_f32 v62, v152, v153
    v_pk_add_f32 v[156:157], v[156:157], v[158:159]
    v_cvt_pk_bf16_f32 v66, v156, v157
    v_cvt_pk_bf16_f32 v70, v156, v157
    v_pk_add_f32 v[160:161], v[160:161], v[162:163]
    v_cvt_pk_bf16_f32 v74, v160, v161
    v_cvt_pk_bf16_f32 v78, v160, v161
    ds_write_b32 v47, v50 offset:8
    ds_write_b32 v47, v58 offset:6152
    ds_write_b32 v47, v66 offset:12296
    ds_write_b32 v47, v74 offset:18440
    s_add_u32 s91, s38, 81920
    buffer_load_dwordx4 v[120:123], v15, s[4:7], s91 offen sc1
    s_add_u32 s91, s38, 122880
    buffer_load_dwordx4 v[124:127], v15, s[4:7], s91 offen sc1
    s_add_u32 s56, s37, -1
    s_and_b32 s55, s56, 3
    s_mul_i32 s55, s55, 114688
    s_add_u32 s55, s55, 53248
    s_add_u32 s48, s38, s55
    s_and_b32 s55, s56, 1
    s_add_u32 s56, s56, 1
    v_mov_b32 v35, -16
    v_writelane_b32 v35, s56, 12
    s_mul_i32 s55, s55, 12288
    s_add_u32 m0, s54, s55
    buffer_load_dword v36, v33, s[4:7], s38 offen sc1
    v_mov_b32 v3, 204
L_p0_112:
    buffer_load_dword v4, v3, s[8:11], 0 offen sc1
    s_sub_u32 s36, s36, 1
    s_cbranch_scc1 L_exit
    s_waitcnt vmcnt(0)
    v_readfirstlane_b32 s90, v4
    s_nop 0
    s_cmp_eq_u32 s90, 0
    s_cbranch_scc1 L_p0_112
    s_and_b32 s90, s90, 2
    s_lshl_b32 s90, s90, 12
    v_xor_b32 v30, s90, v30
    v_xor_b32 v31, s90, v31
    s_waitcnt lgkmcnt(0)
    s_barrier
    v_cmp_lt_i32 vcc, v36, v35
    s_cbranch_vccz L_fok_114
L_fw_113:
    buffer_load_dword v36, v33, s[4:7], s38 offen sc1
    s_sub_u32 s36, s36, 1
    s_cbranch_scc1 L_exit
    s_waitcnt vmcnt(0)
    v_cmp_lt_i32 vcc, v36, v35
    s_cbranch_vccnz L_fw_113
L_fok_114:
    buffer_load_dwordx4 v37, s[4:7], s48 offen offset:0 sc1 lds
    buffer_load_dwordx4 v37, s[4:7], s48 offen offset:1024 sc1 lds
    buffer_load_dwordx4 v37, s[4:7], s48 offen offset:2048 sc1 lds
    v_mov_b32 v128, v220
    v_mov_b32 v129, v221
    v_mov_b32 v130, v222
    v_mov_b32 v131, v223
    s_add_u32 s56, s37, -2
    s_and_b32 s55, s56, 3
    s_mul_i32 s55, s55, 24576
    v_add_u32 v26, s55, v22
    v_add_u32 v27, s55, v23
    s_and_b32 s55, s56, 1
    s_mul_i32 s55, s55, 12288
    v_add_u32 v29, s55, v28
    ds_read_b128 v[204:207], v26 offset:0
    ds_read_b128 v[180:183], v29 offset:0
    ds_read_b128 v[184:187], v29 offset:1024
    ds_read_b64 v[208:209], v27 offset:0
    ds_read_b128 v[188:191], v29 offset:2048
    ds_read_b128 v[212:215], v26 offset:1536
    ds_read_b128 v[192:195], v29 offset:3072
    ds_read_b128 v[196:199], v29 offset:4096
    ds_read_b64 v[216:217], v27 offset:1536
    ds_read_b128 v[200:203], v29 offset:5120
    s_waitcnt lgkmcnt(5)
    v_mfma_f32_16x16x32_bf16 v[220:223], v[180:183], v[204:207], 0
    v_mfma_f32_16x16x32_bf16 v[224:227], v[184:187], v[204:207], 0
    v_mfma_f32_16x16x32_bf16 v[224:227], v[188:191], v[208:211], v[224:227]
    ds_read_b128 v[204:207], v26 offset:3072
    ds_read_b128 v[180:183], v29 offset:6144
    ds_read_b128 v[184:187], v29 offset:7168
    ds_read_b64 v[208:209], v27 offset:3072
    ds_read_b128 v[188:191], v29 offset:8192
    s_waitcnt lgkmcnt(5)
    v_mfma_f32_16x16x32_bf16 v[220:223], v[192:195], v[212:215], v[220:223]
    v_mfma_f32_16x16x32_bf16 v[224:227], v[196:199], v[212:215], v[224:227]
    v_mfma_f32_16x16x32_bf16 v[224:227], v[200:203], v[216:219], v[224:227]
    ds_read_b128 v[212:215], v26 offset:4608
    ds_read_b128 v[192:195], v29 offset:9216
    ds_read_b128 v[196:199], v29 offset:10240
    ds_read_b64 v[216:217], v27 offset:4608
    ds_read_b128 v[200:203], v29 offset:11264
    s_waitcnt lgkmcnt(5)
    v_mfma_f32_16x16x32_bf16 v[220:223], v[180:183], v[204:207], v[220:223]
    v_mfma_f32_16x16x32_bf16 v[224:227], v[184:187], v[204:207], v[224:227]
    v_mfma_f32_16x16x32_bf16 v[224:227], v[188:191], v[208:211], v[224:227]
    s_waitcnt lgkmcnt(0)
    v_mfma_f32_16x16x32_bf16 v[220:223], v[192:195], v[212:215], v[220:223]
    v_mfma_f32_16x16x32_bf16 v[224:227], v[196:199], v[212:215], v[224:227]
    v_mfma_f32_16x16x32_bf16 v[224:227], v[200:203], v[216:219], v[224:227]
    s_nop 0
    v_cvt_pk_bf16_f32 v220, v220, v221
    v_cvt_pk_bf16_f32 v221, v222, v223
    s_nop 4
    v_cvt_pk_bf16_f32 v222, v224, v225
    v_cvt_pk_bf16_f32 v223, v226, v227
    v_mov_b32 v224, v220
    v_mov_b32 v225, v221
    v_mov_b32_dpp v220, v222 row_ror:8 row_mask:0xf bank_mask:0xc
    v_mov_b32_dpp v221, v223 row_ror:8 row_mask:0xf bank_mask:0xc
    v_mov_b32_dpp v222, v224 row_ror:8 row_mask:0xf bank_mask:0x3
    v_mov_b32_dpp v223, v225 row_ror:8 row_mask:0xf bank_mask:0x3
    v_mov_b32 v132, v220
    v_mov_b32 v133, v221
    v_mov_b32 v134, v222
    v_mov_b32 v135, v223
    s_waitcnt vmcnt(0)
    s_barrier
    s_add_u32 s56, s37, -1
    s_and_b32 s55, s56, 3
    s_mul_i32 s55, s55, 24576
    v_add_u32 v26, s55, v22
    v_add_u32 v27, s55, v23
    s_and_b32 s55, s56, 1
    s_mul_i32 s55, s55, 12288
    v_add_u32 v29, s55, v28
    ds_read_b128 v[204:207], v26 offset:0
    ds_read_b128 v[180:183], v29 offset:0
    ds_read_b128 v[184:187], v29 offset:1024
    ds_read_b64 v[208:209], v27 offset:0
    ds_read_b128 v[188:191], v29 offset:2048
    ds_read_b128 v[212:215], v26 offset:1536
    ds_read_b128 v[192:195], v29 offset:3072
    ds_read_b128 v[196:199], v29 offset:4096
    ds_read_b64 v[216:217], v27 offset:1536
    ds_read_b128 v[200:203], v29 offset:5120
    s_waitcnt lgkmcnt(5)
    v_mfma_f32_16x16x32_bf16 v[220:223], v[180:183], v[204:207], 0
    v_mfma_f32_16x16x32_bf16 v[224:227], v[184:187], v[204:207], 0
    v_mfma_f32_16x16x32_bf16 v[224:227], v[188:191], v[208:211], v[224:227]
    ds_read_b128 v[204:207], v26 offset:3072
    ds_read_b128 v[180:183], v29 offset:6144
    ds_read_b128 v[184:187], v29 offset:7168
    ds_read_b64 v[208:209], v27 offset:3072
    ds_read_b128 v[188:191], v29 offset:8192
    s_waitcnt lgkmcnt(5)
    v_mfma_f32_16x16x32_bf16 v[220:223], v[192:195], v[212:215], v[220:223]
    v_mfma_f32_16x16x32_bf16 v[224:227], v[196:199], v[212:215], v[224:227]
    v_mfma_f32_16x16x32_bf16 v[224:227], v[200:203], v[216:219], v[224:227]
    ds_read_b128 v[212:215], v26 offset:4608
    ds_read_b128 v[192:195], v29 offset:9216
    ds_read_b128 v[196:199], v29 offset:10240
    ds_read_b64 v[216:217], v27 offset:4608
    ds_read_b128 v[200:203], v29 offset:11264
    s_waitcnt lgkmcnt(5)
    v_mfma_f32_16x16x32_bf16 v[220:223], v[180:183], v[204:207], v[220:223]
    v_mfma_f32_16x16x32_bf16 v[224:227], v[184:187], v[204:207], v[224:227]
    v_mfma_f32_16x16x32_bf16 v[224:227], v[188:191], v[208:211], v[224:227]
    s_waitcnt lgkmcnt(0)
    v_mfma_f32_16x16x32_bf16 v[220:223], v[192:195], v[212:215], v[220:223]
    v_mfma_f32_16x16x32_bf16 v[224:227], v[196:199], v[212:215], v[224:227]
    v_mfma_f32_16x16x32_bf16 v[224:227], v[200:203], v[216:219], v[224:227]
    s_nop 0
    v_cvt_pk_bf16_f32 v220, v220, v221
    v_cvt_pk_bf16_f32 v221, v222, v223
    s_nop 4
    v_cvt_pk_bf16_f32 v222, v224, v225
    v_cvt_pk_bf16_f32 v223, v226, v227
    v_mov_b32 v224, v220
    v_mov_b32 v225, v221
    v_mov_b32_dpp v220, v222 row_ror:8 row_mask:0xf bank_mask:0xc
    v_mov_b32_dpp v221, v223 row_ror:8 row_mask:0xf bank_mask:0xc
    v_mov_b32_dpp v222, v224 row_ror:8 row_mask:0xf bank_mask:0x3
    v_mov_b32_dpp v223, v225 row_ror:8 row_mask:0xf bank_mask:0x3
    v_mov_b32 v80, v220
    v_mov_b32 v81, v221
    v_mov_b32 v82, v222
    v_mov_b32 v83, v223
    s_add_u32 s56, s37, 0
    s_and_b32 s55, s56, 3
    s_mul_i32 s55, s55, 114688
    s_add_u32 s55, s55, 53248
    s_add_u32 s48, s38, s55
    s_and_b32 s55, s56, 1
    s_add_u32 s56, s56, 1
    v_mov_b32 v35, -16
    v_writelane_b32 v35, s56, 12
    s_mul_i32 s55, s55, 12288
    s_add_u32 m0, s54, s55
    s_add_u32 s56, s37, 0
    s_and_b32 s55, s56, 3
    s_mul_i32 s55, s55, 24576
    v_add_u32 v26, s55, v22
    v_add_u32 v27, s55, v23
    s_and_b32 s55, s56, 1
    s_mul_i32 s55, s55, 12288
    v_add_u32 v29, s55, v28
    buffer_load_dword v36, v33, s[4:7], s38 offen sc1
    buffer_load_dword v36, v33, s[4:7], s38 offen sc1
    buffer_load_dword v36, v33, s[4:7], s38 offen sc1
    buffer_load_dword v36, v33, s[4:7], s38 offen sc1
    buffer_load_dword v36, v33, s[4:7], s38 offen sc1
L_sp_115:
    s_waitcnt vmcnt(4)
    v_cmp_lt_i32 vcc, v36, v35
    buffer_load_dword v36, v33, s[4:7], s38 offen sc1
    s_sub_u32 s36, s36, 1
    s_cbranch_scc1 L_exit
    s_cbranch_vccz L_sp_115x
    s_waitcnt vmcnt(4)
    v_cmp_lt_i32 vcc, v36, v35
    buffer_load_dword v36, v33, s[4:7], s38 offen sc1
    s_cbranch_vccz L_sp_115x
    s_waitcnt vmcnt(4)
    v_cmp_lt_i32 vcc, v36, v35
    buffer_load_dword v36, v33, s[4:7], s38 offen sc1
    s_cbranch_vccz L_sp_115x
    s_waitcnt vmcnt(4)
    v_cmp_lt_i32 vcc, v36, v35
    buffer_load_dword v36, v33, s[4:7], s38 offen sc1
    s_cbranch_vccnz L_sp_115
L_sp_115x:
    buffer_load_dwordx4 v37, s[4:7], s48 offen offset:0 sc1 lds
    buffer_load_dwordx4 v37, s[4:7], s48 offen offset:1024 sc1 lds
    buffer_load_dwordx4 v37, s[4:7], s48 offen offset:2048 sc1 lds
    s_waitcnt vmcnt(0)
    s_barrier
    s_mov_b32 s49, 7143424
    buffer_store_dwordx4 v[120:123], v30, s[4:7], s49 offen sc1
    s_mov_b32 s49, 6815744
    buffer_store_dwordx4 v[124:127], v30, s[4:7], s49 offen sc1
    s_mov_b32 s49, 6488064
    buffer_store_dwordx4 v[128:131], v30, s[4:7], s49 offen sc1
    s_mov_b32 s49, 6160384
    buffer_store_dwordx4 v[132:135], v30, s[4:7], s49 offen sc1
    s_mov_b32 s49, 5832704
    buffer_store_dwordx4 v[80:83], v30, s[4:7], s49 offen sc1
    ds_read_b128 v[204:207], v26 offset:0
    ds_read_b128 v[180:183], v29 offset:0
    ds_read_b128 v[184:187], v29 offset:1024
    ds_read_b64 v[208:209], v27 offset:0
    ds_read_b128 v[188:191], v29 offset:2048
    ds_read_b128 v[212:215], v26 offset:1536
    ds_read_b128 v[192:195], v29 offset:3072
    ds_read_b128 v[196:199], v29 offset:4096
    ds_read_b64 v[216:217], v27 offset:1536
    ds_read_b128 v[200:203], v29 offset:5120
    s_waitcnt lgkmcnt(5)
    v_mfma_f32_16x16x32_bf16 v[220:223], v[180:183], v[204:207], 0
    v_mfma_f32_16x16x32_bf16 v[224:227], v[184:187], v[204:207], 0
    v_mfma_f32_16x16x32_bf16 v[224:227], v[188:191], v[208:211], v[224:227]
    ds_read_b128 v[204:207], v26 offset:3072
    ds_read_b128 v[180:183], v29 offset:6144
    ds_read_b128 v[184:187], v29 offset:7168
    ds_read_b64 v[208:209], v27 offset:3072
    ds_read_b128 v[188:191], v29 offset:8192
    s_waitcnt lgkmcnt(5)
    v_mfma_f32_16x16x32_bf16 v[220:223], v[192:195], v[212:215], v[220:223]
    v_mfma_f32_16x16x32_bf16 v[224:227], v[196:199], v[212:215], v[224:227]
    v_mfma_f32_16x16x32_bf16 v[224:227], v[200:203], v[216:219], v[224:227]
    ds_read_b128 v[212:215], v26 offset:4608
    ds_read_b128 v[192:195], v29 offset:9216
    ds_read_b128 v[196:199], v29 offset:10240
    ds_read_b64 v[216:217], v27 offset:4608
    ds_read_b128 v[200:203], v29 offset:11264
    s_waitcnt lgkmcnt(5)
    v_mfma_f32_16x16x32_bf16 v[220:223], v[180:183], v[204:207], v[220:223]
    v_mfma_f32_16x16x32_bf16 v[224:227], v[184:187], v[204:207], v[224:227]
    v_mfma_f32_16x16x32_bf16 v[224:227], v[188:191], v[208:211], v[224:227]
    s_waitcnt lgkmcnt(0)
    v_mfma_f32_16x16x32_bf16 v[220:223], v[192:195], v[212:215], v[220:223]
    v_mfma_f32_16x16x32_bf16 v[224:227], v[196:199], v[212:215], v[224:227]
    v_mfma_f32_16x16x32_bf16 v[224:227], v[200:203], v[216:219], v[224:227]
    s_nop 0
    v_cvt_pk_bf16_f32 v220, v220, v221
    v_cvt_pk_bf16_f32 v221, v222, v223
    s_nop 4
    v_cvt_pk_bf16_f32 v222, v224, v225
    v_cvt_pk_bf16_f32 v223, v226, v227
    v_mov_b32 v224, v220
    v_mov_b32 v225, v221
    v_mov_b32_dpp v220, v222 row_ror:8 row_mask:0xf bank_mask:0xc
    v_mov_b32_dpp v221, v223 row_ror:8 row_mask:0xf bank_mask:0xc
    v_mov_b32_dpp v222, v224 row_ror:8 row_mask:0xf bank_mask:0x3
    v_mov_b32_dpp v223, v225 row_ror:8 row_mask:0xf bank_mask:0x3
    s_mov_b32 s49, 5505024
    buffer_store_dwordx4 v[220:223], v30, s[4:7], s49 offen sc1
    s_waitcnt vmcnt(0)
L_fp_116:
    s_mov_b32 s51, 5505024
    buffer_load_dwordx4 v[96:99], v31, s[4:7], s51 offen sc1
    s_mov_b32 s51, 7143424
    buffer_load_dwordx4 v[148:151], v31, s[4:7], s51 offen sc1
    s_mov_b32 s51, 6815744
    buffer_load_dwordx4 v[152:155], v31, s[4:7], s51 offen sc1
    s_mov_b32 s51, 6488064
    buffer_load_dwordx4 v[156:159], v31, s[4:7], s51 offen sc1
    s_mov_b32 s51, 6160384
    buffer_load_dwordx4 v[160:163], v31, s[4:7], s51 offen sc1
    s_mov_b32 s51, 5832704
    buffer_load_dwordx4 v[92:95], v31, s[4:7], s51 offen sc1
    s_sub_u32 s36, s36, 1
    s_cbranch_scc1 L_exit
    s_waitcnt vmcnt(0)
L_fp_116c:
    v_mov_b32 v41, 0
    v_max3_u32 v41, v41, v96, v97
    v_max3_u32 v41, v41, v98, v99
    v_max3_u32 v41, v41, v148, v149
    v_max3_u32 v41, v41, v150, v151
    v_max3_u32 v41, v41, v152, v153
    v_max3_u32 v41, v41, v154, v155
    v_max3_u32 v41, v41, v156, v157
    v_max3_u32 v41, v41, v158, v159
    v_max3_u32 v41, v41, v160, v161
    v_max3_u32 v41, v41, v162, v163
    v_max3_u32 v41, v41, v92, v93
    v_max3_u32 v41, v41, v94, v95
    v_cmp_eq_u32 vcc, -1, v41
    s_cbranch_vccnz L_fp_116
    s_mov_b32 s52, 5160960
    v_mfma_f32_16x16x32_bf16 v[232:235], a[144:147], v[96:99], 0
    s_nop 7
    v_cndmask_b32 v234, v232, v233, s[58:59]
    v_cndmask_b32 v235, v233, v232, s[58:59]
    s_nop 1
    v_add_f32_dpp v235, v234, v235 row_ror:8 row_mask:0xf bank_mask:0xf
    v_cvt_pk_bf16_f32 v235, v235, v235
    buffer_store_short v235, v32, s[28:31], s52 offen offset:0
    s_mov_b32 s52, 4751360
    v_mfma_f32_16x16x32_bf16 v[232:235], a[144:147], v[148:151], 0
    s_nop 7
    v_cndmask_b32 v234, v232, v233, s[58:59]
    v_cndmask_b32 v235, v233, v232, s[58:59]
    s_nop 1
    v_add_f32_dpp v235, v234, v235 row_ror:8 row_mask:0xf bank_mask:0xf
    v_cvt_pk_bf16_f32 v235, v235, v235
    buffer_store_short v235, v32, s[28:31], s52 offen offset:0
    s_mov_b32 s52, 4833280
    v_mfma_f32_16x16x32_bf16 v[232:235], a[144:147], v[152:155], 0
    s_nop 7
    v_cndmask_b32 v234, v232, v233, s[58:59]
    v_cndmask_b32 v235, v233, v232, s[58:59]
    s_nop 1
    v_add_f32_dpp v235, v234, v235 row_ror:8 row_mask:0xf bank_mask:0xf
    v_cvt_pk_bf16_f32 v235, v235, v235
    buffer_store_short v235, v32, s[28:31], s52 offen offset:0
    s_mov_b32 s52, 4915200
    v_mfma_f32_16x16x32_bf16 v[232:235], a[144:147], v[156:159], 0
    s_nop 7
    v_cndmask_b32 v234, v232, v233, s[58:59]
    v_cndmask_b32 v235, v233, v232, s[58:59]
    s_nop 1
    v_add_f32_dpp v235, v234, v235 row_ror:8 row_mask:0xf bank_mask:0xf
    v_cvt_pk_bf16_f32 v235, v235, v235
    buffer_store_short v235, v32, s[28:31], s52 offen offset:0
    s_mov_b32 s52, 4997120
    v_mfma_f32_16x16x32_bf16 v[232:235], a[144:147], v[160:163], 0
    s_nop 7
    v_cndmask_b32 v234, v232, v233, s[58:59]
    v_cndmask_b32 v235, v233, v232, s[58:59]
    s_nop 1
    v_add_f32_dpp v235, v234, v235 row_ror:8 row_mask:0xf bank_mask:0xf
    v_cvt_pk_bf16_f32 v235, v235, v235
    buffer_store_short v235, v32, s[28:31], s52 offen offset:0
    s_mov_b32 s52, 5079040
    v_mfma_f32_16x16x32_bf16 v[232:235], a[144:147], v[92:95], 0
    s_nop 7
    v_cndmask_b32 v234, v232, v233, s[58:59]
    v_cndmask_b32 v235, v233, v232, s[58:59]
    s_nop 1
    v_add_f32_dpp v235, v234, v235 row_ror:8 row_mask:0xf bank_mask:0xf
    v_cvt_pk_bf16_f32 v235, v235, v235
    buffer_store_short v235, v32, s[28:31], s52 offen offset:0
    s_endpgm
L_sd_90c:
    v_mov_b32 v3, 204
L_p0_117:
    buffer_load_dword v4, v3, s[8:11], 0 offen sc1
    s_sub_u32 s36, s36, 1
    s_cbranch_scc1 L_exit
    s_waitcnt vmcnt(0)
    v_readfirstlane_b32 s90, v4
    s_nop 0
    s_cmp_eq_u32 s90, 0
    s_cbranch_scc1 L_p0_117
    s_and_b32 s90, s90, 2
    s_lshl_b32 s90, s90, 12
    v_xor_b32 v140, s90, v140
    v_xor_b32 v141, s90, v141
    v_xor_b32 v143, s90, v143
    v_xor_b32 v144, s90, v144
    s_branch L_sd_90
L_an_91:
    s_cmp_lg_u32 s55, 0
    s_cbranch_scc1 L_an_91x
    buffer_load_dword v139, v142, s[4:7], s38 offen sc1
    buffer_load_dword v139, v142, s[4:7], s38 offen sc1
    buffer_load_dword v139, v142, s[4:7], s38 offen sc1
L_sp_118:
    buffer_load_dword v139, v142, s[4:7], s38 offen sc1
    s_sub_u32 s36, s36, 1
    s_cbranch_scc1 L_exit
    s_waitcnt vmcnt(3)
    v_cmp_ge_u32 vcc, s37, v139
    s_cbranch_vccnz L_sp_118
L_an_91x:
    s_barrier
    s_lshl_b32 s90, s32, 10
    s_add_u32 m0, s90, s47
    s_waitcnt lgkmcnt(2)
    v_mfma_f32_16x16x32_bf16 v[108:111], a[0:3], v[84:87], 0
    ds_read_b128 v[100:103], v11 offset:4096
    s_add_u32 s51, s37, 3
    v_mfma_f32_16x16x32_bf16 v[112:115], a[0:3], v[88:91], 0
    ds_read_b128 v[104:107], v11 offset:6144
    s_and_b32 s50, s51, 3
    v_mfma_f32_16x16x32_bf16 v[116:119], a[80:83], v[84:87], 0
    s_mul_i32 s50, s50, 114688
    s_add_u32 s50, s50, 65536
    v_mfma_f32_16x16x32_bf16 v[120:123], a[80:83], v[88:91], 0
    s_waitcnt lgkmcnt(2)
    s_add_u32 s44, s38, s50
    v_mfma_f32_16x16x32_bf16 v[108:111], a[4:7], v[92:95], v[108:111]
    ds_read_b128 v[84:87], v12 offset:4096
    s_add_u32 s45, s44, s56
    v_mfma_f32_16x16x32_bf16 v[112:115], a[4:7], v[96:99], v[112:115]
    ds_read_b128 v[88:91], v12 offset:6144
    s_add_u32 s37, s37, 1
    v_mfma_f32_16x16x32_bf16 v[116:119], a[84:87], v[92:95], v[116:119]
    s_mov_b32 s52, 0
    s_and_b32 s50, s37, 3
    v_mfma_f32_16x16x32_bf16 v[120:123], a[84:87], v[96:99], v[120:123]
    s_waitcnt lgkmcnt(2)
    s_mul_i32 s51, s50, 114688
    v_mfma_f32_16x16x32_bf16 v[108:111], a[8:11], v[100:103], v[108:111]
    ds_read_b128 v[92:95], v11 offset:8192
    s_add_u32 s41, s38, s51
    v_mfma_f32_16x16x32_bf16 v[112:115], a[8:11], v[104:107], v[112:115]
    ds_read_b128 v[96:99], v11 offset:10240
    v_mfma_f32_16x16x32_bf16 v[116:119], a[88:91], v[100:103], v[116:119]
    v_mfma_f32_16x16x32_bf16 v[120:123], a[88:91], v[104:107], v[120:123]
    s_waitcnt lgkmcnt(2)
    v_mfma_f32_16x16x32_bf16 v[108:111], a[12:15], v[84:87], v[108:111]
    ds_read_b128 v[100:103], v12 offset:8192
    v_mfma_f32_16x16x32_bf16 v[112:115], a[12:15], v[88:91], v[112:115]
    ds_read_b128 v[104:107], v12 offset:10240
    v_mfma_f32_16x16x32_bf16 v[116:119], a[92:95], v[84:87], v[116:119]
    v_mfma_f32_16x16x32_bf16 v[120:123], a[92:95], v[88:91], v[120:123]
    buffer_store_dword v20, v140, s[4:7], 0 offen sc1
    s_waitcnt lgkmcnt(2)
    v_mfma_f32_16x16x32_bf16 v[108:111], a[16:19], v[92:95], v[108:111]
    ds_read_b128 v[84:87], v11 offset:12288
    v_mfma_f32_16x16x32_bf16 v[112:115], a[16:19], v[96:99], v[112:115]
    ds_read_b128 v[88:91], v11 offset:14336
    v_mfma_f32_16x16x32_bf16 v[116:119], a[96:99], v[92:95], v[116:119]
    v_mfma_f32_16x16x32_bf16 v[120:123], a[96:99], v[96:99], v[120:123]
    buffer_store_dword v20, v141, s[4:7], 0 offen sc1
    s_waitcnt lgkmcnt(2)
    v_mfma_f32_16x16x32_bf16 v[108:111], a[20:23], v[100:103], v[108:111]
    ds_read_b128 v[92:95], v12 offset:12288
    v_mfma_f32_16x16x32_bf16 v[112:115], a[20:23], v[104:107], v[112:115]
    ds_read_b128 v[96:99], v12 offset:14336
    v_mfma_f32_16x16x32_bf16 v[116:119], a[100:103], v[100:103], v[116:119]
    v_mfma_f32_16x16x32_bf16 v[120:123], a[100:103], v[104:107], v[120:123]
    s_waitcnt lgkmcnt(2)
    v_mfma_f32_16x16x32_bf16 v[108:111], a[24:27], v[84:87], v[108:111]
    ds_read_b128 v[100:103], v11 offset:16384
    v_mfma_f32_16x16x32_bf16 v[112:115], a[24:27], v[88:91], v[112:115]
    ds_read_b128 v[104:107], v11 offset:18432
    v_mfma_f32_16x16x32_bf16 v[116:119], a[104:107], v[84:87], v[116:119]
    v_mfma_f32_16x16x32_bf16 v[120:123], a[104:107], v[88:91], v[120:123]
    s_waitcnt lgkmcnt(2)
    v_mfma_f32_16x16x32_bf16 v[108:111], a[28:31], v[92:95], v[108:111]
    ds_read_b128 v[84:87], v12 offset:16384
    v_mfma_f32_16x16x32_bf16 v[112:115], a[28:31], v[96:99], v[112:115]
    ds_read_b128 v[88:91], v12 offset:18432
    v_mfma_f32_16x16x32_bf16 v[116:119], a[108:111], v[92:95], v[116:119]
    v_mfma_f32_16x16x32_bf16 v[120:123], a[108:111], v[96:99], v[120:123]
    s_waitcnt lgkmcnt(2)
    v_mfma_f32_16x16x32_bf16 v[108:111], a[32:35], v[100:103], v[108:111]
    ds_read_b128 v[92:95], v11 offset:20480
    v_mfma_f32_16x16x32_bf16 v[112:115], a[32:35], v[104:107], v[112:115]
    ds_read_b128 v[96:99], v11 offset:22528
    v_mfma_f32_16x16x32_bf16 v[116:119], a[112:115], v[100:103], v[116:119]
    v_mfma_f32_16x16x32_bf16 v[120:123], a[112:115], v[104:107], v[120:123]
    s_waitcnt lgkmcnt(2)
    v_mfma_f32_16x16x32_bf16 v[108:111], a[36:39], v[84:87], v[108:111]
    ds_read_b128 v[100:103], v12 offset:20480
    v_mfma_f32_16x16x32_bf16 v[112:115], a[36:39], v[88:91], v[112:115]
    ds_read_b128 v[104:107], v12 offset:22528
    v_mfma_f32_16x16x32_bf16 v[116:119], a[116:119], v[84:87], v[116:119]
    v_mfma_f32_16x16x32_bf16 v[120:123], a[116:119], v[88:91], v[120:123]
    s_waitcnt lgkmcnt(2)
    v_mfma_f32_16x16x32_bf16 v[108:111], a[40:43], v[92:95], v[108:111]
    ds_read_b128 v[84:87], v11 offset:24576
    v_mfma_f32_16x16x32_bf16 v[112:115], a[40:43], v[96:99], v[112:115]
    ds_read_b128 v[88:91], v11 offset:26624
    v_mfma_f32_16x16x32_bf16 v[116:119], a[120:123], v[92:95], v[116:119]
    v_mfma_f32_16x16x32_bf16 v[120:123], a[120:123], v[96:99], v[120:123]
    s_waitcnt lgkmcnt(2)
    v_mfma_f32_16x16x32_bf16 v[108:111], a[44:47], v[100:103], v[108:111]
    ds_read_b128 v[92:95], v12 offset:24576
    v_mfma_f32_16x16x32_bf16 v[112:115], a[44:47], v[104:107], v[112:115]
    ds_read_b128 v[96:99], v12 offset:26624
    v_mfma_f32_16x16x32_bf16 v[116:119], a[124:127], v[100:103], v[116:119]
    v_mfma_f32_16x16x32_bf16 v[120:123], a[124:127], v[104:107], v[120:123]
    s_waitcnt lgkmcnt(2)
    v_mfma_f32_16x16x32_bf16 v[108:111], a[48:51], v[84:87], v[108:111]
    ds_read_b128 v[100:103], v11 offset:28672
    v_mfma_f32_16x16x32_bf16 v[112:115], a[48:51], v[88:91], v[112:115]
    ds_read_b128 v[104:107], v11 offset:30720
    v_mfma_f32_16x16x32_bf16 v[116:119], a[128:131], v[84:87], v[116:119]
    buffer_store_dword v20, v147, s[4:7], s38 offen sc1
    buffer_store_dword v22, v135, s[4:7], s42 offen offset:0 sc1
    buffer_store_dword v22, v135, s[4:7], s42 offen offset:1024 sc1
    v_mfma_f32_16x16x32_bf16 v[120:123], a[128:131], v[88:91], v[120:123]
    s_waitcnt lgkmcnt(2)
    v_mfma_f32_16x16x32_bf16 v[108:111], a[52:55], v[92:95], v[108:111]
    ds_read_b128 v[84:87], v12 offset:28672
    v_mfma_f32_16x16x32_bf16 v[112:115], a[52:55], v[96:99], v[112:115]
    ds_read_b128 v[88:91], v12 offset:30720
    v_mfma_f32_16x16x32_bf16 v[116:119], a[132:135], v[92:95], v[116:119]
    buffer_load_dwordx4 v10, s[24:27], s46 offen offset:0 lds
    s_add_u32 m0, m0, 3968
    v_mfma_f32_16x16x32_bf16 v[120:123], a[132:135], v[96:99], v[120:123]
    s_waitcnt lgkmcnt(2)
    v_mfma_f32_16x16x32_bf16 v[108:111], a[56:59], v[100:103], v[108:111]
    ds_read_b128 v[92:95], v11 offset:32768
    v_mfma_f32_16x16x32_bf16 v[112:115], a[56:59], v[104:107], v[112:115]
    ds_read_b128 v[96:99], v11 offset:34816
    v_mfma_f32_16x16x32_bf16 v[116:119], a[136:139], v[100:103], v[116:119]
    buffer_load_dwordx4 v10, s[24:27], s46 offen offset:128 lds
    s_add_u32 m0, m0, 3968
    v_mfma_f32_16x16x32_bf16 v[120:123], a[136:139], v[104:107], v[120:123]
    s_waitcnt lgkmcnt(2)
    v_mfma_f32_16x16x32_bf16 v[108:111], a[60:63], v[84:87], v[108:111]
    ds_read_b128 v[100:103], v12 offset:32768
    v_mfma_f32_16x16x32_bf16 v[112:115], a[60:63], v[88:91], v[112:115]
    ds_read_b128 v[104:107], v12 offset:34816
    v_mfma_f32_16x16x32_bf16 v[116:119], a[140:143], v[84:87], v[116:119]
    buffer_load_dwordx4 v10, s[24:27], s46 offen offset:256 lds
    s_add_u32 m0, m0, 3968
    v_mfma_f32_16x16x32_bf16 v[120:123], a[140:143], v[88:91], v[120:123]
    s_waitcnt lgkmcnt(2)
    v_mfma_f32_16x16x32_bf16 v[108:111], a[64:67], v[92:95], v[108:111]
    ds_read_b128 v[84:87], v11 offset:36864
    v_mfma_f32_16x16x32_bf16 v[112:115], a[64:67], v[96:99], v[112:115]
    ds_read_b128 v[88:91], v11 offset:38912
    v_mfma_f32_16x16x32_bf16 v[116:119], a[144:147], v[92:95], v[116:119]
    buffer_load_dwordx4 v10, s[24:27], s46 offen offset:384 lds
    s_add_u32 m0, m0, 3968
    v_mfma_f32_16x16x32_bf16 v[120:123], a[144:147], v[96:99], v[120:123]
    s_waitcnt lgkmcnt(2)
    v_mfma_f32_16x16x32_bf16 v[108:111], a[68:71], v[100:103], v[108:111]
    ds_read_b128 v[92:95], v12 offset:36864
    v_mfma_f32_16x16x32_bf16 v[112:115], a[68:71], v[104:107], v[112:115]
    ds_read_b128 v[96:99], v12 offset:38912
    v_mfma_f32_16x16x32_bf16 v[116:119], a[148:151], v[100:103], v[116:119]
    buffer_load_dwordx4 v10, s[24:27], s46 offen offset:512 lds
    s_add_u32 m0, m0, 3968
    v_mfma_f32_16x16x32_bf16 v[120:123], a[148:151], v[104:107], v[120:123]
    s_waitcnt lgkmcnt(0)
    buffer_load_dwordx4 v10, s[24:27], s46 offen offset:640 lds
    s_add_u32 m0, m0, 3968
    s_nop 0
    buffer_load_dwordx4 v10, s[24:27], s46 offen offset:768 lds
    s_add_u32 m0, m0, 3968
    s_nop 0
    buffer_load_dwordx4 v10, s[24:27], s46 offen offset:896 lds
    s_add_u32 m0, m0, 3968
    s_nop 0
    buffer_load_dwordx4 v10, s[24:27], s46 offen offset:1024 lds
    s_add_u32 m0, m0, 3968
    s_nop 0
    buffer_load_dwordx4 v10, s[24:27], s46 offen offset:1152 lds
    v_mfma_f32_16x16x32_bf16 v[108:111], a[72:75], v[84:87], v[108:111]
    v_add_u32 v11, s49, v11
    v_mfma_f32_16x16x32_bf16 v[112:115], a[72:75], v[88:91], v[112:115]
    v_add_u32 v12, s49, v12
    v_mfma_f32_16x16x32_bf16 v[108:111], a[76:79], v[92:95], v[108:111]
    s_sub_u32 s47, s47, s49
    v_mfma_f32_16x16x32_bf16 v[112:115], a[76:79], v[96:99], v[112:115]
    s_sub_u32 s49, 0, s49
    v_mfma_f32_16x16x32_bf16 v[116:119], a[152:155], v[84:87], v[116:119]
    v_mfma_f32_16x16x32_bf16 v[120:123], a[152:155], v[88:91], v[120:123]
    v_mfma_f32_16x16x32_bf16 v[116:119], a[156:159], v[92:95], v[116:119]
    v_mfma_f32_16x16x32_bf16 v[120:123], a[156:159], v[96:99], v[120:123]
    v_cvt_pk_bf16_f32 v124, v108, v109
    v_cvt_pk_bf16_f32 v125, v110, v111
    v_cvt_pk_bf16_f32 v126, v112, v113
    v_cvt_pk_bf16_f32 v127, v114, v115
    s_nop 0
    v_permlane16_swap_b32 v124, v126
    v_permlane16_swap_b32 v125, v127
    v_cvt_pk_bf16_f32 v128, v116, v117
    v_cvt_pk_bf16_f32 v129, v118, v119
    v_cvt_pk_bf16_f32 v130, v120, v121
    v_cvt_pk_bf16_f32 v131, v122, v123
    s_nop 0
    v_permlane16_swap_b32 v128, v130
    v_permlane16_swap_b32 v129, v131
    buffer_store_dwordx4 v[124:127], v19, s[4:7], s44 offen sc1
    buffer_store_dwordx4 v[128:131], v19, s[4:7], s45 offen sc1
    s_branch L_v_loop_s
L_fw_92c:
    v_mov_b32 v148, -1
    v_mov_b32 v149, -1
    v_mov_b32 v150, -1
    v_mov_b32 v151, -1
    v_mov_b32 v152, -1
    v_mov_b32 v153, -1
    v_mov_b32 v154, -1
    v_mov_b32 v155, -1
    s_add_u32 s53, s53, 2293760
    buffer_store_dwordx4 v[148:151], v143, s[4:7], s53 offen offset:0 sc1
    buffer_store_dwordx4 v[152:155], v143, s[4:7], s53 offen offset:1024 sc1
    s_sub_u32 s53, s53, 983040
    s_branch L_fw_92
L_sp_106:
    s_cmp_eq_u32 s57, s37
    s_cbranch_scc1 L_sg_107
    s_mov_b32 s57, s37
L_sp_106s:
    buffer_load_dwordx4 v[92:95], v38, s[4:7], s43 offen offset:0 sc1
    buffer_load_dwordx4 v[96:99], v38, s[4:7], s43 offen offset:1280 sc1
    buffer_load_dwordx4 v[100:103], v38, s[4:7], s43 offen offset:2560 sc1
    buffer_load_dword v104, v39, s[4:7], s43 offen offset:0 sc1
    buffer_load_dword v105, v39, s[4:7], s43 offen offset:1280 sc1
    buffer_load_dword v106, v39, s[4:7], s43 offen offset:2560 sc1
    s_sub_u32 s36, s36, 1
    s_cbranch_scc1 L_exit
    s_waitcnt vmcnt(0)
    v_max3_u32 v4, v104, v105, v106
    v_max3_u32 v4, v4, v92, v93
    v_max3_u32 v4, v4, v94, v95
    v_max3_u32 v4, v4, v96, v97
    v_max3_u32 v4, v4, v98, v99
    v_max3_u32 v4, v4, v100, v101
    v_max3_u32 v4, v4, v102, v103
    v_cmp_eq_u32 vcc, -1, v4
    s_cbranch_vccnz L_sp_106s
    v_mov_b32 v129, 0
    v_mov_b32 v130, 0
    v_mov_b32 v131, 0
    v_mov_b32 v132, 0
    v_mov_b32 v133, 0
    v_mov_b32 v134, 0
    v_mov_b32 v135, 0
    v_mov_b32 v116, 0
    v_mov_b32 v117, 0
    v_mov_b32 v118, 0
    v_mov_b32 v119, 0
L_sp_106v:
    buffer_load_dwordx4 v44, s[4:7], s43 offen offset:0 sc1 lds
    buffer_load_dwordx4 v44, s[4:7], s43 offen offset:1024 sc1 lds
    buffer_load_dwordx4 v44, s[4:7], s43 offen offset:2048 sc1 lds
    s_sub_u32 s36, s36, 1
    s_cbranch_scc1 L_exit
    v_add_u32 v5, s53, v12
    s_waitcnt vmcnt(0)
    ds_read_b128 v[136:139], v5 offset:0
    ds_read_b128 v[140:143], v5 offset:1024
    ds_read_b128 v[144:147], v5 offset:2048
    s_waitcnt lgkmcnt(0)
    v_max_u32 v4, v136, v137
    v_max3_u32 v4, v4, v138, v139
    v_max3_u32 v4, v4, v140, v141
    v_max3_u32 v4, v4, v142, v143
    v_max3_u32 v4, v4, v144, v145
    v_max3_u32 v4, v4, v146, v147
    v_cmp_eq_u32 vcc, -1, v4
    s_cbranch_vccnz L_sp_106v
    ds_read_b64_tr_b16 v[136:137], v16 offset:0
    ds_read_b64_tr_b16 v[138:139], v13 offset:0
    ds_read_b64_tr_b16 v[140:141], v16 offset:1024
    ds_read_b64_tr_b16 v[142:143], v13 offset:1024
    ds_read_b64_tr_b16 v[144:145], v16 offset:2048
    ds_read_b64_tr_b16 v[146:147], v13 offset:2048
    v_mov_b32 v148, 0
    v_mov_b32 v149, 0
    v_mov_b32 v150, 0
    v_mov_b32 v151, 0
    v_mov_b32 v152, 0
    v_mov_b32 v153, 0
    v_mov_b32 v154, 0
    v_mov_b32 v155, 0
    v_mov_b32 v156, 0
    v_mov_b32 v157, 0
    v_mov_b32 v158, 0
    v_mov_b32 v159, 0
    v_mov_b32 v160, 0
    v_mov_b32 v161, 0
    v_mov_b32 v162, 0
    v_mov_b32 v163, 0
    s_waitcnt lgkmcnt(0)
    v_smfmac_f32_16x16x64_bf16 v[148:151], v[136:139], a[0:7], v10
    v_smfmac_f32_16x16x64_bf16 v[152:155], v[136:139], a[24:31], v10
    v_smfmac_f32_16x16x64_bf16 v[156:159], v[136:139], a[48:55], v10
    v_smfmac_f32_16x16x64_bf16 v[160:163], v[136:139], a[72:79], v10
    v_smfmac_f32_16x16x64_bf16 v[148:151], v[140:143], a[8:15], v10
    v_smfmac_f32_16x16x64_bf16 v[152:155], v[140:143], a[32:39], v10
    v_smfmac_f32_16x16x64_bf16 v[156:159], v[140:143], a[56:63], v10
    v_smfmac_f32_16x16x64_bf16 v[160:163], v[140:143], a[80:87], v10
    v_smfmac_f32_16x16x64_bf16 v[148:151], v[144:147], a[16:23], v10
    v_smfmac_f32_16x16x64_bf16 v[152:155], v[144:147], a[40:47], v10
    v_smfmac_f32_16x16x64_bf16 v[156:159], v[144:147], a[64:71], v10
    v_smfmac_f32_16x16x64_bf16 v[160:163], v[144:147], a[88:95], v10
    s_nop 3
    s_branch L_sc_105
L_px_s:
    v_and_b32 v1, 15, v0
    v_lshrrev_b32 v2, 4, v0
    s_mul_i32 s90, s32, 12288
    v_lshl_add_u32 v10, v0, 4, s90
    s_mul_i32 s90, s32, 3072
    v_lshl_add_u32 v12, v0, 4, s90
    v_lshrrev_b32 v3, 2, v1
    v_lshlrev_b32 v3, 1, v3
    v_and_b32 v4, 1, v1
    v_or_b32 v3, v3, v4
    v_lshl_add_u32 v3, v2, 3, v3
    v_lshl_add_u32 v11, v3, 4, s90
    s_lshl_b32 s90, s32, 7
    v_min_u32 v3, 11, v0
    v_lshl_add_u32 v3, v3, 2, s90
    v_add_u32 v13, 458752, v3
    v_min_u32 v3, 2, v0
    v_lshl_add_u32 v3, v3, 2, s90
    v_add_u32 v14, 459264, v3
    v_add_u32 v22, 462336, v3
    s_add_u32 s90, s90, 459776
    v_mov_b32 v15, s90
    v_cmp_eq_u32 vcc, 0, v0
    v_mov_b32 v9, 2146435072
    s_nop 0
    v_cndmask_b32 v15, v9, v15, vcc
    s_nop 0
    v_mov_b32 v21, 0xd04e79ff
    s_mov_b32 s44, 0x3dd53b95
    v_lshl_add_u32 v3, v2, 2, 0
    v_cmp_le_u32 s[48:49], v3, v1
    v_lshl_add_u32 v3, v2, 2, 1
    v_cmp_le_u32 s[50:51], v3, v1
    v_lshl_add_u32 v3, v2, 2, 2
    v_cmp_le_u32 s[52:53], v3, v1
    v_lshl_add_u32 v3, v2, 2, 3
    v_cmp_le_u32 s[54:55], v3, v1
    v_mov_b32 v167, 0
    v_mov_b32 v171, 0
    v_mov_b32 v174, 0
    v_mov_b32 v175, 0
    s_mov_b32 s37, 0
    v_mov_b32 v1, 196
L_gw_120:
    buffer_load_dword v2, v1, s[8:11], 0 offen sc1
    s_sub_u32 s36, s36, 1
    s_cbranch_scc1 L_exit
    s_waitcnt vmcnt(0)
L_gw_120c:
    v_readfirstlane_b32 s90, v2
    s_nop 0
    s_cmp_eq_u32 s90, 0
    s_cbranch_scc1 L_gw_120
    s_cmp_lg_u32 s32, 0
    s_cbranch_scc1 L_xg_119
    s_lshl_b32 s92, s34, 14
    s_add_u32 s92, s92, 1966080
    s_add_u32 s93, s92, 8192
    v_lshlrev_b32 v3, 4, v0
    buffer_store_dwordx4 v[24:27], v3, s[4:7], s92 offen offset:0 sc1
    buffer_store_dwordx4 v[24:27], v3, s[4:7], s93 offen offset:0 sc1
    buffer_store_dwordx4 v[24:27], v3, s[4:7], s92 offen offset:1024 sc1
    buffer_store_dwordx4 v[24:27], v3, s[4:7], s93 offen offset:1024 sc1
    buffer_store_dwordx4 v[24:27], v3, s[4:7], s92 offen offset:2048 sc1
    buffer_store_dwordx4 v[24:27], v3, s[4:7], s93 offen offset:2048 sc1
    buffer_store_dwordx4 v[24:27], v3, s[4:7], s92 offen offset:3072 sc1
    buffer_store_dwordx4 v[24:27], v3, s[4:7], s93 offen offset:3072 sc1
    v_mov_b32 v3, 0
    s_mov_b32 s56, -1
    s_mov_b32 s57, -1
    s_mov_b32 s62, 0
    s_mov_b32 s63, 0
    s_waitcnt vmcnt(0)
L_pr_121:
    s_memtime s[58:59]
    s_waitcnt lgkmcnt(0)
    buffer_load_dword v4, v3, s[4:7], s92 offen sc1
    s_waitcnt vmcnt(0)
    s_memtime s[60:61]
    s_waitcnt lgkmcnt(0)
    s_sub_u32 s60, s60, s58
    s_min_u32 s56, s56, s60
    s_memtime s[58:59]
    s_waitcnt lgkmcnt(0)
    buffer_load_dword v4, v3, s[4:7], s93 offen sc1
    s_waitcnt vmcnt(0)
    s_memtime s[60:61]
    s_waitcnt lgkmcnt(0)
    s_sub_u32 s60, s60, s58
    s_min_u32 s57, s57, s60
    buffer_load_dword v4, v13, s[4:7], s38 offen sc1
    v_add_u32 v3, 128, v3
    s_add_u32 s62, s62, 1
    s_waitcnt vmcnt(0)
    v_cmp_eq_u32 vcc, 0, v4
    s_nop 0
    s_cmp_eq_u64 vcc, 0
    s_addc_u32 s63, s63, 0
    s_cmp_ge_u32 s63, 2
    s_cselect_b32 s62, 32, s62
    s_min_u32 s58, s56, s57
    s_max_u32 s59, s56, s57
    s_sub_u32 s59, s59, s58
    s_cmp_ge_u32 s59, 150
    s_cselect_b32 s58, s58, -1
    s_cmp_le_u32 s58, 540
    s_cselect_b32 s62, 32, s62
    s_cmp_lt_u32 s62, 32
    s_cbranch_scc1 L_pr_121
    s_cmp_lt_u32 s57, s56
    s_cselect_b32 s62, 2, 1
    s_nop 0
    v_mov_b32 v3, 460288
    v_mov_b32 v4, s62
    buffer_store_dword v4, v3, s[4:7], s38 offen sc1
    s_cmp_lg_u32 s34, 0
    s_cbranch_scc1 L_xg_119
    v_mov_b32 v3, 204
    buffer_store_dword v4, v3, s[8:11], 0 offen sc1
L_xg_119:
    s_barrier
    s_add_u32 s41, s38, 475136
    buffer_load_dword v16, v22, s[4:7], s38 offen sc1
    buffer_load_dword v16, v22, s[4:7], s38 offen sc1
L_sp_122:
    buffer_load_dword v16, v22, s[4:7], s38 offen sc1
    s_sub_u32 s36, s36, 1
    s_cbranch_scc1 L_exit
    s_waitcnt vmcnt(2)
    v_cmp_ge_u32 vcc, s37, v16
    s_cbranch_vccnz L_sp_122
    s_add_u32 s90, s41, 49152
    buffer_load_dwordx4 v[72:75], v10, s[4:7], s90 offen offset:0 sc1
    buffer_load_dwordx4 v[76:79], v10, s[4:7], s90 offen offset:1024 sc1
    buffer_load_dwordx4 v[80:83], v10, s[4:7], s90 offen offset:2048 sc1
    buffer_load_dwordx4 v[84:87], v10, s[4:7], s90 offen offset:3072 sc1
    s_add_u32 s90, s41, 53248
    buffer_load_dwordx4 v[88:91], v10, s[4:7], s90 offen offset:0 sc1
    buffer_load_dwordx4 v[92:95], v10, s[4:7], s90 offen offset:1024 sc1
    buffer_load_dwordx4 v[96:99], v10, s[4:7], s90 offen offset:2048 sc1
    buffer_load_dwordx4 v[100:103], v10, s[4:7], s90 offen offset:3072 sc1
    s_add_u32 s90, s41, 57344
    buffer_load_dwordx4 v[104:107], v10, s[4:7], s90 offen offset:0 sc1
    buffer_load_dwordx4 v[108:111], v10, s[4:7], s90 offen offset:1024 sc1
    buffer_load_dwordx4 v[112:115], v10, s[4:7], s90 offen offset:2048 sc1
    buffer_load_dwordx4 v[116:119], v10, s[4:7], s90 offen offset:3072 sc1
    s_add_u32 s90, s41, 0
    buffer_load_dwordx4 v[24:27], v10, s[4:7], s90 offen offset:0 sc1
    buffer_load_dwordx4 v[28:31], v10, s[4:7], s90 offen offset:1024 sc1
    buffer_load_dwordx4 v[32:35], v10, s[4:7], s90 offen offset:2048 sc1
    buffer_load_dwordx4 v[36:39], v10, s[4:7], s90 offen offset:3072 sc1
    s_add_u32 s90, s41, 4096
    buffer_load_dwordx4 v[40:43], v10, s[4:7], s90 offen offset:0 sc1
    buffer_load_dwordx4 v[44:47], v10, s[4:7], s90 offen offset:1024 sc1
    buffer_load_dwordx4 v[48:51], v10, s[4:7], s90 offen offset:2048 sc1
    buffer_load_dwordx4 v[52:55], v10, s[4:7], s90 offen offset:3072 sc1
    s_add_u32 s90, s41, 8192
    buffer_load_dwordx4 v[56:59], v10, s[4:7], s90 offen offset:0 sc1
    buffer_load_dwordx4 v[60:63], v10, s[4:7], s90 offen offset:1024 sc1
    buffer_load_dwordx4 v[64:67], v10, s[4:7], s90 offen offset:2048 sc1
    buffer_load_dwordx4 v[68:71], v10, s[4:7], s90 offen offset:3072 sc1
    s_waitcnt vmcnt(0)
L_px_loop_s:
    s_and_b32 s90, s37, 3
    s_mul_i32 s91, s90, 114688
    s_add_u32 s91, s91, s38
    s_add_u32 s42, s91, 40960
    s_add_u32 s43, s91, 53248
    s_add_u32 s90, s37, 1
    v_mov_b32 v17, s90
    s_and_b32 s90, s90, 3
    s_mul_i32 s91, s90, 98304
    s_add_u32 s91, s91, 475136
    s_add_u32 s41, s38, s91
    v_mfma_f32_16x16x32_bf16 v[144:147], v[72:75], v[24:27], 0
    v_mfma_f32_16x16x32_bf16 v[152:155], v[72:75], v[48:51], 0
    v_mfma_f32_16x16x32_bf16 v[156:159], v[96:99], v[48:51], 0
    v_mfma_f32_16x16x32_bf16 v[144:147], v[76:79], v[28:31], v[144:147]
    v_mfma_f32_16x16x32_bf16 v[152:155], v[76:79], v[52:55], v[152:155]
    v_mfma_f32_16x16x32_bf16 v[156:159], v[100:103], v[52:55], v[156:159]
    v_mfma_f32_16x16x32_bf16 v[144:147], v[80:83], v[32:35], v[144:147]
    v_mfma_f32_16x16x32_bf16 v[152:155], v[80:83], v[56:59], v[152:155]
    v_mfma_f32_16x16x32_bf16 v[156:159], v[104:107], v[56:59], v[156:159]
    v_mfma_f32_16x16x32_bf16 v[144:147], v[84:87], v[36:39], v[144:147]
    v_mfma_f32_16x16x32_bf16 v[152:155], v[84:87], v[60:63], v[152:155]
    v_mfma_f32_16x16x32_bf16 v[156:159], v[108:111], v[60:63], v[156:159]
    v_mfma_f32_16x16x32_bf16 v[144:147], v[88:91], v[40:43], v[144:147]
    v_mfma_f32_16x16x32_bf16 v[152:155], v[88:91], v[64:67], v[152:155]
    v_mfma_f32_16x16x32_bf16 v[156:159], v[112:115], v[64:67], v[156:159]
    v_mfma_f32_16x16x32_bf16 v[144:147], v[92:95], v[44:47], v[144:147]
    v_mfma_f32_16x16x32_bf16 v[152:155], v[92:95], v[68:71], v[152:155]
    v_mfma_f32_16x16x32_bf16 v[156:159], v[116:119], v[68:71], v[156:159]
    s_nop 0
    v_cndmask_b32 v144, v21, v144, s[48:49]
    v_cndmask_b32 v145, v21, v145, s[50:51]
    v_cndmask_b32 v146, v21, v146, s[52:53]
    v_cndmask_b32 v147, v21, v147, s[54:55]
    s_nop 2
    v_cndmask_b32 v156, v21, v156, s[48:49]
    v_cndmask_b32 v157, v21, v157, s[50:51]
    v_cndmask_b32 v158, v21, v158, s[52:53]
    v_cndmask_b32 v159, v21, v159, s[54:55]
    buffer_load_dword v16, v14, s[4:7], s38 offen sc1
    buffer_load_dword v16, v14, s[4:7], s38 offen sc1
L_sp_123:
    buffer_load_dword v16, v14, s[4:7], s38 offen sc1
    s_sub_u32 s36, s36, 1
    s_cbranch_scc1 L_exit
    s_waitcnt vmcnt(2)
    v_cmp_ge_u32 vcc, s37, v16
    s_cbranch_vccnz L_sp_123
    buffer_load_dwordx4 v[120:123], v11, s[4:7], s42 offen offset:0 sc1
    buffer_load_dwordx4 v[124:127], v11, s[4:7], s42 offen offset:512 sc1
    buffer_load_dwordx4 v[128:131], v11, s[4:7], s42 offen offset:1024 sc1
    buffer_load_dwordx4 v[132:135], v11, s[4:7], s42 offen offset:1536 sc1
    buffer_load_dwordx4 v[136:139], v11, s[4:7], s42 offen offset:2048 sc1
    buffer_load_dwordx4 v[140:143], v11, s[4:7], s42 offen offset:2560 sc1
    s_waitcnt vmcnt(5)
    v_mfma_f32_16x16x32_bf16 v[148:151], v[120:123], v[24:27], 0
    v_mfma_f32_16x16x32_bf16 v[160:163], v[120:123], v[48:51], 0
    s_waitcnt vmcnt(4)
    v_mfma_f32_16x16x32_bf16 v[148:151], v[124:127], v[28:31], v[148:151]
    v_mfma_f32_16x16x32_bf16 v[160:163], v[124:127], v[52:55], v[160:163]
    s_waitcnt vmcnt(3)
    v_mfma_f32_16x16x32_bf16 v[148:151], v[128:131], v[32:35], v[148:151]
    v_mfma_f32_16x16x32_bf16 v[160:163], v[128:131], v[56:59], v[160:163]
    s_waitcnt vmcnt(2)
    v_mfma_f32_16x16x32_bf16 v[148:151], v[132:135], v[36:39], v[148:151]
    v_mfma_f32_16x16x32_bf16 v[160:163], v[132:135], v[60:63], v[160:163]
    s_waitcnt vmcnt(1)
    v_mfma_f32_16x16x32_bf16 v[148:151], v[136:139], v[40:43], v[148:151]
    v_mfma_f32_16x16x32_bf16 v[160:163], v[136:139], v[64:67], v[160:163]
    s_waitcnt vmcnt(0)
    v_mfma_f32_16x16x32_bf16 v[148:151], v[140:143], v[44:47], v[148:151]
    v_mfma_f32_16x16x32_bf16 v[160:163], v[140:143], v[68:71], v[160:163]
    s_cmp_eq_u32 s37, 63
    s_nop 2
    s_cbranch_scc1 L_pxl_124
    s_add_u32 s90, s41, 49152
    v_max_f32 v18, v144, v145
    v_max3_f32 v18, v18, v146, v147
    v_max3_f32 v18, v18, v148, v149
    v_mov_b32 v19, v18
    buffer_load_dwordx4 v[72:75], v10, s[4:7], s90 offen offset:0 sc1
    s_nop 0
    v_permlane16_swap_b32 v18, v19
    v_max_f32 v18, v18, v19
    v_mov_b32 v19, v18
    s_nop 1
    v_permlane32_swap_b32 v18, v19
    buffer_load_dwordx4 v[76:79], v10, s[4:7], s90 offen offset:1024 sc1
    v_max_f32 v18, v18, v19
    v_sub_f32 v144, v144, v18
    v_sub_f32 v145, v145, v18
    v_sub_f32 v146, v146, v18
    buffer_load_dwordx4 v[80:83], v10, s[4:7], s90 offen offset:2048 sc1
    v_sub_f32 v147, v147, v18
    v_sub_f32 v148, v148, v18
    v_sub_f32 v149, v149, v18
    v_mul_f32 v144, s44, v144
    buffer_load_dwordx4 v[84:87], v10, s[4:7], s90 offen offset:3072 sc1
    v_mul_f32 v145, s44, v145
    v_mul_f32 v146, s44, v146
    v_mul_f32 v147, s44, v147
    v_mul_f32 v148, s44, v148
    s_add_u32 s90, s41, 53248
    v_mul_f32 v149, s44, v149
    v_exp_f32 v144, v144
    v_exp_f32 v145, v145
    v_exp_f32 v146, v146
    buffer_load_dwordx4 v[88:91], v10, s[4:7], s90 offen offset:0 sc1
    v_exp_f32 v147, v147
    v_exp_f32 v148, v148
    v_exp_f32 v149, v149
    v_add_f32 v20, v144, v145
    buffer_load_dwordx4 v[92:95], v10, s[4:7], s90 offen offset:1024 sc1
    v_add_f32 v20, v20, v146
    v_add_f32 v20, v20, v147
    v_add_f32 v20, v20, v148
    v_add_f32 v20, v20, v149
    buffer_load_dwordx4 v[96:99], v10, s[4:7], s90 offen offset:2048 sc1
    v_mov_b32 v19, v20
    s_nop 1
    v_permlane16_swap_b32 v20, v19
    v_add_f32 v20, v20, v19
    v_mov_b32 v19, v20
    buffer_load_dwordx4 v[100:103], v10, s[4:7], s90 offen offset:3072 sc1
    s_nop 0
    v_permlane32_swap_b32 v20, v19
    v_add_f32 v20, v20, v19
    v_rcp_f32 v20, v20
    s_nop 0
    v_mul_f32 v144, v144, v20
    s_add_u32 s90, s41, 57344
    v_mul_f32 v145, v145, v20
    v_mul_f32 v146, v146, v20
    v_mul_f32 v147, v147, v20
    v_mul_f32 v148, v148, v20
    buffer_load_dwordx4 v[104:107], v10, s[4:7], s90 offen offset:0 sc1
    v_mul_f32 v149, v149, v20
    v_cvt_pk_bf16_f32 v164, v144, v145
    v_cvt_pk_bf16_f32 v165, v146, v147
    v_cvt_pk_bf16_f32 v166, v148, v149
    buffer_load_dwordx4 v[108:111], v10, s[4:7], s90 offen offset:1024 sc1
    v_max_f32 v18, v152, v153
    v_max3_f32 v18, v18, v154, v155
    v_max3_f32 v18, v18, v160, v161
    v_max3_f32 v18, v18, v156, v157
    buffer_load_dwordx4 v[112:115], v10, s[4:7], s90 offen offset:2048 sc1
    v_max3_f32 v18, v18, v158, v159
    v_mov_b32 v19, v18
    s_nop 1
    v_permlane16_swap_b32 v18, v19
    v_max_f32 v18, v18, v19
    buffer_load_dwordx4 v[116:119], v10, s[4:7], s90 offen offset:3072 sc1
    v_mov_b32 v19, v18
    s_nop 1
    v_permlane32_swap_b32 v18, v19
    v_max_f32 v18, v18, v19
    v_sub_f32 v152, v152, v18
    s_add_u32 s90, s41, 0
    v_sub_f32 v153, v153, v18
    v_sub_f32 v154, v154, v18
    v_sub_f32 v155, v155, v18
    v_sub_f32 v160, v160, v18
    buffer_load_dwordx4 v[24:27], v10, s[4:7], s90 offen offset:0 sc1
    v_sub_f32 v161, v161, v18
    v_sub_f32 v156, v156, v18
    v_sub_f32 v157, v157, v18
    v_sub_f32 v158, v158, v18
    buffer_load_dwordx4 v[28:31], v10, s[4:7], s90 offen offset:1024 sc1
    v_sub_f32 v159, v159, v18
    v_mul_f32 v152, s44, v152
    v_mul_f32 v153, s44, v153
    v_mul_f32 v154, s44, v154
    buffer_load_dwordx4 v[32:35], v10, s[4:7], s90 offen offset:2048 sc1
    v_mul_f32 v155, s44, v155
    v_mul_f32 v160, s44, v160
    v_mul_f32 v161, s44, v161
    v_mul_f32 v156, s44, v156
    buffer_load_dwordx4 v[36:39], v10, s[4:7], s90 offen offset:3072 sc1
    v_mul_f32 v157, s44, v157
    v_mul_f32 v158, s44, v158
    v_mul_f32 v159, s44, v159
    v_exp_f32 v152, v152
    s_add_u32 s90, s41, 4096
    v_exp_f32 v153, v153
    v_exp_f32 v154, v154
    v_exp_f32 v155, v155
    v_exp_f32 v160, v160
    buffer_load_dwordx4 v[40:43], v10, s[4:7], s90 offen offset:0 sc1
    v_exp_f32 v161, v161
    v_exp_f32 v156, v156
    v_exp_f32 v157, v157
    v_exp_f32 v158, v158
    buffer_load_dwordx4 v[44:47], v10, s[4:7], s90 offen offset:1024 sc1
    v_exp_f32 v159, v159
    v_add_f32 v20, v152, v153
    v_add_f32 v20, v20, v154
    v_add_f32 v20, v20, v155
    buffer_load_dwordx4 v[48:51], v10, s[4:7], s90 offen offset:2048 sc1
    v_add_f32 v20, v20, v160
    v_add_f32 v20, v20, v161
    v_add_f32 v20, v20, v156
    v_add_f32 v20, v20, v157
    buffer_load_dwordx4 v[52:55], v10, s[4:7], s90 offen offset:3072 sc1
    v_add_f32 v20, v20, v158
    v_add_f32 v20, v20, v159
    v_mov_b32 v19, v20
    s_nop 1
    v_permlane16_swap_b32 v20, v19
    s_add_u32 s90, s41, 8192
    v_add_f32 v20, v20, v19
    v_mov_b32 v19, v20
    s_nop 1
    v_permlane32_swap_b32 v20, v19
    v_add_f32 v20, v20, v19
    buffer_load_dwordx4 v[56:59], v10, s[4:7], s90 offen offset:0 sc1
    v_rcp_f32 v20, v20
    s_nop 0
    v_mul_f32 v152, v152, v20
    v_mul_f32 v153, v153, v20
    v_mul_f32 v154, v154, v20
    buffer_load_dwordx4 v[60:63], v10, s[4:7], s90 offen offset:1024 sc1
    v_mul_f32 v155, v155, v20
    v_mul_f32 v160, v160, v20
    v_mul_f32 v161, v161, v20
    v_mul_f32 v156, v156, v20
    buffer_load_dwordx4 v[64:67], v10, s[4:7], s90 offen offset:2048 sc1
    v_mul_f32 v157, v157, v20
    v_mul_f32 v158, v158, v20
    v_mul_f32 v159, v159, v20
    v_cvt_pk_bf16_f32 v168, v152, v153
    buffer_load_dwordx4 v[68:71], v10, s[4:7], s90 offen offset:3072 sc1
    v_cvt_pk_bf16_f32 v169, v154, v155
    v_cvt_pk_bf16_f32 v170, v160, v161
    v_cvt_pk_bf16_f32 v172, v156, v157
    v_cvt_pk_bf16_f32 v173, v158, v159
    buffer_store_dwordx4 v[164:167], v12, s[4:7], s43 offen offset:0 sc1
    buffer_store_dwordx4 v[168:171], v12, s[4:7], s43 offen offset:1024 sc1
    buffer_store_dwordx4 v[172:175], v12, s[4:7], s43 offen offset:2048 sc1
    s_waitcnt vmcnt(0)
    buffer_store_dword v17, v15, s[4:7], s38 offen sc1
    s_add_u32 s37, s37, 1
    s_branch L_px_loop_s
L_pxl_124:
    v_max_f32 v18, v144, v145
    v_max3_f32 v18, v18, v146, v147
    v_max3_f32 v18, v18, v148, v149
    v_mov_b32 v19, v18
    s_nop 1
    v_permlane16_swap_b32 v18, v19
    v_max_f32 v18, v18, v19
    v_mov_b32 v19, v18
    s_nop 1
    v_permlane32_swap_b32 v18, v19
    v_max_f32 v18, v18, v19
    v_sub_f32 v144, v144, v18
    v_sub_f32 v145, v145, v18
    v_sub_f32 v146, v146, v18
    v_sub_f32 v147, v147, v18
    v_sub_f32 v148, v148, v18
    v_sub_f32 v149, v149, v18
    v_mul_f32 v144, s44, v144
    v_mul_f32 v145, s44, v145
    v_mul_f32 v146, s44, v146
    v_mul_f32 v147, s44, v147
    v_mul_f32 v148, s44, v148
    v_mul_f32 v149, s44, v149
    v_exp_f32 v144, v144
    v_exp_f32 v145, v145
    v_exp_f32 v146, v146
    v_exp_f32 v147, v147
    v_exp_f32 v148, v148
    v_exp_f32 v149, v149
    v_add_f32 v20, v144, v145
    v_add_f32 v20, v20, v146
    v_add_f32 v20, v20, v147
    v_add_f32 v20, v20, v148
    v_add_f32 v20, v20, v149
    v_mov_b32 v19, v20
    s_nop 1
    v_permlane16_swap_b32 v20, v19
    v_add_f32 v20, v20, v19
    v_mov_b32 v19, v20
    s_nop 1
    v_permlane32_swap_b32 v20, v19
    v_add_f32 v20, v20, v19
    v_rcp_f32 v20, v20
    s_nop 0
    v_mul_f32 v144, v144, v20
    v_mul_f32 v145, v145, v20
    v_mul_f32 v146, v146, v20
    v_mul_f32 v147, v147, v20
    v_mul_f32 v148, v148, v20
    v_mul_f32 v149, v149, v20
    v_cvt_pk_bf16_f32 v164, v144, v145
    v_cvt_pk_bf16_f32 v165, v146, v147
    v_cvt_pk_bf16_f32 v166, v148, v149
    v_max_f32 v18, v152, v153
    v_max3_f32 v18, v18, v154, v155
    v_max3_f32 v18, v18, v160, v161
    v_max3_f32 v18, v18, v156, v157
    v_max3_f32 v18, v18, v158, v159
    v_mov_b32 v19, v18
    s_nop 1
    v_permlane16_swap_b32 v18, v19
    v_max_f32 v18, v18, v19
    v_mov_b32 v19, v18
    s_nop 1
    v_permlane32_swap_b32 v18, v19
    v_max_f32 v18, v18, v19
    v_sub_f32 v152, v152, v18
    v_sub_f32 v153, v153, v18
    v_sub_f32 v154, v154, v18
    v_sub_f32 v155, v155, v18
    v_sub_f32 v160, v160, v18
    v_sub_f32 v161, v161, v18
    v_sub_f32 v156, v156, v18
    v_sub_f32 v157, v157, v18
    v_sub_f32 v158, v158, v18
    v_sub_f32 v159, v159, v18
    v_mul_f32 v152, s44, v152
    v_mul_f32 v153, s44, v153
    v_mul_f32 v154, s44, v154
    v_mul_f32 v155, s44, v155
    v_mul_f32 v160, s44, v160
    v_mul_f32 v161, s44, v161
    v_mul_f32 v156, s44, v156
    v_mul_f32 v157, s44, v157
    v_mul_f32 v158, s44, v158
    v_mul_f32 v159, s44, v159
    v_exp_f32 v152, v152
    v_exp_f32 v153, v153
    v_exp_f32 v154, v154
    v_exp_f32 v155, v155
    v_exp_f32 v160, v160
    v_exp_f32 v161, v161
    v_exp_f32 v156, v156
    v_exp_f32 v157, v157
    v_exp_f32 v158, v158
    v_exp_f32 v159, v159
    v_add_f32 v20, v152, v153
    v_add_f32 v20, v20, v154
    v_add_f32 v20, v20, v155
    v_add_f32 v20, v20, v160
    v_add_f32 v20, v20, v161
    v_add_f32 v20, v20, v156
    v_add_f32 v20, v20, v157
    v_add_f32 v20, v20, v158
    v_add_f32 v20, v20, v159
    v_mov_b32 v19, v20
    s_nop 1
    v_permlane16_swap_b32 v20, v19
    v_add_f32 v20, v20, v19
    v_mov_b32 v19, v20
    s_nop 1
    v_permlane32_swap_b32 v20, v19
    v_add_f32 v20, v20, v19
    v_rcp_f32 v20, v20
    s_nop 0
    v_mul_f32 v152, v152, v20
    v_mul_f32 v153, v153, v20
    v_mul_f32 v154, v154, v20
    v_mul_f32 v155, v155, v20
    v_mul_f32 v160, v160, v20
    v_mul_f32 v161, v161, v20
    v_mul_f32 v156, v156, v20
    v_mul_f32 v157, v157, v20
    v_mul_f32 v158, v158, v20
    v_mul_f32 v159, v159, v20
    v_cvt_pk_bf16_f32 v168, v152, v153
    v_cvt_pk_bf16_f32 v169, v154, v155
    v_cvt_pk_bf16_f32 v170, v160, v161
    v_cvt_pk_bf16_f32 v172, v156, v157
    v_cvt_pk_bf16_f32 v173, v158, v159
    buffer_store_dwordx4 v[164:167], v12, s[4:7], s43 offen offset:0 sc1
    buffer_store_dwordx4 v[168:171], v12, s[4:7], s43 offen offset:1024 sc1
    buffer_store_dwordx4 v[172:175], v12, s[4:7], s43 offen offset:2048 sc1
    s_waitcnt vmcnt(0)
    buffer_store_dword v17, v15, s[4:7], s38 offen sc1
    s_endpgm
L_pa_s:
    v_mov_b32 v1, 196
L_gw_125:
    buffer_load_dword v2, v1, s[8:11], 0 offen sc1
    s_sub_u32 s36, s36, 1
    s_cbranch_scc1 L_exit
    s_waitcnt vmcnt(0)
L_gw_125c:
    v_readfirstlane_b32 s90, v2
    s_nop 0
    s_cmp_eq_u32 s90, 0
    s_cbranch_scc1 L_gw_125
    s_branch L_pa_body
.section .rodata,"a"
.p2align 6
.amdhsa_kernel concat_heads__sliding_local_dilated__memory_aug_recurrent_mem_tr__prompt_kernel
  .amdhsa_next_free_vgpr 512
  .amdhsa_next_free_sgpr 102
  .amdhsa_accum_offset 256
  .amdhsa_group_segment_fixed_size 0
  .amdhsa_kernarg_size 104
  .amdhsa_user_sgpr_count 2
  .amdhsa_user_sgpr_kernarg_segment_ptr 1
  .amdhsa_system_sgpr_workgroup_id_x 1
  .amdhsa_float_denorm_mode_32 3
.end_amdhsa_kernel
```

```asm
; @launch grid=(256,1,1) block=(256,1,1) lds=163840
.amdgcn_target "amdgcn-amd-amdhsa--gfx950"
.text
.globl concat_heads__sliding_local_dilated__memory_aug_recurrent_mem_tr__prompt_kernel
.p2align 8
.type concat_heads__sliding_local_dilated__memory_aug_recurrent_mem_tr__prompt_kernel,@function
concat_heads__sliding_local_dilated__memory_aug_recurrent_mem_tr__prompt_kernel:
    s_cmp_ge_u32 s2, 256
    s_cbranch_scc1 L_exit
    s_load_dwordx16 s[64:79], s[0:1], 0
    s_load_dwordx8 s[80:87], s[0:1], 64
    s_load_dwordx2 s[88:89], s[0:1], 96
    s_getreg_b32 s33, hwreg(HW_REG_XCC_ID, 0, 4)
    v_lshrrev_b32 v1, 6, v0
    v_and_b32 v0, 63, v0
    v_readfirstlane_b32 s32, v1
    s_mov_b32 s36, 0x40000
    s_mov_b32 s96, 0
    s_mov_b32 s97, 0
    s_and_b32 s90, s33, 4
    s_lshl_b32 s90, s90, 5
    s_and_b32 s91, s33, 3
    s_lshl_b32 s91, s91, 2
    s_add_u32 s90, s90, s91
    s_lshr_b32 s91, s33, 3
    s_lshl_b32 s91, s91, 4
    s_add_u32 s90, s90, s91
    v_mov_b32 v1, s90
    v_mov_b32 v2, 1
    v_mov_b32 v3, 0
    s_waitcnt lgkmcnt(0)
    s_mov_b32 s8, s86
    s_and_b32 s9, s87, 0xffff
    s_mov_b32 s10, 256
    s_mov_b32 s11, 0x20000
    s_mov_b32 s4, s88
    s_and_b32 s5, s89, 0xffff
    s_mov_b32 s6, 33554432
    s_mov_b32 s7, 0x20000
    s_mov_b32 s28, s84
    s_and_b32 s29, s85, 0xffff
    s_mov_b32 s30, 5242880
    s_mov_b32 s31, 0x20000
    s_cmp_lg_u32 s32, 0
    s_cbranch_scc1 L_norank
    s_mov_b64 exec, 1
    buffer_atomic_add v2, v1, s[8:11], 0 offen sc0 sc1
    s_waitcnt vmcnt(0)
    ds_write_b32 v3, v2
    s_mov_b64 exec, -1
    s_waitcnt lgkmcnt(0)
    s_branch L_rank
L_norank:
    s_and_b32 s34, s33, 7
    s_lshr_b32 s93, s2, 3
    s_mul_i32 s93, s93, 3
    s_add_u32 s93, s93, s32
    s_sub_u32 s93, s93, 1
    v_add_u32 v4, 0, v0
    v_cmp_le_u32 vcc, 96, v4
    v_subrev_u32 v5, 96, v4
    s_nop 0
    v_cndmask_b32 v4, v4, v5, vcc
    v_lshlrev_b32 v4, 4, v4
    v_mov_b32 v5, 12288
    v_cndmask_b32 v5, 0, v5, vcc
    s_mul_i32 s90, s34, 1536
    v_add3_u32 v6, v4, v5, s90
    v_add_u32 v4, 64, v0
    v_cmp_le_u32 vcc, 96, v4
    v_subrev_u32 v5, 96, v4
    s_nop 0
    v_cndmask_b32 v4, v4, v5, vcc
    v_lshlrev_b32 v4, 4, v4
    v_mov_b32 v5, 12288
    v_cndmask_b32 v5, 0, v5, vcc
    s_mul_i32 s90, s34, 1536
    v_add3_u32 v7, v4, v5, s90
    v_add_u32 v4, 128, v0
    v_cmp_le_u32 vcc, 96, v4
    v_subrev_u32 v5, 96, v4
    s_nop 0
    v_cndmask_b32 v4, v4, v5, vcc
    v_lshlrev_b32 v4, 4, v4
    v_mov_b32 v5, 12288
    v_cndmask_b32 v5, 0, v5, vcc
    s_mul_i32 s90, s34, 1536
    v_add3_u32 v8, v4, v5, s90
    s_cmp_lt_u32 s93, 64
    s_cselect_b32 s12, s78, s76
    s_cselect_b32 s13, s79, s77
    s_cselect_b32 s91, 2, 0
    s_cmp_lt_u32 s93, 32
    s_cselect_b32 s12, s78, s12
    s_cselect_b32 s13, s79, s13
    s_cselect_b32 s91, 2, s91
    s_and_b32 s13, s13, 0xffff
    s_mov_b32 s14, 7864320
    s_mov_b32 s15, 0x20000
    s_mul_i32 s91, s91, 320
    s_mul_i32 s90, s93, 10
    s_add_u32 s90, s90, s91
    s_sub_u32 s90, s90, 640
    s_mul_i32 s90, s90, 12288
    buffer_load_dwordx4 v[248:251], v6, s[12:15], s90 offen
    buffer_load_dwordx4 v[248:251], v7, s[12:15], s90 offen
    buffer_load_dwordx4 v[248:251], v8, s[12:15], s90 offen
    s_add_u32 s90, s90, 24576
    buffer_load_dwordx4 v[248:251], v6, s[12:15], s90 offen
    buffer_load_dwordx4 v[248:251], v7, s[12:15], s90 offen
    buffer_load_dwordx4 v[248:251], v8, s[12:15], s90 offen
    s_add_u32 s90, s90, 24576
    buffer_load_dwordx4 v[248:251], v6, s[12:15], s90 offen
    buffer_load_dwordx4 v[248:251], v7, s[12:15], s90 offen
    buffer_load_dwordx4 v[248:251], v8, s[12:15], s90 offen
    s_add_u32 s90, s90, 24576
    buffer_load_dwordx4 v[248:251], v6, s[12:15], s90 offen
    buffer_load_dwordx4 v[248:251], v7, s[12:15], s90 offen
    buffer_load_dwordx4 v[248:251], v8, s[12:15], s90 offen
    s_add_u32 s90, s90, 24576
    buffer_load_dwordx4 v[248:251], v6, s[12:15], s90 offen
    buffer_load_dwordx4 v[248:251], v7, s[12:15], s90 offen
    buffer_load_dwordx4 v[248:251], v8, s[12:15], s90 offen
    s_add_u32 s90, s90, 24576
L_rank:
    s_barrier
    ds_read_b32 v2, v3
    s_waitcnt lgkmcnt(0)
    v_readfirstlane_b32 s35, v2
    s_mov_b32 s34, s33
    s_barrier
    s_cmp_ge_u32 s33, 8
    s_cbranch_scc1 L_norole
    s_cmp_ge_u32 s35, 32
    s_cbranch_scc1 L_norole
    s_lshl_b32 s38, s34, 21
    s_add_u32 s38, s38, 8388608
    s_cmp_lt_u32 s35, 28
    s_cbranch_scc1 L_noini_1
    v_mov_b32 v240, -1
    v_mov_b32 v241, -1
    v_mov_b32 v242, -1
    v_mov_b32 v243, -1
    v_mov_b32 v244, 0
    v_lshlrev_b32 v4, 4, v0
    v_lshlrev_b32 v5, 2, v0
    s_sub_u32 s93, s35, 28
    s_lshl_b32 s93, s93, 2
    s_add_u32 s93, s93, s32
    s_lshl_b32 s91, s34, 4
    s_add_u32 s91, s91, s93
    s_lshl_b32 s41, s91, 8
    s_add_u32 s41, s41, 1933312
    s_mul_i32 s91, s91, 5120
    s_lshl_b32 s40, s93, 8
    s_add_u32 s40, s40, s38
    s_add_u32 s40, s40, 458752
    s_lshr_b32 s92, s93, 3
    s_mul_i32 s92, s92, 114688
    s_add_u32 s92, s92, s38
    s_and_b32 s93, s93, 7
    s_mul_i32 s93, s93, 5120
    s_add_u32 s92, s92, s93
    buffer_store_dwordx4 v[240:243], v4, s[4:7], s91 offen offset:0 sc1
    buffer_store_dwordx4 v[240:243], v4, s[4:7], s91 offen offset:1024 sc1
    buffer_store_dwordx4 v[240:243], v4, s[4:7], s91 offen offset:2048 sc1
    buffer_store_dwordx4 v[240:243], v4, s[4:7], s91 offen offset:3072 sc1
    s_add_u32 s91, s91, 4096
    buffer_store_dwordx4 v[240:243], v4, s[4:7], s91 offen offset:0 sc1
    buffer_store_dwordx4 v[240:243], v4, s[4:7], s92 offen offset:0 sc1
    buffer_store_dwordx4 v[240:243], v4, s[4:7], s92 offen offset:1024 sc1
    buffer_store_dwordx4 v[240:243], v4, s[4:7], s92 offen offset:2048 sc1
    buffer_store_dwordx4 v[240:243], v4, s[4:7], s92 offen offset:3072 sc1
    s_add_u32 s92, s92, 4096
    buffer_store_dwordx4 v[240:243], v4, s[4:7], s92 offen offset:0 sc1
    buffer_store_dword v244, v5, s[4:7], s40 offen sc1
    buffer_store_dword v244, v5, s[4:7], s41 offen sc1
    s_waitcnt vmcnt(0)
    s_barrier
    s_cmp_lg_u32 s32, 0
    s_cbranch_scc1 L_ini_2
    v_mov_b32 v1, 64
    v_mov_b32 v2, 1
    s_mov_b64 exec, 1
    buffer_atomic_add v2, v1, s[8:11], 0 offen sc0 sc1
    s_waitcnt vmcnt(0)
    v_readfirstlane_b32 s90, v2
    s_mov_b64 exec, -1
    s_cmp_lg_u32 s90, 31
    s_cbranch_scc1 L_ini_2
    v_mov_b32 v1, 192
    v_mov_b32 v2, 1
    s_mov_b64 exec, 1
    buffer_store_dword v2, v1, s[8:11], 0 offen sc1
    s_mov_b64 exec, -1
L_ini_2:
    s_barrier
    s_cmp_eq_u32 s35, 28
    s_cbranch_scc1 L_px_f
L_noini_1:
    s_sub_u32 s93, s35, 12
    s_cmp_lt_u32 s93, 6
    s_cbranch_scc1 L_v_f
    s_cmp_ge_u32 s35, 12
    s_cselect_b32 s92, 6, 0
    s_sub_u32 s93, s35, s92
    s_cmp_gt_u32 s35, 28
    s_subb_u32 s93, s93, 0
    s_lshl_b32 s93, s93, 2
    s_add_u32 s93, s93, s32
    s_cmp_ge_u32 s93, 96
    s_cbranch_scc1 L_pa_f
    v_add_u32 v4, 0, v0
    v_cmp_le_u32 vcc, 96, v4
    v_subrev_u32 v5, 96, v4
    s_nop 0
    v_cndmask_b32 v4, v4, v5, vcc
    v_lshlrev_b32 v4, 4, v4
    v_mov_b32 v5, 12288
    v_cndmask_b32 v5, 0, v5, vcc
    s_mul_i32 s90, s34, 1536
    v_add3_u32 v6, v4, v5, s90
    v_add_u32 v4, 64, v0
    v_cmp_le_u32 vcc, 96, v4
    v_subrev_u32 v5, 96, v4
    s_nop 0
    v_cndmask_b32 v4, v4, v5, vcc
    v_lshlrev_b32 v4, 4, v4
    v_mov_b32 v5, 12288
    v_cndmask_b32 v5, 0, v5, vcc
    s_mul_i32 s90, s34, 1536
    v_add3_u32 v7, v4, v5, s90
    v_add_u32 v4, 128, v0
    v_cmp_le_u32 vcc, 96, v4
    v_subrev_u32 v5, 96, v4
    s_nop 0
    v_cndmask_b32 v4, v4, v5, vcc
    v_lshlrev_b32 v4, 4, v4
    v_mov_b32 v5, 12288
    v_cndmask_b32 v5, 0, v5, vcc
    s_mul_i32 s90, s34, 1536
    v_add3_u32 v8, v4, v5, s90
    s_cmp_lt_u32 s93, 64
    s_cselect_b32 s12, s76, s74
    s_cselect_b32 s13, s77, s75
    s_cselect_b32 s91, 2, 1
    s_cmp_lt_u32 s93, 32
    s_cselect_b32 s12, s74, s12
    s_cselect_b32 s13, s75, s13
    s_cselect_b32 s91, 2, s91
    s_and_b32 s13, s13, 0xffff
    s_mov_b32 s14, 7864320
    s_mov_b32 s15, 0x20000
    s_mul_i32 s91, s91, 320
    s_mul_i32 s90, s93, 10
    s_add_u32 s90, s90, s91
    s_sub_u32 s90, s90, 640
    s_mul_i32 s90, s90, 12288
    buffer_load_dwordx4 v[248:251], v6, s[12:15], s90 offen
    buffer_load_dwordx4 v[248:251], v7, s[12:15], s90 offen
    buffer_load_dwordx4 v[248:251], v8, s[12:15], s90 offen
    s_add_u32 s90, s90, 24576
    buffer_load_dwordx4 v[248:251], v6, s[12:15], s90 offen
    buffer_load_dwordx4 v[248:251], v7, s[12:15], s90 offen
    buffer_load_dwordx4 v[248:251], v8, s[12:15], s90 offen
    s_add_u32 s90, s90, 24576
    buffer_load_dwordx4 v[248:251], v6, s[12:15], s90 offen
    buffer_load_dwordx4 v[248:251], v7, s[12:15], s90 offen
    buffer_load_dwordx4 v[248:251], v8, s[12:15], s90 offen
    s_add_u32 s90, s90, 24576
    buffer_load_dwordx4 v[248:251], v6, s[12:15], s90 offen
    buffer_load_dwordx4 v[248:251], v7, s[12:15], s90 offen
    buffer_load_dwordx4 v[248:251], v8, s[12:15], s90 offen
    s_add_u32 s90, s90, 24576
    buffer_load_dwordx4 v[248:251], v6, s[12:15], s90 offen
    buffer_load_dwordx4 v[248:251], v7, s[12:15], s90 offen
    buffer_load_dwordx4 v[248:251], v8, s[12:15], s90 offen
    s_add_u32 s90, s90, 24576
    s_waitcnt vmcnt(20)
    s_nop 0
    s_cmp_lt_u32 s35, 12
    s_cbranch_scc1 L_qkv_f
    s_cmp_lt_u32 s35, 18
    s_cbranch_scc1 L_v_f
    s_cmp_lt_u32 s35, 28
    s_cbranch_scc1 L_wo_f
    s_cmp_lt_u32 s35, 29
    s_cbranch_scc1 L_px_f
    s_branch L_pa_f
L_norole:
    v_mov_b32 v1, 192
    v_mov_b32 v2, 2
    s_mov_b64 exec, 1
    buffer_store_dword v2, v1, s[8:11], 0 offen sc1
    s_mov_b64 exec, -1
    s_branch L_slow
L_exit:
    s_endpgm
L_qkv_f:
    s_mov_b32 s12, s74
    s_and_b32 s13, s75, 0xffff
    s_mov_b32 s14, 7864320
    s_mov_b32 s15, 0x20000
    s_mov_b32 s16, s76
    s_and_b32 s17, s77, 0xffff
    s_mov_b32 s18, 7864320
    s_mov_b32 s19, 0x20000
    s_mov_b32 s40, s35
    s_mov_b32 s24, s70
    s_and_b32 s25, s71, 0xffff
    s_mov_b32 s26, 2621440
    s_mov_b32 s27, 0x20000
    v_and_b32 v1, 15, v0
    v_lshrrev_b32 v2, 4, v0
    v_lshrrev_b32 v3, 3, v0
    v_and_b32 v4, 7, v0
    s_lshl_b32 s90, s32, 3
    v_add_u32 v5, s90, v3
    s_and_b32 s91, s32, 1
    s_lshl_b32 s91, s91, 2
    v_and_b32 v6, 2, v3
    v_or_b32 v6, s91, v6
    v_xor_b32 v6, v6, v4
    v_lshlrev_b32 v6, 4, v6
    v_mul_u32_u24 v7, 12288, v5
    s_mul_i32 s92, s34, 1536
    s_lshl_b32 s93, s40, 7
    s_add_u32 s92, s92, s93
    v_add3_u32 v124, v6, v7, s92
    v_lshrrev_b32 v6, 1, v3
    v_or_b32 v6, s91, v6
    v_xor_b32 v6, v6, v4
    v_lshlrev_b32 v6, 4, v6
    v_mul_u32_u24 v7, 1280, v5
    v_add_u32 v10, v6, v7
    s_lshl_b32 s90, s32, 10
    s_add_u32 m0, s90, 81920
    s_mov_b32 s91, 0
    buffer_load_dwordx4 v124, s[16:19], s91 offen nt lds
    s_add_u32 m0, m0, 4096
    s_add_u32 s91, s91, 393216
    buffer_load_dwordx4 v124, s[16:19], s91 offen nt lds
    s_add_u32 m0, m0, 4096
    s_add_u32 s91, s91, 393216
    buffer_load_dwordx4 v124, s[16:19], s91 offen nt lds
    s_add_u32 m0, m0, 4096
    s_add_u32 s91, s91, 393216
    buffer_load_dwordx4 v124, s[16:19], s91 offen nt lds
    s_add_u32 m0, m0, 4096
    s_add_u32 s91, s91, 393216
    buffer_load_dwordx4 v124, s[16:19], s91 offen nt lds
    s_add_u32 m0, m0, 4096
    s_add_u32 s91, s91, 393216
    buffer_load_dwordx4 v124, s[16:19], s91 offen nt lds
    s_add_u32 m0, m0, 4096
    s_add_u32 s91, s91, 393216
    buffer_load_dwordx4 v124, s[16:19], s91 offen nt lds
    s_add_u32 m0, m0, 4096
    s_add_u32 s91, s91, 393216
    buffer_load_dwordx4 v124, s[16:19], s91 offen nt lds
    s_add_u32 m0, m0, 4096
    s_add_u32 s91, s91, 393216
    buffer_load_dwordx4 v124, s[16:19], s91 offen nt lds
    s_add_u32 m0, m0, 4096
    s_add_u32 s91, s91, 393216
    buffer_load_dwordx4 v124, s[16:19], s91 offen nt lds
    s_mul_i32 s60, s40, 86
    s_lshr_b32 s60, s60, 8
    s_mul_i32 s61, s60, 3
    s_sub_u32 s61, s40, s61
    s_add_u32 s90, s40, 1
    s_mul_i32 s62, s90, 86
    s_lshr_b32 s62, s62, 8
    s_mul_i32 s63, s62, 3
    s_sub_u32 s63, s90, s63
    v_lshrrev_b32 v3, 1, v2
    v_and_b32 v5, 1, v2
    s_lshl_b32 s90, s32, 9
    v_lshlrev_b32 v6, 4, v1
    v_lshl_add_u32 v6, v3, 8, v6
    v_add_u32 v6, s90, v6
    s_mul_i32 s90, s60, 12288
    s_lshl_b32 s91, s61, 11
    s_add_u32 s90, s90, s91
    v_mul_u32_u24 v7, 6144, v5
    v_add3_u32 v19, v6, v7, s90
    v_mov_b32 v22, -1
    s_mov_b32 s56, 49152
    v_lshl_add_u32 v137, v5, 11, v6
    v_add_u32 v137, 135168, v137
    s_mul_i32 s90, s40, 1280
    s_add_u32 s90, s90, 10240
    v_lshlrev_b32 v6, 1, v5
    v_or_b32 v7, v6, v3
    v_lshl_add_u32 v7, v7, 4, v1
    v_lshlrev_b32 v7, 2, v7
    v_add_u32 v7, 1024, v7
    v_or_b32 v6, v6, v1
    v_lshl_add_u32 v6, v3, 4, v6
    v_lshlrev_b32 v6, 4, v6
    s_sub_u32 s91, s32, 1
    s_lshl_b32 s91, s91, 9
    v_add_u32 v6, s91, v6
    s_cmp_eq_u32 s32, 0
    s_cselect_b64 vcc, -1, 0
    v_cndmask_b32 v6, v6, v7, vcc
    v_add_u32 v135, s90, v6
    s_lshl_b32 s91, s32, 8
    s_add_u32 s91, s91, s90
    v_lshl_add_u32 v150, v0, 2, s91
    v_and_b32 v4, 2, v1
    v_cmp_eq_u32 vcc, 0, v4
    v_mov_b32 v9, 2146435072
    s_nop 0
    v_cndmask_b32 v135, v9, v135, vcc
    s_lshl_b32 s90, s40, 10
    v_lshrrev_b32 v3, 2, v1
    v_lshlrev_b32 v3, 1, v3
    v_and_b32 v6, 1, v1
    v_or_b32 v3, v3, v6
    v_lshl_add_u32 v3, v2, 3, v3
    v_lshl_add_u32 v136, v3, 4, s90
    v_cmp_ne_u32 vcc, 0, v4
    v_mov_b32 v9, 2146435072
    s_nop 0
    v_cndmask_b32 v136, v9, v136, vcc
    v_and_b32 v6, 9, v1
    v_lshl_or_b32 v6, v4, 1, v6
    v_and_b32 v7, 4, v1
    v_lshrrev_b32 v7, 1, v7
    v_or_b32 v6, v6, v7
    v_lshlrev_b32 v6, 4, v6
    v_lshl_add_u32 v6, v2, 8, v6
    s_cmp_eq_u32 s32, 2
    s_cselect_b32 s90, 2048, 0
    s_add_u32 s90, s90, 135168
    v_add_u32 v138, s90, v6
    s_lshl_b32 s90, s60, 7
    s_lshl_b32 s91, s61, 2
    s_add_u32 s91, s91, s90
    s_add_u32 s91, s91, 459264
    s_cmp_eq_u32 s32, 3
    s_cselect_b32 s91, s91, 2146435072
    s_cselect_b32 s55, -1, 0
    v_mov_b32 v139, s91
    v_cmp_eq_u32 vcc, 0, v0
    v_mov_b32 v9, 2146435072
    s_nop 0
    v_cndmask_b32 v139, v9, v139, vcc
    v_add_u32 v21, 3072, v139
    s_mul_i32 s90, s35, 32768
    s_lshl_b32 s91, s32, 11
    s_add_u32 s90, s90, s91
    s_lshl_b32 s92, s35, 10
    s_lshl_b32 s91, s32, 8
    s_add_u32 s92, s92, s91
    s_cmp_lt_u32 s35, 10
    s_cselect_b32 s90, s90, 2146435072
    s_cselect_b32 s92, s92, 2146435072
    s_lshl_b32 s91, s34, 8
    v_lshlrev_b32 v3, 4, v0
    v_xor_b32 v3, s91, v3
    v_add_u32 v142, s90, v3
    v_xor_b32 v3, 1024, v3
    v_add_u32 v143, s90, v3
    s_min_u32 s90, s35, 9
    s_lshl_b32 s90, s90, 7
    s_add_u32 s90, s90, 460800
    s_add_u32 s90, s90, s38
    v_and_b32 v3, 3, v0
    v_lshl_add_u32 v146, v3, 2, s90
    s_add_u32 s90, s38, 460416
    v_mov_b32 v146, s90
    v_lshl_add_u32 v149, v0, 2, s92
    v_lshlrev_b32 v3, 3, v1
    v_lshl_add_u32 v3, v2, 6, v3
    v_add_u32 v148, s92, v3
    v_cmp_gt_u32 vcc, 8, v1
    v_mov_b32 v9, 2146435072
    s_nop 0
    v_cndmask_b32 v148, v9, v148, vcc
    v_lshrrev_b32 v8, 1, v1
    v_and_b32 v7, 2, v8
    v_cmp_ne_u32 vcc, 0, v7
    v_mov_b32 v5, 0x3f80
    v_mov_b32 v6, 0x3f800000
    v_cndmask_b32 v5, v5, v6, vcc
    v_bfe_u32 v6, v8, 2, 1
    v_and_b32 v7, 1, v8
    v_lshl_or_b32 v6, v7, 1, v6
    v_cmp_eq_u32 vcc, 0, v6
    s_nop 1
    v_cndmask_b32 v196, 0, v5, vcc
    v_cmp_eq_u32 vcc, 1, v6
    s_nop 1
    v_cndmask_b32 v197, 0, v5, vcc
    v_cmp_eq_u32 vcc, 2, v6
    s_nop 1
    v_cndmask_b32 v198, 0, v5, vcc
    v_cmp_eq_u32 vcc, 3, v6
    s_nop 1
    v_cndmask_b32 v199, 0, v5, vcc
    s_mov_b32 s58, 0xaaaaaaaa
    s_mov_b32 s59, 0xaaaaaaaa
    v_lshrrev_b32 v3, 2, v1
    v_and_b32 v4, 3, v1
    v_and_b32 v5, 1, v2
    v_lshl_add_u32 v6, v2, 3, v3
    v_lshlrev_b32 v6, 7, v6
    v_and_b32 v7, 2, v3
    v_lshl_or_b32 v7, v5, 2, v7
    v_lshrrev_b32 v8, 1, v4
    s_lshl_b32 s90, s32, 1
    v_or_b32 v8, s90, v8
    v_xor_b32 v7, v7, v8
    v_lshl_add_u32 v6, v7, 4, v6
    v_and_b32 v7, 1, v4
    v_lshl_add_u32 v6, v7, 3, v6
    v_add_u32 v125, 81920, v6
    v_add_u32 v126, 40960, v6
    v_add_u32 v127, 122880, v6
    s_lshl_b32 s90, s32, 9
    s_add_u32 s90, s90, 133120
    v_xor_b32 v6, 0, v5
    v_lshl_add_u32 v6, v6, 2, v3
    v_lshl_add_u32 v6, v2, 3, v6
    v_lshlrev_b32 v6, 5, v6
    v_lshl_or_b32 v7, v5, 1, 0
    v_xor_b32 v7, v7, v4
    v_lshl_add_u32 v6, v7, 3, v6
    v_add_u32 v24, 133120, v6
    v_xor_b32 v6, 1, v5
    v_lshl_add_u32 v6, v6, 2, v3
    v_lshl_add_u32 v6, v2, 3, v6
    v_lshlrev_b32 v6, 5, v6
    v_lshl_or_b32 v7, v5, 1, 1
    v_xor_b32 v7, v7, v4
    v_lshl_add_u32 v6, v7, 3, v6
    v_add_u32 v134, 133120, v6
    v_lshrrev_b32 v6, 3, v1
    v_lshlrev_b32 v6, 2, v6
    v_xor_b32 v6, v6, v1
    v_lshlrev_b32 v6, 5, v6
    v_xor_b32 v7, v2, v3
    v_lshl_add_u32 v6, v7, 3, v6
    v_add_u32 v23, s90, v6
    v_and_b32 v7, 2, v1
    v_cmp_ne_u32 vcc, 0, v7
    v_mov_b32 v6, 0x4444
    v_mov_b32 v8, 0xeeee
    v_cndmask_b32 v17, v6, v8, vcc
    v_lshlrev_b32 v6, 4, v0
    v_add_u32 v16, 122880, v6
    s_mul_i32 s90, s32, 2560
    v_lshl_add_u32 v13, v0, 4, s90
    v_lshl_add_u32 v14, v0, 2, s90
    s_add_u32 s48, s90, 122880
    v_mul_u32_u24 v6, 40, v0
    v_add_u32 v15, s48, v6
    v_mul_u32_u24 v6, 164, v0
    v_min_u32 v6, 10236, v6
    v_add_u32 v25, 122880, v6
    v_lshrrev_b32 v6, 3, v1
    v_lshlrev_b32 v6, 10, v6
    v_and_b32 v7, 7, v1
    v_lshl_add_u32 v6, v7, 7, v6
    v_lshrrev_b32 v7, 1, v1
    v_xor_b32 v7, v7, v2
    v_lshl_add_u32 v11, v7, 4, v6
    v_xor_b32 v12, 64, v11
    s_and_b32 s91, s34, 1
    s_lshl_b32 s91, s91, 12
    s_lshr_b32 s92, s34, 2
    s_lshl_b32 s92, s92, 13
    s_add_u32 s91, s91, s92
    s_and_b32 s92, s34, 2
    s_lshl_b32 s92, s92, 13
    s_add_u32 s91, s91, s92
    s_add_u32 s91, s91, 1933312
    v_lshrrev_b32 v4, 2, v0
    v_lshl_add_u32 v3, v4, 9, s91
    v_cmp_ne_u32 s[92:93], s34, v4
    v_cmp_gt_u32 vcc, 32, v0
    s_nop 0
    s_and_b64 vcc, vcc, s[92:93]
    s_and_b32 vcc_lo, vcc_lo, s55
    v_cndmask_b32 v146, v146, v3, vcc
    v_cndmask_b32 v152, 0, -1, vcc
    s_lshl_b32 s90, s32, 10
    s_add_u32 m0, s90, 40960
    s_mov_b32 s91, 0
    buffer_load_dwordx4 v124, s[12:15], s91 offen nt lds
    s_add_u32 m0, m0, 4096
    s_add_u32 s91, s91, 393216
    buffer_load_dwordx4 v124, s[12:15], s91 offen nt lds
    s_add_u32 m0, m0, 4096
    s_add_u32 s91, s91, 393216
    buffer_load_dwordx4 v124, s[12:15], s91 offen nt lds
    s_add_u32 m0, m0, 4096
    s_add_u32 s91, s91, 393216
    buffer_load_dwordx4 v124, s[12:15], s91 offen nt lds
    s_add_u32 m0, m0, 4096
    s_add_u32 s91, s91, 393216
    buffer_load_dwordx4 v124, s[12:15], s91 offen nt lds
    s_add_u32 m0, m0, 4096
    s_add_u32 s91, s91, 393216
    buffer_load_dwordx4 v124, s[12:15], s91 offen nt lds
    s_add_u32 m0, m0, 4096
    s_add_u32 s91, s91, 393216
    buffer_load_dwordx4 v124, s[12:15], s91 offen nt lds
    s_add_u32 m0, m0, 4096
    s_add_u32 s91, s91, 393216
    buffer_load_dwordx4 v124, s[12:15], s91 offen nt lds
    s_add_u32 m0, m0, 4096
    s_add_u32 s91, s91, 393216
    buffer_load_dwordx4 v124, s[12:15], s91 offen nt lds
    s_add_u32 m0, m0, 4096
    s_add_u32 s91, s91, 393216
    buffer_load_dwordx4 v124, s[12:15], s91 offen nt lds
    s_lshl_b32 s90, s32, 10
    s_add_u32 m0, s90, 122880
    s_mov_b32 s91, 3932160
    buffer_load_dwordx4 v124, s[16:19], s91 offen nt lds
    s_add_u32 m0, m0, 4096
    s_add_u32 s91, s91, 393216
    buffer_load_dwordx4 v124, s[16:19], s91 offen nt lds
    s_add_u32 m0, m0, 4096
    s_add_u32 s91, s91, 393216
    buffer_load_dwordx4 v124, s[16:19], s91 offen nt lds
    s_add_u32 m0, m0, 4096
    s_add_u32 s91, s91, 393216
    buffer_load_dwordx4 v124, s[16:19], s91 offen nt lds
    s_add_u32 m0, m0, 4096
    s_add_u32 s91, s91, 393216
    buffer_load_dwordx4 v124, s[16:19], s91 offen nt lds
    s_add_u32 m0, m0, 4096
    s_add_u32 s91, s91, 393216
    buffer_load_dwordx4 v124, s[16:19], s91 offen nt lds
    s_add_u32 m0, m0, 4096
    s_add_u32 s91, s91, 393216
    buffer_load_dwordx4 v124, s[16:19], s91 offen nt lds
    s_add_u32 m0, m0, 4096
    s_add_u32 s91, s91, 393216
    buffer_load_dwordx4 v124, s[16:19], s91 offen nt lds
    s_add_u32 m0, m0, 4096
    s_add_u32 s91, s91, 393216
    buffer_load_dwordx4 v124, s[16:19], s91 offen nt lds
    s_add_u32 m0, m0, 4096
    s_add_u32 s91, s91, 393216
    buffer_load_dwordx4 v124, s[16:19], s91 offen nt lds
    s_mov_b32 s46, 0
    s_lshl_b32 s90, s32, 10
    s_add_u32 m0, s90, 0
    s_nop 0
    buffer_load_dwordx4 v10, s[24:27], s46 offen offset:0 nt lds
    s_add_u32 m0, m0, 3968
    s_nop 0
    buffer_load_dwordx4 v10, s[24:27], s46 offen offset:128 nt lds
    s_add_u32 m0, m0, 3968
    s_nop 0
    buffer_load_dwordx4 v10, s[24:27], s46 offen offset:256 nt lds
    s_add_u32 m0, m0, 3968
    s_nop 0
    buffer_load_dwordx4 v10, s[24:27], s46 offen offset:384 nt lds
    s_add_u32 m0, m0, 3968
    s_nop 0
    buffer_load_dwordx4 v10, s[24:27], s46 offen offset:512 nt lds
    s_add_u32 m0, m0, 3968
    s_nop 0
    buffer_load_dwordx4 v10, s[24:27], s46 offen offset:640 nt lds
    s_add_u32 m0, m0, 3968
    s_nop 0
    buffer_load_dwordx4 v10, s[24:27], s46 offen offset:768 nt lds
    s_add_u32 m0, m0, 3968
    s_nop 0
    buffer_load_dwordx4 v10, s[24:27], s46 offen offset:896 nt lds
    s_add_u32 m0, m0, 3968
    s_nop 0
    buffer_load_dwordx4 v10, s[24:27], s46 offen offset:1024 nt lds
    s_add_u32 m0, m0, 3968
    s_nop 0
    buffer_load_dwordx4 v10, s[24:27], s46 offen offset:1152 nt lds
    s_waitcnt vmcnt(30)
    s_barrier
    ds_read_b64_tr_b16 a[80:81], v125 offset:0
    ds_read_b64_tr_b16 a[82:83], v125 offset:512
    ds_read_b64_tr_b16 a[84:85], v125 offset:4096
    ds_read_b64_tr_b16 a[86:87], v125 offset:4608
    ds_read_b64_tr_b16 a[88:89], v125 offset:8192
    ds_read_b64_tr_b16 a[90:91], v125 offset:8704
    ds_read_b64_tr_b16 a[92:93], v125 offset:12288
    ds_read_b64_tr_b16 a[94:95], v125 offset:12800
    ds_read_b64_tr_b16 a[96:97], v125 offset:16384
    ds_read_b64_tr_b16 a[98:99], v125 offset:16896
    ds_read_b64_tr_b16 a[100:101], v125 offset:20480
    ds_read_b64_tr_b16 a[102:103], v125 offset:20992
    ds_read_b64_tr_b16 a[104:105], v125 offset:24576
    ds_read_b64_tr_b16 a[106:107], v125 offset:25088
    ds_read_b64_tr_b16 a[108:109], v125 offset:28672
    ds_read_b64_tr_b16 a[110:111], v125 offset:29184
    ds_read_b64_tr_b16 a[112:113], v125 offset:32768
    ds_read_b64_tr_b16 a[114:115], v125 offset:33280
    ds_read_b64_tr_b16 a[116:117], v125 offset:36864
    ds_read_b64_tr_b16 a[118:119], v125 offset:37376
    s_waitcnt lgkmcnt(0)
    s_barrier
    s_lshl_b32 s90, s32, 10
    s_add_u32 m0, s90, 81920
    s_mov_b32 s91, 3932160
    buffer_load_dwordx4 v124, s[12:15], s91 offen nt lds
    s_add_u32 m0, m0, 4096
    s_add_u32 s91, s91, 393216
    buffer_load_dwordx4 v124, s[12:15], s91 offen nt lds
    s_add_u32 m0, m0, 4096
    s_add_u32 s91, s91, 393216
    buffer_load_dwordx4 v124, s[12:15], s91 offen nt lds
    s_add_u32 m0, m0, 4096
    s_add_u32 s91, s91, 393216
    buffer_load_dwordx4 v124, s[12:15], s91 offen nt lds
    s_add_u32 m0, m0, 4096
    s_add_u32 s91, s91, 393216
    buffer_load_dwordx4 v124, s[12:15], s91 offen nt lds
    s_add_u32 m0, m0, 4096
    s_add_u32 s91, s91, 393216
    buffer_load_dwordx4 v124, s[12:15], s91 offen nt lds
    s_add_u32 m0, m0, 4096
    s_add_u32 s91, s91, 393216
    buffer_load_dwordx4 v124, s[12:15], s91 offen nt lds
    s_add_u32 m0, m0, 4096
    s_add_u32 s91, s91, 393216
    buffer_load_dwordx4 v124, s[12:15], s91 offen nt lds
    s_add_u32 m0, m0, 4096
    s_add_u32 s91, s91, 393216
    buffer_load_dwordx4 v124, s[12:15], s91 offen nt lds
    s_add_u32 m0, m0, 4096
    s_add_u32 s91, s91, 393216
    buffer_load_dwordx4 v124, s[12:15], s91 offen nt lds
    s_waitcnt vmcnt(30)
    s_barrier
    ds_read_b64_tr_b16 a[0:1], v126 offset:0
    ds_read_b64_tr_b16 a[2:3], v126 offset:512
    ds_read_b64_tr_b16 a[4:5], v126 offset:4096
    ds_read_b64_tr_b16 a[6:7], v126 offset:4608
    ds_read_b64_tr_b16 a[8:9], v126 offset:8192
    ds_read_b64_tr_b16 a[10:11], v126 offset:8704
    ds_read_b64_tr_b16 a[12:13], v126 offset:12288
    ds_read_b64_tr_b16 a[14:15], v126 offset:12800
    ds_read_b64_tr_b16 a[16:17], v126 offset:16384
    ds_read_b64_tr_b16 a[18:19], v126 offset:16896
    ds_read_b64_tr_b16 a[20:21], v126 offset:20480
    ds_read_b64_tr_b16 a[22:23], v126 offset:20992
    ds_read_b64_tr_b16 a[24:25], v126 offset:24576
    ds_read_b64_tr_b16 a[26:27], v126 offset:25088
    ds_read_b64_tr_b16 a[28:29], v126 offset:28672
    ds_read_b64_tr_b16 a[30:31], v126 offset:29184
    ds_read_b64_tr_b16 a[32:33], v126 offset:32768
    ds_read_b64_tr_b16 a[34:35], v126 offset:33280
    ds_read_b64_tr_b16 a[36:37], v126 offset:36864
    ds_read_b64_tr_b16 a[38:39], v126 offset:37376
    s_waitcnt lgkmcnt(0)
    s_barrier
    s_mov_b32 s46, 40960
    s_lshl_b32 s90, s32, 10
    s_add_u32 m0, s90, 40960
    s_nop 0
    buffer_load_dwordx4 v10, s[24:27], s46 offen offset:0 nt lds
    s_add_u32 m0, m0, 3968
    s_nop 0
    buffer_load_dwordx4 v10, s[24:27], s46 offen offset:128 nt lds
    s_add_u32 m0, m0, 3968
    s_nop 0
    buffer_load_dwordx4 v10, s[24:27], s46 offen offset:256 nt lds
    s_add_u32 m0, m0, 3968
    s_nop 0
    buffer_load_dwordx4 v10, s[24:27], s46 offen offset:384 nt lds
    s_add_u32 m0, m0, 3968
    s_nop 0
    buffer_load_dwordx4 v10, s[24:27], s46 offen offset:512 nt lds
    s_add_u32 m0, m0, 3968
    s_nop 0
    buffer_load_dwordx4 v10, s[24:27], s46 offen offset:640 nt lds
    s_add_u32 m0, m0, 3968
    s_nop 0
    buffer_load_dwordx4 v10, s[24:27], s46 offen offset:768 nt lds
    s_add_u32 m0, m0, 3968
    s_nop 0
    buffer_load_dwordx4 v10, s[24:27], s46 offen offset:896 nt lds
    s_add_u32 m0, m0, 3968
    s_nop 0
    buffer_load_dwordx4 v10, s[24:27], s46 offen offset:1024 nt lds
    s_add_u32 m0, m0, 3968
    s_nop 0
    buffer_load_dwordx4 v10, s[24:27], s46 offen offset:1152 nt lds
    s_waitcnt vmcnt(30)
    s_barrier
    ds_read_b64_tr_b16 a[120:121], v127 offset:0
    ds_read_b64_tr_b16 a[122:123], v127 offset:512
    ds_read_b64_tr_b16 a[124:125], v127 offset:4096
    ds_read_b64_tr_b16 a[126:127], v127 offset:4608
    ds_read_b64_tr_b16 a[128:129], v127 offset:8192
    ds_read_b64_tr_b16 a[130:131], v127 offset:8704
    ds_read_b64_tr_b16 a[132:133], v127 offset:12288
    ds_read_b64_tr_b16 a[134:135], v127 offset:12800
    ds_read_b64_tr_b16 a[136:137], v127 offset:16384
    ds_read_b64_tr_b16 a[138:139], v127 offset:16896
    ds_read_b64_tr_b16 a[140:141], v127 offset:20480
    ds_read_b64_tr_b16 a[142:143], v127 offset:20992
    ds_read_b64_tr_b16 a[144:145], v127 offset:24576
    ds_read_b64_tr_b16 a[146:147], v127 offset:25088
    ds_read_b64_tr_b16 a[148:149], v127 offset:28672
    ds_read_b64_tr_b16 a[150:151], v127 offset:29184
    ds_read_b64_tr_b16 a[152:153], v127 offset:32768
    ds_read_b64_tr_b16 a[154:155], v127 offset:33280
    ds_read_b64_tr_b16 a[156:157], v127 offset:36864
    ds_read_b64_tr_b16 a[158:159], v127 offset:37376
    s_waitcnt lgkmcnt(0)
    s_waitcnt vmcnt(10)
    s_barrier
    ds_read_b64_tr_b16 a[40:41], v125 offset:0
    ds_read_b64_tr_b16 a[42:43], v125 offset:512
    ds_read_b64_tr_b16 a[44:45], v125 offset:4096
    ds_read_b64_tr_b16 a[46:47], v125 offset:4608
    ds_read_b64_tr_b16 a[48:49], v125 offset:8192
    ds_read_b64_tr_b16 a[50:51], v125 offset:8704
    ds_read_b64_tr_b16 a[52:53], v125 offset:12288
    ds_read_b64_tr_b16 a[54:55], v125 offset:12800
    ds_read_b64_tr_b16 a[56:57], v125 offset:16384
    ds_read_b64_tr_b16 a[58:59], v125 offset:16896
    ds_read_b64_tr_b16 a[60:61], v125 offset:20480
    ds_read_b64_tr_b16 a[62:63], v125 offset:20992
    ds_read_b64_tr_b16 a[64:65], v125 offset:24576
    ds_read_b64_tr_b16 a[66:67], v125 offset:25088
    ds_read_b64_tr_b16 a[68:69], v125 offset:28672
    ds_read_b64_tr_b16 a[70:71], v125 offset:29184
    ds_read_b64_tr_b16 a[72:73], v125 offset:32768
    ds_read_b64_tr_b16 a[74:75], v125 offset:33280
    ds_read_b64_tr_b16 a[76:77], v125 offset:36864
    ds_read_b64_tr_b16 a[78:79], v125 offset:37376
    s_waitcnt lgkmcnt(0)
    s_mov_b32 s49, 40960
    s_mov_b32 s47, 40960
    s_mov_b32 s37, -1
    s_add_u32 s44, s38, 475136
    s_add_u32 s45, s44, s56
    s_mov_b32 s46, 40960
    v_add_u32 v140, 0, v137
    v_mov_b32 v1, 192
    buffer_load_dword v2, v1, s[8:11], 0 offen sc1
    ds_read_b128 v[84:87], v11 offset:0
    ds_read_b128 v[88:91], v11 offset:2048
    ds_read_b128 v[92:95], v12 offset:0
    ds_read_b128 v[96:99], v12 offset:2048
    s_waitcnt lgkmcnt(2)
    v_mfma_f32_16x16x32_bf16 v[108:111], a[0:3], v[84:87], 0
    ds_read_b128 v[100:103], v11 offset:4096
    v_mfma_f32_16x16x32_bf16 v[112:115], a[0:3], v[88:91], 0
    ds_read_b128 v[104:107], v11 offset:6144
    v_mfma_f32_16x16x32_bf16 v[116:119], a[80:83], v[84:87], 0
    v_mfma_f32_16x16x32_bf16 v[120:123], a[80:83], v[88:91], 0
    s_waitcnt lgkmcnt(2)
    v_mfma_f32_16x16x32_bf16 v[108:111], a[4:7], v[92:95], v[108:111]
    ds_read_b128 v[84:87], v12 offset:4096
    v_mfma_f32_16x16x32_bf16 v[112:115], a[4:7], v[96:99], v[112:115]
    ds_read_b128 v[88:91], v12 offset:6144
    v_mfma_f32_16x16x32_bf16 v[116:119], a[84:87], v[92:95], v[116:119]
    v_mfma_f32_16x16x32_bf16 v[120:123], a[84:87], v[96:99], v[120:123]
    s_waitcnt lgkmcnt(2)
    v_mfma_f32_16x16x32_bf16 v[108:111], a[8:11], v[100:103], v[108:111]
    ds_read_b128 v[92:95], v11 offset:8192
    v_mfma_f32_16x16x32_bf16 v[112:115], a[8:11], v[104:107], v[112:115]
    ds_read_b128 v[96:99], v11 offset:10240
    v_mfma_f32_16x16x32_bf16 v[116:119], a[88:91], v[100:103], v[116:119]
    v_mfma_f32_16x16x32_bf16 v[120:123], a[88:91], v[104:107], v[120:123]
    s_waitcnt lgkmcnt(2)
    v_mfma_f32_16x16x32_bf16 v[108:111], a[12:15], v[84:87], v[108:111]
    ds_read_b128 v[100:103], v12 offset:8192
    v_mfma_f32_16x16x32_bf16 v[112:115], a[12:15], v[88:91], v[112:115]
    ds_read_b128 v[104:107], v12 offset:10240
    v_mfma_f32_16x16x32_bf16 v[116:119], a[92:95], v[84:87], v[116:119]
    v_mfma_f32_16x16x32_bf16 v[120:123], a[92:95], v[88:91], v[120:123]
    s_waitcnt lgkmcnt(2)
    v_mfma_f32_16x16x32_bf16 v[108:111], a[16:19], v[92:95], v[108:111]
    ds_read_b128 v[84:87], v11 offset:12288
    v_mfma_f32_16x16x32_bf16 v[112:115], a[16:19], v[96:99], v[112:115]
    ds_read_b128 v[88:91], v11 offset:14336
    v_mfma_f32_16x16x32_bf16 v[116:119], a[96:99], v[92:95], v[116:119]
    v_mfma_f32_16x16x32_bf16 v[120:123], a[96:99], v[96:99], v[120:123]
    s_waitcnt lgkmcnt(2)
    v_mfma_f32_16x16x32_bf16 v[108:111], a[20:23], v[100:103], v[108:111]
    ds_read_b128 v[92:95], v12 offset:12288
    v_mfma_f32_16x16x32_bf16 v[112:115], a[20:23], v[104:107], v[112:115]
    ds_read_b128 v[96:99], v12 offset:14336
    v_mfma_f32_16x16x32_bf16 v[116:119], a[100:103], v[100:103], v[116:119]
    v_mfma_f32_16x16x32_bf16 v[120:123], a[100:103], v[104:107], v[120:123]
    s_waitcnt lgkmcnt(2)
    v_mfma_f32_16x16x32_bf16 v[108:111], a[24:27], v[84:87], v[108:111]
    ds_read_b128 v[100:103], v11 offset:16384
    v_mfma_f32_16x16x32_bf16 v[112:115], a[24:27], v[88:91], v[112:115]
    ds_read_b128 v[104:107], v11 offset:18432
    v_mfma_f32_16x16x32_bf16 v[116:119], a[104:107], v[84:87], v[116:119]
    v_mfma_f32_16x16x32_bf16 v[120:123], a[104:107], v[88:91], v[120:123]
    s_waitcnt lgkmcnt(2)
    v_mfma_f32_16x16x32_bf16 v[108:111], a[28:31], v[92:95], v[108:111]
    ds_read_b128 v[84:87], v12 offset:16384
    v_mfma_f32_16x16x32_bf16 v[112:115], a[28:31], v[96:99], v[112:115]
    ds_read_b128 v[88:91], v12 offset:18432
    v_mfma_f32_16x16x32_bf16 v[116:119], a[108:111], v[92:95], v[116:119]
    v_mfma_f32_16x16x32_bf16 v[120:123], a[108:111], v[96:99], v[120:123]
    s_waitcnt lgkmcnt(2)
    v_mfma_f32_16x16x32_bf16 v[108:111], a[32:35], v[100:103], v[108:111]
    ds_read_b128 v[92:95], v11 offset:20480
    v_mfma_f32_16x16x32_bf16 v[112:115], a[32:35], v[104:107], v[112:115]
    ds_read_b128 v[96:99], v11 offset:22528
    v_mfma_f32_16x16x32_bf16 v[116:119], a[112:115], v[100:103], v[116:119]
    v_mfma_f32_16x16x32_bf16 v[120:123], a[112:115], v[104:107], v[120:123]
    s_waitcnt lgkmcnt(2)
    v_mfma_f32_16x16x32_bf16 v[108:111], a[36:39], v[84:87], v[108:111]
    ds_read_b128 v[100:103], v12 offset:20480
    v_mfma_f32_16x16x32_bf16 v[112:115], a[36:39], v[88:91], v[112:115]
    ds_read_b128 v[104:107], v12 offset:22528
    v_mfma_f32_16x16x32_bf16 v[116:119], a[116:119], v[84:87], v[116:119]
    v_mfma_f32_16x16x32_bf16 v[120:123], a[116:119], v[88:91], v[120:123]
    s_waitcnt lgkmcnt(2)
    v_mfma_f32_16x16x32_bf16 v[108:111], a[40:43], v[92:95], v[108:111]
    ds_read_b128 v[84:87], v11 offset:24576
    v_mfma_f32_16x16x32_bf16 v[112:115], a[40:43], v[96:99], v[112:115]
    ds_read_b128 v[88:91], v11 offset:26624
    v_mfma_f32_16x16x32_bf16 v[116:119], a[120:123], v[92:95], v[116:119]
    v_mfma_f32_16x16x32_bf16 v[120:123], a[120:123], v[96:99], v[120:123]
    s_waitcnt lgkmcnt(2)
    v_mfma_f32_16x16x32_bf16 v[108:111], a[44:47], v[100:103], v[108:111]
    ds_read_b128 v[92:95], v12 offset:24576
    v_mfma_f32_16x16x32_bf16 v[112:115], a[44:47], v[104:107], v[112:115]
    ds_read_b128 v[96:99], v12 offset:26624
    v_mfma_f32_16x16x32_bf16 v[116:119], a[124:127], v[100:103], v[116:119]
    v_mfma_f32_16x16x32_bf16 v[120:123], a[124:127], v[104:107], v[120:123]
    s_waitcnt lgkmcnt(2)
    v_mfma_f32_16x16x32_bf16 v[108:111], a[48:51], v[84:87], v[108:111]
    ds_read_b128 v[100:103], v11 offset:28672
    v_mfma_f32_16x16x32_bf16 v[112:115], a[48:51], v[88:91], v[112:115]
    ds_read_b128 v[104:107], v11 offset:30720
    v_mfma_f32_16x16x32_bf16 v[116:119], a[128:131], v[84:87], v[116:119]
    v_mfma_f32_16x16x32_bf16 v[120:123], a[128:131], v[88:91], v[120:123]
    s_waitcnt lgkmcnt(2)
    v_mfma_f32_16x16x32_bf16 v[108:111], a[52:55], v[92:95], v[108:111]
    ds_read_b128 v[84:87], v12 offset:28672
    v_mfma_f32_16x16x32_bf16 v[112:115], a[52:55], v[96:99], v[112:115]
    ds_read_b128 v[88:91], v12 offset:30720
    v_mfma_f32_16x16x32_bf16 v[116:119], a[132:135], v[92:95], v[116:119]
    v_mfma_f32_16x16x32_bf16 v[120:123], a[132:135], v[96:99], v[120:123]
    s_waitcnt lgkmcnt(2)
    v_mfma_f32_16x16x32_bf16 v[108:111], a[56:59], v[100:103], v[108:111]
    ds_read_b128 v[92:95], v11 offset:32768
    v_mfma_f32_16x16x32_bf16 v[112:115], a[56:59], v[104:107], v[112:115]
    ds_read_b128 v[96:99], v11 offset:34816
    v_mfma_f32_16x16x32_bf16 v[116:119], a[136:139], v[100:103], v[116:119]
    v_mfma_f32_16x16x32_bf16 v[120:123], a[136:139], v[104:107], v[120:123]
    s_waitcnt lgkmcnt(2)
    v_mfma_f32_16x16x32_bf16 v[108:111], a[60:63], v[84:87], v[108:111]
    ds_read_b128 v[100:103], v12 offset:32768
    v_mfma_f32_16x16x32_bf16 v[112:115], a[60:63], v[88:91], v[112:115]
    ds_read_b128 v[104:107], v12 offset:34816
    v_mfma_f32_16x16x32_bf16 v[116:119], a[140:143], v[84:87], v[116:119]
    v_mfma_f32_16x16x32_bf16 v[120:123], a[140:143], v[88:91], v[120:123]
    s_waitcnt lgkmcnt(2)
    v_mfma_f32_16x16x32_bf16 v[108:111], a[64:67], v[92:95], v[108:111]
    ds_read_b128 v[84:87], v11 offset:36864
    v_mfma_f32_16x16x32_bf16 v[112:115], a[64:67], v[96:99], v[112:115]
    ds_read_b128 v[88:91], v11 offset:38912
    v_mfma_f32_16x16x32_bf16 v[116:119], a[144:147], v[92:95], v[116:119]
    v_mfma_f32_16x16x32_bf16 v[120:123], a[144:147], v[96:99], v[120:123]
    s_waitcnt lgkmcnt(2)
    v_mfma_f32_16x16x32_bf16 v[108:111], a[68:71], v[100:103], v[108:111]
    ds_read_b128 v[92:95], v12 offset:36864
    v_mfma_f32_16x16x32_bf16 v[112:115], a[68:71], v[104:107], v[112:115]
    ds_read_b128 v[96:99], v12 offset:38912
    v_mfma_f32_16x16x32_bf16 v[116:119], a[148:151], v[100:103], v[116:119]
    v_mfma_f32_16x16x32_bf16 v[120:123], a[148:151], v[104:107], v[120:123]
    s_waitcnt lgkmcnt(0)
    v_mfma_f32_16x16x32_bf16 v[108:111], a[72:75], v[84:87], v[108:111]
    v_add_u32 v11, s49, v11
    v_mfma_f32_16x16x32_bf16 v[112:115], a[72:75], v[88:91], v[112:115]
    v_add_u32 v12, s49, v12
    v_mfma_f32_16x16x32_bf16 v[108:111], a[76:79], v[92:95], v[108:111]
    s_sub_u32 s47, s47, s49
    v_mfma_f32_16x16x32_bf16 v[112:115], a[76:79], v[96:99], v[112:115]
    s_sub_u32 s49, 0, s49
    v_mfma_f32_16x16x32_bf16 v[116:119], a[152:155], v[84:87], v[116:119]
    v_mfma_f32_16x16x32_bf16 v[120:123], a[152:155], v[88:91], v[120:123]
    v_mfma_f32_16x16x32_bf16 v[116:119], a[156:159], v[92:95], v[116:119]
    v_mfma_f32_16x16x32_bf16 v[120:123], a[156:159], v[96:99], v[120:123]
    v_cvt_pk_bf16_f32 v124, v108, v109
    v_cvt_pk_bf16_f32 v125, v110, v111
    v_cvt_pk_bf16_f32 v126, v112, v113
    v_cvt_pk_bf16_f32 v127, v114, v115
    s_nop 0
    v_permlane16_swap_b32 v124, v126
    v_permlane16_swap_b32 v125, v127
    v_cvt_pk_bf16_f32 v128, v116, v117
    v_cvt_pk_bf16_f32 v129, v118, v119
    v_cvt_pk_bf16_f32 v130, v120, v121
    v_cvt_pk_bf16_f32 v131, v122, v123
    s_nop 0
    v_permlane16_swap_b32 v128, v130
    v_permlane16_swap_b32 v129, v131
    ds_write_b128 v140, v[128:131]
    buffer_store_dwordx4 v[124:127], v19, s[4:7], s44 offen
    buffer_store_dwordx4 v[128:131], v19, s[4:7], s45 offen
    s_waitcnt vmcnt(2)
    s_branch L_gw_3c
L_gw_3:
    buffer_load_dword v2, v1, s[8:11], 0 offen sc1
    s_sub_u32 s36, s36, 1
    s_cbranch_scc1 L_exit
    s_waitcnt vmcnt(0)
L_gw_3c:
    v_readfirstlane_b32 s90, v2
    s_nop 0
    s_cmp_eq_u32 s90, 0
    s_cbranch_scc1 L_gw_3
    s_cmp_lg_u32 s90, 1
    s_cbranch_scc1 L_slow
    s_waitcnt vmcnt(2) lgkmcnt(0)
    s_barrier
    s_add_u32 s44, s38, 573440
    s_add_u32 s45, s44, s56
    s_mov_b32 s46, 81920
    v_add_u32 v140, 4096, v137
    ds_read_b128 v[84:87], v11 offset:0
    ds_read_b128 v[88:91], v11 offset:2048
    ds_read_b128 v[92:95], v12 offset:0
    ds_read_b128 v[96:99], v12 offset:2048
    s_lshl_b32 s90, s32, 10
    s_add_u32 m0, s90, s47
    s_waitcnt lgkmcnt(2)
    v_mfma_f32_16x16x32_bf16 v[108:111], a[0:3], v[84:87], 0
    ds_read_b128 v[100:103], v11 offset:4096
    s_and_b32 s50, s37, 3
    v_mfma_f32_16x16x32_bf16 v[112:115], a[0:3], v[88:91], 0
    ds_read_b128 v[104:107], v11 offset:6144
    s_mul_i32 s53, s50, 327680
    v_mfma_f32_16x16x32_bf16 v[116:119], a[80:83], v[84:87], 0
    buffer_load_dwordx4 v10, s[24:27], s46 offen offset:0 nt lds
    s_add_u32 m0, m0, 3968
    v_mfma_f32_16x16x32_bf16 v[120:123], a[80:83], v[88:91], 0
    s_waitcnt lgkmcnt(2)
    s_add_u32 s51, s37, 2
    v_mfma_f32_16x16x32_bf16 v[108:111], a[4:7], v[92:95], v[108:111]
    ds_read_b128 v[84:87], v12 offset:4096
    s_and_b32 s50, s51, 3
    v_mfma_f32_16x16x32_bf16 v[112:115], a[4:7], v[96:99], v[112:115]
    ds_read_b128 v[88:91], v12 offset:6144
    s_mul_i32 s50, s50, 98304
    v_mfma_f32_16x16x32_bf16 v[116:119], a[84:87], v[92:95], v[116:119]
    buffer_load_dwordx4 v10, s[24:27], s46 offen offset:128 nt lds
    s_add_u32 m0, m0, 3968
    v_mfma_f32_16x16x32_bf16 v[120:123], a[84:87], v[96:99], v[120:123]
    s_waitcnt lgkmcnt(2)
    s_add_u32 s50, s50, 475136
    v_mfma_f32_16x16x32_bf16 v[108:111], a[8:11], v[100:103], v[108:111]
    ds_read_b128 v[92:95], v11 offset:8192
    s_add_u32 s44, s38, s50
    v_mfma_f32_16x16x32_bf16 v[112:115], a[8:11], v[104:107], v[112:115]
    ds_read_b128 v[96:99], v11 offset:10240
    s_add_u32 s45, s44, s56
    v_mfma_f32_16x16x32_bf16 v[116:119], a[88:91], v[100:103], v[116:119]
    buffer_load_dwordx4 v10, s[24:27], s46 offen offset:256 nt lds
    s_add_u32 m0, m0, 3968
    v_mfma_f32_16x16x32_bf16 v[120:123], a[88:91], v[104:107], v[120:123]
    s_waitcnt lgkmcnt(2)
    s_and_b32 s50, s51, 3
    v_mfma_f32_16x16x32_bf16 v[108:111], a[12:15], v[84:87], v[108:111]
    ds_read_b128 v[100:103], v12 offset:8192
    s_lshl_b32 s50, s50, 12
    v_mfma_f32_16x16x32_bf16 v[112:115], a[12:15], v[88:91], v[112:115]
    ds_read_b128 v[104:107], v12 offset:10240
    v_add_u32 v140, s50, v137
    v_mfma_f32_16x16x32_bf16 v[116:119], a[92:95], v[84:87], v[116:119]
    buffer_load_dwordx4 v10, s[24:27], s46 offen offset:384 nt lds
    s_add_u32 m0, m0, 3968
    v_mfma_f32_16x16x32_bf16 v[120:123], a[92:95], v[88:91], v[120:123]
    s_waitcnt lgkmcnt(2)
    s_add_u32 s37, s37, 1
    v_mfma_f32_16x16x32_bf16 v[108:111], a[16:19], v[92:95], v[108:111]
    ds_read_b128 v[84:87], v11 offset:12288
    s_mov_b32 s52, 0
    v_mfma_f32_16x16x32_bf16 v[112:115], a[16:19], v[96:99], v[112:115]
    ds_read_b128 v[88:91], v11 offset:14336
    s_and_b32 s50, s37, 3
    v_mfma_f32_16x16x32_bf16 v[116:119], a[96:99], v[92:95], v[116:119]
    buffer_load_dwordx4 v10, s[24:27], s46 offen offset:512 nt lds
    s_add_u32 m0, m0, 3968
    v_mfma_f32_16x16x32_bf16 v[120:123], a[96:99], v[96:99], v[120:123]
    s_waitcnt lgkmcnt(2)
    s_mul_i32 s51, s50, 114688
    v_mfma_f32_16x16x32_bf16 v[108:111], a[20:23], v[100:103], v[108:111]
    ds_read_b128 v[92:95], v12 offset:12288
    s_add_u32 s41, s38, s51
    v_mfma_f32_16x16x32_bf16 v[112:115], a[20:23], v[104:107], v[112:115]
    ds_read_b128 v[96:99], v12 offset:14336
    s_and_b32 s54, s37, s55
    v_mfma_f32_16x16x32_bf16 v[116:119], a[100:103], v[100:103], v[116:119]
    buffer_load_dwordx4 v10, s[24:27], s46 offen offset:640 nt lds
    s_add_u32 m0, m0, 3968
    v_mfma_f32_16x16x32_bf16 v[120:123], a[100:103], v[104:107], v[120:123]
    s_waitcnt lgkmcnt(2)
    s_lshl_b32 s50, s50, 12
    v_mfma_f32_16x16x32_bf16 v[108:111], a[24:27], v[84:87], v[108:111]
    ds_read_b128 v[100:103], v11 offset:16384
    v_add_u32 v141, s50, v138
    v_mfma_f32_16x16x32_bf16 v[112:115], a[24:27], v[88:91], v[112:115]
    ds_read_b128 v[104:107], v11 offset:18432
    s_add_u32 s43, s41, 40960
    v_mfma_f32_16x16x32_bf16 v[116:119], a[104:107], v[84:87], v[116:119]
    buffer_load_dwordx4 v10, s[24:27], s46 offen offset:768 nt lds
    s_add_u32 m0, m0, 3968
    v_mfma_f32_16x16x32_bf16 v[120:123], a[104:107], v[88:91], v[120:123]
    s_waitcnt lgkmcnt(2)
    v_mfma_f32_16x16x32_bf16 v[108:111], a[28:31], v[92:95], v[108:111]
    ds_read_b128 v[84:87], v12 offset:16384
    v_mfma_f32_16x16x32_bf16 v[112:115], a[28:31], v[96:99], v[112:115]
    ds_read_b128 v[88:91], v12 offset:18432
    v_mfma_f32_16x16x32_bf16 v[116:119], a[108:111], v[92:95], v[116:119]
    buffer_load_dwordx4 v10, s[24:27], s46 offen offset:896 nt lds
    s_add_u32 m0, m0, 3968
    v_mfma_f32_16x16x32_bf16 v[120:123], a[108:111], v[96:99], v[120:123]
    s_waitcnt lgkmcnt(2)
    v_mfma_f32_16x16x32_bf16 v[108:111], a[32:35], v[100:103], v[108:111]
    ds_read_b128 v[92:95], v11 offset:20480
    v_mfma_f32_16x16x32_bf16 v[112:115], a[32:35], v[104:107], v[112:115]
    ds_read_b128 v[96:99], v11 offset:22528
    v_mfma_f32_16x16x32_bf16 v[116:119], a[112:115], v[100:103], v[116:119]
    buffer_load_dwordx4 v10, s[24:27], s46 offen offset:1024 nt lds
    s_add_u32 m0, m0, 3968
    v_mfma_f32_16x16x32_bf16 v[120:123], a[112:115], v[104:107], v[120:123]
    s_waitcnt lgkmcnt(2)
    v_mfma_f32_16x16x32_bf16 v[108:111], a[36:39], v[84:87], v[108:111]
    ds_read_b128 v[100:103], v12 offset:20480
    v_mfma_f32_16x16x32_bf16 v[112:115], a[36:39], v[88:91], v[112:115]
    ds_read_b128 v[104:107], v12 offset:22528
    v_mfma_f32_16x16x32_bf16 v[116:119], a[116:119], v[84:87], v[116:119]
    buffer_load_dwordx4 v10, s[24:27], s46 offen offset:1152 nt lds
    v_mfma_f32_16x16x32_bf16 v[120:123], a[116:119], v[88:91], v[120:123]
    s_waitcnt lgkmcnt(2)
    v_mfma_f32_16x16x32_bf16 v[108:111], a[40:43], v[92:95], v[108:111]
    ds_read_b128 v[84:87], v11 offset:24576
    v_mfma_f32_16x16x32_bf16 v[112:115], a[40:43], v[96:99], v[112:115]
    ds_read_b128 v[88:91], v11 offset:26624
    v_mfma_f32_16x16x32_bf16 v[116:119], a[120:123], v[92:95], v[116:119]
    v_mfma_f32_16x16x32_bf16 v[120:123], a[120:123], v[96:99], v[120:123]
    s_waitcnt lgkmcnt(2)
    v_mfma_f32_16x16x32_bf16 v[108:111], a[44:47], v[100:103], v[108:111]
    ds_read_b128 v[92:95], v12 offset:24576
    v_mfma_f32_16x16x32_bf16 v[112:115], a[44:47], v[104:107], v[112:115]
    ds_read_b128 v[96:99], v12 offset:26624
    v_mfma_f32_16x16x32_bf16 v[116:119], a[124:127], v[100:103], v[116:119]
    v_mfma_f32_16x16x32_bf16 v[120:123], a[124:127], v[104:107], v[120:123]
    s_waitcnt lgkmcnt(2)
    v_mfma_f32_16x16x32_bf16 v[108:111], a[48:51], v[84:87], v[108:111]
    ds_read_b128 v[100:103], v11 offset:28672
    v_mfma_f32_16x16x32_bf16 v[112:115], a[48:51], v[88:91], v[112:115]
    ds_read_b128 v[104:107], v11 offset:30720
    v_mfma_f32_16x16x32_bf16 v[116:119], a[128:131], v[84:87], v[116:119]
    v_mfma_f32_16x16x32_bf16 v[120:123], a[128:131], v[88:91], v[120:123]
    s_waitcnt lgkmcnt(2)
    v_mfma_f32_16x16x32_bf16 v[108:111], a[52:55], v[92:95], v[108:111]
    ds_read_b128 v[84:87], v12 offset:28672
    v_mfma_f32_16x16x32_bf16 v[112:115], a[52:55], v[96:99], v[112:115]
    ds_read_b128 v[88:91], v12 offset:30720
    v_mfma_f32_16x16x32_bf16 v[116:119], a[132:135], v[92:95], v[116:119]
    v_mfma_f32_16x16x32_bf16 v[120:123], a[132:135], v[96:99], v[120:123]
    s_waitcnt lgkmcnt(2)
    v_mfma_f32_16x16x32_bf16 v[108:111], a[56:59], v[100:103], v[108:111]
    ds_read_b128 v[92:95], v11 offset:32768
    v_mfma_f32_16x16x32_bf16 v[112:115], a[56:59], v[104:107], v[112:115]
    ds_read_b128 v[96:99], v11 offset:34816
    v_mfma_f32_16x16x32_bf16 v[116:119], a[136:139], v[100:103], v[116:119]
    v_mfma_f32_16x16x32_bf16 v[120:123], a[136:139], v[104:107], v[120:123]
    s_waitcnt lgkmcnt(2)
    v_mfma_f32_16x16x32_bf16 v[108:111], a[60:63], v[84:87], v[108:111]
    ds_read_b128 v[100:103], v12 offset:32768
    v_mfma_f32_16x16x32_bf16 v[112:115], a[60:63], v[88:91], v[112:115]
    ds_read_b128 v[104:107], v12 offset:34816
    v_mfma_f32_16x16x32_bf16 v[116:119], a[140:143], v[84:87], v[116:119]
    v_mfma_f32_16x16x32_bf16 v[120:123], a[140:143], v[88:91], v[120:123]
    s_waitcnt lgkmcnt(2)
    v_mfma_f32_16x16x32_bf16 v[108:111], a[64:67], v[92:95], v[108:111]
    ds_read_b128 v[84:87], v11 offset:36864
    v_mfma_f32_16x16x32_bf16 v[112:115], a[64:67], v[96:99], v[112:115]
    ds_read_b128 v[88:91], v11 offset:38912
    v_mfma_f32_16x16x32_bf16 v[116:119], a[144:147], v[92:95], v[116:119]
    v_mfma_f32_16x16x32_bf16 v[120:123], a[144:147], v[96:99], v[120:123]
    s_waitcnt lgkmcnt(2)
    v_mfma_f32_16x16x32_bf16 v[108:111], a[68:71], v[100:103], v[108:111]
    ds_read_b128 v[92:95], v12 offset:36864
    v_mfma_f32_16x16x32_bf16 v[112:115], a[68:71], v[104:107], v[112:115]
    ds_read_b128 v[96:99], v12 offset:38912
    v_mfma_f32_16x16x32_bf16 v[116:119], a[148:151], v[100:103], v[116:119]
    v_mfma_f32_16x16x32_bf16 v[120:123], a[148:151], v[104:107], v[120:123]
    s_waitcnt lgkmcnt(0)
    v_mfma_f32_16x16x32_bf16 v[108:111], a[72:75], v[84:87], v[108:111]
    v_add_u32 v11, s49, v11
    v_mfma_f32_16x16x32_bf16 v[112:115], a[72:75], v[88:91], v[112:115]
    v_add_u32 v12, s49, v12
    v_mfma_f32_16x16x32_bf16 v[108:111], a[76:79], v[92:95], v[108:111]
    s_sub_u32 s47, s47, s49
    v_mfma_f32_16x16x32_bf16 v[112:115], a[76:79], v[96:99], v[112:115]
    s_sub_u32 s49, 0, s49
    v_mfma_f32_16x16x32_bf16 v[116:119], a[152:155], v[84:87], v[116:119]
    v_mfma_f32_16x16x32_bf16 v[120:123], a[152:155], v[88:91], v[120:123]
    v_mfma_f32_16x16x32_bf16 v[116:119], a[156:159], v[92:95], v[116:119]
    v_mfma_f32_16x16x32_bf16 v[120:123], a[156:159], v[96:99], v[120:123]
    v_cvt_pk_bf16_f32 v124, v108, v109
    v_cvt_pk_bf16_f32 v125, v110, v111
    v_cvt_pk_bf16_f32 v126, v112, v113
    v_cvt_pk_bf16_f32 v127, v114, v115
    s_nop 0
    v_permlane16_swap_b32 v124, v126
    v_permlane16_swap_b32 v125, v127
    v_cvt_pk_bf16_f32 v128, v116, v117
    v_cvt_pk_bf16_f32 v129, v118, v119
    v_cvt_pk_bf16_f32 v130, v120, v121
    v_cvt_pk_bf16_f32 v131, v122, v123
    s_nop 0
    v_permlane16_swap_b32 v128, v130
    v_permlane16_swap_b32 v129, v131
    ds_write_b128 v140, v[128:131]
    buffer_store_dwordx4 v[124:127], v19, s[4:7], s44 offen
    buffer_store_dwordx4 v[128:131], v19, s[4:7], s45 offen
    s_mov_b32 m0, s48
L_qkv_loop_f:
    s_add_u32 s50, s37, 2
    s_and_b32 s50, s50, 3
    s_mul_i32 s50, s50, 114688
    s_add_u32 s42, s38, s50
    s_add_u32 s50, s37, 3
    s_min_u32 s50, s50, 63
    s_mul_i32 s46, s50, 40960
    s_add_u32 s51, s37, 1
    v_mov_b32 v20, s51
    s_mov_b32 m0, s48
    v_mov_b32 v68, 0
    v_mov_b32 v69, 0
    v_mov_b32 v70, 0
    v_mov_b32 v71, 0
    v_mov_b32 v72, 0
    v_mov_b32 v73, 0
    v_mov_b32 v74, 0
    v_mov_b32 v75, 0
    ds_read_b128 v[156:159], v141
    ds_read_b128 v[160:163], v141 offset:1024
    buffer_load_dwordx4 v13, s[4:7], s41 offen sc1 lds
    buffer_load_dwordx4 v13, s[4:7], s41 offen offset:1024 sc1 lds
    buffer_load_dword v14, s[4:7], s41 offen offset:2048 sc1 lds
    buffer_load_dword v14, s[4:7], s41 offen offset:2304 sc1 lds
    s_waitcnt vmcnt(0)
    ds_read_b32 v18, v15
    s_waitcnt lgkmcnt(0)
    v_cmp_eq_u32 vcc, -1, v18
    s_cbranch_vccnz L_poll_5c
L_poll_5x:
    s_barrier
    ds_read_b128 v[28:31], v16 offset:0
    ds_read_b128 v[32:35], v16 offset:1024
    ds_read_b128 v[36:39], v16 offset:2048
    ds_read_b128 v[40:43], v16 offset:3072
    s_waitcnt lgkmcnt(3)
    v_smfmac_f32_16x16x64_bf16 v[68:71], v[28:31], a[0:7], v17
    ds_read_b128 v[44:47], v16 offset:4096
    v_smfmac_f32_16x16x64_bf16 v[72:75], v[28:31], a[80:87], v17
    ds_read_b128 v[48:51], v16 offset:5120
    s_waitcnt lgkmcnt(4)
    v_smfmac_f32_16x16x64_bf16 v[68:71], v[32:35], a[8:15], v17
    ds_read_b128 v[52:55], v16 offset:6144
    v_smfmac_f32_16x16x64_bf16 v[72:75], v[32:35], a[88:95], v17
    ds_read_b128 v[56:59], v16 offset:7168
    s_waitcnt lgkmcnt(5)
    v_smfmac_f32_16x16x64_bf16 v[68:71], v[36:39], a[16:23], v17
    ds_read_b128 v[60:63], v16 offset:8192
    s_waitcnt lgkmcnt(5)
    v_smfmac_f32_16x16x64_bf16 v[68:71], v[40:43], a[24:31], v17
    ds_read_b128 v[64:67], v16 offset:9216
    s_waitcnt lgkmcnt(5)
    v_smfmac_f32_16x16x64_bf16 v[68:71], v[44:47], a[32:39], v17
    s_waitcnt lgkmcnt(4)
    v_smfmac_f32_16x16x64_bf16 v[68:71], v[48:51], a[40:47], v17
    s_waitcnt lgkmcnt(3)
    v_smfmac_f32_16x16x64_bf16 v[68:71], v[52:55], a[48:55], v17
    s_waitcnt lgkmcnt(2)
    v_smfmac_f32_16x16x64_bf16 v[68:71], v[56:59], a[56:63], v17
    s_waitcnt lgkmcnt(1)
    v_smfmac_f32_16x16x64_bf16 v[68:71], v[60:63], a[64:71], v17
    s_waitcnt lgkmcnt(0)
    v_smfmac_f32_16x16x64_bf16 v[68:71], v[64:67], a[72:79], v17
L_redo_4:
    v_smfmac_f32_16x16x64_bf16 v[72:75], v[36:39], a[96:103], v17
    v_smfmac_f32_16x16x64_bf16 v[72:75], v[40:43], a[104:111], v17
    buffer_store_dword v20, v21, s[4:7], s38 offen offset:0
    v_smfmac_f32_16x16x64_bf16 v[72:75], v[44:47], a[112:119], v17
    v_add_f32 v68, v68, v70
    v_add_f32 v69, v69, v71
    v_smfmac_f32_16x16x64_bf16 v[72:75], v[48:51], a[120:127], v17
    v_cvt_pk_bf16_f32 v132, v68, v69
    ds_write_b32 v23, v132
    v_smfmac_f32_16x16x64_bf16 v[72:75], v[52:55], a[128:135], v17
    v_cmp_u_f32 vcc, v68, v69
    v_smfmac_f32_16x16x64_bf16 v[72:75], v[56:59], a[136:143], v17
    v_smfmac_f32_16x16x64_bf16 v[72:75], v[60:63], a[144:151], v17
    s_cbranch_vccnz L_nan_6
L_cont_7:
    v_smfmac_f32_16x16x64_bf16 v[72:75], v[64:67], a[152:159], v17
    s_waitcnt lgkmcnt(0)
    s_barrier
    ds_read_b64_tr_b16 v[76:77], v24 offset:0
    ds_read_b64_tr_b16 v[78:79], v134 offset:0
    ds_read_b64_tr_b16 v[80:81], v24 offset:1024
    ds_read_b64_tr_b16 v[82:83], v134 offset:1024
    s_cmp_eq_u32 s32, 0
    s_cbranch_scc1 L_w0_8
    s_cmp_eq_u32 s32, 3
    s_cbranch_scc1 L_w3_9
    v_pk_add_f32 v[72:73], v[72:73], v[74:75]
    v_cvt_pk_bf16_f32 v133, v72, v73
    ds_write_b32 v23, v133 offset:4
    s_waitcnt lgkmcnt(3)
    v_mfma_f32_16x16x32_bf16 v[164:167], v[156:159], v[76:79], 0
    s_waitcnt lgkmcnt(1)
    v_mfma_f32_16x16x32_bf16 v[164:167], v[160:163], v[80:83], v[164:167]
    s_waitcnt lgkmcnt(0)
    s_barrier
    s_nop 5
    buffer_store_dwordx4 v[164:167], v135, s[4:7], s41 offen
    ds_read_b128 v[84:87], v11 offset:0
    ds_read_b128 v[88:91], v11 offset:2048
    ds_read_b128 v[92:95], v12 offset:0
    ds_read_b128 v[96:99], v12 offset:2048
    s_branch L_join_10
L_w0_8:
    v_pk_add_f32 v[72:73], v[72:73], v[74:75]
    v_cvt_pk_bf16_f32 v133, v72, v73
    ds_write_b32 v23, v133 offset:4
    s_waitcnt lgkmcnt(0)
    s_barrier
    ds_read_b64_tr_b16 v[76:77], v24 offset:0
    ds_read_b64_tr_b16 v[78:79], v134 offset:0
    ds_read_b64_tr_b16 v[80:81], v24 offset:1024
    ds_read_b64_tr_b16 v[82:83], v134 offset:1024
    s_waitcnt lgkmcnt(2)
    v_mfma_f32_16x16x32_bf16 v[164:167], v[76:79], v[76:79], 0
    s_waitcnt lgkmcnt(0)
    v_mfma_f32_16x16x32_bf16 v[164:167], v[80:83], v[80:83], v[164:167]
    ds_read_b128 v[84:87], v11 offset:0
    ds_read_b128 v[88:91], v11 offset:2048
    ds_read_b128 v[92:95], v12 offset:0
    ds_read_b128 v[96:99], v12 offset:2048
    s_nop 3
    buffer_store_dword v166, v135, s[4:7], s41 offen
    buffer_store_dword v167, v135, s[4:7], s41 offen offset:8
    s_branch L_join_10
L_w3_9:
    v_pk_add_f32 v[72:73], v[72:73], v[74:75]
    v_cvt_pk_bf16_f32 v133, v72, v73
    ds_write_b32 v23, v133 offset:4
    s_waitcnt lgkmcnt(0)
    s_barrier
    ds_read_b64_tr_b16 v[76:77], v24 offset:0
    ds_read_b64_tr_b16 v[78:79], v134 offset:0
    ds_read_b64_tr_b16 v[80:81], v24 offset:1024
    ds_read_b64_tr_b16 v[82:83], v134 offset:1024
    s_waitcnt lgkmcnt(0)
    ds_read_b128 v[84:87], v11 offset:0
    ds_read_b128 v[88:91], v11 offset:2048
    ds_read_b128 v[92:95], v12 offset:0
    ds_read_b128 v[96:99], v12 offset:2048
    s_waitcnt lgkmcnt(0)
    buffer_store_dwordx4 v[76:79], v136, s[4:7], s43 offen
    buffer_store_dwordx4 v[80:83], v136, s[4:7], s43 offen offset:512
L_join_10:
    s_cmp_eq_u32 s37, 63
    s_cbranch_scc1 L_end_11
    s_cmp_eq_u32 s37, 0
    s_cbranch_scc1 L_sd_12c
L_sd_12:
    s_lshl_b32 s90, s32, 10
    s_add_u32 m0, s90, s47
    s_waitcnt lgkmcnt(2)
    v_mfma_f32_16x16x32_bf16 v[108:111], a[0:3], v[84:87], 0
    ds_read_b128 v[100:103], v11 offset:4096
    s_and_b32 s50, s37, 3
    v_mfma_f32_16x16x32_bf16 v[112:115], a[0:3], v[88:91], 0
    ds_read_b128 v[104:107], v11 offset:6144
    s_mul_i32 s53, s50, 327680
    v_mfma_f32_16x16x32_bf16 v[116:119], a[80:83], v[84:87], 0
    s_add_u32 s51, s37, 2
    s_and_b32 s50, s51, 3
    v_mfma_f32_16x16x32_bf16 v[120:123], a[80:83], v[88:91], 0
    s_waitcnt lgkmcnt(2)
    s_mul_i32 s50, s50, 98304
    v_mfma_f32_16x16x32_bf16 v[108:111], a[4:7], v[92:95], v[108:111]
    ds_read_b128 v[84:87], v12 offset:4096
    s_add_u32 s50, s50, 475136
    v_mfma_f32_16x16x32_bf16 v[112:115], a[4:7], v[96:99], v[112:115]
    ds_read_b128 v[88:91], v12 offset:6144
    s_add_u32 s44, s38, s50
    v_mfma_f32_16x16x32_bf16 v[116:119], a[84:87], v[92:95], v[116:119]
    s_add_u32 s45, s44, s56
    s_and_b32 s50, s51, 3
    v_mfma_f32_16x16x32_bf16 v[120:123], a[84:87], v[96:99], v[120:123]
    s_waitcnt lgkmcnt(2)
    s_lshl_b32 s50, s50, 12
    v_mfma_f32_16x16x32_bf16 v[108:111], a[8:11], v[100:103], v[108:111]
    ds_read_b128 v[92:95], v11 offset:8192
    v_add_u32 v140, s50, v137
    v_mfma_f32_16x16x32_bf16 v[112:115], a[8:11], v[104:107], v[112:115]
    ds_read_b128 v[96:99], v11 offset:10240
    s_add_u32 s37, s37, 1
    v_mfma_f32_16x16x32_bf16 v[116:119], a[88:91], v[100:103], v[116:119]
    s_mov_b32 s52, 0
    s_and_b32 s50, s37, 3
    v_mfma_f32_16x16x32_bf16 v[120:123], a[88:91], v[104:107], v[120:123]
    s_waitcnt lgkmcnt(2)
    s_mul_i32 s51, s50, 114688
    v_mfma_f32_16x16x32_bf16 v[108:111], a[12:15], v[84:87], v[108:111]
    ds_read_b128 v[100:103], v12 offset:8192
    s_add_u32 s41, s38, s51
    v_mfma_f32_16x16x32_bf16 v[112:115], a[12:15], v[88:91], v[112:115]
    ds_read_b128 v[104:107], v12 offset:10240
    s_and_b32 s54, s37, s55
    v_mfma_f32_16x16x32_bf16 v[116:119], a[92:95], v[84:87], v[116:119]
    buffer_store_dword v22, v150, s[4:7], s42 offen offset:0
    buffer_store_dword v22, v149, s[4:7], s42 offen offset:0
    v_mfma_f32_16x16x32_bf16 v[120:123], a[92:95], v[88:91], v[120:123]
    s_waitcnt lgkmcnt(2)
    s_lshl_b32 s50, s50, 12
    v_mfma_f32_16x16x32_bf16 v[108:111], a[16:19], v[92:95], v[108:111]
    ds_read_b128 v[84:87], v11 offset:12288
    v_add_u32 v141, s50, v138
    v_mfma_f32_16x16x32_bf16 v[112:115], a[16:19], v[96:99], v[112:115]
    ds_read_b128 v[88:91], v11 offset:14336
    s_add_u32 s43, s41, 40960
    v_mfma_f32_16x16x32_bf16 v[116:119], a[96:99], v[92:95], v[116:119]
    buffer_store_dword v22, v150, s[4:7], s42 offen offset:256
    v_mfma_f32_16x16x32_bf16 v[120:123], a[96:99], v[96:99], v[120:123]
    s_waitcnt lgkmcnt(2)
    v_mfma_f32_16x16x32_bf16 v[108:111], a[20:23], v[100:103], v[108:111]
    ds_read_b128 v[92:95], v12 offset:12288
    v_mfma_f32_16x16x32_bf16 v[112:115], a[20:23], v[104:107], v[112:115]
    ds_read_b128 v[96:99], v12 offset:14336
    v_mfma_f32_16x16x32_bf16 v[116:119], a[100:103], v[100:103], v[116:119]
    buffer_load_dwordx4 v10, s[24:27], s46 offen offset:0 nt lds
    s_add_u32 m0, m0, 3968
    v_mfma_f32_16x16x32_bf16 v[120:123], a[100:103], v[104:107], v[120:123]
    s_waitcnt lgkmcnt(2)
    v_mfma_f32_16x16x32_bf16 v[108:111], a[24:27], v[84:87], v[108:111]
    ds_read_b128 v[100:103], v11 offset:16384
    v_mfma_f32_16x16x32_bf16 v[112:115], a[24:27], v[88:91], v[112:115]
    ds_read_b128 v[104:107], v11 offset:18432
    v_mfma_f32_16x16x32_bf16 v[116:119], a[104:107], v[84:87], v[116:119]
    buffer_load_dwordx4 v10, s[24:27], s46 offen offset:128 nt lds
    s_add_u32 m0, m0, 3968
    v_mfma_f32_16x16x32_bf16 v[120:123], a[104:107], v[88:91], v[120:123]
    s_waitcnt lgkmcnt(2)
    v_mfma_f32_16x16x32_bf16 v[108:111], a[28:31], v[92:95], v[108:111]
    ds_read_b128 v[84:87], v12 offset:16384
    v_mfma_f32_16x16x32_bf16 v[112:115], a[28:31], v[96:99], v[112:115]
    ds_read_b128 v[88:91], v12 offset:18432
    v_mfma_f32_16x16x32_bf16 v[116:119], a[108:111], v[92:95], v[116:119]
    buffer_load_dwordx4 v10, s[24:27], s46 offen offset:256 nt lds
    s_add_u32 m0, m0, 3968
    v_mfma_f32_16x16x32_bf16 v[120:123], a[108:111], v[96:99], v[120:123]
    s_waitcnt lgkmcnt(2)
    v_mfma_f32_16x16x32_bf16 v[108:111], a[32:35], v[100:103], v[108:111]
    ds_read_b128 v[92:95], v11 offset:20480
    v_mfma_f32_16x16x32_bf16 v[112:115], a[32:35], v[104:107], v[112:115]
    ds_read_b128 v[96:99], v11 offset:22528
    v_mfma_f32_16x16x32_bf16 v[116:119], a[112:115], v[100:103], v[116:119]
    s_waitcnt vmcnt(6)
    buffer_store_dword v20, v139, s[4:7], s38 offen
    v_mfma_f32_16x16x32_bf16 v[120:123], a[112:115], v[104:107], v[120:123]
    s_waitcnt lgkmcnt(2)
    v_mfma_f32_16x16x32_bf16 v[108:111], a[36:39], v[84:87], v[108:111]
    ds_read_b128 v[100:103], v12 offset:20480
    v_mfma_f32_16x16x32_bf16 v[112:115], a[36:39], v[88:91], v[112:115]
    buffer_load_dword v147, v146, s[4:7], 0 offen sc1
    ds_read_b128 v[104:107], v12 offset:22528
    v_mfma_f32_16x16x32_bf16 v[116:119], a[116:119], v[84:87], v[116:119]
    buffer_load_dwordx4 v10, s[24:27], s46 offen offset:384 nt lds
    s_add_u32 m0, m0, 3968
    v_mfma_f32_16x16x32_bf16 v[120:123], a[116:119], v[88:91], v[120:123]
    s_waitcnt lgkmcnt(2)
    v_mfma_f32_16x16x32_bf16 v[108:111], a[40:43], v[92:95], v[108:111]
    ds_read_b128 v[84:87], v11 offset:24576
    v_mfma_f32_16x16x32_bf16 v[112:115], a[40:43], v[96:99], v[112:115]
    buffer_load_dword v147, v146, s[4:7], 0 offen sc1
    ds_read_b128 v[88:91], v11 offset:26624
    v_mfma_f32_16x16x32_bf16 v[116:119], a[120:123], v[92:95], v[116:119]
    buffer_load_dwordx4 v10, s[24:27], s46 offen offset:512 nt lds
    s_add_u32 m0, m0, 3968
    v_mfma_f32_16x16x32_bf16 v[120:123], a[120:123], v[96:99], v[120:123]
    s_waitcnt lgkmcnt(2)
    v_mfma_f32_16x16x32_bf16 v[108:111], a[44:47], v[100:103], v[108:111]
    ds_read_b128 v[92:95], v12 offset:24576
    v_mfma_f32_16x16x32_bf16 v[112:115], a[44:47], v[104:107], v[112:115]
    buffer_load_dword v147, v146, s[4:7], 0 offen sc1
    ds_read_b128 v[96:99], v12 offset:26624
    v_mfma_f32_16x16x32_bf16 v[116:119], a[124:127], v[100:103], v[116:119]
    buffer_load_dwordx4 v10, s[24:27], s46 offen offset:640 nt lds
    s_add_u32 m0, m0, 3968
    v_mfma_f32_16x16x32_bf16 v[120:123], a[124:127], v[104:107], v[120:123]
    s_waitcnt lgkmcnt(2)
    v_mfma_f32_16x16x32_bf16 v[108:111], a[48:51], v[84:87], v[108:111]
    ds_read_b128 v[100:103], v11 offset:28672
    v_mfma_f32_16x16x32_bf16 v[112:115], a[48:51], v[88:91], v[112:115]
    buffer_load_dword v147, v146, s[4:7], 0 offen sc1
    ds_read_b128 v[104:107], v11 offset:30720
    v_mfma_f32_16x16x32_bf16 v[116:119], a[128:131], v[84:87], v[116:119]
    buffer_load_dwordx4 v10, s[24:27], s46 offen offset:768 nt lds
    s_add_u32 m0, m0, 3968
    v_mfma_f32_16x16x32_bf16 v[120:123], a[128:131], v[88:91], v[120:123]
    s_waitcnt lgkmcnt(2)
    v_mfma_f32_16x16x32_bf16 v[108:111], a[52:55], v[92:95], v[108:111]
    ds_read_b128 v[84:87], v12 offset:28672
    v_mfma_f32_16x16x32_bf16 v[112:115], a[52:55], v[96:99], v[112:115]
    buffer_load_dword v147, v146, s[4:7], 0 offen sc1
    ds_read_b128 v[88:91], v12 offset:30720
    v_mfma_f32_16x16x32_bf16 v[116:119], a[132:135], v[92:95], v[116:119]
    buffer_load_dwordx4 v10, s[24:27], s46 offen offset:896 nt lds
    s_add_u32 m0, m0, 3968
    v_mfma_f32_16x16x32_bf16 v[120:123], a[132:135], v[96:99], v[120:123]
    s_waitcnt lgkmcnt(2)
    v_mfma_f32_16x16x32_bf16 v[108:111], a[56:59], v[100:103], v[108:111]
    ds_read_b128 v[92:95], v11 offset:32768
    v_mfma_f32_16x16x32_bf16 v[112:115], a[56:59], v[104:107], v[112:115]
    buffer_load_dword v147, v146, s[4:7], 0 offen sc1
    ds_read_b128 v[96:99], v11 offset:34816
    v_mfma_f32_16x16x32_bf16 v[116:119], a[136:139], v[100:103], v[116:119]
    buffer_load_dwordx4 v10, s[24:27], s46 offen offset:1024 nt lds
    s_add_u32 m0, m0, 3968
    v_mfma_f32_16x16x32_bf16 v[120:123], a[136:139], v[104:107], v[120:123]
    s_waitcnt lgkmcnt(2)
    v_mfma_f32_16x16x32_bf16 v[108:111], a[60:63], v[84:87], v[108:111]
    ds_read_b128 v[100:103], v12 offset:32768
    v_mfma_f32_16x16x32_bf16 v[112:115], a[60:63], v[88:91], v[112:115]
    buffer_load_dword v147, v146, s[4:7], 0 offen sc1
    ds_read_b128 v[104:107], v12 offset:34816
    v_mfma_f32_16x16x32_bf16 v[116:119], a[140:143], v[84:87], v[116:119]
    buffer_load_dwordx4 v10, s[24:27], s46 offen offset:1152 nt lds
    v_mfma_f32_16x16x32_bf16 v[120:123], a[140:143], v[88:91], v[120:123]
    s_waitcnt lgkmcnt(2)
    v_mfma_f32_16x16x32_bf16 v[108:111], a[64:67], v[92:95], v[108:111]
    ds_read_b128 v[84:87], v11 offset:36864
    v_mfma_f32_16x16x32_bf16 v[112:115], a[64:67], v[96:99], v[112:115]
L_sp_13:
    buffer_load_dword v147, v146, s[4:7], 0 offen sc1
    s_sub_u32 s36, s36, 1
    s_cbranch_scc1 L_exit
    s_waitcnt vmcnt(7)
    v_cmp_gt_u32 vcc, s54, v147
    s_cbranch_vccnz L_sp_13
    s_barrier
    buffer_load_dwordx4 v[168:171], v142, s[4:7], s53 offen sc1
    ds_read_b128 v[88:91], v11 offset:38912
    v_mfma_f32_16x16x32_bf16 v[116:119], a[144:147], v[92:95], v[116:119]
    v_mfma_f32_16x16x32_bf16 v[120:123], a[144:147], v[96:99], v[120:123]
    s_waitcnt lgkmcnt(2)
    v_mfma_f32_16x16x32_bf16 v[108:111], a[68:71], v[100:103], v[108:111]
    ds_read_b128 v[92:95], v12 offset:36864
    v_mfma_f32_16x16x32_bf16 v[112:115], a[68:71], v[104:107], v[112:115]
    ds_read_b128 v[96:99], v12 offset:38912
    v_mfma_f32_16x16x32_bf16 v[116:119], a[148:151], v[100:103], v[116:119]
    v_mfma_f32_16x16x32_bf16 v[120:123], a[148:151], v[104:107], v[120:123]
    buffer_load_dwordx4 v[172:175], v143, s[4:7], s53 offen sc1
    s_waitcnt lgkmcnt(0)
    v_mfma_f32_16x16x32_bf16 v[108:111], a[72:75], v[84:87], v[108:111]
    v_add_u32 v11, s49, v11
    v_mfma_f32_16x16x32_bf16 v[112:115], a[72:75], v[88:91], v[112:115]
    v_add_u32 v12, s49, v12
    v_mfma_f32_16x16x32_bf16 v[108:111], a[76:79], v[92:95], v[108:111]
    s_sub_u32 s47, s47, s49
    v_mfma_f32_16x16x32_bf16 v[112:115], a[76:79], v[96:99], v[112:115]
    s_sub_u32 s49, 0, s49
    v_mfma_f32_16x16x32_bf16 v[116:119], a[152:155], v[84:87], v[116:119]
    v_mfma_f32_16x16x32_bf16 v[120:123], a[152:155], v[88:91], v[120:123]
    v_mfma_f32_16x16x32_bf16 v[116:119], a[156:159], v[92:95], v[116:119]
    v_mfma_f32_16x16x32_bf16 v[120:123], a[156:159], v[96:99], v[120:123]
    v_cvt_pk_bf16_f32 v124, v108, v109
    v_cvt_pk_bf16_f32 v125, v110, v111
    v_cvt_pk_bf16_f32 v126, v112, v113
    v_cvt_pk_bf16_f32 v127, v114, v115
    s_nop 0
    v_permlane16_swap_b32 v124, v126
    v_permlane16_swap_b32 v125, v127
    v_cvt_pk_bf16_f32 v128, v116, v117
    v_cvt_pk_bf16_f32 v129, v118, v119
    v_cvt_pk_bf16_f32 v130, v120, v121
    v_cvt_pk_bf16_f32 v131, v122, v123
    s_nop 0
    v_permlane16_swap_b32 v128, v130
    v_permlane16_swap_b32 v129, v131
    ds_write_b128 v140, v[128:131]
    buffer_store_dwordx4 v[124:127], v19, s[4:7], s44 offen
    buffer_store_dwordx4 v[128:131], v19, s[4:7], s45 offen
    s_mov_b32 m0, s48
    s_waitcnt vmcnt(3)
    v_mfma_f32_16x16x32_bf16 v[184:187], v[168:171], v[196:199], 0
    s_waitcnt vmcnt(2)
    v_mfma_f32_16x16x32_bf16 v[184:187], v[172:175], v[196:199], v[184:187]
    s_nop 7
    v_pk_add_f32 v[188:189], v[184:185], v[186:187]
    v_cmp_u_f32 vcc, v188, v189
    v_cvt_pk_bf16_f32 v192, v184, v185
    v_cvt_pk_bf16_f32 v193, v186, v187
    v_cndmask_b32 v192, v192, v193, s[58:59]
    s_cbranch_vccnz L_pp_14
L_pc_15:
    buffer_store_dword v192, v149, s[4:7], s41 offen
    s_barrier
    s_branch L_qkv_loop_f
L_end_11:
    s_waitcnt vmcnt(0) lgkmcnt(0)
    buffer_store_dword v20, v139, s[4:7], s38 offen
    s_endpgm
L_nan_6:
    s_cmp_eq_u32 s52, 1
    s_cbranch_scc1 L_cont_7
    v_lshlrev_b32 v1, 4, v0
L_nan_6r:
    s_mov_b32 s90, s41
    v_mov_b32 v2, 0
    buffer_load_dwordx4 v[28:31], v1, s[4:7], s90 offen sc1
    s_add_u32 s90, s90, 1024
    buffer_load_dwordx4 v[32:35], v1, s[4:7], s90 offen sc1
    s_add_u32 s90, s90, 1024
    buffer_load_dwordx4 v[36:39], v1, s[4:7], s90 offen sc1
    s_add_u32 s90, s90, 1024
    buffer_load_dwordx4 v[40:43], v1, s[4:7], s90 offen sc1
    s_add_u32 s90, s90, 1024
    buffer_load_dwordx4 v[44:47], v1, s[4:7], s90 offen sc1
    s_add_u32 s90, s90, 1024
    buffer_load_dwordx4 v[48:51], v1, s[4:7], s90 offen sc1
    s_add_u32 s90, s90, 1024
    buffer_load_dwordx4 v[52:55], v1, s[4:7], s90 offen sc1
    s_add_u32 s90, s90, 1024
    buffer_load_dwordx4 v[56:59], v1, s[4:7], s90 offen sc1
    s_add_u32 s90, s90, 1024
    buffer_load_dwordx4 v[60:63], v1, s[4:7], s90 offen sc1
    s_add_u32 s90, s90, 1024
    buffer_load_dwordx4 v[64:67], v1, s[4:7], s90 offen sc1
    s_add_u32 s90, s90, 1024
    s_sub_u32 s36, s36, 1
    s_cbranch_scc1 L_exit
    s_waitcnt vmcnt(0) lgkmcnt(0)
    v_max3_u32 v2, v2, v28, v29
    v_max3_u32 v2, v2, v30, v31
    v_max3_u32 v2, v2, v32, v33
    v_max3_u32 v2, v2, v34, v35
    v_max3_u32 v2, v2, v36, v37
    v_max3_u32 v2, v2, v38, v39
    v_max3_u32 v2, v2, v40, v41
    v_max3_u32 v2, v2, v42, v43
    v_max3_u32 v2, v2, v44, v45
    v_max3_u32 v2, v2, v46, v47
    v_max3_u32 v2, v2, v48, v49
    v_max3_u32 v2, v2, v50, v51
    v_max3_u32 v2, v2, v52, v53
    v_max3_u32 v2, v2, v54, v55
    v_max3_u32 v2, v2, v56, v57
    v_max3_u32 v2, v2, v58, v59
    v_max3_u32 v2, v2, v60, v61
    v_max3_u32 v2, v2, v62, v63
    v_max3_u32 v2, v2, v64, v65
    v_max3_u32 v2, v2, v66, v67
    v_cmp_eq_u32 vcc, -1, v2
    s_cbranch_vccnz L_nan_6r
    s_mov_b32 s52, 1
    v_mov_b32 v68, 0
    v_mov_b32 v69, 0
    v_mov_b32 v70, 0
    v_mov_b32 v71, 0
    v_mov_b32 v72, 0
    v_mov_b32 v73, 0
    v_mov_b32 v74, 0
    v_mov_b32 v75, 0
    v_smfmac_f32_16x16x64_bf16 v[68:71], v[28:31], a[0:7], v17
    s_nop 0
    v_smfmac_f32_16x16x64_bf16 v[72:75], v[28:31], a[80:87], v17
    v_smfmac_f32_16x16x64_bf16 v[68:71], v[32:35], a[8:15], v17
    v_smfmac_f32_16x16x64_bf16 v[72:75], v[32:35], a[88:95], v17
    v_smfmac_f32_16x16x64_bf16 v[68:71], v[36:39], a[16:23], v17
    v_smfmac_f32_16x16x64_bf16 v[68:71], v[40:43], a[24:31], v17
    v_smfmac_f32_16x16x64_bf16 v[68:71], v[44:47], a[32:39], v17
    v_smfmac_f32_16x16x64_bf16 v[68:71], v[48:51], a[40:47], v17
    v_smfmac_f32_16x16x64_bf16 v[68:71], v[52:55], a[48:55], v17
    v_smfmac_f32_16x16x64_bf16 v[68:71], v[56:59], a[56:63], v17
    v_smfmac_f32_16x16x64_bf16 v[68:71], v[60:63], a[64:71], v17
    v_smfmac_f32_16x16x64_bf16 v[68:71], v[64:67], a[72:79], v17
    s_nop 2
    s_branch L_redo_4
L_poll_5c:
L_poll_5:
    buffer_load_dwordx4 v13, s[4:7], s41 offen sc1 lds
    buffer_load_dwordx4 v13, s[4:7], s41 offen offset:1024 sc1 lds
    buffer_load_dword v14, s[4:7], s41 offen offset:2048 sc1 lds
    buffer_load_dword v14, s[4:7], s41 offen offset:2304 sc1 lds
    s_sub_u32 s36, s36, 1
    s_cbranch_scc1 L_exit
    s_waitcnt vmcnt(0)
    ds_read_b32 v18, v15
    s_waitcnt lgkmcnt(0)
    v_cmp_eq_u32 vcc, -1, v18
    s_cbranch_vccnz L_poll_5
    s_branch L_poll_5x
L_sd_12c:
    v_mov_b32 v5, 460288
L_pf_16:
    buffer_load_dword v6, v5, s[4:7], s38 offen sc1
    v_mov_b32 v3, 200
L_p0_17:
    buffer_load_dword v4, v3, s[8:11], 0 offen sc1
    s_sub_u32 s36, s36, 1
    s_cbranch_scc1 L_exit
    s_waitcnt vmcnt(0)
    v_readfirstlane_b32 s90, v4
    s_nop 0
    s_cmp_eq_u32 s90, 0
    s_cbranch_scc1 L_p0_17
    s_and_b32 s90, s90, 2
    s_lshl_b32 s90, s90, 12
    v_readfirstlane_b32 s91, v6
    s_nop 0
    s_cmp_eq_u32 s91, 0
    s_cbranch_scc1 L_pf_16
    s_and_b32 s91, s91, 2
    s_lshl_b32 s91, s91, 12
    v_add_u32 v142, s91, v142
    v_add_u32 v143, s91, v143
    v_and_b32 v3, s90, v152
    v_xor_b32 v146, v3, v146
    s_branch L_sd_12
L_pp_14:
    buffer_load_dwordx4 v[176:179], v142, s[4:7], s53 offen sc1
    buffer_load_dwordx4 v[180:183], v143, s[4:7], s53 offen sc1
    s_sub_u32 s36, s36, 1
    s_cbranch_scc1 L_exit
    v_max_u32 v151, v168, v169
    v_max3_u32 v151, v151, v170, v171
    v_max3_u32 v151, v151, v172, v173
    v_max3_u32 v151, v151, v174, v175
    v_cmp_eq_u32 vcc, -1, v151
    s_cbranch_vccz L_pc_15
    s_waitcnt vmcnt(1)
    v_mfma_f32_16x16x32_bf16 v[184:187], v[176:179], v[196:199], 0
    s_waitcnt vmcnt(0)
    v_mfma_f32_16x16x32_bf16 v[184:187], v[180:183], v[196:199], v[184:187]
    s_nop 7
    v_pk_add_f32 v[188:189], v[184:185], v[186:187]
    v_cmp_u_f32 vcc, v188, v189
    v_cvt_pk_bf16_f32 v192, v184, v185
    v_cvt_pk_bf16_f32 v193, v186, v187
    v_cndmask_b32 v192, v192, v193, s[58:59]
    s_cbranch_vccnz L_pp_14_1
    s_branch L_pc_15
L_pp_14_1:
    buffer_load_dwordx4 v[168:171], v142, s[4:7], s53 offen sc1
    buffer_load_dwordx4 v[172:175], v143, s[4:7], s53 offen sc1
    s_sub_u32 s36, s36, 1
    s_cbranch_scc1 L_exit
    v_max_u32 v151, v176, v177
    v_max3_u32 v151, v151, v178, v179
    v_max3_u32 v151, v151, v180, v181
    v_max3_u32 v151, v151, v182, v183
    v_cmp_eq_u32 vcc, -1, v151
    s_cbranch_vccz L_pc_15
    s_waitcnt vmcnt(1)
    v_mfma_f32_16x16x32_bf16 v[184:187], v[168:171], v[196:199], 0
    s_waitcnt vmcnt(0)
    v_mfma_f32_16x16x32_bf16 v[184:187], v[172:175], v[196:199], v[184:187]
    s_nop 7
    v_pk_add_f32 v[188:189], v[184:185], v[186:187]
    v_cmp_u_f32 vcc, v188, v189
    v_cvt_pk_bf16_f32 v192, v184, v185
    v_cvt_pk_bf16_f32 v193, v186, v187
    v_cndmask_b32 v192, v192, v193, s[58:59]
    s_cbranch_vccnz L_pp_14
    s_branch L_pc_15
L_v_f:
    s_mov_b32 s12, s78
    s_and_b32 s13, s79, 0xffff
    s_mov_b32 s14, 7864320
    s_mov_b32 s15, 0x20000
    s_sub_u32 s40, s35, 12
    s_lshl_b32 s40, s40, 1
    s_mov_b32 s24, s70
    s_and_b32 s25, s71, 0xffff
    s_mov_b32 s26, 2621440
    s_mov_b32 s27, 0x20000
    v_and_b32 v1, 15, v0
    v_lshrrev_b32 v2, 4, v0
    v_lshrrev_b32 v3, 3, v0
    v_and_b32 v4, 7, v0
    s_lshl_b32 s90, s32, 3
    v_add_u32 v5, s90, v3
    s_and_b32 s91, s32, 1
    s_lshl_b32 s91, s91, 2
    v_and_b32 v6, 2, v3
    v_or_b32 v6, s91, v6
    v_xor_b32 v6, v6, v4
    v_lshlrev_b32 v6, 4, v6
    v_mul_u32_u24 v7, 12288, v5
    s_mul_i32 s92, s34, 1536
    s_lshl_b32 s93, s40, 7
    s_add_u32 s92, s92, s93
    v_add3_u32 v124, v6, v7, s92
    v_lshrrev_b32 v6, 1, v3
    v_or_b32 v6, s91, v6
    v_xor_b32 v6, v6, v4
    v_lshlrev_b32 v6, 4, v6
    v_mul_u32_u24 v7, 1280, v5
    v_add_u32 v10, v6, v7
    s_lshl_b32 s90, s32, 10
    s_add_u32 m0, s90, 81920
    s_mov_b32 s91, 128
    buffer_load_dwordx4 v124, s[12:15], s91 offen nt lds
    s_add_u32 m0, m0, 4096
    s_add_u32 s91, s91, 393216
    buffer_load_dwordx4 v124, s[12:15], s91 offen nt lds
    s_add_u32 m0, m0, 4096
    s_add_u32 s91, s91, 393216
    buffer_load_dwordx4 v124, s[12:15], s91 offen nt lds
    s_add_u32 m0, m0, 4096
    s_add_u32 s91, s91, 393216
    buffer_load_dwordx4 v124, s[12:15], s91 offen nt lds
    s_add_u32 m0, m0, 4096
    s_add_u32 s91, s91, 393216
    buffer_load_dwordx4 v124, s[12:15], s91 offen nt lds
    s_add_u32 m0, m0, 4096
    s_add_u32 s91, s91, 393216
    buffer_load_dwordx4 v124, s[12:15], s91 offen nt lds
    s_add_u32 m0, m0, 4096
    s_add_u32 s91, s91, 393216
    buffer_load_dwordx4 v124, s[12:15], s91 offen nt lds
    s_add_u32 m0, m0, 4096
    s_add_u32 s91, s91, 393216
    buffer_load_dwordx4 v124, s[12:15], s91 offen nt lds
    s_add_u32 m0, m0, 4096
    s_add_u32 s91, s91, 393216
    buffer_load_dwordx4 v124, s[12:15], s91 offen nt lds
    s_add_u32 m0, m0, 4096
    s_add_u32 s91, s91, 393216
    buffer_load_dwordx4 v124, s[12:15], s91 offen nt lds
    s_mul_i32 s60, s40, 86
    s_lshr_b32 s60, s60, 8
    s_mul_i32 s61, s60, 3
    s_sub_u32 s61, s40, s61
    s_add_u32 s90, s40, 1
    s_mul_i32 s62, s90, 86
    s_lshr_b32 s62, s62, 8
    s_mul_i32 s63, s62, 3
    s_sub_u32 s63, s90, s63
    v_lshrrev_b32 v3, 1, v2
    v_and_b32 v5, 1, v2
    s_lshl_b32 s90, s32, 9
    v_lshlrev_b32 v6, 4, v1
    v_lshl_add_u32 v6, v3, 8, v6
    v_add_u32 v6, s90, v6
    s_mul_i32 s90, s60, 12288
    s_lshl_b32 s91, s61, 11
    s_add_u32 s90, s90, s91
    v_mul_u32_u24 v7, 6144, v5
    v_add3_u32 v19, v6, v7, s90
    v_mov_b32 v22, -1
    s_mul_i32 s56, s62, 12288
    s_lshl_b32 s91, s63, 11
    s_add_u32 s56, s56, s91
    s_sub_u32 s56, s56, s90
    s_lshl_b32 s90, s40, 10
    s_lshl_b32 s91, s32, 8
    s_add_u32 s91, s91, s90
    s_add_u32 s91, s91, 25600
    v_lshl_add_u32 v135, v0, 2, s91
    v_and_b32 v6, 60, v0
    v_bfe_u32 v7, v0, 1, 1
    v_or_b32 v6, v6, v7
    v_and_b32 v7, 1, v0
    v_lshl_or_b32 v6, v7, 1, v6
    s_and_b32 s90, s32, 1
    s_lshl_b32 s90, s90, 3
    v_xor_b32 v6, s90, v6
    v_lshl_add_u32 v134, v6, 2, s91
    s_lshl_b32 s90, s60, 5
    s_lshl_b32 s91, s62, 5
    v_mov_b32 v3, s90
    v_mov_b32 v4, s91
    v_mov_b32 v6, s61
    v_mov_b32 v7, s63
    v_cmp_eq_u32 vcc, 0, v0
    s_nop 1
    v_cndmask_b32 v3, v4, v3, vcc
    v_cndmask_b32 v6, v7, v6, vcc
    v_add_u32 v4, v3, v6
    s_cmp_eq_u32 s32, 3
    s_cselect_b32 s91, 0, 2146435072
    s_add_u32 s91, s91, 462348
    v_lshl_add_u32 v21, v4, 2, s91
    v_lshl_add_u32 v4, v6, 2, v3
    s_lshl_b32 s91, s32, 2
    s_add_u32 s91, s91, 458752
    v_lshl_add_u32 v136, v4, 2, s91
    v_cmp_gt_u32 vcc, 2, v0
    v_mov_b32 v9, 2146435072
    s_nop 0
    v_cndmask_b32 v21, v9, v21, vcc
    v_cndmask_b32 v136, v9, v136, vcc
    s_lshl_b32 s90, s40, 1
    s_add_u32 s90, s90, s32
    s_sub_u32 s90, s90, 4
    s_lshl_b32 s90, s90, 11
    s_cmp_eq_u32 s40, 0
    s_cselect_b32 s90, 2146435072, s90
    v_lshl_add_u32 v137, v0, 4, s90
    v_mov_b32 v138, 460416
    v_lshrrev_b32 v3, 2, v1
    v_and_b32 v4, 3, v1
    v_and_b32 v5, 1, v2
    v_lshl_add_u32 v6, v2, 3, v3
    v_lshlrev_b32 v6, 7, v6
    v_and_b32 v7, 2, v3
    v_lshl_or_b32 v7, v5, 2, v7
    v_lshrrev_b32 v8, 1, v4
    s_lshl_b32 s90, s32, 1
    v_or_b32 v8, s90, v8
    v_xor_b32 v7, v7, v8
    v_lshl_add_u32 v6, v7, 4, v6
    v_and_b32 v7, 1, v4
    v_lshl_add_u32 v6, v7, 3, v6
    v_add_u32 v125, 81920, v6
    v_add_u32 v126, 40960, v6
    v_add_u32 v127, 122880, v6
    s_lshl_b32 s90, s32, 9
    s_add_u32 s90, s90, 133120
    v_and_b32 v7, 2, v1
    v_cmp_ne_u32 vcc, 0, v7
    v_mov_b32 v6, 0x4444
    v_mov_b32 v8, 0xeeee
    v_cndmask_b32 v17, v6, v8, vcc
    v_lshlrev_b32 v6, 4, v0
    v_add_u32 v16, 122880, v6
    s_mul_i32 s90, s32, 2560
    v_lshl_add_u32 v13, v0, 4, s90
    v_lshl_add_u32 v14, v0, 2, s90
    s_add_u32 s48, s90, 122880
    v_mul_u32_u24 v6, 40, v0
    v_add_u32 v15, s48, v6
    v_mul_u32_u24 v6, 164, v0
    v_min_u32 v6, 10236, v6
    v_add_u32 v25, 122880, v6
    v_lshrrev_b32 v6, 3, v1
    v_lshlrev_b32 v6, 10, v6
    v_and_b32 v7, 7, v1
    v_lshl_add_u32 v6, v7, 7, v6
    v_lshrrev_b32 v7, 1, v1
    v_xor_b32 v7, v7, v2
    v_lshl_add_u32 v11, v7, 4, v6
    v_xor_b32 v12, 64, v11
    v_and_b32 v3, 1, v0
    v_lshlrev_b32 v3, 12, v3
    v_bfe_u32 v5, v0, 2, 1
    v_lshl_add_u32 v3, v5, 13, v3
    v_bfe_u32 v4, v0, 1, 1
    v_lshl_add_u32 v3, v4, 14, v3
    s_lshl_b32 s91, s34, 9
    s_add_u32 s91, s91, 1933312
    s_xor_b32 s55, s32, 3
    s_or_b32 s55, s55, s40
    s_cselect_b32 s91, 2146435072, s91
    s_cselect_b32 s92, 2146435072, 0
    s_add_u32 s92, s92, 460416
    v_mov_b32 v147, s92
    v_add_u32 v140, s91, v3
    v_cmp_eq_u32 vcc, 0, v0
    v_mov_b32 v9, 2146435072
    s_nop 0
    v_cndmask_b32 v147, v9, v147, vcc
    v_cmp_gt_u32 vcc, 8, v0
    v_mov_b32 v9, 2146435072
    s_nop 0
    v_cndmask_b32 v140, v9, v140, vcc
    v_cmp_ne_u32 vcc, s34, v0
    v_mov_b32 v9, 2146435072
    s_nop 0
    v_cndmask_b32 v140, v9, v140, vcc
    s_lshr_b32 s91, s34, 2
    v_cmp_eq_u32 vcc, s91, v5
    s_nop 1
    v_cndmask_b32 v141, v9, v140, vcc
    v_cndmask_b32 v140, v140, v9, vcc
    v_and_b32 v3, 7, v0
    v_min_u32 v3, 5, v3
    v_bfe_u32 v4, v0, 3, 2
    v_lshlrev_b32 v4, 7, v4
    v_lshl_add_u32 v3, v3, 2, v4
    v_add_u32 v142, 462368, v3
    v_min_u32 v3, 39, v0
    v_lshlrev_b32 v3, 2, v3
    v_add_u32 v142, 460544, v3
    s_lshl_b32 s93, s40, 1
    s_add_u32 s93, s93, s32
    s_lshl_b32 s93, s93, 1
    s_sub_u32 s93, s93, 8
    s_nop 0
    s_lshr_b32 s90, s93, 2
    s_lshl_b32 s90, s90, 15
    s_and_b32 s92, s93, 3
    s_lshl_b32 s92, s92, 10
    s_add_u32 s90, s90, s92
    v_mov_b32 v5, s34
    v_and_b32 v6, 7, v1
    v_lshlrev_b32 v6, 4, v6
    v_lshl_add_u32 v6, v5, 7, v6
    v_lshrrev_b32 v7, 3, v1
    v_lshl_add_u32 v6, v7, 12, v6
    v_lshrrev_b32 v5, 1, v2
    v_lshl_add_u32 v6, v5, 13, v6
    v_and_b32 v5, 1, v2
    v_lshl_add_u32 v6, v5, 14, v6
    v_add_u32 v143, s90, v6
    s_and_b32 s91, s34, 1
    s_lshl_b32 s91, s91, 12
    s_add_u32 s90, s90, s91
    s_lshr_b32 s91, s34, 2
    s_lshl_b32 s91, s91, 13
    s_add_u32 s90, s90, s91
    s_and_b32 s91, s34, 2
    s_lshl_b32 s91, s91, 13
    s_add_u32 s90, s90, s91
    v_lshl_add_u32 v144, v0, 4, s90
    s_lshl_b32 s91, s93, 10
    s_add_u32 s91, s91, 884736
    v_lshl_add_u32 v146, v0, 4, s91
    s_lshr_b32 s91, s34, 1
    s_mul_i32 s91, s91, 10240
    s_lshl_b32 s92, s93, 5
    s_add_u32 s91, s91, s92
    s_and_b32 s92, s34, 1
    s_mul_i32 s92, s92, 40960
    s_add_u32 s91, s91, s92
    s_add_u32 s91, s91, 1280
    v_mul_u32_u24 v6, 2560, v2
    v_lshl_add_u32 v6, v1, 1, v6
    v_add_u32 v145, s91, v6
    v_cmp_gt_u32 s[58:59], 8, v1
    v_and_b32 v5, 1, v1
    v_lshrrev_b32 v6, 3, v1
    v_lshl_add_u32 v5, v5, 1, v6
    v_bfe_u32 v6, v1, 2, 1
    v_cmp_ne_u32 vcc, 0, v6
    v_mov_b32 v6, 0x3f80
    v_mov_b32 v7, 0x3f800000
    v_cndmask_b32 v6, v6, v7, vcc
    v_cmp_eq_u32 vcc, 0, v5
    s_nop 1
    v_cndmask_b32 v7, 0, v6, vcc
    v_accvgpr_write_b32 a160, v7
    v_cmp_eq_u32 vcc, 1, v5
    s_nop 1
    v_cndmask_b32 v7, 0, v6, vcc
    v_accvgpr_write_b32 a161, v7
    v_cmp_eq_u32 vcc, 2, v5
    s_nop 1
    v_cndmask_b32 v7, 0, v6, vcc
    v_accvgpr_write_b32 a162, v7
    v_cmp_eq_u32 vcc, 3, v5
    s_nop 1
    v_cndmask_b32 v7, 0, v6, vcc
    v_accvgpr_write_b32 a163, v7
    s_cmp_lg_u32 s40, 0
    s_cselect_b64 vcc, -1, 0
    v_cndmask_b32 v143, v9, v143, vcc
    v_cndmask_b32 v144, v9, v144, vcc
    v_cndmask_b32 v145, v9, v145, vcc
    v_cndmask_b32 v146, v9, v146, vcc
    s_lshl_b32 s90, s32, 10
    s_add_u32 m0, s90, 40960
    s_mov_b32 s91, 0
    buffer_load_dwordx4 v124, s[12:15], s91 offen nt lds
    s_add_u32 m0, m0, 4096
    s_add_u32 s91, s91, 393216
    buffer_load_dwordx4 v124, s[12:15], s91 offen nt lds
    s_add_u32 m0, m0, 4096
    s_add_u32 s91, s91, 393216
    buffer_load_dwordx4 v124, s[12:15], s91 offen nt lds
    s_add_u32 m0, m0, 4096
    s_add_u32 s91, s91, 393216
    buffer_load_dwordx4 v124, s[12:15], s91 offen nt lds
    s_add_u32 m0, m0, 4096
    s_add_u32 s91, s91, 393216
    buffer_load_dwordx4 v124, s[12:15], s91 offen nt lds
    s_add_u32 m0, m0, 4096
    s_add_u32 s91, s91, 393216
    buffer_load_dwordx4 v124, s[12:15], s91 offen nt lds
    s_add_u32 m0, m0, 4096
    s_add_u32 s91, s91, 393216
    buffer_load_dwordx4 v124, s[12:15], s91 offen nt lds
    s_add_u32 m0, m0, 4096
    s_add_u32 s91, s91, 393216
    buffer_load_dwordx4 v124, s[12:15], s91 offen nt lds
    s_add_u32 m0, m0, 4096
    s_add_u32 s91, s91, 393216
    buffer_load_dwordx4 v124, s[12:15], s91 offen nt lds
    s_add_u32 m0, m0, 4096
    s_add_u32 s91, s91, 393216
    buffer_load_dwordx4 v124, s[12:15], s91 offen nt lds
    s_lshl_b32 s90, s32, 10
    s_add_u32 m0, s90, 122880
    s_mov_b32 s91, 3932288
    buffer_load_dwordx4 v124, s[12:15], s91 offen nt lds
    s_add_u32 m0, m0, 4096
    s_add_u32 s91, s91, 393216
    buffer_load_dwordx4 v124, s[12:15], s91 offen nt lds
    s_add_u32 m0, m0, 4096
    s_add_u32 s91, s91, 393216
    buffer_load_dwordx4 v124, s[12:15], s91 offen nt lds
    s_add_u32 m0, m0, 4096
    s_add_u32 s91, s91, 393216
    buffer_load_dwordx4 v124, s[12:15], s91 offen nt lds
    s_add_u32 m0, m0, 4096
    s_add_u32 s91, s91, 393216
    buffer_load_dwordx4 v124, s[12:15], s91 offen nt lds
    s_add_u32 m0, m0, 4096
    s_add_u32 s91, s91, 393216
    buffer_load_dwordx4 v124, s[12:15], s91 offen nt lds
    s_add_u32 m0, m0, 4096
    s_add_u32 s91, s91, 393216
    buffer_load_dwordx4 v124, s[12:15], s91 offen nt lds
    s_add_u32 m0, m0, 4096
    s_add_u32 s91, s91, 393216
    buffer_load_dwordx4 v124, s[12:15], s91 offen nt lds
    s_add_u32 m0, m0, 4096
    s_add_u32 s91, s91, 393216
    buffer_load_dwordx4 v124, s[12:15], s91 offen nt lds
    s_add_u32 m0, m0, 4096
    s_add_u32 s91, s91, 393216
    buffer_load_dwordx4 v124, s[12:15], s91 offen nt lds
    s_mov_b32 s46, 0
    s_lshl_b32 s90, s32, 10
    s_add_u32 m0, s90, 0
    s_nop 0
    buffer_load_dwordx4 v10, s[24:27], s46 offen offset:0 lds
    s_add_u32 m0, m0, 3968
    s_nop 0
    buffer_load_dwordx4 v10, s[24:27], s46 offen offset:128 lds
    s_add_u32 m0, m0, 3968
    s_nop 0
    buffer_load_dwordx4 v10, s[24:27], s46 offen offset:256 lds
    s_add_u32 m0, m0, 3968
    s_nop 0
    buffer_load_dwordx4 v10, s[24:27], s46 offen offset:384 lds
    s_add_u32 m0, m0, 3968
    s_nop 0
    buffer_load_dwordx4 v10, s[24:27], s46 offen offset:512 lds
    s_add_u32 m0, m0, 3968
    s_nop 0
    buffer_load_dwordx4 v10, s[24:27], s46 offen offset:640 lds
    s_add_u32 m0, m0, 3968
    s_nop 0
    buffer_load_dwordx4 v10, s[24:27], s46 offen offset:768 lds
    s_add_u32 m0, m0, 3968
    s_nop 0
    buffer_load_dwordx4 v10, s[24:27], s46 offen offset:896 lds
    s_add_u32 m0, m0, 3968
    s_nop 0
    buffer_load_dwordx4 v10, s[24:27], s46 offen offset:1024 lds
    s_add_u32 m0, m0, 3968
    s_nop 0
    buffer_load_dwordx4 v10, s[24:27], s46 offen offset:1152 lds
    s_waitcnt vmcnt(30)
    s_barrier
    ds_read_b64_tr_b16 a[80:81], v125 offset:0
    ds_read_b64_tr_b16 a[82:83], v125 offset:512
    ds_read_b64_tr_b16 a[84:85], v125 offset:4096
    ds_read_b64_tr_b16 a[86:87], v125 offset:4608
    ds_read_b64_tr_b16 a[88:89], v125 offset:8192
    ds_read_b64_tr_b16 a[90:91], v125 offset:8704
    ds_read_b64_tr_b16 a[92:93], v125 offset:12288
    ds_read_b64_tr_b16 a[94:95], v125 offset:12800
    ds_read_b64_tr_b16 a[96:97], v125 offset:16384
    ds_read_b64_tr_b16 a[98:99], v125 offset:16896
    ds_read_b64_tr_b16 a[100:101], v125 offset:20480
    ds_read_b64_tr_b16 a[102:103], v125 offset:20992
    ds_read_b64_tr_b16 a[104:105], v125 offset:24576
    ds_read_b64_tr_b16 a[106:107], v125 offset:25088
    ds_read_b64_tr_b16 a[108:109], v125 offset:28672
    ds_read_b64_tr_b16 a[110:111], v125 offset:29184
    ds_read_b64_tr_b16 a[112:113], v125 offset:32768
    ds_read_b64_tr_b16 a[114:115], v125 offset:33280
    ds_read_b64_tr_b16 a[116:117], v125 offset:36864
    ds_read_b64_tr_b16 a[118:119], v125 offset:37376
    s_waitcnt lgkmcnt(0)
    s_barrier
    s_lshl_b32 s90, s32, 10
    s_add_u32 m0, s90, 81920
    s_mov_b32 s91, 3932160
    buffer_load_dwordx4 v124, s[12:15], s91 offen nt lds
    s_add_u32 m0, m0, 4096
    s_add_u32 s91, s91, 393216
    buffer_load_dwordx4 v124, s[12:15], s91 offen nt lds
    s_add_u32 m0, m0, 4096
    s_add_u32 s91, s91, 393216
    buffer_load_dwordx4 v124, s[12:15], s91 offen nt lds
    s_add_u32 m0, m0, 4096
    s_add_u32 s91, s91, 393216
    buffer_load_dwordx4 v124, s[12:15], s91 offen nt lds
    s_add_u32 m0, m0, 4096
    s_add_u32 s91, s91, 393216
    buffer_load_dwordx4 v124, s[12:15], s91 offen nt lds
    s_add_u32 m0, m0, 4096
    s_add_u32 s91, s91, 393216
    buffer_load_dwordx4 v124, s[12:15], s91 offen nt lds
    s_add_u32 m0, m0, 4096
    s_add_u32 s91, s91, 393216
    buffer_load_dwordx4 v124, s[12:15], s91 offen nt lds
    s_add_u32 m0, m0, 4096
    s_add_u32 s91, s91, 393216
    buffer_load_dwordx4 v124, s[12:15], s91 offen nt lds
    s_add_u32 m0, m0, 4096
    s_add_u32 s91, s91, 393216
    buffer_load_dwordx4 v124, s[12:15], s91 offen nt lds
    s_add_u32 m0, m0, 4096
    s_add_u32 s91, s91, 393216
    buffer_load_dwordx4 v124, s[12:15], s91 offen nt lds
    s_waitcnt vmcnt(30)
    s_barrier
    ds_read_b64_tr_b16 a[0:1], v126 offset:0
    ds_read_b64_tr_b16 a[2:3], v126 offset:512
    ds_read_b64_tr_b16 a[4:5], v126 offset:4096
    ds_read_b64_tr_b16 a[6:7], v126 offset:4608
    ds_read_b64_tr_b16 a[8:9], v126 offset:8192
    ds_read_b64_tr_b16 a[10:11], v126 offset:8704
    ds_read_b64_tr_b16 a[12:13], v126 offset:12288
    ds_read_b64_tr_b16 a[14:15], v126 offset:12800
    ds_read_b64_tr_b16 a[16:17], v126 offset:16384
    ds_read_b64_tr_b16 a[18:19], v126 offset:16896
    ds_read_b64_tr_b16 a[20:21], v126 offset:20480
    ds_read_b64_tr_b16 a[22:23], v126 offset:20992
    ds_read_b64_tr_b16 a[24:25], v126 offset:24576
    ds_read_b64_tr_b16 a[26:27], v126 offset:25088
    ds_read_b64_tr_b16 a[28:29], v126 offset:28672
    ds_read_b64_tr_b16 a[30:31], v126 offset:29184
    ds_read_b64_tr_b16 a[32:33], v126 offset:32768
    ds_read_b64_tr_b16 a[34:35], v126 offset:33280
    ds_read_b64_tr_b16 a[36:37], v126 offset:36864
    ds_read_b64_tr_b16 a[38:39], v126 offset:37376
    s_waitcnt lgkmcnt(0)
    s_barrier
    s_mov_b32 s46, 40960
    s_lshl_b32 s90, s32, 10
    s_add_u32 m0, s90, 40960
    s_nop 0
    buffer_load_dwordx4 v10, s[24:27], s46 offen offset:0 lds
    s_add_u32 m0, m0, 3968
    s_nop 0
    buffer_load_dwordx4 v10, s[24:27], s46 offen offset:128 lds
    s_add_u32 m0, m0, 3968
    s_nop 0
    buffer_load_dwordx4 v10, s[24:27], s46 offen offset:256 lds
    s_add_u32 m0, m0, 3968
    s_nop 0
    buffer_load_dwordx4 v10, s[24:27], s46 offen offset:384 lds
    s_add_u32 m0, m0, 3968
    s_nop 0
    buffer_load_dwordx4 v10, s[24:27], s46 offen offset:512 lds
    s_add_u32 m0, m0, 3968
    s_nop 0
    buffer_load_dwordx4 v10, s[24:27], s46 offen offset:640 lds
    s_add_u32 m0, m0, 3968
    s_nop 0
    buffer_load_dwordx4 v10, s[24:27], s46 offen offset:768 lds
    s_add_u32 m0, m0, 3968
    s_nop 0
    buffer_load_dwordx4 v10, s[24:27], s46 offen offset:896 lds
    s_add_u32 m0, m0, 3968
    s_nop 0
    buffer_load_dwordx4 v10, s[24:27], s46 offen offset:1024 lds
    s_add_u32 m0, m0, 3968
    s_nop 0
    buffer_load_dwordx4 v10, s[24:27], s46 offen offset:1152 lds
    s_waitcnt vmcnt(30)
    s_barrier
    ds_read_b64_tr_b16 a[120:121], v127 offset:0
    ds_read_b64_tr_b16 a[122:123], v127 offset:512
    ds_read_b64_tr_b16 a[124:125], v127 offset:4096
    ds_read_b64_tr_b16 a[126:127], v127 offset:4608
    ds_read_b64_tr_b16 a[128:129], v127 offset:8192
    ds_read_b64_tr_b16 a[130:131], v127 offset:8704
    ds_read_b64_tr_b16 a[132:133], v127 offset:12288
    ds_read_b64_tr_b16 a[134:135], v127 offset:12800
    ds_read_b64_tr_b16 a[136:137], v127 offset:16384
    ds_read_b64_tr_b16 a[138:139], v127 offset:16896
    ds_read_b64_tr_b16 a[140:141], v127 offset:20480
    ds_read_b64_tr_b16 a[142:143], v127 offset:20992
    ds_read_b64_tr_b16 a[144:145], v127 offset:24576
    ds_read_b64_tr_b16 a[146:147], v127 offset:25088
    ds_read_b64_tr_b16 a[148:149], v127 offset:28672
    ds_read_b64_tr_b16 a[150:151], v127 offset:29184
    ds_read_b64_tr_b16 a[152:153], v127 offset:32768
    ds_read_b64_tr_b16 a[154:155], v127 offset:33280
    ds_read_b64_tr_b16 a[156:157], v127 offset:36864
    ds_read_b64_tr_b16 a[158:159], v127 offset:37376
    s_waitcnt lgkmcnt(0)
    s_waitcnt vmcnt(10)
    s_barrier
    ds_read_b64_tr_b16 a[40:41], v125 offset:0
    ds_read_b64_tr_b16 a[42:43], v125 offset:512
    ds_read_b64_tr_b16 a[44:45], v125 offset:4096
    ds_read_b64_tr_b16 a[46:47], v125 offset:4608
    ds_read_b64_tr_b16 a[48:49], v125 offset:8192
    ds_read_b64_tr_b16 a[50:51], v125 offset:8704
    ds_read_b64_tr_b16 a[52:53], v125 offset:12288
    ds_read_b64_tr_b16 a[54:55], v125 offset:12800
    ds_read_b64_tr_b16 a[56:57], v125 offset:16384
    ds_read_b64_tr_b16 a[58:59], v125 offset:16896
    ds_read_b64_tr_b16 a[60:61], v125 offset:20480
    ds_read_b64_tr_b16 a[62:63], v125 offset:20992
    ds_read_b64_tr_b16 a[64:65], v125 offset:24576
    ds_read_b64_tr_b16 a[66:67], v125 offset:25088
    ds_read_b64_tr_b16 a[68:69], v125 offset:28672
    ds_read_b64_tr_b16 a[70:71], v125 offset:29184
    ds_read_b64_tr_b16 a[72:73], v125 offset:32768
    ds_read_b64_tr_b16 a[74:75], v125 offset:33280
    ds_read_b64_tr_b16 a[76:77], v125 offset:36864
    ds_read_b64_tr_b16 a[78:79], v125 offset:37376
    s_waitcnt lgkmcnt(0)
    s_mov_b32 s49, 40960
    s_mov_b32 s47, 40960
    s_mov_b32 s37, -1
    s_add_u32 s44, s38, 65536
    s_add_u32 s45, s44, s56
    s_mov_b32 s46, 40960
    v_mov_b32 v1, 192
    buffer_load_dword v2, v1, s[8:11], 0 offen sc1
    ds_read_b128 v[84:87], v11 offset:0
    ds_read_b128 v[88:91], v11 offset:2048
    ds_read_b128 v[92:95], v12 offset:0
    ds_read_b128 v[96:99], v12 offset:2048
    s_waitcnt lgkmcnt(2)
    v_mfma_f32_16x16x32_bf16 v[108:111], a[0:3], v[84:87], 0
    ds_read_b128 v[100:103], v11 offset:4096
    v_mfma_f32_16x16x32_bf16 v[112:115], a[0:3], v[88:91], 0
    ds_read_b128 v[104:107], v11 offset:6144
    v_mfma_f32_16x16x32_bf16 v[116:119], a[80:83], v[84:87], 0
    v_mfma_f32_16x16x32_bf16 v[120:123], a[80:83], v[88:91], 0
    s_waitcnt lgkmcnt(2)
    v_mfma_f32_16x16x32_bf16 v[108:111], a[4:7], v[92:95], v[108:111]
    ds_read_b128 v[84:87], v12 offset:4096
    v_mfma_f32_16x16x32_bf16 v[112:115], a[4:7], v[96:99], v[112:115]
    ds_read_b128 v[88:91], v12 offset:6144
    v_mfma_f32_16x16x32_bf16 v[116:119], a[84:87], v[92:95], v[116:119]
    v_mfma_f32_16x16x32_bf16 v[120:123], a[84:87], v[96:99], v[120:123]
    s_waitcnt lgkmcnt(2)
    v_mfma_f32_16x16x32_bf16 v[108:111], a[8:11], v[100:103], v[108:111]
    ds_read_b128 v[92:95], v11 offset:8192
    v_mfma_f32_16x16x32_bf16 v[112:115], a[8:11], v[104:107], v[112:115]
    ds_read_b128 v[96:99], v11 offset:10240
    v_mfma_f32_16x16x32_bf16 v[116:119], a[88:91], v[100:103], v[116:119]
    v_mfma_f32_16x16x32_bf16 v[120:123], a[88:91], v[104:107], v[120:123]
    s_waitcnt lgkmcnt(2)
    v_mfma_f32_16x16x32_bf16 v[108:111], a[12:15], v[84:87], v[108:111]
    ds_read_b128 v[100:103], v12 offset:8192
    v_mfma_f32_16x16x32_bf16 v[112:115], a[12:15], v[88:91], v[112:115]
    ds_read_b128 v[104:107], v12 offset:10240
    v_mfma_f32_16x16x32_bf16 v[116:119], a[92:95], v[84:87], v[116:119]
    v_mfma_f32_16x16x32_bf16 v[120:123], a[92:95], v[88:91], v[120:123]
    s_waitcnt lgkmcnt(2)
    v_mfma_f32_16x16x32_bf16 v[108:111], a[16:19], v[92:95], v[108:111]
    ds_read_b128 v[84:87], v11 offset:12288
    v_mfma_f32_16x16x32_bf16 v[112:115], a[16:19], v[96:99], v[112:115]
    ds_read_b128 v[88:91], v11 offset:14336
    v_mfma_f32_16x16x32_bf16 v[116:119], a[96:99], v[92:95], v[116:119]
    v_mfma_f32_16x16x32_bf16 v[120:123], a[96:99], v[96:99], v[120:123]
    s_waitcnt lgkmcnt(2)
    v_mfma_f32_16x16x32_bf16 v[108:111], a[20:23], v[100:103], v[108:111]
    ds_read_b128 v[92:95], v12 offset:12288
    v_mfma_f32_16x16x32_bf16 v[112:115], a[20:23], v[104:107], v[112:115]
    ds_read_b128 v[96:99], v12 offset:14336
    v_mfma_f32_16x16x32_bf16 v[116:119], a[100:103], v[100:103], v[116:119]
    v_mfma_f32_16x16x32_bf16 v[120:123], a[100:103], v[104:107], v[120:123]
    s_waitcnt lgkmcnt(2)
    v_mfma_f32_16x16x32_bf16 v[108:111], a[24:27], v[84:87], v[108:111]
    ds_read_b128 v[100:103], v11 offset:16384
    v_mfma_f32_16x16x32_bf16 v[112:115], a[24:27], v[88:91], v[112:115]
    ds_read_b128 v[104:107], v11 offset:18432
    v_mfma_f32_16x16x32_bf16 v[116:119], a[104:107], v[84:87], v[116:119]
    v_mfma_f32_16x16x32_bf16 v[120:123], a[104:107], v[88:91], v[120:123]
    s_waitcnt lgkmcnt(2)
    v_mfma_f32_16x16x32_bf16 v[108:111], a[28:31], v[92:95], v[108:111]
    ds_read_b128 v[84:87], v12 offset:16384
    v_mfma_f32_16x16x32_bf16 v[112:115], a[28:31], v[96:99], v[112:115]
    ds_read_b128 v[88:91], v12 offset:18432
    v_mfma_f32_16x16x32_bf16 v[116:119], a[108:111], v[92:95], v[116:119]
    v_mfma_f32_16x16x32_bf16 v[120:123], a[108:111], v[96:99], v[120:123]
    s_waitcnt lgkmcnt(2)
    v_mfma_f32_16x16x32_bf16 v[108:111], a[32:35], v[100:103], v[108:111]
    ds_read_b128 v[92:95], v11 offset:20480
    v_mfma_f32_16x16x32_bf16 v[112:115], a[32:35], v[104:107], v[112:115]
    ds_read_b128 v[96:99], v11 offset:22528
    v_mfma_f32_16x16x32_bf16 v[116:119], a[112:115], v[100:103], v[116:119]
    v_mfma_f32_16x16x32_bf16 v[120:123], a[112:115], v[104:107], v[120:123]
    s_waitcnt lgkmcnt(2)
    v_mfma_f32_16x16x32_bf16 v[108:111], a[36:39], v[84:87], v[108:111]
    ds_read_b128 v[100:103], v12 offset:20480
    v_mfma_f32_16x16x32_bf16 v[112:115], a[36:39], v[88:91], v[112:115]
    ds_read_b128 v[104:107], v12 offset:22528
    v_mfma_f32_16x16x32_bf16 v[116:119], a[116:119], v[84:87], v[116:119]
    v_mfma_f32_16x16x32_bf16 v[120:123], a[116:119], v[88:91], v[120:123]
    s_waitcnt lgkmcnt(2)
    v_mfma_f32_16x16x32_bf16 v[108:111], a[40:43], v[92:95], v[108:111]
    ds_read_b128 v[84:87], v11 offset:24576
    v_mfma_f32_16x16x32_bf16 v[112:115], a[40:43], v[96:99], v[112:115]
    ds_read_b128 v[88:91], v11 offset:26624
    v_mfma_f32_16x16x32_bf16 v[116:119], a[120:123], v[92:95], v[116:119]
    v_mfma_f32_16x16x32_bf16 v[120:123], a[120:123], v[96:99], v[120:123]
    s_waitcnt lgkmcnt(2)
    v_mfma_f32_16x16x32_bf16 v[108:111], a[44:47], v[100:103], v[108:111]
    ds_read_b128 v[92:95], v12 offset:24576
    v_mfma_f32_16x16x32_bf16 v[112:115], a[44:47], v[104:107], v[112:115]
    ds_read_b128 v[96:99], v12 offset:26624
    v_mfma_f32_16x16x32_bf16 v[116:119], a[124:127], v[100:103], v[116:119]
    v_mfma_f32_16x16x32_bf16 v[120:123], a[124:127], v[104:107], v[120:123]
    s_waitcnt lgkmcnt(2)
    v_mfma_f32_16x16x32_bf16 v[108:111], a[48:51], v[84:87], v[108:111]
    ds_read_b128 v[100:103], v11 offset:28672
    v_mfma_f32_16x16x32_bf16 v[112:115], a[48:51], v[88:91], v[112:115]
    ds_read_b128 v[104:107], v11 offset:30720
    v_mfma_f32_16x16x32_bf16 v[116:119], a[128:131], v[84:87], v[116:119]
    v_mfma_f32_16x16x32_bf16 v[120:123], a[128:131], v[88:91], v[120:123]
    s_waitcnt lgkmcnt(2)
    v_mfma_f32_16x16x32_bf16 v[108:111], a[52:55], v[92:95], v[108:111]
    ds_read_b128 v[84:87], v12 offset:28672
    v_mfma_f32_16x16x32_bf16 v[112:115], a[52:55], v[96:99], v[112:115]
    ds_read_b128 v[88:91], v12 offset:30720
    v_mfma_f32_16x16x32_bf16 v[116:119], a[132:135], v[92:95], v[116:119]
    v_mfma_f32_16x16x32_bf16 v[120:123], a[132:135], v[96:99], v[120:123]
    s_waitcnt lgkmcnt(2)
    v_mfma_f32_16x16x32_bf16 v[108:111], a[56:59], v[100:103], v[108:111]
    ds_read_b128 v[92:95], v11 offset:32768
    v_mfma_f32_16x16x32_bf16 v[112:115], a[56:59], v[104:107], v[112:115]
    ds_read_b128 v[96:99], v11 offset:34816
    v_mfma_f32_16x16x32_bf16 v[116:119], a[136:139], v[100:103], v[116:119]
    v_mfma_f32_16x16x32_bf16 v[120:123], a[136:139], v[104:107], v[120:123]
    s_waitcnt lgkmcnt(2)
    v_mfma_f32_16x16x32_bf16 v[108:111], a[60:63], v[84:87], v[108:111]
    ds_read_b128 v[100:103], v12 offset:32768
    v_mfma_f32_16x16x32_bf16 v[112:115], a[60:63], v[88:91], v[112:115]
    ds_read_b128 v[104:107], v12 offset:34816
    v_mfma_f32_16x16x32_bf16 v[116:119], a[140:143], v[84:87], v[116:119]
    v_mfma_f32_16x16x32_bf16 v[120:123], a[140:143], v[88:91], v[120:123]
    s_waitcnt lgkmcnt(2)
    v_mfma_f32_16x16x32_bf16 v[108:111], a[64:67], v[92:95], v[108:111]
    ds_read_b128 v[84:87], v11 offset:36864
    v_mfma_f32_16x16x32_bf16 v[112:115], a[64:67], v[96:99], v[112:115]
    ds_read_b128 v[88:91], v11 offset:38912
    v_mfma_f32_16x16x32_bf16 v[116:119], a[144:147], v[92:95], v[116:119]
    v_mfma_f32_16x16x32_bf16 v[120:123], a[144:147], v[96:99], v[120:123]
    s_waitcnt lgkmcnt(2)
    v_mfma_f32_16x16x32_bf16 v[108:111], a[68:71], v[100:103], v[108:111]
    ds_read_b128 v[92:95], v12 offset:36864
    v_mfma_f32_16x16x32_bf16 v[112:115], a[68:71], v[104:107], v[112:115]
    ds_read_b128 v[96:99], v12 offset:38912
    v_mfma_f32_16x16x32_bf16 v[116:119], a[148:151], v[100:103], v[116:119]
    v_mfma_f32_16x16x32_bf16 v[120:123], a[148:151], v[104:107], v[120:123]
    s_waitcnt lgkmcnt(0)
    v_mfma_f32_16x16x32_bf16 v[108:111], a[72:75], v[84:87], v[108:111]
    v_add_u32 v11, s49, v11
    v_mfma_f32_16x16x32_bf16 v[112:115], a[72:75], v[88:91], v[112:115]
    v_add_u32 v12, s49, v12
    v_mfma_f32_16x16x32_bf16 v[108:111], a[76:79], v[92:95], v[108:111]
    s_sub_u32 s47, s47, s49
    v_mfma_f32_16x16x32_bf16 v[112:115], a[76:79], v[96:99], v[112:115]
    s_sub_u32 s49, 0, s49
    v_mfma_f32_16x16x32_bf16 v[116:119], a[152:155], v[84:87], v[116:119]
    v_mfma_f32_16x16x32_bf16 v[120:123], a[152:155], v[88:91], v[120:123]
    v_mfma_f32_16x16x32_bf16 v[116:119], a[156:159], v[92:95], v[116:119]
    v_mfma_f32_16x16x32_bf16 v[120:123], a[156:159], v[96:99], v[120:123]
    v_cvt_pk_bf16_f32 v124, v108, v109
    v_cvt_pk_bf16_f32 v125, v110, v111
    v_cvt_pk_bf16_f32 v126, v112, v113
    v_cvt_pk_bf16_f32 v127, v114, v115
    s_nop 0
    v_permlane16_swap_b32 v124, v126
    v_permlane16_swap_b32 v125, v127
    v_cvt_pk_bf16_f32 v128, v116, v117
    v_cvt_pk_bf16_f32 v129, v118, v119
    v_cvt_pk_bf16_f32 v130, v120, v121
    v_cvt_pk_bf16_f32 v131, v122, v123
    s_nop 0
    v_permlane16_swap_b32 v128, v130
    v_permlane16_swap_b32 v129, v131
    buffer_store_dwordx4 v[124:127], v19, s[4:7], s44 offen
    buffer_store_dwordx4 v[128:131], v19, s[4:7], s45 offen
    s_waitcnt vmcnt(2)
    s_branch L_gw_18c
L_gw_18:
    buffer_load_dword v2, v1, s[8:11], 0 offen sc1
    s_sub_u32 s36, s36, 1
    s_cbranch_scc1 L_exit
    s_waitcnt vmcnt(0)
L_gw_18c:
    v_readfirstlane_b32 s90, v2
    s_nop 0
    s_cmp_eq_u32 s90, 0
    s_cbranch_scc1 L_gw_18
    s_cmp_lg_u32 s90, 1
    s_cbranch_scc1 L_slow
    s_waitcnt vmcnt(2) lgkmcnt(0)
    s_barrier
    s_add_u32 s44, s38, 180224
    s_add_u32 s45, s44, s56
    s_mov_b32 s46, 81920
    v_mov_b32 v20, 1
    ds_read_b128 v[84:87], v11 offset:0
    ds_read_b128 v[88:91], v11 offset:2048
    ds_read_b128 v[92:95], v12 offset:0
    ds_read_b128 v[96:99], v12 offset:2048
    s_lshl_b32 s90, s32, 10
    s_add_u32 m0, s90, s47
    s_waitcnt lgkmcnt(2)
    v_mfma_f32_16x16x32_bf16 v[108:111], a[0:3], v[84:87], 0
    ds_read_b128 v[100:103], v11 offset:4096
    v_mfma_f32_16x16x32_bf16 v[112:115], a[0:3], v[88:91], 0
    ds_read_b128 v[104:107], v11 offset:6144
    v_mfma_f32_16x16x32_bf16 v[116:119], a[80:83], v[84:87], 0
    buffer_load_dwordx4 v10, s[24:27], s46 offen offset:0 lds
    s_add_u32 m0, m0, 3968
    v_mfma_f32_16x16x32_bf16 v[120:123], a[80:83], v[88:91], 0
    s_waitcnt lgkmcnt(2)
    v_mfma_f32_16x16x32_bf16 v[108:111], a[4:7], v[92:95], v[108:111]
    ds_read_b128 v[84:87], v12 offset:4096
    v_mfma_f32_16x16x32_bf16 v[112:115], a[4:7], v[96:99], v[112:115]
    ds_read_b128 v[88:91], v12 offset:6144
    v_mfma_f32_16x16x32_bf16 v[116:119], a[84:87], v[92:95], v[116:119]
    buffer_load_dwordx4 v10, s[24:27], s46 offen offset:128 lds
    s_add_u32 m0, m0, 3968
    v_mfma_f32_16x16x32_bf16 v[120:123], a[84:87], v[96:99], v[120:123]
    s_waitcnt lgkmcnt(2)
    v_mfma_f32_16x16x32_bf16 v[108:111], a[8:11], v[100:103], v[108:111]
    ds_read_b128 v[92:95], v11 offset:8192
    v_mfma_f32_16x16x32_bf16 v[112:115], a[8:11], v[104:107], v[112:115]
    ds_read_b128 v[96:99], v11 offset:10240
    v_mfma_f32_16x16x32_bf16 v[116:119], a[88:91], v[100:103], v[116:119]
    buffer_load_dwordx4 v10, s[24:27], s46 offen offset:256 lds
    s_add_u32 m0, m0, 3968
    v_mfma_f32_16x16x32_bf16 v[120:123], a[88:91], v[104:107], v[120:123]
    s_waitcnt lgkmcnt(2)
    v_mfma_f32_16x16x32_bf16 v[108:111], a[12:15], v[84:87], v[108:111]
    ds_read_b128 v[100:103], v12 offset:8192
    v_mfma_f32_16x16x32_bf16 v[112:115], a[12:15], v[88:91], v[112:115]
    ds_read_b128 v[104:107], v12 offset:10240
    v_mfma_f32_16x16x32_bf16 v[116:119], a[92:95], v[84:87], v[116:119]
    buffer_load_dwordx4 v10, s[24:27], s46 offen offset:384 lds
    s_add_u32 m0, m0, 3968
    v_mfma_f32_16x16x32_bf16 v[120:123], a[92:95], v[88:91], v[120:123]
    s_waitcnt lgkmcnt(2)
    v_mfma_f32_16x16x32_bf16 v[108:111], a[16:19], v[92:95], v[108:111]
    ds_read_b128 v[84:87], v11 offset:12288
    v_mfma_f32_16x16x32_bf16 v[112:115], a[16:19], v[96:99], v[112:115]
    ds_read_b128 v[88:91], v11 offset:14336
    v_mfma_f32_16x16x32_bf16 v[116:119], a[96:99], v[92:95], v[116:119]
    buffer_load_dwordx4 v10, s[24:27], s46 offen offset:512 lds
    s_add_u32 m0, m0, 3968
    v_mfma_f32_16x16x32_bf16 v[120:123], a[96:99], v[96:99], v[120:123]
    s_waitcnt lgkmcnt(2)
    v_mfma_f32_16x16x32_bf16 v[108:111], a[20:23], v[100:103], v[108:111]
    ds_read_b128 v[92:95], v12 offset:12288
    v_mfma_f32_16x16x32_bf16 v[112:115], a[20:23], v[104:107], v[112:115]
    ds_read_b128 v[96:99], v12 offset:14336
    v_mfma_f32_16x16x32_bf16 v[116:119], a[100:103], v[100:103], v[116:119]
    s_waitcnt vmcnt(5)
    buffer_store_dword v20, v136, s[4:7], s38 offen
    v_mfma_f32_16x16x32_bf16 v[120:123], a[100:103], v[104:107], v[120:123]
    s_waitcnt lgkmcnt(2)
    v_mfma_f32_16x16x32_bf16 v[108:111], a[24:27], v[84:87], v[108:111]
    ds_read_b128 v[100:103], v11 offset:16384
    v_mfma_f32_16x16x32_bf16 v[112:115], a[24:27], v[88:91], v[112:115]
    ds_read_b128 v[104:107], v11 offset:18432
    v_mfma_f32_16x16x32_bf16 v[116:119], a[104:107], v[84:87], v[116:119]
    buffer_load_dwordx4 v10, s[24:27], s46 offen offset:640 lds
    s_add_u32 m0, m0, 3968
    v_mfma_f32_16x16x32_bf16 v[120:123], a[104:107], v[88:91], v[120:123]
    s_waitcnt lgkmcnt(2)
    v_mfma_f32_16x16x32_bf16 v[108:111], a[28:31], v[92:95], v[108:111]
    ds_read_b128 v[84:87], v12 offset:16384
    v_mfma_f32_16x16x32_bf16 v[112:115], a[28:31], v[96:99], v[112:115]
    ds_read_b128 v[88:91], v12 offset:18432
    v_mfma_f32_16x16x32_bf16 v[116:119], a[108:111], v[92:95], v[116:119]
    buffer_load_dwordx4 v10, s[24:27], s46 offen offset:768 lds
    s_add_u32 m0, m0, 3968
    v_mfma_f32_16x16x32_bf16 v[120:123], a[108:111], v[96:99], v[120:123]
    s_waitcnt lgkmcnt(2)
    v_mfma_f32_16x16x32_bf16 v[108:111], a[32:35], v[100:103], v[108:111]
    ds_read_b128 v[92:95], v11 offset:20480
    v_mfma_f32_16x16x32_bf16 v[112:115], a[32:35], v[104:107], v[112:115]
    ds_read_b128 v[96:99], v11 offset:22528
    v_mfma_f32_16x16x32_bf16 v[116:119], a[112:115], v[100:103], v[116:119]
    buffer_load_dwordx4 v10, s[24:27], s46 offen offset:896 lds
    s_add_u32 m0, m0, 3968
    v_mfma_f32_16x16x32_bf16 v[120:123], a[112:115], v[104:107], v[120:123]
    s_waitcnt lgkmcnt(2)
    v_mfma_f32_16x16x32_bf16 v[108:111], a[36:39], v[84:87], v[108:111]
    ds_read_b128 v[100:103], v12 offset:20480
    v_mfma_f32_16x16x32_bf16 v[112:115], a[36:39], v[88:91], v[112:115]
    ds_read_b128 v[104:107], v12 offset:22528
    v_mfma_f32_16x16x32_bf16 v[116:119], a[116:119], v[84:87], v[116:119]
    buffer_load_dwordx4 v10, s[24:27], s46 offen offset:1024 lds
    s_add_u32 m0, m0, 3968
    v_mfma_f32_16x16x32_bf16 v[120:123], a[116:119], v[88:91], v[120:123]
    s_waitcnt lgkmcnt(2)
    v_mfma_f32_16x16x32_bf16 v[108:111], a[40:43], v[92:95], v[108:111]
    ds_read_b128 v[84:87], v11 offset:24576
    v_mfma_f32_16x16x32_bf16 v[112:115], a[40:43], v[96:99], v[112:115]
    ds_read_b128 v[88:91], v11 offset:26624
    v_mfma_f32_16x16x32_bf16 v[116:119], a[120:123], v[92:95], v[116:119]
    buffer_load_dwordx4 v10, s[24:27], s46 offen offset:1152 lds
    v_mfma_f32_16x16x32_bf16 v[120:123], a[120:123], v[96:99], v[120:123]
    s_waitcnt lgkmcnt(2)
    v_mfma_f32_16x16x32_bf16 v[108:111], a[44:47], v[100:103], v[108:111]
    ds_read_b128 v[92:95], v12 offset:24576
    v_mfma_f32_16x16x32_bf16 v[112:115], a[44:47], v[104:107], v[112:115]
    ds_read_b128 v[96:99], v12 offset:26624
    v_mfma_f32_16x16x32_bf16 v[116:119], a[124:127], v[100:103], v[116:119]
    v_mfma_f32_16x16x32_bf16 v[120:123], a[124:127], v[104:107], v[120:123]
    s_waitcnt lgkmcnt(2)
    v_mfma_f32_16x16x32_bf16 v[108:111], a[48:51], v[84:87], v[108:111]
    ds_read_b128 v[100:103], v11 offset:28672
    v_mfma_f32_16x16x32_bf16 v[112:115], a[48:51], v[88:91], v[112:115]
    ds_read_b128 v[104:107], v11 offset:30720
    v_mfma_f32_16x16x32_bf16 v[116:119], a[128:131], v[84:87], v[116:119]
    v_mfma_f32_16x16x32_bf16 v[120:123], a[128:131], v[88:91], v[120:123]
    s_waitcnt lgkmcnt(2)
    v_mfma_f32_16x16x32_bf16 v[108:111], a[52:55], v[92:95], v[108:111]
    ds_read_b128 v[84:87], v12 offset:28672
    v_mfma_f32_16x16x32_bf16 v[112:115], a[52:55], v[96:99], v[112:115]
    ds_read_b128 v[88:91], v12 offset:30720
    v_mfma_f32_16x16x32_bf16 v[116:119], a[132:135], v[92:95], v[116:119]
    v_mfma_f32_16x16x32_bf16 v[120:123], a[132:135], v[96:99], v[120:123]
    s_waitcnt lgkmcnt(2)
    v_mfma_f32_16x16x32_bf16 v[108:111], a[56:59], v[100:103], v[108:111]
    ds_read_b128 v[92:95], v11 offset:32768
    v_mfma_f32_16x16x32_bf16 v[112:115], a[56:59], v[104:107], v[112:115]
    ds_read_b128 v[96:99], v11 offset:34816
    v_mfma_f32_16x16x32_bf16 v[116:119], a[136:139], v[100:103], v[116:119]
    v_mfma_f32_16x16x32_bf16 v[120:123], a[136:139], v[104:107], v[120:123]
    s_waitcnt lgkmcnt(2)
    v_mfma_f32_16x16x32_bf16 v[108:111], a[60:63], v[84:87], v[108:111]
    ds_read_b128 v[100:103], v12 offset:32768
    v_mfma_f32_16x16x32_bf16 v[112:115], a[60:63], v[88:91], v[112:115]
    ds_read_b128 v[104:107], v12 offset:34816
    v_mfma_f32_16x16x32_bf16 v[116:119], a[140:143], v[84:87], v[116:119]
    v_mfma_f32_16x16x32_bf16 v[120:123], a[140:143], v[88:91], v[120:123]
    s_waitcnt lgkmcnt(2)
    v_mfma_f32_16x16x32_bf16 v[108:111], a[64:67], v[92:95], v[108:111]
    ds_read_b128 v[84:87], v11 offset:36864
    v_mfma_f32_16x16x32_bf16 v[112:115], a[64:67], v[96:99], v[112:115]
    ds_read_b128 v[88:91], v11 offset:38912
    v_mfma_f32_16x16x32_bf16 v[116:119], a[144:147], v[92:95], v[116:119]
    v_mfma_f32_16x16x32_bf16 v[120:123], a[144:147], v[96:99], v[120:123]
    s_waitcnt lgkmcnt(2)
    v_mfma_f32_16x16x32_bf16 v[108:111], a[68:71], v[100:103], v[108:111]
    ds_read_b128 v[92:95], v12 offset:36864
    v_mfma_f32_16x16x32_bf16 v[112:115], a[68:71], v[104:107], v[112:115]
    ds_read_b128 v[96:99], v12 offset:38912
    v_mfma_f32_16x16x32_bf16 v[116:119], a[148:151], v[100:103], v[116:119]
    v_mfma_f32_16x16x32_bf16 v[120:123], a[148:151], v[104:107], v[120:123]
    s_waitcnt lgkmcnt(0)
    v_mfma_f32_16x16x32_bf16 v[108:111], a[72:75], v[84:87], v[108:111]
    v_add_u32 v11, s49, v11
    v_mfma_f32_16x16x32_bf16 v[112:115], a[72:75], v[88:91], v[112:115]
    v_add_u32 v12, s49, v12
    v_mfma_f32_16x16x32_bf16 v[108:111], a[76:79], v[92:95], v[108:111]
    s_sub_u32 s47, s47, s49
    v_mfma_f32_16x16x32_bf16 v[112:115], a[76:79], v[96:99], v[112:115]
    s_sub_u32 s49, 0, s49
    v_mfma_f32_16x16x32_bf16 v[116:119], a[152:155], v[84:87], v[116:119]
    v_mfma_f32_16x16x32_bf16 v[120:123], a[152:155], v[88:91], v[120:123]
    v_mfma_f32_16x16x32_bf16 v[116:119], a[156:159], v[92:95], v[116:119]
    v_mfma_f32_16x16x32_bf16 v[120:123], a[156:159], v[96:99], v[120:123]
    v_cvt_pk_bf16_f32 v124, v108, v109
    v_cvt_pk_bf16_f32 v125, v110, v111
    v_cvt_pk_bf16_f32 v126, v112, v113
    v_cvt_pk_bf16_f32 v127, v114, v115
    s_nop 0
    v_permlane16_swap_b32 v124, v126
    v_permlane16_swap_b32 v125, v127
    v_cvt_pk_bf16_f32 v128, v116, v117
    v_cvt_pk_bf16_f32 v129, v118, v119
    v_cvt_pk_bf16_f32 v130, v120, v121
    v_cvt_pk_bf16_f32 v131, v122, v123
    s_nop 0
    v_permlane16_swap_b32 v128, v130
    v_permlane16_swap_b32 v129, v131
    buffer_store_dwordx4 v[124:127], v19, s[4:7], s44 offen
    buffer_store_dwordx4 v[128:131], v19, s[4:7], s45 offen
    s_waitcnt vmcnt(2) lgkmcnt(0)
    s_barrier
    s_add_u32 s44, s38, 294912
    s_add_u32 s45, s44, s56
    s_mov_b32 s46, 122880
    v_mov_b32 v20, 2
    ds_read_b128 v[84:87], v11 offset:0
    ds_read_b128 v[88:91], v11 offset:2048
    ds_read_b128 v[92:95], v12 offset:0
    ds_read_b128 v[96:99], v12 offset:2048
    s_lshl_b32 s90, s32, 10
    s_add_u32 m0, s90, s47
    s_waitcnt lgkmcnt(2)
    v_mfma_f32_16x16x32_bf16 v[108:111], a[0:3], v[84:87], 0
    ds_read_b128 v[100:103], v11 offset:4096
    s_add_u32 s51, s37, 3
    v_mfma_f32_16x16x32_bf16 v[112:115], a[0:3], v[88:91], 0
    ds_read_b128 v[104:107], v11 offset:6144
    s_and_b32 s50, s51, 3
    v_mfma_f32_16x16x32_bf16 v[116:119], a[80:83], v[84:87], 0
    buffer_load_dwordx4 v10, s[24:27], s46 offen offset:0 lds
    s_add_u32 m0, m0, 3968
    v_mfma_f32_16x16x32_bf16 v[120:123], a[80:83], v[88:91], 0
    s_waitcnt lgkmcnt(2)
    s_mul_i32 s50, s50, 114688
    v_mfma_f32_16x16x32_bf16 v[108:111], a[4:7], v[92:95], v[108:111]
    ds_read_b128 v[84:87], v12 offset:4096
    s_add_u32 s50, s50, 65536
    v_mfma_f32_16x16x32_bf16 v[112:115], a[4:7], v[96:99], v[112:115]
    ds_read_b128 v[88:91], v12 offset:6144
    s_add_u32 s44, s38, s50
    v_mfma_f32_16x16x32_bf16 v[116:119], a[84:87], v[92:95], v[116:119]
    buffer_load_dwordx4 v10, s[24:27], s46 offen offset:128 lds
    s_add_u32 m0, m0, 3968
    v_mfma_f32_16x16x32_bf16 v[120:123], a[84:87], v[96:99], v[120:123]
    s_waitcnt lgkmcnt(2)
    s_add_u32 s45, s44, s56
    v_mfma_f32_16x16x32_bf16 v[108:111], a[8:11], v[100:103], v[108:111]
    ds_read_b128 v[92:95], v11 offset:8192
    s_add_u32 s37, s37, 1
    v_mfma_f32_16x16x32_bf16 v[112:115], a[8:11], v[104:107], v[112:115]
    ds_read_b128 v[96:99], v11 offset:10240
    s_mov_b32 s52, 0
    v_mfma_f32_16x16x32_bf16 v[116:119], a[88:91], v[100:103], v[116:119]
    buffer_load_dwordx4 v10, s[24:27], s46 offen offset:256 lds
    s_add_u32 m0, m0, 3968
    v_mfma_f32_16x16x32_bf16 v[120:123], a[88:91], v[104:107], v[120:123]
    s_waitcnt lgkmcnt(2)
    s_and_b32 s50, s37, 3
    v_mfma_f32_16x16x32_bf16 v[108:111], a[12:15], v[84:87], v[108:111]
    ds_read_b128 v[100:103], v12 offset:8192
    s_mul_i32 s51, s50, 114688
    v_mfma_f32_16x16x32_bf16 v[112:115], a[12:15], v[88:91], v[112:115]
    ds_read_b128 v[104:107], v12 offset:10240
    s_add_u32 s41, s38, s51
    v_mfma_f32_16x16x32_bf16 v[116:119], a[92:95], v[84:87], v[116:119]
    buffer_load_dwordx4 v10, s[24:27], s46 offen offset:384 lds
    s_add_u32 m0, m0, 3968
    v_mfma_f32_16x16x32_bf16 v[120:123], a[92:95], v[88:91], v[120:123]
    s_waitcnt lgkmcnt(2)
    v_mfma_f32_16x16x32_bf16 v[108:111], a[16:19], v[92:95], v[108:111]
    ds_read_b128 v[84:87], v11 offset:12288
    v_mfma_f32_16x16x32_bf16 v[112:115], a[16:19], v[96:99], v[112:115]
    ds_read_b128 v[88:91], v11 offset:14336
    v_mfma_f32_16x16x32_bf16 v[116:119], a[96:99], v[92:95], v[116:119]
    buffer_load_dwordx4 v10, s[24:27], s46 offen offset:512 lds
    s_add_u32 m0, m0, 3968
    v_mfma_f32_16x16x32_bf16 v[120:123], a[96:99], v[96:99], v[120:123]
    s_waitcnt lgkmcnt(2)
    v_mfma_f32_16x16x32_bf16 v[108:111], a[20:23], v[100:103], v[108:111]
    ds_read_b128 v[92:95], v12 offset:12288
    v_mfma_f32_16x16x32_bf16 v[112:115], a[20:23], v[104:107], v[112:115]
    ds_read_b128 v[96:99], v12 offset:14336
    v_mfma_f32_16x16x32_bf16 v[116:119], a[100:103], v[100:103], v[116:119]
    s_waitcnt vmcnt(5)
    buffer_store_dword v20, v136, s[4:7], s38 offen
    v_mfma_f32_16x16x32_bf16 v[120:123], a[100:103], v[104:107], v[120:123]
    s_waitcnt lgkmcnt(2)
    v_mfma_f32_16x16x32_bf16 v[108:111], a[24:27], v[84:87], v[108:111]
    ds_read_b128 v[100:103], v11 offset:16384
    v_mfma_f32_16x16x32_bf16 v[112:115], a[24:27], v[88:91], v[112:115]
    ds_read_b128 v[104:107], v11 offset:18432
    v_mfma_f32_16x16x32_bf16 v[116:119], a[104:107], v[84:87], v[116:119]
    buffer_load_dwordx4 v10, s[24:27], s46 offen offset:640 lds
    s_add_u32 m0, m0, 3968
    v_mfma_f32_16x16x32_bf16 v[120:123], a[104:107], v[88:91], v[120:123]
    s_waitcnt lgkmcnt(2)
    v_mfma_f32_16x16x32_bf16 v[108:111], a[28:31], v[92:95], v[108:111]
    ds_read_b128 v[84:87], v12 offset:16384
    v_mfma_f32_16x16x32_bf16 v[112:115], a[28:31], v[96:99], v[112:115]
    ds_read_b128 v[88:91], v12 offset:18432
    v_mfma_f32_16x16x32_bf16 v[116:119], a[108:111], v[92:95], v[116:119]
    buffer_load_dwordx4 v10, s[24:27], s46 offen offset:768 lds
    s_add_u32 m0, m0, 3968
    v_mfma_f32_16x16x32_bf16 v[120:123], a[108:111], v[96:99], v[120:123]
    s_waitcnt lgkmcnt(2)
    v_mfma_f32_16x16x32_bf16 v[108:111], a[32:35], v[100:103], v[108:111]
    ds_read_b128 v[92:95], v11 offset:20480
    v_mfma_f32_16x16x32_bf16 v[112:115], a[32:35], v[104:107], v[112:115]
    ds_read_b128 v[96:99], v11 offset:22528
    v_mfma_f32_16x16x32_bf16 v[116:119], a[112:115], v[100:103], v[116:119]
    buffer_load_dwordx4 v10, s[24:27], s46 offen offset:896 lds
    s_add_u32 m0, m0, 3968
    v_mfma_f32_16x16x32_bf16 v[120:123], a[112:115], v[104:107], v[120:123]
    s_waitcnt lgkmcnt(2)
    v_mfma_f32_16x16x32_bf16 v[108:111], a[36:39], v[84:87], v[108:111]
    ds_read_b128 v[100:103], v12 offset:20480
    v_mfma_f32_16x16x32_bf16 v[112:115], a[36:39], v[88:91], v[112:115]
    ds_read_b128 v[104:107], v12 offset:22528
    v_mfma_f32_16x16x32_bf16 v[116:119], a[116:119], v[84:87], v[116:119]
    buffer_load_dwordx4 v10, s[24:27], s46 offen offset:1024 lds
    s_add_u32 m0, m0, 3968
    v_mfma_f32_16x16x32_bf16 v[120:123], a[116:119], v[88:91], v[120:123]
    s_waitcnt lgkmcnt(2)
    v_mfma_f32_16x16x32_bf16 v[108:111], a[40:43], v[92:95], v[108:111]
    ds_read_b128 v[84:87], v11 offset:24576
    v_mfma_f32_16x16x32_bf16 v[112:115], a[40:43], v[96:99], v[112:115]
    ds_read_b128 v[88:91], v11 offset:26624
    v_mfma_f32_16x16x32_bf16 v[116:119], a[120:123], v[92:95], v[116:119]
    buffer_load_dwordx4 v10, s[24:27], s46 offen offset:1152 lds
    v_mfma_f32_16x16x32_bf16 v[120:123], a[120:123], v[96:99], v[120:123]
    s_waitcnt lgkmcnt(2)
    v_mfma_f32_16x16x32_bf16 v[108:111], a[44:47], v[100:103], v[108:111]
    ds_read_b128 v[92:95], v12 offset:24576
    v_mfma_f32_16x16x32_bf16 v[112:115], a[44:47], v[104:107], v[112:115]
    ds_read_b128 v[96:99], v12 offset:26624
    v_mfma_f32_16x16x32_bf16 v[116:119], a[124:127], v[100:103], v[116:119]
    v_mfma_f32_16x16x32_bf16 v[120:123], a[124:127], v[104:107], v[120:123]
    s_waitcnt lgkmcnt(2)
    v_mfma_f32_16x16x32_bf16 v[108:111], a[48:51], v[84:87], v[108:111]
    ds_read_b128 v[100:103], v11 offset:28672
    v_mfma_f32_16x16x32_bf16 v[112:115], a[48:51], v[88:91], v[112:115]
    ds_read_b128 v[104:107], v11 offset:30720
    v_mfma_f32_16x16x32_bf16 v[116:119], a[128:131], v[84:87], v[116:119]
    v_mfma_f32_16x16x32_bf16 v[120:123], a[128:131], v[88:91], v[120:123]
    s_waitcnt lgkmcnt(2)
    v_mfma_f32_16x16x32_bf16 v[108:111], a[52:55], v[92:95], v[108:111]
    ds_read_b128 v[84:87], v12 offset:28672
    v_mfma_f32_16x16x32_bf16 v[112:115], a[52:55], v[96:99], v[112:115]
    ds_read_b128 v[88:91], v12 offset:30720
    v_mfma_f32_16x16x32_bf16 v[116:119], a[132:135], v[92:95], v[116:119]
    v_mfma_f32_16x16x32_bf16 v[120:123], a[132:135], v[96:99], v[120:123]
    s_waitcnt lgkmcnt(2)
    v_mfma_f32_16x16x32_bf16 v[108:111], a[56:59], v[100:103], v[108:111]
    ds_read_b128 v[92:95], v11 offset:32768
    v_mfma_f32_16x16x32_bf16 v[112:115], a[56:59], v[104:107], v[112:115]
    ds_read_b128 v[96:99], v11 offset:34816
    v_mfma_f32_16x16x32_bf16 v[116:119], a[136:139], v[100:103], v[116:119]
    v_mfma_f32_16x16x32_bf16 v[120:123], a[136:139], v[104:107], v[120:123]
    s_waitcnt lgkmcnt(2)
    v_mfma_f32_16x16x32_bf16 v[108:111], a[60:63], v[84:87], v[108:111]
    ds_read_b128 v[100:103], v12 offset:32768
    v_mfma_f32_16x16x32_bf16 v[112:115], a[60:63], v[88:91], v[112:115]
    ds_read_b128 v[104:107], v12 offset:34816
    v_mfma_f32_16x16x32_bf16 v[116:119], a[140:143], v[84:87], v[116:119]
    v_mfma_f32_16x16x32_bf16 v[120:123], a[140:143], v[88:91], v[120:123]
    s_waitcnt lgkmcnt(2)
    v_mfma_f32_16x16x32_bf16 v[108:111], a[64:67], v[92:95], v[108:111]
    ds_read_b128 v[84:87], v11 offset:36864
    v_mfma_f32_16x16x32_bf16 v[112:115], a[64:67], v[96:99], v[112:115]
    ds_read_b128 v[88:91], v11 offset:38912
    v_mfma_f32_16x16x32_bf16 v[116:119], a[144:147], v[92:95], v[116:119]
    v_mfma_f32_16x16x32_bf16 v[120:123], a[144:147], v[96:99], v[120:123]
    s_waitcnt lgkmcnt(2)
    v_mfma_f32_16x16x32_bf16 v[108:111], a[68:71], v[100:103], v[108:111]
    ds_read_b128 v[92:95], v12 offset:36864
    v_mfma_f32_16x16x32_bf16 v[112:115], a[68:71], v[104:107], v[112:115]
    ds_read_b128 v[96:99], v12 offset:38912
    v_mfma_f32_16x16x32_bf16 v[116:119], a[148:151], v[100:103], v[116:119]
    v_mfma_f32_16x16x32_bf16 v[120:123], a[148:151], v[104:107], v[120:123]
    s_waitcnt lgkmcnt(0)
    v_mfma_f32_16x16x32_bf16 v[108:111], a[72:75], v[84:87], v[108:111]
    v_add_u32 v11, s49, v11
    v_mfma_f32_16x16x32_bf16 v[112:115], a[72:75], v[88:91], v[112:115]
    v_add_u32 v12, s49, v12
    v_mfma_f32_16x16x32_bf16 v[108:111], a[76:79], v[92:95], v[108:111]
    s_sub_u32 s47, s47, s49
    v_mfma_f32_16x16x32_bf16 v[112:115], a[76:79], v[96:99], v[112:115]
    s_sub_u32 s49, 0, s49
    v_mfma_f32_16x16x32_bf16 v[116:119], a[152:155], v[84:87], v[116:119]
    v_mfma_f32_16x16x32_bf16 v[120:123], a[152:155], v[88:91], v[120:123]
    v_mfma_f32_16x16x32_bf16 v[116:119], a[156:159], v[92:95], v[116:119]
    v_mfma_f32_16x16x32_bf16 v[120:123], a[156:159], v[96:99], v[120:123]
    v_cvt_pk_bf16_f32 v124, v108, v109
    v_cvt_pk_bf16_f32 v125, v110, v111
    v_cvt_pk_bf16_f32 v126, v112, v113
    v_cvt_pk_bf16_f32 v127, v114, v115
    s_nop 0
    v_permlane16_swap_b32 v124, v126
    v_permlane16_swap_b32 v125, v127
    v_cvt_pk_bf16_f32 v128, v116, v117
    v_cvt_pk_bf16_f32 v129, v118, v119
    v_cvt_pk_bf16_f32 v130, v120, v121
    v_cvt_pk_bf16_f32 v131, v122, v123
    s_nop 0
    v_permlane16_swap_b32 v128, v130
    v_permlane16_swap_b32 v129, v131
    buffer_store_dwordx4 v[124:127], v19, s[4:7], s44 offen
    buffer_store_dwordx4 v[128:131], v19, s[4:7], s45 offen
    s_add_u32 s50, s37, 2
    s_and_b32 s50, s50, 3
    s_mul_i32 s50, s50, 114688
    s_add_u32 s42, s38, s50
    s_add_u32 s50, s37, 4
    s_min_u32 s50, s50, 63
    s_mul_i32 s46, s50, 40960
    s_add_u32 s51, s37, 1
    v_mov_b32 v20, s51
    s_mov_b32 m0, s48
    v_mov_b32 v68, 0
    v_mov_b32 v69, 0
    v_mov_b32 v70, 0
    v_mov_b32 v71, 0
    v_mov_b32 v72, 0
    v_mov_b32 v73, 0
    v_mov_b32 v74, 0
    v_mov_b32 v75, 0
    s_add_u32 s50, s37, 6
    s_min_u32 s50, s50, 63
    s_mul_i32 s57, s50, 40960
    s_and_b32 s50, s37, 3
    s_mul_i32 s51, s50, 40960
    s_add_u32 s43, s51, s38
    s_mul_i32 s51, s50, 327680
    s_add_u32 s53, s51, 4194304
    s_xor_b32 s50, s50, 2
    s_mul_i32 s51, s50, 327680
    s_add_u32 s54, s51, 4194304
    s_sub_u32 s51, s37, 6
    s_mul_i32 s60, s51, 81920
    s_branch L_v_first_f
L_v_loop_f:
    s_add_u32 s50, s37, 2
    s_and_b32 s50, s50, 3
    s_mul_i32 s50, s50, 114688
    s_add_u32 s42, s38, s50
    s_add_u32 s50, s37, 4
    s_min_u32 s50, s50, 63
    s_mul_i32 s46, s50, 40960
    s_add_u32 s51, s37, 1
    v_mov_b32 v20, s51
    s_mov_b32 m0, s48
    v_mov_b32 v68, 0
    v_mov_b32 v69, 0
    v_mov_b32 v70, 0
    v_mov_b32 v71, 0
    v_mov_b32 v72, 0
    v_mov_b32 v73, 0
    v_mov_b32 v74, 0
    v_mov_b32 v75, 0
    s_add_u32 s50, s37, 6
    s_min_u32 s50, s50, 63
    s_mul_i32 s57, s50, 40960
    s_and_b32 s50, s37, 3
    s_mul_i32 s51, s50, 40960
    s_add_u32 s43, s51, s38
    s_mul_i32 s51, s50, 327680
    s_add_u32 s53, s51, 4194304
    s_xor_b32 s50, s50, 2
    s_mul_i32 s51, s50, 327680
    s_add_u32 s54, s51, 4194304
    s_sub_u32 s51, s37, 6
    s_mul_i32 s60, s51, 81920
L_vg_19:
    buffer_load_dword v139, v138, s[4:7], s38 offen sc1
    s_sub_u32 s36, s36, 1
    s_cbranch_scc1 L_exit
    s_waitcnt vmcnt(0)
    v_cmp_gt_u32 vcc, s37, v139
    s_cbranch_vccnz L_vg_19
L_v_first_f:
    buffer_load_dwordx4 v13, s[4:7], s41 offen sc1 lds
    buffer_load_dwordx4 v13, s[4:7], s41 offen offset:1024 sc1 lds
    buffer_load_dword v14, s[4:7], s41 offen offset:2048 sc1 lds
    buffer_load_dword v14, s[4:7], s41 offen offset:2304 sc1 lds
L_poll_21:
    buffer_load_dwordx4 v13, s[4:7], s41 offen sc1 lds
    buffer_load_dwordx4 v13, s[4:7], s41 offen offset:1024 sc1 lds
    buffer_load_dword v14, s[4:7], s41 offen offset:2048 sc1 lds
    buffer_load_dword v14, s[4:7], s41 offen offset:2304 sc1 lds
    s_sub_u32 s36, s36, 1
    s_cbranch_scc1 L_exit
    s_waitcnt vmcnt(4)
    ds_read_b32 v18, v15
    s_waitcnt lgkmcnt(0)
    v_cmp_eq_u32 vcc, -1, v18
    s_cbranch_vccnz L_poll_21
    s_barrier
    ds_read_b128 v[28:31], v16 offset:0
    ds_read_b128 v[32:35], v16 offset:1024
    ds_read_b128 v[36:39], v16 offset:2048
    ds_read_b128 v[40:43], v16 offset:3072
    s_waitcnt lgkmcnt(3)
    v_smfmac_f32_16x16x64_bf16 v[68:71], v[28:31], a[0:7], v17
    ds_read_b128 v[44:47], v16 offset:4096
    v_smfmac_f32_16x16x64_bf16 v[72:75], v[28:31], a[80:87], v17
    ds_read_b128 v[48:51], v16 offset:5120
    s_waitcnt lgkmcnt(4)
    v_smfmac_f32_16x16x64_bf16 v[68:71], v[32:35], a[8:15], v17
    ds_read_b128 v[52:55], v16 offset:6144
    v_smfmac_f32_16x16x64_bf16 v[72:75], v[32:35], a[88:95], v17
    ds_read_b128 v[56:59], v16 offset:7168
    s_waitcnt lgkmcnt(5)
    v_smfmac_f32_16x16x64_bf16 v[68:71], v[36:39], a[16:23], v17
    ds_read_b128 v[60:63], v16 offset:8192
    v_smfmac_f32_16x16x64_bf16 v[72:75], v[36:39], a[96:103], v17
    ds_read_b128 v[64:67], v16 offset:9216
    s_waitcnt lgkmcnt(6)
    v_smfmac_f32_16x16x64_bf16 v[68:71], v[40:43], a[24:31], v17
    v_smfmac_f32_16x16x64_bf16 v[72:75], v[40:43], a[104:111], v17
    s_waitcnt lgkmcnt(5)
    v_smfmac_f32_16x16x64_bf16 v[68:71], v[44:47], a[32:39], v17
    v_smfmac_f32_16x16x64_bf16 v[72:75], v[44:47], a[112:119], v17
    s_waitcnt lgkmcnt(4)
    v_smfmac_f32_16x16x64_bf16 v[68:71], v[48:51], a[40:47], v17
    s_waitcnt lgkmcnt(3)
    v_smfmac_f32_16x16x64_bf16 v[68:71], v[52:55], a[48:55], v17
    s_waitcnt lgkmcnt(2)
    v_smfmac_f32_16x16x64_bf16 v[68:71], v[56:59], a[56:63], v17
    s_waitcnt lgkmcnt(1)
    v_smfmac_f32_16x16x64_bf16 v[68:71], v[60:63], a[64:71], v17
    s_waitcnt lgkmcnt(0)
    v_smfmac_f32_16x16x64_bf16 v[68:71], v[64:67], a[72:79], v17
L_redo_20:
    v_smfmac_f32_16x16x64_bf16 v[72:75], v[48:51], a[120:127], v17
    v_smfmac_f32_16x16x64_bf16 v[72:75], v[52:55], a[128:135], v17
    buffer_store_dword v20, v21, s[4:7], s38 offen offset:0
    v_smfmac_f32_16x16x64_bf16 v[72:75], v[56:59], a[136:143], v17
    v_add_f32 v68, v68, v70
    v_add_f32 v69, v69, v71
    v_smfmac_f32_16x16x64_bf16 v[72:75], v[60:63], a[144:151], v17
    v_cmp_u_f32 vcc, v68, v69
    v_cvt_pk_bf16_f32 v132, v68, v69
    v_smfmac_f32_16x16x64_bf16 v[72:75], v[64:67], a[152:159], v17
    s_cbranch_vccnz L_nan_22
L_cont_23:
    buffer_store_dword v132, v134, s[4:7], s41 offen offset:0
    s_nop 5
    v_pk_add_f32 v[72:73], v[72:73], v[74:75]
    v_cvt_pk_bf16_f32 v133, v72, v73
    buffer_store_dword v133, v134, s[4:7], s41 offen offset:1024
    ds_read_b128 v[84:87], v11 offset:0
    ds_read_b128 v[88:91], v11 offset:2048
    ds_read_b128 v[92:95], v12 offset:0
    ds_read_b128 v[96:99], v12 offset:2048
    s_cmp_eq_u32 s37, 63
    s_cbranch_scc1 L_end_24
    s_cmp_eq_u32 s37, 0
    s_cbranch_scc1 L_sd_25c
L_sd_25:
    s_cmp_eq_u32 s40, 0
    s_cbranch_scc1 L_an_26
    s_barrier
    s_lshl_b32 s90, s32, 10
    s_add_u32 m0, s90, s47
    s_waitcnt lgkmcnt(2)
    v_mfma_f32_16x16x32_bf16 v[108:111], a[0:3], v[84:87], 0
    ds_read_b128 v[100:103], v11 offset:4096
    s_add_u32 s51, s37, 3
    v_mfma_f32_16x16x32_bf16 v[112:115], a[0:3], v[88:91], 0
    ds_read_b128 v[104:107], v11 offset:6144
    s_and_b32 s50, s51, 3
    v_mfma_f32_16x16x32_bf16 v[116:119], a[80:83], v[84:87], 0
    buffer_load_dwordx4 v[148:151], v146, s[4:7], s43 offen offset:0 sc1
    buffer_load_dwordx4 v[152:155], v146, s[4:7], s43 offen offset:1024 sc1
    v_mfma_f32_16x16x32_bf16 v[120:123], a[80:83], v[88:91], 0
    s_waitcnt lgkmcnt(2)
    s_mul_i32 s50, s50, 114688
    v_mfma_f32_16x16x32_bf16 v[108:111], a[4:7], v[92:95], v[108:111]
    ds_read_b128 v[84:87], v12 offset:4096
    s_add_u32 s50, s50, 65536
    v_mfma_f32_16x16x32_bf16 v[112:115], a[4:7], v[96:99], v[112:115]
    ds_read_b128 v[88:91], v12 offset:6144
    s_add_u32 s44, s38, s50
    v_mfma_f32_16x16x32_bf16 v[116:119], a[84:87], v[92:95], v[116:119]
    s_cmp_lt_i32 s60, 0
    s_cselect_b32 s54, s38, s54
    buffer_load_dwordx4 v[156:159], v144, s[4:7], s54 offen offset:0 sc1
    buffer_load_dwordx4 v[160:163], v144, s[4:7], s54 offen offset:1024 sc1
    v_mfma_f32_16x16x32_bf16 v[120:123], a[84:87], v[96:99], v[120:123]
    s_waitcnt lgkmcnt(2)
    s_add_u32 s45, s44, s56
    v_mfma_f32_16x16x32_bf16 v[108:111], a[8:11], v[100:103], v[108:111]
    ds_read_b128 v[92:95], v11 offset:8192
    s_add_u32 s37, s37, 1
    v_mfma_f32_16x16x32_bf16 v[112:115], a[8:11], v[104:107], v[112:115]
    ds_read_b128 v[96:99], v11 offset:10240
    s_mov_b32 s52, 0
    v_mfma_f32_16x16x32_bf16 v[116:119], a[88:91], v[100:103], v[116:119]
    s_and_b32 s50, s37, 3
    s_mul_i32 s51, s50, 114688
    v_mfma_f32_16x16x32_bf16 v[120:123], a[88:91], v[104:107], v[120:123]
    s_waitcnt lgkmcnt(2)
    s_add_u32 s41, s38, s51
    v_mfma_f32_16x16x32_bf16 v[108:111], a[12:15], v[84:87], v[108:111]
    ds_read_b128 v[100:103], v12 offset:8192
    v_mfma_f32_16x16x32_bf16 v[112:115], a[12:15], v[88:91], v[112:115]
    ds_read_b128 v[104:107], v12 offset:10240
    v_mfma_f32_16x16x32_bf16 v[116:119], a[92:95], v[84:87], v[116:119]
    buffer_load_dwordx4 v[248:251], v137, s[24:27], s57 offen offset:0
    buffer_load_dwordx4 v[248:251], v137, s[24:27], s57 offen offset:1024
    v_mfma_f32_16x16x32_bf16 v[120:123], a[92:95], v[88:91], v[120:123]
    s_waitcnt lgkmcnt(2)
    v_mfma_f32_16x16x32_bf16 v[108:111], a[16:19], v[92:95], v[108:111]
    ds_read_b128 v[84:87], v11 offset:12288
    v_mfma_f32_16x16x32_bf16 v[112:115], a[16:19], v[96:99], v[112:115]
    ds_read_b128 v[88:91], v11 offset:14336
    v_mfma_f32_16x16x32_bf16 v[116:119], a[96:99], v[92:95], v[116:119]
    v_mfma_f32_16x16x32_bf16 v[120:123], a[96:99], v[96:99], v[120:123]
    s_waitcnt lgkmcnt(2)
    v_mfma_f32_16x16x32_bf16 v[108:111], a[20:23], v[100:103], v[108:111]
    ds_read_b128 v[92:95], v12 offset:12288
    v_mfma_f32_16x16x32_bf16 v[112:115], a[20:23], v[104:107], v[112:115]
    ds_read_b128 v[96:99], v12 offset:14336
    v_mfma_f32_16x16x32_bf16 v[116:119], a[100:103], v[100:103], v[116:119]
    s_waitcnt vmcnt(4)
    s_cmp_lt_i32 s60, -245760
    s_cbranch_scc1 L_fw_27c
L_fw_27:
    buffer_store_dwordx4 v[148:151], v143, s[4:7], s53 offen offset:0 sc1
    buffer_store_dwordx4 v[152:155], v143, s[4:7], s53 offen offset:1024 sc1
    v_mfma_f32_16x16x32_bf16 v[120:123], a[100:103], v[104:107], v[120:123]
    s_waitcnt lgkmcnt(2)
    v_mfma_f32_16x16x32_bf16 v[108:111], a[24:27], v[84:87], v[108:111]
    ds_read_b128 v[100:103], v11 offset:16384
    v_mfma_f32_16x16x32_bf16 v[112:115], a[24:27], v[88:91], v[112:115]
    ds_read_b128 v[104:107], v11 offset:18432
    v_mfma_f32_16x16x32_bf16 v[116:119], a[104:107], v[84:87], v[116:119]
    v_mfma_f32_16x16x32_bf16 v[120:123], a[104:107], v[88:91], v[120:123]
    s_waitcnt lgkmcnt(2)
    v_mfma_f32_16x16x32_bf16 v[108:111], a[28:31], v[92:95], v[108:111]
    ds_read_b128 v[84:87], v12 offset:16384
    v_mfma_f32_16x16x32_bf16 v[112:115], a[28:31], v[96:99], v[112:115]
    ds_read_b128 v[88:91], v12 offset:18432
    v_mfma_f32_16x16x32_bf16 v[116:119], a[108:111], v[92:95], v[116:119]
    buffer_store_dword v22, v135, s[4:7], s42 offen offset:0
    buffer_store_dword v22, v135, s[4:7], s42 offen offset:1024
    v_mfma_f32_16x16x32_bf16 v[120:123], a[108:111], v[96:99], v[120:123]
    s_waitcnt lgkmcnt(2)
    v_mfma_f32_16x16x32_bf16 v[108:111], a[32:35], v[100:103], v[108:111]
    ds_read_b128 v[92:95], v11 offset:20480
    v_mfma_f32_16x16x32_bf16 v[112:115], a[32:35], v[104:107], v[112:115]
    ds_read_b128 v[96:99], v11 offset:22528
    v_mfma_f32_16x16x32_bf16 v[116:119], a[112:115], v[100:103], v[116:119]
    buffer_load_dwordx4 v10, s[24:27], s46 offen offset:0 lds
    s_add_u32 m0, m0, 3968
    v_mfma_f32_16x16x32_bf16 v[120:123], a[112:115], v[104:107], v[120:123]
    s_waitcnt lgkmcnt(2)
    v_mfma_f32_16x16x32_bf16 v[108:111], a[36:39], v[84:87], v[108:111]
    ds_read_b128 v[100:103], v12 offset:20480
    v_mfma_f32_16x16x32_bf16 v[112:115], a[36:39], v[88:91], v[112:115]
    ds_read_b128 v[104:107], v12 offset:22528
    v_mfma_f32_16x16x32_bf16 v[116:119], a[116:119], v[84:87], v[116:119]
    buffer_load_dwordx4 v10, s[24:27], s46 offen offset:128 lds
    s_add_u32 m0, m0, 3968
    v_mfma_f32_16x16x32_bf16 v[120:123], a[116:119], v[88:91], v[120:123]
    s_waitcnt lgkmcnt(2)
    v_mfma_f32_16x16x32_bf16 v[108:111], a[40:43], v[92:95], v[108:111]
    ds_read_b128 v[84:87], v11 offset:24576
    v_mfma_f32_16x16x32_bf16 v[112:115], a[40:43], v[96:99], v[112:115]
    ds_read_b128 v[88:91], v11 offset:26624
    v_mfma_f32_16x16x32_bf16 v[116:119], a[120:123], v[92:95], v[116:119]
    buffer_load_dwordx4 v10, s[24:27], s46 offen offset:256 lds
    s_add_u32 m0, m0, 3968
    v_mfma_f32_16x16x32_bf16 v[120:123], a[120:123], v[96:99], v[120:123]
    s_waitcnt lgkmcnt(2)
    v_mfma_f32_16x16x32_bf16 v[108:111], a[44:47], v[100:103], v[108:111]
    ds_read_b128 v[92:95], v12 offset:24576
    v_mfma_f32_16x16x32_bf16 v[112:115], a[44:47], v[104:107], v[112:115]
    ds_read_b128 v[96:99], v12 offset:26624
    v_mfma_f32_16x16x32_bf16 v[116:119], a[124:127], v[100:103], v[116:119]
    buffer_load_dwordx4 v10, s[24:27], s46 offen offset:384 lds
    s_add_u32 m0, m0, 3968
    v_mfma_f32_16x16x32_bf16 v[120:123], a[124:127], v[104:107], v[120:123]
    s_waitcnt lgkmcnt(2)
    v_mfma_f32_16x16x32_bf16 v[108:111], a[48:51], v[84:87], v[108:111]
    ds_read_b128 v[100:103], v11 offset:28672
    v_mfma_f32_16x16x32_bf16 v[112:115], a[48:51], v[88:91], v[112:115]
    ds_read_b128 v[104:107], v11 offset:30720
    v_mfma_f32_16x16x32_bf16 v[116:119], a[128:131], v[84:87], v[116:119]
    buffer_load_dwordx4 v10, s[24:27], s46 offen offset:512 lds
    s_add_u32 m0, m0, 3968
    v_mfma_f32_16x16x32_bf16 v[120:123], a[128:131], v[88:91], v[120:123]
    s_waitcnt lgkmcnt(2)
    v_mfma_f32_16x16x32_bf16 v[108:111], a[52:55], v[92:95], v[108:111]
    ds_read_b128 v[84:87], v12 offset:28672
    v_mfma_f32_16x16x32_bf16 v[112:115], a[52:55], v[96:99], v[112:115]
    ds_read_b128 v[88:91], v12 offset:30720
    v_mfma_f32_16x16x32_bf16 v[116:119], a[132:135], v[92:95], v[116:119]
    buffer_load_dwordx4 v10, s[24:27], s46 offen offset:640 lds
    s_add_u32 m0, m0, 3968
    v_mfma_f32_16x16x32_bf16 v[120:123], a[132:135], v[96:99], v[120:123]
    s_waitcnt lgkmcnt(2)
    v_mfma_f32_16x16x32_bf16 v[108:111], a[56:59], v[100:103], v[108:111]
    ds_read_b128 v[92:95], v11 offset:32768
    v_mfma_f32_16x16x32_bf16 v[112:115], a[56:59], v[104:107], v[112:115]
    ds_read_b128 v[96:99], v11 offset:34816
    v_mfma_f32_16x16x32_bf16 v[116:119], a[136:139], v[100:103], v[116:119]
    buffer_load_dwordx4 v10, s[24:27], s46 offen offset:768 lds
    s_add_u32 m0, m0, 3968
    v_mfma_f32_16x16x32_bf16 v[120:123], a[136:139], v[104:107], v[120:123]
    s_waitcnt lgkmcnt(2)
    v_mfma_f32_16x16x32_bf16 v[108:111], a[60:63], v[84:87], v[108:111]
    ds_read_b128 v[100:103], v12 offset:32768
    v_mfma_f32_16x16x32_bf16 v[112:115], a[60:63], v[88:91], v[112:115]
    ds_read_b128 v[104:107], v12 offset:34816
    v_mfma_f32_16x16x32_bf16 v[116:119], a[140:143], v[84:87], v[116:119]
    buffer_load_dwordx4 v10, s[24:27], s46 offen offset:896 lds
    s_add_u32 m0, m0, 3968
    v_mfma_f32_16x16x32_bf16 v[120:123], a[140:143], v[88:91], v[120:123]
    s_waitcnt lgkmcnt(2)
    v_mfma_f32_16x16x32_bf16 v[108:111], a[64:67], v[92:95], v[108:111]
    ds_read_b128 v[84:87], v11 offset:36864
    v_mfma_f32_16x16x32_bf16 v[112:115], a[64:67], v[96:99], v[112:115]
    ds_read_b128 v[88:91], v11 offset:38912
    v_mfma_f32_16x16x32_bf16 v[116:119], a[144:147], v[92:95], v[116:119]
    buffer_load_dwordx4 v10, s[24:27], s46 offen offset:1024 lds
    s_add_u32 m0, m0, 3968
    v_mfma_f32_16x16x32_bf16 v[120:123], a[144:147], v[96:99], v[120:123]
    s_waitcnt lgkmcnt(2)
    v_mfma_f32_16x16x32_bf16 v[108:111], a[68:71], v[100:103], v[108:111]
    ds_read_b128 v[92:95], v12 offset:36864
    v_mfma_f32_16x16x32_bf16 v[112:115], a[68:71], v[104:107], v[112:115]
    ds_read_b128 v[96:99], v12 offset:38912
    v_mfma_f32_16x16x32_bf16 v[116:119], a[148:151], v[100:103], v[116:119]
    buffer_load_dwordx4 v10, s[24:27], s46 offen offset:1152 lds
    v_mfma_f32_16x16x32_bf16 v[120:123], a[148:151], v[104:107], v[120:123]
    s_waitcnt lgkmcnt(0)
    v_mfma_f32_16x16x32_bf16 v[108:111], a[72:75], v[84:87], v[108:111]
    v_add_u32 v11, s49, v11
    v_mfma_f32_16x16x32_bf16 v[112:115], a[72:75], v[88:91], v[112:115]
    v_add_u32 v12, s49, v12
    v_mfma_f32_16x16x32_bf16 v[108:111], a[76:79], v[92:95], v[108:111]
    s_sub_u32 s47, s47, s49
    v_mfma_f32_16x16x32_bf16 v[112:115], a[76:79], v[96:99], v[112:115]
    s_sub_u32 s49, 0, s49
    v_mfma_f32_16x16x32_bf16 v[116:119], a[152:155], v[84:87], v[116:119]
    v_mfma_f32_16x16x32_bf16 v[120:123], a[152:155], v[88:91], v[120:123]
    v_mfma_f32_16x16x32_bf16 v[116:119], a[156:159], v[92:95], v[116:119]
    v_mfma_f32_16x16x32_bf16 v[120:123], a[156:159], v[96:99], v[120:123]
    v_cvt_pk_bf16_f32 v124, v108, v109
    v_cvt_pk_bf16_f32 v125, v110, v111
    v_cvt_pk_bf16_f32 v126, v112, v113
    v_cvt_pk_bf16_f32 v127, v114, v115
    s_nop 0
    v_permlane16_swap_b32 v124, v126
    v_permlane16_swap_b32 v125, v127
    v_cvt_pk_bf16_f32 v128, v116, v117
    v_cvt_pk_bf16_f32 v129, v118, v119
    v_cvt_pk_bf16_f32 v130, v120, v121
    v_cvt_pk_bf16_f32 v131, v122, v123
    s_nop 0
    v_permlane16_swap_b32 v128, v130
    v_permlane16_swap_b32 v129, v131
    buffer_store_dwordx4 v[124:127], v19, s[4:7], s44 offen
    buffer_store_dwordx4 v[128:131], v19, s[4:7], s45 offen
    s_waitcnt vmcnt(18)
    s_cmp_lt_i32 s60, 0
    s_cbranch_scc1 L_fin_28
    v_mfma_f32_16x16x32_bf16 v[164:167], a[160:163], v[156:159], 0
    v_mfma_f32_16x16x32_bf16 v[168:171], a[160:163], v[160:163], 0
    s_nop 4
    v_cndmask_b32 v166, v164, v165, s[58:59]
    s_nop 1
    v_cndmask_b32 v170, v168, v169, s[58:59]
    v_cndmask_b32 v167, v165, v164, s[58:59]
    v_cndmask_b32 v171, v169, v168, s[58:59]
    s_nop 0
    v_add_f32_dpp v167, v166, v167 row_ror:8 row_mask:0xf bank_mask:0xf
    v_add_f32_dpp v171, v170, v171 row_ror:8 row_mask:0xf bank_mask:0xf
    v_cvt_pk_bf16_f32 v167, v167, v167
    v_cvt_pk_bf16_f32 v171, v171, v171
    buffer_store_short v167, v145, s[28:31], s60 offen offset:0
    buffer_store_short v171, v145, s[28:31], s60 offen offset:32
L_fin_28:
    s_branch L_v_loop_f
L_end_24:
    s_cmp_lt_i32 s60, 0
    s_cselect_b32 s54, s38, s54
    buffer_load_dwordx4 v[156:159], v144, s[4:7], s54 offen offset:0 sc1
    buffer_load_dwordx4 v[160:163], v144, s[4:7], s54 offen offset:1024 sc1
    s_waitcnt vmcnt(0) lgkmcnt(0)
    s_cmp_lt_i32 s60, 0
    s_cbranch_scc1 L_fin_29
    v_mfma_f32_16x16x32_bf16 v[164:167], a[160:163], v[156:159], 0
    v_mfma_f32_16x16x32_bf16 v[168:171], a[160:163], v[160:163], 0
    s_nop 4
    v_cndmask_b32 v166, v164, v165, s[58:59]
    s_nop 1
    v_cndmask_b32 v170, v168, v169, s[58:59]
    v_cndmask_b32 v167, v165, v164, s[58:59]
    v_cndmask_b32 v171, v169, v168, s[58:59]
    s_nop 0
    v_add_f32_dpp v167, v166, v167 row_ror:8 row_mask:0xf bank_mask:0xf
    v_add_f32_dpp v171, v170, v171 row_ror:8 row_mask:0xf bank_mask:0xf
    v_cvt_pk_bf16_f32 v167, v167, v167
    v_cvt_pk_bf16_f32 v171, v171, v171
    buffer_store_short v167, v145, s[28:31], s60 offen offset:0
    buffer_store_short v171, v145, s[28:31], s60 offen offset:32
L_fin_29:
    s_waitcnt vmcnt(0)
    s_endpgm
L_nan_22:
    s_cmp_eq_u32 s52, 1
    s_cbranch_scc1 L_cont_23
    v_lshlrev_b32 v1, 4, v0
L_nan_22r:
    s_mov_b32 s90, s41
    v_mov_b32 v2, 0
    buffer_load_dwordx4 v[28:31], v1, s[4:7], s90 offen sc1
    s_add_u32 s90, s90, 1024
    buffer_load_dwordx4 v[32:35], v1, s[4:7], s90 offen sc1
    s_add_u32 s90, s90, 1024
    buffer_load_dwordx4 v[36:39], v1, s[4:7], s90 offen sc1
    s_add_u32 s90, s90, 1024
    buffer_load_dwordx4 v[40:43], v1, s[4:7], s90 offen sc1
    s_add_u32 s90, s90, 1024
    buffer_load_dwordx4 v[44:47], v1, s[4:7], s90 offen sc1
    s_add_u32 s90, s90, 1024
    buffer_load_dwordx4 v[48:51], v1, s[4:7], s90 offen sc1
    s_add_u32 s90, s90, 1024
    buffer_load_dwordx4 v[52:55], v1, s[4:7], s90 offen sc1
    s_add_u32 s90, s90, 1024
    buffer_load_dwordx4 v[56:59], v1, s[4:7], s90 offen sc1
    s_add_u32 s90, s90, 1024
    buffer_load_dwordx4 v[60:63], v1, s[4:7], s90 offen sc1
    s_add_u32 s90, s90, 1024
    buffer_load_dwordx4 v[64:67], v1, s[4:7], s90 offen sc1
    s_add_u32 s90, s90, 1024
    s_sub_u32 s36, s36, 1
    s_cbranch_scc1 L_exit
    s_waitcnt vmcnt(0) lgkmcnt(0)
    v_max3_u32 v2, v2, v28, v29
    v_max3_u32 v2, v2, v30, v31
    v_max3_u32 v2, v2, v32, v33
    v_max3_u32 v2, v2, v34, v35
    v_max3_u32 v2, v2, v36, v37
    v_max3_u32 v2, v2, v38, v39
    v_max3_u32 v2, v2, v40, v41
    v_max3_u32 v2, v2, v42, v43
    v_max3_u32 v2, v2, v44, v45
    v_max3_u32 v2, v2, v46, v47
    v_max3_u32 v2, v2, v48, v49
    v_max3_u32 v2, v2, v50, v51
    v_max3_u32 v2, v2, v52, v53
    v_max3_u32 v2, v2, v54, v55
    v_max3_u32 v2, v2, v56, v57
    v_max3_u32 v2, v2, v58, v59
    v_max3_u32 v2, v2, v60, v61
    v_max3_u32 v2, v2, v62, v63
    v_max3_u32 v2, v2, v64, v65
    v_max3_u32 v2, v2, v66, v67
    v_cmp_eq_u32 vcc, -1, v2
    s_cbranch_vccnz L_nan_22r
    s_mov_b32 s52, 1
    v_mov_b32 v68, 0
    v_mov_b32 v69, 0
    v_mov_b32 v70, 0
    v_mov_b32 v71, 0
    v_mov_b32 v72, 0
    v_mov_b32 v73, 0
    v_mov_b32 v74, 0
    v_mov_b32 v75, 0
    v_smfmac_f32_16x16x64_bf16 v[68:71], v[28:31], a[0:7], v17
    s_nop 0
    v_smfmac_f32_16x16x64_bf16 v[72:75], v[28:31], a[80:87], v17
    v_smfmac_f32_16x16x64_bf16 v[68:71], v[32:35], a[8:15], v17
    v_smfmac_f32_16x16x64_bf16 v[72:75], v[32:35], a[88:95], v17
    v_smfmac_f32_16x16x64_bf16 v[68:71], v[36:39], a[16:23], v17
    v_smfmac_f32_16x16x64_bf16 v[72:75], v[36:39], a[96:103], v17
    v_smfmac_f32_16x16x64_bf16 v[68:71], v[40:43], a[24:31], v17
    v_smfmac_f32_16x16x64_bf16 v[72:75], v[40:43], a[104:111], v17
    v_smfmac_f32_16x16x64_bf16 v[68:71], v[44:47], a[32:39], v17
    v_smfmac_f32_16x16x64_bf16 v[72:75], v[44:47], a[112:119], v17
    v_smfmac_f32_16x16x64_bf16 v[68:71], v[48:51], a[40:47], v17
    v_smfmac_f32_16x16x64_bf16 v[68:71], v[52:55], a[48:55], v17
    v_smfmac_f32_16x16x64_bf16 v[68:71], v[56:59], a[56:63], v17
    v_smfmac_f32_16x16x64_bf16 v[68:71], v[60:63], a[64:71], v17
    v_smfmac_f32_16x16x64_bf16 v[68:71], v[64:67], a[72:79], v17
    s_nop 2
    s_branch L_redo_20
L_sd_25c:
    v_mov_b32 v3, 200
L_p0_30:
    buffer_load_dword v4, v3, s[8:11], 0 offen sc1
    s_sub_u32 s36, s36, 1
    s_cbranch_scc1 L_exit
    s_waitcnt vmcnt(0)
    v_readfirstlane_b32 s90, v4
    s_nop 0
    s_cmp_eq_u32 s90, 0
    s_cbranch_scc1 L_p0_30
    s_and_b32 s90, s90, 2
    s_lshl_b32 s90, s90, 12
    v_xor_b32 v140, s90, v140
    v_xor_b32 v141, s90, v141
    v_xor_b32 v143, s90, v143
    v_xor_b32 v144, s90, v144
    s_branch L_sd_25
L_an_26:
    s_cmp_lg_u32 s55, 0
    s_cbranch_scc1 L_an_26x
    buffer_load_dword v139, v142, s[4:7], s38 offen sc1
    buffer_load_dword v139, v142, s[4:7], s38 offen sc1
    buffer_load_dword v139, v142, s[4:7], s38 offen sc1
L_sp_31:
    buffer_load_dword v139, v142, s[4:7], s38 offen sc1
    s_sub_u32 s36, s36, 1
    s_cbranch_scc1 L_exit
    s_waitcnt vmcnt(3)
    v_cmp_ge_u32 vcc, s37, v139
    s_cbranch_vccnz L_sp_31
L_an_26x:
    s_barrier
    s_lshl_b32 s90, s32, 10
    s_add_u32 m0, s90, s47
    s_waitcnt lgkmcnt(2)
    v_mfma_f32_16x16x32_bf16 v[108:111], a[0:3], v[84:87], 0
    ds_read_b128 v[100:103], v11 offset:4096
    s_add_u32 s51, s37, 3
    v_mfma_f32_16x16x32_bf16 v[112:115], a[0:3], v[88:91], 0
    ds_read_b128 v[104:107], v11 offset:6144
    s_and_b32 s50, s51, 3
    v_mfma_f32_16x16x32_bf16 v[116:119], a[80:83], v[84:87], 0
    s_mul_i32 s50, s50, 114688
    s_add_u32 s50, s50, 65536
    v_mfma_f32_16x16x32_bf16 v[120:123], a[80:83], v[88:91], 0
    s_waitcnt lgkmcnt(2)
    s_add_u32 s44, s38, s50
    v_mfma_f32_16x16x32_bf16 v[108:111], a[4:7], v[92:95], v[108:111]
    ds_read_b128 v[84:87], v12 offset:4096
    s_add_u32 s45, s44, s56
    v_mfma_f32_16x16x32_bf16 v[112:115], a[4:7], v[96:99], v[112:115]
    ds_read_b128 v[88:91], v12 offset:6144
    s_add_u32 s37, s37, 1
    v_mfma_f32_16x16x32_bf16 v[116:119], a[84:87], v[92:95], v[116:119]
    s_mov_b32 s52, 0
    s_and_b32 s50, s37, 3
    v_mfma_f32_16x16x32_bf16 v[120:123], a[84:87], v[96:99], v[120:123]
    s_waitcnt lgkmcnt(2)
    s_mul_i32 s51, s50, 114688
    v_mfma_f32_16x16x32_bf16 v[108:111], a[8:11], v[100:103], v[108:111]
    ds_read_b128 v[92:95], v11 offset:8192
    s_add_u32 s41, s38, s51
    v_mfma_f32_16x16x32_bf16 v[112:115], a[8:11], v[104:107], v[112:115]
    ds_read_b128 v[96:99], v11 offset:10240
    v_mfma_f32_16x16x32_bf16 v[116:119], a[88:91], v[100:103], v[116:119]
    v_mfma_f32_16x16x32_bf16 v[120:123], a[88:91], v[104:107], v[120:123]
    s_waitcnt lgkmcnt(2)
    v_mfma_f32_16x16x32_bf16 v[108:111], a[12:15], v[84:87], v[108:111]
    ds_read_b128 v[100:103], v12 offset:8192
    v_mfma_f32_16x16x32_bf16 v[112:115], a[12:15], v[88:91], v[112:115]
    ds_read_b128 v[104:107], v12 offset:10240
    v_mfma_f32_16x16x32_bf16 v[116:119], a[92:95], v[84:87], v[116:119]
    v_mfma_f32_16x16x32_bf16 v[120:123], a[92:95], v[88:91], v[120:123]
    buffer_store_dword v20, v140, s[4:7], 0 offen sc1
    s_waitcnt lgkmcnt(2)
    v_mfma_f32_16x16x32_bf16 v[108:111], a[16:19], v[92:95], v[108:111]
    ds_read_b128 v[84:87], v11 offset:12288
    v_mfma_f32_16x16x32_bf16 v[112:115], a[16:19], v[96:99], v[112:115]
    ds_read_b128 v[88:91], v11 offset:14336
    v_mfma_f32_16x16x32_bf16 v[116:119], a[96:99], v[92:95], v[116:119]
    v_mfma_f32_16x16x32_bf16 v[120:123], a[96:99], v[96:99], v[120:123]
    buffer_store_dword v20, v141, s[4:7], 0 offen sc1
    s_waitcnt lgkmcnt(2)
    v_mfma_f32_16x16x32_bf16 v[108:111], a[20:23], v[100:103], v[108:111]
    ds_read_b128 v[92:95], v12 offset:12288
    v_mfma_f32_16x16x32_bf16 v[112:115], a[20:23], v[104:107], v[112:115]
    ds_read_b128 v[96:99], v12 offset:14336
    v_mfma_f32_16x16x32_bf16 v[116:119], a[100:103], v[100:103], v[116:119]
    v_mfma_f32_16x16x32_bf16 v[120:123], a[100:103], v[104:107], v[120:123]
    s_waitcnt lgkmcnt(2)
    v_mfma_f32_16x16x32_bf16 v[108:111], a[24:27], v[84:87], v[108:111]
    ds_read_b128 v[100:103], v11 offset:16384
    v_mfma_f32_16x16x32_bf16 v[112:115], a[24:27], v[88:91], v[112:115]
    ds_read_b128 v[104:107], v11 offset:18432
    v_mfma_f32_16x16x32_bf16 v[116:119], a[104:107], v[84:87], v[116:119]
    v_mfma_f32_16x16x32_bf16 v[120:123], a[104:107], v[88:91], v[120:123]
    s_waitcnt lgkmcnt(2)
    v_mfma_f32_16x16x32_bf16 v[108:111], a[28:31], v[92:95], v[108:111]
    ds_read_b128 v[84:87], v12 offset:16384
    v_mfma_f32_16x16x32_bf16 v[112:115], a[28:31], v[96:99], v[112:115]
    ds_read_b128 v[88:91], v12 offset:18432
    v_mfma_f32_16x16x32_bf16 v[116:119], a[108:111], v[92:95], v[116:119]
    v_mfma_f32_16x16x32_bf16 v[120:123], a[108:111], v[96:99], v[120:123]
    s_waitcnt lgkmcnt(2)
    v_mfma_f32_16x16x32_bf16 v[108:111], a[32:35], v[100:103], v[108:111]
    ds_read_b128 v[92:95], v11 offset:20480
    v_mfma_f32_16x16x32_bf16 v[112:115], a[32:35], v[104:107], v[112:115]
    ds_read_b128 v[96:99], v11 offset:22528
    v_mfma_f32_16x16x32_bf16 v[116:119], a[112:115], v[100:103], v[116:119]
    v_mfma_f32_16x16x32_bf16 v[120:123], a[112:115], v[104:107], v[120:123]
    s_waitcnt lgkmcnt(2)
    v_mfma_f32_16x16x32_bf16 v[108:111], a[36:39], v[84:87], v[108:111]
    ds_read_b128 v[100:103], v12 offset:20480
    v_mfma_f32_16x16x32_bf16 v[112:115], a[36:39], v[88:91], v[112:115]
    ds_read_b128 v[104:107], v12 offset:22528
    v_mfma_f32_16x16x32_bf16 v[116:119], a[116:119], v[84:87], v[116:119]
    v_mfma_f32_16x16x32_bf16 v[120:123], a[116:119], v[88:91], v[120:123]
    s_waitcnt lgkmcnt(2)
    v_mfma_f32_16x16x32_bf16 v[108:111], a[40:43], v[92:95], v[108:111]
    ds_read_b128 v[84:87], v11 offset:24576
    v_mfma_f32_16x16x32_bf16 v[112:115], a[40:43], v[96:99], v[112:115]
    ds_read_b128 v[88:91], v11 offset:26624
    v_mfma_f32_16x16x32_bf16 v[116:119], a[120:123], v[92:95], v[116:119]
    v_mfma_f32_16x16x32_bf16 v[120:123], a[120:123], v[96:99], v[120:123]
    s_waitcnt lgkmcnt(2)
    v_mfma_f32_16x16x32_bf16 v[108:111], a[44:47], v[100:103], v[108:111]
    ds_read_b128 v[92:95], v12 offset:24576
    v_mfma_f32_16x16x32_bf16 v[112:115], a[44:47], v[104:107], v[112:115]
    ds_read_b128 v[96:99], v12 offset:26624
    v_mfma_f32_16x16x32_bf16 v[116:119], a[124:127], v[100:103], v[116:119]
    v_mfma_f32_16x16x32_bf16 v[120:123], a[124:127], v[104:107], v[120:123]
    s_waitcnt lgkmcnt(2)
    v_mfma_f32_16x16x32_bf16 v[108:111], a[48:51], v[84:87], v[108:111]
    ds_read_b128 v[100:103], v11 offset:28672
    v_mfma_f32_16x16x32_bf16 v[112:115], a[48:51], v[88:91], v[112:115]
    ds_read_b128 v[104:107], v11 offset:30720
    v_mfma_f32_16x16x32_bf16 v[116:119], a[128:131], v[84:87], v[116:119]
    buffer_store_dword v20, v147, s[4:7], s38 offen
    buffer_store_dword v22, v135, s[4:7], s42 offen offset:0
    buffer_store_dword v22, v135, s[4:7], s42 offen offset:1024
    v_mfma_f32_16x16x32_bf16 v[120:123], a[128:131], v[88:91], v[120:123]
    s_waitcnt lgkmcnt(2)
    v_mfma_f32_16x16x32_bf16 v[108:111], a[52:55], v[92:95], v[108:111]
    ds_read_b128 v[84:87], v12 offset:28672
    v_mfma_f32_16x16x32_bf16 v[112:115], a[52:55], v[96:99], v[112:115]
    ds_read_b128 v[88:91], v12 offset:30720
    v_mfma_f32_16x16x32_bf16 v[116:119], a[132:135], v[92:95], v[116:119]
    buffer_load_dwordx4 v10, s[24:27], s46 offen offset:0 lds
    s_add_u32 m0, m0, 3968
    v_mfma_f32_16x16x32_bf16 v[120:123], a[132:135], v[96:99], v[120:123]
    s_waitcnt lgkmcnt(2)
    v_mfma_f32_16x16x32_bf16 v[108:111], a[56:59], v[100:103], v[108:111]
    ds_read_b128 v[92:95], v11 offset:32768
    v_mfma_f32_16x16x32_bf16 v[112:115], a[56:59], v[104:107], v[112:115]
    ds_read_b128 v[96:99], v11 offset:34816
    v_mfma_f32_16x16x32_bf16 v[116:119], a[136:139], v[100:103], v[116:119]
    buffer_load_dwordx4 v10, s[24:27], s46 offen offset:128 lds
    s_add_u32 m0, m0, 3968
    v_mfma_f32_16x16x32_bf16 v[120:123], a[136:139], v[104:107], v[120:123]
    s_waitcnt lgkmcnt(2)
    v_mfma_f32_16x16x32_bf16 v[108:111], a[60:63], v[84:87], v[108:111]
    ds_read_b128 v[100:103], v12 offset:32768
    v_mfma_f32_16x16x32_bf16 v[112:115], a[60:63], v[88:91], v[112:115]
    ds_read_b128 v[104:107], v12 offset:34816
    v_mfma_f32_16x16x32_bf16 v[116:119], a[140:143], v[84:87], v[116:119]
    buffer_load_dwordx4 v10, s[24:27], s46 offen offset:256 lds
    s_add_u32 m0, m0, 3968
    v_mfma_f32_16x16x32_bf16 v[120:123], a[140:143], v[88:91], v[120:123]
    s_waitcnt lgkmcnt(2)
    v_mfma_f32_16x16x32_bf16 v[108:111], a[64:67], v[92:95], v[108:111]
    ds_read_b128 v[84:87], v11 offset:36864
    v_mfma_f32_16x16x32_bf16 v[112:115], a[64:67], v[96:99], v[112:115]
    ds_read_b128 v[88:91], v11 offset:38912
    v_mfma_f32_16x16x32_bf16 v[116:119], a[144:147], v[92:95], v[116:119]
    buffer_load_dwordx4 v10, s[24:27], s46 offen offset:384 lds
    s_add_u32 m0, m0, 3968
    v_mfma_f32_16x16x32_bf16 v[120:123], a[144:147], v[96:99], v[120:123]
    s_waitcnt lgkmcnt(2)
    v_mfma_f32_16x16x32_bf16 v[108:111], a[68:71], v[100:103], v[108:111]
    ds_read_b128 v[92:95], v12 offset:36864
    v_mfma_f32_16x16x32_bf16 v[112:115], a[68:71], v[104:107], v[112:115]
    ds_read_b128 v[96:99], v12 offset:38912
    v_mfma_f32_16x16x32_bf16 v[116:119], a[148:151], v[100:103], v[116:119]
    buffer_load_dwordx4 v10, s[24:27], s46 offen offset:512 lds
    s_add_u32 m0, m0, 3968
    v_mfma_f32_16x16x32_bf16 v[120:123], a[148:151], v[104:107], v[120:123]
    s_waitcnt lgkmcnt(0)
    buffer_load_dwordx4 v10, s[24:27], s46 offen offset:640 lds
    s_add_u32 m0, m0, 3968
    s_nop 0
    buffer_load_dwordx4 v10, s[24:27], s46 offen offset:768 lds
    s_add_u32 m0, m0, 3968
    s_nop 0
    buffer_load_dwordx4 v10, s[24:27], s46 offen offset:896 lds
    s_add_u32 m0, m0, 3968
    s_nop 0
    buffer_load_dwordx4 v10, s[24:27], s46 offen offset:1024 lds
    s_add_u32 m0, m0, 3968
    s_nop 0
    buffer_load_dwordx4 v10, s[24:27], s46 offen offset:1152 lds
    v_mfma_f32_16x16x32_bf16 v[108:111], a[72:75], v[84:87], v[108:111]
    v_add_u32 v11, s49, v11
    v_mfma_f32_16x16x32_bf16 v[112:115], a[72:75], v[88:91], v[112:115]
    v_add_u32 v12, s49, v12
    v_mfma_f32_16x16x32_bf16 v[108:111], a[76:79], v[92:95], v[108:111]
    s_sub_u32 s47, s47, s49
    v_mfma_f32_16x16x32_bf16 v[112:115], a[76:79], v[96:99], v[112:115]
    s_sub_u32 s49, 0, s49
    v_mfma_f32_16x16x32_bf16 v[116:119], a[152:155], v[84:87], v[116:119]
    v_mfma_f32_16x16x32_bf16 v[120:123], a[152:155], v[88:91], v[120:123]
    v_mfma_f32_16x16x32_bf16 v[116:119], a[156:159], v[92:95], v[116:119]
    v_mfma_f32_16x16x32_bf16 v[120:123], a[156:159], v[96:99], v[120:123]
    v_cvt_pk_bf16_f32 v124, v108, v109
    v_cvt_pk_bf16_f32 v125, v110, v111
    v_cvt_pk_bf16_f32 v126, v112, v113
    v_cvt_pk_bf16_f32 v127, v114, v115
    s_nop 0
    v_permlane16_swap_b32 v124, v126
    v_permlane16_swap_b32 v125, v127
    v_cvt_pk_bf16_f32 v128, v116, v117
    v_cvt_pk_bf16_f32 v129, v118, v119
    v_cvt_pk_bf16_f32 v130, v120, v121
    v_cvt_pk_bf16_f32 v131, v122, v123
    s_nop 0
    v_permlane16_swap_b32 v128, v130
    v_permlane16_swap_b32 v129, v131
    buffer_store_dwordx4 v[124:127], v19, s[4:7], s44 offen
    buffer_store_dwordx4 v[128:131], v19, s[4:7], s45 offen
    s_branch L_v_loop_f
L_fw_27c:
    v_mov_b32 v148, -1
    v_mov_b32 v149, -1
    v_mov_b32 v150, -1
    v_mov_b32 v151, -1
    v_mov_b32 v152, -1
    v_mov_b32 v153, -1
    v_mov_b32 v154, -1
    v_mov_b32 v155, -1
    s_add_u32 s53, s53, 2293760
    buffer_store_dwordx4 v[148:151], v143, s[4:7], s53 offen offset:0 sc1
    buffer_store_dwordx4 v[152:155], v143, s[4:7], s53 offen offset:1024 sc1
    s_sub_u32 s53, s53, 983040
    s_branch L_fw_27
L_wo_f:
    s_mov_b32 s12, s80
    s_and_b32 s13, s81, 0xffff
    s_mov_b32 s14, 7864320
    s_mov_b32 s15, 0x20000
    s_mov_b32 s16, s72
    s_and_b32 s17, s73, 0xffff
    s_mov_b32 s18, 10240
    s_mov_b32 s19, 0x20000
    s_sub_u32 s40, s35, 18
    v_and_b32 v1, 15, v0
    v_lshrrev_b32 v2, 4, v0
    v_lshrrev_b32 v3, 3, v0
    v_and_b32 v4, 7, v0
    v_and_b32 v6, 2, v3
    v_xor_b32 v6, v6, v4
    v_lshlrev_b32 v6, 4, v6
    v_mul_u32_u24 v7, 1280, v3
    s_lshl_b32 s90, s34, 2
    s_add_u32 s90, s90, s32
    s_mul_i32 s90, s90, 245760
    s_lshl_b32 s91, s40, 7
    s_add_u32 s90, s90, s91
    v_add3_u32 v180, v6, v7, s90
    v_xor_b32 v181, 64, v180
    s_mul_i32 s90, s40, 32768
    s_lshl_b32 s91, s32, 11
    s_add_u32 s90, s90, s91
    s_lshl_b32 s91, s34, 8
    s_add_u32 s90, s90, s91
    v_and_b32 v7, 7, v1
    v_lshlrev_b32 v7, 3, v7
    v_lshl_add_u32 v7, v2, 6, v7
    v_lshrrev_b32 v6, 3, v1
    v_lshl_add_u32 v7, v6, 13, v7
    v_add_u32 v14, s90, v7
    v_lshlrev_b32 v6, 4, v1
    v_lshlrev_b32 v12, 4, v0
    v_lshlrev_b32 v13, 2, v0
    v_add_u32 v46, s90, v13
    s_lshl_b32 s92, s40, 7
    s_lshl_b32 s93, s32, 2
    s_add_u32 s92, s92, s93
    s_add_u32 s92, s92, 460800
    v_mov_b32 v244, s92
    v_cmp_eq_u32 vcc, 0, v0
    v_mov_b32 v9, 2146435072
    s_nop 0
    v_cndmask_b32 v244, v9, v244, vcc
    s_lshl_b32 s92, s40, 4
    s_add_u32 s92, s92, s93
    s_add_u32 s92, s92, 460544
    v_mov_b32 v45, s92
    v_cndmask_b32 v45, v9, v45, vcc
    s_lshl_b32 s92, s32, 7
    s_add_u32 s92, s92, 462336
    v_min_u32 v3, 5, v0
    v_lshl_add_u32 v245, v3, 2, s92
    s_lshl_b32 s90, s40, 2
    s_add_u32 s90, s90, s32
    s_lshl_b32 s91, s90, 8
    v_add_u32 v17, s91, v6
    v_cmp_eq_u32 vcc, 0, v2
    v_mov_b32 v9, 2146435072
    s_nop 0
    v_cndmask_b32 v17, v9, v17, vcc
    v_lshrrev_b32 v3, 2, v1
    v_and_b32 v7, 1, v1
    v_lshl_or_b32 v4, v3, 1, v7
    v_mul_u32_u24 v4, 1280, v4
    v_and_b32 v5, 2, v1
    v_lshl_add_u32 v4, v5, 1, v4
    s_lshl_b32 s91, s90, 5
    v_add_u32 v4, s91, v4
    v_lshlrev_b32 v6, 6, v3
    v_lshl_add_u32 v6, v7, 5, v6
    v_lshl_add_u32 v6, v2, 3, v6
    v_lshl_add_u32 v6, v5, 1, v6
    s_mul_i32 s92, s32, 1152
    s_add_u32 s92, s92, 122880
    v_add_u32 v18, s92, v6
    buffer_load_dword v164, v4, s[16:19], 0 offen offset:0
    buffer_load_dword v165, v4, s[16:19], 0 offen offset:8
    buffer_load_dword v166, v4, s[16:19], 0 offen offset:16
    buffer_load_dword v167, v4, s[16:19], 0 offen offset:24
    v_mov_b32 v168, -1
    v_mov_b32 v169, -1
    v_mov_b32 v170, -1
    v_mov_b32 v171, -1
    s_mul_i32 s90, s32, 24576
    s_mov_b32 m0, s90
    s_mov_b32 s91, 0
    buffer_load_dwordx4 v180, s[12:15], s91 offen nt lds
    s_add_u32 m0, m0, 1024
    s_add_u32 s91, s91, 10240
    buffer_load_dwordx4 v181, s[12:15], s91 offen nt lds
    s_add_u32 m0, m0, 1024
    s_add_u32 s91, s91, 10240
    buffer_load_dwordx4 v180, s[12:15], s91 offen nt lds
    s_add_u32 m0, m0, 1024
    s_add_u32 s91, s91, 10240
    buffer_load_dwordx4 v181, s[12:15], s91 offen nt lds
    s_add_u32 m0, m0, 1024
    s_add_u32 s91, s91, 10240
    buffer_load_dwordx4 v180, s[12:15], s91 offen nt lds
    s_add_u32 m0, m0, 1024
    s_add_u32 s91, s91, 10240
    buffer_load_dwordx4 v181, s[12:15], s91 offen nt lds
    s_add_u32 m0, m0, 1024
    s_add_u32 s91, s91, 10240
    buffer_load_dwordx4 v180, s[12:15], s91 offen nt lds
    s_add_u32 m0, m0, 1024
    s_add_u32 s91, s91, 10240
    buffer_load_dwordx4 v181, s[12:15], s91 offen nt lds
    s_add_u32 m0, m0, 1024
    s_add_u32 s91, s91, 10240
    buffer_load_dwordx4 v180, s[12:15], s91 offen nt lds
    s_add_u32 m0, m0, 1024
    s_add_u32 s91, s91, 10240
    buffer_load_dwordx4 v181, s[12:15], s91 offen nt lds
    s_add_u32 m0, m0, 1024
    s_add_u32 s91, s91, 10240
    buffer_load_dwordx4 v180, s[12:15], s91 offen nt lds
    s_add_u32 m0, m0, 1024
    s_add_u32 s91, s91, 10240
    buffer_load_dwordx4 v181, s[12:15], s91 offen nt lds
    s_add_u32 m0, m0, 1024
    s_add_u32 s91, s91, 10240
    buffer_load_dwordx4 v180, s[12:15], s91 offen nt lds
    s_add_u32 m0, m0, 1024
    s_add_u32 s91, s91, 10240
    buffer_load_dwordx4 v181, s[12:15], s91 offen nt lds
    s_add_u32 m0, m0, 1024
    s_add_u32 s91, s91, 10240
    buffer_load_dwordx4 v180, s[12:15], s91 offen nt lds
    s_add_u32 m0, m0, 1024
    s_add_u32 s91, s91, 10240
    buffer_load_dwordx4 v181, s[12:15], s91 offen nt lds
    s_add_u32 m0, m0, 1024
    s_add_u32 s91, s91, 10240
    buffer_load_dwordx4 v180, s[12:15], s91 offen nt lds
    s_add_u32 m0, m0, 1024
    s_add_u32 s91, s91, 10240
    buffer_load_dwordx4 v181, s[12:15], s91 offen nt lds
    s_add_u32 m0, m0, 1024
    s_add_u32 s91, s91, 10240
    buffer_load_dwordx4 v180, s[12:15], s91 offen nt lds
    s_add_u32 m0, m0, 1024
    s_add_u32 s91, s91, 10240
    buffer_load_dwordx4 v181, s[12:15], s91 offen nt lds
    s_add_u32 m0, m0, 1024
    s_add_u32 s91, s91, 10240
    buffer_load_dwordx4 v180, s[12:15], s91 offen nt lds
    s_add_u32 m0, m0, 1024
    s_add_u32 s91, s91, 10240
    buffer_load_dwordx4 v181, s[12:15], s91 offen nt lds
    s_add_u32 m0, m0, 1024
    s_add_u32 s91, s91, 10240
    buffer_load_dwordx4 v180, s[12:15], s91 offen nt lds
    s_add_u32 m0, m0, 1024
    s_add_u32 s91, s91, 10240
    buffer_load_dwordx4 v181, s[12:15], s91 offen nt lds
    s_waitcnt vmcnt(24)
    v_min_u32 v164, -2, v164
    v_min_u32 v165, -2, v165
    v_min_u32 v166, -2, v166
    v_min_u32 v167, -2, v167
    v_and_b32 v7, 2, v1
    v_cmp_ne_u32 vcc, 0, v7
    v_mov_b32 v5, 0x4444
    v_mov_b32 v6, 0xeeee
    v_cndmask_b32 v10, v5, v6, vcc
    v_mov_b32 v5, 0xe484
    v_mov_b32 v6, 0xee9e
    v_cndmask_b32 v7, v5, v6, vcc
    v_mov_b32 v5, 0x84e4
    v_mov_b32 v6, 0x9eee
    v_cndmask_b32 v8, v5, v6, vcc
    v_cmp_gt_u32 vcc, 2, v2
    s_nop 1
    v_cndmask_b32 v11, v8, v7, vcc
    v_mov_b32 v84, 1065369472
    v_mov_b32 v85, 1065369472
    v_mov_b32 v86, 1065369472
    v_mov_b32 v87, 0
    v_mov_b32 v88, 1065369472
    v_mov_b32 v89, 1065369472
    v_mov_b32 v90, 1065369472
    v_mov_b32 v91, 0
    v_mov_b32 v51, 0
    v_mov_b32 v55, 0
    v_mov_b32 v59, 0
    v_mov_b32 v63, 0
    v_mov_b32 v67, 0
    v_mov_b32 v71, 0
    v_mov_b32 v75, 0
    v_mov_b32 v79, 0
    v_mov_b32 v210, 0
    v_mov_b32 v211, 0
    v_mov_b32 v218, 0
    v_mov_b32 v219, 0
    v_lshrrev_b32 v8, 1, v1
    v_and_b32 v7, 2, v8
    v_cmp_ne_u32 vcc, 0, v7
    v_mov_b32 v5, 0x3f80
    v_mov_b32 v6, 0x3f800000
    v_cndmask_b32 v5, v5, v6, vcc
    v_bfe_u32 v6, v8, 2, 1
    v_and_b32 v7, 1, v8
    v_lshl_or_b32 v6, v7, 1, v6
    v_cmp_eq_u32 vcc, 0, v6
    s_nop 1
    v_cndmask_b32 v108, 0, v5, vcc
    v_cmp_eq_u32 vcc, 1, v6
    s_nop 1
    v_cndmask_b32 v109, 0, v5, vcc
    v_cmp_eq_u32 vcc, 2, v6
    s_nop 1
    v_cndmask_b32 v110, 0, v5, vcc
    v_cmp_eq_u32 vcc, 3, v6
    s_nop 1
    v_cndmask_b32 v111, 0, v5, vcc
    s_mov_b32 s60, 0xaaaaaaaa
    s_mov_b32 s61, 0xaaaaaaaa
    v_add_u32 v14, 8192, v46
    v_mov_b32 v240, 0x3dd53b95
    v_mov_b32 v241, 0x3dd53b95
    s_lshl_b32 s90, s32, 8
    s_add_u32 s90, s90, 122880
    v_mul_u32_u24 v6, 1152, v2
    v_lshl_add_u32 v6, v1, 3, v6
    v_add_u32 v19, s90, v6
    s_mul_i32 s90, s32, 1536
    v_add_u32 v20, s90, v12
    s_add_u32 s90, s90, 1024
    v_lshl_add_u32 v21, v0, 3, s90
    s_mul_i32 s90, s32, 6144
    v_add_u32 v22, s90, v12
    s_add_u32 s90, s90, 1024
    v_lshl_add_u32 v23, v0, 3, s90
    v_add_u32 v28, 98304, v12
    s_mul_i32 s90, s32, 3072
    v_add_u32 v37, s90, v12
    v_add_u32 v44, 25600, v37
    s_add_u32 s54, s90, 98304
    s_mul_i32 s90, s32, 3840
    s_add_u32 s90, s90, 10240
    v_add_u32 v38, s90, v12
    s_add_u32 s90, s90, 1024
    v_add_u32 v39, s90, v13
    s_mul_i32 s90, s32, 12288
    v_add_u32 v40, s90, v12
    s_lshl_b32 s93, s40, 2
    s_add_u32 s93, s93, s32
    s_nop 0
    s_lshr_b32 s90, s93, 2
    s_lshl_b32 s90, s90, 15
    s_and_b32 s92, s93, 3
    s_lshl_b32 s92, s92, 10
    s_add_u32 s90, s90, s92
    v_mov_b32 v5, s34
    v_and_b32 v6, 7, v1
    v_lshlrev_b32 v6, 4, v6
    v_lshl_add_u32 v6, v5, 7, v6
    v_lshrrev_b32 v7, 3, v1
    v_lshl_add_u32 v6, v7, 12, v6
    v_lshrrev_b32 v5, 1, v2
    v_lshl_add_u32 v6, v5, 13, v6
    v_and_b32 v5, 1, v2
    v_lshl_add_u32 v6, v5, 14, v6
    v_add_u32 v30, s90, v6
    s_and_b32 s91, s34, 1
    s_lshl_b32 s91, s91, 12
    s_add_u32 s90, s90, s91
    s_lshr_b32 s91, s34, 2
    s_lshl_b32 s91, s91, 13
    s_add_u32 s90, s90, s91
    s_and_b32 s91, s34, 2
    s_lshl_b32 s91, s91, 13
    s_add_u32 s90, s90, s91
    v_lshl_add_u32 v31, v0, 4, s90
    s_lshl_b32 s91, s93, 10
    s_add_u32 s91, s91, 884736
    v_lshl_add_u32 v15, v0, 4, s91
    s_lshr_b32 s91, s34, 1
    s_mul_i32 s91, s91, 10240
    s_lshl_b32 s92, s93, 5
    s_add_u32 s91, s91, s92
    s_and_b32 s92, s34, 1
    s_mul_i32 s92, s92, 40960
    s_add_u32 s91, s91, s92
    s_add_u32 s91, s91, 1280
    v_mul_u32_u24 v6, 2560, v2
    v_lshl_add_u32 v6, v1, 1, v6
    v_add_u32 v32, s91, v6
    v_cmp_gt_u32 s[58:59], 8, v1
    v_and_b32 v5, 1, v1
    v_lshrrev_b32 v6, 3, v1
    v_lshl_add_u32 v5, v5, 1, v6
    v_bfe_u32 v6, v1, 2, 1
    v_cmp_ne_u32 vcc, 0, v6
    v_mov_b32 v6, 0x3f80
    v_mov_b32 v7, 0x3f800000
    v_cndmask_b32 v6, v6, v7, vcc
    v_cmp_eq_u32 vcc, 0, v5
    s_nop 1
    v_cndmask_b32 v7, 0, v6, vcc
    v_accvgpr_write_b32 a144, v7
    v_cmp_eq_u32 vcc, 1, v5
    s_nop 1
    v_cndmask_b32 v7, 0, v6, vcc
    v_accvgpr_write_b32 a145, v7
    v_cmp_eq_u32 vcc, 2, v5
    s_nop 1
    v_cndmask_b32 v7, 0, v6, vcc
    v_accvgpr_write_b32 a146, v7
    v_cmp_eq_u32 vcc, 3, v5
    s_nop 1
    v_cndmask_b32 v7, 0, v6, vcc
    v_accvgpr_write_b32 a147, v7
    s_lshl_b32 s90, s32, 7
    v_add_u32 v5, s90, v13
    v_add_u32 v6, 458752, v5
    v_add_u32 v7, 459728, v5
    v_cmp_gt_u32 vcc, 12, v0
    s_nop 1
    v_cndmask_b32 v33, v7, v6, vcc
    v_mov_b32 v5, -2
    v_cndmask_b32 v34, v5, 3, vcc
    v_cmp_gt_u32 vcc, 14, v0
    v_mov_b32 v9, 2146435072
    s_nop 0
    v_cndmask_b32 v33, v9, v33, vcc
    v_mov_b32 v5, -1000
    v_cndmask_b32 v34, v5, v34, vcc
    v_and_b32 v4, 3, v1
    v_lshlrev_b32 v6, 6, v4
    v_lshl_add_u32 v6, v3, 3, v6
    v_lshl_add_u32 v6, v2, 8, v6
    v_and_b32 v5, 1, v2
    v_lshl_add_u32 v6, v5, 5, v6
    s_mul_i32 s90, s32, 3072
    s_add_u32 s53, s90, 131072
    v_add_u32 v16, s53, v6
    v_xor_b32 v13, 32, v16
    v_and_b32 v4, 3, v1
    v_and_b32 v5, 1, v2
    v_lshl_add_u32 v6, v2, 3, v3
    v_lshlrev_b32 v6, 7, v6
    v_and_b32 v7, 2, v3
    v_lshl_or_b32 v7, v5, 2, v7
    v_lshrrev_b32 v8, 1, v4
    v_xor_b32 v7, v7, v8
    v_lshl_add_u32 v6, v7, 4, v6
    v_and_b32 v7, 1, v4
    v_lshl_add_u32 v6, v7, 3, v6
    s_mul_i32 s90, s32, 24576
    v_add_u32 v6, s90, v6
    v_xor_b32 v182, 0, v6
    v_xor_b32 v183, 32, v6
    v_xor_b32 v184, 64, v6
    v_xor_b32 v185, 96, v6
    s_waitcnt vmcnt(0)
    ds_read_b64_tr_b16 a[0:1], v182 offset:0
    ds_read_b64_tr_b16 a[2:3], v182 offset:512
    ds_read_b64_tr_b16 a[4:5], v182 offset:4096
    ds_read_b64_tr_b16 a[6:7], v182 offset:4608
    ds_read_b64_tr_b16 a[8:9], v182 offset:8192
    ds_read_b64_tr_b16 a[10:11], v182 offset:8704
    ds_read_b64_tr_b16 a[12:13], v182 offset:12288
    ds_read_b64_tr_b16 a[14:15], v182 offset:12800
    ds_read_b64_tr_b16 a[16:17], v182 offset:16384
    ds_read_b64_tr_b16 a[18:19], v182 offset:16896
    ds_read_b64_tr_b16 a[20:21], v182 offset:20480
    ds_read_b64_tr_b16 a[22:23], v182 offset:20992
    ds_read_b64_tr_b16 a[24:25], v183 offset:0
    ds_read_b64_tr_b16 a[26:27], v183 offset:512
    ds_read_b64_tr_b16 a[28:29], v183 offset:4096
    ds_read_b64_tr_b16 a[30:31], v183 offset:4608
    ds_read_b64_tr_b16 a[32:33], v183 offset:8192
    ds_read_b64_tr_b16 a[34:35], v183 offset:8704
    ds_read_b64_tr_b16 a[36:37], v183 offset:12288
    ds_read_b64_tr_b16 a[38:39], v183 offset:12800
    ds_read_b64_tr_b16 a[40:41], v183 offset:16384
    ds_read_b64_tr_b16 a[42:43], v183 offset:16896
    ds_read_b64_tr_b16 a[44:45], v183 offset:20480
    ds_read_b64_tr_b16 a[46:47], v183 offset:20992
    ds_read_b64_tr_b16 a[48:49], v184 offset:0
    ds_read_b64_tr_b16 a[50:51], v184 offset:512
    ds_read_b64_tr_b16 a[52:53], v184 offset:4096
    ds_read_b64_tr_b16 a[54:55], v184 offset:4608
    ds_read_b64_tr_b16 a[56:57], v184 offset:8192
    ds_read_b64_tr_b16 a[58:59], v184 offset:8704
    ds_read_b64_tr_b16 a[60:61], v184 offset:12288
    ds_read_b64_tr_b16 a[62:63], v184 offset:12800
    ds_read_b64_tr_b16 a[64:65], v184 offset:16384
    ds_read_b64_tr_b16 a[66:67], v184 offset:16896
    ds_read_b64_tr_b16 a[68:69], v184 offset:20480
    ds_read_b64_tr_b16 a[70:71], v184 offset:20992
    ds_read_b64_tr_b16 a[72:73], v185 offset:0
    ds_read_b64_tr_b16 a[74:75], v185 offset:512
    ds_read_b64_tr_b16 a[76:77], v185 offset:4096
    ds_read_b64_tr_b16 a[78:79], v185 offset:4608
    ds_read_b64_tr_b16 a[80:81], v185 offset:8192
    ds_read_b64_tr_b16 a[82:83], v185 offset:8704
    ds_read_b64_tr_b16 a[84:85], v185 offset:12288
    ds_read_b64_tr_b16 a[86:87], v185 offset:12800
    ds_read_b64_tr_b16 a[88:89], v185 offset:16384
    ds_read_b64_tr_b16 a[90:91], v185 offset:16896
    ds_read_b64_tr_b16 a[92:93], v185 offset:20480
    ds_read_b64_tr_b16 a[94:95], v185 offset:20992
    s_waitcnt lgkmcnt(0)
    s_barrier
    v_mov_b32 v1, 192
L_gw_32:
    buffer_load_dword v2, v1, s[8:11], 0 offen sc1
    s_sub_u32 s36, s36, 1
    s_cbranch_scc1 L_exit
    s_waitcnt vmcnt(0)
L_gw_32c:
    v_readfirstlane_b32 s90, v2
    s_nop 0
    s_cmp_eq_u32 s90, 0
    s_cbranch_scc1 L_gw_32
    s_cmp_lg_u32 s90, 1
    s_cbranch_scc1 L_slow
    buffer_store_dwordx4 v[164:167], v17, s[4:7], s38 offen
    s_mov_b32 s57, -1
    s_mov_b32 s37, -1
    v_add_u32 v35, -2, v34
    s_add_u32 s45, s38, 65536
    s_add_u32 s46, s45, 4096
    s_add_u32 s47, s45, 8192
    v_mov_b32 v24, v20
    v_mov_b32 v25, v21
    buffer_load_dword v36, v33, s[4:7], s38 offen sc1
    s_waitcnt vmcnt(0)
    v_cmp_lt_i32 vcc, v36, v35
    s_cbranch_vccz L_fok_34
L_fw_33:
    buffer_load_dword v36, v33, s[4:7], s38 offen sc1
    s_sub_u32 s36, s36, 1
    s_cbranch_scc1 L_exit
    s_waitcnt vmcnt(0)
    v_cmp_lt_i32 vcc, v36, v35
    s_cbranch_vccnz L_fw_33
L_fok_34:
    buffer_load_dwordx4 a[96:99], v40, s[4:7], s45 offen offset:0 sc1
    buffer_load_dwordx4 a[100:103], v40, s[4:7], s45 offen offset:1024 sc1
    buffer_load_dwordx4 a[104:107], v40, s[4:7], s45 offen offset:2048 sc1
    buffer_load_dwordx4 a[108:111], v40, s[4:7], s45 offen offset:3072 sc1
    buffer_load_dwordx4 a[112:115], v40, s[4:7], s46 offen offset:0 sc1
    buffer_load_dwordx4 a[116:119], v40, s[4:7], s46 offen offset:1024 sc1
    buffer_load_dwordx4 a[120:123], v40, s[4:7], s46 offen offset:2048 sc1
    buffer_load_dwordx4 a[124:127], v40, s[4:7], s46 offen offset:3072 sc1
    buffer_load_dwordx4 a[128:131], v40, s[4:7], s47 offen offset:0 sc1
    buffer_load_dwordx4 a[132:135], v40, s[4:7], s47 offen offset:1024 sc1
    buffer_load_dwordx4 a[136:139], v40, s[4:7], s47 offen offset:2048 sc1
    buffer_load_dwordx4 a[140:143], v40, s[4:7], s47 offen offset:3072 sc1
    s_waitcnt vmcnt(0)
    v_mfma_f32_16x16x32_bf16 v[148:151], a[96:99], a[0:3], 0
    v_mfma_f32_16x16x32_bf16 v[152:155], a[120:123], a[0:3], 0
    v_mfma_f32_16x16x32_bf16 v[156:159], a[96:99], a[24:27], 0
    v_mfma_f32_16x16x32_bf16 v[160:163], a[120:123], a[24:27], 0
    v_mfma_f32_16x16x32_bf16 v[180:183], a[96:99], a[48:51], 0
    v_mfma_f32_16x16x32_bf16 v[184:187], a[120:123], a[48:51], 0
    v_mfma_f32_16x16x32_bf16 v[188:191], a[96:99], a[72:75], 0
    v_mfma_f32_16x16x32_bf16 v[192:195], a[120:123], a[72:75], 0
    v_mfma_f32_16x16x32_bf16 v[148:151], a[100:103], a[4:7], v[148:151]
    v_mfma_f32_16x16x32_bf16 v[152:155], a[124:127], a[4:7], v[152:155]
    v_mfma_f32_16x16x32_bf16 v[156:159], a[100:103], a[28:31], v[156:159]
    v_mfma_f32_16x16x32_bf16 v[160:163], a[124:127], a[28:31], v[160:163]
    v_mfma_f32_16x16x32_bf16 v[180:183], a[100:103], a[52:55], v[180:183]
    v_mfma_f32_16x16x32_bf16 v[184:187], a[124:127], a[52:55], v[184:187]
    v_mfma_f32_16x16x32_bf16 v[188:191], a[100:103], a[76:79], v[188:191]
    v_mfma_f32_16x16x32_bf16 v[192:195], a[124:127], a[76:79], v[192:195]
    v_mfma_f32_16x16x32_bf16 v[148:151], a[104:107], a[8:11], v[148:151]
    v_mfma_f32_16x16x32_bf16 v[152:155], a[128:131], a[8:11], v[152:155]
    v_mfma_f32_16x16x32_bf16 v[156:159], a[104:107], a[32:35], v[156:159]
    v_mfma_f32_16x16x32_bf16 v[160:163], a[128:131], a[32:35], v[160:163]
    v_mfma_f32_16x16x32_bf16 v[180:183], a[104:107], a[56:59], v[180:183]
    v_mfma_f32_16x16x32_bf16 v[184:187], a[128:131], a[56:59], v[184:187]
    v_mfma_f32_16x16x32_bf16 v[188:191], a[104:107], a[80:83], v[188:191]
    v_mfma_f32_16x16x32_bf16 v[192:195], a[128:131], a[80:83], v[192:195]
    v_mfma_f32_16x16x32_bf16 v[148:151], a[108:111], a[12:15], v[148:151]
    v_mfma_f32_16x16x32_bf16 v[152:155], a[132:135], a[12:15], v[152:155]
    v_mfma_f32_16x16x32_bf16 v[156:159], a[108:111], a[36:39], v[156:159]
    v_mfma_f32_16x16x32_bf16 v[160:163], a[132:135], a[36:39], v[160:163]
    v_mfma_f32_16x16x32_bf16 v[180:183], a[108:111], a[60:63], v[180:183]
    v_mfma_f32_16x16x32_bf16 v[184:187], a[132:135], a[60:63], v[184:187]
    v_mfma_f32_16x16x32_bf16 v[188:191], a[108:111], a[84:87], v[188:191]
    v_mfma_f32_16x16x32_bf16 v[192:195], a[132:135], a[84:87], v[192:195]
    v_mfma_f32_16x16x32_bf16 v[148:151], a[112:115], a[16:19], v[148:151]
    v_mfma_f32_16x16x32_bf16 v[152:155], a[136:139], a[16:19], v[152:155]
    v_mfma_f32_16x16x32_bf16 v[156:159], a[112:115], a[40:43], v[156:159]
    v_mfma_f32_16x16x32_bf16 v[160:163], a[136:139], a[40:43], v[160:163]
    v_mfma_f32_16x16x32_bf16 v[180:183], a[112:115], a[64:67], v[180:183]
    v_mfma_f32_16x16x32_bf16 v[184:187], a[136:139], a[64:67], v[184:187]
    v_mfma_f32_16x16x32_bf16 v[188:191], a[112:115], a[88:91], v[188:191]
    v_mfma_f32_16x16x32_bf16 v[192:195], a[136:139], a[88:91], v[192:195]
    v_mfma_f32_16x16x32_bf16 v[148:151], a[116:119], a[20:23], v[148:151]
    v_mfma_f32_16x16x32_bf16 v[152:155], a[140:143], a[20:23], v[152:155]
    v_mfma_f32_16x16x32_bf16 v[156:159], a[116:119], a[44:47], v[156:159]
    v_mfma_f32_16x16x32_bf16 v[160:163], a[140:143], a[44:47], v[160:163]
    v_mfma_f32_16x16x32_bf16 v[180:183], a[116:119], a[68:71], v[180:183]
    v_mfma_f32_16x16x32_bf16 v[184:187], a[140:143], a[68:71], v[184:187]
    v_mfma_f32_16x16x32_bf16 v[188:191], a[116:119], a[92:95], v[188:191]
    v_mfma_f32_16x16x32_bf16 v[192:195], a[140:143], a[92:95], v[192:195]
    v_cvt_pk_bf16_f32 v64, v180, v181
    v_cvt_pk_bf16_f32 v65, v182, v183
    ds_write_b64 v24, v[64:65] offset:12288
    v_cvt_pk_bf16_f32 v68, v184, v185
    v_cvt_pk_bf16_f32 v69, v186, v187
    ds_write_b64 v25, v[68:69] offset:12288
    v_cvt_pk_bf16_f32 v72, v188, v189
    v_cvt_pk_bf16_f32 v73, v190, v191
    ds_write_b64 v24, v[72:73] offset:18432
    v_cvt_pk_bf16_f32 v76, v192, v193
    v_cvt_pk_bf16_f32 v77, v194, v195
    ds_write_b64 v25, v[76:77] offset:18432
    v_cvt_pk_bf16_f32 v48, v148, v149
    v_cvt_pk_bf16_f32 v49, v150, v151
    ds_write_b64 v24, v[48:49] offset:0
    v_cvt_pk_bf16_f32 v52, v152, v153
    v_cvt_pk_bf16_f32 v53, v154, v155
    ds_write_b64 v25, v[52:53] offset:0
    v_cvt_pk_bf16_f32 v56, v156, v157
    v_cvt_pk_bf16_f32 v57, v158, v159
    ds_write_b64 v24, v[56:57] offset:6144
    v_cvt_pk_bf16_f32 v60, v160, v161
    v_cvt_pk_bf16_f32 v61, v162, v163
    ds_write_b64 v25, v[60:61] offset:6144
    s_add_u32 s56, s37, 2
    s_and_b32 s55, s56, 3
    s_mul_i32 s55, s55, 114688
    s_add_u32 s55, s55, 65536
    s_add_u32 s45, s38, s55
    s_add_u32 s46, s45, 4096
    s_add_u32 s47, s45, 8192
    s_add_u32 s56, s37, -1
    s_and_b32 s55, s56, 3
    s_mul_i32 s55, s55, 114688
    s_add_u32 s55, s55, 53248
    s_add_u32 s48, s38, s55
    s_and_b32 s55, s56, 1
    s_add_u32 s56, s56, 1
    v_mov_b32 v35, -16
    v_writelane_b32 v35, s56, 12
    s_mul_i32 s55, s55, 12288
    s_add_u32 m0, s54, s55
    v_add_u32 v35, -1, v34
    buffer_load_dword v36, v33, s[4:7], s38 offen sc1
    s_waitcnt vmcnt(0)
    v_cmp_lt_i32 vcc, v36, v35
    s_cbranch_vccz L_fok_36
L_fw_35:
    buffer_load_dword v36, v33, s[4:7], s38 offen sc1
    s_sub_u32 s36, s36, 1
    s_cbranch_scc1 L_exit
    s_waitcnt vmcnt(0)
    v_cmp_lt_i32 vcc, v36, v35
    s_cbranch_vccnz L_fw_35
L_fok_36:
    buffer_load_dwordx4 a[96:99], v40, s[4:7], s45 offen offset:0 sc1
    buffer_load_dwordx4 a[100:103], v40, s[4:7], s45 offen offset:1024 sc1
    buffer_load_dwordx4 a[104:107], v40, s[4:7], s45 offen offset:2048 sc1
    buffer_load_dwordx4 a[108:111], v40, s[4:7], s45 offen offset:3072 sc1
    buffer_load_dwordx4 a[112:115], v40, s[4:7], s46 offen offset:0 sc1
    buffer_load_dwordx4 a[116:119], v40, s[4:7], s46 offen offset:1024 sc1
    buffer_load_dwordx4 a[120:123], v40, s[4:7], s46 offen offset:2048 sc1
    buffer_load_dwordx4 a[124:127], v40, s[4:7], s46 offen offset:3072 sc1
    buffer_load_dwordx4 a[128:131], v40, s[4:7], s47 offen offset:0 sc1
    buffer_load_dwordx4 a[132:135], v40, s[4:7], s47 offen offset:1024 sc1
    buffer_load_dwordx4 a[136:139], v40, s[4:7], s47 offen offset:2048 sc1
    buffer_load_dwordx4 a[140:143], v40, s[4:7], s47 offen offset:3072 sc1
    s_mov_b32 s50, s42
    s_add_u32 s56, s37, 1
    v_mov_b32 v47, v24
    s_and_b32 s55, s56, 3
    s_mul_i32 s41, s55, 327680
    s_mul_i32 s56, s55, 114688
    s_add_u32 s43, s38, s56
    s_xor_b32 s55, s55, 2
    s_mul_i32 s42, s55, 327680
    s_add_u32 s56, s37, 2
    v_mov_b32 v107, s56
    s_and_b32 s55, s56, 3
    s_mul_i32 s44, s55, 24576
    s_add_u32 s56, s37, -1
    s_and_b32 s55, s56, 3
    s_mul_i32 s55, s55, 40960
    s_add_u32 s49, s55, s38
    s_add_u32 s56, s37, -1
    s_and_b32 s55, s56, 3
    s_mul_i32 s55, s55, 24576
    v_add_u32 v26, s55, v22
    v_add_u32 v27, s55, v23
    s_and_b32 s55, s56, 1
    s_mul_i32 s55, s55, 12288
    v_add_u32 v29, s55, v28
    s_add_u32 s37, s37, 1
    s_mov_b32 m0, s53
    v_add_u32 v24, s44, v20
    v_add_u32 v25, s44, v21
    v_pk_mul_f32 v[148:149], v[210:211], v[210:211]
    v_pk_mul_f32 v[150:151], v[210:211], v[210:211]
    v_pk_mul_f32 v[152:153], v[210:211], v[210:211]
    v_pk_mul_f32 v[154:155], v[210:211], v[210:211]
    v_pk_mul_f32 v[156:157], v[210:211], v[210:211]
    v_pk_mul_f32 v[158:159], v[210:211], v[210:211]
    v_pk_mul_f32 v[160:161], v[210:211], v[210:211]
    v_pk_mul_f32 v[162:163], v[210:211], v[210:211]
    v_mov_b32 v120, 0
    v_mov_b32 v121, 0
    v_mov_b32 v122, 0
    v_mov_b32 v123, 0
    v_mov_b32 v124, 0
    v_mov_b32 v125, 0
    v_mov_b32 v126, 0
    v_mov_b32 v127, 0
    v_mov_b32 v128, 0
    v_mov_b32 v129, 0
    v_mov_b32 v130, 0
    v_mov_b32 v131, 0
    v_mov_b32 v132, 0
    v_mov_b32 v133, 0
    v_mov_b32 v134, 0
    v_mov_b32 v135, 0
    v_mov_b32 v116, 0
    v_mov_b32 v117, 0
    v_mov_b32 v118, 0
    v_mov_b32 v119, 0
L_wo_loop_f:
    buffer_load_dword v41, v245, s[4:7], s38 offen sc1
    buffer_load_dword v41, v245, s[4:7], s38 offen sc1
    buffer_load_dword v41, v245, s[4:7], s38 offen sc1
    buffer_load_dword v41, v245, s[4:7], s38 offen sc1
    buffer_load_dword v41, v245, s[4:7], s38 offen sc1
    buffer_load_dword v41, v245, s[4:7], s38 offen sc1
L_sp_40:
    s_waitcnt vmcnt(5)
    v_cmp_ge_u32 vcc, s37, v41
    buffer_load_dword v41, v245, s[4:7], s38 offen sc1
    s_sub_u32 s36, s36, 1
    s_cbranch_scc1 L_exit
    s_cbranch_vccz L_sp_40x
    s_waitcnt vmcnt(5)
    v_cmp_ge_u32 vcc, s37, v41
    buffer_load_dword v41, v245, s[4:7], s38 offen sc1
    s_cbranch_vccz L_sp_40x
    s_waitcnt vmcnt(5)
    v_cmp_ge_u32 vcc, s37, v41
    buffer_load_dword v41, v245, s[4:7], s38 offen sc1
    s_cbranch_vccz L_sp_40x
    s_waitcnt vmcnt(5)
    v_cmp_ge_u32 vcc, s37, v41
    buffer_load_dword v41, v245, s[4:7], s38 offen sc1
    s_cbranch_vccnz L_sp_40
L_sp_40x:
    buffer_store_dword v107, v45, s[4:7], s38 offen
    buffer_load_dwordx4 v44, s[4:7], s43 offen offset:0 sc1 lds
    buffer_load_dwordx4 v44, s[4:7], s43 offen offset:1024 sc1 lds
    buffer_load_dwordx4 v44, s[4:7], s43 offen offset:2048 sc1 lds
    s_cmp_eq_u32 s37, 63
    s_cbranch_scc1 L_wo_tail_f
    s_waitcnt vmcnt(2)
    ds_read_b64_tr_b16 v[136:137], v16 offset:0
    ds_read_b64_tr_b16 v[138:139], v13 offset:0
    buffer_load_dwordx4 v[92:95], v38, s[4:7], s43 offen offset:0 sc1
    buffer_load_dwordx4 v[96:99], v38, s[4:7], s43 offen offset:1280 sc1
    buffer_load_dwordx4 v[100:103], v38, s[4:7], s43 offen offset:2560 sc1
    s_waitcnt vmcnt(4)
    ds_read_b64_tr_b16 v[140:141], v16 offset:1024
    ds_read_b64_tr_b16 v[142:143], v13 offset:1024
    s_waitcnt vmcnt(3)
    ds_read_b64_tr_b16 v[144:145], v16 offset:2048
    ds_read_b64_tr_b16 v[146:147], v13 offset:2048
    s_waitcnt lgkmcnt(4)
    v_smfmac_f32_16x16x64_bf16 v[148:151], v[136:139], a[0:7], v10
    buffer_load_dword v104, v39, s[4:7], s43 offen offset:0 sc1
    v_smfmac_f32_16x16x64_bf16 v[152:155], v[136:139], a[24:31], v10
    buffer_load_dword v105, v39, s[4:7], s43 offen offset:1280 sc1
    v_smfmac_f32_16x16x64_bf16 v[156:159], v[136:139], a[48:55], v10
    buffer_load_dword v106, v39, s[4:7], s43 offen offset:2560 sc1
    v_smfmac_f32_16x16x64_bf16 v[160:163], v[136:139], a[72:79], v10
    s_waitcnt lgkmcnt(2)
    v_smfmac_f32_16x16x64_bf16 v[148:151], v[140:143], a[8:15], v10
    v_smfmac_f32_16x16x64_bf16 v[152:155], v[140:143], a[32:39], v10
    v_smfmac_f32_16x16x64_bf16 v[156:159], v[140:143], a[56:63], v10
    v_smfmac_f32_16x16x64_bf16 v[160:163], v[140:143], a[80:87], v10
    s_waitcnt lgkmcnt(0)
    v_smfmac_f32_16x16x64_bf16 v[148:151], v[144:147], a[16:23], v10
    v_smfmac_f32_16x16x64_bf16 v[152:155], v[144:147], a[40:47], v10
    v_smfmac_f32_16x16x64_bf16 v[156:159], v[144:147], a[64:71], v10
    v_smfmac_f32_16x16x64_bf16 v[160:163], v[144:147], a[88:95], v10
L_sc_41:
    v_pk_add_f32 v[148:149], v[148:149], v[150:151]
    v_cvt_pk_bf16_f32 v50, v148, v149
    v_cvt_pk_bf16_f32 v54, v148, v149
    v_pk_add_f32 v[152:153], v[152:153], v[154:155]
    v_cvt_pk_bf16_f32 v58, v152, v153
    v_cvt_pk_bf16_f32 v62, v152, v153
    v_pk_add_f32 v[156:157], v[156:157], v[158:159]
    v_cvt_pk_bf16_f32 v66, v156, v157
    v_cvt_pk_bf16_f32 v70, v156, v157
    s_waitcnt vmcnt(4)
    v_pk_add_f32 v[236:237], v[92:93], v[96:97]
    v_pk_add_f32 v[238:239], v[94:95], v[98:99]
    s_waitcnt vmcnt(3)
    v_pk_add_f32 v[236:237], v[236:237], v[100:101]
    v_pk_add_f32 v[238:239], v[238:239], v[102:103]
    v_pk_mul_f32 v[236:237], v[236:237], v[240:241]
    v_pk_mul_f32 v[238:239], v[238:239], v[240:241]
    v_max3_f32 v41, v236, v237, v238
    s_waitcnt vmcnt(0)
    v_add_f32 v43, v104, v105
    v_add_f32 v43, v43, v106
    v_mul_f32 v43, v43, v240
    v_max3_f32 v41, v41, v239, v43
    v_pk_add_f32 v[160:161], v[160:161], v[162:163]
    v_cvt_pk_bf16_f32 v74, v160, v161
    v_max_f32_dpp v42, v41, v41 quad_perm:[2,3,0,1] row_mask:0xf bank_mask:0xf
    v_max_f32_dpp v41, v41, v41 quad_perm:[2,3,0,1] row_mask:0xf bank_mask:0xf
    v_cvt_pk_bf16_f32 v78, v160, v161
    s_nop 0
    v_permlane16_swap_b32 v41, v42
    v_max_f32 v41, v41, v42
    v_mov_b32 v42, v41
    s_nop 1
    v_permlane32_swap_b32 v41, v42
    v_max_f32 v242, v41, v42
    v_pk_add_f32 v[236:237], v[236:237], v[242:243] op_sel_hi:[1,0] neg_lo:[0,1] neg_hi:[0,1]
    v_pk_add_f32 v[238:239], v[238:239], v[242:243] op_sel_hi:[1,0] neg_lo:[0,1] neg_hi:[0,1]
    v_sub_f32 v43, v43, v242
    v_exp_f32 v236, v236
    v_exp_f32 v237, v237
    v_exp_f32 v238, v238
    v_exp_f32 v239, v239
    v_exp_f32 v43, v43
    v_cvt_pk_bf16_f32 v80, v236, v237
    v_cvt_pk_bf16_f32 v82, v238, v239
    v_cvt_pk_bf16_f32 v81, v43, 0
    v_cvt_pk_bf16_f32 v83, v43, 0
    s_nop 1
    v_smfmac_f32_16x16x64_bf16 v[116:119], v[80:83], v[84:91], v11
    v_smfmac_f32_16x16x64_bf16 v[120:123], v[80:83], v[48:55], v11
    v_smfmac_f32_16x16x64_bf16 v[124:127], v[80:83], v[56:63], v11
    v_smfmac_f32_16x16x64_bf16 v[128:131], v[80:83], v[64:71], v11
    v_add_f32 v116, v116, v118
    v_add_f32 v117, v117, v119
    v_smfmac_f32_16x16x64_bf16 v[132:135], v[80:83], v[72:79], v11
    v_rcp_f32 v116, v116
    v_rcp_f32 v117, v117
    v_pk_add_f32 v[120:121], v[120:121], v[122:123]
    v_pk_mul_f32 v[120:121], v[120:121], v[116:117]
    v_cvt_pk_bf16_f32 v236, v120, v121
    v_pk_add_f32 v[124:125], v[124:125], v[126:127]
    v_pk_mul_f32 v[124:125], v[124:125], v[116:117]
    v_cvt_pk_bf16_f32 v237, v124, v125
    ds_write2st64_b32 v18, v236, v237 offset0:0 offset1:1
    v_pk_add_f32 v[128:129], v[128:129], v[130:131]
    v_pk_mul_f32 v[128:129], v[128:129], v[116:117]
    v_cvt_pk_bf16_f32 v238, v128, v129
    v_pk_add_f32 v[132:133], v[132:133], v[134:135]
    v_pk_mul_f32 v[132:133], v[132:133], v[116:117]
    v_cvt_pk_bf16_f32 v239, v132, v133
    ds_write2st64_b32 v18, v238, v239 offset0:2 offset1:3
    v_cmp_u_f32 vcc, v120, v121
    v_mov_b32 v120, 0
    v_mov_b32 v121, 0
    v_mov_b32 v122, 0
    v_mov_b32 v123, 0
    v_mov_b32 v124, 0
    v_mov_b32 v125, 0
    v_mov_b32 v126, 0
    v_mov_b32 v127, 0
    v_mov_b32 v128, 0
    s_cbranch_vccnz L_sp_42
L_sg_43:
    s_waitcnt lgkmcnt(0)
    s_barrier
    ds_read_b64_tr_b16 v[80:81], v19
    ds_read_b64_tr_b16 v[82:83], v19 offset:128
    v_mov_b32 v129, 0
    v_mov_b32 v130, 0
    v_mov_b32 v131, 0
    v_mov_b32 v132, 0
    v_mov_b32 v133, 0
    v_mov_b32 v134, 0
    v_mov_b32 v135, 0
    v_mov_b32 v116, 0
    v_mov_b32 v117, 0
    v_mov_b32 v118, 0
    v_mov_b32 v119, 0
    s_waitcnt lgkmcnt(0)
    v_mfma_f32_16x16x32_bf16 v[172:175], v[80:83], v[108:111], 0
    buffer_load_dword v36, v33, s[4:7], s38 offen sc1
    s_nop 6
    v_cvt_pk_bf16_f32 v236, v172, v173
    v_cvt_pk_bf16_f32 v237, v174, v175
    v_cndmask_b32 v236, v236, v237, s[60:61]
    buffer_store_dword v236, v46, s[4:7], s41 offen sc1
    buffer_store_dword v236, v14, s[4:7], s41 offen sc1
    ds_write_b32 v47, v50 offset:8
    ds_write_b32 v47, v58 offset:6152
    ds_write_b32 v47, v66 offset:12296
    ds_write_b32 v47, v74 offset:18440
    ds_read_b128 v[204:207], v26 offset:0
    ds_read_b128 v[180:183], v29 offset:0
    ds_read_b128 v[184:187], v29 offset:1024
    ds_read_b64 v[208:209], v27 offset:0
    ds_read_b128 v[188:191], v29 offset:2048
    ds_read_b128 v[212:215], v26 offset:1536
    ds_read_b128 v[192:195], v29 offset:3072
    ds_read_b128 v[196:199], v29 offset:4096
    ds_read_b64 v[216:217], v27 offset:1536
    ds_read_b128 v[200:203], v29 offset:5120
    s_add_u32 s55, s42, 0
    buffer_store_dword v168, v46, s[4:7], s55 offen sc1
    s_add_u32 s55, s42, 8192
    buffer_store_dword v168, v46, s[4:7], s55 offen sc1
    s_waitcnt lgkmcnt(5)
    v_mfma_f32_16x16x32_bf16 v[220:223], v[180:183], v[204:207], 0
    v_mfma_f32_16x16x32_bf16 v[224:227], v[184:187], v[204:207], 0
    v_mfma_f32_16x16x32_bf16 v[224:227], v[188:191], v[208:211], v[224:227]
    ds_read_b128 v[204:207], v26 offset:3072
    ds_read_b128 v[180:183], v29 offset:6144
    ds_read_b128 v[184:187], v29 offset:7168
    ds_read_b64 v[208:209], v27 offset:3072
    ds_read_b128 v[188:191], v29 offset:8192
    s_add_u32 s56, s37, 2
    s_and_b32 s55, s56, 3
    s_mul_i32 s55, s55, 114688
    s_add_u32 s55, s55, 65536
    s_add_u32 s45, s38, s55
    s_add_u32 s46, s45, 4096
    s_add_u32 s47, s45, 8192
    s_add_u32 s56, s37, -1
    s_and_b32 s55, s56, 3
    s_mul_i32 s55, s55, 114688
    s_add_u32 s55, s55, 53248
    s_add_u32 s48, s38, s55
    s_and_b32 s55, s56, 1
    s_add_u32 s56, s56, 1
    v_mov_b32 v35, -16
    v_writelane_b32 v35, s56, 12
    s_mul_i32 s55, s55, 12288
    s_add_u32 m0, s54, s55
    s_waitcnt lgkmcnt(5)
    v_mfma_f32_16x16x32_bf16 v[220:223], v[192:195], v[212:215], v[220:223]
    v_mfma_f32_16x16x32_bf16 v[224:227], v[196:199], v[212:215], v[224:227]
    v_mfma_f32_16x16x32_bf16 v[224:227], v[200:203], v[216:219], v[224:227]
    ds_read_b128 v[212:215], v26 offset:4608
    ds_read_b128 v[192:195], v29 offset:9216
    ds_read_b128 v[196:199], v29 offset:10240
    ds_read_b64 v[216:217], v27 offset:4608
    ds_read_b128 v[200:203], v29 offset:11264
    s_waitcnt lgkmcnt(5)
    v_mfma_f32_16x16x32_bf16 v[220:223], v[180:183], v[204:207], v[220:223]
    v_mfma_f32_16x16x32_bf16 v[224:227], v[184:187], v[204:207], v[224:227]
    v_mfma_f32_16x16x32_bf16 v[224:227], v[188:191], v[208:211], v[224:227]
    s_waitcnt lgkmcnt(0)
    v_mfma_f32_16x16x32_bf16 v[220:223], v[192:195], v[212:215], v[220:223]
    v_mfma_f32_16x16x32_bf16 v[224:227], v[196:199], v[212:215], v[224:227]
    v_mfma_f32_16x16x32_bf16 v[224:227], v[200:203], v[216:219], v[224:227]
    s_waitcnt vmcnt(4)
    v_cmp_lt_i32 vcc, v36, v35
    s_cbranch_vccz L_fok_46
L_fw_45:
    buffer_load_dword v36, v33, s[4:7], s38 offen sc1
    s_sub_u32 s36, s36, 1
    s_cbranch_scc1 L_exit
    s_waitcnt vmcnt(0)
    v_cmp_lt_i32 vcc, v36, v35
    s_cbranch_vccnz L_fw_45
L_fok_46:
    buffer_load_dwordx4 v37, s[4:7], s48 offen offset:0 sc1 lds
    buffer_load_dwordx4 v37, s[4:7], s48 offen offset:1024 sc1 lds
    buffer_load_dwordx4 v37, s[4:7], s48 offen offset:2048 sc1 lds
    v_cvt_pk_bf16_f32 v220, v220, v221
    v_cvt_pk_bf16_f32 v221, v222, v223
    v_cvt_pk_bf16_f32 v222, v224, v225
    v_cvt_pk_bf16_f32 v223, v226, v227
    v_mov_b32 v224, v220
    v_mov_b32 v225, v221
    v_mov_b32_dpp v220, v222 row_ror:8 row_mask:0xf bank_mask:0xc
    v_mov_b32_dpp v221, v223 row_ror:8 row_mask:0xf bank_mask:0xc
    v_mov_b32_dpp v222, v224 row_ror:8 row_mask:0xf bank_mask:0x3
    v_mov_b32_dpp v223, v225 row_ror:8 row_mask:0xf bank_mask:0x3
    buffer_store_dwordx4 v[220:223], v15, s[4:7], s49 offen
    v_mfma_f32_16x16x32_bf16 v[148:151], a[96:99], a[0:3], 0
    s_mov_b32 s50, s42
    s_add_u32 s56, s37, 1
    v_mov_b32 v47, v24
    v_mfma_f32_16x16x32_bf16 v[152:155], a[120:123], a[0:3], 0
    s_and_b32 s55, s56, 3
    s_mul_i32 s41, s55, 327680
    s_mul_i32 s56, s55, 114688
    v_mfma_f32_16x16x32_bf16 v[156:159], a[96:99], a[24:27], 0
    s_add_u32 s43, s38, s56
    s_xor_b32 s55, s55, 2
    s_mul_i32 s42, s55, 327680
    v_mfma_f32_16x16x32_bf16 v[160:163], a[120:123], a[24:27], 0
    s_add_u32 s56, s37, 2
    v_mov_b32 v107, s56
    s_and_b32 s55, s56, 3
    v_mfma_f32_16x16x32_bf16 v[180:183], a[96:99], a[48:51], 0
    s_mul_i32 s44, s55, 24576
    s_add_u32 s56, s37, -1
    s_and_b32 s55, s56, 3
    v_mfma_f32_16x16x32_bf16 v[184:187], a[120:123], a[48:51], 0
    s_mul_i32 s55, s55, 40960
    s_add_u32 s49, s55, s38
    s_add_u32 s56, s37, -1
    v_mfma_f32_16x16x32_bf16 v[188:191], a[96:99], a[72:75], 0
    s_and_b32 s55, s56, 3
    s_mul_i32 s55, s55, 24576
    v_add_u32 v26, s55, v22
    v_mfma_f32_16x16x32_bf16 v[192:195], a[120:123], a[72:75], 0
    buffer_load_dwordx4 a[96:99], v40, s[4:7], s45 offen offset:0 sc1
    v_mfma_f32_16x16x32_bf16 v[148:151], a[100:103], a[4:7], v[148:151]
    v_add_u32 v27, s55, v23
    s_and_b32 s55, s56, 1
    s_mul_i32 s55, s55, 12288
    v_mfma_f32_16x16x32_bf16 v[152:155], a[124:127], a[4:7], v[152:155]
    buffer_load_dwordx4 a[120:123], v40, s[4:7], s46 offen offset:2048 sc1
    v_mfma_f32_16x16x32_bf16 v[156:159], a[100:103], a[28:31], v[156:159]
    v_add_u32 v29, s55, v28
    v_mfma_f32_16x16x32_bf16 v[160:163], a[124:127], a[28:31], v[160:163]
    v_mfma_f32_16x16x32_bf16 v[180:183], a[100:103], a[52:55], v[180:183]
    v_mfma_f32_16x16x32_bf16 v[184:187], a[124:127], a[52:55], v[184:187]
    v_mfma_f32_16x16x32_bf16 v[188:191], a[100:103], a[76:79], v[188:191]
    v_mfma_f32_16x16x32_bf16 v[192:195], a[124:127], a[76:79], v[192:195]
    buffer_load_dwordx4 a[100:103], v40, s[4:7], s45 offen offset:1024 sc1
    v_mfma_f32_16x16x32_bf16 v[148:151], a[104:107], a[8:11], v[148:151]
    v_mfma_f32_16x16x32_bf16 v[152:155], a[128:131], a[8:11], v[152:155]
    buffer_load_dwordx4 a[124:127], v40, s[4:7], s46 offen offset:3072 sc1
    v_mfma_f32_16x16x32_bf16 v[156:159], a[104:107], a[32:35], v[156:159]
    v_mfma_f32_16x16x32_bf16 v[160:163], a[128:131], a[32:35], v[160:163]
    v_mfma_f32_16x16x32_bf16 v[180:183], a[104:107], a[56:59], v[180:183]
    v_mfma_f32_16x16x32_bf16 v[184:187], a[128:131], a[56:59], v[184:187]
    v_mfma_f32_16x16x32_bf16 v[188:191], a[104:107], a[80:83], v[188:191]
    v_mfma_f32_16x16x32_bf16 v[192:195], a[128:131], a[80:83], v[192:195]
    buffer_load_dwordx4 a[104:107], v40, s[4:7], s45 offen offset:2048 sc1
    v_mfma_f32_16x16x32_bf16 v[148:151], a[108:111], a[12:15], v[148:151]
    v_mfma_f32_16x16x32_bf16 v[152:155], a[132:135], a[12:15], v[152:155]
    buffer_load_dwordx4 a[128:131], v40, s[4:7], s47 offen offset:0 sc1
    v_mfma_f32_16x16x32_bf16 v[156:159], a[108:111], a[36:39], v[156:159]
    v_mfma_f32_16x16x32_bf16 v[160:163], a[132:135], a[36:39], v[160:163]
    v_mfma_f32_16x16x32_bf16 v[180:183], a[108:111], a[60:63], v[180:183]
    v_mfma_f32_16x16x32_bf16 v[184:187], a[132:135], a[60:63], v[184:187]
    v_mfma_f32_16x16x32_bf16 v[188:191], a[108:111], a[84:87], v[188:191]
    v_mfma_f32_16x16x32_bf16 v[192:195], a[132:135], a[84:87], v[192:195]
    buffer_load_dwordx4 a[108:111], v40, s[4:7], s45 offen offset:3072 sc1
    v_mfma_f32_16x16x32_bf16 v[148:151], a[112:115], a[16:19], v[148:151]
    v_mfma_f32_16x16x32_bf16 v[152:155], a[136:139], a[16:19], v[152:155]
    buffer_load_dwordx4 a[132:135], v40, s[4:7], s47 offen offset:1024 sc1
    v_mfma_f32_16x16x32_bf16 v[156:159], a[112:115], a[40:43], v[156:159]
    v_mfma_f32_16x16x32_bf16 v[160:163], a[136:139], a[40:43], v[160:163]
    v_mfma_f32_16x16x32_bf16 v[180:183], a[112:115], a[64:67], v[180:183]
    v_mfma_f32_16x16x32_bf16 v[184:187], a[136:139], a[64:67], v[184:187]
    v_mfma_f32_16x16x32_bf16 v[188:191], a[112:115], a[88:91], v[188:191]
    v_mfma_f32_16x16x32_bf16 v[192:195], a[136:139], a[88:91], v[192:195]
    buffer_load_dwordx4 a[112:115], v40, s[4:7], s46 offen offset:0 sc1
    v_mfma_f32_16x16x32_bf16 v[148:151], a[116:119], a[20:23], v[148:151]
    v_mfma_f32_16x16x32_bf16 v[152:155], a[140:143], a[20:23], v[152:155]
    v_mfma_f32_16x16x32_bf16 v[156:159], a[116:119], a[44:47], v[156:159]
    v_mfma_f32_16x16x32_bf16 v[160:163], a[140:143], a[44:47], v[160:163]
    v_mfma_f32_16x16x32_bf16 v[180:183], a[116:119], a[68:71], v[180:183]
    v_mfma_f32_16x16x32_bf16 v[184:187], a[140:143], a[68:71], v[184:187]
    v_mfma_f32_16x16x32_bf16 v[188:191], a[116:119], a[92:95], v[188:191]
    v_mfma_f32_16x16x32_bf16 v[192:195], a[140:143], a[92:95], v[192:195]
    v_cvt_pk_bf16_f32 v64, v180, v181
    v_cvt_pk_bf16_f32 v65, v182, v183
    ds_write_b64 v24, v[64:65] offset:12288
    v_cvt_pk_bf16_f32 v68, v184, v185
    v_cvt_pk_bf16_f32 v69, v186, v187
    ds_write_b64 v25, v[68:69] offset:12288
    v_cvt_pk_bf16_f32 v72, v188, v189
    v_cvt_pk_bf16_f32 v73, v190, v191
    ds_write_b64 v24, v[72:73] offset:18432
    v_cvt_pk_bf16_f32 v76, v192, v193
    v_cvt_pk_bf16_f32 v77, v194, v195
    ds_write_b64 v25, v[76:77] offset:18432
    v_cvt_pk_bf16_f32 v48, v148, v149
    v_cvt_pk_bf16_f32 v49, v150, v151
    ds_write_b64 v24, v[48:49] offset:0
    v_cvt_pk_bf16_f32 v52, v152, v153
    v_cvt_pk_bf16_f32 v53, v154, v155
    ds_write_b64 v25, v[52:53] offset:0
    v_cvt_pk_bf16_f32 v56, v156, v157
    v_cvt_pk_bf16_f32 v57, v158, v159
    ds_write_b64 v24, v[56:57] offset:6144
    v_cvt_pk_bf16_f32 v60, v160, v161
    v_cvt_pk_bf16_f32 v61, v162, v163
    ds_write_b64 v25, v[60:61] offset:6144
    s_add_u32 s37, s37, 1
    s_mov_b32 m0, s53
    v_add_u32 v24, s44, v20
    v_add_u32 v25, s44, v21
    v_pk_mul_f32 v[148:149], v[210:211], v[210:211]
    v_pk_mul_f32 v[150:151], v[210:211], v[210:211]
    v_pk_mul_f32 v[152:153], v[210:211], v[210:211]
    v_pk_mul_f32 v[154:155], v[210:211], v[210:211]
    v_pk_mul_f32 v[156:157], v[210:211], v[210:211]
    v_pk_mul_f32 v[158:159], v[210:211], v[210:211]
    v_pk_mul_f32 v[160:161], v[210:211], v[210:211]
    v_pk_mul_f32 v[162:163], v[210:211], v[210:211]
    buffer_load_dwordx4 a[136:139], v40, s[4:7], s47 offen offset:2048 sc1
    buffer_load_dwordx4 a[116:119], v40, s[4:7], s46 offen offset:1024 sc1
    buffer_load_dwordx4 a[140:143], v40, s[4:7], s47 offen offset:3072 sc1
    s_branch L_wo_loop_f
L_wo_tail_f:
L_tv_47:
    buffer_load_dwordx4 v44, s[4:7], s43 offen offset:0 sc1 lds
    buffer_load_dwordx4 v44, s[4:7], s43 offen offset:1024 sc1 lds
    buffer_load_dwordx4 v44, s[4:7], s43 offen offset:2048 sc1 lds
    s_sub_u32 s36, s36, 1
    s_cbranch_scc1 L_exit
    v_add_u32 v5, s53, v12
    s_waitcnt vmcnt(0)
    ds_read_b128 v[136:139], v5 offset:0
    ds_read_b128 v[140:143], v5 offset:1024
    ds_read_b128 v[144:147], v5 offset:2048
    s_waitcnt lgkmcnt(0)
    v_max_u32 v4, v136, v137
    v_max3_u32 v4, v4, v138, v139
    v_max3_u32 v4, v4, v140, v141
    v_max3_u32 v4, v4, v142, v143
    v_max3_u32 v4, v4, v144, v145
    v_max3_u32 v4, v4, v146, v147
    v_cmp_eq_u32 vcc, -1, v4
    s_cbranch_vccnz L_tv_47
    ds_read_b64_tr_b16 v[136:137], v16 offset:0
    ds_read_b64_tr_b16 v[138:139], v13 offset:0
    ds_read_b64_tr_b16 v[140:141], v16 offset:1024
    ds_read_b64_tr_b16 v[142:143], v13 offset:1024
    ds_read_b64_tr_b16 v[144:145], v16 offset:2048
    ds_read_b64_tr_b16 v[146:147], v13 offset:2048
    v_mov_b32 v148, 0
    v_mov_b32 v149, 0
    v_mov_b32 v150, 0
    v_mov_b32 v151, 0
    v_mov_b32 v152, 0
    v_mov_b32 v153, 0
    v_mov_b32 v154, 0
    v_mov_b32 v155, 0
    v_mov_b32 v156, 0
    v_mov_b32 v157, 0
    v_mov_b32 v158, 0
    v_mov_b32 v159, 0
    v_mov_b32 v160, 0
    v_mov_b32 v161, 0
    v_mov_b32 v162, 0
    v_mov_b32 v163, 0
    s_waitcnt lgkmcnt(0)
    v_smfmac_f32_16x16x64_bf16 v[148:151], v[136:139], a[0:7], v10
    v_smfmac_f32_16x16x64_bf16 v[152:155], v[136:139], a[24:31], v10
    v_smfmac_f32_16x16x64_bf16 v[156:159], v[136:139], a[48:55], v10
    v_smfmac_f32_16x16x64_bf16 v[160:163], v[136:139], a[72:79], v10
    v_smfmac_f32_16x16x64_bf16 v[148:151], v[140:143], a[8:15], v10
    v_smfmac_f32_16x16x64_bf16 v[152:155], v[140:143], a[32:39], v10
    v_smfmac_f32_16x16x64_bf16 v[156:159], v[140:143], a[56:63], v10
    v_smfmac_f32_16x16x64_bf16 v[160:163], v[140:143], a[80:87], v10
    v_smfmac_f32_16x16x64_bf16 v[148:151], v[144:147], a[16:23], v10
    v_smfmac_f32_16x16x64_bf16 v[152:155], v[144:147], a[40:47], v10
    v_smfmac_f32_16x16x64_bf16 v[156:159], v[144:147], a[64:71], v10
    v_smfmac_f32_16x16x64_bf16 v[160:163], v[144:147], a[88:95], v10
    v_pk_add_f32 v[148:149], v[148:149], v[150:151]
    v_cvt_pk_bf16_f32 v50, v148, v149
    v_cvt_pk_bf16_f32 v54, v148, v149
    v_pk_add_f32 v[152:153], v[152:153], v[154:155]
    v_cvt_pk_bf16_f32 v58, v152, v153
    v_cvt_pk_bf16_f32 v62, v152, v153
    v_pk_add_f32 v[156:157], v[156:157], v[158:159]
    v_cvt_pk_bf16_f32 v66, v156, v157
    v_cvt_pk_bf16_f32 v70, v156, v157
    v_pk_add_f32 v[160:161], v[160:161], v[162:163]
    v_cvt_pk_bf16_f32 v74, v160, v161
    v_cvt_pk_bf16_f32 v78, v160, v161
    ds_write_b32 v47, v50 offset:8
    ds_write_b32 v47, v58 offset:6152
    ds_write_b32 v47, v66 offset:12296
    ds_write_b32 v47, v74 offset:18440
    s_add_u32 s91, s38, 81920
    buffer_load_dwordx4 v[120:123], v15, s[4:7], s91 offen sc1
    s_add_u32 s91, s38, 122880
    buffer_load_dwordx4 v[124:127], v15, s[4:7], s91 offen sc1
    s_add_u32 s56, s37, -1
    s_and_b32 s55, s56, 3
    s_mul_i32 s55, s55, 114688
    s_add_u32 s55, s55, 53248
    s_add_u32 s48, s38, s55
    s_and_b32 s55, s56, 1
    s_add_u32 s56, s56, 1
    v_mov_b32 v35, -16
    v_writelane_b32 v35, s56, 12
    s_mul_i32 s55, s55, 12288
    s_add_u32 m0, s54, s55
    buffer_load_dword v36, v33, s[4:7], s38 offen sc1
    v_mov_b32 v3, 200
L_p0_48:
    buffer_load_dword v4, v3, s[8:11], 0 offen sc1
    s_sub_u32 s36, s36, 1
    s_cbranch_scc1 L_exit
    s_waitcnt vmcnt(0)
    v_readfirstlane_b32 s90, v4
    s_nop 0
    s_cmp_eq_u32 s90, 0
    s_cbranch_scc1 L_p0_48
    s_and_b32 s90, s90, 2
    s_lshl_b32 s90, s90, 12
    v_xor_b32 v30, s90, v30
    v_xor_b32 v31, s90, v31
    s_waitcnt lgkmcnt(0)
    s_barrier
    v_cmp_lt_i32 vcc, v36, v35
    s_cbranch_vccz L_fok_50
L_fw_49:
    buffer_load_dword v36, v33, s[4:7], s38 offen sc1
    s_sub_u32 s36, s36, 1
    s_cbranch_scc1 L_exit
    s_waitcnt vmcnt(0)
    v_cmp_lt_i32 vcc, v36, v35
    s_cbranch_vccnz L_fw_49
L_fok_50:
    buffer_load_dwordx4 v37, s[4:7], s48 offen offset:0 sc1 lds
    buffer_load_dwordx4 v37, s[4:7], s48 offen offset:1024 sc1 lds
    buffer_load_dwordx4 v37, s[4:7], s48 offen offset:2048 sc1 lds
    v_mov_b32 v128, v220
    v_mov_b32 v129, v221
    v_mov_b32 v130, v222
    v_mov_b32 v131, v223
    s_add_u32 s56, s37, -2
    s_and_b32 s55, s56, 3
    s_mul_i32 s55, s55, 24576
    v_add_u32 v26, s55, v22
    v_add_u32 v27, s55, v23
    s_and_b32 s55, s56, 1
    s_mul_i32 s55, s55, 12288
    v_add_u32 v29, s55, v28
    ds_read_b128 v[204:207], v26 offset:0
    ds_read_b128 v[180:183], v29 offset:0
    ds_read_b128 v[184:187], v29 offset:1024
    ds_read_b64 v[208:209], v27 offset:0
    ds_read_b128 v[188:191], v29 offset:2048
    ds_read_b128 v[212:215], v26 offset:1536
    ds_read_b128 v[192:195], v29 offset:3072
    ds_read_b128 v[196:199], v29 offset:4096
    ds_read_b64 v[216:217], v27 offset:1536
    ds_read_b128 v[200:203], v29 offset:5120
    s_waitcnt lgkmcnt(5)
    v_mfma_f32_16x16x32_bf16 v[220:223], v[180:183], v[204:207], 0
    v_mfma_f32_16x16x32_bf16 v[224:227], v[184:187], v[204:207], 0
    v_mfma_f32_16x16x32_bf16 v[224:227], v[188:191], v[208:211], v[224:227]
    ds_read_b128 v[204:207], v26 offset:3072
    ds_read_b128 v[180:183], v29 offset:6144
    ds_read_b128 v[184:187], v29 offset:7168
    ds_read_b64 v[208:209], v27 offset:3072
    ds_read_b128 v[188:191], v29 offset:8192
    s_waitcnt lgkmcnt(5)
    v_mfma_f32_16x16x32_bf16 v[220:223], v[192:195], v[212:215], v[220:223]
    v_mfma_f32_16x16x32_bf16 v[224:227], v[196:199], v[212:215], v[224:227]
    v_mfma_f32_16x16x32_bf16 v[224:227], v[200:203], v[216:219], v[224:227]
    ds_read_b128 v[212:215], v26 offset:4608
    ds_read_b128 v[192:195], v29 offset:9216
    ds_read_b128 v[196:199], v29 offset:10240
    ds_read_b64 v[216:217], v27 offset:4608
    ds_read_b128 v[200:203], v29 offset:11264
    s_waitcnt lgkmcnt(5)
    v_mfma_f32_16x16x32_bf16 v[220:223], v[180:183], v[204:207], v[220:223]
    v_mfma_f32_16x16x32_bf16 v[224:227], v[184:187], v[204:207], v[224:227]
    v_mfma_f32_16x16x32_bf16 v[224:227], v[188:191], v[208:211], v[224:227]
    s_waitcnt lgkmcnt(0)
    v_mfma_f32_16x16x32_bf16 v[220:223], v[192:195], v[212:215], v[220:223]
    v_mfma_f32_16x16x32_bf16 v[224:227], v[196:199], v[212:215], v[224:227]
    v_mfma_f32_16x16x32_bf16 v[224:227], v[200:203], v[216:219], v[224:227]
    s_nop 0
    v_cvt_pk_bf16_f32 v220, v220, v221
    v_cvt_pk_bf16_f32 v221, v222, v223
    s_nop 4
    v_cvt_pk_bf16_f32 v222, v224, v225
    v_cvt_pk_bf16_f32 v223, v226, v227
    v_mov_b32 v224, v220
    v_mov_b32 v225, v221
    v_mov_b32_dpp v220, v222 row_ror:8 row_mask:0xf bank_mask:0xc
    v_mov_b32_dpp v221, v223 row_ror:8 row_mask:0xf bank_mask:0xc
    v_mov_b32_dpp v222, v224 row_ror:8 row_mask:0xf bank_mask:0x3
    v_mov_b32_dpp v223, v225 row_ror:8 row_mask:0xf bank_mask:0x3
    v_mov_b32 v132, v220
    v_mov_b32 v133, v221
    v_mov_b32 v134, v222
    v_mov_b32 v135, v223
    s_waitcnt vmcnt(0)
    s_barrier
    s_add_u32 s56, s37, -1
    s_and_b32 s55, s56, 3
    s_mul_i32 s55, s55, 24576
    v_add_u32 v26, s55, v22
    v_add_u32 v27, s55, v23
    s_and_b32 s55, s56, 1
    s_mul_i32 s55, s55, 12288
    v_add_u32 v29, s55, v28
    ds_read_b128 v[204:207], v26 offset:0
    ds_read_b128 v[180:183], v29 offset:0
    ds_read_b128 v[184:187], v29 offset:1024
    ds_read_b64 v[208:209], v27 offset:0
    ds_read_b128 v[188:191], v29 offset:2048
    ds_read_b128 v[212:215], v26 offset:1536
    ds_read_b128 v[192:195], v29 offset:3072
    ds_read_b128 v[196:199], v29 offset:4096
    ds_read_b64 v[216:217], v27 offset:1536
    ds_read_b128 v[200:203], v29 offset:5120
    s_waitcnt lgkmcnt(5)
    v_mfma_f32_16x16x32_bf16 v[220:223], v[180:183], v[204:207], 0
    v_mfma_f32_16x16x32_bf16 v[224:227], v[184:187], v[204:207], 0
    v_mfma_f32_16x16x32_bf16 v[224:227], v[188:191], v[208:211], v[224:227]
    ds_read_b128 v[204:207], v26 offset:3072
    ds_read_b128 v[180:183], v29 offset:6144
    ds_read_b128 v[184:187], v29 offset:7168
    ds_read_b64 v[208:209], v27 offset:3072
    ds_read_b128 v[188:191], v29 offset:8192
    s_waitcnt lgkmcnt(5)
    v_mfma_f32_16x16x32_bf16 v[220:223], v[192:195], v[212:215], v[220:223]
    v_mfma_f32_16x16x32_bf16 v[224:227], v[196:199], v[212:215], v[224:227]
    v_mfma_f32_16x16x32_bf16 v[224:227], v[200:203], v[216:219], v[224:227]
    ds_read_b128 v[212:215], v26 offset:4608
    ds_read_b128 v[192:195], v29 offset:9216
    ds_read_b128 v[196:199], v29 offset:10240
    ds_read_b64 v[216:217], v27 offset:4608
    ds_read_b128 v[200:203], v29 offset:11264
    s_waitcnt lgkmcnt(5)
    v_mfma_f32_16x16x32_bf16 v[220:223], v[180:183], v[204:207], v[220:223]
    v_mfma_f32_16x16x32_bf16 v[224:227], v[184:187], v[204:207], v[224:227]
    v_mfma_f32_16x16x32_bf16 v[224:227], v[188:191], v[208:211], v[224:227]
    s_waitcnt lgkmcnt(0)
    v_mfma_f32_16x16x32_bf16 v[220:223], v[192:195], v[212:215], v[220:223]
    v_mfma_f32_16x16x32_bf16 v[224:227], v[196:199], v[212:215], v[224:227]
    v_mfma_f32_16x16x32_bf16 v[224:227], v[200:203], v[216:219], v[224:227]
    s_nop 0
    v_cvt_pk_bf16_f32 v220, v220, v221
    v_cvt_pk_bf16_f32 v221, v222, v223
    s_nop 4
    v_cvt_pk_bf16_f32 v222, v224, v225
    v_cvt_pk_bf16_f32 v223, v226, v227
    v_mov_b32 v224, v220
    v_mov_b32 v225, v221
    v_mov_b32_dpp v220, v222 row_ror:8 row_mask:0xf bank_mask:0xc
    v_mov_b32_dpp v221, v223 row_ror:8 row_mask:0xf bank_mask:0xc
    v_mov_b32_dpp v222, v224 row_ror:8 row_mask:0xf bank_mask:0x3
    v_mov_b32_dpp v223, v225 row_ror:8 row_mask:0xf bank_mask:0x3
    v_mov_b32 v80, v220
    v_mov_b32 v81, v221
    v_mov_b32 v82, v222
    v_mov_b32 v83, v223
    s_add_u32 s56, s37, 0
    s_and_b32 s55, s56, 3
    s_mul_i32 s55, s55, 114688
    s_add_u32 s55, s55, 53248
    s_add_u32 s48, s38, s55
    s_and_b32 s55, s56, 1
    s_add_u32 s56, s56, 1
    v_mov_b32 v35, -16
    v_writelane_b32 v35, s56, 12
    s_mul_i32 s55, s55, 12288
    s_add_u32 m0, s54, s55
    s_add_u32 s56, s37, 0
    s_and_b32 s55, s56, 3
    s_mul_i32 s55, s55, 24576
    v_add_u32 v26, s55, v22
    v_add_u32 v27, s55, v23
    s_and_b32 s55, s56, 1
    s_mul_i32 s55, s55, 12288
    v_add_u32 v29, s55, v28
    buffer_load_dword v36, v33, s[4:7], s38 offen sc1
    buffer_load_dword v36, v33, s[4:7], s38 offen sc1
    buffer_load_dword v36, v33, s[4:7], s38 offen sc1
    buffer_load_dword v36, v33, s[4:7], s38 offen sc1
    buffer_load_dword v36, v33, s[4:7], s38 offen sc1
L_sp_51:
    s_waitcnt vmcnt(4)
    v_cmp_lt_i32 vcc, v36, v35
    buffer_load_dword v36, v33, s[4:7], s38 offen sc1
    s_sub_u32 s36, s36, 1
    s_cbranch_scc1 L_exit
    s_cbranch_vccz L_sp_51x
    s_waitcnt vmcnt(4)
    v_cmp_lt_i32 vcc, v36, v35
    buffer_load_dword v36, v33, s[4:7], s38 offen sc1
    s_cbranch_vccz L_sp_51x
    s_waitcnt vmcnt(4)
    v_cmp_lt_i32 vcc, v36, v35
    buffer_load_dword v36, v33, s[4:7], s38 offen sc1
    s_cbranch_vccz L_sp_51x
    s_waitcnt vmcnt(4)
    v_cmp_lt_i32 vcc, v36, v35
    buffer_load_dword v36, v33, s[4:7], s38 offen sc1
    s_cbranch_vccnz L_sp_51
L_sp_51x:
    buffer_load_dwordx4 v37, s[4:7], s48 offen offset:0 sc1 lds
    buffer_load_dwordx4 v37, s[4:7], s48 offen offset:1024 sc1 lds
    buffer_load_dwordx4 v37, s[4:7], s48 offen offset:2048 sc1 lds
    s_waitcnt vmcnt(0)
    s_barrier
    s_mov_b32 s49, 7143424
    buffer_store_dwordx4 v[120:123], v30, s[4:7], s49 offen sc1
    s_mov_b32 s49, 6815744
    buffer_store_dwordx4 v[124:127], v30, s[4:7], s49 offen sc1
    s_mov_b32 s49, 6488064
    buffer_store_dwordx4 v[128:131], v30, s[4:7], s49 offen sc1
    s_mov_b32 s49, 6160384
    buffer_store_dwordx4 v[132:135], v30, s[4:7], s49 offen sc1
    s_mov_b32 s49, 5832704
    buffer_store_dwordx4 v[80:83], v30, s[4:7], s49 offen sc1
    ds_read_b128 v[204:207], v26 offset:0
    ds_read_b128 v[180:183], v29 offset:0
    ds_read_b128 v[184:187], v29 offset:1024
    ds_read_b64 v[208:209], v27 offset:0
    ds_read_b128 v[188:191], v29 offset:2048
    ds_read_b128 v[212:215], v26 offset:1536
    ds_read_b128 v[192:195], v29 offset:3072
    ds_read_b128 v[196:199], v29 offset:4096
    ds_read_b64 v[216:217], v27 offset:1536
    ds_read_b128 v[200:203], v29 offset:5120
    s_waitcnt lgkmcnt(5)
    v_mfma_f32_16x16x32_bf16 v[220:223], v[180:183], v[204:207], 0
    v_mfma_f32_16x16x32_bf16 v[224:227], v[184:187], v[204:207], 0
    v_mfma_f32_16x16x32_bf16 v[224:227], v[188:191], v[208:211], v[224:227]
    ds_read_b128 v[204:207], v26 offset:3072
    ds_read_b128 v[180:183], v29 offset:6144
    ds_read_b128 v[184:187], v29 offset:7168
    ds_read_b64 v[208:209], v27 offset:3072
    ds_read_b128 v[188:191], v29 offset:8192
    s_waitcnt lgkmcnt(5)
    v_mfma_f32_16x16x32_bf16 v[220:223], v[192:195], v[212:215], v[220:223]
    v_mfma_f32_16x16x32_bf16 v[224:227], v[196:199], v[212:215], v[224:227]
    v_mfma_f32_16x16x32_bf16 v[224:227], v[200:203], v[216:219], v[224:227]
    ds_read_b128 v[212:215], v26 offset:4608
    ds_read_b128 v[192:195], v29 offset:9216
    ds_read_b128 v[196:199], v29 offset:10240
    ds_read_b64 v[216:217], v27 offset:4608
    ds_read_b128 v[200:203], v29 offset:11264
    s_waitcnt lgkmcnt(5)
    v_mfma_f32_16x16x32_bf16 v[220:223], v[180:183], v[204:207], v[220:223]
    v_mfma_f32_16x16x32_bf16 v[224:227], v[184:187], v[204:207], v[224:227]
    v_mfma_f32_16x16x32_bf16 v[224:227], v[188:191], v[208:211], v[224:227]
    s_waitcnt lgkmcnt(0)
    v_mfma_f32_16x16x32_bf16 v[220:223], v[192:195], v[212:215], v[220:223]
    v_mfma_f32_16x16x32_bf16 v[224:227], v[196:199], v[212:215], v[224:227]
    v_mfma_f32_16x16x32_bf16 v[224:227], v[200:203], v[216:219], v[224:227]
    s_nop 0
    v_cvt_pk_bf16_f32 v220, v220, v221
    v_cvt_pk_bf16_f32 v221, v222, v223
    s_nop 4
    v_cvt_pk_bf16_f32 v222, v224, v225
    v_cvt_pk_bf16_f32 v223, v226, v227
    v_mov_b32 v224, v220
    v_mov_b32 v225, v221
    v_mov_b32_dpp v220, v222 row_ror:8 row_mask:0xf bank_mask:0xc
    v_mov_b32_dpp v221, v223 row_ror:8 row_mask:0xf bank_mask:0xc
    v_mov_b32_dpp v222, v224 row_ror:8 row_mask:0xf bank_mask:0x3
    v_mov_b32_dpp v223, v225 row_ror:8 row_mask:0xf bank_mask:0x3
    s_mov_b32 s49, 5505024
    buffer_store_dwordx4 v[220:223], v30, s[4:7], s49 offen sc1
    s_waitcnt vmcnt(0)
L_fp_52:
    s_mov_b32 s51, 5505024
    buffer_load_dwordx4 v[96:99], v31, s[4:7], s51 offen sc1
    s_mov_b32 s51, 7143424
    buffer_load_dwordx4 v[148:151], v31, s[4:7], s51 offen sc1
    s_mov_b32 s51, 6815744
    buffer_load_dwordx4 v[152:155], v31, s[4:7], s51 offen sc1
    s_mov_b32 s51, 6488064
    buffer_load_dwordx4 v[156:159], v31, s[4:7], s51 offen sc1
    s_mov_b32 s51, 6160384
    buffer_load_dwordx4 v[160:163], v31, s[4:7], s51 offen sc1
    s_mov_b32 s51, 5832704
    buffer_load_dwordx4 v[92:95], v31, s[4:7], s51 offen sc1
    s_sub_u32 s36, s36, 1
    s_cbranch_scc1 L_exit
    s_waitcnt vmcnt(0)
L_fp_52c:
    v_mov_b32 v41, 0
    v_max3_u32 v41, v41, v96, v97
    v_max3_u32 v41, v41, v98, v99
    v_max3_u32 v41, v41, v148, v149
    v_max3_u32 v41, v41, v150, v151
    v_max3_u32 v41, v41, v152, v153
    v_max3_u32 v41, v41, v154, v155
    v_max3_u32 v41, v41, v156, v157
    v_max3_u32 v41, v41, v158, v159
    v_max3_u32 v41, v41, v160, v161
    v_max3_u32 v41, v41, v162, v163
    v_max3_u32 v41, v41, v92, v93
    v_max3_u32 v41, v41, v94, v95
    v_cmp_eq_u32 vcc, -1, v41
    s_cbranch_vccnz L_fp_52
    s_mov_b32 s52, 5160960
    v_mfma_f32_16x16x32_bf16 v[232:235], a[144:147], v[96:99], 0
    s_nop 7
    v_cndmask_b32 v234, v232, v233, s[58:59]
    v_cndmask_b32 v235, v233, v232, s[58:59]
    s_nop 1
    v_add_f32_dpp v235, v234, v235 row_ror:8 row_mask:0xf bank_mask:0xf
    v_cvt_pk_bf16_f32 v235, v235, v235
    buffer_store_short v235, v32, s[28:31], s52 offen offset:0
    s_mov_b32 s52, 4751360
    v_mfma_f32_16x16x32_bf16 v[232:235], a[144:147], v[148:151], 0
    s_nop 7
    v_cndmask_b32 v234, v232, v233, s[58:59]
    v_cndmask_b32 v235, v233, v232, s[58:59]
    s_nop 1
    v_add_f32_dpp v235, v234, v235 row_ror:8 row_mask:0xf bank_mask:0xf
    v_cvt_pk_bf16_f32 v235, v235, v235
    buffer_store_short v235, v32, s[28:31], s52 offen offset:0
    s_mov_b32 s52, 4833280
    v_mfma_f32_16x16x32_bf16 v[232:235], a[144:147], v[152:155], 0
    s_nop 7
    v_cndmask_b32 v234, v232, v233, s[58:59]
    v_cndmask_b32 v235, v233, v232, s[58:59]
    s_nop 1
    v_add_f32_dpp v235, v234, v235 row_ror:8 row_mask:0xf bank_mask:0xf
    v_cvt_pk_bf16_f32 v235, v235, v235
    buffer_store_short v235, v32, s[28:31], s52 offen offset:0
    s_mov_b32 s52, 4915200
    v_mfma_f32_16x16x32_bf16 v[232:235], a[144:147], v[156:159], 0
    s_nop 7
    v_cndmask_b32 v234, v232, v233, s[58:59]
    v_cndmask_b32 v235, v233, v232, s[58:59]
    s_nop 1
    v_add_f32_dpp v235, v234, v235 row_ror:8 row_mask:0xf bank_mask:0xf
    v_cvt_pk_bf16_f32 v235, v235, v235
    buffer_store_short v235, v32, s[28:31], s52 offen offset:0
    s_mov_b32 s52, 4997120
    v_mfma_f32_16x16x32_bf16 v[232:235], a[144:147], v[160:163], 0
    s_nop 7
    v_cndmask_b32 v234, v232, v233, s[58:59]
    v_cndmask_b32 v235, v233, v232, s[58:59]
    s_nop 1
    v_add_f32_dpp v235, v234, v235 row_ror:8 row_mask:0xf bank_mask:0xf
    v_cvt_pk_bf16_f32 v235, v235, v235
    buffer_store_short v235, v32, s[28:31], s52 offen offset:0
    s_mov_b32 s52, 5079040
    v_mfma_f32_16x16x32_bf16 v[232:235], a[144:147], v[92:95], 0
    s_nop 7
    v_cndmask_b32 v234, v232, v233, s[58:59]
    v_cndmask_b32 v235, v233, v232, s[58:59]
    s_nop 1
    v_add_f32_dpp v235, v234, v235 row_ror:8 row_mask:0xf bank_mask:0xf
    v_cvt_pk_bf16_f32 v235, v235, v235
    buffer_store_short v235, v32, s[28:31], s52 offen offset:0
    s_endpgm
L_sp_42:
    s_cmp_eq_u32 s57, s37
    s_cbranch_scc1 L_sg_43
    s_mov_b32 s57, s37
L_sp_42s:
    buffer_load_dwordx4 v[92:95], v38, s[4:7], s43 offen offset:0 sc1
    buffer_load_dwordx4 v[96:99], v38, s[4:7], s43 offen offset:1280 sc1
    buffer_load_dwordx4 v[100:103], v38, s[4:7], s43 offen offset:2560 sc1
    buffer_load_dword v104, v39, s[4:7], s43 offen offset:0 sc1
    buffer_load_dword v105, v39, s[4:7], s43 offen offset:1280 sc1
    buffer_load_dword v106, v39, s[4:7], s43 offen offset:2560 sc1
    s_sub_u32 s36, s36, 1
    s_cbranch_scc1 L_exit
    s_waitcnt vmcnt(0)
    v_max3_u32 v4, v104, v105, v106
    v_max3_u32 v4, v4, v92, v93
    v_max3_u32 v4, v4, v94, v95
    v_max3_u32 v4, v4, v96, v97
    v_max3_u32 v4, v4, v98, v99
    v_max3_u32 v4, v4, v100, v101
    v_max3_u32 v4, v4, v102, v103
    v_cmp_eq_u32 vcc, -1, v4
    s_cbranch_vccnz L_sp_42s
    v_mov_b32 v129, 0
    v_mov_b32 v130, 0
    v_mov_b32 v131, 0
    v_mov_b32 v132, 0
    v_mov_b32 v133, 0
    v_mov_b32 v134, 0
    v_mov_b32 v135, 0
    v_mov_b32 v116, 0
    v_mov_b32 v117, 0
    v_mov_b32 v118, 0
    v_mov_b32 v119, 0
L_sp_42v:
    buffer_load_dwordx4 v44, s[4:7], s43 offen offset:0 sc1 lds
    buffer_load_dwordx4 v44, s[4:7], s43 offen offset:1024 sc1 lds
    buffer_load_dwordx4 v44, s[4:7], s43 offen offset:2048 sc1 lds
    s_sub_u32 s36, s36, 1
    s_cbranch_scc1 L_exit
    v_add_u32 v5, s53, v12
    s_waitcnt vmcnt(0)
    ds_read_b128 v[136:139], v5 offset:0
    ds_read_b128 v[140:143], v5 offset:1024
    ds_read_b128 v[144:147], v5 offset:2048
    s_waitcnt lgkmcnt(0)
    v_max_u32 v4, v136, v137
    v_max3_u32 v4, v4, v138, v139
    v_max3_u32 v4, v4, v140, v141
    v_max3_u32 v4, v4, v142, v143
    v_max3_u32 v4, v4, v144, v145
    v_max3_u32 v4, v4, v146, v147
    v_cmp_eq_u32 vcc, -1, v4
    s_cbranch_vccnz L_sp_42v
    ds_read_b64_tr_b16 v[136:137], v16 offset:0
    ds_read_b64_tr_b16 v[138:139], v13 offset:0
    ds_read_b64_tr_b16 v[140:141], v16 offset:1024
    ds_read_b64_tr_b16 v[142:143], v13 offset:1024
    ds_read_b64_tr_b16 v[144:145], v16 offset:2048
    ds_read_b64_tr_b16 v[146:147], v13 offset:2048
    v_mov_b32 v148, 0
    v_mov_b32 v149, 0
    v_mov_b32 v150, 0
    v_mov_b32 v151, 0
    v_mov_b32 v152, 0
    v_mov_b32 v153, 0
    v_mov_b32 v154, 0
    v_mov_b32 v155, 0
    v_mov_b32 v156, 0
    v_mov_b32 v157, 0
    v_mov_b32 v158, 0
    v_mov_b32 v159, 0
    v_mov_b32 v160, 0
    v_mov_b32 v161, 0
    v_mov_b32 v162, 0
    v_mov_b32 v163, 0
    s_waitcnt lgkmcnt(0)
    v_smfmac_f32_16x16x64_bf16 v[148:151], v[136:139], a[0:7], v10
    v_smfmac_f32_16x16x64_bf16 v[152:155], v[136:139], a[24:31], v10
    v_smfmac_f32_16x16x64_bf16 v[156:159], v[136:139], a[48:55], v10
    v_smfmac_f32_16x16x64_bf16 v[160:163], v[136:139], a[72:79], v10
    v_smfmac_f32_16x16x64_bf16 v[148:151], v[140:143], a[8:15], v10
    v_smfmac_f32_16x16x64_bf16 v[152:155], v[140:143], a[32:39], v10
    v_smfmac_f32_16x16x64_bf16 v[156:159], v[140:143], a[56:63], v10
    v_smfmac_f32_16x16x64_bf16 v[160:163], v[140:143], a[80:87], v10
    v_smfmac_f32_16x16x64_bf16 v[148:151], v[144:147], a[16:23], v10
    v_smfmac_f32_16x16x64_bf16 v[152:155], v[144:147], a[40:47], v10
    v_smfmac_f32_16x16x64_bf16 v[156:159], v[144:147], a[64:71], v10
    v_smfmac_f32_16x16x64_bf16 v[160:163], v[144:147], a[88:95], v10
    s_nop 3
    s_branch L_sc_41
L_px_f:
    v_and_b32 v1, 15, v0
    v_lshrrev_b32 v2, 4, v0
    s_mul_i32 s90, s32, 12288
    v_lshl_add_u32 v10, v0, 4, s90
    s_mul_i32 s90, s32, 3072
    v_lshl_add_u32 v12, v0, 4, s90
    v_lshrrev_b32 v3, 2, v1
    v_lshlrev_b32 v3, 1, v3
    v_and_b32 v4, 1, v1
    v_or_b32 v3, v3, v4
    v_lshl_add_u32 v3, v2, 3, v3
    v_lshl_add_u32 v11, v3, 4, s90
    s_lshl_b32 s90, s32, 7
    v_min_u32 v3, 11, v0
    v_lshl_add_u32 v3, v3, 2, s90
    v_add_u32 v13, 458752, v3
    v_min_u32 v3, 2, v0
    v_lshl_add_u32 v3, v3, 2, s90
    v_add_u32 v14, 459264, v3
    v_add_u32 v22, 462336, v3
    s_add_u32 s90, s90, 459776
    v_mov_b32 v15, s90
    v_cmp_eq_u32 vcc, 0, v0
    v_mov_b32 v9, 2146435072
    s_nop 0
    v_cndmask_b32 v15, v9, v15, vcc
    s_nop 0
    v_mov_b32 v21, 0xd04e79ff
    s_mov_b32 s44, 0x3dd53b95
    v_lshl_add_u32 v3, v2, 2, 0
    v_cmp_le_u32 s[48:49], v3, v1
    v_lshl_add_u32 v3, v2, 2, 1
    v_cmp_le_u32 s[50:51], v3, v1
    v_lshl_add_u32 v3, v2, 2, 2
    v_cmp_le_u32 s[52:53], v3, v1
    v_lshl_add_u32 v3, v2, 2, 3
    v_cmp_le_u32 s[54:55], v3, v1
    v_mov_b32 v167, 0
    v_mov_b32 v171, 0
    v_mov_b32 v174, 0
    v_mov_b32 v175, 0
    s_mov_b32 s37, 0
    v_mov_b32 v1, 192
L_gw_54:
    buffer_load_dword v2, v1, s[8:11], 0 offen sc1
    s_sub_u32 s36, s36, 1
    s_cbranch_scc1 L_exit
    s_waitcnt vmcnt(0)
L_gw_54c:
    v_readfirstlane_b32 s90, v2
    s_nop 0
    s_cmp_eq_u32 s90, 0
    s_cbranch_scc1 L_gw_54
    s_cmp_lg_u32 s90, 1
    s_cbranch_scc1 L_slow
    s_cmp_lg_u32 s32, 0
    s_cbranch_scc1 L_xg_53
    s_lshl_b32 s92, s34, 14
    s_add_u32 s92, s92, 1966080
    s_add_u32 s93, s92, 8192
    v_lshlrev_b32 v3, 4, v0
    buffer_store_dwordx4 v[24:27], v3, s[4:7], s92 offen offset:0 sc1
    buffer_store_dwordx4 v[24:27], v3, s[4:7], s93 offen offset:0 sc1
    buffer_store_dwordx4 v[24:27], v3, s[4:7], s92 offen offset:1024 sc1
    buffer_store_dwordx4 v[24:27], v3, s[4:7], s93 offen offset:1024 sc1
    buffer_store_dwordx4 v[24:27], v3, s[4:7], s92 offen offset:2048 sc1
    buffer_store_dwordx4 v[24:27], v3, s[4:7], s93 offen offset:2048 sc1
    buffer_store_dwordx4 v[24:27], v3, s[4:7], s92 offen offset:3072 sc1
    buffer_store_dwordx4 v[24:27], v3, s[4:7], s93 offen offset:3072 sc1
    v_mov_b32 v3, 0
    s_mov_b32 s56, -1
    s_mov_b32 s57, -1
    s_mov_b32 s62, 0
    s_mov_b32 s63, 0
    s_waitcnt vmcnt(0)
L_pr_55:
    s_memtime s[58:59]
    s_waitcnt lgkmcnt(0)
    buffer_load_dword v4, v3, s[4:7], s92 offen sc1
    s_waitcnt vmcnt(0)
    s_memtime s[60:61]
    s_waitcnt lgkmcnt(0)
    s_sub_u32 s60, s60, s58
    s_min_u32 s56, s56, s60
    s_memtime s[58:59]
    s_waitcnt lgkmcnt(0)
    buffer_load_dword v4, v3, s[4:7], s93 offen sc1
    s_waitcnt vmcnt(0)
    s_memtime s[60:61]
    s_waitcnt lgkmcnt(0)
    s_sub_u32 s60, s60, s58
    s_min_u32 s57, s57, s60
    buffer_load_dword v4, v13, s[4:7], s38 offen sc1
    v_add_u32 v3, 128, v3
    s_add_u32 s62, s62, 1
    s_waitcnt vmcnt(0)
    v_cmp_eq_u32 vcc, 0, v4
    s_nop 0
    s_cmp_eq_u64 vcc, 0
    s_addc_u32 s63, s63, 0
    s_cmp_ge_u32 s63, 2
    s_cselect_b32 s62, 32, s62
    s_min_u32 s58, s56, s57
    s_max_u32 s59, s56, s57
    s_sub_u32 s59, s59, s58
    s_cmp_ge_u32 s59, 150
    s_cselect_b32 s58, s58, -1
    s_cmp_le_u32 s58, 540
    s_cselect_b32 s62, 32, s62
    s_cmp_lt_u32 s62, 32
    s_cbranch_scc1 L_pr_55
    s_cmp_lt_u32 s57, s56
    s_cselect_b32 s62, 2, 1
    s_nop 0
    v_mov_b32 v3, 460288
    v_mov_b32 v4, s62
    buffer_store_dword v4, v3, s[4:7], s38 offen
    s_cmp_lg_u32 s34, 0
    s_cbranch_scc1 L_xg_53
    v_mov_b32 v3, 200
    buffer_store_dword v4, v3, s[8:11], 0 offen sc1
L_xg_53:
    s_barrier
    s_add_u32 s41, s38, 475136
    buffer_load_dword v16, v22, s[4:7], s38 offen sc1
    buffer_load_dword v16, v22, s[4:7], s38 offen sc1
L_sp_56:
    buffer_load_dword v16, v22, s[4:7], s38 offen sc1
    s_sub_u32 s36, s36, 1
    s_cbranch_scc1 L_exit
    s_waitcnt vmcnt(2)
    v_cmp_ge_u32 vcc, s37, v16
    s_cbranch_vccnz L_sp_56
    s_add_u32 s90, s41, 49152
    buffer_load_dwordx4 v[72:75], v10, s[4:7], s90 offen offset:0 sc1
    buffer_load_dwordx4 v[76:79], v10, s[4:7], s90 offen offset:1024 sc1
    buffer_load_dwordx4 v[80:83], v10, s[4:7], s90 offen offset:2048 sc1
    buffer_load_dwordx4 v[84:87], v10, s[4:7], s90 offen offset:3072 sc1
    s_add_u32 s90, s41, 53248
    buffer_load_dwordx4 v[88:91], v10, s[4:7], s90 offen offset:0 sc1
    buffer_load_dwordx4 v[92:95], v10, s[4:7], s90 offen offset:1024 sc1
    buffer_load_dwordx4 v[96:99], v10, s[4:7], s90 offen offset:2048 sc1
    buffer_load_dwordx4 v[100:103], v10, s[4:7], s90 offen offset:3072 sc1
    s_add_u32 s90, s41, 57344
    buffer_load_dwordx4 v[104:107], v10, s[4:7], s90 offen offset:0 sc1
    buffer_load_dwordx4 v[108:111], v10, s[4:7], s90 offen offset:1024 sc1
    buffer_load_dwordx4 v[112:115], v10, s[4:7], s90 offen offset:2048 sc1
    buffer_load_dwordx4 v[116:119], v10, s[4:7], s90 offen offset:3072 sc1
    s_add_u32 s90, s41, 0
    buffer_load_dwordx4 v[24:27], v10, s[4:7], s90 offen offset:0 sc1
    buffer_load_dwordx4 v[28:31], v10, s[4:7], s90 offen offset:1024 sc1
    buffer_load_dwordx4 v[32:35], v10, s[4:7], s90 offen offset:2048 sc1
    buffer_load_dwordx4 v[36:39], v10, s[4:7], s90 offen offset:3072 sc1
    s_add_u32 s90, s41, 4096
    buffer_load_dwordx4 v[40:43], v10, s[4:7], s90 offen offset:0 sc1
    buffer_load_dwordx4 v[44:47], v10, s[4:7], s90 offen offset:1024 sc1
    buffer_load_dwordx4 v[48:51], v10, s[4:7], s90 offen offset:2048 sc1
    buffer_load_dwordx4 v[52:55], v10, s[4:7], s90 offen offset:3072 sc1
    s_add_u32 s90, s41, 8192
    buffer_load_dwordx4 v[56:59], v10, s[4:7], s90 offen offset:0 sc1
    buffer_load_dwordx4 v[60:63], v10, s[4:7], s90 offen offset:1024 sc1
    buffer_load_dwordx4 v[64:67], v10, s[4:7], s90 offen offset:2048 sc1
    buffer_load_dwordx4 v[68:71], v10, s[4:7], s90 offen offset:3072 sc1
    s_waitcnt vmcnt(0)
L_px_loop_f:
    s_and_b32 s90, s37, 3
    s_mul_i32 s91, s90, 114688
    s_add_u32 s91, s91, s38
    s_add_u32 s42, s91, 40960
    s_add_u32 s43, s91, 53248
    s_add_u32 s90, s37, 1
    v_mov_b32 v17, s90
    s_and_b32 s90, s90, 3
    s_mul_i32 s91, s90, 98304
    s_add_u32 s91, s91, 475136
    s_add_u32 s41, s38, s91
    v_mfma_f32_16x16x32_bf16 v[144:147], v[72:75], v[24:27], 0
    v_mfma_f32_16x16x32_bf16 v[152:155], v[72:75], v[48:51], 0
    v_mfma_f32_16x16x32_bf16 v[156:159], v[96:99], v[48:51], 0
    v_mfma_f32_16x16x32_bf16 v[144:147], v[76:79], v[28:31], v[144:147]
    v_mfma_f32_16x16x32_bf16 v[152:155], v[76:79], v[52:55], v[152:155]
    v_mfma_f32_16x16x32_bf16 v[156:159], v[100:103], v[52:55], v[156:159]
    v_mfma_f32_16x16x32_bf16 v[144:147], v[80:83], v[32:35], v[144:147]
    v_mfma_f32_16x16x32_bf16 v[152:155], v[80:83], v[56:59], v[152:155]
    v_mfma_f32_16x16x32_bf16 v[156:159], v[104:107], v[56:59], v[156:159]
    v_mfma_f32_16x16x32_bf16 v[144:147], v[84:87], v[36:39], v[144:147]
    v_mfma_f32_16x16x32_bf16 v[152:155], v[84:87], v[60:63], v[152:155]
    v_mfma_f32_16x16x32_bf16 v[156:159], v[108:111], v[60:63], v[156:159]
    v_mfma_f32_16x16x32_bf16 v[144:147], v[88:91], v[40:43], v[144:147]
    v_mfma_f32_16x16x32_bf16 v[152:155], v[88:91], v[64:67], v[152:155]
    v_mfma_f32_16x16x32_bf16 v[156:159], v[112:115], v[64:67], v[156:159]
    v_mfma_f32_16x16x32_bf16 v[144:147], v[92:95], v[44:47], v[144:147]
    v_mfma_f32_16x16x32_bf16 v[152:155], v[92:95], v[68:71], v[152:155]
    v_mfma_f32_16x16x32_bf16 v[156:159], v[116:119], v[68:71], v[156:159]
    s_nop 0
    v_cndmask_b32 v144, v21, v144, s[48:49]
    v_cndmask_b32 v145, v21, v145, s[50:51]
    v_cndmask_b32 v146, v21, v146, s[52:53]
    v_cndmask_b32 v147, v21, v147, s[54:55]
    s_nop 2
    v_cndmask_b32 v156, v21, v156, s[48:49]
    v_cndmask_b32 v157, v21, v157, s[50:51]
    v_cndmask_b32 v158, v21, v158, s[52:53]
    v_cndmask_b32 v159, v21, v159, s[54:55]
    buffer_load_dword v16, v14, s[4:7], s38 offen sc1
    buffer_load_dword v16, v14, s[4:7], s38 offen sc1
L_sp_57:
    buffer_load_dword v16, v14, s[4:7], s38 offen sc1
    s_sub_u32 s36, s36, 1
    s_cbranch_scc1 L_exit
    s_waitcnt vmcnt(2)
    v_cmp_ge_u32 vcc, s37, v16
    s_cbranch_vccnz L_sp_57
    buffer_load_dwordx4 v[120:123], v11, s[4:7], s42 offen offset:0 sc1
    buffer_load_dwordx4 v[124:127], v11, s[4:7], s42 offen offset:512 sc1
    buffer_load_dwordx4 v[128:131], v11, s[4:7], s42 offen offset:1024 sc1
    buffer_load_dwordx4 v[132:135], v11, s[4:7], s42 offen offset:1536 sc1
    buffer_load_dwordx4 v[136:139], v11, s[4:7], s42 offen offset:2048 sc1
    buffer_load_dwordx4 v[140:143], v11, s[4:7], s42 offen offset:2560 sc1
    s_waitcnt vmcnt(5)
    v_mfma_f32_16x16x32_bf16 v[148:151], v[120:123], v[24:27], 0
    v_mfma_f32_16x16x32_bf16 v[160:163], v[120:123], v[48:51], 0
    s_waitcnt vmcnt(4)
    v_mfma_f32_16x16x32_bf16 v[148:151], v[124:127], v[28:31], v[148:151]
    v_mfma_f32_16x16x32_bf16 v[160:163], v[124:127], v[52:55], v[160:163]
    s_waitcnt vmcnt(3)
    v_mfma_f32_16x16x32_bf16 v[148:151], v[128:131], v[32:35], v[148:151]
    v_mfma_f32_16x16x32_bf16 v[160:163], v[128:131], v[56:59], v[160:163]
    s_waitcnt vmcnt(2)
    v_mfma_f32_16x16x32_bf16 v[148:151], v[132:135], v[36:39], v[148:151]
    v_mfma_f32_16x16x32_bf16 v[160:163], v[132:135], v[60:63], v[160:163]
    s_waitcnt vmcnt(1)
    v_mfma_f32_16x16x32_bf16 v[148:151], v[136:139], v[40:43], v[148:151]
    v_mfma_f32_16x16x32_bf16 v[160:163], v[136:139], v[64:67], v[160:163]
    s_waitcnt vmcnt(0)
    v_mfma_f32_16x16x32_bf16 v[148:151], v[140:143], v[44:47], v[148:151]
    v_mfma_f32_16x16x32_bf16 v[160:163], v[140:143], v[68:71], v[160:163]
    s_cmp_eq_u32 s37, 63
    s_nop 2
    s_cbranch_scc1 L_pxl_58
    s_add_u32 s90, s41, 49152
    v_max_f32 v18, v144, v145
    v_max3_f32 v18, v18, v146, v147
    v_max3_f32 v18, v18, v148, v149
    v_mov_b32 v19, v18
    buffer_load_dwordx4 v[72:75], v10, s[4:7], s90 offen offset:0 sc1
    s_nop 0
    v_permlane16_swap_b32 v18, v19
    v_max_f32 v18, v18, v19
    v_mov_b32 v19, v18
    s_nop 1
    v_permlane32_swap_b32 v18, v19
    buffer_load_dwordx4 v[76:79], v10, s[4:7], s90 offen offset:1024 sc1
    v_max_f32 v18, v18, v19
    v_sub_f32 v144, v144, v18
    v_sub_f32 v145, v145, v18
    v_sub_f32 v146, v146, v18
    buffer_load_dwordx4 v[80:83], v10, s[4:7], s90 offen offset:2048 sc1
    v_sub_f32 v147, v147, v18
    v_sub_f32 v148, v148, v18
    v_sub_f32 v149, v149, v18
    v_mul_f32 v144, s44, v144
    buffer_load_dwordx4 v[84:87], v10, s[4:7], s90 offen offset:3072 sc1
    v_mul_f32 v145, s44, v145
    v_mul_f32 v146, s44, v146
    v_mul_f32 v147, s44, v147
    v_mul_f32 v148, s44, v148
    s_add_u32 s90, s41, 53248
    v_mul_f32 v149, s44, v149
    v_exp_f32 v144, v144
    v_exp_f32 v145, v145
    v_exp_f32 v146, v146
    buffer_load_dwordx4 v[88:91], v10, s[4:7], s90 offen offset:0 sc1
    v_exp_f32 v147, v147
    v_exp_f32 v148, v148
    v_exp_f32 v149, v149
    v_add_f32 v20, v144, v145
    buffer_load_dwordx4 v[92:95], v10, s[4:7], s90 offen offset:1024 sc1
    v_add_f32 v20, v20, v146
    v_add_f32 v20, v20, v147
    v_add_f32 v20, v20, v148
    v_add_f32 v20, v20, v149
    buffer_load_dwordx4 v[96:99], v10, s[4:7], s90 offen offset:2048 sc1
    v_mov_b32 v19, v20
    s_nop 1
    v_permlane16_swap_b32 v20, v19
    v_add_f32 v20, v20, v19
    v_mov_b32 v19, v20
    buffer_load_dwordx4 v[100:103], v10, s[4:7], s90 offen offset:3072 sc1
    s_nop 0
    v_permlane32_swap_b32 v20, v19
    v_add_f32 v20, v20, v19
    v_rcp_f32 v20, v20
    s_nop 0
    v_mul_f32 v144, v144, v20
    s_add_u32 s90, s41, 57344
    v_mul_f32 v145, v145, v20
    v_mul_f32 v146, v146, v20
    v_mul_f32 v147, v147, v20
    v_mul_f32 v148, v148, v20
    buffer_load_dwordx4 v[104:107], v10, s[4:7], s90 offen offset:0 sc1
    v_mul_f32 v149, v149, v20
    v_cvt_pk_bf16_f32 v164, v144, v145
    v_cvt_pk_bf16_f32 v165, v146, v147
    v_cvt_pk_bf16_f32 v166, v148, v149
    buffer_load_dwordx4 v[108:111], v10, s[4:7], s90 offen offset:1024 sc1
    v_max_f32 v18, v152, v153
    v_max3_f32 v18, v18, v154, v155
    v_max3_f32 v18, v18, v160, v161
    v_max3_f32 v18, v18, v156, v157
    buffer_load_dwordx4 v[112:115], v10, s[4:7], s90 offen offset:2048 sc1
    v_max3_f32 v18, v18, v158, v159
    v_mov_b32 v19, v18
    s_nop 1
    v_permlane16_swap_b32 v18, v19
    v_max_f32 v18, v18, v19
    buffer_load_dwordx4 v[116:119], v10, s[4:7], s90 offen offset:3072 sc1
    v_mov_b32 v19, v18
    s_nop 1
    v_permlane32_swap_b32 v18, v19
    v_max_f32 v18, v18, v19
    v_sub_f32 v152, v152, v18
    s_add_u32 s90, s41, 0
    v_sub_f32 v153, v153, v18
    v_sub_f32 v154, v154, v18
    v_sub_f32 v155, v155, v18
    v_sub_f32 v160, v160, v18
    buffer_load_dwordx4 v[24:27], v10, s[4:7], s90 offen offset:0 sc1
    v_sub_f32 v161, v161, v18
    v_sub_f32 v156, v156, v18
    v_sub_f32 v157, v157, v18
    v_sub_f32 v158, v158, v18
    buffer_load_dwordx4 v[28:31], v10, s[4:7], s90 offen offset:1024 sc1
    v_sub_f32 v159, v159, v18
    v_mul_f32 v152, s44, v152
    v_mul_f32 v153, s44, v153
    v_mul_f32 v154, s44, v154
    buffer_load_dwordx4 v[32:35], v10, s[4:7], s90 offen offset:2048 sc1
    v_mul_f32 v155, s44, v155
    v_mul_f32 v160, s44, v160
    v_mul_f32 v161, s44, v161
    v_mul_f32 v156, s44, v156
    buffer_load_dwordx4 v[36:39], v10, s[4:7], s90 offen offset:3072 sc1
    v_mul_f32 v157, s44, v157
    v_mul_f32 v158, s44, v158
    v_mul_f32 v159, s44, v159
    v_exp_f32 v152, v152
    s_add_u32 s90, s41, 4096
    v_exp_f32 v153, v153
    v_exp_f32 v154, v154
    v_exp_f32 v155, v155
    v_exp_f32 v160, v160
    buffer_load_dwordx4 v[40:43], v10, s[4:7], s90 offen offset:0 sc1
    v_exp_f32 v161, v161
    v_exp_f32 v156, v156
    v_exp_f32 v157, v157
    v_exp_f32 v158, v158
    buffer_load_dwordx4 v[44:47], v10, s[4:7], s90 offen offset:1024 sc1
    v_exp_f32 v159, v159
    v_add_f32 v20, v152, v153
    v_add_f32 v20, v20, v154
    v_add_f32 v20, v20, v155
    buffer_load_dwordx4 v[48:51], v10, s[4:7], s90 offen offset:2048 sc1
    v_add_f32 v20, v20, v160
    v_add_f32 v20, v20, v161
    v_add_f32 v20, v20, v156
    v_add_f32 v20, v20, v157
    buffer_load_dwordx4 v[52:55], v10, s[4:7], s90 offen offset:3072 sc1
    v_add_f32 v20, v20, v158
    v_add_f32 v20, v20, v159
    v_mov_b32 v19, v20
    s_nop 1
    v_permlane16_swap_b32 v20, v19
    s_add_u32 s90, s41, 8192
    v_add_f32 v20, v20, v19
    v_mov_b32 v19, v20
    s_nop 1
    v_permlane32_swap_b32 v20, v19
    v_add_f32 v20, v20, v19
    buffer_load_dwordx4 v[56:59], v10, s[4:7], s90 offen offset:0 sc1
    v_rcp_f32 v20, v20
    s_nop 0
    v_mul_f32 v152, v152, v20
    v_mul_f32 v153, v153, v20
    v_mul_f32 v154, v154, v20
    buffer_load_dwordx4 v[60:63], v10, s[4:7], s90 offen offset:1024 sc1
    v_mul_f32 v155, v155, v20
    v_mul_f32 v160, v160, v20
    v_mul_f32 v161, v161, v20
    v_mul_f32 v156, v156, v20
    buffer_load_dwordx4 v[64:67], v10, s[4:7], s90 offen offset:2048 sc1
    v_mul_f32 v157, v157, v20
    v_mul_f32 v158, v158, v20
    v_mul_f32 v159, v159, v20
    v_cvt_pk_bf16_f32 v168, v152, v153
    buffer_load_dwordx4 v[68:71], v10, s[4:7], s90 offen offset:3072 sc1
    v_cvt_pk_bf16_f32 v169, v154, v155
    v_cvt_pk_bf16_f32 v170, v160, v161
    v_cvt_pk_bf16_f32 v172, v156, v157
    v_cvt_pk_bf16_f32 v173, v158, v159
    buffer_store_dwordx4 v[164:167], v12, s[4:7], s43 offen offset:0
    buffer_store_dwordx4 v[168:171], v12, s[4:7], s43 offen offset:1024
    buffer_store_dwordx4 v[172:175], v12, s[4:7], s43 offen offset:2048
    s_waitcnt vmcnt(0)
    buffer_store_dword v17, v15, s[4:7], s38 offen
    s_add_u32 s37, s37, 1
    s_branch L_px_loop_f
L_pxl_58:
    v_max_f32 v18, v144, v145
    v_max3_f32 v18, v18, v146, v147
    v_max3_f32 v18, v18, v148, v149
    v_mov_b32 v19, v18
    s_nop 1
    v_permlane16_swap_b32 v18, v19
    v_max_f32 v18, v18, v19
    v_mov_b32 v19, v18
    s_nop 1
    v_permlane32_swap_b32 v18, v19
    v_max_f32 v18, v18, v19
    v_sub_f32 v144, v144, v18
    v_sub_f32 v145, v145, v18
    v_sub_f32 v146, v146, v18
    v_sub_f32 v147, v147, v18
    v_sub_f32 v148, v148, v18
    v_sub_f32 v149, v149, v18
    v_mul_f32 v144, s44, v144
    v_mul_f32 v145, s44, v145
    v_mul_f32 v146, s44, v146
    v_mul_f32 v147, s44, v147
    v_mul_f32 v148, s44, v148
    v_mul_f32 v149, s44, v149
    v_exp_f32 v144, v144
    v_exp_f32 v145, v145
    v_exp_f32 v146, v146
    v_exp_f32 v147, v147
    v_exp_f32 v148, v148
    v_exp_f32 v149, v149
    v_add_f32 v20, v144, v145
    v_add_f32 v20, v20, v146
    v_add_f32 v20, v20, v147
    v_add_f32 v20, v20, v148
    v_add_f32 v20, v20, v149
    v_mov_b32 v19, v20
    s_nop 1
    v_permlane16_swap_b32 v20, v19
    v_add_f32 v20, v20, v19
    v_mov_b32 v19, v20
    s_nop 1
    v_permlane32_swap_b32 v20, v19
    v_add_f32 v20, v20, v19
    v_rcp_f32 v20, v20
    s_nop 0
    v_mul_f32 v144, v144, v20
    v_mul_f32 v145, v145, v20
    v_mul_f32 v146, v146, v20
    v_mul_f32 v147, v147, v20
    v_mul_f32 v148, v148, v20
    v_mul_f32 v149, v149, v20
    v_cvt_pk_bf16_f32 v164, v144, v145
    v_cvt_pk_bf16_f32 v165, v146, v147
    v_cvt_pk_bf16_f32 v166, v148, v149
    v_max_f32 v18, v152, v153
    v_max3_f32 v18, v18, v154, v155
    v_max3_f32 v18, v18, v160, v161
    v_max3_f32 v18, v18, v156, v157
    v_max3_f32 v18, v18, v158, v159
    v_mov_b32 v19, v18
    s_nop 1
    v_permlane16_swap_b32 v18, v19
    v_max_f32 v18, v18, v19
    v_mov_b32 v19, v18
    s_nop 1
    v_permlane32_swap_b32 v18, v19
    v_max_f32 v18, v18, v19
    v_sub_f32 v152, v152, v18
    v_sub_f32 v153, v153, v18
    v_sub_f32 v154, v154, v18
    v_sub_f32 v155, v155, v18
    v_sub_f32 v160, v160, v18
    v_sub_f32 v161, v161, v18
    v_sub_f32 v156, v156, v18
    v_sub_f32 v157, v157, v18
    v_sub_f32 v158, v158, v18
    v_sub_f32 v159, v159, v18
    v_mul_f32 v152, s44, v152
    v_mul_f32 v153, s44, v153
    v_mul_f32 v154, s44, v154
    v_mul_f32 v155, s44, v155
    v_mul_f32 v160, s44, v160
    v_mul_f32 v161, s44, v161
    v_mul_f32 v156, s44, v156
    v_mul_f32 v157, s44, v157
    v_mul_f32 v158, s44, v158
    v_mul_f32 v159, s44, v159
    v_exp_f32 v152, v152
    v_exp_f32 v153, v153
    v_exp_f32 v154, v154
    v_exp_f32 v155, v155
    v_exp_f32 v160, v160
    v_exp_f32 v161, v161
    v_exp_f32 v156, v156
    v_exp_f32 v157, v157
    v_exp_f32 v158, v158
    v_exp_f32 v159, v159
    v_add_f32 v20, v152, v153
    v_add_f32 v20, v20, v154
    v_add_f32 v20, v20, v155
    v_add_f32 v20, v20, v160
    v_add_f32 v20, v20, v161
    v_add_f32 v20, v20, v156
    v_add_f32 v20, v20, v157
    v_add_f32 v20, v20, v158
    v_add_f32 v20, v20, v159
    v_mov_b32 v19, v20
    s_nop 1
    v_permlane16_swap_b32 v20, v19
    v_add_f32 v20, v20, v19
    v_mov_b32 v19, v20
    s_nop 1
    v_permlane32_swap_b32 v20, v19
    v_add_f32 v20, v20, v19
    v_rcp_f32 v20, v20
    s_nop 0
    v_mul_f32 v152, v152, v20
    v_mul_f32 v153, v153, v20
    v_mul_f32 v154, v154, v20
    v_mul_f32 v155, v155, v20
    v_mul_f32 v160, v160, v20
    v_mul_f32 v161, v161, v20
    v_mul_f32 v156, v156, v20
    v_mul_f32 v157, v157, v20
    v_mul_f32 v158, v158, v20
    v_mul_f32 v159, v159, v20
    v_cvt_pk_bf16_f32 v168, v152, v153
    v_cvt_pk_bf16_f32 v169, v154, v155
    v_cvt_pk_bf16_f32 v170, v160, v161
    v_cvt_pk_bf16_f32 v172, v156, v157
    v_cvt_pk_bf16_f32 v173, v158, v159
    buffer_store_dwordx4 v[164:167], v12, s[4:7], s43 offen offset:0
    buffer_store_dwordx4 v[168:171], v12, s[4:7], s43 offen offset:1024
    buffer_store_dwordx4 v[172:175], v12, s[4:7], s43 offen offset:2048
    s_waitcnt vmcnt(0)
    buffer_store_dword v17, v15, s[4:7], s38 offen
    s_endpgm
L_pa_f:
    s_mov_b32 s24, s70
    s_and_b32 s25, s71, 0xffff
    s_mov_b32 s26, 2621440
    s_mov_b32 s27, 0x20000
    s_sub_u32 s93, s35, 29
    s_lshl_b32 s93, s93, 2
    s_add_u32 s93, s93, s32
    s_lshl_b32 s93, s93, 11
    v_lshl_add_u32 v4, v0, 4, s93
    v_mov_b32 v1, 192
L_gw_59:
    buffer_load_dword v2, v1, s[8:11], 0 offen sc1
    s_sub_u32 s36, s36, 1
    s_cbranch_scc1 L_exit
    s_waitcnt vmcnt(0)
L_gw_59c:
    v_readfirstlane_b32 s90, v2
    s_nop 0
    s_cmp_eq_u32 s90, 0
    s_cbranch_scc1 L_gw_59
    s_cmp_lg_u32 s90, 1
    s_cbranch_scc1 L_slow
    s_mov_b32 s92, 0
L_tch_60:
    s_add_u32 s91, s92, s38
    buffer_load_dwordx4 v[248:251], v4, s[4:7], s91 offen
    buffer_load_dwordx4 v[248:251], v4, s[4:7], s91 offen offset:1024
    s_add_u32 s92, s92, 24576
    s_waitcnt vmcnt(24)
    s_cmp_lt_u32 s92, 475136
    s_cbranch_scc1 L_tch_60
    s_mov_b32 s92, 81920
L_tch_61:
    s_add_u32 s91, s92, 0
    buffer_load_dwordx4 v[248:251], v4, s[24:27], s91 offen
    buffer_load_dwordx4 v[248:251], v4, s[24:27], s91 offen offset:1024
    s_add_u32 s92, s92, 24576
    s_waitcnt vmcnt(24)
    s_cmp_lt_u32 s92, 245760
    s_cbranch_scc1 L_tch_61
    s_mov_b32 s92, 475136
L_tch_62:
    s_add_u32 s91, s92, s38
    buffer_load_dwordx4 v[248:251], v4, s[4:7], s91 offen
    buffer_load_dwordx4 v[248:251], v4, s[4:7], s91 offen offset:1024
    s_add_u32 s92, s92, 24576
    s_waitcnt vmcnt(24)
    s_cmp_lt_u32 s92, 1048576
    s_cbranch_scc1 L_tch_62
    s_waitcnt vmcnt(0)
    s_branch L_pa_body
L_pa_body:
    s_sub_u32 s90, s35, 29
    s_cmp_ge_u32 s90, 3
    s_cbranch_scc1 L_pa_end
    s_mul_i32 s52, s90, 3
    s_add_u32 s52, s52, s34
    s_and_b32 s52, s52, 7
    s_cmp_eq_u32 s90, 0
    s_cselect_b32 s91, 0x76543210, 0
    s_cmp_eq_u32 s90, 1
    s_cselect_b32 s91, 0x54c321b0, s91
    s_cmp_eq_u32 s90, 2
    s_cselect_b32 s91, 0xf9ea87d6, s91
    s_lshl_b32 s92, s34, 2
    s_lshr_b32 s91, s91, s92
    s_and_b32 s91, s91, 15
    s_min_u32 s90, s90, 1
    s_lshl_b32 s90, s90, 3
    s_add_u32 s54, s90, s91
    s_mul_i32 s40, s54, 112
    s_lshl_b32 s90, s32, 5
    s_add_u32 s40, s40, s90
    s_sub_u32 s40, s40, 16
    s_mov_b32 s12, s64
    s_and_b32 s13, s65, 0xffff
    s_mov_b32 s14, 2621440
    s_mov_b32 s15, 0x20000
    s_mov_b32 s16, s66
    s_and_b32 s17, s67, 0xffff
    s_mov_b32 s18, 2457600
    s_mov_b32 s19, 0x20000
    s_mov_b32 s20, s68
    s_and_b32 s21, s69, 0xffff
    s_mov_b32 s22, 819200
    s_mov_b32 s23, 0x20000
    v_and_b32 v1, 15, v0
    v_lshrrev_b32 v2, 4, v0
    s_add_u32 s90, s40, 0
    v_add_u32 v3, s90, v1
    v_cmp_gt_u32 vcc, 2048, v3
    v_mul_u32_u24 v3, 1280, v3
    v_lshl_add_u32 v3, v2, 4, v3
    v_mov_b32 v4, 2146435072
    v_cndmask_b32 v3, v4, v3, vcc
    buffer_load_dwordx4 a[0:3], v3, s[12:15], 0 offen offset:0
    buffer_load_dwordx4 a[4:7], v3, s[12:15], 0 offen offset:64
    buffer_load_dwordx4 a[8:11], v3, s[12:15], 0 offen offset:128
    buffer_load_dwordx4 a[12:15], v3, s[12:15], 0 offen offset:192
    buffer_load_dwordx4 a[16:19], v3, s[12:15], 0 offen offset:256
    buffer_load_dwordx4 a[20:23], v3, s[12:15], 0 offen offset:320
    buffer_load_dwordx4 a[24:27], v3, s[12:15], 0 offen offset:384
    buffer_load_dwordx4 a[28:31], v3, s[12:15], 0 offen offset:448
    buffer_load_dwordx4 a[32:35], v3, s[12:15], 0 offen offset:512
    buffer_load_dwordx4 a[36:39], v3, s[12:15], 0 offen offset:576
    buffer_load_dwordx4 a[40:43], v3, s[12:15], 0 offen offset:640
    buffer_load_dwordx4 a[44:47], v3, s[12:15], 0 offen offset:704
    buffer_load_dwordx4 a[48:51], v3, s[12:15], 0 offen offset:768
    buffer_load_dwordx4 a[52:55], v3, s[12:15], 0 offen offset:832
    buffer_load_dwordx4 a[56:59], v3, s[12:15], 0 offen offset:896
    buffer_load_dwordx4 a[60:63], v3, s[12:15], 0 offen offset:960
    buffer_load_dwordx4 a[64:67], v3, s[12:15], 0 offen offset:1024
    buffer_load_dwordx4 a[68:71], v3, s[12:15], 0 offen offset:1088
    buffer_load_dwordx4 a[72:75], v3, s[12:15], 0 offen offset:1152
    buffer_load_dwordx4 a[76:79], v3, s[12:15], 0 offen offset:1216
    s_add_u32 s90, s40, 16
    v_add_u32 v3, s90, v1
    v_cmp_gt_u32 vcc, 2048, v3
    v_mul_u32_u24 v3, 1280, v3
    v_lshl_add_u32 v3, v2, 4, v3
    v_mov_b32 v4, 2146435072
    v_cndmask_b32 v3, v4, v3, vcc
    buffer_load_dwordx4 a[80:83], v3, s[12:15], 0 offen offset:0
    buffer_load_dwordx4 a[84:87], v3, s[12:15], 0 offen offset:64
    buffer_load_dwordx4 a[88:91], v3, s[12:15], 0 offen offset:128
    buffer_load_dwordx4 a[92:95], v3, s[12:15], 0 offen offset:192
    buffer_load_dwordx4 a[96:99], v3, s[12:15], 0 offen offset:256
    buffer_load_dwordx4 a[100:103], v3, s[12:15], 0 offen offset:320
    buffer_load_dwordx4 a[104:107], v3, s[12:15], 0 offen offset:384
    buffer_load_dwordx4 a[108:111], v3, s[12:15], 0 offen offset:448
    buffer_load_dwordx4 a[112:115], v3, s[12:15], 0 offen offset:512
    buffer_load_dwordx4 a[116:119], v3, s[12:15], 0 offen offset:576
    buffer_load_dwordx4 a[120:123], v3, s[12:15], 0 offen offset:640
    buffer_load_dwordx4 a[124:127], v3, s[12:15], 0 offen offset:704
    buffer_load_dwordx4 a[128:131], v3, s[12:15], 0 offen offset:768
    buffer_load_dwordx4 a[132:135], v3, s[12:15], 0 offen offset:832
    buffer_load_dwordx4 a[136:139], v3, s[12:15], 0 offen offset:896
    buffer_load_dwordx4 a[140:143], v3, s[12:15], 0 offen offset:960
    buffer_load_dwordx4 a[144:147], v3, s[12:15], 0 offen offset:1024
    buffer_load_dwordx4 a[148:151], v3, s[12:15], 0 offen offset:1088
    buffer_load_dwordx4 a[152:155], v3, s[12:15], 0 offen offset:1152
    buffer_load_dwordx4 a[156:159], v3, s[12:15], 0 offen offset:1216
    v_add_u32 v3, 0, v0
    v_mul_u32_u24 v4, 6554, v3
    v_lshrrev_b32 v4, 16, v4
    v_mul_u32_u24 v5, 10, v4
    v_sub_u32 v5, v3, v5
    v_and_b32 v6, 19, v4
    v_and_b32 v7, 4, v4
    v_lshl_or_b32 v6, v7, 1, v6
    v_and_b32 v7, 8, v4
    v_lshrrev_b32 v7, 1, v7
    v_or_b32 v6, v6, v7
    s_lshl_b32 s90, s32, 5
    v_add_u32 v6, s90, v6
    v_mul_u32_u24 v6, 3840, v6
    v_lshl_add_u32 v10, v5, 4, v6
    v_add_u32 v3, 64, v0
    v_mul_u32_u24 v4, 6554, v3
    v_lshrrev_b32 v4, 16, v4
    v_mul_u32_u24 v5, 10, v4
    v_sub_u32 v5, v3, v5
    v_and_b32 v6, 19, v4
    v_and_b32 v7, 4, v4
    v_lshl_or_b32 v6, v7, 1, v6
    v_and_b32 v7, 8, v4
    v_lshrrev_b32 v7, 1, v7
    v_or_b32 v6, v6, v7
    s_lshl_b32 s90, s32, 5
    v_add_u32 v6, s90, v6
    v_mul_u32_u24 v6, 3840, v6
    v_lshl_add_u32 v11, v5, 4, v6
    v_add_u32 v3, 128, v0
    v_mul_u32_u24 v4, 6554, v3
    v_lshrrev_b32 v4, 16, v4
    v_mul_u32_u24 v5, 10, v4
    v_sub_u32 v5, v3, v5
    v_and_b32 v6, 19, v4
    v_and_b32 v7, 4, v4
    v_lshl_or_b32 v6, v7, 1, v6
    v_and_b32 v7, 8, v4
    v_lshrrev_b32 v7, 1, v7
    v_or_b32 v6, v6, v7
    s_lshl_b32 s90, s32, 5
    v_add_u32 v6, s90, v6
    v_mul_u32_u24 v6, 3840, v6
    v_lshl_add_u32 v12, v5, 4, v6
    v_add_u32 v3, 192, v0
    v_mul_u32_u24 v4, 6554, v3
    v_lshrrev_b32 v4, 16, v4
    v_mul_u32_u24 v5, 10, v4
    v_sub_u32 v5, v3, v5
    v_and_b32 v6, 19, v4
    v_and_b32 v7, 4, v4
    v_lshl_or_b32 v6, v7, 1, v6
    v_and_b32 v7, 8, v4
    v_lshrrev_b32 v7, 1, v7
    v_or_b32 v6, v6, v7
    s_lshl_b32 s90, s32, 5
    v_add_u32 v6, s90, v6
    v_mul_u32_u24 v6, 3840, v6
    v_lshl_add_u32 v13, v5, 4, v6
    v_add_u32 v3, 256, v0
    v_mul_u32_u24 v4, 6554, v3
    v_lshrrev_b32 v4, 16, v4
    v_mul_u32_u24 v5, 10, v4
    v_sub_u32 v5, v3, v5
    v_and_b32 v6, 19, v4
    v_and_b32 v7, 4, v4
    v_lshl_or_b32 v6, v7, 1, v6
    v_and_b32 v7, 8, v4
    v_lshrrev_b32 v7, 1, v7
    v_or_b32 v6, v6, v7
    s_lshl_b32 s90, s32, 5
    v_add_u32 v6, s90, v6
    v_mul_u32_u24 v6, 3840, v6
    v_lshl_add_u32 v14, v5, 4, v6
    v_lshrrev_b32 v3, 2, v1
    v_and_b32 v4, 3, v1
    v_and_b32 v5, 1, v2
    v_lshl_add_u32 v3, v5, 2, v3
    v_lshrrev_b32 v6, 1, v2
    v_lshl_add_u32 v3, v6, 4, v3
    v_mul_u32_u24 v3, 160, v3
    v_lshl_add_u32 v15, v4, 3, v3
    s_lshl_b32 s90, s32, 5
    v_add_u32 v3, s90, v1
    v_mul_u32_u24 v3, 168, v3
    v_add_u32 v3, 81920, v3
    v_lshl_add_u32 v17, v2, 3, v3
    v_lshl_add_u32 v28, v2, 4, v3
    v_add_u32 v28, -32, v28
    v_lshl_add_u32 v3, v5, 4, v1
    v_add_u32 v4, s90, v3
    v_add_u32 v3, s40, v3
    v_cmp_le_u32 s[92:93], 16, v4
    v_cmp_gt_u32 vcc, 2048, v3
    s_nop 0
    s_and_b64 vcc, vcc, s[92:93]
    v_mul_u32_u24 v3, 2560, v3
    v_lshl_add_u32 v3, v6, 4, v3
    v_mov_b32 v4, 2146435072
    v_cndmask_b32 v19, v4, v3, vcc
    v_and_b32 v3, 31, v0
    v_add_u32 v24, s40, v3
    v_add_u32 v3, s90, v3
    v_mul_u32_u24 v3, 168, v3
    v_lshrrev_b32 v4, 5, v0
    v_mul_u32_u24 v4, 40, v4
    v_add_u32 v3, v3, v4
    v_add_u32 v20, 81920, v3
    v_add_u32 v21, 101072, v3
    v_mov_b32 v27, 0xcf8547b1
    s_mov_b32 s49, 0x3ea52b5c
    s_cmp_lt_u32 s54, 19
    s_cbranch_scc1 L_pa_rows
    s_mov_b32 s24, s70
    s_and_b32 s25, s71, 0xffff
    s_mov_b32 s26, 2621440
    s_mov_b32 s27, 0x20000
    s_sub_u32 s90, s54, 19
    s_lshl_b32 s90, s90, 2
    s_add_u32 s90, s90, s32
    s_lshl_b32 s90, s90, 11
    v_lshl_add_u32 v3, v0, 4, s90
    s_mov_b32 s91, 245760
L_pa_xw:
    buffer_load_dwordx4 v[248:251], v3, s[24:27], s91 offen
    buffer_load_dwordx4 v[248:251], v3, s[24:27], s91 offen offset:1024
    s_add_u32 s91, s91, 40960
    s_waitcnt vmcnt(20)
    s_cmp_lt_u32 s91, 2621440
    s_cbranch_scc1 L_pa_xw
    s_branch L_pa_end
    s_mov_b32 s46, 0
    s_mov_b32 s47, 0
    s_mul_i32 s43, s52, 160
    s_mov_b32 s44, 0
    s_mov_b32 s45, 0
    s_mov_b32 s51, 45
    s_mov_b32 s48, s52
    s_mov_b32 s53, 0
L_pa_pf_63:
    s_mul_i32 s90, s32, 5120
    s_add_u32 m0, s90, s47
    s_mul_i32 s91, s44, 491520
    s_add_u32 s91, s91, s43
    buffer_load_dwordx4 v[248:251], v10, s[16:19], s91 offen
    s_add_u32 s47, s47, 20480
    s_cmp_eq_u32 s47, 81920
    s_cselect_b32 s47, 0, s47
    s_cmp_lg_u32 s51, 0
    s_cselect_b32 s90, 1, 0
    s_sub_u32 s51, s51, s90
    s_add_u32 s44, s44, s90
    s_cmp_eq_u32 s44, 5
    s_cselect_b32 s44, 0, s44
    s_cselect_b32 s90, 1280, 0
    s_addc_u32 s45, s45, 0
    s_add_u32 s43, s43, s90
    s_cmp_eq_u32 s45, 3
    s_cselect_b32 s45, 0, s45
    s_cselect_b32 s90, 3680, 0
    s_cmp_eq_u32 s43, 4960
    s_cselect_b32 s90, s43, s90
    s_sub_u32 s43, s43, s90
    s_add_u32 m0, m0, 1024
    buffer_load_dwordx4 v[248:251], v11, s[16:19], s91 offen
    s_add_u32 m0, m0, 1024
    buffer_load_dwordx4 v[248:251], v12, s[16:19], s91 offen
    s_add_u32 m0, m0, 1024
    buffer_load_dwordx4 v[248:251], v13, s[16:19], s91 offen
    s_add_u32 m0, m0, 1024
    buffer_load_dwordx4 v[248:251], v14, s[16:19], s91 offen
    s_waitcnt vmcnt(20)
    s_cmp_lg_u32 s51, 0
    s_cbranch_scc1 L_pa_pf_63
    v_add_u32 v3, 0, v0
    v_mul_u32_u24 v4, 6554, v3
    v_lshrrev_b32 v4, 16, v4
    v_mul_u32_u24 v5, 10, v4
    v_sub_u32 v5, v3, v5
    v_and_b32 v6, 19, v4
    v_and_b32 v7, 4, v4
    v_lshl_or_b32 v6, v7, 1, v6
    v_and_b32 v7, 8, v4
    v_lshrrev_b32 v7, 1, v7
    v_or_b32 v6, v6, v7
    s_lshl_b32 s90, s32, 5
    v_add_u32 v6, s90, v6
    v_mul_u32_u24 v6, 1280, v6
    v_lshl_add_u32 v10, v5, 4, v6
    v_add_u32 v3, 64, v0
    v_mul_u32_u24 v4, 6554, v3
    v_lshrrev_b32 v4, 16, v4
    v_mul_u32_u24 v5, 10, v4
    v_sub_u32 v5, v3, v5
    v_and_b32 v6, 19, v4
    v_and_b32 v7, 4, v4
    v_lshl_or_b32 v6, v7, 1, v6
    v_and_b32 v7, 8, v4
    v_lshrrev_b32 v7, 1, v7
    v_or_b32 v6, v6, v7
    s_lshl_b32 s90, s32, 5
    v_add_u32 v6, s90, v6
    v_mul_u32_u24 v6, 1280, v6
    v_lshl_add_u32 v11, v5, 4, v6
    v_add_u32 v3, 128, v0
    v_mul_u32_u24 v4, 6554, v3
    v_lshrrev_b32 v4, 16, v4
    v_mul_u32_u24 v5, 10, v4
    v_sub_u32 v5, v3, v5
    v_and_b32 v6, 19, v4
    v_and_b32 v7, 4, v4
    v_lshl_or_b32 v6, v7, 1, v6
    v_and_b32 v7, 8, v4
    v_lshrrev_b32 v7, 1, v7
    v_or_b32 v6, v6, v7
    s_lshl_b32 s90, s32, 5
    v_add_u32 v6, s90, v6
    v_mul_u32_u24 v6, 1280, v6
    v_lshl_add_u32 v12, v5, 4, v6
    v_add_u32 v3, 192, v0
    v_mul_u32_u24 v4, 6554, v3
    v_lshrrev_b32 v4, 16, v4
    v_mul_u32_u24 v5, 10, v4
    v_sub_u32 v5, v3, v5
    v_and_b32 v6, 19, v4
    v_and_b32 v7, 4, v4
    v_lshl_or_b32 v6, v7, 1, v6
    v_and_b32 v7, 8, v4
    v_lshrrev_b32 v7, 1, v7
    v_or_b32 v6, v6, v7
    s_lshl_b32 s90, s32, 5
    v_add_u32 v6, s90, v6
    v_mul_u32_u24 v6, 1280, v6
    v_lshl_add_u32 v13, v5, 4, v6
    v_add_u32 v3, 256, v0
    v_mul_u32_u24 v4, 6554, v3
    v_lshrrev_b32 v4, 16, v4
    v_mul_u32_u24 v5, 10, v4
    v_sub_u32 v5, v3, v5
    v_and_b32 v6, 19, v4
    v_and_b32 v7, 4, v4
    v_lshl_or_b32 v6, v7, 1, v6
    v_and_b32 v7, 8, v4
    v_lshrrev_b32 v7, 1, v7
    v_or_b32 v6, v6, v7
    s_lshl_b32 s90, s32, 5
    v_add_u32 v6, s90, v6
    v_mul_u32_u24 v6, 1280, v6
    v_lshl_add_u32 v14, v5, 4, v6
    s_mov_b32 s46, 0
    s_mov_b32 s47, 0
    s_mul_i32 s43, s52, 160
    s_mov_b32 s44, 0
    s_mov_b32 s45, 0
    s_mov_b32 s51, 40
    s_mov_b32 s48, s52
    s_mov_b32 s53, 0
L_pa_pf_64:
    s_mul_i32 s90, s32, 5120
    s_add_u32 m0, s90, s47
    s_mul_i32 s91, s44, 163840
    s_add_u32 s91, s91, s43
    buffer_load_dwordx4 v[248:251], v10, s[20:23], s91 offen
    s_add_u32 s47, s47, 20480
    s_cmp_eq_u32 s47, 81920
    s_cselect_b32 s47, 0, s47
    s_cmp_lg_u32 s51, 0
    s_cselect_b32 s90, 1, 0
    s_sub_u32 s51, s51, s90
    s_add_u32 s44, s44, s90
    s_cmp_eq_u32 s44, 5
    s_cselect_b32 s44, 0, s44
    s_cselect_b32 s90, 160, 0
    s_add_u32 s43, s43, s90
    s_cmp_eq_u32 s43, 1280
    s_cselect_b32 s43, 0, s43
    s_add_u32 m0, m0, 1024
    buffer_load_dwordx4 v[248:251], v11, s[20:23], s91 offen
    s_add_u32 m0, m0, 1024
    buffer_load_dwordx4 v[248:251], v12, s[20:23], s91 offen
    s_add_u32 m0, m0, 1024
    buffer_load_dwordx4 v[248:251], v13, s[20:23], s91 offen
    s_add_u32 m0, m0, 1024
    buffer_load_dwordx4 v[248:251], v14, s[20:23], s91 offen
    s_waitcnt vmcnt(20)
    s_cmp_lg_u32 s51, 0
    s_cbranch_scc1 L_pa_pf_64
    s_branch L_pa_end
L_pa_rows:
    s_mov_b32 s46, 0
    s_mov_b32 s47, 0
    s_mul_i32 s43, s52, 160
    s_mov_b32 s44, 0
    s_mov_b32 s45, 0
    s_mov_b32 s51, 119
    s_mov_b32 s48, s52
    s_mov_b32 s53, 0
    s_mul_i32 s90, s32, 5120
    s_add_u32 m0, s90, s47
    s_mul_i32 s91, s44, 491520
    s_add_u32 s91, s91, s43
    buffer_load_dwordx4 v10, s[16:19], s91 offen lds
    s_add_u32 s47, s47, 20480
    s_cmp_eq_u32 s47, 81920
    s_cselect_b32 s47, 0, s47
    s_cmp_lg_u32 s51, 0
    s_cselect_b32 s90, 1, 0
    s_sub_u32 s51, s51, s90
    s_add_u32 s44, s44, s90
    s_cmp_eq_u32 s44, 5
    s_cselect_b32 s44, 0, s44
    s_cselect_b32 s90, 1280, 0
    s_addc_u32 s45, s45, 0
    s_add_u32 s43, s43, s90
    s_cmp_eq_u32 s45, 3
    s_cselect_b32 s45, 0, s45
    s_cselect_b32 s90, 3680, 0
    s_cmp_eq_u32 s43, 4960
    s_cselect_b32 s90, s43, s90
    s_sub_u32 s43, s43, s90
    s_add_u32 m0, m0, 1024
    s_nop 0
    buffer_load_dwordx4 v11, s[16:19], s91 offen lds
    s_add_u32 m0, m0, 1024
    s_nop 0
    buffer_load_dwordx4 v12, s[16:19], s91 offen lds
    s_add_u32 m0, m0, 1024
    s_nop 0
    buffer_load_dwordx4 v13, s[16:19], s91 offen lds
    s_add_u32 m0, m0, 1024
    s_nop 0
    buffer_load_dwordx4 v14, s[16:19], s91 offen lds
    s_mul_i32 s90, s32, 5120
    s_add_u32 m0, s90, s47
    s_mul_i32 s91, s44, 491520
    s_add_u32 s91, s91, s43
    buffer_load_dwordx4 v10, s[16:19], s91 offen lds
    s_add_u32 s47, s47, 20480
    s_cmp_eq_u32 s47, 81920
    s_cselect_b32 s47, 0, s47
    s_cmp_lg_u32 s51, 0
    s_cselect_b32 s90, 1, 0
    s_sub_u32 s51, s51, s90
    s_add_u32 s44, s44, s90
    s_cmp_eq_u32 s44, 5
    s_cselect_b32 s44, 0, s44
    s_cselect_b32 s90, 1280, 0
    s_addc_u32 s45, s45, 0
    s_add_u32 s43, s43, s90
    s_cmp_eq_u32 s45, 3
    s_cselect_b32 s45, 0, s45
    s_cselect_b32 s90, 3680, 0
    s_cmp_eq_u32 s43, 4960
    s_cselect_b32 s90, s43, s90
    s_sub_u32 s43, s43, s90
    s_add_u32 m0, m0, 1024
    s_nop 0
    buffer_load_dwordx4 v11, s[16:19], s91 offen lds
    s_add_u32 m0, m0, 1024
    s_nop 0
    buffer_load_dwordx4 v12, s[16:19], s91 offen lds
    s_add_u32 m0, m0, 1024
    s_nop 0
    buffer_load_dwordx4 v13, s[16:19], s91 offen lds
    s_add_u32 m0, m0, 1024
    s_nop 0
    buffer_load_dwordx4 v14, s[16:19], s91 offen lds
    s_mul_i32 s90, s32, 5120
    s_add_u32 m0, s90, s47
    s_mul_i32 s91, s44, 491520
    s_add_u32 s91, s91, s43
    buffer_load_dwordx4 v10, s[16:19], s91 offen lds
    s_add_u32 s47, s47, 20480
    s_cmp_eq_u32 s47, 81920
    s_cselect_b32 s47, 0, s47
    s_cmp_lg_u32 s51, 0
    s_cselect_b32 s90, 1, 0
    s_sub_u32 s51, s51, s90
    s_add_u32 s44, s44, s90
    s_cmp_eq_u32 s44, 5
    s_cselect_b32 s44, 0, s44
    s_cselect_b32 s90, 1280, 0
    s_addc_u32 s45, s45, 0
    s_add_u32 s43, s43, s90
    s_cmp_eq_u32 s45, 3
    s_cselect_b32 s45, 0, s45
    s_cselect_b32 s90, 3680, 0
    s_cmp_eq_u32 s43, 4960
    s_cselect_b32 s90, s43, s90
    s_sub_u32 s43, s43, s90
    s_add_u32 m0, m0, 1024
    s_nop 0
    buffer_load_dwordx4 v11, s[16:19], s91 offen lds
    s_add_u32 m0, m0, 1024
    s_nop 0
    buffer_load_dwordx4 v12, s[16:19], s91 offen lds
    s_add_u32 m0, m0, 1024
    s_nop 0
    buffer_load_dwordx4 v13, s[16:19], s91 offen lds
    s_add_u32 m0, m0, 1024
    s_nop 0
    buffer_load_dwordx4 v14, s[16:19], s91 offen lds
    v_add_u32 v16, s46, v15
    s_waitcnt vmcnt(10) lgkmcnt(0)
    s_barrier
    ds_read_b64_tr_b16 v[96:97], v16 offset:0
    ds_read_b64_tr_b16 v[98:99], v16 offset:1280
    ds_read_b64_tr_b16 v[100:101], v16 offset:32
    ds_read_b64_tr_b16 v[102:103], v16 offset:1312
    ds_read_b64_tr_b16 v[104:105], v16 offset:64
    ds_read_b64_tr_b16 v[106:107], v16 offset:1344
    ds_read_b64_tr_b16 v[108:109], v16 offset:96
    ds_read_b64_tr_b16 v[110:111], v16 offset:1376
    ds_read_b64_tr_b16 v[112:113], v16 offset:128
    ds_read_b64_tr_b16 v[114:115], v16 offset:1408
L_pa_grp:
    s_mov_b32 s41, 0
L_pa_blk:
    s_waitcnt lgkmcnt(8)
    v_mfma_f32_16x16x32_bf16 v[136:139], v[96:99], a[0:3], 0
    ds_read_b64_tr_b16 v[116:117], v16 offset:5120
    s_add_u32 s46, s46, 20480
    s_cmp_eq_u32 s46, 81920
    v_mfma_f32_16x16x32_bf16 v[140:143], v[96:99], a[80:83], 0
    ds_read_b64_tr_b16 v[118:119], v16 offset:6400
    s_cselect_b32 s46, 0, s46
    s_mul_i32 s90, s32, 5120
    s_waitcnt lgkmcnt(8)
    v_mfma_f32_16x16x32_bf16 v[144:147], v[100:103], a[0:3], 0
    ds_read_b64_tr_b16 v[120:121], v16 offset:5152
    s_add_u32 m0, s90, s47
    s_mul_i32 s91, s44, 491520
    v_mfma_f32_16x16x32_bf16 v[148:151], v[100:103], a[80:83], 0
    ds_read_b64_tr_b16 v[122:123], v16 offset:6432
    s_add_u32 s91, s91, s43
    buffer_load_dwordx4 v10, s[16:19], s91 offen lds
    s_waitcnt lgkmcnt(8)
    v_mfma_f32_16x16x32_bf16 v[152:155], v[104:107], a[0:3], 0
    ds_read_b64_tr_b16 v[124:125], v16 offset:5184
    s_add_u32 s47, s47, 20480
    s_cmp_eq_u32 s47, 81920
    v_mfma_f32_16x16x32_bf16 v[156:159], v[104:107], a[80:83], 0
    ds_read_b64_tr_b16 v[126:127], v16 offset:6464
    s_cselect_b32 s47, 0, s47
    s_cmp_lg_u32 s51, 0
    s_waitcnt lgkmcnt(8)
    v_mfma_f32_16x16x32_bf16 v[160:163], v[108:111], a[0:3], 0
    ds_read_b64_tr_b16 v[128:129], v16 offset:5216
    s_cselect_b32 s90, 1, 0
    s_sub_u32 s51, s51, s90
    v_mfma_f32_16x16x32_bf16 v[164:167], v[108:111], a[80:83], 0
    ds_read_b64_tr_b16 v[130:131], v16 offset:6496
    s_add_u32 s44, s44, s90
    s_cmp_eq_u32 s44, 5
    s_waitcnt lgkmcnt(8)
    v_mfma_f32_16x16x32_bf16 v[168:171], v[112:115], a[0:3], 0
    ds_read_b64_tr_b16 v[132:133], v16 offset:5248
    s_cselect_b32 s44, 0, s44
    s_cselect_b32 s90, 1280, 0
    v_mfma_f32_16x16x32_bf16 v[172:175], v[112:115], a[80:83], 0
    ds_read_b64_tr_b16 v[134:135], v16 offset:6528
    s_addc_u32 s45, s45, 0
    s_add_u32 s43, s43, s90
    s_waitcnt lgkmcnt(8)
    v_mfma_f32_16x16x32_bf16 v[136:139], v[116:119], a[4:7], v[136:139]
    ds_read_b64_tr_b16 v[96:97], v16 offset:10240
    s_cmp_eq_u32 s45, 3
    s_cselect_b32 s45, 0, s45
    v_mfma_f32_16x16x32_bf16 v[140:143], v[116:119], a[84:87], v[140:143]
    ds_read_b64_tr_b16 v[98:99], v16 offset:11520
    s_cselect_b32 s90, 3680, 0
    s_cmp_eq_u32 s43, 4960
    s_waitcnt lgkmcnt(8)
    v_mfma_f32_16x16x32_bf16 v[144:147], v[120:123], a[4:7], v[144:147]
    ds_read_b64_tr_b16 v[100:101], v16 offset:10272
    s_cselect_b32 s90, s43, s90
    s_sub_u32 s43, s43, s90
    v_mfma_f32_16x16x32_bf16 v[148:151], v[120:123], a[84:87], v[148:151]
    ds_read_b64_tr_b16 v[102:103], v16 offset:11552
    s_add_u32 m0, m0, 1024
    s_nop 0
    buffer_load_dwordx4 v11, s[16:19], s91 offen lds
    s_waitcnt lgkmcnt(8)
    v_mfma_f32_16x16x32_bf16 v[152:155], v[124:127], a[4:7], v[152:155]
    ds_read_b64_tr_b16 v[104:105], v16 offset:10304
    s_add_u32 m0, m0, 1024
    v_mfma_f32_16x16x32_bf16 v[156:159], v[124:127], a[84:87], v[156:159]
    ds_read_b64_tr_b16 v[106:107], v16 offset:11584
    s_waitcnt lgkmcnt(8)
    v_mfma_f32_16x16x32_bf16 v[160:163], v[128:131], a[4:7], v[160:163]
    ds_read_b64_tr_b16 v[108:109], v16 offset:10336
    v_mfma_f32_16x16x32_bf16 v[164:167], v[128:131], a[84:87], v[164:167]
    ds_read_b64_tr_b16 v[110:111], v16 offset:11616
    s_waitcnt lgkmcnt(8)
    v_mfma_f32_16x16x32_bf16 v[168:171], v[132:135], a[4:7], v[168:171]
    ds_read_b64_tr_b16 v[112:113], v16 offset:10368
    buffer_load_dwordx4 v12, s[16:19], s91 offen lds
    s_add_u32 m0, m0, 1024
    v_mfma_f32_16x16x32_bf16 v[172:175], v[132:135], a[84:87], v[172:175]
    ds_read_b64_tr_b16 v[114:115], v16 offset:11648
    s_waitcnt lgkmcnt(8)
    v_mfma_f32_16x16x32_bf16 v[136:139], v[96:99], a[8:11], v[136:139]
    ds_read_b64_tr_b16 v[116:117], v16 offset:15360
    v_mfma_f32_16x16x32_bf16 v[140:143], v[96:99], a[88:91], v[140:143]
    ds_read_b64_tr_b16 v[118:119], v16 offset:16640
    s_waitcnt lgkmcnt(8)
    v_mfma_f32_16x16x32_bf16 v[144:147], v[100:103], a[8:11], v[144:147]
    ds_read_b64_tr_b16 v[120:121], v16 offset:15392
    v_mfma_f32_16x16x32_bf16 v[148:151], v[100:103], a[88:91], v[148:151]
    ds_read_b64_tr_b16 v[122:123], v16 offset:16672
    buffer_load_dwordx4 v13, s[16:19], s91 offen lds
    s_add_u32 m0, m0, 1024
    s_waitcnt lgkmcnt(8)
    v_mfma_f32_16x16x32_bf16 v[152:155], v[104:107], a[8:11], v[152:155]
    ds_read_b64_tr_b16 v[124:125], v16 offset:15424
    v_mfma_f32_16x16x32_bf16 v[156:159], v[104:107], a[88:91], v[156:159]
    ds_read_b64_tr_b16 v[126:127], v16 offset:16704
    s_waitcnt lgkmcnt(8)
    v_mfma_f32_16x16x32_bf16 v[160:163], v[108:111], a[8:11], v[160:163]
    ds_read_b64_tr_b16 v[128:129], v16 offset:15456
    v_mfma_f32_16x16x32_bf16 v[164:167], v[108:111], a[88:91], v[164:167]
    ds_read_b64_tr_b16 v[130:131], v16 offset:16736
    s_waitcnt lgkmcnt(8)
    v_mfma_f32_16x16x32_bf16 v[168:171], v[112:115], a[8:11], v[168:171]
    ds_read_b64_tr_b16 v[132:133], v16 offset:15488
    buffer_load_dwordx4 v14, s[16:19], s91 offen lds
    v_mfma_f32_16x16x32_bf16 v[172:175], v[112:115], a[88:91], v[172:175]
    ds_read_b64_tr_b16 v[134:135], v16 offset:16768
    s_waitcnt lgkmcnt(8)
    v_mfma_f32_16x16x32_bf16 v[136:139], v[116:119], a[12:15], v[136:139]
    v_mfma_f32_16x16x32_bf16 v[140:143], v[116:119], a[92:95], v[140:143]
    s_waitcnt lgkmcnt(6)
    v_mfma_f32_16x16x32_bf16 v[144:147], v[120:123], a[12:15], v[144:147]
    v_mfma_f32_16x16x32_bf16 v[148:151], v[120:123], a[92:95], v[148:151]
    v_add_u32 v16, s46, v15
    s_waitcnt vmcnt(10) lgkmcnt(0)
    s_barrier
    v_mfma_f32_16x16x32_bf16 v[152:155], v[124:127], a[12:15], v[152:155]
    ds_read_b64_tr_b16 v[96:97], v16 offset:0
    ds_read_b64_tr_b16 v[98:99], v16 offset:1280
    v_mfma_f32_16x16x32_bf16 v[156:159], v[124:127], a[92:95], v[156:159]
    ds_read_b64_tr_b16 v[100:101], v16 offset:32
    ds_read_b64_tr_b16 v[102:103], v16 offset:1312
    v_mfma_f32_16x16x32_bf16 v[160:163], v[128:131], a[12:15], v[160:163]
    ds_read_b64_tr_b16 v[104:105], v16 offset:64
    ds_read_b64_tr_b16 v[106:107], v16 offset:1344
    v_mfma_f32_16x16x32_bf16 v[164:167], v[128:131], a[92:95], v[164:167]
    ds_read_b64_tr_b16 v[108:109], v16 offset:96
    ds_read_b64_tr_b16 v[110:111], v16 offset:1376
    v_mfma_f32_16x16x32_bf16 v[168:171], v[132:135], a[12:15], v[168:171]
    ds_read_b64_tr_b16 v[112:113], v16 offset:128
    ds_read_b64_tr_b16 v[114:115], v16 offset:1408
    v_mfma_f32_16x16x32_bf16 v[172:175], v[132:135], a[92:95], v[172:175]
    s_waitcnt lgkmcnt(8)
    v_mfma_f32_16x16x32_bf16 v[136:139], v[96:99], a[16:19], v[136:139]
    ds_read_b64_tr_b16 v[116:117], v16 offset:5120
    s_add_u32 s46, s46, 20480
    s_cmp_eq_u32 s46, 81920
    v_mfma_f32_16x16x32_bf16 v[140:143], v[96:99], a[96:99], v[140:143]
    ds_read_b64_tr_b16 v[118:119], v16 offset:6400
    s_cselect_b32 s46, 0, s46
    s_mul_i32 s90, s32, 5120
    s_waitcnt lgkmcnt(8)
    v_mfma_f32_16x16x32_bf16 v[144:147], v[100:103], a[16:19], v[144:147]
    ds_read_b64_tr_b16 v[120:121], v16 offset:5152
    s_add_u32 m0, s90, s47
    s_mul_i32 s91, s44, 491520
    v_mfma_f32_16x16x32_bf16 v[148:151], v[100:103], a[96:99], v[148:151]
    ds_read_b64_tr_b16 v[122:123], v16 offset:6432
    s_add_u32 s91, s91, s43
    buffer_load_dwordx4 v10, s[16:19], s91 offen lds
    s_waitcnt lgkmcnt(8)
    v_mfma_f32_16x16x32_bf16 v[152:155], v[104:107], a[16:19], v[152:155]
    ds_read_b64_tr_b16 v[124:125], v16 offset:5184
    s_add_u32 s47, s47, 20480
    s_cmp_eq_u32 s47, 81920
    v_mfma_f32_16x16x32_bf16 v[156:159], v[104:107], a[96:99], v[156:159]
    ds_read_b64_tr_b16 v[126:127], v16 offset:6464
    s_cselect_b32 s47, 0, s47
    s_cmp_lg_u32 s51, 0
    s_waitcnt lgkmcnt(8)
    v_mfma_f32_16x16x32_bf16 v[160:163], v[108:111], a[16:19], v[160:163]
    ds_read_b64_tr_b16 v[128:129], v16 offset:5216
    s_cselect_b32 s90, 1, 0
    s_sub_u32 s51, s51, s90
    v_mfma_f32_16x16x32_bf16 v[164:167], v[108:111], a[96:99], v[164:167]
    ds_read_b64_tr_b16 v[130:131], v16 offset:6496
    s_add_u32 s44, s44, s90
    s_cmp_eq_u32 s44, 5
    s_waitcnt lgkmcnt(8)
    v_mfma_f32_16x16x32_bf16 v[168:171], v[112:115], a[16:19], v[168:171]
    ds_read_b64_tr_b16 v[132:133], v16 offset:5248
    s_cselect_b32 s44, 0, s44
    s_cselect_b32 s90, 1280, 0
    v_mfma_f32_16x16x32_bf16 v[172:175], v[112:115], a[96:99], v[172:175]
    ds_read_b64_tr_b16 v[134:135], v16 offset:6528
    s_addc_u32 s45, s45, 0
    s_add_u32 s43, s43, s90
    s_waitcnt lgkmcnt(8)
    v_mfma_f32_16x16x32_bf16 v[136:139], v[116:119], a[20:23], v[136:139]
    ds_read_b64_tr_b16 v[96:97], v16 offset:10240
    s_cmp_eq_u32 s45, 3
    s_cselect_b32 s45, 0, s45
    v_mfma_f32_16x16x32_bf16 v[140:143], v[116:119], a[100:103], v[140:143]
    ds_read_b64_tr_b16 v[98:99], v16 offset:11520
    s_cselect_b32 s90, 3680, 0
    s_cmp_eq_u32 s43, 4960
    s_waitcnt lgkmcnt(8)
    v_mfma_f32_16x16x32_bf16 v[144:147], v[120:123], a[20:23], v[144:147]
    ds_read_b64_tr_b16 v[100:101], v16 offset:10272
    s_cselect_b32 s90, s43, s90
    s_sub_u32 s43, s43, s90
    v_mfma_f32_16x16x32_bf16 v[148:151], v[120:123], a[100:103], v[148:151]
    ds_read_b64_tr_b16 v[102:103], v16 offset:11552
    s_add_u32 m0, m0, 1024
    s_nop 0
    buffer_load_dwordx4 v11, s[16:19], s91 offen lds
    s_waitcnt lgkmcnt(8)
    v_mfma_f32_16x16x32_bf16 v[152:155], v[124:127], a[20:23], v[152:155]
    ds_read_b64_tr_b16 v[104:105], v16 offset:10304
    s_add_u32 m0, m0, 1024
    v_mfma_f32_16x16x32_bf16 v[156:159], v[124:127], a[100:103], v[156:159]
    ds_read_b64_tr_b16 v[106:107], v16 offset:11584
    s_waitcnt lgkmcnt(8)
    v_mfma_f32_16x16x32_bf16 v[160:163], v[128:131], a[20:23], v[160:163]
    ds_read_b64_tr_b16 v[108:109], v16 offset:10336
    v_mfma_f32_16x16x32_bf16 v[164:167], v[128:131], a[100:103], v[164:167]
    ds_read_b64_tr_b16 v[110:111], v16 offset:11616
    s_waitcnt lgkmcnt(8)
    v_mfma_f32_16x16x32_bf16 v[168:171], v[132:135], a[20:23], v[168:171]
    ds_read_b64_tr_b16 v[112:113], v16 offset:10368
    buffer_load_dwordx4 v12, s[16:19], s91 offen lds
    s_add_u32 m0, m0, 1024
    v_mfma_f32_16x16x32_bf16 v[172:175], v[132:135], a[100:103], v[172:175]
    ds_read_b64_tr_b16 v[114:115], v16 offset:11648
    s_waitcnt lgkmcnt(8)
    v_mfma_f32_16x16x32_bf16 v[136:139], v[96:99], a[24:27], v[136:139]
    ds_read_b64_tr_b16 v[116:117], v16 offset:15360
    v_mfma_f32_16x16x32_bf16 v[140:143], v[96:99], a[104:107], v[140:143]
    ds_read_b64_tr_b16 v[118:119], v16 offset:16640
    s_waitcnt lgkmcnt(8)
    v_mfma_f32_16x16x32_bf16 v[144:147], v[100:103], a[24:27], v[144:147]
    ds_read_b64_tr_b16 v[120:121], v16 offset:15392
    v_mfma_f32_16x16x32_bf16 v[148:151], v[100:103], a[104:107], v[148:151]
    ds_read_b64_tr_b16 v[122:123], v16 offset:16672
    buffer_load_dwordx4 v13, s[16:19], s91 offen lds
    s_add_u32 m0, m0, 1024
    s_waitcnt lgkmcnt(8)
    v_mfma_f32_16x16x32_bf16 v[152:155], v[104:107], a[24:27], v[152:155]
    ds_read_b64_tr_b16 v[124:125], v16 offset:15424
    v_mfma_f32_16x16x32_bf16 v[156:159], v[104:107], a[104:107], v[156:159]
    ds_read_b64_tr_b16 v[126:127], v16 offset:16704
    s_waitcnt lgkmcnt(8)
    v_mfma_f32_16x16x32_bf16 v[160:163], v[108:111], a[24:27], v[160:163]
    ds_read_b64_tr_b16 v[128:129], v16 offset:15456
    v_mfma_f32_16x16x32_bf16 v[164:167], v[108:111], a[104:107], v[164:167]
    ds_read_b64_tr_b16 v[130:131], v16 offset:16736
    s_waitcnt lgkmcnt(8)
    v_mfma_f32_16x16x32_bf16 v[168:171], v[112:115], a[24:27], v[168:171]
    ds_read_b64_tr_b16 v[132:133], v16 offset:15488
    buffer_load_dwordx4 v14, s[16:19], s91 offen lds
    v_mfma_f32_16x16x32_bf16 v[172:175], v[112:115], a[104:107], v[172:175]
    ds_read_b64_tr_b16 v[134:135], v16 offset:16768
    s_waitcnt lgkmcnt(8)
    v_mfma_f32_16x16x32_bf16 v[136:139], v[116:119], a[28:31], v[136:139]
    v_mfma_f32_16x16x32_bf16 v[140:143], v[116:119], a[108:111], v[140:143]
    s_waitcnt lgkmcnt(6)
    v_mfma_f32_16x16x32_bf16 v[144:147], v[120:123], a[28:31], v[144:147]
    v_mfma_f32_16x16x32_bf16 v[148:151], v[120:123], a[108:111], v[148:151]
    v_add_u32 v16, s46, v15
    s_waitcnt vmcnt(10) lgkmcnt(0)
    s_barrier
    v_mfma_f32_16x16x32_bf16 v[152:155], v[124:127], a[28:31], v[152:155]
    ds_read_b64_tr_b16 v[96:97], v16 offset:0
    ds_read_b64_tr_b16 v[98:99], v16 offset:1280
    v_mfma_f32_16x16x32_bf16 v[156:159], v[124:127], a[108:111], v[156:159]
    ds_read_b64_tr_b16 v[100:101], v16 offset:32
    ds_read_b64_tr_b16 v[102:103], v16 offset:1312
    v_mfma_f32_16x16x32_bf16 v[160:163], v[128:131], a[28:31], v[160:163]
    ds_read_b64_tr_b16 v[104:105], v16 offset:64
    ds_read_b64_tr_b16 v[106:107], v16 offset:1344
    v_mfma_f32_16x16x32_bf16 v[164:167], v[128:131], a[108:111], v[164:167]
    ds_read_b64_tr_b16 v[108:109], v16 offset:96
    ds_read_b64_tr_b16 v[110:111], v16 offset:1376
    v_mfma_f32_16x16x32_bf16 v[168:171], v[132:135], a[28:31], v[168:171]
    ds_read_b64_tr_b16 v[112:113], v16 offset:128
    ds_read_b64_tr_b16 v[114:115], v16 offset:1408
    v_mfma_f32_16x16x32_bf16 v[172:175], v[132:135], a[108:111], v[172:175]
    s_waitcnt lgkmcnt(8)
    v_mfma_f32_16x16x32_bf16 v[136:139], v[96:99], a[32:35], v[136:139]
    ds_read_b64_tr_b16 v[116:117], v16 offset:5120
    s_add_u32 s46, s46, 20480
    s_cmp_eq_u32 s46, 81920
    v_mfma_f32_16x16x32_bf16 v[140:143], v[96:99], a[112:115], v[140:143]
    ds_read_b64_tr_b16 v[118:119], v16 offset:6400
    s_cselect_b32 s46, 0, s46
    s_mul_i32 s90, s32, 5120
    s_waitcnt lgkmcnt(8)
    v_mfma_f32_16x16x32_bf16 v[144:147], v[100:103], a[32:35], v[144:147]
    ds_read_b64_tr_b16 v[120:121], v16 offset:5152
    s_add_u32 m0, s90, s47
    s_mul_i32 s91, s44, 491520
    v_mfma_f32_16x16x32_bf16 v[148:151], v[100:103], a[112:115], v[148:151]
    ds_read_b64_tr_b16 v[122:123], v16 offset:6432
    s_add_u32 s91, s91, s43
    buffer_load_dwordx4 v10, s[16:19], s91 offen lds
    s_waitcnt lgkmcnt(8)
    v_mfma_f32_16x16x32_bf16 v[152:155], v[104:107], a[32:35], v[152:155]
    ds_read_b64_tr_b16 v[124:125], v16 offset:5184
    s_add_u32 s47, s47, 20480
    s_cmp_eq_u32 s47, 81920
    v_mfma_f32_16x16x32_bf16 v[156:159], v[104:107], a[112:115], v[156:159]
    ds_read_b64_tr_b16 v[126:127], v16 offset:6464
    s_cselect_b32 s47, 0, s47
    s_cmp_lg_u32 s51, 0
    s_waitcnt lgkmcnt(8)
    v_mfma_f32_16x16x32_bf16 v[160:163], v[108:111], a[32:35], v[160:163]
    ds_read_b64_tr_b16 v[128:129], v16 offset:5216
    s_cselect_b32 s90, 1, 0
    s_sub_u32 s51, s51, s90
    v_mfma_f32_16x16x32_bf16 v[164:167], v[108:111], a[112:115], v[164:167]
    ds_read_b64_tr_b16 v[130:131], v16 offset:6496
    s_add_u32 s44, s44, s90
    s_cmp_eq_u32 s44, 5
    s_waitcnt lgkmcnt(8)
    v_mfma_f32_16x16x32_bf16 v[168:171], v[112:115], a[32:35], v[168:171]
    ds_read_b64_tr_b16 v[132:133], v16 offset:5248
    s_cselect_b32 s44, 0, s44
    s_cselect_b32 s90, 1280, 0
    v_mfma_f32_16x16x32_bf16 v[172:175], v[112:115], a[112:115], v[172:175]
    ds_read_b64_tr_b16 v[134:135], v16 offset:6528
    s_addc_u32 s45, s45, 0
    s_add_u32 s43, s43, s90
    s_waitcnt lgkmcnt(8)
    v_mfma_f32_16x16x32_bf16 v[136:139], v[116:119], a[36:39], v[136:139]
    ds_read_b64_tr_b16 v[96:97], v16 offset:10240
    s_cmp_eq_u32 s45, 3
    s_cselect_b32 s45, 0, s45
    v_mfma_f32_16x16x32_bf16 v[140:143], v[116:119], a[116:119], v[140:143]
    ds_read_b64_tr_b16 v[98:99], v16 offset:11520
    s_cselect_b32 s90, 3680, 0
    s_cmp_eq_u32 s43, 4960
    s_waitcnt lgkmcnt(8)
    v_mfma_f32_16x16x32_bf16 v[144:147], v[120:123], a[36:39], v[144:147]
    ds_read_b64_tr_b16 v[100:101], v16 offset:10272
    s_cselect_b32 s90, s43, s90
    s_sub_u32 s43, s43, s90
    v_mfma_f32_16x16x32_bf16 v[148:151], v[120:123], a[116:119], v[148:151]
    ds_read_b64_tr_b16 v[102:103], v16 offset:11552
    s_add_u32 m0, m0, 1024
    s_nop 0
    buffer_load_dwordx4 v11, s[16:19], s91 offen lds
    s_waitcnt lgkmcnt(8)
    v_mfma_f32_16x16x32_bf16 v[152:155], v[124:127], a[36:39], v[152:155]
    ds_read_b64_tr_b16 v[104:105], v16 offset:10304
    s_add_u32 m0, m0, 1024
    v_mfma_f32_16x16x32_bf16 v[156:159], v[124:127], a[116:119], v[156:159]
    ds_read_b64_tr_b16 v[106:107], v16 offset:11584
    s_waitcnt lgkmcnt(8)
    v_mfma_f32_16x16x32_bf16 v[160:163], v[128:131], a[36:39], v[160:163]
    ds_read_b64_tr_b16 v[108:109], v16 offset:10336
    v_mfma_f32_16x16x32_bf16 v[164:167], v[128:131], a[116:119], v[164:167]
    ds_read_b64_tr_b16 v[110:111], v16 offset:11616
    s_waitcnt lgkmcnt(8)
    v_mfma_f32_16x16x32_bf16 v[168:171], v[132:135], a[36:39], v[168:171]
    ds_read_b64_tr_b16 v[112:113], v16 offset:10368
    buffer_load_dwordx4 v12, s[16:19], s91 offen lds
    s_add_u32 m0, m0, 1024
    v_mfma_f32_16x16x32_bf16 v[172:175], v[132:135], a[116:119], v[172:175]
    ds_read_b64_tr_b16 v[114:115], v16 offset:11648
    s_waitcnt lgkmcnt(8)
    v_mfma_f32_16x16x32_bf16 v[136:139], v[96:99], a[40:43], v[136:139]
    ds_read_b64_tr_b16 v[116:117], v16 offset:15360
    v_mfma_f32_16x16x32_bf16 v[140:143], v[96:99], a[120:123], v[140:143]
    ds_read_b64_tr_b16 v[118:119], v16 offset:16640
    s_waitcnt lgkmcnt(8)
    v_mfma_f32_16x16x32_bf16 v[144:147], v[100:103], a[40:43], v[144:147]
    ds_read_b64_tr_b16 v[120:121], v16 offset:15392
    v_mfma_f32_16x16x32_bf16 v[148:151], v[100:103], a[120:123], v[148:151]
    ds_read_b64_tr_b16 v[122:123], v16 offset:16672
    buffer_load_dwordx4 v13, s[16:19], s91 offen lds
    s_add_u32 m0, m0, 1024
    s_waitcnt lgkmcnt(8)
    v_mfma_f32_16x16x32_bf16 v[152:155], v[104:107], a[40:43], v[152:155]
    ds_read_b64_tr_b16 v[124:125], v16 offset:15424
    v_mfma_f32_16x16x32_bf16 v[156:159], v[104:107], a[120:123], v[156:159]
    ds_read_b64_tr_b16 v[126:127], v16 offset:16704
    s_waitcnt lgkmcnt(8)
    v_mfma_f32_16x16x32_bf16 v[160:163], v[108:111], a[40:43], v[160:163]
    ds_read_b64_tr_b16 v[128:129], v16 offset:15456
    v_mfma_f32_16x16x32_bf16 v[164:167], v[108:111], a[120:123], v[164:167]
    ds_read_b64_tr_b16 v[130:131], v16 offset:16736
    s_waitcnt lgkmcnt(8)
    v_mfma_f32_16x16x32_bf16 v[168:171], v[112:115], a[40:43], v[168:171]
    ds_read_b64_tr_b16 v[132:133], v16 offset:15488
    buffer_load_dwordx4 v14, s[16:19], s91 offen lds
    v_mfma_f32_16x16x32_bf16 v[172:175], v[112:115], a[120:123], v[172:175]
    ds_read_b64_tr_b16 v[134:135], v16 offset:16768
    s_waitcnt lgkmcnt(8)
    v_mfma_f32_16x16x32_bf16 v[136:139], v[116:119], a[44:47], v[136:139]
    v_mfma_f32_16x16x32_bf16 v[140:143], v[116:119], a[124:127], v[140:143]
    s_waitcnt lgkmcnt(6)
    v_mfma_f32_16x16x32_bf16 v[144:147], v[120:123], a[44:47], v[144:147]
    v_mfma_f32_16x16x32_bf16 v[148:151], v[120:123], a[124:127], v[148:151]
    v_add_u32 v16, s46, v15
    s_waitcnt vmcnt(10) lgkmcnt(0)
    s_barrier
    v_mfma_f32_16x16x32_bf16 v[152:155], v[124:127], a[44:47], v[152:155]
    ds_read_b64_tr_b16 v[96:97], v16 offset:0
    ds_read_b64_tr_b16 v[98:99], v16 offset:1280
    v_mfma_f32_16x16x32_bf16 v[156:159], v[124:127], a[124:127], v[156:159]
    ds_read_b64_tr_b16 v[100:101], v16 offset:32
    ds_read_b64_tr_b16 v[102:103], v16 offset:1312
    v_mfma_f32_16x16x32_bf16 v[160:163], v[128:131], a[44:47], v[160:163]
    ds_read_b64_tr_b16 v[104:105], v16 offset:64
    ds_read_b64_tr_b16 v[106:107], v16 offset:1344
    v_mfma_f32_16x16x32_bf16 v[164:167], v[128:131], a[124:127], v[164:167]
    ds_read_b64_tr_b16 v[108:109], v16 offset:96
    ds_read_b64_tr_b16 v[110:111], v16 offset:1376
    v_mfma_f32_16x16x32_bf16 v[168:171], v[132:135], a[44:47], v[168:171]
    ds_read_b64_tr_b16 v[112:113], v16 offset:128
    ds_read_b64_tr_b16 v[114:115], v16 offset:1408
    v_mfma_f32_16x16x32_bf16 v[172:175], v[132:135], a[124:127], v[172:175]
    s_waitcnt lgkmcnt(8)
    v_mfma_f32_16x16x32_bf16 v[136:139], v[96:99], a[48:51], v[136:139]
    ds_read_b64_tr_b16 v[116:117], v16 offset:5120
    s_add_u32 s46, s46, 20480
    s_cmp_eq_u32 s46, 81920
    v_mfma_f32_16x16x32_bf16 v[140:143], v[96:99], a[128:131], v[140:143]
    ds_read_b64_tr_b16 v[118:119], v16 offset:6400
    s_cselect_b32 s46, 0, s46
    s_mul_i32 s90, s32, 5120
    s_waitcnt lgkmcnt(8)
    v_mfma_f32_16x16x32_bf16 v[144:147], v[100:103], a[48:51], v[144:147]
    ds_read_b64_tr_b16 v[120:121], v16 offset:5152
    s_add_u32 m0, s90, s47
    s_mul_i32 s91, s44, 491520
    v_mfma_f32_16x16x32_bf16 v[148:151], v[100:103], a[128:131], v[148:151]
    ds_read_b64_tr_b16 v[122:123], v16 offset:6432
    s_add_u32 s91, s91, s43
    buffer_load_dwordx4 v10, s[16:19], s91 offen lds
    s_waitcnt lgkmcnt(8)
    v_mfma_f32_16x16x32_bf16 v[152:155], v[104:107], a[48:51], v[152:155]
    ds_read_b64_tr_b16 v[124:125], v16 offset:5184
    s_add_u32 s47, s47, 20480
    s_cmp_eq_u32 s47, 81920
    v_mfma_f32_16x16x32_bf16 v[156:159], v[104:107], a[128:131], v[156:159]
    ds_read_b64_tr_b16 v[126:127], v16 offset:6464
    s_cselect_b32 s47, 0, s47
    s_cmp_lg_u32 s51, 0
    s_waitcnt lgkmcnt(8)
    v_mfma_f32_16x16x32_bf16 v[160:163], v[108:111], a[48:51], v[160:163]
    ds_read_b64_tr_b16 v[128:129], v16 offset:5216
    s_cselect_b32 s90, 1, 0
    s_sub_u32 s51, s51, s90
    v_mfma_f32_16x16x32_bf16 v[164:167], v[108:111], a[128:131], v[164:167]
    ds_read_b64_tr_b16 v[130:131], v16 offset:6496
    s_add_u32 s44, s44, s90
    s_cmp_eq_u32 s44, 5
    s_waitcnt lgkmcnt(8)
    v_mfma_f32_16x16x32_bf16 v[168:171], v[112:115], a[48:51], v[168:171]
    ds_read_b64_tr_b16 v[132:133], v16 offset:5248
    s_cselect_b32 s44, 0, s44
    s_cselect_b32 s90, 1280, 0
    v_mfma_f32_16x16x32_bf16 v[172:175], v[112:115], a[128:131], v[172:175]
    ds_read_b64_tr_b16 v[134:135], v16 offset:6528
    s_addc_u32 s45, s45, 0
    s_add_u32 s43, s43, s90
    s_waitcnt lgkmcnt(8)
    v_mfma_f32_16x16x32_bf16 v[136:139], v[116:119], a[52:55], v[136:139]
    ds_read_b64_tr_b16 v[96:97], v16 offset:10240
    s_cmp_eq_u32 s45, 3
    s_cselect_b32 s45, 0, s45
    v_mfma_f32_16x16x32_bf16 v[140:143], v[116:119], a[132:135], v[140:143]
    ds_read_b64_tr_b16 v[98:99], v16 offset:11520
    s_cselect_b32 s90, 3680, 0
    s_cmp_eq_u32 s43, 4960
    s_waitcnt lgkmcnt(8)
    v_mfma_f32_16x16x32_bf16 v[144:147], v[120:123], a[52:55], v[144:147]
    ds_read_b64_tr_b16 v[100:101], v16 offset:10272
    s_cselect_b32 s90, s43, s90
    s_sub_u32 s43, s43, s90
    v_mfma_f32_16x16x32_bf16 v[148:151], v[120:123], a[132:135], v[148:151]
    ds_read_b64_tr_b16 v[102:103], v16 offset:11552
    s_add_u32 m0, m0, 1024
    s_nop 0
    buffer_load_dwordx4 v11, s[16:19], s91 offen lds
    s_waitcnt lgkmcnt(8)
    v_mfma_f32_16x16x32_bf16 v[152:155], v[124:127], a[52:55], v[152:155]
    ds_read_b64_tr_b16 v[104:105], v16 offset:10304
    s_add_u32 m0, m0, 1024
    v_mfma_f32_16x16x32_bf16 v[156:159], v[124:127], a[132:135], v[156:159]
    ds_read_b64_tr_b16 v[106:107], v16 offset:11584
    s_waitcnt lgkmcnt(8)
    v_mfma_f32_16x16x32_bf16 v[160:163], v[128:131], a[52:55], v[160:163]
    ds_read_b64_tr_b16 v[108:109], v16 offset:10336
    v_mfma_f32_16x16x32_bf16 v[164:167], v[128:131], a[132:135], v[164:167]
    ds_read_b64_tr_b16 v[110:111], v16 offset:11616
    s_waitcnt lgkmcnt(8)
    v_mfma_f32_16x16x32_bf16 v[168:171], v[132:135], a[52:55], v[168:171]
    ds_read_b64_tr_b16 v[112:113], v16 offset:10368
    buffer_load_dwordx4 v12, s[16:19], s91 offen lds
    s_add_u32 m0, m0, 1024
    v_mfma_f32_16x16x32_bf16 v[172:175], v[132:135], a[132:135], v[172:175]
    ds_read_b64_tr_b16 v[114:115], v16 offset:11648
    s_waitcnt lgkmcnt(8)
    v_mfma_f32_16x16x32_bf16 v[136:139], v[96:99], a[56:59], v[136:139]
    ds_read_b64_tr_b16 v[116:117], v16 offset:15360
    v_mfma_f32_16x16x32_bf16 v[140:143], v[96:99], a[136:139], v[140:143]
    ds_read_b64_tr_b16 v[118:119], v16 offset:16640
    s_waitcnt lgkmcnt(8)
    v_mfma_f32_16x16x32_bf16 v[144:147], v[100:103], a[56:59], v[144:147]
    ds_read_b64_tr_b16 v[120:121], v16 offset:15392
    v_mfma_f32_16x16x32_bf16 v[148:151], v[100:103], a[136:139], v[148:151]
    ds_read_b64_tr_b16 v[122:123], v16 offset:16672
    buffer_load_dwordx4 v13, s[16:19], s91 offen lds
    s_add_u32 m0, m0, 1024
    s_waitcnt lgkmcnt(8)
    v_mfma_f32_16x16x32_bf16 v[152:155], v[104:107], a[56:59], v[152:155]
    ds_read_b64_tr_b16 v[124:125], v16 offset:15424
    v_mfma_f32_16x16x32_bf16 v[156:159], v[104:107], a[136:139], v[156:159]
    ds_read_b64_tr_b16 v[126:127], v16 offset:16704
    s_waitcnt lgkmcnt(8)
    v_mfma_f32_16x16x32_bf16 v[160:163], v[108:111], a[56:59], v[160:163]
    ds_read_b64_tr_b16 v[128:129], v16 offset:15456
    v_mfma_f32_16x16x32_bf16 v[164:167], v[108:111], a[136:139], v[164:167]
    ds_read_b64_tr_b16 v[130:131], v16 offset:16736
    s_waitcnt lgkmcnt(8)
    v_mfma_f32_16x16x32_bf16 v[168:171], v[112:115], a[56:59], v[168:171]
    ds_read_b64_tr_b16 v[132:133], v16 offset:15488
    buffer_load_dwordx4 v14, s[16:19], s91 offen lds
    v_mfma_f32_16x16x32_bf16 v[172:175], v[112:115], a[136:139], v[172:175]
    ds_read_b64_tr_b16 v[134:135], v16 offset:16768
    s_waitcnt lgkmcnt(8)
    v_mfma_f32_16x16x32_bf16 v[136:139], v[116:119], a[60:63], v[136:139]
    v_mfma_f32_16x16x32_bf16 v[140:143], v[116:119], a[140:143], v[140:143]
    s_waitcnt lgkmcnt(6)
    v_mfma_f32_16x16x32_bf16 v[144:147], v[120:123], a[60:63], v[144:147]
    v_mfma_f32_16x16x32_bf16 v[148:151], v[120:123], a[140:143], v[148:151]
    v_add_u32 v16, s46, v15
    s_waitcnt vmcnt(10) lgkmcnt(0)
    s_barrier
    v_mfma_f32_16x16x32_bf16 v[152:155], v[124:127], a[60:63], v[152:155]
    ds_read_b64_tr_b16 v[96:97], v16 offset:0
    ds_read_b64_tr_b16 v[98:99], v16 offset:1280
    v_mfma_f32_16x16x32_bf16 v[156:159], v[124:127], a[140:143], v[156:159]
    ds_read_b64_tr_b16 v[100:101], v16 offset:32
    ds_read_b64_tr_b16 v[102:103], v16 offset:1312
    v_mfma_f32_16x16x32_bf16 v[160:163], v[128:131], a[60:63], v[160:163]
    ds_read_b64_tr_b16 v[104:105], v16 offset:64
    ds_read_b64_tr_b16 v[106:107], v16 offset:1344
    v_mfma_f32_16x16x32_bf16 v[164:167], v[128:131], a[140:143], v[164:167]
    ds_read_b64_tr_b16 v[108:109], v16 offset:96
    ds_read_b64_tr_b16 v[110:111], v16 offset:1376
    v_mfma_f32_16x16x32_bf16 v[168:171], v[132:135], a[60:63], v[168:171]
    ds_read_b64_tr_b16 v[112:113], v16 offset:128
    ds_read_b64_tr_b16 v[114:115], v16 offset:1408
    v_mfma_f32_16x16x32_bf16 v[172:175], v[132:135], a[140:143], v[172:175]
    s_waitcnt lgkmcnt(8)
    v_mfma_f32_16x16x32_bf16 v[136:139], v[96:99], a[64:67], v[136:139]
    ds_read_b64_tr_b16 v[116:117], v16 offset:5120
    s_add_u32 s46, s46, 20480
    s_cmp_eq_u32 s46, 81920
    v_mfma_f32_16x16x32_bf16 v[140:143], v[96:99], a[144:147], v[140:143]
    ds_read_b64_tr_b16 v[118:119], v16 offset:6400
    s_cselect_b32 s46, 0, s46
    s_mul_i32 s90, s32, 5120
    s_waitcnt lgkmcnt(8)
    v_mfma_f32_16x16x32_bf16 v[144:147], v[100:103], a[64:67], v[144:147]
    ds_read_b64_tr_b16 v[120:121], v16 offset:5152
    s_add_u32 m0, s90, s47
    s_mul_i32 s91, s44, 491520
    v_mfma_f32_16x16x32_bf16 v[148:151], v[100:103], a[144:147], v[148:151]
    ds_read_b64_tr_b16 v[122:123], v16 offset:6432
    s_add_u32 s91, s91, s43
    buffer_load_dwordx4 v10, s[16:19], s91 offen lds
    s_waitcnt lgkmcnt(8)
    v_mfma_f32_16x16x32_bf16 v[152:155], v[104:107], a[64:67], v[152:155]
    ds_read_b64_tr_b16 v[124:125], v16 offset:5184
    s_add_u32 s47, s47, 20480
    s_cmp_eq_u32 s47, 81920
    v_mfma_f32_16x16x32_bf16 v[156:159], v[104:107], a[144:147], v[156:159]
    ds_read_b64_tr_b16 v[126:127], v16 offset:6464
    s_cselect_b32 s47, 0, s47
    s_cmp_lg_u32 s51, 0
    s_waitcnt lgkmcnt(8)
    v_mfma_f32_16x16x32_bf16 v[160:163], v[108:111], a[64:67], v[160:163]
    ds_read_b64_tr_b16 v[128:129], v16 offset:5216
    s_cselect_b32 s90, 1, 0
    s_sub_u32 s51, s51, s90
    v_mfma_f32_16x16x32_bf16 v[164:167], v[108:111], a[144:147], v[164:167]
    ds_read_b64_tr_b16 v[130:131], v16 offset:6496
    s_add_u32 s44, s44, s90
    s_cmp_eq_u32 s44, 5
    s_waitcnt lgkmcnt(8)
    v_mfma_f32_16x16x32_bf16 v[168:171], v[112:115], a[64:67], v[168:171]
    ds_read_b64_tr_b16 v[132:133], v16 offset:5248
    s_cselect_b32 s44, 0, s44
    s_cselect_b32 s90, 1280, 0
    v_mfma_f32_16x16x32_bf16 v[172:175], v[112:115], a[144:147], v[172:175]
    ds_read_b64_tr_b16 v[134:135], v16 offset:6528
    s_addc_u32 s45, s45, 0
    s_add_u32 s43, s43, s90
    s_waitcnt lgkmcnt(8)
    v_mfma_f32_16x16x32_bf16 v[136:139], v[116:119], a[68:71], v[136:139]
    ds_read_b64_tr_b16 v[96:97], v16 offset:10240
    s_cmp_eq_u32 s45, 3
    s_cselect_b32 s45, 0, s45
    v_mfma_f32_16x16x32_bf16 v[140:143], v[116:119], a[148:151], v[140:143]
    ds_read_b64_tr_b16 v[98:99], v16 offset:11520
    s_cselect_b32 s90, 3680, 0
    s_cmp_eq_u32 s43, 4960
    s_waitcnt lgkmcnt(8)
    v_mfma_f32_16x16x32_bf16 v[144:147], v[120:123], a[68:71], v[144:147]
    ds_read_b64_tr_b16 v[100:101], v16 offset:10272
    s_cselect_b32 s90, s43, s90
    s_sub_u32 s43, s43, s90
    v_mfma_f32_16x16x32_bf16 v[148:151], v[120:123], a[148:151], v[148:151]
    ds_read_b64_tr_b16 v[102:103], v16 offset:11552
    s_add_u32 m0, m0, 1024
    s_nop 0
    buffer_load_dwordx4 v11, s[16:19], s91 offen lds
    s_waitcnt lgkmcnt(8)
    v_mfma_f32_16x16x32_bf16 v[152:155], v[124:127], a[68:71], v[152:155]
    ds_read_b64_tr_b16 v[104:105], v16 offset:10304
    s_add_u32 m0, m0, 1024
    v_mfma_f32_16x16x32_bf16 v[156:159], v[124:127], a[148:151], v[156:159]
    ds_read_b64_tr_b16 v[106:107], v16 offset:11584
    s_waitcnt lgkmcnt(8)
    v_mfma_f32_16x16x32_bf16 v[160:163], v[128:131], a[68:71], v[160:163]
    ds_read_b64_tr_b16 v[108:109], v16 offset:10336
    v_mfma_f32_16x16x32_bf16 v[164:167], v[128:131], a[148:151], v[164:167]
    ds_read_b64_tr_b16 v[110:111], v16 offset:11616
    s_waitcnt lgkmcnt(8)
    v_mfma_f32_16x16x32_bf16 v[168:171], v[132:135], a[68:71], v[168:171]
    ds_read_b64_tr_b16 v[112:113], v16 offset:10368
    buffer_load_dwordx4 v12, s[16:19], s91 offen lds
    s_add_u32 m0, m0, 1024
    v_mfma_f32_16x16x32_bf16 v[172:175], v[132:135], a[148:151], v[172:175]
    ds_read_b64_tr_b16 v[114:115], v16 offset:11648
    s_waitcnt lgkmcnt(8)
    v_mfma_f32_16x16x32_bf16 v[136:139], v[96:99], a[72:75], v[136:139]
    ds_read_b64_tr_b16 v[116:117], v16 offset:15360
    v_mfma_f32_16x16x32_bf16 v[140:143], v[96:99], a[152:155], v[140:143]
    ds_read_b64_tr_b16 v[118:119], v16 offset:16640
    s_waitcnt lgkmcnt(8)
    v_mfma_f32_16x16x32_bf16 v[144:147], v[100:103], a[72:75], v[144:147]
    ds_read_b64_tr_b16 v[120:121], v16 offset:15392
    v_mfma_f32_16x16x32_bf16 v[148:151], v[100:103], a[152:155], v[148:151]
    ds_read_b64_tr_b16 v[122:123], v16 offset:16672
    buffer_load_dwordx4 v13, s[16:19], s91 offen lds
    s_add_u32 m0, m0, 1024
    s_waitcnt lgkmcnt(8)
    v_mfma_f32_16x16x32_bf16 v[152:155], v[104:107], a[72:75], v[152:155]
    ds_read_b64_tr_b16 v[124:125], v16 offset:15424
    v_mfma_f32_16x16x32_bf16 v[156:159], v[104:107], a[152:155], v[156:159]
    ds_read_b64_tr_b16 v[126:127], v16 offset:16704
    s_waitcnt lgkmcnt(8)
    v_mfma_f32_16x16x32_bf16 v[160:163], v[108:111], a[72:75], v[160:163]
    ds_read_b64_tr_b16 v[128:129], v16 offset:15456
    v_mfma_f32_16x16x32_bf16 v[164:167], v[108:111], a[152:155], v[164:167]
    ds_read_b64_tr_b16 v[130:131], v16 offset:16736
    s_waitcnt lgkmcnt(8)
    v_mfma_f32_16x16x32_bf16 v[168:171], v[112:115], a[72:75], v[168:171]
    ds_read_b64_tr_b16 v[132:133], v16 offset:15488
    buffer_load_dwordx4 v14, s[16:19], s91 offen lds
    v_mfma_f32_16x16x32_bf16 v[172:175], v[112:115], a[152:155], v[172:175]
    ds_read_b64_tr_b16 v[134:135], v16 offset:16768
    s_waitcnt lgkmcnt(8)
    v_mfma_f32_16x16x32_bf16 v[136:139], v[116:119], a[76:79], v[136:139]
    v_mfma_f32_16x16x32_bf16 v[140:143], v[116:119], a[156:159], v[140:143]
    s_waitcnt lgkmcnt(6)
    v_mfma_f32_16x16x32_bf16 v[144:147], v[120:123], a[76:79], v[144:147]
    v_mfma_f32_16x16x32_bf16 v[148:151], v[120:123], a[156:159], v[148:151]
    v_add_u32 v16, s46, v15
    s_waitcnt vmcnt(10) lgkmcnt(0)
    s_barrier
    v_mfma_f32_16x16x32_bf16 v[152:155], v[124:127], a[76:79], v[152:155]
    ds_read_b64_tr_b16 v[96:97], v16 offset:0
    ds_read_b64_tr_b16 v[98:99], v16 offset:1280
    v_mfma_f32_16x16x32_bf16 v[156:159], v[124:127], a[156:159], v[156:159]
    ds_read_b64_tr_b16 v[100:101], v16 offset:32
    ds_read_b64_tr_b16 v[102:103], v16 offset:1312
    v_mfma_f32_16x16x32_bf16 v[160:163], v[128:131], a[76:79], v[160:163]
    ds_read_b64_tr_b16 v[104:105], v16 offset:64
    ds_read_b64_tr_b16 v[106:107], v16 offset:1344
    v_mfma_f32_16x16x32_bf16 v[164:167], v[128:131], a[156:159], v[164:167]
    ds_read_b64_tr_b16 v[108:109], v16 offset:96
    ds_read_b64_tr_b16 v[110:111], v16 offset:1376
    v_mfma_f32_16x16x32_bf16 v[168:171], v[132:135], a[76:79], v[168:171]
    ds_read_b64_tr_b16 v[112:113], v16 offset:128
    ds_read_b64_tr_b16 v[114:115], v16 offset:1408
    v_mfma_f32_16x16x32_bf16 v[172:175], v[132:135], a[156:159], v[172:175]
    v_add_u32 v18, s41, v17
    v_cvt_pk_bf16_f32 v176, v136, v137
    v_cvt_pk_bf16_f32 v177, v138, v139
    v_cvt_pk_bf16_f32 v178, v140, v141
    v_cvt_pk_bf16_f32 v179, v142, v143
    ds_write_b64 v18, v[176:177] offset:0
    ds_write_b64 v18, v[178:179] offset:2688
    v_cvt_pk_bf16_f32 v176, v144, v145
    v_cvt_pk_bf16_f32 v177, v146, v147
    v_cvt_pk_bf16_f32 v178, v148, v149
    v_cvt_pk_bf16_f32 v179, v150, v151
    ds_write_b64 v18, v[176:177] offset:32
    ds_write_b64 v18, v[178:179] offset:2720
    v_cvt_pk_bf16_f32 v176, v152, v153
    v_cvt_pk_bf16_f32 v177, v154, v155
    v_cvt_pk_bf16_f32 v178, v156, v157
    v_cvt_pk_bf16_f32 v179, v158, v159
    ds_write_b64 v18, v[176:177] offset:64
    ds_write_b64 v18, v[178:179] offset:2752
    v_cvt_pk_bf16_f32 v176, v160, v161
    v_cvt_pk_bf16_f32 v177, v162, v163
    v_cvt_pk_bf16_f32 v178, v164, v165
    v_cvt_pk_bf16_f32 v179, v166, v167
    ds_write_b64 v18, v[176:177] offset:96
    ds_write_b64 v18, v[178:179] offset:2784
    v_cvt_pk_bf16_f32 v176, v168, v169
    v_cvt_pk_bf16_f32 v177, v170, v171
    v_cvt_pk_bf16_f32 v178, v172, v173
    v_cvt_pk_bf16_f32 v179, v174, v175
    ds_write_b64 v18, v[176:177] offset:128
    ds_write_b64 v18, v[178:179] offset:2816
    s_waitcnt lgkmcnt(0)
    s_add_u32 s41, s41, 21504
    s_cmp_lt_u32 s41, 64512
    s_cbranch_scc1 L_pa_blk
    s_barrier
    s_mov_b32 s50, 0
L_pa_att:
    v_add_u32 v23, s50, v21
    v_add_u32 v22, s50, v20
    ds_read_b64 v[116:117], v22 offset:0
    ds_read_b64 v[118:119], v22 offset:8
    ds_read_b64 v[120:121], v22 offset:16
    ds_read_b64 v[122:123], v22 offset:24
    ds_read_b64 v[124:125], v22 offset:32
    ds_read_b64 v[126:127], v23 offset:2352
    ds_read_b64 v[128:129], v23 offset:2360
    ds_read_b64 v[130:131], v23 offset:2368
    ds_read_b64 v[132:133], v23 offset:2376
    ds_read_b64 v[134:135], v23 offset:2384
    ds_read_b64 v[136:137], v23 offset:2016
    ds_read_b64 v[138:139], v23 offset:2024
    ds_read_b64 v[140:141], v23 offset:2032
    ds_read_b64 v[142:143], v23 offset:2040
    ds_read_b64 v[144:145], v23 offset:2048
    s_waitcnt lgkmcnt(5)
    v_dot2_f32_bf16 v146, v116, v126, 0
    v_dot2_f32_bf16 v146, v117, v127, v146
    v_dot2_f32_bf16 v146, v118, v128, v146
    v_dot2_f32_bf16 v146, v119, v129, v146
    v_dot2_f32_bf16 v146, v120, v130, v146
    v_dot2_f32_bf16 v146, v121, v131, v146
    v_dot2_f32_bf16 v146, v122, v132, v146
    v_dot2_f32_bf16 v146, v123, v133, v146
    v_dot2_f32_bf16 v146, v124, v134, v146
    v_dot2_f32_bf16 v146, v125, v135, v146
    ds_read_b64 v[126:127], v23 offset:1680
    ds_read_b64 v[128:129], v23 offset:1688
    ds_read_b64 v[130:131], v23 offset:1696
    ds_read_b64 v[132:133], v23 offset:1704
    ds_read_b64 v[134:135], v23 offset:1712
    s_waitcnt lgkmcnt(5)
    v_dot2_f32_bf16 v147, v116, v136, 0
    v_dot2_f32_bf16 v147, v117, v137, v147
    v_dot2_f32_bf16 v147, v118, v138, v147
    v_dot2_f32_bf16 v147, v119, v139, v147
    v_dot2_f32_bf16 v147, v120, v140, v147
    v_dot2_f32_bf16 v147, v121, v141, v147
    v_dot2_f32_bf16 v147, v122, v142, v147
    v_dot2_f32_bf16 v147, v123, v143, v147
    v_dot2_f32_bf16 v147, v124, v144, v147
    v_dot2_f32_bf16 v147, v125, v145, v147
    ds_read_b64 v[136:137], v23 offset:1344
    ds_read_b64 v[138:139], v23 offset:1352
    ds_read_b64 v[140:141], v23 offset:1360
    ds_read_b64 v[142:143], v23 offset:1368
    ds_read_b64 v[144:145], v23 offset:1376
    s_waitcnt lgkmcnt(5)
    v_dot2_f32_bf16 v148, v116, v126, 0
    v_dot2_f32_bf16 v148, v117, v127, v148
    v_dot2_f32_bf16 v148, v118, v128, v148
    v_dot2_f32_bf16 v148, v119, v129, v148
    v_dot2_f32_bf16 v148, v120, v130, v148
    v_dot2_f32_bf16 v148, v121, v131, v148
    v_dot2_f32_bf16 v148, v122, v132, v148
    v_dot2_f32_bf16 v148, v123, v133, v148
    v_dot2_f32_bf16 v148, v124, v134, v148
    v_dot2_f32_bf16 v148, v125, v135, v148
    ds_read_b64 v[126:127], v23 offset:1008
    ds_read_b64 v[128:129], v23 offset:1016
    ds_read_b64 v[130:131], v23 offset:1024
    ds_read_b64 v[132:133], v23 offset:1032
    ds_read_b64 v[134:135], v23 offset:1040
    s_waitcnt lgkmcnt(5)
    v_dot2_f32_bf16 v149, v116, v136, 0
    v_dot2_f32_bf16 v149, v117, v137, v149
    v_dot2_f32_bf16 v149, v118, v138, v149
    v_dot2_f32_bf16 v149, v119, v139, v149
    v_dot2_f32_bf16 v149, v120, v140, v149
    v_dot2_f32_bf16 v149, v121, v141, v149
    v_dot2_f32_bf16 v149, v122, v142, v149
    v_dot2_f32_bf16 v149, v123, v143, v149
    v_dot2_f32_bf16 v149, v124, v144, v149
    v_dot2_f32_bf16 v149, v125, v145, v149
    ds_read_b64 v[136:137], v23 offset:672
    ds_read_b64 v[138:139], v23 offset:680
    ds_read_b64 v[140:141], v23 offset:688
    ds_read_b64 v[142:143], v23 offset:696
    ds_read_b64 v[144:145], v23 offset:704
    s_waitcnt lgkmcnt(5)
    v_dot2_f32_bf16 v150, v116, v126, 0
    v_dot2_f32_bf16 v150, v117, v127, v150
    v_dot2_f32_bf16 v150, v118, v128, v150
    v_dot2_f32_bf16 v150, v119, v129, v150
    v_dot2_f32_bf16 v150, v120, v130, v150
    v_dot2_f32_bf16 v150, v121, v131, v150
    v_dot2_f32_bf16 v150, v122, v132, v150
    v_dot2_f32_bf16 v150, v123, v133, v150
    v_dot2_f32_bf16 v150, v124, v134, v150
    v_dot2_f32_bf16 v150, v125, v135, v150
    ds_read_b64 v[126:127], v23 offset:336
    ds_read_b64 v[128:129], v23 offset:344
    ds_read_b64 v[130:131], v23 offset:352
    ds_read_b64 v[132:133], v23 offset:360
    ds_read_b64 v[134:135], v23 offset:368
    s_waitcnt lgkmcnt(5)
    v_dot2_f32_bf16 v151, v116, v136, 0
    v_dot2_f32_bf16 v151, v117, v137, v151
    v_dot2_f32_bf16 v151, v118, v138, v151
    v_dot2_f32_bf16 v151, v119, v139, v151
    v_dot2_f32_bf16 v151, v120, v140, v151
    v_dot2_f32_bf16 v151, v121, v141, v151
    v_dot2_f32_bf16 v151, v122, v142, v151
    v_dot2_f32_bf16 v151, v123, v143, v151
    v_dot2_f32_bf16 v151, v124, v144, v151
    v_dot2_f32_bf16 v151, v125, v145, v151
    ds_read_b64 v[136:137], v23 offset:0
    ds_read_b64 v[138:139], v23 offset:8
    ds_read_b64 v[140:141], v23 offset:16
    ds_read_b64 v[142:143], v23 offset:24
    ds_read_b64 v[144:145], v23 offset:32
    s_waitcnt lgkmcnt(5)
    v_dot2_f32_bf16 v152, v116, v126, 0
    v_dot2_f32_bf16 v152, v117, v127, v152
    v_dot2_f32_bf16 v152, v118, v128, v152
    v_dot2_f32_bf16 v152, v119, v129, v152
    v_dot2_f32_bf16 v152, v120, v130, v152
    v_dot2_f32_bf16 v152, v121, v131, v152
    v_dot2_f32_bf16 v152, v122, v132, v152
    v_dot2_f32_bf16 v152, v123, v133, v152
    v_dot2_f32_bf16 v152, v124, v134, v152
    v_dot2_f32_bf16 v152, v125, v135, v152
    ds_read_b64 v[126:127], v23 offset:23856
    ds_read_b64 v[128:129], v23 offset:23864
    ds_read_b64 v[130:131], v23 offset:23872
    ds_read_b64 v[132:133], v23 offset:23880
    ds_read_b64 v[134:135], v23 offset:23888
    s_waitcnt lgkmcnt(5)
    v_dot2_f32_bf16 v153, v116, v136, 0
    v_dot2_f32_bf16 v153, v117, v137, v153
    v_dot2_f32_bf16 v153, v118, v138, v153
    v_dot2_f32_bf16 v153, v119, v139, v153
    v_dot2_f32_bf16 v153, v120, v140, v153
    v_dot2_f32_bf16 v153, v121, v141, v153
    v_dot2_f32_bf16 v153, v122, v142, v153
    v_dot2_f32_bf16 v153, v123, v143, v153
    v_dot2_f32_bf16 v153, v124, v144, v153
    v_dot2_f32_bf16 v153, v125, v145, v153
    v_cmp_le_i32 vcc, 2, v24
    s_nop 1
    v_cndmask_b32 v147, v27, v147, vcc
    v_cmp_le_i32 vcc, 4, v24
    s_nop 1
    v_cndmask_b32 v148, v27, v148, vcc
    v_cmp_le_i32 vcc, 6, v24
    s_nop 1
    v_cndmask_b32 v149, v27, v149, vcc
    v_cmp_le_i32 vcc, 8, v24
    s_nop 1
    v_cndmask_b32 v150, v27, v150, vcc
    v_cmp_le_i32 vcc, 10, v24
    s_nop 1
    v_cndmask_b32 v151, v27, v151, vcc
    v_cmp_le_i32 vcc, 12, v24
    s_nop 1
    v_cndmask_b32 v152, v27, v152, vcc
    v_cmp_le_i32 vcc, 14, v24
    s_nop 1
    v_cndmask_b32 v153, v27, v153, vcc
    v_max_f32 v25, v146, v147
    v_max3_f32 v25, v25, v148, v149
    v_max3_f32 v25, v25, v150, v151
    v_max3_f32 v25, v25, v152, v153
    v_sub_f32 v146, v146, v25
    v_sub_f32 v147, v147, v25
    v_sub_f32 v148, v148, v25
    v_sub_f32 v149, v149, v25
    v_sub_f32 v150, v150, v25
    v_sub_f32 v151, v151, v25
    v_sub_f32 v152, v152, v25
    v_sub_f32 v153, v153, v25
    v_mul_f32 v146, s49, v146
    v_mul_f32 v147, s49, v147
    v_mul_f32 v148, s49, v148
    v_mul_f32 v149, s49, v149
    v_mul_f32 v150, s49, v150
    v_mul_f32 v151, s49, v151
    v_mul_f32 v152, s49, v152
    v_mul_f32 v153, s49, v153
    v_exp_f32 v146, v146
    v_exp_f32 v147, v147
    v_exp_f32 v148, v148
    v_exp_f32 v149, v149
    v_exp_f32 v150, v150
    v_exp_f32 v151, v151
    v_exp_f32 v152, v152
    v_exp_f32 v153, v153
    v_add_f32 v26, v146, v147
    v_add_f32 v26, v26, v148
    v_add_f32 v26, v26, v149
    v_add_f32 v26, v26, v150
    v_add_f32 v26, v26, v151
    v_add_f32 v26, v26, v152
    v_add_f32 v26, v26, v153
    v_rcp_f32 v26, v26
    s_nop 0
    v_mul_f32 v146, v146, v26
    v_cvt_pk_bf16_f32 v154, v146, 0
    v_cvt_pk_bf16_f32 v155, 0, v146
    v_mul_f32 v147, v147, v26
    v_cvt_pk_bf16_f32 v156, v147, 0
    v_cvt_pk_bf16_f32 v157, 0, v147
    v_mul_f32 v148, v148, v26
    v_cvt_pk_bf16_f32 v158, v148, 0
    v_cvt_pk_bf16_f32 v159, 0, v148
    v_mul_f32 v149, v149, v26
    v_cvt_pk_bf16_f32 v160, v149, 0
    v_cvt_pk_bf16_f32 v161, 0, v149
    v_mul_f32 v150, v150, v26
    v_cvt_pk_bf16_f32 v162, v150, 0
    v_cvt_pk_bf16_f32 v163, 0, v150
    v_mul_f32 v151, v151, v26
    v_cvt_pk_bf16_f32 v164, v151, 0
    v_cvt_pk_bf16_f32 v165, 0, v151
    v_mul_f32 v152, v152, v26
    v_cvt_pk_bf16_f32 v166, v152, 0
    v_cvt_pk_bf16_f32 v167, 0, v152
    v_mul_f32 v153, v153, v26
    v_cvt_pk_bf16_f32 v168, v153, 0
    v_cvt_pk_bf16_f32 v169, 0, v153
    ds_read_b64 v[136:137], v23 offset:23520
    ds_read_b64 v[138:139], v23 offset:23528
    ds_read_b64 v[140:141], v23 offset:23536
    ds_read_b64 v[142:143], v23 offset:23544
    ds_read_b64 v[144:145], v23 offset:23552
    s_waitcnt lgkmcnt(5)
    v_dot2_f32_bf16 v170, v126, v154, 0
    v_dot2_f32_bf16 v171, v126, v155, 0
    v_dot2_f32_bf16 v172, v127, v154, 0
    v_dot2_f32_bf16 v173, v127, v155, 0
    v_dot2_f32_bf16 v174, v128, v154, 0
    v_dot2_f32_bf16 v175, v128, v155, 0
    v_dot2_f32_bf16 v176, v129, v154, 0
    v_dot2_f32_bf16 v177, v129, v155, 0
    v_dot2_f32_bf16 v178, v130, v154, 0
    v_dot2_f32_bf16 v179, v130, v155, 0
    v_dot2_f32_bf16 v180, v131, v154, 0
    v_dot2_f32_bf16 v181, v131, v155, 0
    v_dot2_f32_bf16 v182, v132, v154, 0
    v_dot2_f32_bf16 v183, v132, v155, 0
    v_dot2_f32_bf16 v184, v133, v154, 0
    v_dot2_f32_bf16 v185, v133, v155, 0
    v_dot2_f32_bf16 v186, v134, v154, 0
    v_dot2_f32_bf16 v187, v134, v155, 0
    v_dot2_f32_bf16 v188, v135, v154, 0
    v_dot2_f32_bf16 v189, v135, v155, 0
    ds_read_b64 v[126:127], v23 offset:23184
    ds_read_b64 v[128:129], v23 offset:23192
    ds_read_b64 v[130:131], v23 offset:23200
    ds_read_b64 v[132:133], v23 offset:23208
    ds_read_b64 v[134:135], v23 offset:23216
    s_waitcnt lgkmcnt(5)
    v_dot2_f32_bf16 v170, v136, v156, v170
    v_dot2_f32_bf16 v171, v136, v157, v171
    v_dot2_f32_bf16 v172, v137, v156, v172
    v_dot2_f32_bf16 v173, v137, v157, v173
    v_dot2_f32_bf16 v174, v138, v156, v174
    v_dot2_f32_bf16 v175, v138, v157, v175
    v_dot2_f32_bf16 v176, v139, v156, v176
    v_dot2_f32_bf16 v177, v139, v157, v177
    v_dot2_f32_bf16 v178, v140, v156, v178
    v_dot2_f32_bf16 v179, v140, v157, v179
    v_dot2_f32_bf16 v180, v141, v156, v180
    v_dot2_f32_bf16 v181, v141, v157, v181
    v_dot2_f32_bf16 v182, v142, v156, v182
    v_dot2_f32_bf16 v183, v142, v157, v183
    v_dot2_f32_bf16 v184, v143, v156, v184
    v_dot2_f32_bf16 v185, v143, v157, v185
    v_dot2_f32_bf16 v186, v144, v156, v186
    v_dot2_f32_bf16 v187, v144, v157, v187
    v_dot2_f32_bf16 v188, v145, v156, v188
    v_dot2_f32_bf16 v189, v145, v157, v189
    ds_read_b64 v[136:137], v23 offset:22848
    ds_read_b64 v[138:139], v23 offset:22856
    ds_read_b64 v[140:141], v23 offset:22864
    ds_read_b64 v[142:143], v23 offset:22872
    ds_read_b64 v[144:145], v23 offset:22880
    s_waitcnt lgkmcnt(5)
    v_dot2_f32_bf16 v170, v126, v158, v170
    v_dot2_f32_bf16 v171, v126, v159, v171
    v_dot2_f32_bf16 v172, v127, v158, v172
    v_dot2_f32_bf16 v173, v127, v159, v173
    v_dot2_f32_bf16 v174, v128, v158, v174
    v_dot2_f32_bf16 v175, v128, v159, v175
    v_dot2_f32_bf16 v176, v129, v158, v176
    v_dot2_f32_bf16 v177, v129, v159, v177
    v_dot2_f32_bf16 v178, v130, v158, v178
    v_dot2_f32_bf16 v179, v130, v159, v179
    v_dot2_f32_bf16 v180, v131, v158, v180
    v_dot2_f32_bf16 v181, v131, v159, v181
    v_dot2_f32_bf16 v182, v132, v158, v182
    v_dot2_f32_bf16 v183, v132, v159, v183
    v_dot2_f32_bf16 v184, v133, v158, v184
    v_dot2_f32_bf16 v185, v133, v159, v185
    v_dot2_f32_bf16 v186, v134, v158, v186
    v_dot2_f32_bf16 v187, v134, v159, v187
    v_dot2_f32_bf16 v188, v135, v158, v188
    v_dot2_f32_bf16 v189, v135, v159, v189
    ds_read_b64 v[126:127], v23 offset:22512
    ds_read_b64 v[128:129], v23 offset:22520
    ds_read_b64 v[130:131], v23 offset:22528
    ds_read_b64 v[132:133], v23 offset:22536
    ds_read_b64 v[134:135], v23 offset:22544
    s_waitcnt lgkmcnt(5)
    v_dot2_f32_bf16 v170, v136, v160, v170
    v_dot2_f32_bf16 v171, v136, v161, v171
    v_dot2_f32_bf16 v172, v137, v160, v172
    v_dot2_f32_bf16 v173, v137, v161, v173
    v_dot2_f32_bf16 v174, v138, v160, v174
    v_dot2_f32_bf16 v175, v138, v161, v175
    v_dot2_f32_bf16 v176, v139, v160, v176
    v_dot2_f32_bf16 v177, v139, v161, v177
    v_dot2_f32_bf16 v178, v140, v160, v178
    v_dot2_f32_bf16 v179, v140, v161, v179
    v_dot2_f32_bf16 v180, v141, v160, v180
    v_dot2_f32_bf16 v181, v141, v161, v181
    v_dot2_f32_bf16 v182, v142, v160, v182
    v_dot2_f32_bf16 v183, v142, v161, v183
    v_dot2_f32_bf16 v184, v143, v160, v184
    v_dot2_f32_bf16 v185, v143, v161, v185
    v_dot2_f32_bf16 v186, v144, v160, v186
    v_dot2_f32_bf16 v187, v144, v161, v187
    v_dot2_f32_bf16 v188, v145, v160, v188
    v_dot2_f32_bf16 v189, v145, v161, v189
    ds_read_b64 v[136:137], v23 offset:22176
    ds_read_b64 v[138:139], v23 offset:22184
    ds_read_b64 v[140:141], v23 offset:22192
    ds_read_b64 v[142:143], v23 offset:22200
    ds_read_b64 v[144:145], v23 offset:22208
    s_waitcnt lgkmcnt(5)
    v_dot2_f32_bf16 v170, v126, v162, v170
    v_dot2_f32_bf16 v171, v126, v163, v171
    v_dot2_f32_bf16 v172, v127, v162, v172
    v_dot2_f32_bf16 v173, v127, v163, v173
    v_dot2_f32_bf16 v174, v128, v162, v174
    v_dot2_f32_bf16 v175, v128, v163, v175
    v_dot2_f32_bf16 v176, v129, v162, v176
    v_dot2_f32_bf16 v177, v129, v163, v177
    v_dot2_f32_bf16 v178, v130, v162, v178
    v_dot2_f32_bf16 v179, v130, v163, v179
    v_dot2_f32_bf16 v180, v131, v162, v180
    v_dot2_f32_bf16 v181, v131, v163, v181
    v_dot2_f32_bf16 v182, v132, v162, v182
    v_dot2_f32_bf16 v183, v132, v163, v183
    v_dot2_f32_bf16 v184, v133, v162, v184
    v_dot2_f32_bf16 v185, v133, v163, v185
    v_dot2_f32_bf16 v186, v134, v162, v186
    v_dot2_f32_bf16 v187, v134, v163, v187
    v_dot2_f32_bf16 v188, v135, v162, v188
    v_dot2_f32_bf16 v189, v135, v163, v189
    ds_read_b64 v[126:127], v23 offset:21840
    ds_read_b64 v[128:129], v23 offset:21848
    ds_read_b64 v[130:131], v23 offset:21856
    ds_read_b64 v[132:133], v23 offset:21864
    ds_read_b64 v[134:135], v23 offset:21872
    s_waitcnt lgkmcnt(5)
    v_dot2_f32_bf16 v170, v136, v164, v170
    v_dot2_f32_bf16 v171, v136, v165, v171
    v_dot2_f32_bf16 v172, v137, v164, v172
    v_dot2_f32_bf16 v173, v137, v165, v173
    v_dot2_f32_bf16 v174, v138, v164, v174
    v_dot2_f32_bf16 v175, v138, v165, v175
    v_dot2_f32_bf16 v176, v139, v164, v176
    v_dot2_f32_bf16 v177, v139, v165, v177
    v_dot2_f32_bf16 v178, v140, v164, v178
    v_dot2_f32_bf16 v179, v140, v165, v179
    v_dot2_f32_bf16 v180, v141, v164, v180
    v_dot2_f32_bf16 v181, v141, v165, v181
    v_dot2_f32_bf16 v182, v142, v164, v182
    v_dot2_f32_bf16 v183, v142, v165, v183
    v_dot2_f32_bf16 v184, v143, v164, v184
    v_dot2_f32_bf16 v185, v143, v165, v185
    v_dot2_f32_bf16 v186, v144, v164, v186
    v_dot2_f32_bf16 v187, v144, v165, v187
    v_dot2_f32_bf16 v188, v145, v164, v188
    v_dot2_f32_bf16 v189, v145, v165, v189
    ds_read_b64 v[136:137], v23 offset:21504
    ds_read_b64 v[138:139], v23 offset:21512
    ds_read_b64 v[140:141], v23 offset:21520
    ds_read_b64 v[142:143], v23 offset:21528
    ds_read_b64 v[144:145], v23 offset:21536
    s_waitcnt lgkmcnt(5)
    v_dot2_f32_bf16 v170, v126, v166, v170
    v_dot2_f32_bf16 v171, v126, v167, v171
    v_dot2_f32_bf16 v172, v127, v166, v172
    v_dot2_f32_bf16 v173, v127, v167, v173
    v_dot2_f32_bf16 v174, v128, v166, v174
    v_dot2_f32_bf16 v175, v128, v167, v175
    v_dot2_f32_bf16 v176, v129, v166, v176
    v_dot2_f32_bf16 v177, v129, v167, v177
    v_dot2_f32_bf16 v178, v130, v166, v178
    v_dot2_f32_bf16 v179, v130, v167, v179
    v_dot2_f32_bf16 v180, v131, v166, v180
    v_dot2_f32_bf16 v181, v131, v167, v181
    v_dot2_f32_bf16 v182, v132, v166, v182
    v_dot2_f32_bf16 v183, v132, v167, v183
    v_dot2_f32_bf16 v184, v133, v166, v184
    v_dot2_f32_bf16 v185, v133, v167, v185
    v_dot2_f32_bf16 v186, v134, v166, v186
    v_dot2_f32_bf16 v187, v134, v167, v187
    v_dot2_f32_bf16 v188, v135, v166, v188
    v_dot2_f32_bf16 v189, v135, v167, v189
    s_waitcnt lgkmcnt(0)
    v_dot2_f32_bf16 v170, v136, v168, v170
    v_dot2_f32_bf16 v171, v136, v169, v171
    v_dot2_f32_bf16 v172, v137, v168, v172
    v_dot2_f32_bf16 v173, v137, v169, v173
    v_dot2_f32_bf16 v174, v138, v168, v174
    v_dot2_f32_bf16 v175, v138, v169, v175
    v_dot2_f32_bf16 v176, v139, v168, v176
    v_dot2_f32_bf16 v177, v139, v169, v177
    v_dot2_f32_bf16 v178, v140, v168, v178
    v_dot2_f32_bf16 v179, v140, v169, v179
    v_dot2_f32_bf16 v180, v141, v168, v180
    v_dot2_f32_bf16 v181, v141, v169, v181
    v_dot2_f32_bf16 v182, v142, v168, v182
    v_dot2_f32_bf16 v183, v142, v169, v183
    v_dot2_f32_bf16 v184, v143, v168, v184
    v_dot2_f32_bf16 v185, v143, v169, v185
    v_dot2_f32_bf16 v186, v144, v168, v186
    v_dot2_f32_bf16 v187, v144, v169, v187
    v_dot2_f32_bf16 v188, v145, v168, v188
    v_dot2_f32_bf16 v189, v145, v169, v189
    v_cvt_pk_bf16_f32 v116, v170, v171
    v_cvt_pk_bf16_f32 v117, v172, v173
    v_cvt_pk_bf16_f32 v118, v174, v175
    v_cvt_pk_bf16_f32 v119, v176, v177
    v_cvt_pk_bf16_f32 v120, v178, v179
    v_cvt_pk_bf16_f32 v121, v180, v181
    v_cvt_pk_bf16_f32 v122, v182, v183
    v_cvt_pk_bf16_f32 v123, v184, v185
    v_cvt_pk_bf16_f32 v124, v186, v187
    v_cvt_pk_bf16_f32 v125, v188, v189
    ds_write_b64 v22, v[116:117] offset:0
    ds_write_b64 v22, v[118:119] offset:8
    ds_write_b64 v22, v[120:121] offset:16
    ds_write_b64 v22, v[122:123] offset:24
    ds_write_b64 v22, v[124:125] offset:32
    s_waitcnt lgkmcnt(0)
    s_add_u32 s50, s50, 80
    s_cmp_lt_u32 s50, 160
    s_cbranch_scc1 L_pa_att
    s_cmp_lg_u32 s48, 0
    s_cbranch_scc1 L_pa_o1
    ds_read_b64 a[160:161], v28 offset:32
    ds_read_b64 a[162:163], v28 offset:40
    ds_read_b64 a[240:241], v28 offset:2720
    ds_read_b64 a[242:243], v28 offset:2728
    ds_read_b64 a[164:165], v28 offset:96
    ds_read_b64 a[166:167], v28 offset:104
    ds_read_b64 a[244:245], v28 offset:2784
    ds_read_b64 a[246:247], v28 offset:2792
    s_mov_b32 exec_hi, 0
    ds_read_b64 a[168:169], v28 offset:160
    ds_read_b64 a[170:171], v28 offset:168
    ds_read_b64 a[248:249], v28 offset:2848
    ds_read_b64 a[250:251], v28 offset:2856
    s_mov_b64 exec, -1
    s_branch L_pa_oe
L_pa_o1:
    s_cmp_lg_u32 s48, 1
    s_cbranch_scc1 L_pa_o2
    s_mov_b32 exec_lo, 0
    ds_read_b64 a[168:169], v28 offset:0
    ds_read_b64 a[170:171], v28 offset:8
    ds_read_b64 a[248:249], v28 offset:2688
    ds_read_b64 a[250:251], v28 offset:2696
    s_mov_b64 exec, -1
    ds_read_b64 a[172:173], v28 offset:64
    ds_read_b64 a[174:175], v28 offset:72
    ds_read_b64 a[252:253], v28 offset:2752
    ds_read_b64 a[254:255], v28 offset:2760
    ds_read_b64 a[176:177], v28 offset:128
    ds_read_b64 a[178:179], v28 offset:136
    ds_read_b64 v[32:33], v28 offset:2816
    ds_read_b64 v[34:35], v28 offset:2824
    s_branch L_pa_oe
L_pa_o2:
    s_cmp_lg_u32 s48, 2
    s_cbranch_scc1 L_pa_o3
    ds_read_b64 a[180:181], v28 offset:32
    ds_read_b64 a[182:183], v28 offset:40
    ds_read_b64 v[36:37], v28 offset:2720
    ds_read_b64 v[38:39], v28 offset:2728
    ds_read_b64 a[184:185], v28 offset:96
    ds_read_b64 a[186:187], v28 offset:104
    ds_read_b64 v[40:41], v28 offset:2784
    ds_read_b64 v[42:43], v28 offset:2792
    s_mov_b32 exec_hi, 0
    ds_read_b64 a[188:189], v28 offset:160
    ds_read_b64 a[190:191], v28 offset:168
    ds_read_b64 v[44:45], v28 offset:2848
    ds_read_b64 v[46:47], v28 offset:2856
    s_mov_b64 exec, -1
    s_branch L_pa_oe
L_pa_o3:
    s_cmp_lg_u32 s48, 3
    s_cbranch_scc1 L_pa_o4
    s_mov_b32 exec_lo, 0
    ds_read_b64 a[188:189], v28 offset:0
    ds_read_b64 a[190:191], v28 offset:8
    ds_read_b64 v[44:45], v28 offset:2688
    ds_read_b64 v[46:47], v28 offset:2696
    s_mov_b64 exec, -1
    ds_read_b64 a[192:193], v28 offset:64
    ds_read_b64 a[194:195], v28 offset:72
    ds_read_b64 v[48:49], v28 offset:2752
    ds_read_b64 v[50:51], v28 offset:2760
    ds_read_b64 a[196:197], v28 offset:128
    ds_read_b64 a[198:199], v28 offset:136
    ds_read_b64 v[52:53], v28 offset:2816
    ds_read_b64 v[54:55], v28 offset:2824
    s_branch L_pa_oe
L_pa_o4:
    s_cmp_lg_u32 s48, 4
    s_cbranch_scc1 L_pa_o5
    ds_read_b64 a[200:201], v28 offset:32
    ds_read_b64 a[202:203], v28 offset:40
    ds_read_b64 v[56:57], v28 offset:2720
    ds_read_b64 v[58:59], v28 offset:2728
    ds_read_b64 a[204:205], v28 offset:96
    ds_read_b64 a[206:207], v28 offset:104
    ds_read_b64 v[60:61], v28 offset:2784
    ds_read_b64 v[62:63], v28 offset:2792
    s_mov_b32 exec_hi, 0
    ds_read_b64 a[208:209], v28 offset:160
    ds_read_b64 a[210:211], v28 offset:168
    ds_read_b64 v[64:65], v28 offset:2848
    ds_read_b64 v[66:67], v28 offset:2856
    s_mov_b64 exec, -1
    s_branch L_pa_oe
L_pa_o5:
    s_cmp_lg_u32 s48, 5
    s_cbranch_scc1 L_pa_o6
    s_mov_b32 exec_lo, 0
    ds_read_b64 a[208:209], v28 offset:0
    ds_read_b64 a[210:211], v28 offset:8
    ds_read_b64 v[64:65], v28 offset:2688
    ds_read_b64 v[66:67], v28 offset:2696
    s_mov_b64 exec, -1
    ds_read_b64 a[212:213], v28 offset:64
    ds_read_b64 a[214:215], v28 offset:72
    ds_read_b64 v[68:69], v28 offset:2752
    ds_read_b64 v[70:71], v28 offset:2760
    ds_read_b64 a[216:217], v28 offset:128
    ds_read_b64 a[218:219], v28 offset:136
    ds_read_b64 v[72:73], v28 offset:2816
    ds_read_b64 v[74:75], v28 offset:2824
    s_branch L_pa_oe
L_pa_o6:
    s_cmp_lg_u32 s48, 6
    s_cbranch_scc1 L_pa_o7
    ds_read_b64 a[220:221], v28 offset:32
    ds_read_b64 a[222:223], v28 offset:40
    ds_read_b64 v[76:77], v28 offset:2720
    ds_read_b64 v[78:79], v28 offset:2728
    ds_read_b64 a[224:225], v28 offset:96
    ds_read_b64 a[226:227], v28 offset:104
    ds_read_b64 v[80:81], v28 offset:2784
    ds_read_b64 v[82:83], v28 offset:2792
    s_mov_b32 exec_hi, 0
    ds_read_b64 a[228:229], v28 offset:160
    ds_read_b64 a[230:231], v28 offset:168
    ds_read_b64 v[84:85], v28 offset:2848
    ds_read_b64 v[86:87], v28 offset:2856
    s_mov_b64 exec, -1
    s_branch L_pa_oe
L_pa_o7:
    s_mov_b32 exec_lo, 0
    ds_read_b64 a[228:229], v28 offset:0
    ds_read_b64 a[230:231], v28 offset:8
    ds_read_b64 v[84:85], v28 offset:2688
    ds_read_b64 v[86:87], v28 offset:2696
    s_mov_b64 exec, -1
    ds_read_b64 a[232:233], v28 offset:64
    ds_read_b64 a[234:235], v28 offset:72
    ds_read_b64 v[88:89], v28 offset:2752
    ds_read_b64 v[90:91], v28 offset:2760
    ds_read_b64 a[236:237], v28 offset:128
    ds_read_b64 a[238:239], v28 offset:136
    ds_read_b64 v[92:93], v28 offset:2816
    ds_read_b64 v[94:95], v28 offset:2824
L_pa_oe:
    s_waitcnt lgkmcnt(0)
    s_add_u32 s48, s48, 1
    s_and_b32 s48, s48, 7
    s_cmp_lg_u32 s48, s52
    s_cbranch_scc1 L_pa_grp
    v_add_u32 v3, 0, v0
    v_mul_u32_u24 v4, 6554, v3
    v_lshrrev_b32 v4, 16, v4
    v_mul_u32_u24 v5, 10, v4
    v_sub_u32 v5, v3, v5
    v_and_b32 v6, 19, v4
    v_and_b32 v7, 4, v4
    v_lshl_or_b32 v6, v7, 1, v6
    v_and_b32 v7, 8, v4
    v_lshrrev_b32 v7, 1, v7
    v_or_b32 v6, v6, v7
    s_lshl_b32 s90, s32, 5
    v_add_u32 v6, s90, v6
    v_mul_u32_u24 v6, 1280, v6
    v_lshl_add_u32 v10, v5, 4, v6
    v_add_u32 v3, 64, v0
    v_mul_u32_u24 v4, 6554, v3
    v_lshrrev_b32 v4, 16, v4
    v_mul_u32_u24 v5, 10, v4
    v_sub_u32 v5, v3, v5
    v_and_b32 v6, 19, v4
    v_and_b32 v7, 4, v4
    v_lshl_or_b32 v6, v7, 1, v6
    v_and_b32 v7, 8, v4
    v_lshrrev_b32 v7, 1, v7
    v_or_b32 v6, v6, v7
    s_lshl_b32 s90, s32, 5
    v_add_u32 v6, s90, v6
    v_mul_u32_u24 v6, 1280, v6
    v_lshl_add_u32 v11, v5, 4, v6
    v_add_u32 v3, 128, v0
    v_mul_u32_u24 v4, 6554, v3
    v_lshrrev_b32 v4, 16, v4
    v_mul_u32_u24 v5, 10, v4
    v_sub_u32 v5, v3, v5
    v_and_b32 v6, 19, v4
    v_and_b32 v7, 4, v4
    v_lshl_or_b32 v6, v7, 1, v6
    v_and_b32 v7, 8, v4
    v_lshrrev_b32 v7, 1, v7
    v_or_b32 v6, v6, v7
    s_lshl_b32 s90, s32, 5
    v_add_u32 v6, s90, v6
    v_mul_u32_u24 v6, 1280, v6
    v_lshl_add_u32 v12, v5, 4, v6
    v_add_u32 v3, 192, v0
    v_mul_u32_u24 v4, 6554, v3
    v_lshrrev_b32 v4, 16, v4
    v_mul_u32_u24 v5, 10, v4
    v_sub_u32 v5, v3, v5
    v_and_b32 v6, 19, v4
    v_and_b32 v7, 4, v4
    v_lshl_or_b32 v6, v7, 1, v6
    v_and_b32 v7, 8, v4
    v_lshrrev_b32 v7, 1, v7
    v_or_b32 v6, v6, v7
    s_lshl_b32 s90, s32, 5
    v_add_u32 v6, s90, v6
    v_mul_u32_u24 v6, 1280, v6
    v_lshl_add_u32 v13, v5, 4, v6
    v_add_u32 v3, 256, v0
    v_mul_u32_u24 v4, 6554, v3
    v_lshrrev_b32 v4, 16, v4
    v_mul_u32_u24 v5, 10, v4
    v_sub_u32 v5, v3, v5
    v_and_b32 v6, 19, v4
    v_and_b32 v7, 4, v4
    v_lshl_or_b32 v6, v7, 1, v6
    v_and_b32 v7, 8, v4
    v_lshrrev_b32 v7, 1, v7
    v_or_b32 v6, v6, v7
    s_lshl_b32 s90, s32, 5
    v_add_u32 v6, s90, v6
    v_mul_u32_u24 v6, 1280, v6
    v_lshl_add_u32 v14, v5, 4, v6
    s_waitcnt vmcnt(0) lgkmcnt(0)
    s_barrier
    s_mov_b32 s46, 0
    s_mov_b32 s47, 0
    s_mul_i32 s43, s52, 160
    s_mov_b32 s44, 0
    s_mov_b32 s45, 0
    s_mov_b32 s51, 39
    s_mov_b32 s48, s52
    s_mov_b32 s53, 0
    s_mul_i32 s90, s32, 5120
    s_add_u32 m0, s90, s47
    s_mul_i32 s91, s44, 163840
    s_add_u32 s91, s91, s43
    buffer_load_dwordx4 v10, s[20:23], s91 offen lds
    s_add_u32 s47, s47, 20480
    s_cmp_eq_u32 s47, 81920
    s_cselect_b32 s47, 0, s47
    s_cmp_lg_u32 s51, 0
    s_cselect_b32 s90, 1, 0
    s_sub_u32 s51, s51, s90
    s_add_u32 s44, s44, s90
    s_cmp_eq_u32 s44, 5
    s_cselect_b32 s44, 0, s44
    s_cselect_b32 s90, 160, 0
    s_add_u32 s43, s43, s90
    s_cmp_eq_u32 s43, 1280
    s_cselect_b32 s43, 0, s43
    s_add_u32 m0, m0, 1024
    s_nop 0
    buffer_load_dwordx4 v11, s[20:23], s91 offen lds
    s_add_u32 m0, m0, 1024
    s_nop 0
    buffer_load_dwordx4 v12, s[20:23], s91 offen lds
    s_add_u32 m0, m0, 1024
    s_nop 0
    buffer_load_dwordx4 v13, s[20:23], s91 offen lds
    s_add_u32 m0, m0, 1024
    s_nop 0
    buffer_load_dwordx4 v14, s[20:23], s91 offen lds
    s_mul_i32 s90, s32, 5120
    s_add_u32 m0, s90, s47
    s_mul_i32 s91, s44, 163840
    s_add_u32 s91, s91, s43
    buffer_load_dwordx4 v10, s[20:23], s91 offen lds
    s_add_u32 s47, s47, 20480
    s_cmp_eq_u32 s47, 81920
    s_cselect_b32 s47, 0, s47
    s_cmp_lg_u32 s51, 0
    s_cselect_b32 s90, 1, 0
    s_sub_u32 s51, s51, s90
    s_add_u32 s44, s44, s90
    s_cmp_eq_u32 s44, 5
    s_cselect_b32 s44, 0, s44
    s_cselect_b32 s90, 160, 0
    s_add_u32 s43, s43, s90
    s_cmp_eq_u32 s43, 1280
    s_cselect_b32 s43, 0, s43
    s_add_u32 m0, m0, 1024
    s_nop 0
    buffer_load_dwordx4 v11, s[20:23], s91 offen lds
    s_add_u32 m0, m0, 1024
    s_nop 0
    buffer_load_dwordx4 v12, s[20:23], s91 offen lds
    s_add_u32 m0, m0, 1024
    s_nop 0
    buffer_load_dwordx4 v13, s[20:23], s91 offen lds
    s_add_u32 m0, m0, 1024
    s_nop 0
    buffer_load_dwordx4 v14, s[20:23], s91 offen lds
    s_mul_i32 s90, s32, 5120
    s_add_u32 m0, s90, s47
    s_mul_i32 s91, s44, 163840
    s_add_u32 s91, s91, s43
    buffer_load_dwordx4 v10, s[20:23], s91 offen lds
    s_add_u32 s47, s47, 20480
    s_cmp_eq_u32 s47, 81920
    s_cselect_b32 s47, 0, s47
    s_cmp_lg_u32 s51, 0
    s_cselect_b32 s90, 1, 0
    s_sub_u32 s51, s51, s90
    s_add_u32 s44, s44, s90
    s_cmp_eq_u32 s44, 5
    s_cselect_b32 s44, 0, s44
    s_cselect_b32 s90, 160, 0
    s_add_u32 s43, s43, s90
    s_cmp_eq_u32 s43, 1280
    s_cselect_b32 s43, 0, s43
    s_add_u32 m0, m0, 1024
    s_nop 0
    buffer_load_dwordx4 v11, s[20:23], s91 offen lds
    s_add_u32 m0, m0, 1024
    s_nop 0
    buffer_load_dwordx4 v12, s[20:23], s91 offen lds
    s_add_u32 m0, m0, 1024
    s_nop 0
    buffer_load_dwordx4 v13, s[20:23], s91 offen lds
    s_add_u32 m0, m0, 1024
    s_nop 0
    buffer_load_dwordx4 v14, s[20:23], s91 offen lds
    v_add_u32 v16, s46, v15
    s_waitcnt vmcnt(10) lgkmcnt(0)
    s_barrier
    ds_read_b64_tr_b16 v[96:97], v16 offset:0
    ds_read_b64_tr_b16 v[98:99], v16 offset:1280
    ds_read_b64_tr_b16 v[100:101], v16 offset:32
    ds_read_b64_tr_b16 v[102:103], v16 offset:1312
    ds_read_b64_tr_b16 v[104:105], v16 offset:64
    ds_read_b64_tr_b16 v[106:107], v16 offset:1344
    ds_read_b64_tr_b16 v[108:109], v16 offset:96
    ds_read_b64_tr_b16 v[110:111], v16 offset:1376
    ds_read_b64_tr_b16 v[112:113], v16 offset:128
    ds_read_b64_tr_b16 v[114:115], v16 offset:1408
    s_mul_i32 s42, s52, 160
L_pa_oblk:
    s_waitcnt lgkmcnt(8)
    v_mfma_f32_16x16x32_bf16 v[136:139], v[96:99], a[160:163], 0
    ds_read_b64_tr_b16 v[116:117], v16 offset:5120
    s_add_u32 s46, s46, 20480
    s_cmp_eq_u32 s46, 81920
    v_mfma_f32_16x16x32_bf16 v[140:143], v[96:99], a[240:243], 0
    ds_read_b64_tr_b16 v[118:119], v16 offset:6400
    s_cselect_b32 s46, 0, s46
    s_mul_i32 s90, s32, 5120
    s_waitcnt lgkmcnt(8)
    v_mfma_f32_16x16x32_bf16 v[144:147], v[100:103], a[160:163], 0
    ds_read_b64_tr_b16 v[120:121], v16 offset:5152
    s_add_u32 m0, s90, s47
    s_mul_i32 s91, s44, 163840
    v_mfma_f32_16x16x32_bf16 v[148:151], v[100:103], a[240:243], 0
    ds_read_b64_tr_b16 v[122:123], v16 offset:6432
    s_add_u32 s91, s91, s43
    buffer_load_dwordx4 v10, s[20:23], s91 offen lds
    s_waitcnt lgkmcnt(8)
    v_mfma_f32_16x16x32_bf16 v[152:155], v[104:107], a[160:163], 0
    ds_read_b64_tr_b16 v[124:125], v16 offset:5184
    s_add_u32 s47, s47, 20480
    s_cmp_eq_u32 s47, 81920
    v_mfma_f32_16x16x32_bf16 v[156:159], v[104:107], a[240:243], 0
    ds_read_b64_tr_b16 v[126:127], v16 offset:6464
    s_cselect_b32 s47, 0, s47
    s_cmp_lg_u32 s51, 0
    s_waitcnt lgkmcnt(8)
    v_mfma_f32_16x16x32_bf16 v[160:163], v[108:111], a[160:163], 0
    ds_read_b64_tr_b16 v[128:129], v16 offset:5216
    s_cselect_b32 s90, 1, 0
    s_sub_u32 s51, s51, s90
    v_mfma_f32_16x16x32_bf16 v[164:167], v[108:111], a[240:243], 0
    ds_read_b64_tr_b16 v[130:131], v16 offset:6496
    s_add_u32 s44, s44, s90
    s_cmp_eq_u32 s44, 5
    s_waitcnt lgkmcnt(8)
    v_mfma_f32_16x16x32_bf16 v[168:171], v[112:115], a[160:163], 0
    ds_read_b64_tr_b16 v[132:133], v16 offset:5248
    s_cselect_b32 s44, 0, s44
    s_cselect_b32 s90, 160, 0
    v_mfma_f32_16x16x32_bf16 v[172:175], v[112:115], a[240:243], 0
    ds_read_b64_tr_b16 v[134:135], v16 offset:6528
    s_add_u32 s43, s43, s90
    s_cmp_eq_u32 s43, 1280
    s_waitcnt lgkmcnt(8)
    v_mfma_f32_16x16x32_bf16 v[136:139], v[116:119], a[164:167], v[136:139]
    ds_read_b64_tr_b16 v[96:97], v16 offset:10240
    s_cselect_b32 s43, 0, s43
    s_add_u32 m0, m0, 1024
    v_mfma_f32_16x16x32_bf16 v[140:143], v[116:119], a[244:247], v[140:143]
    ds_read_b64_tr_b16 v[98:99], v16 offset:11520
    buffer_load_dwordx4 v11, s[20:23], s91 offen lds
    s_add_u32 m0, m0, 1024
    s_waitcnt lgkmcnt(8)
    v_mfma_f32_16x16x32_bf16 v[144:147], v[120:123], a[164:167], v[144:147]
    ds_read_b64_tr_b16 v[100:101], v16 offset:10272
    v_mfma_f32_16x16x32_bf16 v[148:151], v[120:123], a[244:247], v[148:151]
    ds_read_b64_tr_b16 v[102:103], v16 offset:11552
    s_waitcnt lgkmcnt(8)
    v_mfma_f32_16x16x32_bf16 v[152:155], v[124:127], a[164:167], v[152:155]
    ds_read_b64_tr_b16 v[104:105], v16 offset:10304
    v_mfma_f32_16x16x32_bf16 v[156:159], v[124:127], a[244:247], v[156:159]
    ds_read_b64_tr_b16 v[106:107], v16 offset:11584
    s_waitcnt lgkmcnt(8)
    v_mfma_f32_16x16x32_bf16 v[160:163], v[128:131], a[164:167], v[160:163]
    ds_read_b64_tr_b16 v[108:109], v16 offset:10336
    buffer_load_dwordx4 v12, s[20:23], s91 offen lds
    s_add_u32 m0, m0, 1024
    v_mfma_f32_16x16x32_bf16 v[164:167], v[128:131], a[244:247], v[164:167]
    ds_read_b64_tr_b16 v[110:111], v16 offset:11616
    s_waitcnt lgkmcnt(8)
    v_mfma_f32_16x16x32_bf16 v[168:171], v[132:135], a[164:167], v[168:171]
    ds_read_b64_tr_b16 v[112:113], v16 offset:10368
    v_mfma_f32_16x16x32_bf16 v[172:175], v[132:135], a[244:247], v[172:175]
    ds_read_b64_tr_b16 v[114:115], v16 offset:11648
    s_waitcnt lgkmcnt(8)
    v_mfma_f32_16x16x32_bf16 v[136:139], v[96:99], a[168:171], v[136:139]
    ds_read_b64_tr_b16 v[116:117], v16 offset:15360
    v_mfma_f32_16x16x32_bf16 v[140:143], v[96:99], a[248:251], v[140:143]
    ds_read_b64_tr_b16 v[118:119], v16 offset:16640
    buffer_load_dwordx4 v13, s[20:23], s91 offen lds
    s_add_u32 m0, m0, 1024
    s_waitcnt lgkmcnt(8)
    v_mfma_f32_16x16x32_bf16 v[144:147], v[100:103], a[168:171], v[144:147]
    ds_read_b64_tr_b16 v[120:121], v16 offset:15392
    v_mfma_f32_16x16x32_bf16 v[148:151], v[100:103], a[248:251], v[148:151]
    ds_read_b64_tr_b16 v[122:123], v16 offset:16672
    s_waitcnt lgkmcnt(8)
    v_mfma_f32_16x16x32_bf16 v[152:155], v[104:107], a[168:171], v[152:155]
    ds_read_b64_tr_b16 v[124:125], v16 offset:15424
    v_mfma_f32_16x16x32_bf16 v[156:159], v[104:107], a[248:251], v[156:159]
    ds_read_b64_tr_b16 v[126:127], v16 offset:16704
    s_waitcnt lgkmcnt(8)
    v_mfma_f32_16x16x32_bf16 v[160:163], v[108:111], a[168:171], v[160:163]
    ds_read_b64_tr_b16 v[128:129], v16 offset:15456
    buffer_load_dwordx4 v14, s[20:23], s91 offen lds
    v_mfma_f32_16x16x32_bf16 v[164:167], v[108:111], a[248:251], v[164:167]
    ds_read_b64_tr_b16 v[130:131], v16 offset:16736
    s_waitcnt lgkmcnt(8)
    v_mfma_f32_16x16x32_bf16 v[168:171], v[112:115], a[168:171], v[168:171]
    ds_read_b64_tr_b16 v[132:133], v16 offset:15488
    v_mfma_f32_16x16x32_bf16 v[172:175], v[112:115], a[248:251], v[172:175]
    ds_read_b64_tr_b16 v[134:135], v16 offset:16768
    s_waitcnt lgkmcnt(8)
    v_mfma_f32_16x16x32_bf16 v[136:139], v[116:119], a[172:175], v[136:139]
    v_mfma_f32_16x16x32_bf16 v[140:143], v[116:119], a[252:255], v[140:143]
    s_waitcnt lgkmcnt(6)
    v_mfma_f32_16x16x32_bf16 v[144:147], v[120:123], a[172:175], v[144:147]
    v_mfma_f32_16x16x32_bf16 v[148:151], v[120:123], a[252:255], v[148:151]
    v_add_u32 v16, s46, v15
    s_waitcnt vmcnt(10) lgkmcnt(0)
    s_barrier
    v_mfma_f32_16x16x32_bf16 v[152:155], v[124:127], a[172:175], v[152:155]
    ds_read_b64_tr_b16 v[96:97], v16 offset:0
    ds_read_b64_tr_b16 v[98:99], v16 offset:1280
    v_mfma_f32_16x16x32_bf16 v[156:159], v[124:127], a[252:255], v[156:159]
    ds_read_b64_tr_b16 v[100:101], v16 offset:32
    ds_read_b64_tr_b16 v[102:103], v16 offset:1312
    v_mfma_f32_16x16x32_bf16 v[160:163], v[128:131], a[172:175], v[160:163]
    ds_read_b64_tr_b16 v[104:105], v16 offset:64
    ds_read_b64_tr_b16 v[106:107], v16 offset:1344
    v_mfma_f32_16x16x32_bf16 v[164:167], v[128:131], a[252:255], v[164:167]
    ds_read_b64_tr_b16 v[108:109], v16 offset:96
    ds_read_b64_tr_b16 v[110:111], v16 offset:1376
    v_mfma_f32_16x16x32_bf16 v[168:171], v[132:135], a[172:175], v[168:171]
    ds_read_b64_tr_b16 v[112:113], v16 offset:128
    ds_read_b64_tr_b16 v[114:115], v16 offset:1408
    v_mfma_f32_16x16x32_bf16 v[172:175], v[132:135], a[252:255], v[172:175]
    s_waitcnt lgkmcnt(8)
    v_mfma_f32_16x16x32_bf16 v[136:139], v[96:99], a[176:179], v[136:139]
    ds_read_b64_tr_b16 v[116:117], v16 offset:5120
    s_add_u32 s46, s46, 20480
    s_cmp_eq_u32 s46, 81920
    v_mfma_f32_16x16x32_bf16 v[140:143], v[96:99], v[32:35], v[140:143]
    ds_read_b64_tr_b16 v[118:119], v16 offset:6400
    s_cselect_b32 s46, 0, s46
    s_mul_i32 s90, s32, 5120
    s_waitcnt lgkmcnt(8)
    v_mfma_f32_16x16x32_bf16 v[144:147], v[100:103], a[176:179], v[144:147]
    ds_read_b64_tr_b16 v[120:121], v16 offset:5152
    s_add_u32 m0, s90, s47
    s_mul_i32 s91, s44, 163840
    v_mfma_f32_16x16x32_bf16 v[148:151], v[100:103], v[32:35], v[148:151]
    ds_read_b64_tr_b16 v[122:123], v16 offset:6432
    s_add_u32 s91, s91, s43
    buffer_load_dwordx4 v10, s[20:23], s91 offen lds
    s_waitcnt lgkmcnt(8)
    v_mfma_f32_16x16x32_bf16 v[152:155], v[104:107], a[176:179], v[152:155]
    ds_read_b64_tr_b16 v[124:125], v16 offset:5184
    s_add_u32 s47, s47, 20480
    s_cmp_eq_u32 s47, 81920
    v_mfma_f32_16x16x32_bf16 v[156:159], v[104:107], v[32:35], v[156:159]
    ds_read_b64_tr_b16 v[126:127], v16 offset:6464
    s_cselect_b32 s47, 0, s47
    s_cmp_lg_u32 s51, 0
    s_waitcnt lgkmcnt(8)
    v_mfma_f32_16x16x32_bf16 v[160:163], v[108:111], a[176:179], v[160:163]
    ds_read_b64_tr_b16 v[128:129], v16 offset:5216
    s_cselect_b32 s90, 1, 0
    s_sub_u32 s51, s51, s90
    v_mfma_f32_16x16x32_bf16 v[164:167], v[108:111], v[32:35], v[164:167]
    ds_read_b64_tr_b16 v[130:131], v16 offset:6496
    s_add_u32 s44, s44, s90
    s_cmp_eq_u32 s44, 5
    s_waitcnt lgkmcnt(8)
    v_mfma_f32_16x16x32_bf16 v[168:171], v[112:115], a[176:179], v[168:171]
    ds_read_b64_tr_b16 v[132:133], v16 offset:5248
    s_cselect_b32 s44, 0, s44
    s_cselect_b32 s90, 160, 0
    v_mfma_f32_16x16x32_bf16 v[172:175], v[112:115], v[32:35], v[172:175]
    ds_read_b64_tr_b16 v[134:135], v16 offset:6528
    s_add_u32 s43, s43, s90
    s_cmp_eq_u32 s43, 1280
    s_waitcnt lgkmcnt(8)
    v_mfma_f32_16x16x32_bf16 v[136:139], v[116:119], a[180:183], v[136:139]
    ds_read_b64_tr_b16 v[96:97], v16 offset:10240
    s_cselect_b32 s43, 0, s43
    s_add_u32 m0, m0, 1024
    v_mfma_f32_16x16x32_bf16 v[140:143], v[116:119], v[36:39], v[140:143]
    ds_read_b64_tr_b16 v[98:99], v16 offset:11520
    buffer_load_dwordx4 v11, s[20:23], s91 offen lds
    s_add_u32 m0, m0, 1024
    s_waitcnt lgkmcnt(8)
    v_mfma_f32_16x16x32_bf16 v[144:147], v[120:123], a[180:183], v[144:147]
    ds_read_b64_tr_b16 v[100:101], v16 offset:10272
    v_mfma_f32_16x16x32_bf16 v[148:151], v[120:123], v[36:39], v[148:151]
    ds_read_b64_tr_b16 v[102:103], v16 offset:11552
    s_waitcnt lgkmcnt(8)
    v_mfma_f32_16x16x32_bf16 v[152:155], v[124:127], a[180:183], v[152:155]
    ds_read_b64_tr_b16 v[104:105], v16 offset:10304
    v_mfma_f32_16x16x32_bf16 v[156:159], v[124:127], v[36:39], v[156:159]
    ds_read_b64_tr_b16 v[106:107], v16 offset:11584
    s_waitcnt lgkmcnt(8)
    v_mfma_f32_16x16x32_bf16 v[160:163], v[128:131], a[180:183], v[160:163]
    ds_read_b64_tr_b16 v[108:109], v16 offset:10336
    buffer_load_dwordx4 v12, s[20:23], s91 offen lds
    s_add_u32 m0, m0, 1024
    v_mfma_f32_16x16x32_bf16 v[164:167], v[128:131], v[36:39], v[164:167]
    ds_read_b64_tr_b16 v[110:111], v16 offset:11616
    s_waitcnt lgkmcnt(8)
    v_mfma_f32_16x16x32_bf16 v[168:171], v[132:135], a[180:183], v[168:171]
    ds_read_b64_tr_b16 v[112:113], v16 offset:10368
    v_mfma_f32_16x16x32_bf16 v[172:175], v[132:135], v[36:39], v[172:175]
    ds_read_b64_tr_b16 v[114:115], v16 offset:11648
    s_waitcnt lgkmcnt(8)
    v_mfma_f32_16x16x32_bf16 v[136:139], v[96:99], a[184:187], v[136:139]
    ds_read_b64_tr_b16 v[116:117], v16 offset:15360
    v_mfma_f32_16x16x32_bf16 v[140:143], v[96:99], v[40:43], v[140:143]
    ds_read_b64_tr_b16 v[118:119], v16 offset:16640
    buffer_load_dwordx4 v13, s[20:23], s91 offen lds
    s_add_u32 m0, m0, 1024
    s_waitcnt lgkmcnt(8)
    v_mfma_f32_16x16x32_bf16 v[144:147], v[100:103], a[184:187], v[144:147]
    ds_read_b64_tr_b16 v[120:121], v16 offset:15392
    v_mfma_f32_16x16x32_bf16 v[148:151], v[100:103], v[40:43], v[148:151]
    ds_read_b64_tr_b16 v[122:123], v16 offset:16672
    s_waitcnt lgkmcnt(8)
    v_mfma_f32_16x16x32_bf16 v[152:155], v[104:107], a[184:187], v[152:155]
    ds_read_b64_tr_b16 v[124:125], v16 offset:15424
    v_mfma_f32_16x16x32_bf16 v[156:159], v[104:107], v[40:43], v[156:159]
    ds_read_b64_tr_b16 v[126:127], v16 offset:16704
    s_waitcnt lgkmcnt(8)
    v_mfma_f32_16x16x32_bf16 v[160:163], v[108:111], a[184:187], v[160:163]
    ds_read_b64_tr_b16 v[128:129], v16 offset:15456
    buffer_load_dwordx4 v14, s[20:23], s91 offen lds
    v_mfma_f32_16x16x32_bf16 v[164:167], v[108:111], v[40:43], v[164:167]
    ds_read_b64_tr_b16 v[130:131], v16 offset:16736
    s_waitcnt lgkmcnt(8)
    v_mfma_f32_16x16x32_bf16 v[168:171], v[112:115], a[184:187], v[168:171]
    ds_read_b64_tr_b16 v[132:133], v16 offset:15488
    v_mfma_f32_16x16x32_bf16 v[172:175], v[112:115], v[40:43], v[172:175]
    ds_read_b64_tr_b16 v[134:135], v16 offset:16768
    s_waitcnt lgkmcnt(8)
    v_mfma_f32_16x16x32_bf16 v[136:139], v[116:119], a[188:191], v[136:139]
    v_mfma_f32_16x16x32_bf16 v[140:143], v[116:119], v[44:47], v[140:143]
    s_waitcnt lgkmcnt(6)
    v_mfma_f32_16x16x32_bf16 v[144:147], v[120:123], a[188:191], v[144:147]
    v_mfma_f32_16x16x32_bf16 v[148:151], v[120:123], v[44:47], v[148:151]
    v_add_u32 v16, s46, v15
    s_waitcnt vmcnt(10) lgkmcnt(0)
    s_barrier
    v_mfma_f32_16x16x32_bf16 v[152:155], v[124:127], a[188:191], v[152:155]
    ds_read_b64_tr_b16 v[96:97], v16 offset:0
    ds_read_b64_tr_b16 v[98:99], v16 offset:1280
    v_mfma_f32_16x16x32_bf16 v[156:159], v[124:127], v[44:47], v[156:159]
    ds_read_b64_tr_b16 v[100:101], v16 offset:32
    ds_read_b64_tr_b16 v[102:103], v16 offset:1312
    v_mfma_f32_16x16x32_bf16 v[160:163], v[128:131], a[188:191], v[160:163]
    ds_read_b64_tr_b16 v[104:105], v16 offset:64
    ds_read_b64_tr_b16 v[106:107], v16 offset:1344
    v_mfma_f32_16x16x32_bf16 v[164:167], v[128:131], v[44:47], v[164:167]
    ds_read_b64_tr_b16 v[108:109], v16 offset:96
    ds_read_b64_tr_b16 v[110:111], v16 offset:1376
    v_mfma_f32_16x16x32_bf16 v[168:171], v[132:135], a[188:191], v[168:171]
    ds_read_b64_tr_b16 v[112:113], v16 offset:128
    ds_read_b64_tr_b16 v[114:115], v16 offset:1408
    v_mfma_f32_16x16x32_bf16 v[172:175], v[132:135], v[44:47], v[172:175]
    s_waitcnt lgkmcnt(8)
    v_mfma_f32_16x16x32_bf16 v[136:139], v[96:99], a[192:195], v[136:139]
    ds_read_b64_tr_b16 v[116:117], v16 offset:5120
    s_add_u32 s46, s46, 20480
    s_cmp_eq_u32 s46, 81920
    v_mfma_f32_16x16x32_bf16 v[140:143], v[96:99], v[48:51], v[140:143]
    ds_read_b64_tr_b16 v[118:119], v16 offset:6400
    s_cselect_b32 s46, 0, s46
    s_mul_i32 s90, s32, 5120
    s_waitcnt lgkmcnt(8)
    v_mfma_f32_16x16x32_bf16 v[144:147], v[100:103], a[192:195], v[144:147]
    ds_read_b64_tr_b16 v[120:121], v16 offset:5152
    s_add_u32 m0, s90, s47
    s_mul_i32 s91, s44, 163840
    v_mfma_f32_16x16x32_bf16 v[148:151], v[100:103], v[48:51], v[148:151]
    ds_read_b64_tr_b16 v[122:123], v16 offset:6432
    s_add_u32 s91, s91, s43
    buffer_load_dwordx4 v10, s[20:23], s91 offen lds
    s_waitcnt lgkmcnt(8)
    v_mfma_f32_16x16x32_bf16 v[152:155], v[104:107], a[192:195], v[152:155]
    ds_read_b64_tr_b16 v[124:125], v16 offset:5184
    s_add_u32 s47, s47, 20480
    s_cmp_eq_u32 s47, 81920
    v_mfma_f32_16x16x32_bf16 v[156:159], v[104:107], v[48:51], v[156:159]
    ds_read_b64_tr_b16 v[126:127], v16 offset:6464
    s_cselect_b32 s47, 0, s47
    s_cmp_lg_u32 s51, 0
    s_waitcnt lgkmcnt(8)
    v_mfma_f32_16x16x32_bf16 v[160:163], v[108:111], a[192:195], v[160:163]
    ds_read_b64_tr_b16 v[128:129], v16 offset:5216
    s_cselect_b32 s90, 1, 0
    s_sub_u32 s51, s51, s90
    v_mfma_f32_16x16x32_bf16 v[164:167], v[108:111], v[48:51], v[164:167]
    ds_read_b64_tr_b16 v[130:131], v16 offset:6496
    s_add_u32 s44, s44, s90
    s_cmp_eq_u32 s44, 5
    s_waitcnt lgkmcnt(8)
    v_mfma_f32_16x16x32_bf16 v[168:171], v[112:115], a[192:195], v[168:171]
    ds_read_b64_tr_b16 v[132:133], v16 offset:5248
    s_cselect_b32 s44, 0, s44
    s_cselect_b32 s90, 160, 0
    v_mfma_f32_16x16x32_bf16 v[172:175], v[112:115], v[48:51], v[172:175]
    ds_read_b64_tr_b16 v[134:135], v16 offset:6528
    s_add_u32 s43, s43, s90
    s_cmp_eq_u32 s43, 1280
    s_waitcnt lgkmcnt(8)
    v_mfma_f32_16x16x32_bf16 v[136:139], v[116:119], a[196:199], v[136:139]
    ds_read_b64_tr_b16 v[96:97], v16 offset:10240
    s_cselect_b32 s43, 0, s43
    s_add_u32 m0, m0, 1024
    v_mfma_f32_16x16x32_bf16 v[140:143], v[116:119], v[52:55], v[140:143]
    ds_read_b64_tr_b16 v[98:99], v16 offset:11520
    buffer_load_dwordx4 v11, s[20:23], s91 offen lds
    s_add_u32 m0, m0, 1024
    s_waitcnt lgkmcnt(8)
    v_mfma_f32_16x16x32_bf16 v[144:147], v[120:123], a[196:199], v[144:147]
    ds_read_b64_tr_b16 v[100:101], v16 offset:10272
    v_mfma_f32_16x16x32_bf16 v[148:151], v[120:123], v[52:55], v[148:151]
    ds_read_b64_tr_b16 v[102:103], v16 offset:11552
    s_waitcnt lgkmcnt(8)
    v_mfma_f32_16x16x32_bf16 v[152:155], v[124:127], a[196:199], v[152:155]
    ds_read_b64_tr_b16 v[104:105], v16 offset:10304
    v_mfma_f32_16x16x32_bf16 v[156:159], v[124:127], v[52:55], v[156:159]
    ds_read_b64_tr_b16 v[106:107], v16 offset:11584
    s_waitcnt lgkmcnt(8)
    v_mfma_f32_16x16x32_bf16 v[160:163], v[128:131], a[196:199], v[160:163]
    ds_read_b64_tr_b16 v[108:109], v16 offset:10336
    buffer_load_dwordx4 v12, s[20:23], s91 offen lds
    s_add_u32 m0, m0, 1024
    v_mfma_f32_16x16x32_bf16 v[164:167], v[128:131], v[52:55], v[164:167]
    ds_read_b64_tr_b16 v[110:111], v16 offset:11616
    s_waitcnt lgkmcnt(8)
    v_mfma_f32_16x16x32_bf16 v[168:171], v[132:135], a[196:199], v[168:171]
    ds_read_b64_tr_b16 v[112:113], v16 offset:10368
    v_mfma_f32_16x16x32_bf16 v[172:175], v[132:135], v[52:55], v[172:175]
    ds_read_b64_tr_b16 v[114:115], v16 offset:11648
    s_waitcnt lgkmcnt(8)
    v_mfma_f32_16x16x32_bf16 v[136:139], v[96:99], a[200:203], v[136:139]
    ds_read_b64_tr_b16 v[116:117], v16 offset:15360
    v_mfma_f32_16x16x32_bf16 v[140:143], v[96:99], v[56:59], v[140:143]
    ds_read_b64_tr_b16 v[118:119], v16 offset:16640
    buffer_load_dwordx4 v13, s[20:23], s91 offen lds
    s_add_u32 m0, m0, 1024
    s_waitcnt lgkmcnt(8)
    v_mfma_f32_16x16x32_bf16 v[144:147], v[100:103], a[200:203], v[144:147]
    ds_read_b64_tr_b16 v[120:121], v16 offset:15392
    v_mfma_f32_16x16x32_bf16 v[148:151], v[100:103], v[56:59], v[148:151]
    ds_read_b64_tr_b16 v[122:123], v16 offset:16672
    s_waitcnt lgkmcnt(8)
    v_mfma_f32_16x16x32_bf16 v[152:155], v[104:107], a[200:203], v[152:155]
    ds_read_b64_tr_b16 v[124:125], v16 offset:15424
    v_mfma_f32_16x16x32_bf16 v[156:159], v[104:107], v[56:59], v[156:159]
    ds_read_b64_tr_b16 v[126:127], v16 offset:16704
    s_waitcnt lgkmcnt(8)
    v_mfma_f32_16x16x32_bf16 v[160:163], v[108:111], a[200:203], v[160:163]
    ds_read_b64_tr_b16 v[128:129], v16 offset:15456
    buffer_load_dwordx4 v14, s[20:23], s91 offen lds
    v_mfma_f32_16x16x32_bf16 v[164:167], v[108:111], v[56:59], v[164:167]
    ds_read_b64_tr_b16 v[130:131], v16 offset:16736
    s_waitcnt lgkmcnt(8)
    v_mfma_f32_16x16x32_bf16 v[168:171], v[112:115], a[200:203], v[168:171]
    ds_read_b64_tr_b16 v[132:133], v16 offset:15488
    v_mfma_f32_16x16x32_bf16 v[172:175], v[112:115], v[56:59], v[172:175]
    ds_read_b64_tr_b16 v[134:135], v16 offset:16768
    s_waitcnt lgkmcnt(8)
    v_mfma_f32_16x16x32_bf16 v[136:139], v[116:119], a[204:207], v[136:139]
    v_mfma_f32_16x16x32_bf16 v[140:143], v[116:119], v[60:63], v[140:143]
    s_waitcnt lgkmcnt(6)
    v_mfma_f32_16x16x32_bf16 v[144:147], v[120:123], a[204:207], v[144:147]
    v_mfma_f32_16x16x32_bf16 v[148:151], v[120:123], v[60:63], v[148:151]
    v_add_u32 v16, s46, v15
    s_waitcnt vmcnt(10) lgkmcnt(0)
    s_barrier
    v_mfma_f32_16x16x32_bf16 v[152:155], v[124:127], a[204:207], v[152:155]
    ds_read_b64_tr_b16 v[96:97], v16 offset:0
    ds_read_b64_tr_b16 v[98:99], v16 offset:1280
    v_mfma_f32_16x16x32_bf16 v[156:159], v[124:127], v[60:63], v[156:159]
    ds_read_b64_tr_b16 v[100:101], v16 offset:32
    ds_read_b64_tr_b16 v[102:103], v16 offset:1312
    v_mfma_f32_16x16x32_bf16 v[160:163], v[128:131], a[204:207], v[160:163]
    ds_read_b64_tr_b16 v[104:105], v16 offset:64
    ds_read_b64_tr_b16 v[106:107], v16 offset:1344
    v_mfma_f32_16x16x32_bf16 v[164:167], v[128:131], v[60:63], v[164:167]
    ds_read_b64_tr_b16 v[108:109], v16 offset:96
    ds_read_b64_tr_b16 v[110:111], v16 offset:1376
    v_mfma_f32_16x16x32_bf16 v[168:171], v[132:135], a[204:207], v[168:171]
    ds_read_b64_tr_b16 v[112:113], v16 offset:128
    ds_read_b64_tr_b16 v[114:115], v16 offset:1408
    v_mfma_f32_16x16x32_bf16 v[172:175], v[132:135], v[60:63], v[172:175]
    s_waitcnt lgkmcnt(8)
    v_mfma_f32_16x16x32_bf16 v[136:139], v[96:99], a[208:211], v[136:139]
    ds_read_b64_tr_b16 v[116:117], v16 offset:5120
    s_add_u32 s46, s46, 20480
    s_cmp_eq_u32 s46, 81920
    v_mfma_f32_16x16x32_bf16 v[140:143], v[96:99], v[64:67], v[140:143]
    ds_read_b64_tr_b16 v[118:119], v16 offset:6400
    s_cselect_b32 s46, 0, s46
    s_mul_i32 s90, s32, 5120
    s_waitcnt lgkmcnt(8)
    v_mfma_f32_16x16x32_bf16 v[144:147], v[100:103], a[208:211], v[144:147]
    ds_read_b64_tr_b16 v[120:121], v16 offset:5152
    s_add_u32 m0, s90, s47
    s_mul_i32 s91, s44, 163840
    v_mfma_f32_16x16x32_bf16 v[148:151], v[100:103], v[64:67], v[148:151]
    ds_read_b64_tr_b16 v[122:123], v16 offset:6432
    s_add_u32 s91, s91, s43
    buffer_load_dwordx4 v10, s[20:23], s91 offen lds
    s_waitcnt lgkmcnt(8)
    v_mfma_f32_16x16x32_bf16 v[152:155], v[104:107], a[208:211], v[152:155]
    ds_read_b64_tr_b16 v[124:125], v16 offset:5184
    s_add_u32 s47, s47, 20480
    s_cmp_eq_u32 s47, 81920
    v_mfma_f32_16x16x32_bf16 v[156:159], v[104:107], v[64:67], v[156:159]
    ds_read_b64_tr_b16 v[126:127], v16 offset:6464
    s_cselect_b32 s47, 0, s47
    s_cmp_lg_u32 s51, 0
    s_waitcnt lgkmcnt(8)
    v_mfma_f32_16x16x32_bf16 v[160:163], v[108:111], a[208:211], v[160:163]
    ds_read_b64_tr_b16 v[128:129], v16 offset:5216
    s_cselect_b32 s90, 1, 0
    s_sub_u32 s51, s51, s90
    v_mfma_f32_16x16x32_bf16 v[164:167], v[108:111], v[64:67], v[164:167]
    ds_read_b64_tr_b16 v[130:131], v16 offset:6496
    s_add_u32 s44, s44, s90
    s_cmp_eq_u32 s44, 5
    s_waitcnt lgkmcnt(8)
    v_mfma_f32_16x16x32_bf16 v[168:171], v[112:115], a[208:211], v[168:171]
    ds_read_b64_tr_b16 v[132:133], v16 offset:5248
    s_cselect_b32 s44, 0, s44
    s_cselect_b32 s90, 160, 0
    v_mfma_f32_16x16x32_bf16 v[172:175], v[112:115], v[64:67], v[172:175]
    ds_read_b64_tr_b16 v[134:135], v16 offset:6528
    s_add_u32 s43, s43, s90
    s_cmp_eq_u32 s43, 1280
    s_waitcnt lgkmcnt(8)
    v_mfma_f32_16x16x32_bf16 v[136:139], v[116:119], a[212:215], v[136:139]
    ds_read_b64_tr_b16 v[96:97], v16 offset:10240
    s_cselect_b32 s43, 0, s43
    s_add_u32 m0, m0, 1024
    v_mfma_f32_16x16x32_bf16 v[140:143], v[116:119], v[68:71], v[140:143]
    ds_read_b64_tr_b16 v[98:99], v16 offset:11520
    buffer_load_dwordx4 v11, s[20:23], s91 offen lds
    s_add_u32 m0, m0, 1024
    s_waitcnt lgkmcnt(8)
    v_mfma_f32_16x16x32_bf16 v[144:147], v[120:123], a[212:215], v[144:147]
    ds_read_b64_tr_b16 v[100:101], v16 offset:10272
    v_mfma_f32_16x16x32_bf16 v[148:151], v[120:123], v[68:71], v[148:151]
    ds_read_b64_tr_b16 v[102:103], v16 offset:11552
    s_waitcnt lgkmcnt(8)
    v_mfma_f32_16x16x32_bf16 v[152:155], v[124:127], a[212:215], v[152:155]
    ds_read_b64_tr_b16 v[104:105], v16 offset:10304
    v_mfma_f32_16x16x32_bf16 v[156:159], v[124:127], v[68:71], v[156:159]
    ds_read_b64_tr_b16 v[106:107], v16 offset:11584
    s_waitcnt lgkmcnt(8)
    v_mfma_f32_16x16x32_bf16 v[160:163], v[128:131], a[212:215], v[160:163]
    ds_read_b64_tr_b16 v[108:109], v16 offset:10336
    buffer_load_dwordx4 v12, s[20:23], s91 offen lds
    s_add_u32 m0, m0, 1024
    v_mfma_f32_16x16x32_bf16 v[164:167], v[128:131], v[68:71], v[164:167]
    ds_read_b64_tr_b16 v[110:111], v16 offset:11616
    s_waitcnt lgkmcnt(8)
    v_mfma_f32_16x16x32_bf16 v[168:171], v[132:135], a[212:215], v[168:171]
    ds_read_b64_tr_b16 v[112:113], v16 offset:10368
    v_mfma_f32_16x16x32_bf16 v[172:175], v[132:135], v[68:71], v[172:175]
    ds_read_b64_tr_b16 v[114:115], v16 offset:11648
    s_waitcnt lgkmcnt(8)
    v_mfma_f32_16x16x32_bf16 v[136:139], v[96:99], a[216:219], v[136:139]
    ds_read_b64_tr_b16 v[116:117], v16 offset:15360
    v_mfma_f32_16x16x32_bf16 v[140:143], v[96:99], v[72:75], v[140:143]
    ds_read_b64_tr_b16 v[118:119], v16 offset:16640
    buffer_load_dwordx4 v13, s[20:23], s91 offen lds
    s_add_u32 m0, m0, 1024
    s_waitcnt lgkmcnt(8)
    v_mfma_f32_16x16x32_bf16 v[144:147], v[100:103], a[216:219], v[144:147]
    ds_read_b64_tr_b16 v[120:121], v16 offset:15392
    v_mfma_f32_16x16x32_bf16 v[148:151], v[100:103], v[72:75], v[148:151]
    ds_read_b64_tr_b16 v[122:123], v16 offset:16672
    s_waitcnt lgkmcnt(8)
    v_mfma_f32_16x16x32_bf16 v[152:155], v[104:107], a[216:219], v[152:155]
    ds_read_b64_tr_b16 v[124:125], v16 offset:15424
    v_mfma_f32_16x16x32_bf16 v[156:159], v[104:107], v[72:75], v[156:159]
    ds_read_b64_tr_b16 v[126:127], v16 offset:16704
    s_waitcnt lgkmcnt(8)
    v_mfma_f32_16x16x32_bf16 v[160:163], v[108:111], a[216:219], v[160:163]
    ds_read_b64_tr_b16 v[128:129], v16 offset:15456
    buffer_load_dwordx4 v14, s[20:23], s91 offen lds
    v_mfma_f32_16x16x32_bf16 v[164:167], v[108:111], v[72:75], v[164:167]
    ds_read_b64_tr_b16 v[130:131], v16 offset:16736
    s_waitcnt lgkmcnt(8)
    v_mfma_f32_16x16x32_bf16 v[168:171], v[112:115], a[216:219], v[168:171]
    ds_read_b64_tr_b16 v[132:133], v16 offset:15488
    v_mfma_f32_16x16x32_bf16 v[172:175], v[112:115], v[72:75], v[172:175]
    ds_read_b64_tr_b16 v[134:135], v16 offset:16768
    s_waitcnt lgkmcnt(8)
    v_mfma_f32_16x16x32_bf16 v[136:139], v[116:119], a[220:223], v[136:139]
    v_mfma_f32_16x16x32_bf16 v[140:143], v[116:119], v[76:79], v[140:143]
    s_waitcnt lgkmcnt(6)
    v_mfma_f32_16x16x32_bf16 v[144:147], v[120:123], a[220:223], v[144:147]
    v_mfma_f32_16x16x32_bf16 v[148:151], v[120:123], v[76:79], v[148:151]
    v_add_u32 v16, s46, v15
    s_waitcnt vmcnt(10) lgkmcnt(0)
    s_barrier
    v_mfma_f32_16x16x32_bf16 v[152:155], v[124:127], a[220:223], v[152:155]
    ds_read_b64_tr_b16 v[96:97], v16 offset:0
    ds_read_b64_tr_b16 v[98:99], v16 offset:1280
    v_mfma_f32_16x16x32_bf16 v[156:159], v[124:127], v[76:79], v[156:159]
    ds_read_b64_tr_b16 v[100:101], v16 offset:32
    ds_read_b64_tr_b16 v[102:103], v16 offset:1312
    v_mfma_f32_16x16x32_bf16 v[160:163], v[128:131], a[220:223], v[160:163]
    ds_read_b64_tr_b16 v[104:105], v16 offset:64
    ds_read_b64_tr_b16 v[106:107], v16 offset:1344
    v_mfma_f32_16x16x32_bf16 v[164:167], v[128:131], v[76:79], v[164:167]
    ds_read_b64_tr_b16 v[108:109], v16 offset:96
    ds_read_b64_tr_b16 v[110:111], v16 offset:1376
    v_mfma_f32_16x16x32_bf16 v[168:171], v[132:135], a[220:223], v[168:171]
    ds_read_b64_tr_b16 v[112:113], v16 offset:128
    ds_read_b64_tr_b16 v[114:115], v16 offset:1408
    v_mfma_f32_16x16x32_bf16 v[172:175], v[132:135], v[76:79], v[172:175]
    s_waitcnt lgkmcnt(8)
    v_mfma_f32_16x16x32_bf16 v[136:139], v[96:99], a[224:227], v[136:139]
    ds_read_b64_tr_b16 v[116:117], v16 offset:5120
    s_add_u32 s46, s46, 20480
    s_cmp_eq_u32 s46, 81920
    v_mfma_f32_16x16x32_bf16 v[140:143], v[96:99], v[80:83], v[140:143]
    ds_read_b64_tr_b16 v[118:119], v16 offset:6400
    s_cselect_b32 s46, 0, s46
    s_mul_i32 s90, s32, 5120
    s_waitcnt lgkmcnt(8)
    v_mfma_f32_16x16x32_bf16 v[144:147], v[100:103], a[224:227], v[144:147]
    ds_read_b64_tr_b16 v[120:121], v16 offset:5152
    s_add_u32 m0, s90, s47
    s_mul_i32 s91, s44, 163840
    v_mfma_f32_16x16x32_bf16 v[148:151], v[100:103], v[80:83], v[148:151]
    ds_read_b64_tr_b16 v[122:123], v16 offset:6432
    s_add_u32 s91, s91, s43
    buffer_load_dwordx4 v10, s[20:23], s91 offen lds
    s_waitcnt lgkmcnt(8)
    v_mfma_f32_16x16x32_bf16 v[152:155], v[104:107], a[224:227], v[152:155]
    ds_read_b64_tr_b16 v[124:125], v16 offset:5184
    s_add_u32 s47, s47, 20480
    s_cmp_eq_u32 s47, 81920
    v_mfma_f32_16x16x32_bf16 v[156:159], v[104:107], v[80:83], v[156:159]
    ds_read_b64_tr_b16 v[126:127], v16 offset:6464
    s_cselect_b32 s47, 0, s47
    s_cmp_lg_u32 s51, 0
    s_waitcnt lgkmcnt(8)
    v_mfma_f32_16x16x32_bf16 v[160:163], v[108:111], a[224:227], v[160:163]
    ds_read_b64_tr_b16 v[128:129], v16 offset:5216
    s_cselect_b32 s90, 1, 0
    s_sub_u32 s51, s51, s90
    v_mfma_f32_16x16x32_bf16 v[164:167], v[108:111], v[80:83], v[164:167]
    ds_read_b64_tr_b16 v[130:131], v16 offset:6496
    s_add_u32 s44, s44, s90
    s_cmp_eq_u32 s44, 5
    s_waitcnt lgkmcnt(8)
    v_mfma_f32_16x16x32_bf16 v[168:171], v[112:115], a[224:227], v[168:171]
    ds_read_b64_tr_b16 v[132:133], v16 offset:5248
    s_cselect_b32 s44, 0, s44
    s_cselect_b32 s90, 160, 0
    v_mfma_f32_16x16x32_bf16 v[172:175], v[112:115], v[80:83], v[172:175]
    ds_read_b64_tr_b16 v[134:135], v16 offset:6528
    s_add_u32 s43, s43, s90
    s_cmp_eq_u32 s43, 1280
    s_waitcnt lgkmcnt(8)
    v_mfma_f32_16x16x32_bf16 v[136:139], v[116:119], a[228:231], v[136:139]
    ds_read_b64_tr_b16 v[96:97], v16 offset:10240
    s_cselect_b32 s43, 0, s43
    s_add_u32 m0, m0, 1024
    v_mfma_f32_16x16x32_bf16 v[140:143], v[116:119], v[84:87], v[140:143]
    ds_read_b64_tr_b16 v[98:99], v16 offset:11520
    buffer_load_dwordx4 v11, s[20:23], s91 offen lds
    s_add_u32 m0, m0, 1024
    s_waitcnt lgkmcnt(8)
    v_mfma_f32_16x16x32_bf16 v[144:147], v[120:123], a[228:231], v[144:147]
    ds_read_b64_tr_b16 v[100:101], v16 offset:10272
    v_mfma_f32_16x16x32_bf16 v[148:151], v[120:123], v[84:87], v[148:151]
    ds_read_b64_tr_b16 v[102:103], v16 offset:11552
    s_waitcnt lgkmcnt(8)
    v_mfma_f32_16x16x32_bf16 v[152:155], v[124:127], a[228:231], v[152:155]
    ds_read_b64_tr_b16 v[104:105], v16 offset:10304
    v_mfma_f32_16x16x32_bf16 v[156:159], v[124:127], v[84:87], v[156:159]
    ds_read_b64_tr_b16 v[106:107], v16 offset:11584
    s_waitcnt lgkmcnt(8)
    v_mfma_f32_16x16x32_bf16 v[160:163], v[128:131], a[228:231], v[160:163]
    ds_read_b64_tr_b16 v[108:109], v16 offset:10336
    buffer_load_dwordx4 v12, s[20:23], s91 offen lds
    s_add_u32 m0, m0, 1024
    v_mfma_f32_16x16x32_bf16 v[164:167], v[128:131], v[84:87], v[164:167]
    ds_read_b64_tr_b16 v[110:111], v16 offset:11616
    s_waitcnt lgkmcnt(8)
    v_mfma_f32_16x16x32_bf16 v[168:171], v[132:135], a[228:231], v[168:171]
    ds_read_b64_tr_b16 v[112:113], v16 offset:10368
    v_mfma_f32_16x16x32_bf16 v[172:175], v[132:135], v[84:87], v[172:175]
    ds_read_b64_tr_b16 v[114:115], v16 offset:11648
    s_waitcnt lgkmcnt(8)
    v_mfma_f32_16x16x32_bf16 v[136:139], v[96:99], a[232:235], v[136:139]
    ds_read_b64_tr_b16 v[116:117], v16 offset:15360
    v_mfma_f32_16x16x32_bf16 v[140:143], v[96:99], v[88:91], v[140:143]
    ds_read_b64_tr_b16 v[118:119], v16 offset:16640
    buffer_load_dwordx4 v13, s[20:23], s91 offen lds
    s_add_u32 m0, m0, 1024
    s_waitcnt lgkmcnt(8)
    v_mfma_f32_16x16x32_bf16 v[144:147], v[100:103], a[232:235], v[144:147]
    ds_read_b64_tr_b16 v[120:121], v16 offset:15392
    v_mfma_f32_16x16x32_bf16 v[148:151], v[100:103], v[88:91], v[148:151]
    ds_read_b64_tr_b16 v[122:123], v16 offset:16672
    s_waitcnt lgkmcnt(8)
    v_mfma_f32_16x16x32_bf16 v[152:155], v[104:107], a[232:235], v[152:155]
    ds_read_b64_tr_b16 v[124:125], v16 offset:15424
    v_mfma_f32_16x16x32_bf16 v[156:159], v[104:107], v[88:91], v[156:159]
    ds_read_b64_tr_b16 v[126:127], v16 offset:16704
    s_waitcnt lgkmcnt(8)
    v_mfma_f32_16x16x32_bf16 v[160:163], v[108:111], a[232:235], v[160:163]
    ds_read_b64_tr_b16 v[128:129], v16 offset:15456
    buffer_load_dwordx4 v14, s[20:23], s91 offen lds
    v_mfma_f32_16x16x32_bf16 v[164:167], v[108:111], v[88:91], v[164:167]
    ds_read_b64_tr_b16 v[130:131], v16 offset:16736
    s_waitcnt lgkmcnt(8)
    v_mfma_f32_16x16x32_bf16 v[168:171], v[112:115], a[232:235], v[168:171]
    ds_read_b64_tr_b16 v[132:133], v16 offset:15488
    v_mfma_f32_16x16x32_bf16 v[172:175], v[112:115], v[88:91], v[172:175]
    ds_read_b64_tr_b16 v[134:135], v16 offset:16768
    s_waitcnt lgkmcnt(8)
    v_mfma_f32_16x16x32_bf16 v[136:139], v[116:119], a[236:239], v[136:139]
    v_mfma_f32_16x16x32_bf16 v[140:143], v[116:119], v[92:95], v[140:143]
    s_waitcnt lgkmcnt(6)
    v_mfma_f32_16x16x32_bf16 v[144:147], v[120:123], a[236:239], v[144:147]
    v_mfma_f32_16x16x32_bf16 v[148:151], v[120:123], v[92:95], v[148:151]
    v_add_u32 v16, s46, v15
    s_waitcnt vmcnt(10) lgkmcnt(0)
    s_barrier
    v_mfma_f32_16x16x32_bf16 v[152:155], v[124:127], a[236:239], v[152:155]
    ds_read_b64_tr_b16 v[96:97], v16 offset:0
    ds_read_b64_tr_b16 v[98:99], v16 offset:1280
    v_mfma_f32_16x16x32_bf16 v[156:159], v[124:127], v[92:95], v[156:159]
    ds_read_b64_tr_b16 v[100:101], v16 offset:32
    ds_read_b64_tr_b16 v[102:103], v16 offset:1312
    v_mfma_f32_16x16x32_bf16 v[160:163], v[128:131], a[236:239], v[160:163]
    ds_read_b64_tr_b16 v[104:105], v16 offset:64
    ds_read_b64_tr_b16 v[106:107], v16 offset:1344
    v_mfma_f32_16x16x32_bf16 v[164:167], v[128:131], v[92:95], v[164:167]
    ds_read_b64_tr_b16 v[108:109], v16 offset:96
    ds_read_b64_tr_b16 v[110:111], v16 offset:1376
    v_mfma_f32_16x16x32_bf16 v[168:171], v[132:135], a[236:239], v[168:171]
    ds_read_b64_tr_b16 v[112:113], v16 offset:128
    ds_read_b64_tr_b16 v[114:115], v16 offset:1408
    v_mfma_f32_16x16x32_bf16 v[172:175], v[132:135], v[92:95], v[172:175]
    v_cvt_pk_bf16_f32 v176, v136, v137
    v_cvt_pk_bf16_f32 v177, v138, v139
    v_cvt_pk_bf16_f32 v178, v140, v141
    v_cvt_pk_bf16_f32 v179, v142, v143
    s_nop 0
    v_permlane16_swap_b32 v176, v178
    v_permlane16_swap_b32 v177, v179
    buffer_store_dwordx4 v[176:179], v19, s[28:31], s42 offen offset:0
    s_nop 1
    v_cvt_pk_bf16_f32 v176, v144, v145
    v_cvt_pk_bf16_f32 v177, v146, v147
    v_cvt_pk_bf16_f32 v178, v148, v149
    v_cvt_pk_bf16_f32 v179, v150, v151
    s_nop 0
    v_permlane16_swap_b32 v176, v178
    v_permlane16_swap_b32 v177, v179
    buffer_store_dwordx4 v[176:179], v19, s[28:31], s42 offen offset:32
    s_nop 1
    v_cvt_pk_bf16_f32 v176, v152, v153
    v_cvt_pk_bf16_f32 v177, v154, v155
    v_cvt_pk_bf16_f32 v178, v156, v157
    v_cvt_pk_bf16_f32 v179, v158, v159
    s_nop 0
    v_permlane16_swap_b32 v176, v178
    v_permlane16_swap_b32 v177, v179
    buffer_store_dwordx4 v[176:179], v19, s[28:31], s42 offen offset:64
    s_nop 1
    v_cvt_pk_bf16_f32 v176, v160, v161
    v_cvt_pk_bf16_f32 v177, v162, v163
    v_cvt_pk_bf16_f32 v178, v164, v165
    v_cvt_pk_bf16_f32 v179, v166, v167
    s_nop 0
    v_permlane16_swap_b32 v176, v178
    v_permlane16_swap_b32 v177, v179
    buffer_store_dwordx4 v[176:179], v19, s[28:31], s42 offen offset:96
    s_nop 1
    v_cvt_pk_bf16_f32 v176, v168, v169
    v_cvt_pk_bf16_f32 v177, v170, v171
    v_cvt_pk_bf16_f32 v178, v172, v173
    v_cvt_pk_bf16_f32 v179, v174, v175
    s_nop 0
    v_permlane16_swap_b32 v176, v178
    v_permlane16_swap_b32 v177, v179
    buffer_store_dwordx4 v[176:179], v19, s[28:31], s42 offen offset:128
    s_add_u32 s42, s42, 160
    s_cmp_eq_u32 s42, 1280
    s_cselect_b32 s42, 0, s42
    s_add_u32 s53, s53, 1
    s_cmp_lt_u32 s53, 8
    s_cbranch_scc1 L_pa_oblk
L_pa_end:
    s_waitcnt vmcnt(0)
    s_endpgm
L_slow:
    s_waitcnt vmcnt(0) lgkmcnt(0)
    s_barrier
    s_and_b32 s34, s2, 7
    s_lshr_b32 s35, s2, 3
    s_add_u32 s4, s88, 33554432
    s_addc_u32 s5, s89, 0
    s_and_b32 s5, s5, 0xffff
    s_lshl_b32 s38, s34, 21
    s_add_u32 s38, s38, 8388608
    s_cmp_lt_u32 s35, 28
    s_cbranch_scc1 L_noini_65
    v_mov_b32 v240, -1
    v_mov_b32 v241, -1
    v_mov_b32 v242, -1
    v_mov_b32 v243, -1
    v_mov_b32 v244, 0
    v_lshlrev_b32 v4, 4, v0
    v_lshlrev_b32 v5, 2, v0
    s_sub_u32 s93, s35, 28
    s_lshl_b32 s93, s93, 2
    s_add_u32 s93, s93, s32
    s_lshl_b32 s91, s34, 4
    s_add_u32 s91, s91, s93
    s_lshl_b32 s41, s91, 8
    s_add_u32 s41, s41, 1933312
    s_mul_i32 s91, s91, 5120
    s_lshl_b32 s40, s93, 8
    s_add_u32 s40, s40, s38
    s_add_u32 s40, s40, 458752
    s_lshr_b32 s92, s93, 3
    s_mul_i32 s92, s92, 114688
    s_add_u32 s92, s92, s38
    s_and_b32 s93, s93, 7
    s_mul_i32 s93, s93, 5120
    s_add_u32 s92, s92, s93
    buffer_store_dwordx4 v[240:243], v4, s[4:7], s91 offen offset:0 sc1
    buffer_store_dwordx4 v[240:243], v4, s[4:7], s91 offen offset:1024 sc1
    buffer_store_dwordx4 v[240:243], v4, s[4:7], s91 offen offset:2048 sc1
    buffer_store_dwordx4 v[240:243], v4, s[4:7], s91 offen offset:3072 sc1
    s_add_u32 s91, s91, 4096
    buffer_store_dwordx4 v[240:243], v4, s[4:7], s91 offen offset:0 sc1
    buffer_store_dwordx4 v[240:243], v4, s[4:7], s92 offen offset:0 sc1
    buffer_store_dwordx4 v[240:243], v4, s[4:7], s92 offen offset:1024 sc1
    buffer_store_dwordx4 v[240:243], v4, s[4:7], s92 offen offset:2048 sc1
    buffer_store_dwordx4 v[240:243], v4, s[4:7], s92 offen offset:3072 sc1
    s_add_u32 s92, s92, 4096
    buffer_store_dwordx4 v[240:243], v4, s[4:7], s92 offen offset:0 sc1
    buffer_store_dword v244, v5, s[4:7], s40 offen sc1
    buffer_store_dword v244, v5, s[4:7], s41 offen sc1
    s_waitcnt vmcnt(0)
    s_barrier
    s_cmp_lg_u32 s32, 0
    s_cbranch_scc1 L_ini_66
    v_mov_b32 v1, 68
    v_mov_b32 v2, 1
    s_mov_b64 exec, 1
    buffer_atomic_add v2, v1, s[8:11], 0 offen sc0 sc1
    s_waitcnt vmcnt(0)
    v_readfirstlane_b32 s90, v2
    s_mov_b64 exec, -1
    s_cmp_lg_u32 s90, 31
    s_cbranch_scc1 L_ini_66
    v_mov_b32 v1, 196
    v_mov_b32 v2, 1
    s_mov_b64 exec, 1
    buffer_store_dword v2, v1, s[8:11], 0 offen sc1
    s_mov_b64 exec, -1
L_ini_66:
    s_barrier
    s_cmp_eq_u32 s35, 28
    s_cbranch_scc1 L_px_s
L_noini_65:
    s_nop 0
    s_cmp_lt_u32 s35, 12
    s_cbranch_scc1 L_qkv_s
    s_cmp_lt_u32 s35, 18
    s_cbranch_scc1 L_v_s
    s_cmp_lt_u32 s35, 28
    s_cbranch_scc1 L_wo_s
    s_cmp_lt_u32 s35, 29
    s_cbranch_scc1 L_px_s
    s_branch L_pa_s
L_qkv_s:
    s_mov_b32 s12, s74
    s_and_b32 s13, s75, 0xffff
    s_mov_b32 s14, 7864320
    s_mov_b32 s15, 0x20000
    s_mov_b32 s16, s76
    s_and_b32 s17, s77, 0xffff
    s_mov_b32 s18, 7864320
    s_mov_b32 s19, 0x20000
    s_mov_b32 s40, s35
    s_mov_b32 s24, s70
    s_and_b32 s25, s71, 0xffff
    s_mov_b32 s26, 2621440
    s_mov_b32 s27, 0x20000
    v_and_b32 v1, 15, v0
    v_lshrrev_b32 v2, 4, v0
    v_lshrrev_b32 v3, 3, v0
    v_and_b32 v4, 7, v0
    s_lshl_b32 s90, s32, 3
    v_add_u32 v5, s90, v3
    s_and_b32 s91, s32, 1
    s_lshl_b32 s91, s91, 2
    v_and_b32 v6, 2, v3
    v_or_b32 v6, s91, v6
    v_xor_b32 v6, v6, v4
    v_lshlrev_b32 v6, 4, v6
    v_mul_u32_u24 v7, 12288, v5
    s_mul_i32 s92, s34, 1536
    s_lshl_b32 s93, s40, 7
    s_add_u32 s92, s92, s93
    v_add3_u32 v124, v6, v7, s92
    v_lshrrev_b32 v6, 1, v3
    v_or_b32 v6, s91, v6
    v_xor_b32 v6, v6, v4
    v_lshlrev_b32 v6, 4, v6
    v_mul_u32_u24 v7, 1280, v5
    v_add_u32 v10, v6, v7
    s_lshl_b32 s90, s32, 10
    s_add_u32 m0, s90, 81920
    s_mov_b32 s91, 0
    buffer_load_dwordx4 v124, s[16:19], s91 offen nt lds
    s_add_u32 m0, m0, 4096
    s_add_u32 s91, s91, 393216
    buffer_load_dwordx4 v124, s[16:19], s91 offen nt lds
    s_add_u32 m0, m0, 4096
    s_add_u32 s91, s91, 393216
    buffer_load_dwordx4 v124, s[16:19], s91 offen nt lds
    s_add_u32 m0, m0, 4096
    s_add_u32 s91, s91, 393216
    buffer_load_dwordx4 v124, s[16:19], s91 offen nt lds
    s_add_u32 m0, m0, 4096
    s_add_u32 s91, s91, 393216
    buffer_load_dwordx4 v124, s[16:19], s91 offen nt lds
    s_add_u32 m0, m0, 4096
    s_add_u32 s91, s91, 393216
    buffer_load_dwordx4 v124, s[16:19], s91 offen nt lds
    s_add_u32 m0, m0, 4096
    s_add_u32 s91, s91, 393216
    buffer_load_dwordx4 v124, s[16:19], s91 offen nt lds
    s_add_u32 m0, m0, 4096
    s_add_u32 s91, s91, 393216
    buffer_load_dwordx4 v124, s[16:19], s91 offen nt lds
    s_add_u32 m0, m0, 4096
    s_add_u32 s91, s91, 393216
    buffer_load_dwordx4 v124, s[16:19], s91 offen nt lds
    s_add_u32 m0, m0, 4096
    s_add_u32 s91, s91, 393216
    buffer_load_dwordx4 v124, s[16:19], s91 offen nt lds
    s_mul_i32 s60, s40, 86
    s_lshr_b32 s60, s60, 8
    s_mul_i32 s61, s60, 3
    s_sub_u32 s61, s40, s61
    s_add_u32 s90, s40, 1
    s_mul_i32 s62, s90, 86
    s_lshr_b32 s62, s62, 8
    s_mul_i32 s63, s62, 3
    s_sub_u32 s63, s90, s63
    v_lshrrev_b32 v3, 1, v2
    v_and_b32 v5, 1, v2
    s_lshl_b32 s90, s32, 9
    v_lshlrev_b32 v6, 4, v1
    v_lshl_add_u32 v6, v3, 8, v6
    v_add_u32 v6, s90, v6
    s_mul_i32 s90, s60, 12288
    s_lshl_b32 s91, s61, 11
    s_add_u32 s90, s90, s91
    v_mul_u32_u24 v7, 6144, v5
    v_add3_u32 v19, v6, v7, s90
    v_mov_b32 v22, -1
    s_mov_b32 s56, 49152
    v_lshl_add_u32 v137, v5, 11, v6
    v_add_u32 v137, 135168, v137
    s_mul_i32 s90, s40, 1280
    s_add_u32 s90, s90, 10240
    v_lshlrev_b32 v6, 1, v5
    v_or_b32 v7, v6, v3
    v_lshl_add_u32 v7, v7, 4, v1
    v_lshlrev_b32 v7, 2, v7
    v_add_u32 v7, 1024, v7
    v_or_b32 v6, v6, v1
    v_lshl_add_u32 v6, v3, 4, v6
    v_lshlrev_b32 v6, 4, v6
    s_sub_u32 s91, s32, 1
    s_lshl_b32 s91, s91, 9
    v_add_u32 v6, s91, v6
    s_cmp_eq_u32 s32, 0
    s_cselect_b64 vcc, -1, 0
    v_cndmask_b32 v6, v6, v7, vcc
    v_add_u32 v135, s90, v6
    s_lshl_b32 s91, s32, 8
    s_add_u32 s91, s91, s90
    v_lshl_add_u32 v150, v0, 2, s91
    v_and_b32 v4, 2, v1
    v_cmp_eq_u32 vcc, 0, v4
    v_mov_b32 v9, 2146435072
    s_nop 0
    v_cndmask_b32 v135, v9, v135, vcc
    s_lshl_b32 s90, s40, 10
    v_lshrrev_b32 v3, 2, v1
    v_lshlrev_b32 v3, 1, v3
    v_and_b32 v6, 1, v1
    v_or_b32 v3, v3, v6
    v_lshl_add_u32 v3, v2, 3, v3
    v_lshl_add_u32 v136, v3, 4, s90
    v_cmp_ne_u32 vcc, 0, v4
    v_mov_b32 v9, 2146435072
    s_nop 0
    v_cndmask_b32 v136, v9, v136, vcc
    v_and_b32 v6, 9, v1
    v_lshl_or_b32 v6, v4, 1, v6
    v_and_b32 v7, 4, v1
    v_lshrrev_b32 v7, 1, v7
    v_or_b32 v6, v6, v7
    v_lshlrev_b32 v6, 4, v6
    v_lshl_add_u32 v6, v2, 8, v6
    s_cmp_eq_u32 s32, 2
    s_cselect_b32 s90, 2048, 0
    s_add_u32 s90, s90, 135168
    v_add_u32 v138, s90, v6
    s_lshl_b32 s90, s60, 7
    s_lshl_b32 s91, s61, 2
    s_add_u32 s91, s91, s90
    s_add_u32 s91, s91, 459264
    s_cmp_eq_u32 s32, 3
    s_cselect_b32 s91, s91, 2146435072
    s_cselect_b32 s55, -1, 0
    v_mov_b32 v139, s91
    v_cmp_eq_u32 vcc, 0, v0
    v_mov_b32 v9, 2146435072
    s_nop 0
    v_cndmask_b32 v139, v9, v139, vcc
    v_add_u32 v21, 3072, v139
    s_mul_i32 s90, s35, 32768
    s_lshl_b32 s91, s32, 11
    s_add_u32 s90, s90, s91
    s_lshl_b32 s92, s35, 10
    s_lshl_b32 s91, s32, 8
    s_add_u32 s92, s92, s91
    s_cmp_lt_u32 s35, 10
    s_cselect_b32 s90, s90, 2146435072
    s_cselect_b32 s92, s92, 2146435072
    s_lshl_b32 s91, s34, 8
    v_lshlrev_b32 v3, 4, v0
    v_xor_b32 v3, s91, v3
    v_add_u32 v142, s90, v3
    v_xor_b32 v3, 1024, v3
    v_add_u32 v143, s90, v3
    s_min_u32 s90, s35, 9
    s_lshl_b32 s90, s90, 7
    s_add_u32 s90, s90, 460800
    s_add_u32 s90, s90, s38
    v_and_b32 v3, 3, v0
    v_lshl_add_u32 v146, v3, 2, s90
    s_add_u32 s90, s38, 460416
    v_mov_b32 v146, s90
    v_lshl_add_u32 v149, v0, 2, s92
    v_lshlrev_b32 v3, 3, v1
    v_lshl_add_u32 v3, v2, 6, v3
    v_add_u32 v148, s92, v3
    v_cmp_gt_u32 vcc, 8, v1
    v_mov_b32 v9, 2146435072
    s_nop 0
    v_cndmask_b32 v148, v9, v148, vcc
    v_lshrrev_b32 v8, 1, v1
    v_and_b32 v7, 2, v8
    v_cmp_ne_u32 vcc, 0, v7
    v_mov_b32 v5, 0x3f80
    v_mov_b32 v6, 0x3f800000
    v_cndmask_b32 v5, v5, v6, vcc
    v_bfe_u32 v6, v8, 2, 1
    v_and_b32 v7, 1, v8
    v_lshl_or_b32 v6, v7, 1, v6
    v_cmp_eq_u32 vcc, 0, v6
    s_nop 1
    v_cndmask_b32 v196, 0, v5, vcc
    v_cmp_eq_u32 vcc, 1, v6
    s_nop 1
    v_cndmask_b32 v197, 0, v5, vcc
    v_cmp_eq_u32 vcc, 2, v6
    s_nop 1
    v_cndmask_b32 v198, 0, v5, vcc
    v_cmp_eq_u32 vcc, 3, v6
    s_nop 1
    v_cndmask_b32 v199, 0, v5, vcc
    s_mov_b32 s58, 0xaaaaaaaa
    s_mov_b32 s59, 0xaaaaaaaa
    v_lshrrev_b32 v3, 2, v1
    v_and_b32 v4, 3, v1
    v_and_b32 v5, 1, v2
    v_lshl_add_u32 v6, v2, 3, v3
    v_lshlrev_b32 v6, 7, v6
    v_and_b32 v7, 2, v3
    v_lshl_or_b32 v7, v5, 2, v7
    v_lshrrev_b32 v8, 1, v4
    s_lshl_b32 s90, s32, 1
    v_or_b32 v8, s90, v8
    v_xor_b32 v7, v7, v8
    v_lshl_add_u32 v6, v7, 4, v6
    v_and_b32 v7, 1, v4
    v_lshl_add_u32 v6, v7, 3, v6
    v_add_u32 v125, 81920, v6
    v_add_u32 v126, 40960, v6
    v_add_u32 v127, 122880, v6
    s_lshl_b32 s90, s32, 9
    s_add_u32 s90, s90, 133120
    v_xor_b32 v6, 0, v5
    v_lshl_add_u32 v6, v6, 2, v3
    v_lshl_add_u32 v6, v2, 3, v6
    v_lshlrev_b32 v6, 5, v6
    v_lshl_or_b32 v7, v5, 1, 0
    v_xor_b32 v7, v7, v4
    v_lshl_add_u32 v6, v7, 3, v6
    v_add_u32 v24, 133120, v6
    v_xor_b32 v6, 1, v5
    v_lshl_add_u32 v6, v6, 2, v3
    v_lshl_add_u32 v6, v2, 3, v6
    v_lshlrev_b32 v6, 5, v6
    v_lshl_or_b32 v7, v5, 1, 1
    v_xor_b32 v7, v7, v4
    v_lshl_add_u32 v6, v7, 3, v6
    v_add_u32 v134, 133120, v6
    v_lshrrev_b32 v6, 3, v1
    v_lshlrev_b32 v6, 2, v6
    v_xor_b32 v6, v6, v1
    v_lshlrev_b32 v6, 5, v6
    v_xor_b32 v7, v2, v3
    v_lshl_add_u32 v6, v7, 3, v6
    v_add_u32 v23, s90, v6
    v_and_b32 v7, 2, v1
    v_cmp_ne_u32 vcc, 0, v7
    v_mov_b32 v6, 0x4444
    v_mov_b32 v8, 0xeeee
    v_cndmask_b32 v17, v6, v8, vcc
    v_lshlrev_b32 v6, 4, v0
    v_add_u32 v16, 122880, v6
    s_mul_i32 s90, s32, 2560
    v_lshl_add_u32 v13, v0, 4, s90
    v_lshl_add_u32 v14, v0, 2, s90
    s_add_u32 s48, s90, 122880
    v_mul_u32_u24 v6, 40, v0
    v_add_u32 v15, s48, v6
    v_mul_u32_u24 v6, 164, v0
    v_min_u32 v6, 10236, v6
    v_add_u32 v25, 122880, v6
    v_lshrrev_b32 v6, 3, v1
    v_lshlrev_b32 v6, 10, v6
    v_and_b32 v7, 7, v1
    v_lshl_add_u32 v6, v7, 7, v6
    v_lshrrev_b32 v7, 1, v1
    v_xor_b32 v7, v7, v2
    v_lshl_add_u32 v11, v7, 4, v6
    v_xor_b32 v12, 64, v11
    s_and_b32 s91, s34, 1
    s_lshl_b32 s91, s91, 12
    s_lshr_b32 s92, s34, 2
    s_lshl_b32 s92, s92, 13
    s_add_u32 s91, s91, s92
    s_and_b32 s92, s34, 2
    s_lshl_b32 s92, s92, 13
    s_add_u32 s91, s91, s92
    s_add_u32 s91, s91, 1933312
    v_lshrrev_b32 v4, 2, v0
    v_lshl_add_u32 v3, v4, 9, s91
    v_cmp_ne_u32 s[92:93], s34, v4
    v_cmp_gt_u32 vcc, 32, v0
    s_nop 0
    s_and_b64 vcc, vcc, s[92:93]
    s_and_b32 vcc_lo, vcc_lo, s55
    v_cndmask_b32 v146, v146, v3, vcc
    v_cndmask_b32 v152, 0, -1, vcc
    s_lshl_b32 s90, s32, 10
    s_add_u32 m0, s90, 40960
    s_mov_b32 s91, 0
    buffer_load_dwordx4 v124, s[12:15], s91 offen nt lds
    s_add_u32 m0, m0, 4096
    s_add_u32 s91, s91, 393216
    buffer_load_dwordx4 v124, s[12:15], s91 offen nt lds
    s_add_u32 m0, m0, 4096
    s_add_u32 s91, s91, 393216
    buffer_load_dwordx4 v124, s[12:15], s91 offen nt lds
    s_add_u32 m0, m0, 4096
    s_add_u32 s91, s91, 393216
    buffer_load_dwordx4 v124, s[12:15], s91 offen nt lds
    s_add_u32 m0, m0, 4096
    s_add_u32 s91, s91, 393216
    buffer_load_dwordx4 v124, s[12:15], s91 offen nt lds
    s_add_u32 m0, m0, 4096
    s_add_u32 s91, s91, 393216
    buffer_load_dwordx4 v124, s[12:15], s91 offen nt lds
    s_add_u32 m0, m0, 4096
    s_add_u32 s91, s91, 393216
    buffer_load_dwordx4 v124, s[12:15], s91 offen nt lds
    s_add_u32 m0, m0, 4096
    s_add_u32 s91, s91, 393216
    buffer_load_dwordx4 v124, s[12:15], s91 offen nt lds
    s_add_u32 m0, m0, 4096
    s_add_u32 s91, s91, 393216
    buffer_load_dwordx4 v124, s[12:15], s91 offen nt lds
    s_add_u32 m0, m0, 4096
    s_add_u32 s91, s91, 393216
    buffer_load_dwordx4 v124, s[12:15], s91 offen nt lds
    s_lshl_b32 s90, s32, 10
    s_add_u32 m0, s90, 122880
    s_mov_b32 s91, 3932160
    buffer_load_dwordx4 v124, s[16:19], s91 offen nt lds
    s_add_u32 m0, m0, 4096
    s_add_u32 s91, s91, 393216
    buffer_load_dwordx4 v124, s[16:19], s91 offen nt lds
    s_add_u32 m0, m0, 4096
    s_add_u32 s91, s91, 393216
    buffer_load_dwordx4 v124, s[16:19], s91 offen nt lds
    s_add_u32 m0, m0, 4096
    s_add_u32 s91, s91, 393216
    buffer_load_dwordx4 v124, s[16:19], s91 offen nt lds
    s_add_u32 m0, m0, 4096
    s_add_u32 s91, s91, 393216
    buffer_load_dwordx4 v124, s[16:19], s91 offen nt lds
    s_add_u32 m0, m0, 4096
    s_add_u32 s91, s91, 393216
    buffer_load_dwordx4 v124, s[16:19], s91 offen nt lds
    s_add_u32 m0, m0, 4096
    s_add_u32 s91, s91, 393216
    buffer_load_dwordx4 v124, s[16:19], s91 offen nt lds
    s_add_u32 m0, m0, 4096
    s_add_u32 s91, s91, 393216
    buffer_load_dwordx4 v124, s[16:19], s91 offen nt lds
    s_add_u32 m0, m0, 4096
    s_add_u32 s91, s91, 393216
    buffer_load_dwordx4 v124, s[16:19], s91 offen nt lds
    s_add_u32 m0, m0, 4096
    s_add_u32 s91, s91, 393216
    buffer_load_dwordx4 v124, s[16:19], s91 offen nt lds
    s_mov_b32 s46, 0
    s_lshl_b32 s90, s32, 10
    s_add_u32 m0, s90, 0
    s_nop 0
    buffer_load_dwordx4 v10, s[24:27], s46 offen offset:0 nt lds
    s_add_u32 m0, m0, 3968
    s_nop 0
    buffer_load_dwordx4 v10, s[24:27], s46 offen offset:128 nt lds
    s_add_u32 m0, m0, 3968
    s_nop 0
    buffer_load_dwordx4 v10, s[24:27], s46 offen offset:256 nt lds
    s_add_u32 m0, m0, 3968
    s_nop 0
    buffer_load_dwordx4 v10, s[24:27], s46 offen offset:384 nt lds
    s_add_u32 m0, m0, 3968
    s_nop 0
    buffer_load_dwordx4 v10, s[24:27], s46 offen offset:512 nt lds
    s_add_u32 m0, m0, 3968
    s_nop 0
    buffer_load_dwordx4 v10, s[24:27], s46 offen offset:640 nt lds
    s_add_u32 m0, m0, 3968
    s_nop 0
    buffer_load_dwordx4 v10, s[24:27], s46 offen offset:768 nt lds
    s_add_u32 m0, m0, 3968
    s_nop 0
    buffer_load_dwordx4 v10, s[24:27], s46 offen offset:896 nt lds
    s_add_u32 m0, m0, 3968
    s_nop 0
    buffer_load_dwordx4 v10, s[24:27], s46 offen offset:1024 nt lds
    s_add_u32 m0, m0, 3968
    s_nop 0
    buffer_load_dwordx4 v10, s[24:27], s46 offen offset:1152 nt lds
    s_waitcnt vmcnt(30)
    s_barrier
    ds_read_b64_tr_b16 a[80:81], v125 offset:0
    ds_read_b64_tr_b16 a[82:83], v125 offset:512
    ds_read_b64_tr_b16 a[84:85], v125 offset:4096
    ds_read_b64_tr_b16 a[86:87], v125 offset:4608
    ds_read_b64_tr_b16 a[88:89], v125 offset:8192
    ds_read_b64_tr_b16 a[90:91], v125 offset:8704
    ds_read_b64_tr_b16 a[92:93], v125 offset:12288
    ds_read_b64_tr_b16 a[94:95], v125 offset:12800
    ds_read_b64_tr_b16 a[96:97], v125 offset:16384
    ds_read_b64_tr_b16 a[98:99], v125 offset:16896
    ds_read_b64_tr_b16 a[100:101], v125 offset:20480
    ds_read_b64_tr_b16 a[102:103], v125 offset:20992
    ds_read_b64_tr_b16 a[104:105], v125 offset:24576
    ds_read_b64_tr_b16 a[106:107], v125 offset:25088
    ds_read_b64_tr_b16 a[108:109], v125 offset:28672
    ds_read_b64_tr_b16 a[110:111], v125 offset:29184
    ds_read_b64_tr_b16 a[112:113], v125 offset:32768
    ds_read_b64_tr_b16 a[114:115], v125 offset:33280
    ds_read_b64_tr_b16 a[116:117], v125 offset:36864
    ds_read_b64_tr_b16 a[118:119], v125 offset:37376
    s_waitcnt lgkmcnt(0)
    s_barrier
    s_lshl_b32 s90, s32, 10
    s_add_u32 m0, s90, 81920
    s_mov_b32 s91, 3932160
    buffer_load_dwordx4 v124, s[12:15], s91 offen nt lds
    s_add_u32 m0, m0, 4096
    s_add_u32 s91, s91, 393216
    buffer_load_dwordx4 v124, s[12:15], s91 offen nt lds
    s_add_u32 m0, m0, 4096
    s_add_u32 s91, s91, 393216
    buffer_load_dwordx4 v124, s[12:15], s91 offen nt lds
    s_add_u32 m0, m0, 4096
    s_add_u32 s91, s91, 393216
    buffer_load_dwordx4 v124, s[12:15], s91 offen nt lds
    s_add_u32 m0, m0, 4096
    s_add_u32 s91, s91, 393216
    buffer_load_dwordx4 v124, s[12:15], s91 offen nt lds
    s_add_u32 m0, m0, 4096
    s_add_u32 s91, s91, 393216
    buffer_load_dwordx4 v124, s[12:15], s91 offen nt lds
    s_add_u32 m0, m0, 4096
    s_add_u32 s91, s91, 393216
    buffer_load_dwordx4 v124, s[12:15], s91 offen nt lds
    s_add_u32 m0, m0, 4096
    s_add_u32 s91, s91, 393216
    buffer_load_dwordx4 v124, s[12:15], s91 offen nt lds
    s_add_u32 m0, m0, 4096
    s_add_u32 s91, s91, 393216
    buffer_load_dwordx4 v124, s[12:15], s91 offen nt lds
    s_add_u32 m0, m0, 4096
    s_add_u32 s91, s91, 393216
    buffer_load_dwordx4 v124, s[12:15], s91 offen nt lds
    s_waitcnt vmcnt(30)
    s_barrier
    ds_read_b64_tr_b16 a[0:1], v126 offset:0
    ds_read_b64_tr_b16 a[2:3], v126 offset:512
    ds_read_b64_tr_b16 a[4:5], v126 offset:4096
    ds_read_b64_tr_b16 a[6:7], v126 offset:4608
    ds_read_b64_tr_b16 a[8:9], v126 offset:8192
    ds_read_b64_tr_b16 a[10:11], v126 offset:8704
    ds_read_b64_tr_b16 a[12:13], v126 offset:12288
    ds_read_b64_tr_b16 a[14:15], v126 offset:12800
    ds_read_b64_tr_b16 a[16:17], v126 offset:16384
    ds_read_b64_tr_b16 a[18:19], v126 offset:16896
    ds_read_b64_tr_b16 a[20:21], v126 offset:20480
    ds_read_b64_tr_b16 a[22:23], v126 offset:20992
    ds_read_b64_tr_b16 a[24:25], v126 offset:24576
    ds_read_b64_tr_b16 a[26:27], v126 offset:25088
    ds_read_b64_tr_b16 a[28:29], v126 offset:28672
    ds_read_b64_tr_b16 a[30:31], v126 offset:29184
    ds_read_b64_tr_b16 a[32:33], v126 offset:32768
    ds_read_b64_tr_b16 a[34:35], v126 offset:33280
    ds_read_b64_tr_b16 a[36:37], v126 offset:36864
    ds_read_b64_tr_b16 a[38:39], v126 offset:37376
    s_waitcnt lgkmcnt(0)
    s_barrier
    s_mov_b32 s46, 40960
    s_lshl_b32 s90, s32, 10
    s_add_u32 m0, s90, 40960
    s_nop 0
    buffer_load_dwordx4 v10, s[24:27], s46 offen offset:0 nt lds
    s_add_u32 m0, m0, 3968
    s_nop 0
    buffer_load_dwordx4 v10, s[24:27], s46 offen offset:128 nt lds
    s_add_u32 m0, m0, 3968
    s_nop 0
    buffer_load_dwordx4 v10, s[24:27], s46 offen offset:256 nt lds
    s_add_u32 m0, m0, 3968
    s_nop 0
    buffer_load_dwordx4 v10, s[24:27], s46 offen offset:384 nt lds
    s_add_u32 m0, m0, 3968
    s_nop 0
    buffer_load_dwordx4 v10, s[24:27], s46 offen offset:512 nt lds
    s_add_u32 m0, m0, 3968
    s_nop 0
    buffer_load_dwordx4 v10, s[24:27], s46 offen offset:640 nt lds
    s_add_u32 m0, m0, 3968
    s_nop 0
    buffer_load_dwordx4 v10, s[24:27], s46 offen offset:768 nt lds
    s_add_u32 m0, m0, 3968
    s_nop 0
    buffer_load_dwordx4 v10, s[24:27], s46 offen offset:896 nt lds
    s_add_u32 m0, m0, 3968
    s_nop 0
    buffer_load_dwordx4 v10, s[24:27], s46 offen offset:1024 nt lds
    s_add_u32 m0, m0, 3968
    s_nop 0
    buffer_load_dwordx4 v10, s[24:27], s46 offen offset:1152 nt lds
    s_waitcnt vmcnt(30)
    s_barrier
    ds_read_b64_tr_b16 a[120:121], v127 offset:0
    ds_read_b64_tr_b16 a[122:123], v127 offset:512
    ds_read_b64_tr_b16 a[124:125], v127 offset:4096
    ds_read_b64_tr_b16 a[126:127], v127 offset:4608
    ds_read_b64_tr_b16 a[128:129], v127 offset:8192
    ds_read_b64_tr_b16 a[130:131], v127 offset:8704
    ds_read_b64_tr_b16 a[132:133], v127 offset:12288
    ds_read_b64_tr_b16 a[134:135], v127 offset:12800
    ds_read_b64_tr_b16 a[136:137], v127 offset:16384
    ds_read_b64_tr_b16 a[138:139], v127 offset:16896
    ds_read_b64_tr_b16 a[140:141], v127 offset:20480
    ds_read_b64_tr_b16 a[142:143], v127 offset:20992
    ds_read_b64_tr_b16 a[144:145], v127 offset:24576
    ds_read_b64_tr_b16 a[146:147], v127 offset:25088
    ds_read_b64_tr_b16 a[148:149], v127 offset:28672
    ds_read_b64_tr_b16 a[150:151], v127 offset:29184
    ds_read_b64_tr_b16 a[152:153], v127 offset:32768
    ds_read_b64_tr_b16 a[154:155], v127 offset:33280
    ds_read_b64_tr_b16 a[156:157], v127 offset:36864
    ds_read_b64_tr_b16 a[158:159], v127 offset:37376
    s_waitcnt lgkmcnt(0)
    s_waitcnt vmcnt(10)
    s_barrier
    ds_read_b64_tr_b16 a[40:41], v125 offset:0
    ds_read_b64_tr_b16 a[42:43], v125 offset:512
    ds_read_b64_tr_b16 a[44:45], v125 offset:4096
    ds_read_b64_tr_b16 a[46:47], v125 offset:4608
    ds_read_b64_tr_b16 a[48:49], v125 offset:8192
    ds_read_b64_tr_b16 a[50:51], v125 offset:8704
    ds_read_b64_tr_b16 a[52:53], v125 offset:12288
    ds_read_b64_tr_b16 a[54:55], v125 offset:12800
    ds_read_b64_tr_b16 a[56:57], v125 offset:16384
    ds_read_b64_tr_b16 a[58:59], v125 offset:16896
    ds_read_b64_tr_b16 a[60:61], v125 offset:20480
    ds_read_b64_tr_b16 a[62:63], v125 offset:20992
    ds_read_b64_tr_b16 a[64:65], v125 offset:24576
    ds_read_b64_tr_b16 a[66:67], v125 offset:25088
    ds_read_b64_tr_b16 a[68:69], v125 offset:28672
    ds_read_b64_tr_b16 a[70:71], v125 offset:29184
    ds_read_b64_tr_b16 a[72:73], v125 offset:32768
    ds_read_b64_tr_b16 a[74:75], v125 offset:33280
    ds_read_b64_tr_b16 a[76:77], v125 offset:36864
    ds_read_b64_tr_b16 a[78:79], v125 offset:37376
    s_waitcnt lgkmcnt(0)
    s_mov_b32 s49, 40960
    s_mov_b32 s47, 40960
    s_mov_b32 s37, -1
    s_add_u32 s44, s38, 475136
    s_add_u32 s45, s44, s56
    s_mov_b32 s46, 40960
    v_add_u32 v140, 0, v137
    v_mov_b32 v1, 196
    buffer_load_dword v2, v1, s[8:11], 0 offen sc1
    ds_read_b128 v[84:87], v11 offset:0
    ds_read_b128 v[88:91], v11 offset:2048
    ds_read_b128 v[92:95], v12 offset:0
    ds_read_b128 v[96:99], v12 offset:2048
    s_waitcnt lgkmcnt(2)
    v_mfma_f32_16x16x32_bf16 v[108:111], a[0:3], v[84:87], 0
    ds_read_b128 v[100:103], v11 offset:4096
    v_mfma_f32_16x16x32_bf16 v[112:115], a[0:3], v[88:91], 0
    ds_read_b128 v[104:107], v11 offset:6144
    v_mfma_f32_16x16x32_bf16 v[116:119], a[80:83], v[84:87], 0
    v_mfma_f32_16x16x32_bf16 v[120:123], a[80:83], v[88:91], 0
    s_waitcnt lgkmcnt(2)
    v_mfma_f32_16x16x32_bf16 v[108:111], a[4:7], v[92:95], v[108:111]
    ds_read_b128 v[84:87], v12 offset:4096
    v_mfma_f32_16x16x32_bf16 v[112:115], a[4:7], v[96:99], v[112:115]
    ds_read_b128 v[88:91], v12 offset:6144
    v_mfma_f32_16x16x32_bf16 v[116:119], a[84:87], v[92:95], v[116:119]
    v_mfma_f32_16x16x32_bf16 v[120:123], a[84:87], v[96:99], v[120:123]
    s_waitcnt lgkmcnt(2)
    v_mfma_f32_16x16x32_bf16 v[108:111], a[8:11], v[100:103], v[108:111]
    ds_read_b128 v[92:95], v11 offset:8192
    v_mfma_f32_16x16x32_bf16 v[112:115], a[8:11], v[104:107], v[112:115]
    ds_read_b128 v[96:99], v11 offset:10240
    v_mfma_f32_16x16x32_bf16 v[116:119], a[88:91], v[100:103], v[116:119]
    v_mfma_f32_16x16x32_bf16 v[120:123], a[88:91], v[104:107], v[120:123]
    s_waitcnt lgkmcnt(2)
    v_mfma_f32_16x16x32_bf16 v[108:111], a[12:15], v[84:87], v[108:111]
    ds_read_b128 v[100:103], v12 offset:8192
    v_mfma_f32_16x16x32_bf16 v[112:115], a[12:15], v[88:91], v[112:115]
    ds_read_b128 v[104:107], v12 offset:10240
    v_mfma_f32_16x16x32_bf16 v[116:119], a[92:95], v[84:87], v[116:119]
    v_mfma_f32_16x16x32_bf16 v[120:123], a[92:95], v[88:91], v[120:123]
    s_waitcnt lgkmcnt(2)
    v_mfma_f32_16x16x32_bf16 v[108:111], a[16:19], v[92:95], v[108:111]
    ds_read_b128 v[84:87], v11 offset:12288
    v_mfma_f32_16x16x32_bf16 v[112:115], a[16:19], v[96:99], v[112:115]
    ds_read_b128 v[88:91], v11 offset:14336
    v_mfma_f32_16x16x32_bf16 v[116:119], a[96:99], v[92:95], v[116:119]
    v_mfma_f32_16x16x32_bf16 v[120:123], a[96:99], v[96:99], v[120:123]
    s_waitcnt lgkmcnt(2)
    v_mfma_f32_16x16x32_bf16 v[108:111], a[20:23], v[100:103], v[108:111]
    ds_read_b128 v[92:95], v12 offset:12288
    v_mfma_f32_16x16x32_bf16 v[112:115], a[20:23], v[104:107], v[112:115]
    ds_read_b128 v[96:99], v12 offset:14336
    v_mfma_f32_16x16x32_bf16 v[116:119], a[100:103], v[100:103], v[116:119]
    v_mfma_f32_16x16x32_bf16 v[120:123], a[100:103], v[104:107], v[120:123]
    s_waitcnt lgkmcnt(2)
    v_mfma_f32_16x16x32_bf16 v[108:111], a[24:27], v[84:87], v[108:111]
    ds_read_b128 v[100:103], v11 offset:16384
    v_mfma_f32_16x16x32_bf16 v[112:115], a[24:27], v[88:91], v[112:115]
    ds_read_b128 v[104:107], v11 offset:18432
    v_mfma_f32_16x16x32_bf16 v[116:119], a[104:107], v[84:87], v[116:119]
    v_mfma_f32_16x16x32_bf16 v[120:123], a[104:107], v[88:91], v[120:123]
    s_waitcnt lgkmcnt(2)
    v_mfma_f32_16x16x32_bf16 v[108:111], a[28:31], v[92:95], v[108:111]
    ds_read_b128 v[84:87], v12 offset:16384
    v_mfma_f32_16x16x32_bf16 v[112:115], a[28:31], v[96:99], v[112:115]
    ds_read_b128 v[88:91], v12 offset:18432
    v_mfma_f32_16x16x32_bf16 v[116:119], a[108:111], v[92:95], v[116:119]
    v_mfma_f32_16x16x32_bf16 v[120:123], a[108:111], v[96:99], v[120:123]
    s_waitcnt lgkmcnt(2)
    v_mfma_f32_16x16x32_bf16 v[108:111], a[32:35], v[100:103], v[108:111]
    ds_read_b128 v[92:95], v11 offset:20480
    v_mfma_f32_16x16x32_bf16 v[112:115], a[32:35], v[104:107], v[112:115]
    ds_read_b128 v[96:99], v11 offset:22528
    v_mfma_f32_16x16x32_bf16 v[116:119], a[112:115], v[100:103], v[116:119]
    v_mfma_f32_16x16x32_bf16 v[120:123], a[112:115], v[104:107], v[120:123]
    s_waitcnt lgkmcnt(2)
    v_mfma_f32_16x16x32_bf16 v[108:111], a[36:39], v[84:87], v[108:111]
    ds_read_b128 v[100:103], v12 offset:20480
    v_mfma_f32_16x16x32_bf16 v[112:115], a[36:39], v[88:91], v[112:115]
    ds_read_b128 v[104:107], v12 offset:22528
    v_mfma_f32_16x16x32_bf16 v[116:119], a[116:119], v[84:87], v[116:119]
    v_mfma_f32_16x16x32_bf16 v[120:123], a[116:119], v[88:91], v[120:123]
    s_waitcnt lgkmcnt(2)
    v_mfma_f32_16x16x32_bf16 v[108:111], a[40:43], v[92:95], v[108:111]
    ds_read_b128 v[84:87], v11 offset:24576
    v_mfma_f32_16x16x32_bf16 v[112:115], a[40:43], v[96:99], v[112:115]
    ds_read_b128 v[88:91], v11 offset:26624
    v_mfma_f32_16x16x32_bf16 v[116:119], a[120:123], v[92:95], v[116:119]
    v_mfma_f32_16x16x32_bf16 v[120:123], a[120:123], v[96:99], v[120:123]
    s_waitcnt lgkmcnt(2)
    v_mfma_f32_16x16x32_bf16 v[108:111], a[44:47], v[100:103], v[108:111]
    ds_read_b128 v[92:95], v12 offset:24576
    v_mfma_f32_16x16x32_bf16 v[112:115], a[44:47], v[104:107], v[112:115]
    ds_read_b128 v[96:99], v12 offset:26624
    v_mfma_f32_16x16x32_bf16 v[116:119], a[124:127], v[100:103], v[116:119]
    v_mfma_f32_16x16x32_bf16 v[120:123], a[124:127], v[104:107], v[120:123]
    s_waitcnt lgkmcnt(2)
    v_mfma_f32_16x16x32_bf16 v[108:111], a[48:51], v[84:87], v[108:111]
    ds_read_b128 v[100:103], v11 offset:28672
    v_mfma_f32_16x16x32_bf16 v[112:115], a[48:51], v[88:91], v[112:115]
    ds_read_b128 v[104:107], v11 offset:30720
    v_mfma_f32_16x16x32_bf16 v[116:119], a[128:131], v[84:87], v[116:119]
    v_mfma_f32_16x16x32_bf16 v[120:123], a[128:131], v[88:91], v[120:123]
    s_waitcnt lgkmcnt(2)
    v_mfma_f32_16x16x32_bf16 v[108:111], a[52:55], v[92:95], v[108:111]
    ds_read_b128 v[84:87], v12 offset:28672
    v_mfma_f32_16x16x32_bf16 v[112:115], a[52:55], v[96:99], v[112:115]
    ds_read_b128 v[88:91], v12 offset:30720
    v_mfma_f32_16x16x32_bf16 v[116:119], a[132:135], v[92:95], v[116:119]
    v_mfma_f32_16x16x32_bf16 v[120:123], a[132:135], v[96:99], v[120:123]
    s_waitcnt lgkmcnt(2)
    v_mfma_f32_16x16x32_bf16 v[108:111], a[56:59], v[100:103], v[108:111]
    ds_read_b128 v[92:95], v11 offset:32768
    v_mfma_f32_16x16x32_bf16 v[112:115], a[56:59], v[104:107], v[112:115]
    ds_read_b128 v[96:99], v11 offset:34816
    v_mfma_f32_16x16x32_bf16 v[116:119], a[136:139], v[100:103], v[116:119]
    v_mfma_f32_16x16x32_bf16 v[120:123], a[136:139], v[104:107], v[120:123]
    s_waitcnt lgkmcnt(2)
    v_mfma_f32_16x16x32_bf16 v[108:111], a[60:63], v[84:87], v[108:111]
    ds_read_b128 v[100:103], v12 offset:32768
    v_mfma_f32_16x16x32_bf16 v[112:115], a[60:63], v[88:91], v[112:115]
    ds_read_b128 v[104:107], v12 offset:34816
    v_mfma_f32_16x16x32_bf16 v[116:119], a[140:143], v[84:87], v[116:119]
    v_mfma_f32_16x16x32_bf16 v[120:123], a[140:143], v[88:91], v[120:123]
    s_waitcnt lgkmcnt(2)
    v_mfma_f32_16x16x32_bf16 v[108:111], a[64:67], v[92:95], v[108:111]
    ds_read_b128 v[84:87], v11 offset:36864
    v_mfma_f32_16x16x32_bf16 v[112:115], a[64:67], v[96:99], v[112:115]
    ds_read_b128 v[88:91], v11 offset:38912
    v_mfma_f32_16x16x32_bf16 v[116:119], a[144:147], v[92:95], v[116:119]
    v_mfma_f32_16x16x32_bf16 v[120:123], a[144:147], v[96:99], v[120:123]
    s_waitcnt lgkmcnt(2)
    v_mfma_f32_16x16x32_bf16 v[108:111], a[68:71], v[100:103], v[108:111]
    ds_read_b128 v[92:95], v12 offset:36864
    v_mfma_f32_16x16x32_bf16 v[112:115], a[68:71], v[104:107], v[112:115]
    ds_read_b128 v[96:99], v12 offset:38912
    v_mfma_f32_16x16x32_bf16 v[116:119], a[148:151], v[100:103], v[116:119]
    v_mfma_f32_16x16x32_bf16 v[120:123], a[148:151], v[104:107], v[120:123]
    s_waitcnt lgkmcnt(0)
    v_mfma_f32_16x16x32_bf16 v[108:111], a[72:75], v[84:87], v[108:111]
    v_add_u32 v11, s49, v11
    v_mfma_f32_16x16x32_bf16 v[112:115], a[72:75], v[88:91], v[112:115]
    v_add_u32 v12, s49, v12
    v_mfma_f32_16x16x32_bf16 v[108:111], a[76:79], v[92:95], v[108:111]
    s_sub_u32 s47, s47, s49
    v_mfma_f32_16x16x32_bf16 v[112:115], a[76:79], v[96:99], v[112:115]
    s_sub_u32 s49, 0, s49
    v_mfma_f32_16x16x32_bf16 v[116:119], a[152:155], v[84:87], v[116:119]
    v_mfma_f32_16x16x32_bf16 v[120:123], a[152:155], v[88:91], v[120:123]
    v_mfma_f32_16x16x32_bf16 v[116:119], a[156:159], v[92:95], v[116:119]
    v_mfma_f32_16x16x32_bf16 v[120:123], a[156:159], v[96:99], v[120:123]
    v_cvt_pk_bf16_f32 v124, v108, v109
    v_cvt_pk_bf16_f32 v125, v110, v111
    v_cvt_pk_bf16_f32 v126, v112, v113
    v_cvt_pk_bf16_f32 v127, v114, v115
    s_nop 0
    v_permlane16_swap_b32 v124, v126
    v_permlane16_swap_b32 v125, v127
    v_cvt_pk_bf16_f32 v128, v116, v117
    v_cvt_pk_bf16_f32 v129, v118, v119
    v_cvt_pk_bf16_f32 v130, v120, v121
    v_cvt_pk_bf16_f32 v131, v122, v123
    s_nop 0
    v_permlane16_swap_b32 v128, v130
    v_permlane16_swap_b32 v129, v131
    ds_write_b128 v140, v[128:131]
    buffer_store_dwordx4 v[124:127], v19, s[4:7], s44 offen sc1
    buffer_store_dwordx4 v[128:131], v19, s[4:7], s45 offen sc1
    s_waitcnt vmcnt(2)
    s_branch L_gw_67c
L_gw_67:
    buffer_load_dword v2, v1, s[8:11], 0 offen sc1
    s_sub_u32 s36, s36, 1
    s_cbranch_scc1 L_exit
    s_waitcnt vmcnt(0)
L_gw_67c:
    v_readfirstlane_b32 s90, v2
    s_nop 0
    s_cmp_eq_u32 s90, 0
    s_cbranch_scc1 L_gw_67
    s_waitcnt vmcnt(2) lgkmcnt(0)
    s_barrier
    s_add_u32 s44, s38, 573440
    s_add_u32 s45, s44, s56
    s_mov_b32 s46, 81920
    v_add_u32 v140, 4096, v137
    ds_read_b128 v[84:87], v11 offset:0
    ds_read_b128 v[88:91], v11 offset:2048
    ds_read_b128 v[92:95], v12 offset:0
    ds_read_b128 v[96:99], v12 offset:2048
    s_lshl_b32 s90, s32, 10
    s_add_u32 m0, s90, s47
    s_waitcnt lgkmcnt(2)
    v_mfma_f32_16x16x32_bf16 v[108:111], a[0:3], v[84:87], 0
    ds_read_b128 v[100:103], v11 offset:4096
    s_and_b32 s50, s37, 3
    v_mfma_f32_16x16x32_bf16 v[112:115], a[0:3], v[88:91], 0
    ds_read_b128 v[104:107], v11 offset:6144
    s_mul_i32 s53, s50, 327680
    v_mfma_f32_16x16x32_bf16 v[116:119], a[80:83], v[84:87], 0
    buffer_load_dwordx4 v10, s[24:27], s46 offen offset:0 nt lds
    s_add_u32 m0, m0, 3968
    v_mfma_f32_16x16x32_bf16 v[120:123], a[80:83], v[88:91], 0
    s_waitcnt lgkmcnt(2)
    s_add_u32 s51, s37, 2
    v_mfma_f32_16x16x32_bf16 v[108:111], a[4:7], v[92:95], v[108:111]
    ds_read_b128 v[84:87], v12 offset:4096
    s_and_b32 s50, s51, 3
    v_mfma_f32_16x16x32_bf16 v[112:115], a[4:7], v[96:99], v[112:115]
    ds_read_b128 v[88:91], v12 offset:6144
    s_mul_i32 s50, s50, 98304
    v_mfma_f32_16x16x32_bf16 v[116:119], a[84:87], v[92:95], v[116:119]
    buffer_load_dwordx4 v10, s[24:27], s46 offen offset:128 nt lds
    s_add_u32 m0, m0, 3968
    v_mfma_f32_16x16x32_bf16 v[120:123], a[84:87], v[96:99], v[120:123]
    s_waitcnt lgkmcnt(2)
    s_add_u32 s50, s50, 475136
    v_mfma_f32_16x16x32_bf16 v[108:111], a[8:11], v[100:103], v[108:111]
    ds_read_b128 v[92:95], v11 offset:8192
    s_add_u32 s44, s38, s50
    v_mfma_f32_16x16x32_bf16 v[112:115], a[8:11], v[104:107], v[112:115]
    ds_read_b128 v[96:99], v11 offset:10240
    s_add_u32 s45, s44, s56
    v_mfma_f32_16x16x32_bf16 v[116:119], a[88:91], v[100:103], v[116:119]
    buffer_load_dwordx4 v10, s[24:27], s46 offen offset:256 nt lds
    s_add_u32 m0, m0, 3968
    v_mfma_f32_16x16x32_bf16 v[120:123], a[88:91], v[104:107], v[120:123]
    s_waitcnt lgkmcnt(2)
    s_and_b32 s50, s51, 3
    v_mfma_f32_16x16x32_bf16 v[108:111], a[12:15], v[84:87], v[108:111]
    ds_read_b128 v[100:103], v12 offset:8192
    s_lshl_b32 s50, s50, 12
    v_mfma_f32_16x16x32_bf16 v[112:115], a[12:15], v[88:91], v[112:115]
    ds_read_b128 v[104:107], v12 offset:10240
    v_add_u32 v140, s50, v137
    v_mfma_f32_16x16x32_bf16 v[116:119], a[92:95], v[84:87], v[116:119]
    buffer_load_dwordx4 v10, s[24:27], s46 offen offset:384 nt lds
    s_add_u32 m0, m0, 3968
    v_mfma_f32_16x16x32_bf16 v[120:123], a[92:95], v[88:91], v[120:123]
    s_waitcnt lgkmcnt(2)
    s_add_u32 s37, s37, 1
    v_mfma_f32_16x16x32_bf16 v[108:111], a[16:19], v[92:95], v[108:111]
    ds_read_b128 v[84:87], v11 offset:12288
    s_mov_b32 s52, 0
    v_mfma_f32_16x16x32_bf16 v[112:115], a[16:19], v[96:99], v[112:115]
    ds_read_b128 v[88:91], v11 offset:14336
    s_and_b32 s50, s37, 3
    v_mfma_f32_16x16x32_bf16 v[116:119], a[96:99], v[92:95], v[116:119]
    buffer_load_dwordx4 v10, s[24:27], s46 offen offset:512 nt lds
    s_add_u32 m0, m0, 3968
    v_mfma_f32_16x16x32_bf16 v[120:123], a[96:99], v[96:99], v[120:123]
    s_waitcnt lgkmcnt(2)
    s_mul_i32 s51, s50, 114688
    v_mfma_f32_16x16x32_bf16 v[108:111], a[20:23], v[100:103], v[108:111]
    ds_read_b128 v[92:95], v12 offset:12288
    s_add_u32 s41, s38, s51
    v_mfma_f32_16x16x32_bf16 v[112:115], a[20:23], v[104:107], v[112:115]
    ds_read_b128 v[96:99], v12 offset:14336
    s_and_b32 s54, s37, s55
    v_mfma_f32_16x16x32_bf16 v[116:119], a[100:103], v[100:103], v[116:119]
    buffer_load_dwordx4 v10, s[24:27], s46 offen offset:640 nt lds
    s_add_u32 m0, m0, 3968
    v_mfma_f32_16x16x32_bf16 v[120:123], a[100:103], v[104:107], v[120:123]
    s_waitcnt lgkmcnt(2)
    s_lshl_b32 s50, s50, 12
    v_mfma_f32_16x16x32_bf16 v[108:111], a[24:27], v[84:87], v[108:111]
    ds_read_b128 v[100:103], v11 offset:16384
    v_add_u32 v141, s50, v138
    v_mfma_f32_16x16x32_bf16 v[112:115], a[24:27], v[88:91], v[112:115]
    ds_read_b128 v[104:107], v11 offset:18432
    s_add_u32 s43, s41, 40960
    v_mfma_f32_16x16x32_bf16 v[116:119], a[104:107], v[84:87], v[116:119]
    buffer_load_dwordx4 v10, s[24:27], s46 offen offset:768 nt lds
    s_add_u32 m0, m0, 3968
    v_mfma_f32_16x16x32_bf16 v[120:123], a[104:107], v[88:91], v[120:123]
    s_waitcnt lgkmcnt(2)
    v_mfma_f32_16x16x32_bf16 v[108:111], a[28:31], v[92:95], v[108:111]
    ds_read_b128 v[84:87], v12 offset:16384
    v_mfma_f32_16x16x32_bf16 v[112:115], a[28:31], v[96:99], v[112:115]
    ds_read_b128 v[88:91], v12 offset:18432
    v_mfma_f32_16x16x32_bf16 v[116:119], a[108:111], v[92:95], v[116:119]
    buffer_load_dwordx4 v10, s[24:27], s46 offen offset:896 nt lds
    s_add_u32 m0, m0, 3968
    v_mfma_f32_16x16x32_bf16 v[120:123], a[108:111], v[96:99], v[120:123]
    s_waitcnt lgkmcnt(2)
    v_mfma_f32_16x16x32_bf16 v[108:111], a[32:35], v[100:103], v[108:111]
    ds_read_b128 v[92:95], v11 offset:20480
    v_mfma_f32_16x16x32_bf16 v[112:115], a[32:35], v[104:107], v[112:115]
    ds_read_b128 v[96:99], v11 offset:22528
    v_mfma_f32_16x16x32_bf16 v[116:119], a[112:115], v[100:103], v[116:119]
    buffer_load_dwordx4 v10, s[24:27], s46 offen offset:1024 nt lds
    s_add_u32 m0, m0, 3968
    v_mfma_f32_16x16x32_bf16 v[120:123], a[112:115], v[104:107], v[120:123]
    s_waitcnt lgkmcnt(2)
    v_mfma_f32_16x16x32_bf16 v[108:111], a[36:39], v[84:87], v[108:111]
    ds_read_b128 v[100:103], v12 offset:20480
    v_mfma_f32_16x16x32_bf16 v[112:115], a[36:39], v[88:91], v[112:115]
    ds_read_b128 v[104:107], v12 offset:22528
    v_mfma_f32_16x16x32_bf16 v[116:119], a[116:119], v[84:87], v[116:119]
    buffer_load_dwordx4 v10, s[24:27], s46 offen offset:1152 nt lds
    v_mfma_f32_16x16x32_bf16 v[120:123], a[116:119], v[88:91], v[120:123]
    s_waitcnt lgkmcnt(2)
    v_mfma_f32_16x16x32_bf16 v[108:111], a[40:43], v[92:95], v[108:111]
    ds_read_b128 v[84:87], v11 offset:24576
    v_mfma_f32_16x16x32_bf16 v[112:115], a[40:43], v[96:99], v[112:115]
    ds_read_b128 v[88:91], v11 offset:26624
    v_mfma_f32_16x16x32_bf16 v[116:119], a[120:123], v[92:95], v[116:119]
    v_mfma_f32_16x16x32_bf16 v[120:123], a[120:123], v[96:99], v[120:123]
    s_waitcnt lgkmcnt(2)
    v_mfma_f32_16x16x32_bf16 v[108:111], a[44:47], v[100:103], v[108:111]
    ds_read_b128 v[92:95], v12 offset:24576
    v_mfma_f32_16x16x32_bf16 v[112:115], a[44:47], v[104:107], v[112:115]
    ds_read_b128 v[96:99], v12 offset:26624
    v_mfma_f32_16x16x32_bf16 v[116:119], a[124:127], v[100:103], v[116:119]
    v_mfma_f32_16x16x32_bf16 v[120:123], a[124:127], v[104:107], v[120:123]
    s_waitcnt lgkmcnt(2)
    v_mfma_f32_16x16x32_bf16 v[108:111], a[48:51], v[84:87], v[108:111]
    ds_read_b128 v[100:103], v11 offset:28672
    v_mfma_f32_16x16x32_bf16 v[112:115], a[48:51], v[88:91], v[112:115]
    ds_read_b128 v[104:107], v11 offset:30720
    v_mfma_f32_16x16x32_bf16 v[116:119], a[128:131], v[84:87], v[116:119]
    v_mfma_f32_16x16x32_bf16 v[120:123], a[128:131], v[88:91], v[120:123]
    s_waitcnt lgkmcnt(2)
    v_mfma_f32_16x16x32_bf16 v[108:111], a[52:55], v[92:95], v[108:111]
    ds_read_b128 v[84:87], v12 offset:28672
    v_mfma_f32_16x16x32_bf16 v[112:115], a[52:55], v[96:99], v[112:115]
    ds_read_b128 v[88:91], v12 offset:30720
    v_mfma_f32_16x16x32_bf16 v[116:119], a[132:135], v[92:95], v[116:119]
    v_mfma_f32_16x16x32_bf16 v[120:123], a[132:135], v[96:99], v[120:123]
    s_waitcnt lgkmcnt(2)
    v_mfma_f32_16x16x32_bf16 v[108:111], a[56:59], v[100:103], v[108:111]
    ds_read_b128 v[92:95], v11 offset:32768
    v_mfma_f32_16x16x32_bf16 v[112:115], a[56:59], v[104:107], v[112:115]
    ds_read_b128 v[96:99], v11 offset:34816
    v_mfma_f32_16x16x32_bf16 v[116:119], a[136:139], v[100:103], v[116:119]
    v_mfma_f32_16x16x32_bf16 v[120:123], a[136:139], v[104:107], v[120:123]
    s_waitcnt lgkmcnt(2)
    v_mfma_f32_16x16x32_bf16 v[108:111], a[60:63], v[84:87], v[108:111]
    ds_read_b128 v[100:103], v12 offset:32768
    v_mfma_f32_16x16x32_bf16 v[112:115], a[60:63], v[88:91], v[112:115]
    ds_read_b128 v[104:107], v12 offset:34816
    v_mfma_f32_16x16x32_bf16 v[116:119], a[140:143], v[84:87], v[116:119]
    v_mfma_f32_16x16x32_bf16 v[120:123], a[140:143], v[88:91], v[120:123]
    s_waitcnt lgkmcnt(2)
    v_mfma_f32_16x16x32_bf16 v[108:111], a[64:67], v[92:95], v[108:111]
    ds_read_b128 v[84:87], v11 offset:36864
    v_mfma_f32_16x16x32_bf16 v[112:115], a[64:67], v[96:99], v[112:115]
    ds_read_b128 v[88:91], v11 offset:38912
    v_mfma_f32_16x16x32_bf16 v[116:119], a[144:147], v[92:95], v[116:119]
    v_mfma_f32_16x16x32_bf16 v[120:123], a[144:147], v[96:99], v[120:123]
    s_waitcnt lgkmcnt(2)
    v_mfma_f32_16x16x32_bf16 v[108:111], a[68:71], v[100:103], v[108:111]
    ds_read_b128 v[92:95], v12 offset:36864
    v_mfma_f32_16x16x32_bf16 v[112:115], a[68:71], v[104:107], v[112:115]
    ds_read_b128 v[96:99], v12 offset:38912
    v_mfma_f32_16x16x32_bf16 v[116:119], a[148:151], v[100:103], v[116:119]
    v_mfma_f32_16x16x32_bf16 v[120:123], a[148:151], v[104:107], v[120:123]
    s_waitcnt lgkmcnt(0)
    v_mfma_f32_16x16x32_bf16 v[108:111], a[72:75], v[84:87], v[108:111]
    v_add_u32 v11, s49, v11
    v_mfma_f32_16x16x32_bf16 v[112:115], a[72:75], v[88:91], v[112:115]
    v_add_u32 v12, s49, v12
    v_mfma_f32_16x16x32_bf16 v[108:111], a[76:79], v[92:95], v[108:111]
    s_sub_u32 s47, s47, s49
    v_mfma_f32_16x16x32_bf16 v[112:115], a[76:79], v[96:99], v[112:115]
    s_sub_u32 s49, 0, s49
    v_mfma_f32_16x16x32_bf16 v[116:119], a[152:155], v[84:87], v[116:119]
    v_mfma_f32_16x16x32_bf16 v[120:123], a[152:155], v[88:91], v[120:123]
    v_mfma_f32_16x16x32_bf16 v[116:119], a[156:159], v[92:95], v[116:119]
    v_mfma_f32_16x16x32_bf16 v[120:123], a[156:159], v[96:99], v[120:123]
    v_cvt_pk_bf16_f32 v124, v108, v109
    v_cvt_pk_bf16_f32 v125, v110, v111
    v_cvt_pk_bf16_f32 v126, v112, v113
    v_cvt_pk_bf16_f32 v127, v114, v115
    s_nop 0
    v_permlane16_swap_b32 v124, v126
    v_permlane16_swap_b32 v125, v127
    v_cvt_pk_bf16_f32 v128, v116, v117
    v_cvt_pk_bf16_f32 v129, v118, v119
    v_cvt_pk_bf16_f32 v130, v120, v121
    v_cvt_pk_bf16_f32 v131, v122, v123
    s_nop 0
    v_permlane16_swap_b32 v128, v130
    v_permlane16_swap_b32 v129, v131
    ds_write_b128 v140, v[128:131]
    buffer_store_dwordx4 v[124:127], v19, s[4:7], s44 offen sc1
    buffer_store_dwordx4 v[128:131], v19, s[4:7], s45 offen sc1
    s_mov_b32 m0, s48
L_qkv_loop_s:
    s_add_u32 s50, s37, 2
    s_and_b32 s50, s50, 3
    s_mul_i32 s50, s50, 114688
    s_add_u32 s42, s38, s50
    s_add_u32 s50, s37, 3
    s_min_u32 s50, s50, 63
    s_mul_i32 s46, s50, 40960
    s_add_u32 s51, s37, 1
    v_mov_b32 v20, s51
    s_mov_b32 m0, s48
    v_mov_b32 v68, 0
    v_mov_b32 v69, 0
    v_mov_b32 v70, 0
    v_mov_b32 v71, 0
    v_mov_b32 v72, 0
    v_mov_b32 v73, 0
    v_mov_b32 v74, 0
    v_mov_b32 v75, 0
    ds_read_b128 v[156:159], v141
    ds_read_b128 v[160:163], v141 offset:1024
    buffer_load_dwordx4 v13, s[4:7], s41 offen sc1 lds
    buffer_load_dwordx4 v13, s[4:7], s41 offen offset:1024 sc1 lds
    buffer_load_dword v14, s[4:7], s41 offen offset:2048 sc1 lds
    buffer_load_dword v14, s[4:7], s41 offen offset:2304 sc1 lds
    s_waitcnt vmcnt(0)
    ds_read_b32 v18, v15
    s_waitcnt lgkmcnt(0)
    v_cmp_eq_u32 vcc, -1, v18
    s_cbranch_vccnz L_poll_69c
L_poll_69x:
    s_barrier
    ds_read_b128 v[28:31], v16 offset:0
    ds_read_b128 v[32:35], v16 offset:1024
    ds_read_b128 v[36:39], v16 offset:2048
    ds_read_b128 v[40:43], v16 offset:3072
    s_waitcnt lgkmcnt(3)
    v_smfmac_f32_16x16x64_bf16 v[68:71], v[28:31], a[0:7], v17
    ds_read_b128 v[44:47], v16 offset:4096
    v_smfmac_f32_16x16x64_bf16 v[72:75], v[28:31], a[80:87], v17
    ds_read_b128 v[48:51], v16 offset:5120
    s_waitcnt lgkmcnt(4)
    v_smfmac_f32_16x16x64_bf16 v[68:71], v[32:35], a[8:15], v17
    ds_read_b128 v[52:55], v16 offset:6144
    v_smfmac_f32_16x16x64_bf16 v[72:75], v[32:35], a[88:95], v17
    ds_read_b128 v[56:59], v16 offset:7168
    s_waitcnt lgkmcnt(5)
    v_smfmac_f32_16x16x64_bf16 v[68:71], v[36:39], a[16:23], v17
    ds_read_b128 v[60:63], v16 offset:8192
    s_waitcnt lgkmcnt(5)
    v_smfmac_f32_16x16x64_bf16 v[68:71], v[40:43], a[24:31], v17
    ds_read_b128 v[64:67], v16 offset:9216
    s_waitcnt lgkmcnt(5)
    v_smfmac_f32_16x16x64_bf16 v[68:71], v[44:47], a[32:39], v17
    s_waitcnt lgkmcnt(4)
    v_smfmac_f32_16x16x64_bf16 v[68:71], v[48:51], a[40:47], v17
    s_waitcnt lgkmcnt(3)
    v_smfmac_f32_16x16x64_bf16 v[68:71], v[52:55], a[48:55], v17
    s_waitcnt lgkmcnt(2)
    v_smfmac_f32_16x16x64_bf16 v[68:71], v[56:59], a[56:63], v17
    s_waitcnt lgkmcnt(1)
    v_smfmac_f32_16x16x64_bf16 v[68:71], v[60:63], a[64:71], v17
    s_waitcnt lgkmcnt(0)
    v_smfmac_f32_16x16x64_bf16 v[68:71], v[64:67], a[72:79], v17
L_redo_68:
    v_smfmac_f32_16x16x64_bf16 v[72:75], v[36:39], a[96:103], v17
    v_smfmac_f32_16x16x64_bf16 v[72:75], v[40:43], a[104:111], v17
    buffer_store_dword v20, v21, s[4:7], s38 offen offset:0 sc1
    v_smfmac_f32_16x16x64_bf16 v[72:75], v[44:47], a[112:119], v17
    v_add_f32 v68, v68, v70
    v_add_f32 v69, v69, v71
    v_smfmac_f32_16x16x64_bf16 v[72:75], v[48:51], a[120:127], v17
    v_cvt_pk_bf16_f32 v132, v68, v69
    ds_write_b32 v23, v132
    v_smfmac_f32_16x16x64_bf16 v[72:75], v[52:55], a[128:135], v17
    v_cmp_u_f32 vcc, v68, v69
    v_smfmac_f32_16x16x64_bf16 v[72:75], v[56:59], a[136:143], v17
    v_smfmac_f32_16x16x64_bf16 v[72:75], v[60:63], a[144:151], v17
    s_cbranch_vccnz L_nan_70
L_cont_71:
    v_smfmac_f32_16x16x64_bf16 v[72:75], v[64:67], a[152:159], v17
    s_waitcnt lgkmcnt(0)
    s_barrier
    ds_read_b64_tr_b16 v[76:77], v24 offset:0
    ds_read_b64_tr_b16 v[78:79], v134 offset:0
    ds_read_b64_tr_b16 v[80:81], v24 offset:1024
    ds_read_b64_tr_b16 v[82:83], v134 offset:1024
    s_cmp_eq_u32 s32, 0
    s_cbranch_scc1 L_w0_72
    s_cmp_eq_u32 s32, 3
    s_cbranch_scc1 L_w3_73
    v_pk_add_f32 v[72:73], v[72:73], v[74:75]
    v_cvt_pk_bf16_f32 v133, v72, v73
    ds_write_b32 v23, v133 offset:4
    s_waitcnt lgkmcnt(3)
    v_mfma_f32_16x16x32_bf16 v[164:167], v[156:159], v[76:79], 0
    s_waitcnt lgkmcnt(1)
    v_mfma_f32_16x16x32_bf16 v[164:167], v[160:163], v[80:83], v[164:167]
    s_waitcnt lgkmcnt(0)
    s_barrier
    s_nop 5
    buffer_store_dwordx4 v[164:167], v135, s[4:7], s41 offen sc1
    ds_read_b128 v[84:87], v11 offset:0
    ds_read_b128 v[88:91], v11 offset:2048
    ds_read_b128 v[92:95], v12 offset:0
    ds_read_b128 v[96:99], v12 offset:2048
    s_branch L_join_74
L_w0_72:
    v_pk_add_f32 v[72:73], v[72:73], v[74:75]
    v_cvt_pk_bf16_f32 v133, v72, v73
    ds_write_b32 v23, v133 offset:4
    s_waitcnt lgkmcnt(0)
    s_barrier
    ds_read_b64_tr_b16 v[76:77], v24 offset:0
    ds_read_b64_tr_b16 v[78:79], v134 offset:0
    ds_read_b64_tr_b16 v[80:81], v24 offset:1024
    ds_read_b64_tr_b16 v[82:83], v134 offset:1024
    s_waitcnt lgkmcnt(2)
    v_mfma_f32_16x16x32_bf16 v[164:167], v[76:79], v[76:79], 0
    s_waitcnt lgkmcnt(0)
    v_mfma_f32_16x16x32_bf16 v[164:167], v[80:83], v[80:83], v[164:167]
    ds_read_b128 v[84:87], v11 offset:0
    ds_read_b128 v[88:91], v11 offset:2048
    ds_read_b128 v[92:95], v12 offset:0
    ds_read_b128 v[96:99], v12 offset:2048
    s_nop 3
    buffer_store_dword v166, v135, s[4:7], s41 offen sc1
    buffer_store_dword v167, v135, s[4:7], s41 offen offset:8 sc1
    s_branch L_join_74
L_w3_73:
    v_pk_add_f32 v[72:73], v[72:73], v[74:75]
    v_cvt_pk_bf16_f32 v133, v72, v73
    ds_write_b32 v23, v133 offset:4
    s_waitcnt lgkmcnt(0)
    s_barrier
    ds_read_b64_tr_b16 v[76:77], v24 offset:0
    ds_read_b64_tr_b16 v[78:79], v134 offset:0
    ds_read_b64_tr_b16 v[80:81], v24 offset:1024
    ds_read_b64_tr_b16 v[82:83], v134 offset:1024
    s_waitcnt lgkmcnt(0)
    ds_read_b128 v[84:87], v11 offset:0
    ds_read_b128 v[88:91], v11 offset:2048
    ds_read_b128 v[92:95], v12 offset:0
    ds_read_b128 v[96:99], v12 offset:2048
    s_waitcnt lgkmcnt(0)
    buffer_store_dwordx4 v[76:79], v136, s[4:7], s43 offen sc1
    buffer_store_dwordx4 v[80:83], v136, s[4:7], s43 offen offset:512 sc1
L_join_74:
    s_cmp_eq_u32 s37, 63
    s_cbranch_scc1 L_end_75
    s_cmp_eq_u32 s37, 0
    s_cbranch_scc1 L_sd_76c
L_sd_76:
    s_lshl_b32 s90, s32, 10
    s_add_u32 m0, s90, s47
    s_waitcnt lgkmcnt(2)
    v_mfma_f32_16x16x32_bf16 v[108:111], a[0:3], v[84:87], 0
    ds_read_b128 v[100:103], v11 offset:4096
    s_and_b32 s50, s37, 3
    v_mfma_f32_16x16x32_bf16 v[112:115], a[0:3], v[88:91], 0
    ds_read_b128 v[104:107], v11 offset:6144
    s_mul_i32 s53, s50, 327680
    v_mfma_f32_16x16x32_bf16 v[116:119], a[80:83], v[84:87], 0
    s_add_u32 s51, s37, 2
    s_and_b32 s50, s51, 3
    v_mfma_f32_16x16x32_bf16 v[120:123], a[80:83], v[88:91], 0
    s_waitcnt lgkmcnt(2)
    s_mul_i32 s50, s50, 98304
    v_mfma_f32_16x16x32_bf16 v[108:111], a[4:7], v[92:95], v[108:111]
    ds_read_b128 v[84:87], v12 offset:4096
    s_add_u32 s50, s50, 475136
    v_mfma_f32_16x16x32_bf16 v[112:115], a[4:7], v[96:99], v[112:115]
    ds_read_b128 v[88:91], v12 offset:6144
    s_add_u32 s44, s38, s50
    v_mfma_f32_16x16x32_bf16 v[116:119], a[84:87], v[92:95], v[116:119]
    s_add_u32 s45, s44, s56
    s_and_b32 s50, s51, 3
    v_mfma_f32_16x16x32_bf16 v[120:123], a[84:87], v[96:99], v[120:123]
    s_waitcnt lgkmcnt(2)
    s_lshl_b32 s50, s50, 12
    v_mfma_f32_16x16x32_bf16 v[108:111], a[8:11], v[100:103], v[108:111]
    ds_read_b128 v[92:95], v11 offset:8192
    v_add_u32 v140, s50, v137
    v_mfma_f32_16x16x32_bf16 v[112:115], a[8:11], v[104:107], v[112:115]
    ds_read_b128 v[96:99], v11 offset:10240
    s_add_u32 s37, s37, 1
    v_mfma_f32_16x16x32_bf16 v[116:119], a[88:91], v[100:103], v[116:119]
    s_mov_b32 s52, 0
    s_and_b32 s50, s37, 3
    v_mfma_f32_16x16x32_bf16 v[120:123], a[88:91], v[104:107], v[120:123]
    s_waitcnt lgkmcnt(2)
    s_mul_i32 s51, s50, 114688
    v_mfma_f32_16x16x32_bf16 v[108:111], a[12:15], v[84:87], v[108:111]
    ds_read_b128 v[100:103], v12 offset:8192
    s_add_u32 s41, s38, s51
    v_mfma_f32_16x16x32_bf16 v[112:115], a[12:15], v[88:91], v[112:115]
    ds_read_b128 v[104:107], v12 offset:10240
    s_and_b32 s54, s37, s55
    v_mfma_f32_16x16x32_bf16 v[116:119], a[92:95], v[84:87], v[116:119]
    buffer_store_dword v22, v150, s[4:7], s42 offen offset:0 sc1
    buffer_store_dword v22, v149, s[4:7], s42 offen offset:0 sc1
    v_mfma_f32_16x16x32_bf16 v[120:123], a[92:95], v[88:91], v[120:123]
    s_waitcnt lgkmcnt(2)
    s_lshl_b32 s50, s50, 12
    v_mfma_f32_16x16x32_bf16 v[108:111], a[16:19], v[92:95], v[108:111]
    ds_read_b128 v[84:87], v11 offset:12288
    v_add_u32 v141, s50, v138
    v_mfma_f32_16x16x32_bf16 v[112:115], a[16:19], v[96:99], v[112:115]
    ds_read_b128 v[88:91], v11 offset:14336
    s_add_u32 s43, s41, 40960
    v_mfma_f32_16x16x32_bf16 v[116:119], a[96:99], v[92:95], v[116:119]
    buffer_store_dword v22, v150, s[4:7], s42 offen offset:256 sc1
    v_mfma_f32_16x16x32_bf16 v[120:123], a[96:99], v[96:99], v[120:123]
    s_waitcnt lgkmcnt(2)
    v_mfma_f32_16x16x32_bf16 v[108:111], a[20:23], v[100:103], v[108:111]
    ds_read_b128 v[92:95], v12 offset:12288
    v_mfma_f32_16x16x32_bf16 v[112:115], a[20:23], v[104:107], v[112:115]
    ds_read_b128 v[96:99], v12 offset:14336
    v_mfma_f32_16x16x32_bf16 v[116:119], a[100:103], v[100:103], v[116:119]
    buffer_load_dwordx4 v10, s[24:27], s46 offen offset:0 nt lds
    s_add_u32 m0, m0, 3968
    v_mfma_f32_16x16x32_bf16 v[120:123], a[100:103], v[104:107], v[120:123]
    s_waitcnt lgkmcnt(2)
    v_mfma_f32_16x16x32_bf16 v[108:111], a[24:27], v[84:87], v[108:111]
    ds_read_b128 v[100:103], v11 offset:16384
    v_mfma_f32_16x16x32_bf16 v[112:115], a[24:27], v[88:91], v[112:115]
    ds_read_b128 v[104:107], v11 offset:18432
    v_mfma_f32_16x16x32_bf16 v[116:119], a[104:107], v[84:87], v[116:119]
    buffer_load_dwordx4 v10, s[24:27], s46 offen offset:128 nt lds
    s_add_u32 m0, m0, 3968
    v_mfma_f32_16x16x32_bf16 v[120:123], a[104:107], v[88:91], v[120:123]
    s_waitcnt lgkmcnt(2)
    v_mfma_f32_16x16x32_bf16 v[108:111], a[28:31], v[92:95], v[108:111]
    ds_read_b128 v[84:87], v12 offset:16384
    v_mfma_f32_16x16x32_bf16 v[112:115], a[28:31], v[96:99], v[112:115]
    ds_read_b128 v[88:91], v12 offset:18432
    v_mfma_f32_16x16x32_bf16 v[116:119], a[108:111], v[92:95], v[116:119]
    buffer_load_dwordx4 v10, s[24:27], s46 offen offset:256 nt lds
    s_add_u32 m0, m0, 3968
    v_mfma_f32_16x16x32_bf16 v[120:123], a[108:111], v[96:99], v[120:123]
    s_waitcnt lgkmcnt(2)
    v_mfma_f32_16x16x32_bf16 v[108:111], a[32:35], v[100:103], v[108:111]
    ds_read_b128 v[92:95], v11 offset:20480
    v_mfma_f32_16x16x32_bf16 v[112:115], a[32:35], v[104:107], v[112:115]
    ds_read_b128 v[96:99], v11 offset:22528
    v_mfma_f32_16x16x32_bf16 v[116:119], a[112:115], v[100:103], v[116:119]
    s_waitcnt vmcnt(6)
    buffer_store_dword v20, v139, s[4:7], s38 offen sc1
    v_mfma_f32_16x16x32_bf16 v[120:123], a[112:115], v[104:107], v[120:123]
    s_waitcnt lgkmcnt(2)
    v_mfma_f32_16x16x32_bf16 v[108:111], a[36:39], v[84:87], v[108:111]
    ds_read_b128 v[100:103], v12 offset:20480
    v_mfma_f32_16x16x32_bf16 v[112:115], a[36:39], v[88:91], v[112:115]
    buffer_load_dword v147, v146, s[4:7], 0 offen sc1
    ds_read_b128 v[104:107], v12 offset:22528
    v_mfma_f32_16x16x32_bf16 v[116:119], a[116:119], v[84:87], v[116:119]
    buffer_load_dwordx4 v10, s[24:27], s46 offen offset:384 nt lds
    s_add_u32 m0, m0, 3968
    v_mfma_f32_16x16x32_bf16 v[120:123], a[116:119], v[88:91], v[120:123]
    s_waitcnt lgkmcnt(2)
    v_mfma_f32_16x16x32_bf16 v[108:111], a[40:43], v[92:95], v[108:111]
    ds_read_b128 v[84:87], v11 offset:24576
    v_mfma_f32_16x16x32_bf16 v[112:115], a[40:43], v[96:99], v[112:115]
    buffer_load_dword v147, v146, s[4:7], 0 offen sc1
    ds_read_b128 v[88:91], v11 offset:26624
    v_mfma_f32_16x16x32_bf16 v[116:119], a[120:123], v[92:95], v[116:119]
    buffer_load_dwordx4 v10, s[24:27], s46 offen offset:512 nt lds
    s_add_u32 m0, m0, 3968
    v_mfma_f32_16x16x32_bf16 v[120:123], a[120:123], v[96:99], v[120:123]
    s_waitcnt lgkmcnt(2)
    v_mfma_f32_16x16x32_bf16 v[108:111], a[44:47], v[100:103], v[108:111]
    ds_read_b128 v[92:95], v12 offset:24576
    v_mfma_f32_16x16x32_bf16 v[112:115], a[44:47], v[104:107], v[112:115]
    buffer_load_dword v147, v146, s[4:7], 0 offen sc1
    ds_read_b128 v[96:99], v12 offset:26624
    v_mfma_f32_16x16x32_bf16 v[116:119], a[124:127], v[100:103], v[116:119]
    buffer_load_dwordx4 v10, s[24:27], s46 offen offset:640 nt lds
    s_add_u32 m0, m0, 3968
    v_mfma_f32_16x16x32_bf16 v[120:123], a[124:127], v[104:107], v[120:123]
    s_waitcnt lgkmcnt(2)
    v_mfma_f32_16x16x32_bf16 v[108:111], a[48:51], v[84:87], v[108:111]
    ds_read_b128 v[100:103], v11 offset:28672
    v_mfma_f32_16x16x32_bf16 v[112:115], a[48:51], v[88:91], v[112:115]
    buffer_load_dword v147, v146, s[4:7], 0 offen sc1
    ds_read_b128 v[104:107], v11 offset:30720
    v_mfma_f32_16x16x32_bf16 v[116:119], a[128:131], v[84:87], v[116:119]
    buffer_load_dwordx4 v10, s[24:27], s46 offen offset:768 nt lds
    s_add_u32 m0, m0, 3968
    v_mfma_f32_16x16x32_bf16 v[120:123], a[128:131], v[88:91], v[120:123]
    s_waitcnt lgkmcnt(2)
    v_mfma_f32_16x16x32_bf16 v[108:111], a[52:55], v[92:95], v[108:111]
    ds_read_b128 v[84:87], v12 offset:28672
    v_mfma_f32_16x16x32_bf16 v[112:115], a[52:55], v[96:99], v[112:115]
    buffer_load_dword v147, v146, s[4:7], 0 offen sc1
    ds_read_b128 v[88:91], v12 offset:30720
    v_mfma_f32_16x16x32_bf16 v[116:119], a[132:135], v[92:95], v[116:119]
    buffer_load_dwordx4 v10, s[24:27], s46 offen offset:896 nt lds
    s_add_u32 m0, m0, 3968
    v_mfma_f32_16x16x32_bf16 v[120:123], a[132:135], v[96:99], v[120:123]
    s_waitcnt lgkmcnt(2)
    v_mfma_f32_16x16x32_bf16 v[108:111], a[56:59], v[100:103], v[108:111]
    ds_read_b128 v[92:95], v11 offset:32768
    v_mfma_f32_16x16x32_bf16 v[112:115], a[56:59], v[104:107], v[112:115]
    buffer_load_dword v147, v146, s[4:7], 0 offen sc1
    ds_read_b128 v[96:99], v11 offset:34816
    v_mfma_f32_16x16x32_bf16 v[116:119], a[136:139], v[100:103], v[116:119]
    buffer_load_dwordx4 v10, s[24:27], s46 offen offset:1024 nt lds
    s_add_u32 m0, m0, 3968
    v_mfma_f32_16x16x32_bf16 v[120:123], a[136:139], v[104:107], v[120:123]
    s_waitcnt lgkmcnt(2)
    v_mfma_f32_16x16x32_bf16 v[108:111], a[60:63], v[84:87], v[108:111]
    ds_read_b128 v[100:103], v12 offset:32768
    v_mfma_f32_16x16x32_bf16 v[112:115], a[60:63], v[88:91], v[112:115]
    buffer_load_dword v147, v146, s[4:7], 0 offen sc1
    ds_read_b128 v[104:107], v12 offset:34816
    v_mfma_f32_16x16x32_bf16 v[116:119], a[140:143], v[84:87], v[116:119]
    buffer_load_dwordx4 v10, s[24:27], s46 offen offset:1152 nt lds
    v_mfma_f32_16x16x32_bf16 v[120:123], a[140:143], v[88:91], v[120:123]
    s_waitcnt lgkmcnt(2)
    v_mfma_f32_16x16x32_bf16 v[108:111], a[64:67], v[92:95], v[108:111]
    ds_read_b128 v[84:87], v11 offset:36864
    v_mfma_f32_16x16x32_bf16 v[112:115], a[64:67], v[96:99], v[112:115]
L_sp_77:
    buffer_load_dword v147, v146, s[4:7], 0 offen sc1
    s_sub_u32 s36, s36, 1
    s_cbranch_scc1 L_exit
    s_waitcnt vmcnt(7)
    v_cmp_gt_u32 vcc, s54, v147
    s_cbranch_vccnz L_sp_77
    s_barrier
    buffer_load_dwordx4 v[168:171], v142, s[4:7], s53 offen sc1
    ds_read_b128 v[88:91], v11 offset:38912
    v_mfma_f32_16x16x32_bf16 v[116:119], a[144:147], v[92:95], v[116:119]
    v_mfma_f32_16x16x32_bf16 v[120:123], a[144:147], v[96:99], v[120:123]
    s_waitcnt lgkmcnt(2)
    v_mfma_f32_16x16x32_bf16 v[108:111], a[68:71], v[100:103], v[108:111]
    ds_read_b128 v[92:95], v12 offset:36864
    v_mfma_f32_16x16x32_bf16 v[112:115], a[68:71], v[104:107], v[112:115]
    ds_read_b128 v[96:99], v12 offset:38912
    v_mfma_f32_16x16x32_bf16 v[116:119], a[148:151], v[100:103], v[116:119]
    v_mfma_f32_16x16x32_bf16 v[120:123], a[148:151], v[104:107], v[120:123]
    buffer_load_dwordx4 v[172:175], v143, s[4:7], s53 offen sc1
    s_waitcnt lgkmcnt(0)
    v_mfma_f32_16x16x32_bf16 v[108:111], a[72:75], v[84:87], v[108:111]
    v_add_u32 v11, s49, v11
    v_mfma_f32_16x16x32_bf16 v[112:115], a[72:75], v[88:91], v[112:115]
    v_add_u32 v12, s49, v12
    v_mfma_f32_16x16x32_bf16 v[108:111], a[76:79], v[92:95], v[108:111]
    s_sub_u32 s47, s47, s49
    v_mfma_f32_16x16x32_bf16 v[112:115], a[76:79], v[96:99], v[112:115]
    s_sub_u32 s49, 0, s49
    v_mfma_f32_16x16x32_bf16 v[116:119], a[152:155], v[84:87], v[116:119]
    v_mfma_f32_16x16x32_bf16 v[120:123], a[152:155], v[88:91], v[120:123]
    v_mfma_f32_16x16x32_bf16 v[116:119], a[156:159], v[92:95], v[116:119]
    v_mfma_f32_16x16x32_bf16 v[120:123], a[156:159], v[96:99], v[120:123]
    v_cvt_pk_bf16_f32 v124, v108, v109
    v_cvt_pk_bf16_f32 v125, v110, v111
    v_cvt_pk_bf16_f32 v126, v112, v113
    v_cvt_pk_bf16_f32 v127, v114, v115
    s_nop 0
    v_permlane16_swap_b32 v124, v126
    v_permlane16_swap_b32 v125, v127
    v_cvt_pk_bf16_f32 v128, v116, v117
    v_cvt_pk_bf16_f32 v129, v118, v119
    v_cvt_pk_bf16_f32 v130, v120, v121
    v_cvt_pk_bf16_f32 v131, v122, v123
    s_nop 0
    v_permlane16_swap_b32 v128, v130
    v_permlane16_swap_b32 v129, v131
    ds_write_b128 v140, v[128:131]
    buffer_store_dwordx4 v[124:127], v19, s[4:7], s44 offen sc1
    buffer_store_dwordx4 v[128:131], v19, s[4:7], s45 offen sc1
    s_mov_b32 m0, s48
    s_waitcnt vmcnt(3)
    v_mfma_f32_16x16x32_bf16 v[184:187], v[168:171], v[196:199], 0
    s_waitcnt vmcnt(2)
    v_mfma_f32_16x16x32_bf16 v[184:187], v[172:175], v[196:199], v[184:187]
    s_nop 7
    v_pk_add_f32 v[188:189], v[184:185], v[186:187]
    v_cmp_u_f32 vcc, v188, v189
    v_cvt_pk_bf16_f32 v192, v184, v185
    v_cvt_pk_bf16_f32 v193, v186, v187
    v_cndmask_b32 v192, v192, v193, s[58:59]
    s_cbranch_vccnz L_pp_78
L_pc_79:
    buffer_store_dword v192, v149, s[4:7], s41 offen sc1
    s_barrier
    s_branch L_qkv_loop_s
L_end_75:
    s_waitcnt vmcnt(0) lgkmcnt(0)
    buffer_store_dword v20, v139, s[4:7], s38 offen sc1
    s_endpgm
L_nan_70:
    s_cmp_eq_u32 s52, 1
    s_cbranch_scc1 L_cont_71
    v_lshlrev_b32 v1, 4, v0
L_nan_70r:
    s_mov_b32 s90, s41
    v_mov_b32 v2, 0
    buffer_load_dwordx4 v[28:31], v1, s[4:7], s90 offen sc1
    s_add_u32 s90, s90, 1024
    buffer_load_dwordx4 v[32:35], v1, s[4:7], s90 offen sc1
    s_add_u32 s90, s90, 1024
    buffer_load_dwordx4 v[36:39], v1, s[4:7], s90 offen sc1
    s_add_u32 s90, s90, 1024
    buffer_load_dwordx4 v[40:43], v1, s[4:7], s90 offen sc1
    s_add_u32 s90, s90, 1024
    buffer_load_dwordx4 v[44:47], v1, s[4:7], s90 offen sc1
    s_add_u32 s90, s90, 1024
    buffer_load_dwordx4 v[48:51], v1, s[4:7], s90 offen sc1
    s_add_u32 s90, s90, 1024
    buffer_load_dwordx4 v[52:55], v1, s[4:7], s90 offen sc1
    s_add_u32 s90, s90, 1024
    buffer_load_dwordx4 v[56:59], v1, s[4:7], s90 offen sc1
    s_add_u32 s90, s90, 1024
    buffer_load_dwordx4 v[60:63], v1, s[4:7], s90 offen sc1
    s_add_u32 s90, s90, 1024
    buffer_load_dwordx4 v[64:67], v1, s[4:7], s90 offen sc1
    s_add_u32 s90, s90, 1024
    s_sub_u32 s36, s36, 1
    s_cbranch_scc1 L_exit
    s_waitcnt vmcnt(0) lgkmcnt(0)
    v_max3_u32 v2, v2, v28, v29
    v_max3_u32 v2, v2, v30, v31
    v_max3_u32 v2, v2, v32, v33
    v_max3_u32 v2, v2, v34, v35
    v_max3_u32 v2, v2, v36, v37
    v_max3_u32 v2, v2, v38, v39
    v_max3_u32 v2, v2, v40, v41
    v_max3_u32 v2, v2, v42, v43
    v_max3_u32 v2, v2, v44, v45
    v_max3_u32 v2, v2, v46, v47
    v_max3_u32 v2, v2, v48, v49
    v_max3_u32 v2, v2, v50, v51
    v_max3_u32 v2, v2, v52, v53
    v_max3_u32 v2, v2, v54, v55
    v_max3_u32 v2, v2, v56, v57
    v_max3_u32 v2, v2, v58, v59
    v_max3_u32 v2, v2, v60, v61
    v_max3_u32 v2, v2, v62, v63
    v_max3_u32 v2, v2, v64, v65
    v_max3_u32 v2, v2, v66, v67
    v_cmp_eq_u32 vcc, -1, v2
    s_cbranch_vccnz L_nan_70r
    s_mov_b32 s52, 1
    v_mov_b32 v68, 0
    v_mov_b32 v69, 0
    v_mov_b32 v70, 0
    v_mov_b32 v71, 0
    v_mov_b32 v72, 0
    v_mov_b32 v73, 0
    v_mov_b32 v74, 0
    v_mov_b32 v75, 0
    v_smfmac_f32_16x16x64_bf16 v[68:71], v[28:31], a[0:7], v17
    s_nop 0
    v_smfmac_f32_16x16x64_bf16 v[72:75], v[28:31], a[80:87], v17
    v_smfmac_f32_16x16x64_bf16 v[68:71], v[32:35], a[8:15], v17
    v_smfmac_f32_16x16x64_bf16 v[72:75], v[32:35], a[88:95], v17
    v_smfmac_f32_16x16x64_bf16 v[68:71], v[36:39], a[16:23], v17
    v_smfmac_f32_16x16x64_bf16 v[68:71], v[40:43], a[24:31], v17
    v_smfmac_f32_16x16x64_bf16 v[68:71], v[44:47], a[32:39], v17
    v_smfmac_f32_16x16x64_bf16 v[68:71], v[48:51], a[40:47], v17
    v_smfmac_f32_16x16x64_bf16 v[68:71], v[52:55], a[48:55], v17
    v_smfmac_f32_16x16x64_bf16 v[68:71], v[56:59], a[56:63], v17
    v_smfmac_f32_16x16x64_bf16 v[68:71], v[60:63], a[64:71], v17
    v_smfmac_f32_16x16x64_bf16 v[68:71], v[64:67], a[72:79], v17
    s_nop 2
    s_branch L_redo_68
L_poll_69c:
L_poll_69:
    buffer_load_dwordx4 v13, s[4:7], s41 offen sc1 lds
    buffer_load_dwordx4 v13, s[4:7], s41 offen offset:1024 sc1 lds
    buffer_load_dword v14, s[4:7], s41 offen offset:2048 sc1 lds
    buffer_load_dword v14, s[4:7], s41 offen offset:2304 sc1 lds
    s_sub_u32 s36, s36, 1
    s_cbranch_scc1 L_exit
    s_waitcnt vmcnt(0)
    ds_read_b32 v18, v15
    s_waitcnt lgkmcnt(0)
    v_cmp_eq_u32 vcc, -1, v18
    s_cbranch_vccnz L_poll_69
    s_branch L_poll_69x
L_sd_76c:
    v_mov_b32 v5, 460288
L_pf_80:
    buffer_load_dword v6, v5, s[4:7], s38 offen sc1
    v_mov_b32 v3, 204
L_p0_81:
    buffer_load_dword v4, v3, s[8:11], 0 offen sc1
    s_sub_u32 s36, s36, 1
    s_cbranch_scc1 L_exit
    s_waitcnt vmcnt(0)
    v_readfirstlane_b32 s90, v4
    s_nop 0
    s_cmp_eq_u32 s90, 0
    s_cbranch_scc1 L_p0_81
    s_and_b32 s90, s90, 2
    s_lshl_b32 s90, s90, 12
    v_readfirstlane_b32 s91, v6
    s_nop 0
    s_cmp_eq_u32 s91, 0
    s_cbranch_scc1 L_pf_80
    s_and_b32 s91, s91, 2
    s_lshl_b32 s91, s91, 12
    v_add_u32 v142, s91, v142
    v_add_u32 v143, s91, v143
    v_and_b32 v3, s90, v152
    v_xor_b32 v146, v3, v146
    s_branch L_sd_76
L_pp_78:
    buffer_load_dwordx4 v[176:179], v142, s[4:7], s53 offen sc1
    buffer_load_dwordx4 v[180:183], v143, s[4:7], s53 offen sc1
    s_sub_u32 s36, s36, 1
    s_cbranch_scc1 L_exit
    v_max_u32 v151, v168, v169
    v_max3_u32 v151, v151, v170, v171
    v_max3_u32 v151, v151, v172, v173
    v_max3_u32 v151, v151, v174, v175
    v_cmp_eq_u32 vcc, -1, v151
    s_cbranch_vccz L_pc_79
    s_waitcnt vmcnt(1)
    v_mfma_f32_16x16x32_bf16 v[184:187], v[176:179], v[196:199], 0
    s_waitcnt vmcnt(0)
    v_mfma_f32_16x16x32_bf16 v[184:187], v[180:183], v[196:199], v[184:187]
    s_nop 7
    v_pk_add_f32 v[188:189], v[184:185], v[186:187]
    v_cmp_u_f32 vcc, v188, v189
    v_cvt_pk_bf16_f32 v192, v184, v185
    v_cvt_pk_bf16_f32 v193, v186, v187
    v_cndmask_b32 v192, v192, v193, s[58:59]
    s_cbranch_vccnz L_pp_78_1
    s_branch L_pc_79
L_pp_78_1:
    buffer_load_dwordx4 v[168:171], v142, s[4:7], s53 offen sc1
    buffer_load_dwordx4 v[172:175], v143, s[4:7], s53 offen sc1
    s_sub_u32 s36, s36, 1
    s_cbranch_scc1 L_exit
    v_max_u32 v151, v176, v177
    v_max3_u32 v151, v151, v178, v179
    v_max3_u32 v151, v151, v180, v181
    v_max3_u32 v151, v151, v182, v183
    v_cmp_eq_u32 vcc, -1, v151
    s_cbranch_vccz L_pc_79
    s_waitcnt vmcnt(1)
    v_mfma_f32_16x16x32_bf16 v[184:187], v[168:171], v[196:199], 0
    s_waitcnt vmcnt(0)
    v_mfma_f32_16x16x32_bf16 v[184:187], v[172:175], v[196:199], v[184:187]
    s_nop 7
    v_pk_add_f32 v[188:189], v[184:185], v[186:187]
    v_cmp_u_f32 vcc, v188, v189
    v_cvt_pk_bf16_f32 v192, v184, v185
    v_cvt_pk_bf16_f32 v193, v186, v187
    v_cndmask_b32 v192, v192, v193, s[58:59]
    s_cbranch_vccnz L_pp_78
    s_branch L_pc_79
L_v_s:
    s_mov_b32 s12, s78
    s_and_b32 s13, s79, 0xffff
    s_mov_b32 s14, 7864320
    s_mov_b32 s15, 0x20000
    s_sub_u32 s40, s35, 12
    s_lshl_b32 s40, s40, 1
    s_mov_b32 s24, s70
    s_and_b32 s25, s71, 0xffff
    s_mov_b32 s26, 2621440
    s_mov_b32 s27, 0x20000
    v_and_b32 v1, 15, v0
    v_lshrrev_b32 v2, 4, v0
    v_lshrrev_b32 v3, 3, v0
    v_and_b32 v4, 7, v0
    s_lshl_b32 s90, s32, 3
    v_add_u32 v5, s90, v3
    s_and_b32 s91, s32, 1
    s_lshl_b32 s91, s91, 2
    v_and_b32 v6, 2, v3
    v_or_b32 v6, s91, v6
    v_xor_b32 v6, v6, v4
    v_lshlrev_b32 v6, 4, v6
    v_mul_u32_u24 v7, 12288, v5
    s_mul_i32 s92, s34, 1536
    s_lshl_b32 s93, s40, 7
    s_add_u32 s92, s92, s93
    v_add3_u32 v124, v6, v7, s92
    v_lshrrev_b32 v6, 1, v3
    v_or_b32 v6, s91, v6
    v_xor_b32 v6, v6, v4
    v_lshlrev_b32 v6, 4, v6
    v_mul_u32_u24 v7, 1280, v5
    v_add_u32 v10, v6, v7
    s_lshl_b32 s90, s32, 10
    s_add_u32 m0, s90, 81920
    s_mov_b32 s91, 128
    buffer_load_dwordx4 v124, s[12:15], s91 offen nt lds
    s_add_u32 m0, m0, 4096
    s_add_u32 s91, s91, 393216
    buffer_load_dwordx4 v124, s[12:15], s91 offen nt lds
    s_add_u32 m0, m0, 4096
    s_add_u32 s91, s91, 393216
    buffer_load_dwordx4 v124, s[12:15], s91 offen nt lds
    s_add_u32 m0, m0, 4096
    s_add_u32 s91, s91, 393216
    buffer_load_dwordx4 v124, s[12:15], s91 offen nt lds
    s_add_u32 m0, m0, 4096
    s_add_u32 s91, s91, 393216
    buffer_load_dwordx4 v124, s[12:15], s91 offen nt lds
    s_add_u32 m0, m0, 4096
    s_add_u32 s91, s91, 393216
    buffer_load_dwordx4 v124, s[12:15], s91 offen nt lds
    s_add_u32 m0, m0, 4096
    s_add_u32 s91, s91, 393216
    buffer_load_dwordx4 v124, s[12:15], s91 offen nt lds
    s_add_u32 m0, m0, 4096
    s_add_u32 s91, s91, 393216
    buffer_load_dwordx4 v124, s[12:15], s91 offen nt lds
    s_add_u32 m0, m0, 4096
    s_add_u32 s91, s91, 393216
    buffer_load_dwordx4 v124, s[12:15], s91 offen nt lds
    s_add_u32 m0, m0, 4096
    s_add_u32 s91, s91, 393216
    buffer_load_dwordx4 v124, s[12:15], s91 offen nt lds
    s_mul_i32 s60, s40, 86
    s_lshr_b32 s60, s60, 8
    s_mul_i32 s61, s60, 3
    s_sub_u32 s61, s40, s61
    s_add_u32 s90, s40, 1
    s_mul_i32 s62, s90, 86
    s_lshr_b32 s62, s62, 8
    s_mul_i32 s63, s62, 3
    s_sub_u32 s63, s90, s63
    v_lshrrev_b32 v3, 1, v2
    v_and_b32 v5, 1, v2
    s_lshl_b32 s90, s32, 9
    v_lshlrev_b32 v6, 4, v1
    v_lshl_add_u32 v6, v3, 8, v6
    v_add_u32 v6, s90, v6
    s_mul_i32 s90, s60, 12288
    s_lshl_b32 s91, s61, 11
    s_add_u32 s90, s90, s91
    v_mul_u32_u24 v7, 6144, v5
    v_add3_u32 v19, v6, v7, s90
    v_mov_b32 v22, -1
    s_mul_i32 s56, s62, 12288
    s_lshl_b32 s91, s63, 11
    s_add_u32 s56, s56, s91
    s_sub_u32 s56, s56, s90
    s_lshl_b32 s90, s40, 10
    s_lshl_b32 s91, s32, 8
    s_add_u32 s91, s91, s90
    s_add_u32 s91, s91, 25600
    v_lshl_add_u32 v135, v0, 2, s91
    v_and_b32 v6, 60, v0
    v_bfe_u32 v7, v0, 1, 1
    v_or_b32 v6, v6, v7
    v_and_b32 v7, 1, v0
    v_lshl_or_b32 v6, v7, 1, v6
    s_and_b32 s90, s32, 1
    s_lshl_b32 s90, s90, 3
    v_xor_b32 v6, s90, v6
    v_lshl_add_u32 v134, v6, 2, s91
    s_lshl_b32 s90, s60, 5
    s_lshl_b32 s91, s62, 5
    v_mov_b32 v3, s90
    v_mov_b32 v4, s91
    v_mov_b32 v6, s61
    v_mov_b32 v7, s63
    v_cmp_eq_u32 vcc, 0, v0
    s_nop 1
    v_cndmask_b32 v3, v4, v3, vcc
    v_cndmask_b32 v6, v7, v6, vcc
    v_add_u32 v4, v3, v6
    s_cmp_eq_u32 s32, 3
    s_cselect_b32 s91, 0, 2146435072
    s_add_u32 s91, s91, 462348
    v_lshl_add_u32 v21, v4, 2, s91
    v_lshl_add_u32 v4, v6, 2, v3
    s_lshl_b32 s91, s32, 2
    s_add_u32 s91, s91, 458752
    v_lshl_add_u32 v136, v4, 2, s91
    v_cmp_gt_u32 vcc, 2, v0
    v_mov_b32 v9, 2146435072
    s_nop 0
    v_cndmask_b32 v21, v9, v21, vcc
    v_cndmask_b32 v136, v9, v136, vcc
    s_lshl_b32 s90, s40, 1
    s_add_u32 s90, s90, s32
    s_sub_u32 s90, s90, 4
    s_lshl_b32 s90, s90, 11
    s_cmp_eq_u32 s40, 0
    s_cselect_b32 s90, 2146435072, s90
    v_lshl_add_u32 v137, v0, 4, s90
    v_mov_b32 v138, 460416
    v_lshrrev_b32 v3, 2, v1
    v_and_b32 v4, 3, v1
    v_and_b32 v5, 1, v2
    v_lshl_add_u32 v6, v2, 3, v3
    v_lshlrev_b32 v6, 7, v6
    v_and_b32 v7, 2, v3
    v_lshl_or_b32 v7, v5, 2, v7
    v_lshrrev_b32 v8, 1, v4
    s_lshl_b32 s90, s32, 1
    v_or_b32 v8, s90, v8
    v_xor_b32 v7, v7, v8
    v_lshl_add_u32 v6, v7, 4, v6
    v_and_b32 v7, 1, v4
    v_lshl_add_u32 v6, v7, 3, v6
    v_add_u32 v125, 81920, v6
    v_add_u32 v126, 40960, v6
    v_add_u32 v127, 122880, v6
    s_lshl_b32 s90, s32, 9
    s_add_u32 s90, s90, 133120
    v_and_b32 v7, 2, v1
    v_cmp_ne_u32 vcc, 0, v7
    v_mov_b32 v6, 0x4444
    v_mov_b32 v8, 0xeeee
    v_cndmask_b32 v17, v6, v8, vcc
    v_lshlrev_b32 v6, 4, v0
    v_add_u32 v16, 122880, v6
    s_mul_i32 s90, s32, 2560
    v_lshl_add_u32 v13, v0, 4, s90
    v_lshl_add_u32 v14, v0, 2, s90
    s_add_u32 s48, s90, 122880
    v_mul_u32_u24 v6, 40, v0
    v_add_u32 v15, s48, v6
    v_mul_u32_u24 v6, 164, v0
    v_min_u32 v6, 10236, v6
    v_add_u32 v25, 122880, v6
    v_lshrrev_b32 v6, 3, v1
    v_lshlrev_b32 v6, 10, v6
    v_and_b32 v7, 7, v1
    v_lshl_add_u32 v6, v7, 7, v6
    v_lshrrev_b32 v7, 1, v1
    v_xor_b32 v7, v7, v2
    v_lshl_add_u32 v11, v7, 4, v6
    v_xor_b32 v12, 64, v11
    v_and_b32 v3, 1, v0
    v_lshlrev_b32 v3, 12, v3
    v_bfe_u32 v5, v0, 2, 1
    v_lshl_add_u32 v3, v5, 13, v3
    v_bfe_u32 v4, v0, 1, 1
    v_lshl_add_u32 v3, v4, 14, v3
    s_lshl_b32 s91, s34, 9
    s_add_u32 s91, s91, 1933312
    s_xor_b32 s55, s32, 3
    s_or_b32 s55, s55, s40
    s_cselect_b32 s91, 2146435072, s91
    s_cselect_b32 s92, 2146435072, 0
    s_add_u32 s92, s92, 460416
    v_mov_b32 v147, s92
    v_add_u32 v140, s91, v3
    v_cmp_eq_u32 vcc, 0, v0
    v_mov_b32 v9, 2146435072
    s_nop 0
    v_cndmask_b32 v147, v9, v147, vcc
    v_cmp_gt_u32 vcc, 8, v0
    v_mov_b32 v9, 2146435072
    s_nop 0
    v_cndmask_b32 v140, v9, v140, vcc
    v_cmp_ne_u32 vcc, s34, v0
    v_mov_b32 v9, 2146435072
    s_nop 0
    v_cndmask_b32 v140, v9, v140, vcc
    s_lshr_b32 s91, s34, 2
    v_cmp_eq_u32 vcc, s91, v5
    s_nop 1
    v_cndmask_b32 v141, v9, v140, vcc
    v_cndmask_b32 v140, v140, v9, vcc
    v_and_b32 v3, 7, v0
    v_min_u32 v3, 5, v3
    v_bfe_u32 v4, v0, 3, 2
    v_lshlrev_b32 v4, 7, v4
    v_lshl_add_u32 v3, v3, 2, v4
    v_add_u32 v142, 462368, v3
    v_min_u32 v3, 39, v0
    v_lshlrev_b32 v3, 2, v3
    v_add_u32 v142, 460544, v3
    s_lshl_b32 s93, s40, 1
    s_add_u32 s93, s93, s32
    s_lshl_b32 s93, s93, 1
    s_sub_u32 s93, s93, 8
    s_nop 0
    s_lshr_b32 s90, s93, 2
    s_lshl_b32 s90, s90, 15
    s_and_b32 s92, s93, 3
    s_lshl_b32 s92, s92, 10
    s_add_u32 s90, s90, s92
    v_mov_b32 v5, s34
    v_and_b32 v6, 7, v1
    v_lshlrev_b32 v6, 4, v6
    v_lshl_add_u32 v6, v5, 7, v6
    v_lshrrev_b32 v7, 3, v1
    v_lshl_add_u32 v6, v7, 12, v6
    v_lshrrev_b32 v5, 1, v2
    v_lshl_add_u32 v6, v5, 13, v6
    v_and_b32 v5, 1, v2
    v_lshl_add_u32 v6, v5, 14, v6
    v_add_u32 v143, s90, v6
    s_and_b32 s91, s34, 1
    s_lshl_b32 s91, s91, 12
    s_add_u32 s90, s90, s91
    s_lshr_b32 s91, s34, 2
    s_lshl_b32 s91, s91, 13
    s_add_u32 s90, s90, s91
    s_and_b32 s91, s34, 2
    s_lshl_b32 s91, s91, 13
    s_add_u32 s90, s90, s91
    v_lshl_add_u32 v144, v0, 4, s90
    s_lshl_b32 s91, s93, 10
    s_add_u32 s91, s91, 884736
    v_lshl_add_u32 v146, v0, 4, s91
    s_lshr_b32 s91, s34, 1
    s_mul_i32 s91, s91, 10240
    s_lshl_b32 s92, s93, 5
    s_add_u32 s91, s91, s92
    s_and_b32 s92, s34, 1
    s_mul_i32 s92, s92, 40960
    s_add_u32 s91, s91, s92
    s_add_u32 s91, s91, 1280
    v_mul_u32_u24 v6, 2560, v2
    v_lshl_add_u32 v6, v1, 1, v6
    v_add_u32 v145, s91, v6
    v_cmp_gt_u32 s[58:59], 8, v1
    v_and_b32 v5, 1, v1
    v_lshrrev_b32 v6, 3, v1
    v_lshl_add_u32 v5, v5, 1, v6
    v_bfe_u32 v6, v1, 2, 1
    v_cmp_ne_u32 vcc, 0, v6
    v_mov_b32 v6, 0x3f80
    v_mov_b32 v7, 0x3f800000
    v_cndmask_b32 v6, v6, v7, vcc
    v_cmp_eq_u32 vcc, 0, v5
    s_nop 1
    v_cndmask_b32 v7, 0, v6, vcc
    v_accvgpr_write_b32 a160, v7
    v_cmp_eq_u32 vcc, 1, v5
    s_nop 1
    v_cndmask_b32 v7, 0, v6, vcc
    v_accvgpr_write_b32 a161, v7
    v_cmp_eq_u32 vcc, 2, v5
    s_nop 1
    v_cndmask_b32 v7, 0, v6, vcc
    v_accvgpr_write_b32 a162, v7
    v_cmp_eq_u32 vcc, 3, v5
    s_nop 1
    v_cndmask_b32 v7, 0, v6, vcc
    v_accvgpr_write_b32 a163, v7
    s_cmp_lg_u32 s40, 0
    s_cselect_b64 vcc, -1, 0
    v_cndmask_b32 v143, v9, v143, vcc
    v_cndmask_b32 v144, v9, v144, vcc
    v_cndmask_b32 v145, v9, v145, vcc
    v_cndmask_b32 v146, v9, v146, vcc
    s_lshl_b32 s90, s32, 10
    s_add_u32 m0, s90, 40960
    s_mov_b32 s91, 0
    buffer_load_dwordx4 v124, s[12:15], s91 offen nt lds
    s_add_u32 m0, m0, 4096
    s_add_u32 s91, s91, 393216
    buffer_load_dwordx4 v124, s[12:15], s91 offen nt lds
    s_add_u32 m0, m0, 4096
    s_add_u32 s91, s91, 393216
    buffer_load_dwordx4 v124, s[12:15], s91 offen nt lds
    s_add_u32 m0, m0, 4096
    s_add_u32 s91, s91, 393216
    buffer_load_dwordx4 v124, s[12:15], s91 offen nt lds
    s_add_u32 m0, m0, 4096
    s_add_u32 s91, s91, 393216
    buffer_load_dwordx4 v124, s[12:15], s91 offen nt lds
    s_add_u32 m0, m0, 4096
    s_add_u32 s91, s91, 393216
    buffer_load_dwordx4 v124, s[12:15], s91 offen nt lds
    s_add_u32 m0, m0, 4096
    s_add_u32 s91, s91, 393216
    buffer_load_dwordx4 v124, s[12:15], s91 offen nt lds
    s_add_u32 m0, m0, 4096
    s_add_u32 s91, s91, 393216
    buffer_load_dwordx4 v124, s[12:15], s91 offen nt lds
    s_add_u32 m0, m0, 4096
    s_add_u32 s91, s91, 393216
    buffer_load_dwordx4 v124, s[12:15], s91 offen nt lds
    s_add_u32 m0, m0, 4096
    s_add_u32 s91, s91, 393216
    buffer_load_dwordx4 v124, s[12:15], s91 offen nt lds
    s_lshl_b32 s90, s32, 10
    s_add_u32 m0, s90, 122880
    s_mov_b32 s91, 3932288
    buffer_load_dwordx4 v124, s[12:15], s91 offen nt lds
    s_add_u32 m0, m0, 4096
    s_add_u32 s91, s91, 393216
    buffer_load_dwordx4 v124, s[12:15], s91 offen nt lds
    s_add_u32 m0, m0, 4096
    s_add_u32 s91, s91, 393216
    buffer_load_dwordx4 v124, s[12:15], s91 offen nt lds
    s_add_u32 m0, m0, 4096
    s_add_u32 s91, s91, 393216
    buffer_load_dwordx4 v124, s[12:15], s91 offen nt lds
    s_add_u32 m0, m0, 4096
    s_add_u32 s91, s91, 393216
    buffer_load_dwordx4 v124, s[12:15], s91 offen nt lds
    s_add_u32 m0, m0, 4096
    s_add_u32 s91, s91, 393216
    buffer_load_dwordx4 v124, s[12:15], s91 offen nt lds
    s_add_u32 m0, m0, 4096
    s_add_u32 s91, s91, 393216
    buffer_load_dwordx4 v124, s[12:15], s91 offen nt lds
    s_add_u32 m0, m0, 4096
    s_add_u32 s91, s91, 393216
    buffer_load_dwordx4 v124, s[12:15], s91 offen nt lds
    s_add_u32 m0, m0, 4096
    s_add_u32 s91, s91, 393216
    buffer_load_dwordx4 v124, s[12:15], s91 offen nt lds
    s_add_u32 m0, m0, 4096
    s_add_u32 s91, s91, 393216
    buffer_load_dwordx4 v124, s[12:15], s91 offen nt lds
    s_mov_b32 s46, 0
    s_lshl_b32 s90, s32, 10
    s_add_u32 m0, s90, 0
    s_nop 0
    buffer_load_dwordx4 v10, s[24:27], s46 offen offset:0 lds
    s_add_u32 m0, m0, 3968
    s_nop 0
    buffer_load_dwordx4 v10, s[24:27], s46 offen offset:128 lds
    s_add_u32 m0, m0, 3968
    s_nop 0
    buffer_load_dwordx4 v10, s[24:27], s46 offen offset:256 lds
    s_add_u32 m0, m0, 3968
    s_nop 0
    buffer_load_dwordx4 v10, s[24:27], s46 offen offset:384 lds
    s_add_u32 m0, m0, 3968
    s_nop 0
    buffer_load_dwordx4 v10, s[24:27], s46 offen offset:512 lds
    s_add_u32 m0, m0, 3968
    s_nop 0
    buffer_load_dwordx4 v10, s[24:27], s46 offen offset:640 lds
    s_add_u32 m0, m0, 3968
    s_nop 0
    buffer_load_dwordx4 v10, s[24:27], s46 offen offset:768 lds
    s_add_u32 m0, m0, 3968
    s_nop 0
    buffer_load_dwordx4 v10, s[24:27], s46 offen offset:896 lds
    s_add_u32 m0, m0, 3968
    s_nop 0
    buffer_load_dwordx4 v10, s[24:27], s46 offen offset:1024 lds
    s_add_u32 m0, m0, 3968
    s_nop 0
    buffer_load_dwordx4 v10, s[24:27], s46 offen offset:1152 lds
    s_waitcnt vmcnt(30)
    s_barrier
    ds_read_b64_tr_b16 a[80:81], v125 offset:0
    ds_read_b64_tr_b16 a[82:83], v125 offset:512
    ds_read_b64_tr_b16 a[84:85], v125 offset:4096
    ds_read_b64_tr_b16 a[86:87], v125 offset:4608
    ds_read_b64_tr_b16 a[88:89], v125 offset:8192
    ds_read_b64_tr_b16 a[90:91], v125 offset:8704
    ds_read_b64_tr_b16 a[92:93], v125 offset:12288
    ds_read_b64_tr_b16 a[94:95], v125 offset:12800
    ds_read_b64_tr_b16 a[96:97], v125 offset:16384
    ds_read_b64_tr_b16 a[98:99], v125 offset:16896
    ds_read_b64_tr_b16 a[100:101], v125 offset:20480
    ds_read_b64_tr_b16 a[102:103], v125 offset:20992
    ds_read_b64_tr_b16 a[104:105], v125 offset:24576
    ds_read_b64_tr_b16 a[106:107], v125 offset:25088
    ds_read_b64_tr_b16 a[108:109], v125 offset:28672
    ds_read_b64_tr_b16 a[110:111], v125 offset:29184
    ds_read_b64_tr_b16 a[112:113], v125 offset:32768
    ds_read_b64_tr_b16 a[114:115], v125 offset:33280
    ds_read_b64_tr_b16 a[116:117], v125 offset:36864
    ds_read_b64_tr_b16 a[118:119], v125 offset:37376
    s_waitcnt lgkmcnt(0)
    s_barrier
    s_lshl_b32 s90, s32, 10
    s_add_u32 m0, s90, 81920
    s_mov_b32 s91, 3932160
    buffer_load_dwordx4 v124, s[12:15], s91 offen nt lds
    s_add_u32 m0, m0, 4096
    s_add_u32 s91, s91, 393216
    buffer_load_dwordx4 v124, s[12:15], s91 offen nt lds
    s_add_u32 m0, m0, 4096
    s_add_u32 s91, s91, 393216
    buffer_load_dwordx4 v124, s[12:15], s91 offen nt lds
    s_add_u32 m0, m0, 4096
    s_add_u32 s91, s91, 393216
    buffer_load_dwordx4 v124, s[12:15], s91 offen nt lds
    s_add_u32 m0, m0, 4096
    s_add_u32 s91, s91, 393216
    buffer_load_dwordx4 v124, s[12:15], s91 offen nt lds
    s_add_u32 m0, m0, 4096
    s_add_u32 s91, s91, 393216
    buffer_load_dwordx4 v124, s[12:15], s91 offen nt lds
    s_add_u32 m0, m0, 4096
    s_add_u32 s91, s91, 393216
    buffer_load_dwordx4 v124, s[12:15], s91 offen nt lds
    s_add_u32 m0, m0, 4096
    s_add_u32 s91, s91, 393216
    buffer_load_dwordx4 v124, s[12:15], s91 offen nt lds
    s_add_u32 m0, m0, 4096
    s_add_u32 s91, s91, 393216
    buffer_load_dwordx4 v124, s[12:15], s91 offen nt lds
    s_add_u32 m0, m0, 4096
    s_add_u32 s91, s91, 393216
    buffer_load_dwordx4 v124, s[12:15], s91 offen nt lds
    s_waitcnt vmcnt(30)
    s_barrier
    ds_read_b64_tr_b16 a[0:1], v126 offset:0
    ds_read_b64_tr_b16 a[2:3], v126 offset:512
    ds_read_b64_tr_b16 a[4:5], v126 offset:4096
    ds_read_b64_tr_b16 a[6:7], v126 offset:4608
    ds_read_b64_tr_b16 a[8:9], v126 offset:8192
    ds_read_b64_tr_b16 a[10:11], v126 offset:8704
    ds_read_b64_tr_b16 a[12:13], v126 offset:12288
    ds_read_b64_tr_b16 a[14:15], v126 offset:12800
    ds_read_b64_tr_b16 a[16:17], v126 offset:16384
    ds_read_b64_tr_b16 a[18:19], v126 offset:16896
    ds_read_b64_tr_b16 a[20:21], v126 offset:20480
    ds_read_b64_tr_b16 a[22:23], v126 offset:20992
    ds_read_b64_tr_b16 a[24:25], v126 offset:24576
    ds_read_b64_tr_b16 a[26:27], v126 offset:25088
    ds_read_b64_tr_b16 a[28:29], v126 offset:28672
    ds_read_b64_tr_b16 a[30:31], v126 offset:29184
    ds_read_b64_tr_b16 a[32:33], v126 offset:32768
    ds_read_b64_tr_b16 a[34:35], v126 offset:33280
    ds_read_b64_tr_b16 a[36:37], v126 offset:36864
    ds_read_b64_tr_b16 a[38:39], v126 offset:37376
    s_waitcnt lgkmcnt(0)
    s_barrier
    s_mov_b32 s46, 40960
    s_lshl_b32 s90, s32, 10
    s_add_u32 m0, s90, 40960
    s_nop 0
    buffer_load_dwordx4 v10, s[24:27], s46 offen offset:0 lds
    s_add_u32 m0, m0, 3968
    s_nop 0
    buffer_load_dwordx4 v10, s[24:27], s46 offen offset:128 lds
    s_add_u32 m0, m0, 3968
    s_nop 0
    buffer_load_dwordx4 v10, s[24:27], s46 offen offset:256 lds
    s_add_u32 m0, m0, 3968
    s_nop 0
    buffer_load_dwordx4 v10, s[24:27], s46 offen offset:384 lds
    s_add_u32 m0, m0, 3968
    s_nop 0
    buffer_load_dwordx4 v10, s[24:27], s46 offen offset:512 lds
    s_add_u32 m0, m0, 3968
    s_nop 0
    buffer_load_dwordx4 v10, s[24:27], s46 offen offset:640 lds
    s_add_u32 m0, m0, 3968
    s_nop 0
    buffer_load_dwordx4 v10, s[24:27], s46 offen offset:768 lds
    s_add_u32 m0, m0, 3968
    s_nop 0
    buffer_load_dwordx4 v10, s[24:27], s46 offen offset:896 lds
    s_add_u32 m0, m0, 3968
    s_nop 0
    buffer_load_dwordx4 v10, s[24:27], s46 offen offset:1024 lds
    s_add_u32 m0, m0, 3968
    s_nop 0
    buffer_load_dwordx4 v10, s[24:27], s46 offen offset:1152 lds
    s_waitcnt vmcnt(30)
    s_barrier
    ds_read_b64_tr_b16 a[120:121], v127 offset:0
    ds_read_b64_tr_b16 a[122:123], v127 offset:512
    ds_read_b64_tr_b16 a[124:125], v127 offset:4096
    ds_read_b64_tr_b16 a[126:127], v127 offset:4608
    ds_read_b64_tr_b16 a[128:129], v127 offset:8192
    ds_read_b64_tr_b16 a[130:131], v127 offset:8704
    ds_read_b64_tr_b16 a[132:133], v127 offset:12288
    ds_read_b64_tr_b16 a[134:135], v127 offset:12800
    ds_read_b64_tr_b16 a[136:137], v127 offset:16384
    ds_read_b64_tr_b16 a[138:139], v127 offset:16896
    ds_read_b64_tr_b16 a[140:141], v127 offset:20480
    ds_read_b64_tr_b16 a[142:143], v127 offset:20992
    ds_read_b64_tr_b16 a[144:145], v127 offset:24576
    ds_read_b64_tr_b16 a[146:147], v127 offset:25088
    ds_read_b64_tr_b16 a[148:149], v127 offset:28672
    ds_read_b64_tr_b16 a[150:151], v127 offset:29184
    ds_read_b64_tr_b16 a[152:153], v127 offset:32768
    ds_read_b64_tr_b16 a[154:155], v127 offset:33280
    ds_read_b64_tr_b16 a[156:157], v127 offset:36864
    ds_read_b64_tr_b16 a[158:159], v127 offset:37376
    s_waitcnt lgkmcnt(0)
    s_waitcnt vmcnt(10)
    s_barrier
    ds_read_b64_tr_b16 a[40:41], v125 offset:0
    ds_read_b64_tr_b16 a[42:43], v125 offset:512
    ds_read_b64_tr_b16 a[44:45], v125 offset:4096
    ds_read_b64_tr_b16 a[46:47], v125 offset:4608
    ds_read_b64_tr_b16 a[48:49], v125 offset:8192
    ds_read_b64_tr_b16 a[50:51], v125 offset:8704
    ds_read_b64_tr_b16 a[52:53], v125 offset:12288
    ds_read_b64_tr_b16 a[54:55], v125 offset:12800
    ds_read_b64_tr_b16 a[56:57], v125 offset:16384
    ds_read_b64_tr_b16 a[58:59], v125 offset:16896
    ds_read_b64_tr_b16 a[60:61], v125 offset:20480
    ds_read_b64_tr_b16 a[62:63], v125 offset:20992
    ds_read_b64_tr_b16 a[64:65], v125 offset:24576
    ds_read_b64_tr_b16 a[66:67], v125 offset:25088
    ds_read_b64_tr_b16 a[68:69], v125 offset:28672
    ds_read_b64_tr_b16 a[70:71], v125 offset:29184
    ds_read_b64_tr_b16 a[72:73], v125 offset:32768
    ds_read_b64_tr_b16 a[74:75], v125 offset:33280
    ds_read_b64_tr_b16 a[76:77], v125 offset:36864
    ds_read_b64_tr_b16 a[78:79], v125 offset:37376
    s_waitcnt lgkmcnt(0)
    s_mov_b32 s49, 40960
    s_mov_b32 s47, 40960
    s_mov_b32 s37, -1
    s_add_u32 s44, s38, 65536
    s_add_u32 s45, s44, s56
    s_mov_b32 s46, 40960
    v_mov_b32 v1, 196
    buffer_load_dword v2, v1, s[8:11], 0 offen sc1
    ds_read_b128 v[84:87], v11 offset:0
    ds_read_b128 v[88:91], v11 offset:2048
    ds_read_b128 v[92:95], v12 offset:0
    ds_read_b128 v[96:99], v12 offset:2048
    s_waitcnt lgkmcnt(2)
    v_mfma_f32_16x16x32_bf16 v[108:111], a[0:3], v[84:87], 0
    ds_read_b128 v[100:103], v11 offset:4096
    v_mfma_f32_16x16x32_bf16 v[112:115], a[0:3], v[88:91], 0
    ds_read_b128 v[104:107], v11 offset:6144
    v_mfma_f32_16x16x32_bf16 v[116:119], a[80:83], v[84:87], 0
    v_mfma_f32_16x16x32_bf16 v[120:123], a[80:83], v[88:91], 0
    s_waitcnt lgkmcnt(2)
    v_mfma_f32_16x16x32_bf16 v[108:111], a[4:7], v[92:95], v[108:111]
    ds_read_b128 v[84:87], v12 offset:4096
    v_mfma_f32_16x16x32_bf16 v[112:115], a[4:7], v[96:99], v[112:115]
    ds_read_b128 v[88:91], v12 offset:6144
    v_mfma_f32_16x16x32_bf16 v[116:119], a[84:87], v[92:95], v[116:119]
    v_mfma_f32_16x16x32_bf16 v[120:123], a[84:87], v[96:99], v[120:123]
    s_waitcnt lgkmcnt(2)
    v_mfma_f32_16x16x32_bf16 v[108:111], a[8:11], v[100:103], v[108:111]
    ds_read_b128 v[92:95], v11 offset:8192
    v_mfma_f32_16x16x32_bf16 v[112:115], a[8:11], v[104:107], v[112:115]
    ds_read_b128 v[96:99], v11 offset:10240
    v_mfma_f32_16x16x32_bf16 v[116:119], a[88:91], v[100:103], v[116:119]
    v_mfma_f32_16x16x32_bf16 v[120:123], a[88:91], v[104:107], v[120:123]
    s_waitcnt lgkmcnt(2)
    v_mfma_f32_16x16x32_bf16 v[108:111], a[12:15], v[84:87], v[108:111]
    ds_read_b128 v[100:103], v12 offset:8192
    v_mfma_f32_16x16x32_bf16 v[112:115], a[12:15], v[88:91], v[112:115]
    ds_read_b128 v[104:107], v12 offset:10240
    v_mfma_f32_16x16x32_bf16 v[116:119], a[92:95], v[84:87], v[116:119]
    v_mfma_f32_16x16x32_bf16 v[120:123], a[92:95], v[88:91], v[120:123]
    s_waitcnt lgkmcnt(2)
    v_mfma_f32_16x16x32_bf16 v[108:111], a[16:19], v[92:95], v[108:111]
    ds_read_b128 v[84:87], v11 offset:12288
    v_mfma_f32_16x16x32_bf16 v[112:115], a[16:19], v[96:99], v[112:115]
    ds_read_b128 v[88:91], v11 offset:14336
    v_mfma_f32_16x16x32_bf16 v[116:119], a[96:99], v[92:95], v[116:119]
    v_mfma_f32_16x16x32_bf16 v[120:123], a[96:99], v[96:99], v[120:123]
    s_waitcnt lgkmcnt(2)
    v_mfma_f32_16x16x32_bf16 v[108:111], a[20:23], v[100:103], v[108:111]
    ds_read_b128 v[92:95], v12 offset:12288
    v_mfma_f32_16x16x32_bf16 v[112:115], a[20:23], v[104:107], v[112:115]
    ds_read_b128 v[96:99], v12 offset:14336
    v_mfma_f32_16x16x32_bf16 v[116:119], a[100:103], v[100:103], v[116:119]
    v_mfma_f32_16x16x32_bf16 v[120:123], a[100:103], v[104:107], v[120:123]
    s_waitcnt lgkmcnt(2)
    v_mfma_f32_16x16x32_bf16 v[108:111], a[24:27], v[84:87], v[108:111]
    ds_read_b128 v[100:103], v11 offset:16384
    v_mfma_f32_16x16x32_bf16 v[112:115], a[24:27], v[88:91], v[112:115]
    ds_read_b128 v[104:107], v11 offset:18432
    v_mfma_f32_16x16x32_bf16 v[116:119], a[104:107], v[84:87], v[116:119]
    v_mfma_f32_16x16x32_bf16 v[120:123], a[104:107], v[88:91], v[120:123]
    s_waitcnt lgkmcnt(2)
    v_mfma_f32_16x16x32_bf16 v[108:111], a[28:31], v[92:95], v[108:111]
    ds_read_b128 v[84:87], v12 offset:16384
    v_mfma_f32_16x16x32_bf16 v[112:115], a[28:31], v[96:99], v[112:115]
    ds_read_b128 v[88:91], v12 offset:18432
    v_mfma_f32_16x16x32_bf16 v[116:119], a[108:111], v[92:95], v[116:119]
    v_mfma_f32_16x16x32_bf16 v[120:123], a[108:111], v[96:99], v[120:123]
    s_waitcnt lgkmcnt(2)
    v_mfma_f32_16x16x32_bf16 v[108:111], a[32:35], v[100:103], v[108:111]
    ds_read_b128 v[92:95], v11 offset:20480
    v_mfma_f32_16x16x32_bf16 v[112:115], a[32:35], v[104:107], v[112:115]
    ds_read_b128 v[96:99], v11 offset:22528
    v_mfma_f32_16x16x32_bf16 v[116:119], a[112:115], v[100:103], v[116:119]
    v_mfma_f32_16x16x32_bf16 v[120:123], a[112:115], v[104:107], v[120:123]
    s_waitcnt lgkmcnt(2)
    v_mfma_f32_16x16x32_bf16 v[108:111], a[36:39], v[84:87], v[108:111]
    ds_read_b128 v[100:103], v12 offset:20480
    v_mfma_f32_16x16x32_bf16 v[112:115], a[36:39], v[88:91], v[112:115]
    ds_read_b128 v[104:107], v12 offset:22528
    v_mfma_f32_16x16x32_bf16 v[116:119], a[116:119], v[84:87], v[116:119]
    v_mfma_f32_16x16x32_bf16 v[120:123], a[116:119], v[88:91], v[120:123]
    s_waitcnt lgkmcnt(2)
    v_mfma_f32_16x16x32_bf16 v[108:111], a[40:43], v[92:95], v[108:111]
    ds_read_b128 v[84:87], v11 offset:24576
    v_mfma_f32_16x16x32_bf16 v[112:115], a[40:43], v[96:99], v[112:115]
    ds_read_b128 v[88:91], v11 offset:26624
    v_mfma_f32_16x16x32_bf16 v[116:119], a[120:123], v[92:95], v[116:119]
    v_mfma_f32_16x16x32_bf16 v[120:123], a[120:123], v[96:99], v[120:123]
    s_waitcnt lgkmcnt(2)
    v_mfma_f32_16x16x32_bf16 v[108:111], a[44:47], v[100:103], v[108:111]
    ds_read_b128 v[92:95], v12 offset:24576
    v_mfma_f32_16x16x32_bf16 v[112:115], a[44:47], v[104:107], v[112:115]
    ds_read_b128 v[96:99], v12 offset:26624
    v_mfma_f32_16x16x32_bf16 v[116:119], a[124:127], v[100:103], v[116:119]
    v_mfma_f32_16x16x32_bf16 v[120:123], a[124:127], v[104:107], v[120:123]
    s_waitcnt lgkmcnt(2)
    v_mfma_f32_16x16x32_bf16 v[108:111], a[48:51], v[84:87], v[108:111]
    ds_read_b128 v[100:103], v11 offset:28672
    v_mfma_f32_16x16x32_bf16 v[112:115], a[48:51], v[88:91], v[112:115]
    ds_read_b128 v[104:107], v11 offset:30720
    v_mfma_f32_16x16x32_bf16 v[116:119], a[128:131], v[84:87], v[116:119]
    v_mfma_f32_16x16x32_bf16 v[120:123], a[128:131], v[88:91], v[120:123]
    s_waitcnt lgkmcnt(2)
    v_mfma_f32_16x16x32_bf16 v[108:111], a[52:55], v[92:95], v[108:111]
    ds_read_b128 v[84:87], v12 offset:28672
    v_mfma_f32_16x16x32_bf16 v[112:115], a[52:55], v[96:99], v[112:115]
    ds_read_b128 v[88:91], v12 offset:30720
    v_mfma_f32_16x16x32_bf16 v[116:119], a[132:135], v[92:95], v[116:119]
    v_mfma_f32_16x16x32_bf16 v[120:123], a[132:135], v[96:99], v[120:123]
    s_waitcnt lgkmcnt(2)
    v_mfma_f32_16x16x32_bf16 v[108:111], a[56:59], v[100:103], v[108:111]
    ds_read_b128 v[92:95], v11 offset:32768
    v_mfma_f32_16x16x32_bf16 v[112:115], a[56:59], v[104:107], v[112:115]
    ds_read_b128 v[96:99], v11 offset:34816
    v_mfma_f32_16x16x32_bf16 v[116:119], a[136:139], v[100:103], v[116:119]
    v_mfma_f32_16x16x32_bf16 v[120:123], a[136:139], v[104:107], v[120:123]
    s_waitcnt lgkmcnt(2)
    v_mfma_f32_16x16x32_bf16 v[108:111], a[60:63], v[84:87], v[108:111]
    ds_read_b128 v[100:103], v12 offset:32768
    v_mfma_f32_16x16x32_bf16 v[112:115], a[60:63], v[88:91], v[112:115]
    ds_read_b128 v[104:107], v12 offset:34816
    v_mfma_f32_16x16x32_bf16 v[116:119], a[140:143], v[84:87], v[116:119]
    v_mfma_f32_16x16x32_bf16 v[120:123], a[140:143], v[88:91], v[120:123]
    s_waitcnt lgkmcnt(2)
    v_mfma_f32_16x16x32_bf16 v[108:111], a[64:67], v[92:95], v[108:111]
    ds_read_b128 v[84:87], v11 offset:36864
    v_mfma_f32_16x16x32_bf16 v[112:115], a[64:67], v[96:99], v[112:115]
    ds_read_b128 v[88:91], v11 offset:38912
    v_mfma_f32_16x16x32_bf16 v[116:119], a[144:147], v[92:95], v[116:119]
    v_mfma_f32_16x16x32_bf16 v[120:123], a[144:147], v[96:99], v[120:123]
    s_waitcnt lgkmcnt(2)
    v_mfma_f32_16x16x32_bf16 v[108:111], a[68:71], v[100:103], v[108:111]
    ds_read_b128 v[92:95], v12 offset:36864
    v_mfma_f32_16x16x32_bf16 v[112:115], a[68:71], v[104:107], v[112:115]
    ds_read_b128 v[96:99], v12 offset:38912
    v_mfma_f32_16x16x32_bf16 v[116:119], a[148:151], v[100:103], v[116:119]
    v_mfma_f32_16x16x32_bf16 v[120:123], a[148:151], v[104:107], v[120:123]
    s_waitcnt lgkmcnt(0)
    v_mfma_f32_16x16x32_bf16 v[108:111], a[72:75], v[84:87], v[108:111]
    v_add_u32 v11, s49, v11
    v_mfma_f32_16x16x32_bf16 v[112:115], a[72:75], v[88:91], v[112:115]
    v_add_u32 v12, s49, v12
    v_mfma_f32_16x16x32_bf16 v[108:111], a[76:79], v[92:95], v[108:111]
    s_sub_u32 s47, s47, s49
    v_mfma_f32_16x16x32_bf16 v[112:115], a[76:79], v[96:99], v[112:115]
    s_sub_u32 s49, 0, s49
    v_mfma_f32_16x16x32_bf16 v[116:119], a[152:155], v[84:87], v[116:119]
    v_mfma_f32_16x16x32_bf16 v[120:123], a[152:155], v[88:91], v[120:123]
    v_mfma_f32_16x16x32_bf16 v[116:119], a[156:159], v[92:95], v[116:119]
    v_mfma_f32_16x16x32_bf16 v[120:123], a[156:159], v[96:99], v[120:123]
    v_cvt_pk_bf16_f32 v124, v108, v109
    v_cvt_pk_bf16_f32 v125, v110, v111
    v_cvt_pk_bf16_f32 v126, v112, v113
    v_cvt_pk_bf16_f32 v127, v114, v115
    s_nop 0
    v_permlane16_swap_b32 v124, v126
    v_permlane16_swap_b32 v125, v127
    v_cvt_pk_bf16_f32 v128, v116, v117
    v_cvt_pk_bf16_f32 v129, v118, v119
    v_cvt_pk_bf16_f32 v130, v120, v121
    v_cvt_pk_bf16_f32 v131, v122, v123
    s_nop 0
    v_permlane16_swap_b32 v128, v130
    v_permlane16_swap_b32 v129, v131
    buffer_store_dwordx4 v[124:127], v19, s[4:7], s44 offen sc1
    buffer_store_dwordx4 v[128:131], v19, s[4:7], s45 offen sc1
    s_waitcnt vmcnt(2)
    s_branch L_gw_82c
L_gw_82:
    buffer_load_dword v2, v1, s[8:11], 0 offen sc1
    s_sub_u32 s36, s36, 1
    s_cbranch_scc1 L_exit
    s_waitcnt vmcnt(0)
L_gw_82c:
    v_readfirstlane_b32 s90, v2
    s_nop 0
    s_cmp_eq_u32 s90, 0
    s_cbranch_scc1 L_gw_82
    s_waitcnt vmcnt(2) lgkmcnt(0)
    s_barrier
    s_add_u32 s44, s38, 180224
    s_add_u32 s45, s44, s56
    s_mov_b32 s46, 81920
    v_mov_b32 v20, 1
    ds_read_b128 v[84:87], v11 offset:0
    ds_read_b128 v[88:91], v11 offset:2048
    ds_read_b128 v[92:95], v12 offset:0
    ds_read_b128 v[96:99], v12 offset:2048
    s_lshl_b32 s90, s32, 10
    s_add_u32 m0, s90, s47
    s_waitcnt lgkmcnt(2)
    v_mfma_f32_16x16x32_bf16 v[108:111], a[0:3], v[84:87], 0
    ds_read_b128 v[100:103], v11 offset:4096
    v_mfma_f32_16x16x32_bf16 v[112:115], a[0:3], v[88:91], 0
    ds_read_b128 v[104:107], v11 offset:6144
    v_mfma_f32_16x16x32_bf16 v[116:119], a[80:83], v[84:87], 0
    buffer_load_dwordx4 v10, s[24:27], s46 offen offset:0 lds
    s_add_u32 m0, m0, 3968
    v_mfma_f32_16x16x32_bf16 v[120:123], a[80:83], v[88:91], 0
    s_waitcnt lgkmcnt(2)
    v_mfma_f32_16x16x32_bf16 v[108:111], a[4:7], v[92:95], v[108:111]
    ds_read_b128 v[84:87], v12 offset:4096
    v_mfma_f32_16x16x32_bf16 v[112:115], a[4:7], v[96:99], v[112:115]
    ds_read_b128 v[88:91], v12 offset:6144
    v_mfma_f32_16x16x32_bf16 v[116:119], a[84:87], v[92:95], v[116:119]
    buffer_load_dwordx4 v10, s[24:27], s46 offen offset:128 lds
    s_add_u32 m0, m0, 3968
    v_mfma_f32_16x16x32_bf16 v[120:123], a[84:87], v[96:99], v[120:123]
    s_waitcnt lgkmcnt(2)
    v_mfma_f32_16x16x32_bf16 v[108:111], a[8:11], v[100:103], v[108:111]
    ds_read_b128 v[92:95], v11 offset:8192
    v_mfma_f32_16x16x32_bf16 v[112:115], a[8:11], v[104:107], v[112:115]
    ds_read_b128 v[96:99], v11 offset:10240
    v_mfma_f32_16x16x32_bf16 v[116:119], a[88:91], v[100:103], v[116:119]
    buffer_load_dwordx4 v10, s[24:27], s46 offen offset:256 lds
    s_add_u32 m0, m0, 3968
    v_mfma_f32_16x16x32_bf16 v[120:123], a[88:91], v[104:107], v[120:123]
    s_waitcnt lgkmcnt(2)
    v_mfma_f32_16x16x32_bf16 v[108:111], a[12:15], v[84:87], v[108:111]
    ds_read_b128 v[100:103], v12 offset:8192
    v_mfma_f32_16x16x32_bf16 v[112:115], a[12:15], v[88:91], v[112:115]
    ds_read_b128 v[104:107], v12 offset:10240
    v_mfma_f32_16x16x32_bf16 v[116:119], a[92:95], v[84:87], v[116:119]
    buffer_load_dwordx4 v10, s[24:27], s46 offen offset:384 lds
    s_add_u32 m0, m0, 3968
    v_mfma_f32_16x16x32_bf16 v[120:123], a[92:95], v[88:91], v[120:123]
    s_waitcnt lgkmcnt(2)
    v_mfma_f32_16x16x32_bf16 v[108:111], a[16:19], v[92:95], v[108:111]
    ds_read_b128 v[84:87], v11 offset:12288
    v_mfma_f32_16x16x32_bf16 v[112:115], a[16:19], v[96:99], v[112:115]
    ds_read_b128 v[88:91], v11 offset:14336
    v_mfma_f32_16x16x32_bf16 v[116:119], a[96:99], v[92:95], v[116:119]
    buffer_load_dwordx4 v10, s[24:27], s46 offen offset:512 lds
    s_add_u32 m0, m0, 3968
    v_mfma_f32_16x16x32_bf16 v[120:123], a[96:99], v[96:99], v[120:123]
    s_waitcnt lgkmcnt(2)
    v_mfma_f32_16x16x32_bf16 v[108:111], a[20:23], v[100:103], v[108:111]
    ds_read_b128 v[92:95], v12 offset:12288
    v_mfma_f32_16x16x32_bf16 v[112:115], a[20:23], v[104:107], v[112:115]
    ds_read_b128 v[96:99], v12 offset:14336
    v_mfma_f32_16x16x32_bf16 v[116:119], a[100:103], v[100:103], v[116:119]
    s_waitcnt vmcnt(5)
    buffer_store_dword v20, v136, s[4:7], s38 offen sc1
    v_mfma_f32_16x16x32_bf16 v[120:123], a[100:103], v[104:107], v[120:123]
    s_waitcnt lgkmcnt(2)
    v_mfma_f32_16x16x32_bf16 v[108:111], a[24:27], v[84:87], v[108:111]
    ds_read_b128 v[100:103], v11 offset:16384
    v_mfma_f32_16x16x32_bf16 v[112:115], a[24:27], v[88:91], v[112:115]
    ds_read_b128 v[104:107], v11 offset:18432
    v_mfma_f32_16x16x32_bf16 v[116:119], a[104:107], v[84:87], v[116:119]
    buffer_load_dwordx4 v10, s[24:27], s46 offen offset:640 lds
    s_add_u32 m0, m0, 3968
    v_mfma_f32_16x16x32_bf16 v[120:123], a[104:107], v[88:91], v[120:123]
    s_waitcnt lgkmcnt(2)
    v_mfma_f32_16x16x32_bf16 v[108:111], a[28:31], v[92:95], v[108:111]
    ds_read_b128 v[84:87], v12 offset:16384
    v_mfma_f32_16x16x32_bf16 v[112:115], a[28:31], v[96:99], v[112:115]
    ds_read_b128 v[88:91], v12 offset:18432
    v_mfma_f32_16x16x32_bf16 v[116:119], a[108:111], v[92:95], v[116:119]
    buffer_load_dwordx4 v10, s[24:27], s46 offen offset:768 lds
    s_add_u32 m0, m0, 3968
    v_mfma_f32_16x16x32_bf16 v[120:123], a[108:111], v[96:99], v[120:123]
    s_waitcnt lgkmcnt(2)
    v_mfma_f32_16x16x32_bf16 v[108:111], a[32:35], v[100:103], v[108:111]
    ds_read_b128 v[92:95], v11 offset:20480
    v_mfma_f32_16x16x32_bf16 v[112:115], a[32:35], v[104:107], v[112:115]
    ds_read_b128 v[96:99], v11 offset:22528
    v_mfma_f32_16x16x32_bf16 v[116:119], a[112:115], v[100:103], v[116:119]
    buffer_load_dwordx4 v10, s[24:27], s46 offen offset:896 lds
    s_add_u32 m0, m0, 3968
    v_mfma_f32_16x16x32_bf16 v[120:123], a[112:115], v[104:107], v[120:123]
    s_waitcnt lgkmcnt(2)
    v_mfma_f32_16x16x32_bf16 v[108:111], a[36:39], v[84:87], v[108:111]
    ds_read_b128 v[100:103], v12 offset:20480
    v_mfma_f32_16x16x32_bf16 v[112:115], a[36:39], v[88:91], v[112:115]
    ds_read_b128 v[104:107], v12 offset:22528
    v_mfma_f32_16x16x32_bf16 v[116:119], a[116:119], v[84:87], v[116:119]
    buffer_load_dwordx4 v10, s[24:27], s46 offen offset:1024 lds
    s_add_u32 m0, m0, 3968
    v_mfma_f32_16x16x32_bf16 v[120:123], a[116:119], v[88:91], v[120:123]
    s_waitcnt lgkmcnt(2)
    v_mfma_f32_16x16x32_bf16 v[108:111], a[40:43], v[92:95], v[108:111]
    ds_read_b128 v[84:87], v11 offset:24576
    v_mfma_f32_16x16x32_bf16 v[112:115], a[40:43], v[96:99], v[112:115]
    ds_read_b128 v[88:91], v11 offset:26624
    v_mfma_f32_16x16x32_bf16 v[116:119], a[120:123], v[92:95], v[116:119]
    buffer_load_dwordx4 v10, s[24:27], s46 offen offset:1152 lds
    v_mfma_f32_16x16x32_bf16 v[120:123], a[120:123], v[96:99], v[120:123]
    s_waitcnt lgkmcnt(2)
    v_mfma_f32_16x16x32_bf16 v[108:111], a[44:47], v[100:103], v[108:111]
    ds_read_b128 v[92:95], v12 offset:24576
    v_mfma_f32_16x16x32_bf16 v[112:115], a[44:47], v[104:107], v[112:115]
    ds_read_b128 v[96:99], v12 offset:26624
    v_mfma_f32_16x16x32_bf16 v[116:119], a[124:127], v[100:103], v[116:119]
    v_mfma_f32_16x16x32_bf16 v[120:123], a[124:127], v[104:107], v[120:123]
    s_waitcnt lgkmcnt(2)
    v_mfma_f32_16x16x32_bf16 v[108:111], a[48:51], v[84:87], v[108:111]
    ds_read_b128 v[100:103], v11 offset:28672
    v_mfma_f32_16x16x32_bf16 v[112:115], a[48:51], v[88:91], v[112:115]
    ds_read_b128 v[104:107], v11 offset:30720
    v_mfma_f32_16x16x32_bf16 v[116:119], a[128:131], v[84:87], v[116:119]
    v_mfma_f32_16x16x32_bf16 v[120:123], a[128:131], v[88:91], v[120:123]
    s_waitcnt lgkmcnt(2)
    v_mfma_f32_16x16x32_bf16 v[108:111], a[52:55], v[92:95], v[108:111]
    ds_read_b128 v[84:87], v12 offset:28672
    v_mfma_f32_16x16x32_bf16 v[112:115], a[52:55], v[96:99], v[112:115]
    ds_read_b128 v[88:91], v12 offset:30720
    v_mfma_f32_16x16x32_bf16 v[116:119], a[132:135], v[92:95], v[116:119]
    v_mfma_f32_16x16x32_bf16 v[120:123], a[132:135], v[96:99], v[120:123]
    s_waitcnt lgkmcnt(2)
    v_mfma_f32_16x16x32_bf16 v[108:111], a[56:59], v[100:103], v[108:111]
    ds_read_b128 v[92:95], v11 offset:32768
    v_mfma_f32_16x16x32_bf16 v[112:115], a[56:59], v[104:107], v[112:115]
    ds_read_b128 v[96:99], v11 offset:34816
    v_mfma_f32_16x16x32_bf16 v[116:119], a[136:139], v[100:103], v[116:119]
    v_mfma_f32_16x16x32_bf16 v[120:123], a[136:139], v[104:107], v[120:123]
    s_waitcnt lgkmcnt(2)
    v_mfma_f32_16x16x32_bf16 v[108:111], a[60:63], v[84:87], v[108:111]
    ds_read_b128 v[100:103], v12 offset:32768
    v_mfma_f32_16x16x32_bf16 v[112:115], a[60:63], v[88:91], v[112:115]
    ds_read_b128 v[104:107], v12 offset:34816
    v_mfma_f32_16x16x32_bf16 v[116:119], a[140:143], v[84:87], v[116:119]
    v_mfma_f32_16x16x32_bf16 v[120:123], a[140:143], v[88:91], v[120:123]
    s_waitcnt lgkmcnt(2)
    v_mfma_f32_16x16x32_bf16 v[108:111], a[64:67], v[92:95], v[108:111]
    ds_read_b128 v[84:87], v11 offset:36864
    v_mfma_f32_16x16x32_bf16 v[112:115], a[64:67], v[96:99], v[112:115]
    ds_read_b128 v[88:91], v11 offset:38912
    v_mfma_f32_16x16x32_bf16 v[116:119], a[144:147], v[92:95], v[116:119]
    v_mfma_f32_16x16x32_bf16 v[120:123], a[144:147], v[96:99], v[120:123]
    s_waitcnt lgkmcnt(2)
    v_mfma_f32_16x16x32_bf16 v[108:111], a[68:71], v[100:103], v[108:111]
    ds_read_b128 v[92:95], v12 offset:36864
    v_mfma_f32_16x16x32_bf16 v[112:115], a[68:71], v[104:107], v[112:115]
    ds_read_b128 v[96:99], v12 offset:38912
    v_mfma_f32_16x16x32_bf16 v[116:119], a[148:151], v[100:103], v[116:119]
    v_mfma_f32_16x16x32_bf16 v[120:123], a[148:151], v[104:107], v[120:123]
    s_waitcnt lgkmcnt(0)
    v_mfma_f32_16x16x32_bf16 v[108:111], a[72:75], v[84:87], v[108:111]
    v_add_u32 v11, s49, v11
    v_mfma_f32_16x16x32_bf16 v[112:115], a[72:75], v[88:91], v[112:115]
    v_add_u32 v12, s49, v12
    v_mfma_f32_16x16x32_bf16 v[108:111], a[76:79], v[92:95], v[108:111]
    s_sub_u32 s47, s47, s49
    v_mfma_f32_16x16x32_bf16 v[112:115], a[76:79], v[96:99], v[112:115]
    s_sub_u32 s49, 0, s49
    v_mfma_f32_16x16x32_bf16 v[116:119], a[152:155], v[84:87], v[116:119]
    v_mfma_f32_16x16x32_bf16 v[120:123], a[152:155], v[88:91], v[120:123]
    v_mfma_f32_16x16x32_bf16 v[116:119], a[156:159], v[92:95], v[116:119]
    v_mfma_f32_16x16x32_bf16 v[120:123], a[156:159], v[96:99], v[120:123]
    v_cvt_pk_bf16_f32 v124, v108, v109
    v_cvt_pk_bf16_f32 v125, v110, v111
    v_cvt_pk_bf16_f32 v126, v112, v113
    v_cvt_pk_bf16_f32 v127, v114, v115
    s_nop 0
    v_permlane16_swap_b32 v124, v126
    v_permlane16_swap_b32 v125, v127
    v_cvt_pk_bf16_f32 v128, v116, v117
    v_cvt_pk_bf16_f32 v129, v118, v119
    v_cvt_pk_bf16_f32 v130, v120, v121
    v_cvt_pk_bf16_f32 v131, v122, v123
    s_nop 0
    v_permlane16_swap_b32 v128, v130
    v_permlane16_swap_b32 v129, v131
    buffer_store_dwordx4 v[124:127], v19, s[4:7], s44 offen sc1
    buffer_store_dwordx4 v[128:131], v19, s[4:7], s45 offen sc1
    s_waitcnt vmcnt(2) lgkmcnt(0)
    s_barrier
    s_add_u32 s44, s38, 294912
    s_add_u32 s45, s44, s56
    s_mov_b32 s46, 122880
    v_mov_b32 v20, 2
    ds_read_b128 v[84:87], v11 offset:0
    ds_read_b128 v[88:91], v11 offset:2048
    ds_read_b128 v[92:95], v12 offset:0
    ds_read_b128 v[96:99], v12 offset:2048
    s_lshl_b32 s90, s32, 10
    s_add_u32 m0, s90, s47
    s_waitcnt lgkmcnt(2)
    v_mfma_f32_16x16x32_bf16 v[108:111], a[0:3], v[84:87], 0
    ds_read_b128 v[100:103], v11 offset:4096
    s_add_u32 s51, s37, 3
    v_mfma_f32_16x16x32_bf16 v[112:115], a[0:3], v[88:91], 0
    ds_read_b128 v[104:107], v11 offset:6144
    s_and_b32 s50, s51, 3
    v_mfma_f32_16x16x32_bf16 v[116:119], a[80:83], v[84:87], 0
    buffer_load_dwordx4 v10, s[24:27], s46 offen offset:0 lds
    s_add_u32 m0, m0, 3968
    v_mfma_f32_16x16x32_bf16 v[120:123], a[80:83], v[88:91], 0
    s_waitcnt lgkmcnt(2)
    s_mul_i32 s50, s50, 114688
    v_mfma_f32_16x16x32_bf16 v[108:111], a[4:7], v[92:95], v[108:111]
    ds_read_b128 v[84:87], v12 offset:4096
    s_add_u32 s50, s50, 65536
    v_mfma_f32_16x16x32_bf16 v[112:115], a[4:7], v[96:99], v[112:115]
    ds_read_b128 v[88:91], v12 offset:6144
    s_add_u32 s44, s38, s50
    v_mfma_f32_16x16x32_bf16 v[116:119], a[84:87], v[92:95], v[116:119]
    buffer_load_dwordx4 v10, s[24:27], s46 offen offset:128 lds
    s_add_u32 m0, m0, 3968
    v_mfma_f32_16x16x32_bf16 v[120:123], a[84:87], v[96:99], v[120:123]
    s_waitcnt lgkmcnt(2)
    s_add_u32 s45, s44, s56
    v_mfma_f32_16x16x32_bf16 v[108:111], a[8:11], v[100:103], v[108:111]
    ds_read_b128 v[92:95], v11 offset:8192
    s_add_u32 s37, s37, 1
    v_mfma_f32_16x16x32_bf16 v[112:115], a[8:11], v[104:107], v[112:115]
    ds_read_b128 v[96:99], v11 offset:10240
    s_mov_b32 s52, 0
    v_mfma_f32_16x16x32_bf16 v[116:119], a[88:91], v[100:103], v[116:119]
    buffer_load_dwordx4 v10, s[24:27], s46 offen offset:256 lds
    s_add_u32 m0, m0, 3968
    v_mfma_f32_16x16x32_bf16 v[120:123], a[88:91], v[104:107], v[120:123]
    s_waitcnt lgkmcnt(2)
    s_and_b32 s50, s37, 3
    v_mfma_f32_16x16x32_bf16 v[108:111], a[12:15], v[84:87], v[108:111]
    ds_read_b128 v[100:103], v12 offset:8192
    s_mul_i32 s51, s50, 114688
    v_mfma_f32_16x16x32_bf16 v[112:115], a[12:15], v[88:91], v[112:115]
    ds_read_b128 v[104:107], v12 offset:10240
    s_add_u32 s41, s38, s51
    v_mfma_f32_16x16x32_bf16 v[116:119], a[92:95], v[84:87], v[116:119]
    buffer_load_dwordx4 v10, s[24:27], s46 offen offset:384 lds
    s_add_u32 m0, m0, 3968
    v_mfma_f32_16x16x32_bf16 v[120:123], a[92:95], v[88:91], v[120:123]
    s_waitcnt lgkmcnt(2)
    v_mfma_f32_16x16x32_bf16 v[108:111], a[16:19], v[92:95], v[108:111]
    ds_read_b128 v[84:87], v11 offset:12288
    v_mfma_f32_16x16x32_bf16 v[112:115], a[16:19], v[96:99], v[112:115]
    ds_read_b128 v[88:91], v11 offset:14336
    v_mfma_f32_16x16x32_bf16 v[116:119], a[96:99], v[92:95], v[116:119]
    buffer_load_dwordx4 v10, s[24:27], s46 offen offset:512 lds
    s_add_u32 m0, m0, 3968
    v_mfma_f32_16x16x32_bf16 v[120:123], a[96:99], v[96:99], v[120:123]
    s_waitcnt lgkmcnt(2)
    v_mfma_f32_16x16x32_bf16 v[108:111], a[20:23], v[100:103], v[108:111]
    ds_read_b128 v[92:95], v12 offset:12288
    v_mfma_f32_16x16x32_bf16 v[112:115], a[20:23], v[104:107], v[112:115]
    ds_read_b128 v[96:99], v12 offset:14336
    v_mfma_f32_16x16x32_bf16 v[116:119], a[100:103], v[100:103], v[116:119]
    s_waitcnt vmcnt(5)
    buffer_store_dword v20, v136, s[4:7], s38 offen sc1
    v_mfma_f32_16x16x32_bf16 v[120:123], a[100:103], v[104:107], v[120:123]
    s_waitcnt lgkmcnt(2)
    v_mfma_f32_16x16x32_bf16 v[108:111], a[24:27], v[84:87], v[108:111]
    ds_read_b128 v[100:103], v11 offset:16384
    v_mfma_f32_16x16x32_bf16 v[112:115], a[24:27], v[88:91], v[112:115]
    ds_read_b128 v[104:107], v11 offset:18432
    v_mfma_f32_16x16x32_bf16 v[116:119], a[104:107], v[84:87], v[116:119]
    buffer_load_dwordx4 v10, s[24:27], s46 offen offset:640 lds
    s_add_u32 m0, m0, 3968
    v_mfma_f32_16x16x32_bf16 v[120:123], a[104:107], v[88:91], v[120:123]
    s_waitcnt lgkmcnt(2)
    v_mfma_f32_16x16x32_bf16 v[108:111], a[28:31], v[92:95], v[108:111]
    ds_read_b128 v[84:87], v12 offset:16384
    v_mfma_f32_16x16x32_bf16 v[112:115], a[28:31], v[96:99], v[112:115]
    ds_read_b128 v[88:91], v12 offset:18432
    v_mfma_f32_16x16x32_bf16 v[116:119], a[108:111], v[92:95], v[116:119]
    buffer_load_dwordx4 v10, s[24:27], s46 offen offset:768 lds
    s_add_u32 m0, m0, 3968
    v_mfma_f32_16x16x32_bf16 v[120:123], a[108:111], v[96:99], v[120:123]
    s_waitcnt lgkmcnt(2)
    v_mfma_f32_16x16x32_bf16 v[108:111], a[32:35], v[100:103], v[108:111]
    ds_read_b128 v[92:95], v11 offset:20480
    v_mfma_f32_16x16x32_bf16 v[112:115], a[32:35], v[104:107], v[112:115]
    ds_read_b128 v[96:99], v11 offset:22528
    v_mfma_f32_16x16x32_bf16 v[116:119], a[112:115], v[100:103], v[116:119]
    buffer_load_dwordx4 v10, s[24:27], s46 offen offset:896 lds
    s_add_u32 m0, m0, 3968
    v_mfma_f32_16x16x32_bf16 v[120:123], a[112:115], v[104:107], v[120:123]
    s_waitcnt lgkmcnt(2)
    v_mfma_f32_16x16x32_bf16 v[108:111], a[36:39], v[84:87], v[108:111]
    ds_read_b128 v[100:103], v12 offset:20480
    v_mfma_f32_16x16x32_bf16 v[112:115], a[36:39], v[88:91], v[112:115]
    ds_read_b128 v[104:107], v12 offset:22528
    v_mfma_f32_16x16x32_bf16 v[116:119], a[116:119], v[84:87], v[116:119]
    buffer_load_dwordx4 v10, s[24:27], s46 offen offset:1024 lds
    s_add_u32 m0, m0, 3968
    v_mfma_f32_16x16x32_bf16 v[120:123], a[116:119], v[88:91], v[120:123]
    s_waitcnt lgkmcnt(2)
    v_mfma_f32_16x16x32_bf16 v[108:111], a[40:43], v[92:95], v[108:111]
    ds_read_b128 v[84:87], v11 offset:24576
    v_mfma_f32_16x16x32_bf16 v[112:115], a[40:43], v[96:99], v[112:115]
    ds_read_b128 v[88:91], v11 offset:26624
    v_mfma_f32_16x16x32_bf16 v[116:119], a[120:123], v[92:95], v[116:119]
    buffer_load_dwordx4 v10, s[24:27], s46 offen offset:1152 lds
    v_mfma_f32_16x16x32_bf16 v[120:123], a[120:123], v[96:99], v[120:123]
    s_waitcnt lgkmcnt(2)
    v_mfma_f32_16x16x32_bf16 v[108:111], a[44:47], v[100:103], v[108:111]
    ds_read_b128 v[92:95], v12 offset:24576
    v_mfma_f32_16x16x32_bf16 v[112:115], a[44:47], v[104:107], v[112:115]
    ds_read_b128 v[96:99], v12 offset:26624
    v_mfma_f32_16x16x32_bf16 v[116:119], a[124:127], v[100:103], v[116:119]
    v_mfma_f32_16x16x32_bf16 v[120:123], a[124:127], v[104:107], v[120:123]
    s_waitcnt lgkmcnt(2)
    v_mfma_f32_16x16x32_bf16 v[108:111], a[48:51], v[84:87], v[108:111]
    ds_read_b128 v[100:103], v11 offset:28672
    v_mfma_f32_16x16x32_bf16 v[112:115], a[48:51], v[88:91], v[112:115]
    ds_read_b128 v[104:107], v11 offset:30720
    v_mfma_f32_16x16x32_bf16 v[116:119], a[128:131], v[84:87], v[116:119]
    v_mfma_f32_16x16x32_bf16 v[120:123], a[128:131], v[88:91], v[120:123]
    s_waitcnt lgkmcnt(2)
    v_mfma_f32_16x16x32_bf16 v[108:111], a[52:55], v[92:95], v[108:111]
    ds_read_b128 v[84:87], v12 offset:28672
    v_mfma_f32_16x16x32_bf16 v[112:115], a[52:55], v[96:99], v[112:115]
    ds_read_b128 v[88:91], v12 offset:30720
    v_mfma_f32_16x16x32_bf16 v[116:119], a[132:135], v[92:95], v[116:119]
    v_mfma_f32_16x16x32_bf16 v[120:123], a[132:135], v[96:99], v[120:123]
    s_waitcnt lgkmcnt(2)
    v_mfma_f32_16x16x32_bf16 v[108:111], a[56:59], v[100:103], v[108:111]
    ds_read_b128 v[92:95], v11 offset:32768
    v_mfma_f32_16x16x32_bf16 v[112:115], a[56:59], v[104:107], v[112:115]
    ds_read_b128 v[96:99], v11 offset:34816
    v_mfma_f32_16x16x32_bf16 v[116:119], a[136:139], v[100:103], v[116:119]
    v_mfma_f32_16x16x32_bf16 v[120:123], a[136:139], v[104:107], v[120:123]
    s_waitcnt lgkmcnt(2)
    v_mfma_f32_16x16x32_bf16 v[108:111], a[60:63], v[84:87], v[108:111]
    ds_read_b128 v[100:103], v12 offset:32768
    v_mfma_f32_16x16x32_bf16 v[112:115], a[60:63], v[88:91], v[112:115]
    ds_read_b128 v[104:107], v12 offset:34816
    v_mfma_f32_16x16x32_bf16 v[116:119], a[140:143], v[84:87], v[116:119]
    v_mfma_f32_16x16x32_bf16 v[120:123], a[140:143], v[88:91], v[120:123]
    s_waitcnt lgkmcnt(2)
    v_mfma_f32_16x16x32_bf16 v[108:111], a[64:67], v[92:95], v[108:111]
    ds_read_b128 v[84:87], v11 offset:36864
    v_mfma_f32_16x16x32_bf16 v[112:115], a[64:67], v[96:99], v[112:115]
    ds_read_b128 v[88:91], v11 offset:38912
    v_mfma_f32_16x16x32_bf16 v[116:119], a[144:147], v[92:95], v[116:119]
    v_mfma_f32_16x16x32_bf16 v[120:123], a[144:147], v[96:99], v[120:123]
    s_waitcnt lgkmcnt(2)
    v_mfma_f32_16x16x32_bf16 v[108:111], a[68:71], v[100:103], v[108:111]
    ds_read_b128 v[92:95], v12 offset:36864
    v_mfma_f32_16x16x32_bf16 v[112:115], a[68:71], v[104:107], v[112:115]
    ds_read_b128 v[96:99], v12 offset:38912
    v_mfma_f32_16x16x32_bf16 v[116:119], a[148:151], v[100:103], v[116:119]
    v_mfma_f32_16x16x32_bf16 v[120:123], a[148:151], v[104:107], v[120:123]
    s_waitcnt lgkmcnt(0)
    v_mfma_f32_16x16x32_bf16 v[108:111], a[72:75], v[84:87], v[108:111]
    v_add_u32 v11, s49, v11
    v_mfma_f32_16x16x32_bf16 v[112:115], a[72:75], v[88:91], v[112:115]
    v_add_u32 v12, s49, v12
    v_mfma_f32_16x16x32_bf16 v[108:111], a[76:79], v[92:95], v[108:111]
    s_sub_u32 s47, s47, s49
    v_mfma_f32_16x16x32_bf16 v[112:115], a[76:79], v[96:99], v[112:115]
    s_sub_u32 s49, 0, s49
    v_mfma_f32_16x16x32_bf16 v[116:119], a[152:155], v[84:87], v[116:119]
    v_mfma_f32_16x16x32_bf16 v[120:123], a[152:155], v[88:91], v[120:123]
    v_mfma_f32_16x16x32_bf16 v[116:119], a[156:159], v[92:95], v[116:119]
    v_mfma_f32_16x16x32_bf16 v[120:123], a[156:159], v[96:99], v[120:123]
    v_cvt_pk_bf16_f32 v124, v108, v109
    v_cvt_pk_bf16_f32 v125, v110, v111
    v_cvt_pk_bf16_f32 v126, v112, v113
    v_cvt_pk_bf16_f32 v127, v114, v115
    s_nop 0
    v_permlane16_swap_b32 v124, v126
    v_permlane16_swap_b32 v125, v127
    v_cvt_pk_bf16_f32 v128, v116, v117
    v_cvt_pk_bf16_f32 v129, v118, v119
    v_cvt_pk_bf16_f32 v130, v120, v121
    v_cvt_pk_bf16_f32 v131, v122, v123
    s_nop 0
    v_permlane16_swap_b32 v128, v130
    v_permlane16_swap_b32 v129, v131
    buffer_store_dwordx4 v[124:127], v19, s[4:7], s44 offen sc1
    buffer_store_dwordx4 v[128:131], v19, s[4:7], s45 offen sc1
    s_add_u32 s50, s37, 2
    s_and_b32 s50, s50, 3
    s_mul_i32 s50, s50, 114688
    s_add_u32 s42, s38, s50
    s_add_u32 s50, s37, 4
    s_min_u32 s50, s50, 63
    s_mul_i32 s46, s50, 40960
    s_add_u32 s51, s37, 1
    v_mov_b32 v20, s51
    s_mov_b32 m0, s48
    v_mov_b32 v68, 0
    v_mov_b32 v69, 0
    v_mov_b32 v70, 0
    v_mov_b32 v71, 0
    v_mov_b32 v72, 0
    v_mov_b32 v73, 0
    v_mov_b32 v74, 0
    v_mov_b32 v75, 0
    s_add_u32 s50, s37, 6
    s_min_u32 s50, s50, 63
    s_mul_i32 s57, s50, 40960
    s_and_b32 s50, s37, 3
    s_mul_i32 s51, s50, 40960
    s_add_u32 s43, s51, s38
    s_mul_i32 s51, s50, 327680
    s_add_u32 s53, s51, 4194304
    s_xor_b32 s50, s50, 2
    s_mul_i32 s51, s50, 327680
    s_add_u32 s54, s51, 4194304
    s_sub_u32 s51, s37, 6
    s_mul_i32 s60, s51, 81920
    s_branch L_v_first_s
L_v_loop_s:
    s_add_u32 s50, s37, 2
    s_and_b32 s50, s50, 3
    s_mul_i32 s50, s50, 114688
    s_add_u32 s42, s38, s50
    s_add_u32 s50, s37, 4
    s_min_u32 s50, s50, 63
    s_mul_i32 s46, s50, 40960
    s_add_u32 s51, s37, 1
    v_mov_b32 v20, s51
    s_mov_b32 m0, s48
    v_mov_b32 v68, 0
    v_mov_b32 v69, 0
    v_mov_b32 v70, 0
    v_mov_b32 v71, 0
    v_mov_b32 v72, 0
    v_mov_b32 v73, 0
    v_mov_b32 v74, 0
    v_mov_b32 v75, 0
    s_add_u32 s50, s37, 6
    s_min_u32 s50, s50, 63
    s_mul_i32 s57, s50, 40960
    s_and_b32 s50, s37, 3
    s_mul_i32 s51, s50, 40960
    s_add_u32 s43, s51, s38
    s_mul_i32 s51, s50, 327680
    s_add_u32 s53, s51, 4194304
    s_xor_b32 s50, s50, 2
    s_mul_i32 s51, s50, 327680
    s_add_u32 s54, s51, 4194304
    s_sub_u32 s51, s37, 6
    s_mul_i32 s60, s51, 81920
L_vg_83:
    buffer_load_dword v139, v138, s[4:7], s38 offen sc1
    s_sub_u32 s36, s36, 1
    s_cbranch_scc1 L_exit
    s_waitcnt vmcnt(0)
    v_cmp_gt_u32 vcc, s37, v139
    s_cbranch_vccnz L_vg_83
L_v_first_s:
    buffer_load_dwordx4 v13, s[4:7], s41 offen sc1 lds
    buffer_load_dwordx4 v13, s[4:7], s41 offen offset:1024 sc1 lds
    buffer_load_dword v14, s[4:7], s41 offen offset:2048 sc1 lds
    buffer_load_dword v14, s[4:7], s41 offen offset:2304 sc1 lds
L_poll_85:
    buffer_load_dwordx4 v13, s[4:7], s41 offen sc1 lds
    buffer_load_dwordx4 v13, s[4:7], s41 offen offset:1024 sc1 lds
    buffer_load_dword v14, s[4:7], s41 offen offset:2048 sc1 lds
    buffer_load_dword v14, s[4:7], s41 offen offset:2304 sc1 lds
    s_sub_u32 s36, s36, 1
    s_cbranch_scc1 L_exit
    s_waitcnt vmcnt(4)
    ds_read_b32 v18, v15
    s_waitcnt lgkmcnt(0)
    v_cmp_eq_u32 vcc, -1, v18
    s_cbranch_vccnz L_poll_85
    s_barrier
    ds_read_b128 v[28:31], v16 offset:0
    ds_read_b128 v[32:35], v16 offset:1024
    ds_read_b128 v[36:39], v16 offset:2048
    ds_read_b128 v[40:43], v16 offset:3072
    s_waitcnt lgkmcnt(3)
    v_smfmac_f32_16x16x64_bf16 v[68:71], v[28:31], a[0:7], v17
    ds_read_b128 v[44:47], v16 offset:4096
    v_smfmac_f32_16x16x64_bf16 v[72:75], v[28:31], a[80:87], v17
    ds_read_b128 v[48:51], v16 offset:5120
    s_waitcnt lgkmcnt(4)
    v_smfmac_f32_16x16x64_bf16 v[68:71], v[32:35], a[8:15], v17
    ds_read_b128 v[52:55], v16 offset:6144
    v_smfmac_f32_16x16x64_bf16 v[72:75], v[32:35], a[88:95], v17
    ds_read_b128 v[56:59], v16 offset:7168
    s_waitcnt lgkmcnt(5)
    v_smfmac_f32_16x16x64_bf16 v[68:71], v[36:39], a[16:23], v17
    ds_read_b128 v[60:63], v16 offset:8192
    v_smfmac_f32_16x16x64_bf16 v[72:75], v[36:39], a[96:103], v17
    ds_read_b128 v[64:67], v16 offset:9216
    s_waitcnt lgkmcnt(6)
    v_smfmac_f32_16x16x64_bf16 v[68:71], v[40:43], a[24:31], v17
    v_smfmac_f32_16x16x64_bf16 v[72:75], v[40:43], a[104:111], v17
    s_waitcnt lgkmcnt(5)
    v_smfmac_f32_16x16x64_bf16 v[68:71], v[44:47], a[32:39], v17
    v_smfmac_f32_16x16x64_bf16 v[72:75], v[44:47], a[112:119], v17
    s_waitcnt lgkmcnt(4)
    v_smfmac_f32_16x16x64_bf16 v[68:71], v[48:51], a[40:47], v17
    s_waitcnt lgkmcnt(3)
    v_smfmac_f32_16x16x64_bf16 v[68:71], v[52:55], a[48:55], v17
    s_waitcnt lgkmcnt(2)
    v_smfmac_f32_16x16x64_bf16 v[68:71], v[56:59], a[56:63], v17
    s_waitcnt lgkmcnt(1)
    v_smfmac_f32_16x16x64_bf16 v[68:71], v[60:63], a[64:71], v17
    s_waitcnt lgkmcnt(0)
    v_smfmac_f32_16x16x64_bf16 v[68:71], v[64:67], a[72:79], v17
L_redo_84:
    v_smfmac_f32_16x16x64_bf16 v[72:75], v[48:51], a[120:127], v17
    v_smfmac_f32_16x16x64_bf16 v[72:75], v[52:55], a[128:135], v17
    buffer_store_dword v20, v21, s[4:7], s38 offen offset:0 sc1
    v_smfmac_f32_16x16x64_bf16 v[72:75], v[56:59], a[136:143], v17
    v_add_f32 v68, v68, v70
    v_add_f32 v69, v69, v71
    v_smfmac_f32_16x16x64_bf16 v[72:75], v[60:63], a[144:151], v17
    v_cmp_u_f32 vcc, v68, v69
    v_cvt_pk_bf16_f32 v132, v68, v69
    v_smfmac_f32_16x16x64_bf16 v[72:75], v[64:67], a[152:159], v17
    s_cbranch_vccnz L_nan_86
L_cont_87:
    buffer_store_dword v132, v134, s[4:7], s41 offen offset:0 sc1
    s_nop 5
    v_pk_add_f32 v[72:73], v[72:73], v[74:75]
    v_cvt_pk_bf16_f32 v133, v72, v73
    buffer_store_dword v133, v134, s[4:7], s41 offen offset:1024 sc1
    ds_read_b128 v[84:87], v11 offset:0
    ds_read_b128 v[88:91], v11 offset:2048
    ds_read_b128 v[92:95], v12 offset:0
    ds_read_b128 v[96:99], v12 offset:2048
    s_cmp_eq_u32 s37, 63
    s_cbranch_scc1 L_end_88
    s_cmp_eq_u32 s37, 0
    s_cbranch_scc1 L_sd_89c
L_sd_89:
    s_cmp_eq_u32 s40, 0
    s_cbranch_scc1 L_an_90
    s_barrier
    s_lshl_b32 s90, s32, 10
    s_add_u32 m0, s90, s47
    s_waitcnt lgkmcnt(2)
    v_mfma_f32_16x16x32_bf16 v[108:111], a[0:3], v[84:87], 0
    ds_read_b128 v[100:103], v11 offset:4096
    s_add_u32 s51, s37, 3
    v_mfma_f32_16x16x32_bf16 v[112:115], a[0:3], v[88:91], 0
    ds_read_b128 v[104:107], v11 offset:6144
    s_and_b32 s50, s51, 3
    v_mfma_f32_16x16x32_bf16 v[116:119], a[80:83], v[84:87], 0
    buffer_load_dwordx4 v[148:151], v146, s[4:7], s43 offen offset:0 sc1
    buffer_load_dwordx4 v[152:155], v146, s[4:7], s43 offen offset:1024 sc1
    v_mfma_f32_16x16x32_bf16 v[120:123], a[80:83], v[88:91], 0
    s_waitcnt lgkmcnt(2)
    s_mul_i32 s50, s50, 114688
    v_mfma_f32_16x16x32_bf16 v[108:111], a[4:7], v[92:95], v[108:111]
    ds_read_b128 v[84:87], v12 offset:4096
    s_add_u32 s50, s50, 65536
    v_mfma_f32_16x16x32_bf16 v[112:115], a[4:7], v[96:99], v[112:115]
    ds_read_b128 v[88:91], v12 offset:6144
    s_add_u32 s44, s38, s50
    v_mfma_f32_16x16x32_bf16 v[116:119], a[84:87], v[92:95], v[116:119]
    s_cmp_lt_i32 s60, 0
    s_cselect_b32 s54, s38, s54
    buffer_load_dwordx4 v[156:159], v144, s[4:7], s54 offen offset:0 sc1
    buffer_load_dwordx4 v[160:163], v144, s[4:7], s54 offen offset:1024 sc1
    v_mfma_f32_16x16x32_bf16 v[120:123], a[84:87], v[96:99], v[120:123]
    s_waitcnt lgkmcnt(2)
    s_add_u32 s45, s44, s56
    v_mfma_f32_16x16x32_bf16 v[108:111], a[8:11], v[100:103], v[108:111]
    ds_read_b128 v[92:95], v11 offset:8192
    s_add_u32 s37, s37, 1
    v_mfma_f32_16x16x32_bf16 v[112:115], a[8:11], v[104:107], v[112:115]
    ds_read_b128 v[96:99], v11 offset:10240
    s_mov_b32 s52, 0
    v_mfma_f32_16x16x32_bf16 v[116:119], a[88:91], v[100:103], v[116:119]
    s_and_b32 s50, s37, 3
    s_mul_i32 s51, s50, 114688
    v_mfma_f32_16x16x32_bf16 v[120:123], a[88:91], v[104:107], v[120:123]
    s_waitcnt lgkmcnt(2)
    s_add_u32 s41, s38, s51
    v_mfma_f32_16x16x32_bf16 v[108:111], a[12:15], v[84:87], v[108:111]
    ds_read_b128 v[100:103], v12 offset:8192
    v_mfma_f32_16x16x32_bf16 v[112:115], a[12:15], v[88:91], v[112:115]
    ds_read_b128 v[104:107], v12 offset:10240
    v_mfma_f32_16x16x32_bf16 v[116:119], a[92:95], v[84:87], v[116:119]
    buffer_load_dwordx4 v[248:251], v137, s[24:27], s57 offen offset:0
    buffer_load_dwordx4 v[248:251], v137, s[24:27], s57 offen offset:1024
    v_mfma_f32_16x16x32_bf16 v[120:123], a[92:95], v[88:91], v[120:123]
    s_waitcnt lgkmcnt(2)
    v_mfma_f32_16x16x32_bf16 v[108:111], a[16:19], v[92:95], v[108:111]
    ds_read_b128 v[84:87], v11 offset:12288
    v_mfma_f32_16x16x32_bf16 v[112:115], a[16:19], v[96:99], v[112:115]
    ds_read_b128 v[88:91], v11 offset:14336
    v_mfma_f32_16x16x32_bf16 v[116:119], a[96:99], v[92:95], v[116:119]
    v_mfma_f32_16x16x32_bf16 v[120:123], a[96:99], v[96:99], v[120:123]
    s_waitcnt lgkmcnt(2)
    v_mfma_f32_16x16x32_bf16 v[108:111], a[20:23], v[100:103], v[108:111]
    ds_read_b128 v[92:95], v12 offset:12288
    v_mfma_f32_16x16x32_bf16 v[112:115], a[20:23], v[104:107], v[112:115]
    ds_read_b128 v[96:99], v12 offset:14336
    v_mfma_f32_16x16x32_bf16 v[116:119], a[100:103], v[100:103], v[116:119]
    s_waitcnt vmcnt(4)
    s_cmp_lt_i32 s60, -245760
    s_cbranch_scc1 L_fw_91c
L_fw_91:
    buffer_store_dwordx4 v[148:151], v143, s[4:7], s53 offen offset:0 sc1
    buffer_store_dwordx4 v[152:155], v143, s[4:7], s53 offen offset:1024 sc1
    v_mfma_f32_16x16x32_bf16 v[120:123], a[100:103], v[104:107], v[120:123]
    s_waitcnt lgkmcnt(2)
    v_mfma_f32_16x16x32_bf16 v[108:111], a[24:27], v[84:87], v[108:111]
    ds_read_b128 v[100:103], v11 offset:16384
    v_mfma_f32_16x16x32_bf16 v[112:115], a[24:27], v[88:91], v[112:115]
    ds_read_b128 v[104:107], v11 offset:18432
    v_mfma_f32_16x16x32_bf16 v[116:119], a[104:107], v[84:87], v[116:119]
    v_mfma_f32_16x16x32_bf16 v[120:123], a[104:107], v[88:91], v[120:123]
    s_waitcnt lgkmcnt(2)
    v_mfma_f32_16x16x32_bf16 v[108:111], a[28:31], v[92:95], v[108:111]
    ds_read_b128 v[84:87], v12 offset:16384
    v_mfma_f32_16x16x32_bf16 v[112:115], a[28:31], v[96:99], v[112:115]
    ds_read_b128 v[88:91], v12 offset:18432
    v_mfma_f32_16x16x32_bf16 v[116:119], a[108:111], v[92:95], v[116:119]
    buffer_store_dword v22, v135, s[4:7], s42 offen offset:0 sc1
    buffer_store_dword v22, v135, s[4:7], s42 offen offset:1024 sc1
    v_mfma_f32_16x16x32_bf16 v[120:123], a[108:111], v[96:99], v[120:123]
    s_waitcnt lgkmcnt(2)
    v_mfma_f32_16x16x32_bf16 v[108:111], a[32:35], v[100:103], v[108:111]
    ds_read_b128 v[92:95], v11 offset:20480
    v_mfma_f32_16x16x32_bf16 v[112:115], a[32:35], v[104:107], v[112:115]
    ds_read_b128 v[96:99], v11 offset:22528
    v_mfma_f32_16x16x32_bf16 v[116:119], a[112:115], v[100:103], v[116:119]
    buffer_load_dwordx4 v10, s[24:27], s46 offen offset:0 lds
    s_add_u32 m0, m0, 3968
    v_mfma_f32_16x16x32_bf16 v[120:123], a[112:115], v[104:107], v[120:123]
    s_waitcnt lgkmcnt(2)
    v_mfma_f32_16x16x32_bf16 v[108:111], a[36:39], v[84:87], v[108:111]
    ds_read_b128 v[100:103], v12 offset:20480
    v_mfma_f32_16x16x32_bf16 v[112:115], a[36:39], v[88:91], v[112:115]
    ds_read_b128 v[104:107], v12 offset:22528
    v_mfma_f32_16x16x32_bf16 v[116:119], a[116:119], v[84:87], v[116:119]
    buffer_load_dwordx4 v10, s[24:27], s46 offen offset:128 lds
    s_add_u32 m0, m0, 3968
    v_mfma_f32_16x16x32_bf16 v[120:123], a[116:119], v[88:91], v[120:123]
    s_waitcnt lgkmcnt(2)
    v_mfma_f32_16x16x32_bf16 v[108:111], a[40:43], v[92:95], v[108:111]
    ds_read_b128 v[84:87], v11 offset:24576
    v_mfma_f32_16x16x32_bf16 v[112:115], a[40:43], v[96:99], v[112:115]
    ds_read_b128 v[88:91], v11 offset:26624
    v_mfma_f32_16x16x32_bf16 v[116:119], a[120:123], v[92:95], v[116:119]
    buffer_load_dwordx4 v10, s[24:27], s46 offen offset:256 lds
    s_add_u32 m0, m0, 3968
    v_mfma_f32_16x16x32_bf16 v[120:123], a[120:123], v[96:99], v[120:123]
    s_waitcnt lgkmcnt(2)
    v_mfma_f32_16x16x32_bf16 v[108:111], a[44:47], v[100:103], v[108:111]
    ds_read_b128 v[92:95], v12 offset:24576
    v_mfma_f32_16x16x32_bf16 v[112:115], a[44:47], v[104:107], v[112:115]
    ds_read_b128 v[96:99], v12 offset:26624
    v_mfma_f32_16x16x32_bf16 v[116:119], a[124:127], v[100:103], v[116:119]
    buffer_load_dwordx4 v10, s[24:27], s46 offen offset:384 lds
    s_add_u32 m0, m0, 3968
    v_mfma_f32_16x16x32_bf16 v[120:123], a[124:127], v[104:107], v[120:123]
    s_waitcnt lgkmcnt(2)
    v_mfma_f32_16x16x32_bf16 v[108:111], a[48:51], v[84:87], v[108:111]
    ds_read_b128 v[100:103], v11 offset:28672
    v_mfma_f32_16x16x32_bf16 v[112:115], a[48:51], v[88:91], v[112:115]
    ds_read_b128 v[104:107], v11 offset:30720
    v_mfma_f32_16x16x32_bf16 v[116:119], a[128:131], v[84:87], v[116:119]
    buffer_load_dwordx4 v10, s[24:27], s46 offen offset:512 lds
    s_add_u32 m0, m0, 3968
    v_mfma_f32_16x16x32_bf16 v[120:123], a[128:131], v[88:91], v[120:123]
    s_waitcnt lgkmcnt(2)
    v_mfma_f32_16x16x32_bf16 v[108:111], a[52:55], v[92:95], v[108:111]
    ds_read_b128 v[84:87], v12 offset:28672
    v_mfma_f32_16x16x32_bf16 v[112:115], a[52:55], v[96:99], v[112:115]
    ds_read_b128 v[88:91], v12 offset:30720
    v_mfma_f32_16x16x32_bf16 v[116:119], a[132:135], v[92:95], v[116:119]
    buffer_load_dwordx4 v10, s[24:27], s46 offen offset:640 lds
    s_add_u32 m0, m0, 3968
    v_mfma_f32_16x16x32_bf16 v[120:123], a[132:135], v[96:99], v[120:123]
    s_waitcnt lgkmcnt(2)
    v_mfma_f32_16x16x32_bf16 v[108:111], a[56:59], v[100:103], v[108:111]
    ds_read_b128 v[92:95], v11 offset:32768
    v_mfma_f32_16x16x32_bf16 v[112:115], a[56:59], v[104:107], v[112:115]
    ds_read_b128 v[96:99], v11 offset:34816
    v_mfma_f32_16x16x32_bf16 v[116:119], a[136:139], v[100:103], v[116:119]
    buffer_load_dwordx4 v10, s[24:27], s46 offen offset:768 lds
    s_add_u32 m0, m0, 3968
    v_mfma_f32_16x16x32_bf16 v[120:123], a[136:139], v[104:107], v[120:123]
    s_waitcnt lgkmcnt(2)
    v_mfma_f32_16x16x32_bf16 v[108:111], a[60:63], v[84:87], v[108:111]
    ds_read_b128 v[100:103], v12 offset:32768
    v_mfma_f32_16x16x32_bf16 v[112:115], a[60:63], v[88:91], v[112:115]
    ds_read_b128 v[104:107], v12 offset:34816
    v_mfma_f32_16x16x32_bf16 v[116:119], a[140:143], v[84:87], v[116:119]
    buffer_load_dwordx4 v10, s[24:27], s46 offen offset:896 lds
    s_add_u32 m0, m0, 3968
    v_mfma_f32_16x16x32_bf16 v[120:123], a[140:143], v[88:91], v[120:123]
    s_waitcnt lgkmcnt(2)
    v_mfma_f32_16x16x32_bf16 v[108:111], a[64:67], v[92:95], v[108:111]
    ds_read_b128 v[84:87], v11 offset:36864
    v_mfma_f32_16x16x32_bf16 v[112:115], a[64:67], v[96:99], v[112:115]
    ds_read_b128 v[88:91], v11 offset:38912
    v_mfma_f32_16x16x32_bf16 v[116:119], a[144:147], v[92:95], v[116:119]
    buffer_load_dwordx4 v10, s[24:27], s46 offen offset:1024 lds
    s_add_u32 m0, m0, 3968
    v_mfma_f32_16x16x32_bf16 v[120:123], a[144:147], v[96:99], v[120:123]
    s_waitcnt lgkmcnt(2)
    v_mfma_f32_16x16x32_bf16 v[108:111], a[68:71], v[100:103], v[108:111]
    ds_read_b128 v[92:95], v12 offset:36864
    v_mfma_f32_16x16x32_bf16 v[112:115], a[68:71], v[104:107], v[112:115]
    ds_read_b128 v[96:99], v12 offset:38912
    v_mfma_f32_16x16x32_bf16 v[116:119], a[148:151], v[100:103], v[116:119]
    buffer_load_dwordx4 v10, s[24:27], s46 offen offset:1152 lds
    v_mfma_f32_16x16x32_bf16 v[120:123], a[148:151], v[104:107], v[120:123]
    s_waitcnt lgkmcnt(0)
    v_mfma_f32_16x16x32_bf16 v[108:111], a[72:75], v[84:87], v[108:111]
    v_add_u32 v11, s49, v11
    v_mfma_f32_16x16x32_bf16 v[112:115], a[72:75], v[88:91], v[112:115]
    v_add_u32 v12, s49, v12
    v_mfma_f32_16x16x32_bf16 v[108:111], a[76:79], v[92:95], v[108:111]
    s_sub_u32 s47, s47, s49
    v_mfma_f32_16x16x32_bf16 v[112:115], a[76:79], v[96:99], v[112:115]
    s_sub_u32 s49, 0, s49
    v_mfma_f32_16x16x32_bf16 v[116:119], a[152:155], v[84:87], v[116:119]
    v_mfma_f32_16x16x32_bf16 v[120:123], a[152:155], v[88:91], v[120:123]
    v_mfma_f32_16x16x32_bf16 v[116:119], a[156:159], v[92:95], v[116:119]
    v_mfma_f32_16x16x32_bf16 v[120:123], a[156:159], v[96:99], v[120:123]
    v_cvt_pk_bf16_f32 v124, v108, v109
    v_cvt_pk_bf16_f32 v125, v110, v111
    v_cvt_pk_bf16_f32 v126, v112, v113
    v_cvt_pk_bf16_f32 v127, v114, v115
    s_nop 0
    v_permlane16_swap_b32 v124, v126
    v_permlane16_swap_b32 v125, v127
    v_cvt_pk_bf16_f32 v128, v116, v117
    v_cvt_pk_bf16_f32 v129, v118, v119
    v_cvt_pk_bf16_f32 v130, v120, v121
    v_cvt_pk_bf16_f32 v131, v122, v123
    s_nop 0
    v_permlane16_swap_b32 v128, v130
    v_permlane16_swap_b32 v129, v131
    buffer_store_dwordx4 v[124:127], v19, s[4:7], s44 offen sc1
    buffer_store_dwordx4 v[128:131], v19, s[4:7], s45 offen sc1
    s_waitcnt vmcnt(18)
    s_cmp_lt_i32 s60, 0
    s_cbranch_scc1 L_fin_92
    v_mfma_f32_16x16x32_bf16 v[164:167], a[160:163], v[156:159], 0
    v_mfma_f32_16x16x32_bf16 v[168:171], a[160:163], v[160:163], 0
    s_nop 4
    v_cndmask_b32 v166, v164, v165, s[58:59]
    s_nop 1
    v_cndmask_b32 v170, v168, v169, s[58:59]
    v_cndmask_b32 v167, v165, v164, s[58:59]
    v_cndmask_b32 v171, v169, v168, s[58:59]
    s_nop 0
    v_add_f32_dpp v167, v166, v167 row_ror:8 row_mask:0xf bank_mask:0xf
    v_add_f32_dpp v171, v170, v171 row_ror:8 row_mask:0xf bank_mask:0xf
    v_cvt_pk_bf16_f32 v167, v167, v167
    v_cvt_pk_bf16_f32 v171, v171, v171
    buffer_store_short v167, v145, s[28:31], s60 offen offset:0
    buffer_store_short v171, v145, s[28:31], s60 offen offset:32
L_fin_92:
    s_branch L_v_loop_s
L_end_88:
    s_cmp_lt_i32 s60, 0
    s_cselect_b32 s54, s38, s54
    buffer_load_dwordx4 v[156:159], v144, s[4:7], s54 offen offset:0 sc1
    buffer_load_dwordx4 v[160:163], v144, s[4:7], s54 offen offset:1024 sc1
    s_waitcnt vmcnt(0) lgkmcnt(0)
    s_cmp_lt_i32 s60, 0
    s_cbranch_scc1 L_fin_93
    v_mfma_f32_16x16x32_bf16 v[164:167], a[160:163], v[156:159], 0
    v_mfma_f32_16x16x32_bf16 v[168:171], a[160:163], v[160:163], 0
    s_nop 4
    v_cndmask_b32 v166, v164, v165, s[58:59]
    s_nop 1
    v_cndmask_b32 v170, v168, v169, s[58:59]
    v_cndmask_b32 v167, v165, v164, s[58:59]
    v_cndmask_b32 v171, v169, v168, s[58:59]
    s_nop 0
    v_add_f32_dpp v167, v166, v167 row_ror:8 row_mask:0xf bank_mask:0xf
    v_add_f32_dpp v171, v170, v171 row_ror:8 row_mask:0xf bank_mask:0xf
    v_cvt_pk_bf16_f32 v167, v167, v167
    v_cvt_pk_bf16_f32 v171, v171, v171
    buffer_store_short v167, v145, s[28:31], s60 offen offset:0
    buffer_store_short v171, v145, s[28:31], s60 offen offset:32
L_fin_93:
    s_waitcnt vmcnt(0)
    s_endpgm
L_nan_86:
    s_cmp_eq_u32 s52, 1
    s_cbranch_scc1 L_cont_87
    v_lshlrev_b32 v1, 4, v0
L_nan_86r:
    s_mov_b32 s90, s41
    v_mov_b32 v2, 0
    buffer_load_dwordx4 v[28:31], v1, s[4:7], s90 offen sc1
    s_add_u32 s90, s90, 1024
    buffer_load_dwordx4 v[32:35], v1, s[4:7], s90 offen sc1
    s_add_u32 s90, s90, 1024
    buffer_load_dwordx4 v[36:39], v1, s[4:7], s90 offen sc1
    s_add_u32 s90, s90, 1024
    buffer_load_dwordx4 v[40:43], v1, s[4:7], s90 offen sc1
    s_add_u32 s90, s90, 1024
    buffer_load_dwordx4 v[44:47], v1, s[4:7], s90 offen sc1
    s_add_u32 s90, s90, 1024
    buffer_load_dwordx4 v[48:51], v1, s[4:7], s90 offen sc1
    s_add_u32 s90, s90, 1024
    buffer_load_dwordx4 v[52:55], v1, s[4:7], s90 offen sc1
    s_add_u32 s90, s90, 1024
    buffer_load_dwordx4 v[56:59], v1, s[4:7], s90 offen sc1
    s_add_u32 s90, s90, 1024
    buffer_load_dwordx4 v[60:63], v1, s[4:7], s90 offen sc1
    s_add_u32 s90, s90, 1024
    buffer_load_dwordx4 v[64:67], v1, s[4:7], s90 offen sc1
    s_add_u32 s90, s90, 1024
    s_sub_u32 s36, s36, 1
    s_cbranch_scc1 L_exit
    s_waitcnt vmcnt(0) lgkmcnt(0)
    v_max3_u32 v2, v2, v28, v29
    v_max3_u32 v2, v2, v30, v31
    v_max3_u32 v2, v2, v32, v33
    v_max3_u32 v2, v2, v34, v35
    v_max3_u32 v2, v2, v36, v37
    v_max3_u32 v2, v2, v38, v39
    v_max3_u32 v2, v2, v40, v41
    v_max3_u32 v2, v2, v42, v43
    v_max3_u32 v2, v2, v44, v45
    v_max3_u32 v2, v2, v46, v47
    v_max3_u32 v2, v2, v48, v49
    v_max3_u32 v2, v2, v50, v51
    v_max3_u32 v2, v2, v52, v53
    v_max3_u32 v2, v2, v54, v55
    v_max3_u32 v2, v2, v56, v57
    v_max3_u32 v2, v2, v58, v59
    v_max3_u32 v2, v2, v60, v61
    v_max3_u32 v2, v2, v62, v63
    v_max3_u32 v2, v2, v64, v65
    v_max3_u32 v2, v2, v66, v67
    v_cmp_eq_u32 vcc, -1, v2
    s_cbranch_vccnz L_nan_86r
    s_mov_b32 s52, 1
    v_mov_b32 v68, 0
    v_mov_b32 v69, 0
    v_mov_b32 v70, 0
    v_mov_b32 v71, 0
    v_mov_b32 v72, 0
    v_mov_b32 v73, 0
    v_mov_b32 v74, 0
    v_mov_b32 v75, 0
    v_smfmac_f32_16x16x64_bf16 v[68:71], v[28:31], a[0:7], v17
    s_nop 0
    v_smfmac_f32_16x16x64_bf16 v[72:75], v[28:31], a[80:87], v17
    v_smfmac_f32_16x16x64_bf16 v[68:71], v[32:35], a[8:15], v17
    v_smfmac_f32_16x16x64_bf16 v[72:75], v[32:35], a[88:95], v17
    v_smfmac_f32_16x16x64_bf16 v[68:71], v[36:39], a[16:23], v17
    v_smfmac_f32_16x16x64_bf16 v[72:75], v[36:39], a[96:103], v17
    v_smfmac_f32_16x16x64_bf16 v[68:71], v[40:43], a[24:31], v17
    v_smfmac_f32_16x16x64_bf16 v[72:75], v[40:43], a[104:111], v17
    v_smfmac_f32_16x16x64_bf16 v[68:71], v[44:47], a[32:39], v17
    v_smfmac_f32_16x16x64_bf16 v[72:75], v[44:47], a[112:119], v17
    v_smfmac_f32_16x16x64_bf16 v[68:71], v[48:51], a[40:47], v17
    v_smfmac_f32_16x16x64_bf16 v[68:71], v[52:55], a[48:55], v17
    v_smfmac_f32_16x16x64_bf16 v[68:71], v[56:59], a[56:63], v17
    v_smfmac_f32_16x16x64_bf16 v[68:71], v[60:63], a[64:71], v17
    v_smfmac_f32_16x16x64_bf16 v[68:71], v[64:67], a[72:79], v17
    s_nop 2
    s_branch L_redo_84
L_wo_s:
    s_mov_b32 s12, s80
    s_and_b32 s13, s81, 0xffff
    s_mov_b32 s14, 7864320
    s_mov_b32 s15, 0x20000
    s_mov_b32 s16, s72
    s_and_b32 s17, s73, 0xffff
    s_mov_b32 s18, 10240
    s_mov_b32 s19, 0x20000
    s_sub_u32 s40, s35, 18
    v_and_b32 v1, 15, v0
    v_lshrrev_b32 v2, 4, v0
    v_lshrrev_b32 v3, 3, v0
    v_and_b32 v4, 7, v0
    v_and_b32 v6, 2, v3
    v_xor_b32 v6, v6, v4
    v_lshlrev_b32 v6, 4, v6
    v_mul_u32_u24 v7, 1280, v3
    s_lshl_b32 s90, s34, 2
    s_add_u32 s90, s90, s32
    s_mul_i32 s90, s90, 245760
    s_lshl_b32 s91, s40, 7
    s_add_u32 s90, s90, s91
    v_add3_u32 v180, v6, v7, s90
    v_xor_b32 v181, 64, v180
    s_mul_i32 s90, s40, 32768
    s_lshl_b32 s91, s32, 11
    s_add_u32 s90, s90, s91
    s_lshl_b32 s91, s34, 8
    s_add_u32 s90, s90, s91
    v_and_b32 v7, 7, v1
    v_lshlrev_b32 v7, 3, v7
    v_lshl_add_u32 v7, v2, 6, v7
    v_lshrrev_b32 v6, 3, v1
    v_lshl_add_u32 v7, v6, 13, v7
    v_add_u32 v14, s90, v7
    v_lshlrev_b32 v6, 4, v1
    v_lshlrev_b32 v12, 4, v0
    v_lshlrev_b32 v13, 2, v0
    v_add_u32 v46, s90, v13
    s_lshl_b32 s92, s40, 7
    s_lshl_b32 s93, s32, 2
    s_add_u32 s92, s92, s93
    s_add_u32 s92, s92, 460800
    v_mov_b32 v244, s92
    v_cmp_eq_u32 vcc, 0, v0
    v_mov_b32 v9, 2146435072
    s_nop 0
    v_cndmask_b32 v244, v9, v244, vcc
    s_lshl_b32 s92, s40, 4
    s_add_u32 s92, s92, s93
    s_add_u32 s92, s92, 460544
    v_mov_b32 v45, s92
    v_cndmask_b32 v45, v9, v45, vcc
    s_lshl_b32 s92, s32, 7
    s_add_u32 s92, s92, 462336
    v_min_u32 v3, 5, v0
    v_lshl_add_u32 v245, v3, 2, s92
    s_lshl_b32 s90, s40, 2
    s_add_u32 s90, s90, s32
    s_lshl_b32 s91, s90, 8
    v_add_u32 v17, s91, v6
    v_cmp_eq_u32 vcc, 0, v2
    v_mov_b32 v9, 2146435072
    s_nop 0
    v_cndmask_b32 v17, v9, v17, vcc
    v_lshrrev_b32 v3, 2, v1
    v_and_b32 v7, 1, v1
    v_lshl_or_b32 v4, v3, 1, v7
    v_mul_u32_u24 v4, 1280, v4
    v_and_b32 v5, 2, v1
    v_lshl_add_u32 v4, v5, 1, v4
    s_lshl_b32 s91, s90, 5
    v_add_u32 v4, s91, v4
    v_lshlrev_b32 v6, 6, v3
    v_lshl_add_u32 v6, v7, 5, v6
    v_lshl_add_u32 v6, v2, 3, v6
    v_lshl_add_u32 v6, v5, 1, v6
    s_mul_i32 s92, s32, 1152
    s_add_u32 s92, s92, 122880
    v_add_u32 v18, s92, v6
    buffer_load_dword v164, v4, s[16:19], 0 offen offset:0
    buffer_load_dword v165, v4, s[16:19], 0 offen offset:8
    buffer_load_dword v166, v4, s[16:19], 0 offen offset:16
    buffer_load_dword v167, v4, s[16:19], 0 offen offset:24
    v_mov_b32 v168, -1
    v_mov_b32 v169, -1
    v_mov_b32 v170, -1
    v_mov_b32 v171, -1
    s_mul_i32 s90, s32, 24576
    s_mov_b32 m0, s90
    s_mov_b32 s91, 0
    buffer_load_dwordx4 v180, s[12:15], s91 offen nt lds
    s_add_u32 m0, m0, 1024
    s_add_u32 s91, s91, 10240
    buffer_load_dwordx4 v181, s[12:15], s91 offen nt lds
    s_add_u32 m0, m0, 1024
    s_add_u32 s91, s91, 10240
    buffer_load_dwordx4 v180, s[12:15], s91 offen nt lds
    s_add_u32 m0, m0, 1024
    s_add_u32 s91, s91, 10240
    buffer_load_dwordx4 v181, s[12:15], s91 offen nt lds
    s_add_u32 m0, m0, 1024
    s_add_u32 s91, s91, 10240
    buffer_load_dwordx4 v180, s[12:15], s91 offen nt lds
    s_add_u32 m0, m0, 1024
    s_add_u32 s91, s91, 10240
    buffer_load_dwordx4 v181, s[12:15], s91 offen nt lds
    s_add_u32 m0, m0, 1024
    s_add_u32 s91, s91, 10240
    buffer_load_dwordx4 v180, s[12:15], s91 offen nt lds
    s_add_u32 m0, m0, 1024
    s_add_u32 s91, s91, 10240
    buffer_load_dwordx4 v181, s[12:15], s91 offen nt lds
    s_add_u32 m0, m0, 1024
    s_add_u32 s91, s91, 10240
    buffer_load_dwordx4 v180, s[12:15], s91 offen nt lds
    s_add_u32 m0, m0, 1024
    s_add_u32 s91, s91, 10240
    buffer_load_dwordx4 v181, s[12:15], s91 offen nt lds
    s_add_u32 m0, m0, 1024
    s_add_u32 s91, s91, 10240
    buffer_load_dwordx4 v180, s[12:15], s91 offen nt lds
    s_add_u32 m0, m0, 1024
    s_add_u32 s91, s91, 10240
    buffer_load_dwordx4 v181, s[12:15], s91 offen nt lds
    s_add_u32 m0, m0, 1024
    s_add_u32 s91, s91, 10240
    buffer_load_dwordx4 v180, s[12:15], s91 offen nt lds
    s_add_u32 m0, m0, 1024
    s_add_u32 s91, s91, 10240
    buffer_load_dwordx4 v181, s[12:15], s91 offen nt lds
    s_add_u32 m0, m0, 1024
    s_add_u32 s91, s91, 10240
    buffer_load_dwordx4 v180, s[12:15], s91 offen nt lds
    s_add_u32 m0, m0, 1024
    s_add_u32 s91, s91, 10240
    buffer_load_dwordx4 v181, s[12:15], s91 offen nt lds
    s_add_u32 m0, m0, 1024
    s_add_u32 s91, s91, 10240
    buffer_load_dwordx4 v180, s[12:15], s91 offen nt lds
    s_add_u32 m0, m0, 1024
    s_add_u32 s91, s91, 10240
    buffer_load_dwordx4 v181, s[12:15], s91 offen nt lds
    s_add_u32 m0, m0, 1024
    s_add_u32 s91, s91, 10240
    buffer_load_dwordx4 v180, s[12:15], s91 offen nt lds
    s_add_u32 m0, m0, 1024
    s_add_u32 s91, s91, 10240
    buffer_load_dwordx4 v181, s[12:15], s91 offen nt lds
    s_add_u32 m0, m0, 1024
    s_add_u32 s91, s91, 10240
    buffer_load_dwordx4 v180, s[12:15], s91 offen nt lds
    s_add_u32 m0, m0, 1024
    s_add_u32 s91, s91, 10240
    buffer_load_dwordx4 v181, s[12:15], s91 offen nt lds
    s_add_u32 m0, m0, 1024
    s_add_u32 s91, s91, 10240
    buffer_load_dwordx4 v180, s[12:15], s91 offen nt lds
    s_add_u32 m0, m0, 1024
    s_add_u32 s91, s91, 10240
    buffer_load_dwordx4 v181, s[12:15], s91 offen nt lds
    s_waitcnt vmcnt(24)
    v_min_u32 v164, -2, v164
    v_min_u32 v165, -2, v165
    v_min_u32 v166, -2, v166
    v_min_u32 v167, -2, v167
    v_and_b32 v7, 2, v1
    v_cmp_ne_u32 vcc, 0, v7
    v_mov_b32 v5, 0x4444
    v_mov_b32 v6, 0xeeee
    v_cndmask_b32 v10, v5, v6, vcc
    v_mov_b32 v5, 0xe484
    v_mov_b32 v6, 0xee9e
    v_cndmask_b32 v7, v5, v6, vcc
    v_mov_b32 v5, 0x84e4
    v_mov_b32 v6, 0x9eee
    v_cndmask_b32 v8, v5, v6, vcc
    v_cmp_gt_u32 vcc, 2, v2
    s_nop 1
    v_cndmask_b32 v11, v8, v7, vcc
    v_mov_b32 v84, 1065369472
    v_mov_b32 v85, 1065369472
    v_mov_b32 v86, 1065369472
    v_mov_b32 v87, 0
    v_mov_b32 v88, 1065369472
    v_mov_b32 v89, 1065369472
    v_mov_b32 v90, 1065369472
    v_mov_b32 v91, 0
    v_mov_b32 v51, 0
    v_mov_b32 v55, 0
    v_mov_b32 v59, 0
    v_mov_b32 v63, 0
    v_mov_b32 v67, 0
    v_mov_b32 v71, 0
    v_mov_b32 v75, 0
    v_mov_b32 v79, 0
    v_mov_b32 v210, 0
    v_mov_b32 v211, 0
    v_mov_b32 v218, 0
    v_mov_b32 v219, 0
    v_lshrrev_b32 v8, 1, v1
    v_and_b32 v7, 2, v8
    v_cmp_ne_u32 vcc, 0, v7
    v_mov_b32 v5, 0x3f80
    v_mov_b32 v6, 0x3f800000
    v_cndmask_b32 v5, v5, v6, vcc
    v_bfe_u32 v6, v8, 2, 1
    v_and_b32 v7, 1, v8
    v_lshl_or_b32 v6, v7, 1, v6
    v_cmp_eq_u32 vcc, 0, v6
    s_nop 1
    v_cndmask_b32 v108, 0, v5, vcc
    v_cmp_eq_u32 vcc, 1, v6
    s_nop 1
    v_cndmask_b32 v109, 0, v5, vcc
    v_cmp_eq_u32 vcc, 2, v6
    s_nop 1
    v_cndmask_b32 v110, 0, v5, vcc
    v_cmp_eq_u32 vcc, 3, v6
    s_nop 1
    v_cndmask_b32 v111, 0, v5, vcc
    s_mov_b32 s60, 0xaaaaaaaa
    s_mov_b32 s61, 0xaaaaaaaa
    v_add_u32 v14, 8192, v46
    v_mov_b32 v240, 0x3dd53b95
    v_mov_b32 v241, 0x3dd53b95
    s_lshl_b32 s90, s32, 8
    s_add_u32 s90, s90, 122880
    v_mul_u32_u24 v6, 1152, v2
    v_lshl_add_u32 v6, v1, 3, v6
    v_add_u32 v19, s90, v6
    s_mul_i32 s90, s32, 1536
    v_add_u32 v20, s90, v12
    s_add_u32 s90, s90, 1024
    v_lshl_add_u32 v21, v0, 3, s90
    s_mul_i32 s90, s32, 6144
    v_add_u32 v22, s90, v12
    s_add_u32 s90, s90, 1024
    v_lshl_add_u32 v23, v0, 3, s90
    v_add_u32 v28, 98304, v12
    s_mul_i32 s90, s32, 3072
    v_add_u32 v37, s90, v12
    v_add_u32 v44, 25600, v37
    s_add_u32 s54, s90, 98304
    s_mul_i32 s90, s32, 3840
    s_add_u32 s90, s90, 10240
    v_add_u32 v38, s90, v12
    s_add_u32 s90, s90, 1024
    v_add_u32 v39, s90, v13
    s_mul_i32 s90, s32, 12288
    v_add_u32 v40, s90, v12
    s_lshl_b32 s93, s40, 2
    s_add_u32 s93, s93, s32
    s_nop 0
    s_lshr_b32 s90, s93, 2
    s_lshl_b32 s90, s90, 15
    s_and_b32 s92, s93, 3
    s_lshl_b32 s92, s92, 10
    s_add_u32 s90, s90, s92
    v_mov_b32 v5, s34
    v_and_b32 v6, 7, v1
    v_lshlrev_b32 v6, 4, v6
    v_lshl_add_u32 v6, v5, 7, v6
    v_lshrrev_b32 v7, 3, v1
    v_lshl_add_u32 v6, v7, 12, v6
    v_lshrrev_b32 v5, 1, v2
    v_lshl_add_u32 v6, v5, 13, v6
    v_and_b32 v5, 1, v2
    v_lshl_add_u32 v6, v5, 14, v6
    v_add_u32 v30, s90, v6
    s_and_b32 s91, s34, 1
    s_lshl_b32 s91, s91, 12
    s_add_u32 s90, s90, s91
    s_lshr_b32 s91, s34, 2
    s_lshl_b32 s91, s91, 13
    s_add_u32 s90, s90, s91
    s_and_b32 s91, s34, 2
    s_lshl_b32 s91, s91, 13
    s_add_u32 s90, s90, s91
    v_lshl_add_u32 v31, v0, 4, s90
    s_lshl_b32 s91, s93, 10
    s_add_u32 s91, s91, 884736
    v_lshl_add_u32 v15, v0, 4, s91
    s_lshr_b32 s91, s34, 1
    s_mul_i32 s91, s91, 10240
    s_lshl_b32 s92, s93, 5
    s_add_u32 s91, s91, s92
    s_and_b32 s92, s34, 1
    s_mul_i32 s92, s92, 40960
    s_add_u32 s91, s91, s92
    s_add_u32 s91, s91, 1280
    v_mul_u32_u24 v6, 2560, v2
    v_lshl_add_u32 v6, v1, 1, v6
    v_add_u32 v32, s91, v6
    v_cmp_gt_u32 s[58:59], 8, v1
    v_and_b32 v5, 1, v1
    v_lshrrev_b32 v6, 3, v1
    v_lshl_add_u32 v5, v5, 1, v6
    v_bfe_u32 v6, v1, 2, 1
    v_cmp_ne_u32 vcc, 0, v6
    v_mov_b32 v6, 0x3f80
    v_mov_b32 v7, 0x3f800000
    v_cndmask_b32 v6, v6, v7, vcc
    v_cmp_eq_u32 vcc, 0, v5
    s_nop 1
    v_cndmask_b32 v7, 0, v6, vcc
    v_accvgpr_write_b32 a144, v7
    v_cmp_eq_u32 vcc, 1, v5
    s_nop 1
    v_cndmask_b32 v7, 0, v6, vcc
    v_accvgpr_write_b32 a145, v7
    v_cmp_eq_u32 vcc, 2, v5
    s_nop 1
    v_cndmask_b32 v7, 0, v6, vcc
    v_accvgpr_write_b32 a146, v7
    v_cmp_eq_u32 vcc, 3, v5
    s_nop 1
    v_cndmask_b32 v7, 0, v6, vcc
    v_accvgpr_write_b32 a147, v7
    s_lshl_b32 s90, s32, 7
    v_add_u32 v5, s90, v13
    v_add_u32 v6, 458752, v5
    v_add_u32 v7, 459728, v5
    v_cmp_gt_u32 vcc, 12, v0
    s_nop 1
    v_cndmask_b32 v33, v7, v6, vcc
    v_mov_b32 v5, -2
    v_cndmask_b32 v34, v5, 3, vcc
    v_cmp_gt_u32 vcc, 14, v0
    v_mov_b32 v9, 2146435072
    s_nop 0
    v_cndmask_b32 v33, v9, v33, vcc
    v_mov_b32 v5, -1000
    v_cndmask_b32 v34, v5, v34, vcc
    v_and_b32 v4, 3, v1
    v_lshlrev_b32 v6, 6, v4
    v_lshl_add_u32 v6, v3, 3, v6
    v_lshl_add_u32 v6, v2, 8, v6
    v_and_b32 v5, 1, v2
    v_lshl_add_u32 v6, v5, 5, v6
    s_mul_i32 s90, s32, 3072
    s_add_u32 s53, s90, 131072
    v_add_u32 v16, s53, v6
    v_xor_b32 v13, 32, v16
    v_and_b32 v4, 3, v1
    v_and_b32 v5, 1, v2
    v_lshl_add_u32 v6, v2, 3, v3
    v_lshlrev_b32 v6, 7, v6
    v_and_b32 v7, 2, v3
    v_lshl_or_b32 v7, v5, 2, v7
    v_lshrrev_b32 v8, 1, v4
    v_xor_b32 v7, v7, v8
    v_lshl_add_u32 v6, v7, 4, v6
    v_and_b32 v7, 1, v4
    v_lshl_add_u32 v6, v7, 3, v6
    s_mul_i32 s90, s32, 24576
    v_add_u32 v6, s90, v6
    v_xor_b32 v182, 0, v6
    v_xor_b32 v183, 32, v6
    v_xor_b32 v184, 64, v6
    v_xor_b32 v185, 96, v6
    s_waitcnt vmcnt(0)
    ds_read_b64_tr_b16 a[0:1], v182 offset:0
    ds_read_b64_tr_b16 a[2:3], v182 offset:512
    ds_read_b64_tr_b16 a[4:5], v182 offset:4096
    ds_read_b64_tr_b16 a[6:7], v182 offset:4608
    ds_read_b64_tr_b16 a[8:9], v182 offset:8192
    ds_read_b64_tr_b16 a[10:11], v182 offset:8704
    ds_read_b64_tr_b16 a[12:13], v182 offset:12288
    ds_read_b64_tr_b16 a[14:15], v182 offset:12800
    ds_read_b64_tr_b16 a[16:17], v182 offset:16384
    ds_read_b64_tr_b16 a[18:19], v182 offset:16896
    ds_read_b64_tr_b16 a[20:21], v182 offset:20480
    ds_read_b64_tr_b16 a[22:23], v182 offset:20992
    ds_read_b64_tr_b16 a[24:25], v183 offset:0
    ds_read_b64_tr_b16 a[26:27], v183 offset:512
    ds_read_b64_tr_b16 a[28:29], v183 offset:4096
    ds_read_b64_tr_b16 a[30:31], v183 offset:4608
    ds_read_b64_tr_b16 a[32:33], v183 offset:8192
    ds_read_b64_tr_b16 a[34:35], v183 offset:8704
    ds_read_b64_tr_b16 a[36:37], v183 offset:12288
    ds_read_b64_tr_b16 a[38:39], v183 offset:12800
    ds_read_b64_tr_b16 a[40:41], v183 offset:16384
    ds_read_b64_tr_b16 a[42:43], v183 offset:16896
    ds_read_b64_tr_b16 a[44:45], v183 offset:20480
    ds_read_b64_tr_b16 a[46:47], v183 offset:20992
    ds_read_b64_tr_b16 a[48:49], v184 offset:0
    ds_read_b64_tr_b16 a[50:51], v184 offset:512
    ds_read_b64_tr_b16 a[52:53], v184 offset:4096
    ds_read_b64_tr_b16 a[54:55], v184 offset:4608
    ds_read_b64_tr_b16 a[56:57], v184 offset:8192
    ds_read_b64_tr_b16 a[58:59], v184 offset:8704
    ds_read_b64_tr_b16 a[60:61], v184 offset:12288
    ds_read_b64_tr_b16 a[62:63], v184 offset:12800
    ds_read_b64_tr_b16 a[64:65], v184 offset:16384
    ds_read_b64_tr_b16 a[66:67], v184 offset:16896
    ds_read_b64_tr_b16 a[68:69], v184 offset:20480
    ds_read_b64_tr_b16 a[70:71], v184 offset:20992
    ds_read_b64_tr_b16 a[72:73], v185 offset:0
    ds_read_b64_tr_b16 a[74:75], v185 offset:512
    ds_read_b64_tr_b16 a[76:77], v185 offset:4096
    ds_read_b64_tr_b16 a[78:79], v185 offset:4608
    ds_read_b64_tr_b16 a[80:81], v185 offset:8192
    ds_read_b64_tr_b16 a[82:83], v185 offset:8704
    ds_read_b64_tr_b16 a[84:85], v185 offset:12288
    ds_read_b64_tr_b16 a[86:87], v185 offset:12800
    ds_read_b64_tr_b16 a[88:89], v185 offset:16384
    ds_read_b64_tr_b16 a[90:91], v185 offset:16896
    ds_read_b64_tr_b16 a[92:93], v185 offset:20480
    ds_read_b64_tr_b16 a[94:95], v185 offset:20992
    s_waitcnt lgkmcnt(0)
    s_barrier
    v_mov_b32 v1, 196
L_gw_94:
    buffer_load_dword v2, v1, s[8:11], 0 offen sc1
    s_sub_u32 s36, s36, 1
    s_cbranch_scc1 L_exit
    s_waitcnt vmcnt(0)
L_gw_94c:
    v_readfirstlane_b32 s90, v2
    s_nop 0
    s_cmp_eq_u32 s90, 0
    s_cbranch_scc1 L_gw_94
    buffer_store_dwordx4 v[164:167], v17, s[4:7], s38 offen sc1
    s_mov_b32 s57, -1
    s_mov_b32 s37, -1
    v_add_u32 v35, -2, v34
    s_add_u32 s45, s38, 65536
    s_add_u32 s46, s45, 4096
    s_add_u32 s47, s45, 8192
    v_mov_b32 v24, v20
    v_mov_b32 v25, v21
    buffer_load_dword v36, v33, s[4:7], s38 offen sc1
    s_waitcnt vmcnt(0)
    v_cmp_lt_i32 vcc, v36, v35
    s_cbranch_vccz L_fok_96
L_fw_95:
    buffer_load_dword v36, v33, s[4:7], s38 offen sc1
    s_sub_u32 s36, s36, 1
    s_cbranch_scc1 L_exit
    s_waitcnt vmcnt(0)
    v_cmp_lt_i32 vcc, v36, v35
    s_cbranch_vccnz L_fw_95
L_fok_96:
    buffer_load_dwordx4 a[96:99], v40, s[4:7], s45 offen offset:0 sc1
    buffer_load_dwordx4 a[100:103], v40, s[4:7], s45 offen offset:1024 sc1
    buffer_load_dwordx4 a[104:107], v40, s[4:7], s45 offen offset:2048 sc1
    buffer_load_dwordx4 a[108:111], v40, s[4:7], s45 offen offset:3072 sc1
    buffer_load_dwordx4 a[112:115], v40, s[4:7], s46 offen offset:0 sc1
    buffer_load_dwordx4 a[116:119], v40, s[4:7], s46 offen offset:1024 sc1
    buffer_load_dwordx4 a[120:123], v40, s[4:7], s46 offen offset:2048 sc1
    buffer_load_dwordx4 a[124:127], v40, s[4:7], s46 offen offset:3072 sc1
    buffer_load_dwordx4 a[128:131], v40, s[4:7], s47 offen offset:0 sc1
    buffer_load_dwordx4 a[132:135], v40, s[4:7], s47 offen offset:1024 sc1
    buffer_load_dwordx4 a[136:139], v40, s[4:7], s47 offen offset:2048 sc1
    buffer_load_dwordx4 a[140:143], v40, s[4:7], s47 offen offset:3072 sc1
    s_waitcnt vmcnt(0)
    v_mfma_f32_16x16x32_bf16 v[148:151], a[96:99], a[0:3], 0
    v_mfma_f32_16x16x32_bf16 v[152:155], a[120:123], a[0:3], 0
    v_mfma_f32_16x16x32_bf16 v[156:159], a[96:99], a[24:27], 0
    v_mfma_f32_16x16x32_bf16 v[160:163], a[120:123], a[24:27], 0
    v_mfma_f32_16x16x32_bf16 v[180:183], a[96:99], a[48:51], 0
    v_mfma_f32_16x16x32_bf16 v[184:187], a[120:123], a[48:51], 0
    v_mfma_f32_16x16x32_bf16 v[188:191], a[96:99], a[72:75], 0
    v_mfma_f32_16x16x32_bf16 v[192:195], a[120:123], a[72:75], 0
    v_mfma_f32_16x16x32_bf16 v[148:151], a[100:103], a[4:7], v[148:151]
    v_mfma_f32_16x16x32_bf16 v[152:155], a[124:127], a[4:7], v[152:155]
    v_mfma_f32_16x16x32_bf16 v[156:159], a[100:103], a[28:31], v[156:159]
    v_mfma_f32_16x16x32_bf16 v[160:163], a[124:127], a[28:31], v[160:163]
    v_mfma_f32_16x16x32_bf16 v[180:183], a[100:103], a[52:55], v[180:183]
    v_mfma_f32_16x16x32_bf16 v[184:187], a[124:127], a[52:55], v[184:187]
    v_mfma_f32_16x16x32_bf16 v[188:191], a[100:103], a[76:79], v[188:191]
    v_mfma_f32_16x16x32_bf16 v[192:195], a[124:127], a[76:79], v[192:195]
    v_mfma_f32_16x16x32_bf16 v[148:151], a[104:107], a[8:11], v[148:151]
    v_mfma_f32_16x16x32_bf16 v[152:155], a[128:131], a[8:11], v[152:155]
    v_mfma_f32_16x16x32_bf16 v[156:159], a[104:107], a[32:35], v[156:159]
    v_mfma_f32_16x16x32_bf16 v[160:163], a[128:131], a[32:35], v[160:163]
    v_mfma_f32_16x16x32_bf16 v[180:183], a[104:107], a[56:59], v[180:183]
    v_mfma_f32_16x16x32_bf16 v[184:187], a[128:131], a[56:59], v[184:187]
    v_mfma_f32_16x16x32_bf16 v[188:191], a[104:107], a[80:83], v[188:191]
    v_mfma_f32_16x16x32_bf16 v[192:195], a[128:131], a[80:83], v[192:195]
    v_mfma_f32_16x16x32_bf16 v[148:151], a[108:111], a[12:15], v[148:151]
    v_mfma_f32_16x16x32_bf16 v[152:155], a[132:135], a[12:15], v[152:155]
    v_mfma_f32_16x16x32_bf16 v[156:159], a[108:111], a[36:39], v[156:159]
    v_mfma_f32_16x16x32_bf16 v[160:163], a[132:135], a[36:39], v[160:163]
    v_mfma_f32_16x16x32_bf16 v[180:183], a[108:111], a[60:63], v[180:183]
    v_mfma_f32_16x16x32_bf16 v[184:187], a[132:135], a[60:63], v[184:187]
    v_mfma_f32_16x16x32_bf16 v[188:191], a[108:111], a[84:87], v[188:191]
    v_mfma_f32_16x16x32_bf16 v[192:195], a[132:135], a[84:87], v[192:195]
    v_mfma_f32_16x16x32_bf16 v[148:151], a[112:115], a[16:19], v[148:151]
    v_mfma_f32_16x16x32_bf16 v[152:155], a[136:139], a[16:19], v[152:155]
    v_mfma_f32_16x16x32_bf16 v[156:159], a[112:115], a[40:43], v[156:159]
    v_mfma_f32_16x16x32_bf16 v[160:163], a[136:139], a[40:43], v[160:163]
    v_mfma_f32_16x16x32_bf16 v[180:183], a[112:115], a[64:67], v[180:183]
    v_mfma_f32_16x16x32_bf16 v[184:187], a[136:139], a[64:67], v[184:187]
    v_mfma_f32_16x16x32_bf16 v[188:191], a[112:115], a[88:91], v[188:191]
    v_mfma_f32_16x16x32_bf16 v[192:195], a[136:139], a[88:91], v[192:195]
    v_mfma_f32_16x16x32_bf16 v[148:151], a[116:119], a[20:23], v[148:151]
    v_mfma_f32_16x16x32_bf16 v[152:155], a[140:143], a[20:23], v[152:155]
    v_mfma_f32_16x16x32_bf16 v[156:159], a[116:119], a[44:47], v[156:159]
    v_mfma_f32_16x16x32_bf16 v[160:163], a[140:143], a[44:47], v[160:163]
    v_mfma_f32_16x16x32_bf16 v[180:183], a[116:119], a[68:71], v[180:183]
    v_mfma_f32_16x16x32_bf16 v[184:187], a[140:143], a[68:71], v[184:187]
    v_mfma_f32_16x16x32_bf16 v[188:191], a[116:119], a[92:95], v[188:191]
    v_mfma_f32_16x16x32_bf16 v[192:195], a[140:143], a[92:95], v[192:195]
    v_cvt_pk_bf16_f32 v64, v180, v181
    v_cvt_pk_bf16_f32 v65, v182, v183
    ds_write_b64 v24, v[64:65] offset:12288
    v_cvt_pk_bf16_f32 v68, v184, v185
    v_cvt_pk_bf16_f32 v69, v186, v187
    ds_write_b64 v25, v[68:69] offset:12288
    v_cvt_pk_bf16_f32 v72, v188, v189
    v_cvt_pk_bf16_f32 v73, v190, v191
    ds_write_b64 v24, v[72:73] offset:18432
    v_cvt_pk_bf16_f32 v76, v192, v193
    v_cvt_pk_bf16_f32 v77, v194, v195
    ds_write_b64 v25, v[76:77] offset:18432
    v_cvt_pk_bf16_f32 v48, v148, v149
    v_cvt_pk_bf16_f32 v49, v150, v151
    ds_write_b64 v24, v[48:49] offset:0
    v_cvt_pk_bf16_f32 v52, v152, v153
    v_cvt_pk_bf16_f32 v53, v154, v155
    ds_write_b64 v25, v[52:53] offset:0
    v_cvt_pk_bf16_f32 v56, v156, v157
    v_cvt_pk_bf16_f32 v57, v158, v159
    ds_write_b64 v24, v[56:57] offset:6144
    v_cvt_pk_bf16_f32 v60, v160, v161
    v_cvt_pk_bf16_f32 v61, v162, v163
    ds_write_b64 v25, v[60:61] offset:6144
    s_add_u32 s56, s37, 2
    s_and_b32 s55, s56, 3
    s_mul_i32 s55, s55, 114688
    s_add_u32 s55, s55, 65536
    s_add_u32 s45, s38, s55
    s_add_u32 s46, s45, 4096
    s_add_u32 s47, s45, 8192
    s_add_u32 s56, s37, -1
    s_and_b32 s55, s56, 3
    s_mul_i32 s55, s55, 114688
    s_add_u32 s55, s55, 53248
    s_add_u32 s48, s38, s55
    s_and_b32 s55, s56, 1
    s_add_u32 s56, s56, 1
    v_mov_b32 v35, -16
    v_writelane_b32 v35, s56, 12
    s_mul_i32 s55, s55, 12288
    s_add_u32 m0, s54, s55
    v_add_u32 v35, -1, v34
    buffer_load_dword v36, v33, s[4:7], s38 offen sc1
    s_waitcnt vmcnt(0)
    v_cmp_lt_i32 vcc, v36, v35
    s_cbranch_vccz L_fok_98
L_fw_97:
    buffer_load_dword v36, v33, s[4:7], s38 offen sc1
    s_sub_u32 s36, s36, 1
    s_cbranch_scc1 L_exit
    s_waitcnt vmcnt(0)
    v_cmp_lt_i32 vcc, v36, v35
    s_cbranch_vccnz L_fw_97
L_fok_98:
    buffer_load_dwordx4 a[96:99], v40, s[4:7], s45 offen offset:0 sc1
    buffer_load_dwordx4 a[100:103], v40, s[4:7], s45 offen offset:1024 sc1
    buffer_load_dwordx4 a[104:107], v40, s[4:7], s45 offen offset:2048 sc1
    buffer_load_dwordx4 a[108:111], v40, s[4:7], s45 offen offset:3072 sc1
    buffer_load_dwordx4 a[112:115], v40, s[4:7], s46 offen offset:0 sc1
    buffer_load_dwordx4 a[116:119], v40, s[4:7], s46 offen offset:1024 sc1
    buffer_load_dwordx4 a[120:123], v40, s[4:7], s46 offen offset:2048 sc1
    buffer_load_dwordx4 a[124:127], v40, s[4:7], s46 offen offset:3072 sc1
    buffer_load_dwordx4 a[128:131], v40, s[4:7], s47 offen offset:0 sc1
    buffer_load_dwordx4 a[132:135], v40, s[4:7], s47 offen offset:1024 sc1
    buffer_load_dwordx4 a[136:139], v40, s[4:7], s47 offen offset:2048 sc1
    buffer_load_dwordx4 a[140:143], v40, s[4:7], s47 offen offset:3072 sc1
    s_mov_b32 s50, s42
    s_add_u32 s56, s37, 1
    v_mov_b32 v47, v24
    s_and_b32 s55, s56, 3
    s_mul_i32 s41, s55, 327680
    s_mul_i32 s56, s55, 114688
    s_add_u32 s43, s38, s56
    s_xor_b32 s55, s55, 2
    s_mul_i32 s42, s55, 327680
    s_add_u32 s56, s37, 2
    v_mov_b32 v107, s56
    s_and_b32 s55, s56, 3
    s_mul_i32 s44, s55, 24576
    s_add_u32 s56, s37, -1
    s_and_b32 s55, s56, 3
    s_mul_i32 s55, s55, 40960
    s_add_u32 s49, s55, s38
    s_add_u32 s56, s37, -1
    s_and_b32 s55, s56, 3
    s_mul_i32 s55, s55, 24576
    v_add_u32 v26, s55, v22
    v_add_u32 v27, s55, v23
    s_and_b32 s55, s56, 1
    s_mul_i32 s55, s55, 12288
    v_add_u32 v29, s55, v28
    s_add_u32 s37, s37, 1
    s_mov_b32 m0, s53
    v_add_u32 v24, s44, v20
    v_add_u32 v25, s44, v21
    v_pk_mul_f32 v[148:149], v[210:211], v[210:211]
    v_pk_mul_f32 v[150:151], v[210:211], v[210:211]
    v_pk_mul_f32 v[152:153], v[210:211], v[210:211]
    v_pk_mul_f32 v[154:155], v[210:211], v[210:211]
    v_pk_mul_f32 v[156:157], v[210:211], v[210:211]
    v_pk_mul_f32 v[158:159], v[210:211], v[210:211]
    v_pk_mul_f32 v[160:161], v[210:211], v[210:211]
    v_pk_mul_f32 v[162:163], v[210:211], v[210:211]
    v_mov_b32 v120, 0
    v_mov_b32 v121, 0
    v_mov_b32 v122, 0
    v_mov_b32 v123, 0
    v_mov_b32 v124, 0
    v_mov_b32 v125, 0
    v_mov_b32 v126, 0
    v_mov_b32 v127, 0
    v_mov_b32 v128, 0
    v_mov_b32 v129, 0
    v_mov_b32 v130, 0
    v_mov_b32 v131, 0
    v_mov_b32 v132, 0
    v_mov_b32 v133, 0
    v_mov_b32 v134, 0
    v_mov_b32 v135, 0
    v_mov_b32 v116, 0
    v_mov_b32 v117, 0
    v_mov_b32 v118, 0
    v_mov_b32 v119, 0
L_wo_loop_s:
    buffer_load_dword v41, v245, s[4:7], s38 offen sc1
    buffer_load_dword v41, v245, s[4:7], s38 offen sc1
    buffer_load_dword v41, v245, s[4:7], s38 offen sc1
    buffer_load_dword v41, v245, s[4:7], s38 offen sc1
    buffer_load_dword v41, v245, s[4:7], s38 offen sc1
    buffer_load_dword v41, v245, s[4:7], s38 offen sc1
L_sp_102:
    s_waitcnt vmcnt(5)
    v_cmp_ge_u32 vcc, s37, v41
    buffer_load_dword v41, v245, s[4:7], s38 offen sc1
    s_sub_u32 s36, s36, 1
    s_cbranch_scc1 L_exit
    s_cbranch_vccz L_sp_102x
    s_waitcnt vmcnt(5)
    v_cmp_ge_u32 vcc, s37, v41
    buffer_load_dword v41, v245, s[4:7], s38 offen sc1
    s_cbranch_vccz L_sp_102x
    s_waitcnt vmcnt(5)
    v_cmp_ge_u32 vcc, s37, v41
    buffer_load_dword v41, v245, s[4:7], s38 offen sc1
    s_cbranch_vccz L_sp_102x
    s_waitcnt vmcnt(5)
    v_cmp_ge_u32 vcc, s37, v41
    buffer_load_dword v41, v245, s[4:7], s38 offen sc1
    s_cbranch_vccnz L_sp_102
L_sp_102x:
    buffer_store_dword v107, v45, s[4:7], s38 offen sc1
    buffer_load_dwordx4 v44, s[4:7], s43 offen offset:0 sc1 lds
    buffer_load_dwordx4 v44, s[4:7], s43 offen offset:1024 sc1 lds
    buffer_load_dwordx4 v44, s[4:7], s43 offen offset:2048 sc1 lds
    s_cmp_eq_u32 s37, 63
    s_cbranch_scc1 L_wo_tail_s
    s_waitcnt vmcnt(2)
    ds_read_b64_tr_b16 v[136:137], v16 offset:0
    ds_read_b64_tr_b16 v[138:139], v13 offset:0
    buffer_load_dwordx4 v[92:95], v38, s[4:7], s43 offen offset:0 sc1
    buffer_load_dwordx4 v[96:99], v38, s[4:7], s43 offen offset:1280 sc1
    buffer_load_dwordx4 v[100:103], v38, s[4:7], s43 offen offset:2560 sc1
    s_waitcnt vmcnt(4)
    ds_read_b64_tr_b16 v[140:141], v16 offset:1024
    ds_read_b64_tr_b16 v[142:143], v13 offset:1024
    s_waitcnt vmcnt(3)
    ds_read_b64_tr_b16 v[144:145], v16 offset:2048
    ds_read_b64_tr_b16 v[146:147], v13 offset:2048
    s_waitcnt lgkmcnt(4)
    v_smfmac_f32_16x16x64_bf16 v[148:151], v[136:139], a[0:7], v10
    buffer_load_dword v104, v39, s[4:7], s43 offen offset:0 sc1
    v_smfmac_f32_16x16x64_bf16 v[152:155], v[136:139], a[24:31], v10
    buffer_load_dword v105, v39, s[4:7], s43 offen offset:1280 sc1
    v_smfmac_f32_16x16x64_bf16 v[156:159], v[136:139], a[48:55], v10
    buffer_load_dword v106, v39, s[4:7], s43 offen offset:2560 sc1
    v_smfmac_f32_16x16x64_bf16 v[160:163], v[136:139], a[72:79], v10
    s_waitcnt lgkmcnt(2)
    v_smfmac_f32_16x16x64_bf16 v[148:151], v[140:143], a[8:15], v10
    v_smfmac_f32_16x16x64_bf16 v[152:155], v[140:143], a[32:39], v10
    v_smfmac_f32_16x16x64_bf16 v[156:159], v[140:143], a[56:63], v10
    v_smfmac_f32_16x16x64_bf16 v[160:163], v[140:143], a[80:87], v10
    s_waitcnt lgkmcnt(0)
    v_smfmac_f32_16x16x64_bf16 v[148:151], v[144:147], a[16:23], v10
    v_smfmac_f32_16x16x64_bf16 v[152:155], v[144:147], a[40:47], v10
    v_smfmac_f32_16x16x64_bf16 v[156:159], v[144:147], a[64:71], v10
    v_smfmac_f32_16x16x64_bf16 v[160:163], v[144:147], a[88:95], v10
L_sc_103:
    v_pk_add_f32 v[148:149], v[148:149], v[150:151]
    v_cvt_pk_bf16_f32 v50, v148, v149
    v_cvt_pk_bf16_f32 v54, v148, v149
    v_pk_add_f32 v[152:153], v[152:153], v[154:155]
    v_cvt_pk_bf16_f32 v58, v152, v153
    v_cvt_pk_bf16_f32 v62, v152, v153
    v_pk_add_f32 v[156:157], v[156:157], v[158:159]
    v_cvt_pk_bf16_f32 v66, v156, v157
    v_cvt_pk_bf16_f32 v70, v156, v157
    s_waitcnt vmcnt(4)
    v_pk_add_f32 v[236:237], v[92:93], v[96:97]
    v_pk_add_f32 v[238:239], v[94:95], v[98:99]
    s_waitcnt vmcnt(3)
    v_pk_add_f32 v[236:237], v[236:237], v[100:101]
    v_pk_add_f32 v[238:239], v[238:239], v[102:103]
    v_pk_mul_f32 v[236:237], v[236:237], v[240:241]
    v_pk_mul_f32 v[238:239], v[238:239], v[240:241]
    v_max3_f32 v41, v236, v237, v238
    s_waitcnt vmcnt(0)
    v_add_f32 v43, v104, v105
    v_add_f32 v43, v43, v106
    v_mul_f32 v43, v43, v240
    v_max3_f32 v41, v41, v239, v43
    v_pk_add_f32 v[160:161], v[160:161], v[162:163]
    v_cvt_pk_bf16_f32 v74, v160, v161
    v_max_f32_dpp v42, v41, v41 quad_perm:[2,3,0,1] row_mask:0xf bank_mask:0xf
    v_max_f32_dpp v41, v41, v41 quad_perm:[2,3,0,1] row_mask:0xf bank_mask:0xf
    v_cvt_pk_bf16_f32 v78, v160, v161
    s_nop 0
    v_permlane16_swap_b32 v41, v42
    v_max_f32 v41, v41, v42
    v_mov_b32 v42, v41
    s_nop 1
    v_permlane32_swap_b32 v41, v42
    v_max_f32 v242, v41, v42
    v_pk_add_f32 v[236:237], v[236:237], v[242:243] op_sel_hi:[1,0] neg_lo:[0,1] neg_hi:[0,1]
    v_pk_add_f32 v[238:239], v[238:239], v[242:243] op_sel_hi:[1,0] neg_lo:[0,1] neg_hi:[0,1]
    v_sub_f32 v43, v43, v242
    v_exp_f32 v236, v236
    v_exp_f32 v237, v237
    v_exp_f32 v238, v238
    v_exp_f32 v239, v239
    v_exp_f32 v43, v43
    v_cvt_pk_bf16_f32 v80, v236, v237
    v_cvt_pk_bf16_f32 v82, v238, v239
    v_cvt_pk_bf16_f32 v81, v43, 0
    v_cvt_pk_bf16_f32 v83, v43, 0
    s_nop 1
    v_smfmac_f32_16x16x64_bf16 v[116:119], v[80:83], v[84:91], v11
    v_smfmac_f32_16x16x64_bf16 v[120:123], v[80:83], v[48:55], v11
    v_smfmac_f32_16x16x64_bf16 v[124:127], v[80:83], v[56:63], v11
    v_smfmac_f32_16x16x64_bf16 v[128:131], v[80:83], v[64:71], v11
    v_add_f32 v116, v116, v118
    v_add_f32 v117, v117, v119
    v_smfmac_f32_16x16x64_bf16 v[132:135], v[80:83], v[72:79], v11
    v_rcp_f32 v116, v116
    v_rcp_f32 v117, v117
    v_pk_add_f32 v[120:121], v[120:121], v[122:123]
    v_pk_mul_f32 v[120:121], v[120:121], v[116:117]
    v_cvt_pk_bf16_f32 v236, v120, v121
    v_pk_add_f32 v[124:125], v[124:125], v[126:127]
    v_pk_mul_f32 v[124:125], v[124:125], v[116:117]
    v_cvt_pk_bf16_f32 v237, v124, v125
    ds_write2st64_b32 v18, v236, v237 offset0:0 offset1:1
    v_pk_add_f32 v[128:129], v[128:129], v[130:131]
    v_pk_mul_f32 v[128:129], v[128:129], v[116:117]
    v_cvt_pk_bf16_f32 v238, v128, v129
    v_pk_add_f32 v[132:133], v[132:133], v[134:135]
    v_pk_mul_f32 v[132:133], v[132:133], v[116:117]
    v_cvt_pk_bf16_f32 v239, v132, v133
    ds_write2st64_b32 v18, v238, v239 offset0:2 offset1:3
    v_cmp_u_f32 vcc, v120, v121
    v_mov_b32 v120, 0
    v_mov_b32 v121, 0
    v_mov_b32 v122, 0
    v_mov_b32 v123, 0
    v_mov_b32 v124, 0
    v_mov_b32 v125, 0
    v_mov_b32 v126, 0
    v_mov_b32 v127, 0
    v_mov_b32 v128, 0
    s_cbranch_vccnz L_sp_104
L_sg_105:
    s_waitcnt lgkmcnt(0)
    s_barrier
    ds_read_b64_tr_b16 v[80:81], v19
    ds_read_b64_tr_b16 v[82:83], v19 offset:128
    v_mov_b32 v129, 0
    v_mov_b32 v130, 0
    v_mov_b32 v131, 0
    v_mov_b32 v132, 0
    v_mov_b32 v133, 0
    v_mov_b32 v134, 0
    v_mov_b32 v135, 0
    v_mov_b32 v116, 0
    v_mov_b32 v117, 0
    v_mov_b32 v118, 0
    v_mov_b32 v119, 0
    s_waitcnt lgkmcnt(0)
    v_mfma_f32_16x16x32_bf16 v[172:175], v[80:83], v[108:111], 0
    buffer_load_dword v36, v33, s[4:7], s38 offen sc1
    s_nop 6
    v_cvt_pk_bf16_f32 v236, v172, v173
    v_cvt_pk_bf16_f32 v237, v174, v175
    v_cndmask_b32 v236, v236, v237, s[60:61]
    buffer_store_dword v236, v46, s[4:7], s41 offen sc1
    buffer_store_dword v236, v14, s[4:7], s41 offen sc1
    ds_write_b32 v47, v50 offset:8
    ds_write_b32 v47, v58 offset:6152
    ds_write_b32 v47, v66 offset:12296
    ds_write_b32 v47, v74 offset:18440
    ds_read_b128 v[204:207], v26 offset:0
    ds_read_b128 v[180:183], v29 offset:0
    ds_read_b128 v[184:187], v29 offset:1024
    ds_read_b64 v[208:209], v27 offset:0
    ds_read_b128 v[188:191], v29 offset:2048
    ds_read_b128 v[212:215], v26 offset:1536
    ds_read_b128 v[192:195], v29 offset:3072
    ds_read_b128 v[196:199], v29 offset:4096
    ds_read_b64 v[216:217], v27 offset:1536
    ds_read_b128 v[200:203], v29 offset:5120
    s_add_u32 s55, s42, 0
    buffer_store_dword v168, v46, s[4:7], s55 offen sc1
    s_add_u32 s55, s42, 8192
    buffer_store_dword v168, v46, s[4:7], s55 offen sc1
    s_waitcnt lgkmcnt(5)
    v_mfma_f32_16x16x32_bf16 v[220:223], v[180:183], v[204:207], 0
    v_mfma_f32_16x16x32_bf16 v[224:227], v[184:187], v[204:207], 0
    v_mfma_f32_16x16x32_bf16 v[224:227], v[188:191], v[208:211], v[224:227]
    ds_read_b128 v[204:207], v26 offset:3072
    ds_read_b128 v[180:183], v29 offset:6144
    ds_read_b128 v[184:187], v29 offset:7168
    ds_read_b64 v[208:209], v27 offset:3072
    ds_read_b128 v[188:191], v29 offset:8192
    s_add_u32 s56, s37, 2
    s_and_b32 s55, s56, 3
    s_mul_i32 s55, s55, 114688
    s_add_u32 s55, s55, 65536
    s_add_u32 s45, s38, s55
    s_add_u32 s46, s45, 4096
    s_add_u32 s47, s45, 8192
    s_add_u32 s56, s37, -1
    s_and_b32 s55, s56, 3
    s_mul_i32 s55, s55, 114688
    s_add_u32 s55, s55, 53248
    s_add_u32 s48, s38, s55
    s_and_b32 s55, s56, 1
    s_add_u32 s56, s56, 1
    v_mov_b32 v35, -16
    v_writelane_b32 v35, s56, 12
    s_mul_i32 s55, s55, 12288
    s_add_u32 m0, s54, s55
    s_waitcnt lgkmcnt(5)
    v_mfma_f32_16x16x32_bf16 v[220:223], v[192:195], v[212:215], v[220:223]
    v_mfma_f32_16x16x32_bf16 v[224:227], v[196:199], v[212:215], v[224:227]
    v_mfma_f32_16x16x32_bf16 v[224:227], v[200:203], v[216:219], v[224:227]
    ds_read_b128 v[212:215], v26 offset:4608
    ds_read_b128 v[192:195], v29 offset:9216
    ds_read_b128 v[196:199], v29 offset:10240
    ds_read_b64 v[216:217], v27 offset:4608
    ds_read_b128 v[200:203], v29 offset:11264
    s_waitcnt lgkmcnt(5)
    v_mfma_f32_16x16x32_bf16 v[220:223], v[180:183], v[204:207], v[220:223]
    v_mfma_f32_16x16x32_bf16 v[224:227], v[184:187], v[204:207], v[224:227]
    v_mfma_f32_16x16x32_bf16 v[224:227], v[188:191], v[208:211], v[224:227]
    s_waitcnt lgkmcnt(0)
    v_mfma_f32_16x16x32_bf16 v[220:223], v[192:195], v[212:215], v[220:223]
    v_mfma_f32_16x16x32_bf16 v[224:227], v[196:199], v[212:215], v[224:227]
    v_mfma_f32_16x16x32_bf16 v[224:227], v[200:203], v[216:219], v[224:227]
    s_waitcnt vmcnt(4)
    v_cmp_lt_i32 vcc, v36, v35
    s_cbranch_vccz L_fok_108
L_fw_107:
    buffer_load_dword v36, v33, s[4:7], s38 offen sc1
    s_sub_u32 s36, s36, 1
    s_cbranch_scc1 L_exit
    s_waitcnt vmcnt(0)
    v_cmp_lt_i32 vcc, v36, v35
    s_cbranch_vccnz L_fw_107
L_fok_108:
    buffer_load_dwordx4 v37, s[4:7], s48 offen offset:0 sc1 lds
    buffer_load_dwordx4 v37, s[4:7], s48 offen offset:1024 sc1 lds
    buffer_load_dwordx4 v37, s[4:7], s48 offen offset:2048 sc1 lds
    v_cvt_pk_bf16_f32 v220, v220, v221
    v_cvt_pk_bf16_f32 v221, v222, v223
    v_cvt_pk_bf16_f32 v222, v224, v225
    v_cvt_pk_bf16_f32 v223, v226, v227
    v_mov_b32 v224, v220
    v_mov_b32 v225, v221
    v_mov_b32_dpp v220, v222 row_ror:8 row_mask:0xf bank_mask:0xc
    v_mov_b32_dpp v221, v223 row_ror:8 row_mask:0xf bank_mask:0xc
    v_mov_b32_dpp v222, v224 row_ror:8 row_mask:0xf bank_mask:0x3
    v_mov_b32_dpp v223, v225 row_ror:8 row_mask:0xf bank_mask:0x3
    buffer_store_dwordx4 v[220:223], v15, s[4:7], s49 offen sc1
    v_mfma_f32_16x16x32_bf16 v[148:151], a[96:99], a[0:3], 0
    s_mov_b32 s50, s42
    s_add_u32 s56, s37, 1
    v_mov_b32 v47, v24
    v_mfma_f32_16x16x32_bf16 v[152:155], a[120:123], a[0:3], 0
    s_and_b32 s55, s56, 3
    s_mul_i32 s41, s55, 327680
    s_mul_i32 s56, s55, 114688
    v_mfma_f32_16x16x32_bf16 v[156:159], a[96:99], a[24:27], 0
    s_add_u32 s43, s38, s56
    s_xor_b32 s55, s55, 2
    s_mul_i32 s42, s55, 327680
    v_mfma_f32_16x16x32_bf16 v[160:163], a[120:123], a[24:27], 0
    s_add_u32 s56, s37, 2
    v_mov_b32 v107, s56
    s_and_b32 s55, s56, 3
    v_mfma_f32_16x16x32_bf16 v[180:183], a[96:99], a[48:51], 0
    s_mul_i32 s44, s55, 24576
    s_add_u32 s56, s37, -1
    s_and_b32 s55, s56, 3
    v_mfma_f32_16x16x32_bf16 v[184:187], a[120:123], a[48:51], 0
    s_mul_i32 s55, s55, 40960
    s_add_u32 s49, s55, s38
    s_add_u32 s56, s37, -1
    v_mfma_f32_16x16x32_bf16 v[188:191], a[96:99], a[72:75], 0
    s_and_b32 s55, s56, 3
    s_mul_i32 s55, s55, 24576
    v_add_u32 v26, s55, v22
    v_mfma_f32_16x16x32_bf16 v[192:195], a[120:123], a[72:75], 0
    buffer_load_dwordx4 a[96:99], v40, s[4:7], s45 offen offset:0 sc1
    v_mfma_f32_16x16x32_bf16 v[148:151], a[100:103], a[4:7], v[148:151]
    v_add_u32 v27, s55, v23
    s_and_b32 s55, s56, 1
    s_mul_i32 s55, s55, 12288
    v_mfma_f32_16x16x32_bf16 v[152:155], a[124:127], a[4:7], v[152:155]
    buffer_load_dwordx4 a[120:123], v40, s[4:7], s46 offen offset:2048 sc1
    v_mfma_f32_16x16x32_bf16 v[156:159], a[100:103], a[28:31], v[156:159]
    v_add_u32 v29, s55, v28
    v_mfma_f32_16x16x32_bf16 v[160:163], a[124:127], a[28:31], v[160:163]
    v_mfma_f32_16x16x32_bf16 v[180:183], a[100:103], a[52:55], v[180:183]
    v_mfma_f32_16x16x32_bf16 v[184:187], a[124:127], a[52:55], v[184:187]
    v_mfma_f32_16x16x32_bf16 v[188:191], a[100:103], a[76:79], v[188:191]
    v_mfma_f32_16x16x32_bf16 v[192:195], a[124:127], a[76:79], v[192:195]
    buffer_load_dwordx4 a[100:103], v40, s[4:7], s45 offen offset:1024 sc1
    v_mfma_f32_16x16x32_bf16 v[148:151], a[104:107], a[8:11], v[148:151]
    v_mfma_f32_16x16x32_bf16 v[152:155], a[128:131], a[8:11], v[152:155]
    buffer_load_dwordx4 a[124:127], v40, s[4:7], s46 offen offset:3072 sc1
    v_mfma_f32_16x16x32_bf16 v[156:159], a[104:107], a[32:35], v[156:159]
    v_mfma_f32_16x16x32_bf16 v[160:163], a[128:131], a[32:35], v[160:163]
    v_mfma_f32_16x16x32_bf16 v[180:183], a[104:107], a[56:59], v[180:183]
    v_mfma_f32_16x16x32_bf16 v[184:187], a[128:131], a[56:59], v[184:187]
    v_mfma_f32_16x16x32_bf16 v[188:191], a[104:107], a[80:83], v[188:191]
    v_mfma_f32_16x16x32_bf16 v[192:195], a[128:131], a[80:83], v[192:195]
    buffer_load_dwordx4 a[104:107], v40, s[4:7], s45 offen offset:2048 sc1
    v_mfma_f32_16x16x32_bf16 v[148:151], a[108:111], a[12:15], v[148:151]
    v_mfma_f32_16x16x32_bf16 v[152:155], a[132:135], a[12:15], v[152:155]
    buffer_load_dwordx4 a[128:131], v40, s[4:7], s47 offen offset:0 sc1
    v_mfma_f32_16x16x32_bf16 v[156:159], a[108:111], a[36:39], v[156:159]
    v_mfma_f32_16x16x32_bf16 v[160:163], a[132:135], a[36:39], v[160:163]
    v_mfma_f32_16x16x32_bf16 v[180:183], a[108:111], a[60:63], v[180:183]
    v_mfma_f32_16x16x32_bf16 v[184:187], a[132:135], a[60:63], v[184:187]
    v_mfma_f32_16x16x32_bf16 v[188:191], a[108:111], a[84:87], v[188:191]
    v_mfma_f32_16x16x32_bf16 v[192:195], a[132:135], a[84:87], v[192:195]
    buffer_load_dwordx4 a[108:111], v40, s[4:7], s45 offen offset:3072 sc1
    v_mfma_f32_16x16x32_bf16 v[148:151], a[112:115], a[16:19], v[148:151]
    v_mfma_f32_16x16x32_bf16 v[152:155], a[136:139], a[16:19], v[152:155]
    buffer_load_dwordx4 a[132:135], v40, s[4:7], s47 offen offset:1024 sc1
    v_mfma_f32_16x16x32_bf16 v[156:159], a[112:115], a[40:43], v[156:159]
    v_mfma_f32_16x16x32_bf16 v[160:163], a[136:139], a[40:43], v[160:163]
    v_mfma_f32_16x16x32_bf16 v[180:183], a[112:115], a[64:67], v[180:183]
    v_mfma_f32_16x16x32_bf16 v[184:187], a[136:139], a[64:67], v[184:187]
    v_mfma_f32_16x16x32_bf16 v[188:191], a[112:115], a[88:91], v[188:191]
    v_mfma_f32_16x16x32_bf16 v[192:195], a[136:139], a[88:91], v[192:195]
    buffer_load_dwordx4 a[112:115], v40, s[4:7], s46 offen offset:0 sc1
    v_mfma_f32_16x16x32_bf16 v[148:151], a[116:119], a[20:23], v[148:151]
    v_mfma_f32_16x16x32_bf16 v[152:155], a[140:143], a[20:23], v[152:155]
    v_mfma_f32_16x16x32_bf16 v[156:159], a[116:119], a[44:47], v[156:159]
    v_mfma_f32_16x16x32_bf16 v[160:163], a[140:143], a[44:47], v[160:163]
    v_mfma_f32_16x16x32_bf16 v[180:183], a[116:119], a[68:71], v[180:183]
    v_mfma_f32_16x16x32_bf16 v[184:187], a[140:143], a[68:71], v[184:187]
    v_mfma_f32_16x16x32_bf16 v[188:191], a[116:119], a[92:95], v[188:191]
    v_mfma_f32_16x16x32_bf16 v[192:195], a[140:143], a[92:95], v[192:195]
    v_cvt_pk_bf16_f32 v64, v180, v181
    v_cvt_pk_bf16_f32 v65, v182, v183
    ds_write_b64 v24, v[64:65] offset:12288
    v_cvt_pk_bf16_f32 v68, v184, v185
    v_cvt_pk_bf16_f32 v69, v186, v187
    ds_write_b64 v25, v[68:69] offset:12288
    v_cvt_pk_bf16_f32 v72, v188, v189
    v_cvt_pk_bf16_f32 v73, v190, v191
    ds_write_b64 v24, v[72:73] offset:18432
    v_cvt_pk_bf16_f32 v76, v192, v193
    v_cvt_pk_bf16_f32 v77, v194, v195
    ds_write_b64 v25, v[76:77] offset:18432
    v_cvt_pk_bf16_f32 v48, v148, v149
    v_cvt_pk_bf16_f32 v49, v150, v151
    ds_write_b64 v24, v[48:49] offset:0
    v_cvt_pk_bf16_f32 v52, v152, v153
    v_cvt_pk_bf16_f32 v53, v154, v155
    ds_write_b64 v25, v[52:53] offset:0
    v_cvt_pk_bf16_f32 v56, v156, v157
    v_cvt_pk_bf16_f32 v57, v158, v159
    ds_write_b64 v24, v[56:57] offset:6144
    v_cvt_pk_bf16_f32 v60, v160, v161
    v_cvt_pk_bf16_f32 v61, v162, v163
    ds_write_b64 v25, v[60:61] offset:6144
    s_add_u32 s37, s37, 1
    s_mov_b32 m0, s53
    v_add_u32 v24, s44, v20
    v_add_u32 v25, s44, v21
    v_pk_mul_f32 v[148:149], v[210:211], v[210:211]
    v_pk_mul_f32 v[150:151], v[210:211], v[210:211]
    v_pk_mul_f32 v[152:153], v[210:211], v[210:211]
    v_pk_mul_f32 v[154:155], v[210:211], v[210:211]
    v_pk_mul_f32 v[156:157], v[210:211], v[210:211]
    v_pk_mul_f32 v[158:159], v[210:211], v[210:211]
    v_pk_mul_f32 v[160:161], v[210:211], v[210:211]
    v_pk_mul_f32 v[162:163], v[210:211], v[210:211]
    buffer_load_dwordx4 a[136:139], v40, s[4:7], s47 offen offset:2048 sc1
    buffer_load_dwordx4 a[116:119], v40, s[4:7], s46 offen offset:1024 sc1
    buffer_load_dwordx4 a[140:143], v40, s[4:7], s47 offen offset:3072 sc1
    s_branch L_wo_loop_s
L_wo_tail_s:
L_tv_109:
    buffer_load_dwordx4 v44, s[4:7], s43 offen offset:0 sc1 lds
    buffer_load_dwordx4 v44, s[4:7], s43 offen offset:1024 sc1 lds
    buffer_load_dwordx4 v44, s[4:7], s43 offen offset:2048 sc1 lds
    s_sub_u32 s36, s36, 1
    s_cbranch_scc1 L_exit
    v_add_u32 v5, s53, v12
    s_waitcnt vmcnt(0)
    ds_read_b128 v[136:139], v5 offset:0
    ds_read_b128 v[140:143], v5 offset:1024
    ds_read_b128 v[144:147], v5 offset:2048
    s_waitcnt lgkmcnt(0)
    v_max_u32 v4, v136, v137
    v_max3_u32 v4, v4, v138, v139
    v_max3_u32 v4, v4, v140, v141
    v_max3_u32 v4, v4, v142, v143
    v_max3_u32 v4, v4, v144, v145
    v_max3_u32 v4, v4, v146, v147
    v_cmp_eq_u32 vcc, -1, v4
    s_cbranch_vccnz L_tv_109
    ds_read_b64_tr_b16 v[136:137], v16 offset:0
    ds_read_b64_tr_b16 v[138:139], v13 offset:0
    ds_read_b64_tr_b16 v[140:141], v16 offset:1024
    ds_read_b64_tr_b16 v[142:143], v13 offset:1024
    ds_read_b64_tr_b16 v[144:145], v16 offset:2048
    ds_read_b64_tr_b16 v[146:147], v13 offset:2048
    v_mov_b32 v148, 0
    v_mov_b32 v149, 0
    v_mov_b32 v150, 0
    v_mov_b32 v151, 0
    v_mov_b32 v152, 0
    v_mov_b32 v153, 0
    v_mov_b32 v154, 0
    v_mov_b32 v155, 0
    v_mov_b32 v156, 0
    v_mov_b32 v157, 0
    v_mov_b32 v158, 0
    v_mov_b32 v159, 0
    v_mov_b32 v160, 0
    v_mov_b32 v161, 0
    v_mov_b32 v162, 0
    v_mov_b32 v163, 0
    s_waitcnt lgkmcnt(0)
    v_smfmac_f32_16x16x64_bf16 v[148:151], v[136:139], a[0:7], v10
    v_smfmac_f32_16x16x64_bf16 v[152:155], v[136:139], a[24:31], v10
    v_smfmac_f32_16x16x64_bf16 v[156:159], v[136:139], a[48:55], v10
    v_smfmac_f32_16x16x64_bf16 v[160:163], v[136:139], a[72:79], v10
    v_smfmac_f32_16x16x64_bf16 v[148:151], v[140:143], a[8:15], v10
    v_smfmac_f32_16x16x64_bf16 v[152:155], v[140:143], a[32:39], v10
    v_smfmac_f32_16x16x64_bf16 v[156:159], v[140:143], a[56:63], v10
    v_smfmac_f32_16x16x64_bf16 v[160:163], v[140:143], a[80:87], v10
    v_smfmac_f32_16x16x64_bf16 v[148:151], v[144:147], a[16:23], v10
    v_smfmac_f32_16x16x64_bf16 v[152:155], v[144:147], a[40:47], v10
    v_smfmac_f32_16x16x64_bf16 v[156:159], v[144:147], a[64:71], v10
    v_smfmac_f32_16x16x64_bf16 v[160:163], v[144:147], a[88:95], v10
    v_pk_add_f32 v[148:149], v[148:149], v[150:151]
    v_cvt_pk_bf16_f32 v50, v148, v149
    v_cvt_pk_bf16_f32 v54, v148, v149
    v_pk_add_f32 v[152:153], v[152:153], v[154:155]
    v_cvt_pk_bf16_f32 v58, v152, v153
    v_cvt_pk_bf16_f32 v62, v152, v153
    v_pk_add_f32 v[156:157], v[156:157], v[158:159]
    v_cvt_pk_bf16_f32 v66, v156, v157
    v_cvt_pk_bf16_f32 v70, v156, v157
    v_pk_add_f32 v[160:161], v[160:161], v[162:163]
    v_cvt_pk_bf16_f32 v74, v160, v161
    v_cvt_pk_bf16_f32 v78, v160, v161
    ds_write_b32 v47, v50 offset:8
    ds_write_b32 v47, v58 offset:6152
    ds_write_b32 v47, v66 offset:12296
    ds_write_b32 v47, v74 offset:18440
    s_add_u32 s91, s38, 81920
    buffer_load_dwordx4 v[120:123], v15, s[4:7], s91 offen sc1
    s_add_u32 s91, s38, 122880
    buffer_load_dwordx4 v[124:127], v15, s[4:7], s91 offen sc1
    s_add_u32 s56, s37, -1
    s_and_b32 s55, s56, 3
    s_mul_i32 s55, s55, 114688
    s_add_u32 s55, s55, 53248
    s_add_u32 s48, s38, s55
    s_and_b32 s55, s56, 1
    s_add_u32 s56, s56, 1
    v_mov_b32 v35, -16
    v_writelane_b32 v35, s56, 12
    s_mul_i32 s55, s55, 12288
    s_add_u32 m0, s54, s55
    buffer_load_dword v36, v33, s[4:7], s38 offen sc1
    v_mov_b32 v3, 204
L_p0_110:
    buffer_load_dword v4, v3, s[8:11], 0 offen sc1
    s_sub_u32 s36, s36, 1
    s_cbranch_scc1 L_exit
    s_waitcnt vmcnt(0)
    v_readfirstlane_b32 s90, v4
    s_nop 0
    s_cmp_eq_u32 s90, 0
    s_cbranch_scc1 L_p0_110
    s_and_b32 s90, s90, 2
    s_lshl_b32 s90, s90, 12
    v_xor_b32 v30, s90, v30
    v_xor_b32 v31, s90, v31
    s_waitcnt lgkmcnt(0)
    s_barrier
    v_cmp_lt_i32 vcc, v36, v35
    s_cbranch_vccz L_fok_112
L_fw_111:
    buffer_load_dword v36, v33, s[4:7], s38 offen sc1
    s_sub_u32 s36, s36, 1
    s_cbranch_scc1 L_exit
    s_waitcnt vmcnt(0)
    v_cmp_lt_i32 vcc, v36, v35
    s_cbranch_vccnz L_fw_111
L_fok_112:
    buffer_load_dwordx4 v37, s[4:7], s48 offen offset:0 sc1 lds
    buffer_load_dwordx4 v37, s[4:7], s48 offen offset:1024 sc1 lds
    buffer_load_dwordx4 v37, s[4:7], s48 offen offset:2048 sc1 lds
    v_mov_b32 v128, v220
    v_mov_b32 v129, v221
    v_mov_b32 v130, v222
    v_mov_b32 v131, v223
    s_add_u32 s56, s37, -2
    s_and_b32 s55, s56, 3
    s_mul_i32 s55, s55, 24576
    v_add_u32 v26, s55, v22
    v_add_u32 v27, s55, v23
    s_and_b32 s55, s56, 1
    s_mul_i32 s55, s55, 12288
    v_add_u32 v29, s55, v28
    ds_read_b128 v[204:207], v26 offset:0
    ds_read_b128 v[180:183], v29 offset:0
    ds_read_b128 v[184:187], v29 offset:1024
    ds_read_b64 v[208:209], v27 offset:0
    ds_read_b128 v[188:191], v29 offset:2048
    ds_read_b128 v[212:215], v26 offset:1536
    ds_read_b128 v[192:195], v29 offset:3072
    ds_read_b128 v[196:199], v29 offset:4096
    ds_read_b64 v[216:217], v27 offset:1536
    ds_read_b128 v[200:203], v29 offset:5120
    s_waitcnt lgkmcnt(5)
    v_mfma_f32_16x16x32_bf16 v[220:223], v[180:183], v[204:207], 0
    v_mfma_f32_16x16x32_bf16 v[224:227], v[184:187], v[204:207], 0
    v_mfma_f32_16x16x32_bf16 v[224:227], v[188:191], v[208:211], v[224:227]
    ds_read_b128 v[204:207], v26 offset:3072
    ds_read_b128 v[180:183], v29 offset:6144
    ds_read_b128 v[184:187], v29 offset:7168
    ds_read_b64 v[208:209], v27 offset:3072
    ds_read_b128 v[188:191], v29 offset:8192
    s_waitcnt lgkmcnt(5)
    v_mfma_f32_16x16x32_bf16 v[220:223], v[192:195], v[212:215], v[220:223]
    v_mfma_f32_16x16x32_bf16 v[224:227], v[196:199], v[212:215], v[224:227]
    v_mfma_f32_16x16x32_bf16 v[224:227], v[200:203], v[216:219], v[224:227]
    ds_read_b128 v[212:215], v26 offset:4608
    ds_read_b128 v[192:195], v29 offset:9216
    ds_read_b128 v[196:199], v29 offset:10240
    ds_read_b64 v[216:217], v27 offset:4608
    ds_read_b128 v[200:203], v29 offset:11264
    s_waitcnt lgkmcnt(5)
    v_mfma_f32_16x16x32_bf16 v[220:223], v[180:183], v[204:207], v[220:223]
    v_mfma_f32_16x16x32_bf16 v[224:227], v[184:187], v[204:207], v[224:227]
    v_mfma_f32_16x16x32_bf16 v[224:227], v[188:191], v[208:211], v[224:227]
    s_waitcnt lgkmcnt(0)
    v_mfma_f32_16x16x32_bf16 v[220:223], v[192:195], v[212:215], v[220:223]
    v_mfma_f32_16x16x32_bf16 v[224:227], v[196:199], v[212:215], v[224:227]
    v_mfma_f32_16x16x32_bf16 v[224:227], v[200:203], v[216:219], v[224:227]
    s_nop 0
    v_cvt_pk_bf16_f32 v220, v220, v221
    v_cvt_pk_bf16_f32 v221, v222, v223
    s_nop 4
    v_cvt_pk_bf16_f32 v222, v224, v225
    v_cvt_pk_bf16_f32 v223, v226, v227
    v_mov_b32 v224, v220
    v_mov_b32 v225, v221
    v_mov_b32_dpp v220, v222 row_ror:8 row_mask:0xf bank_mask:0xc
    v_mov_b32_dpp v221, v223 row_ror:8 row_mask:0xf bank_mask:0xc
    v_mov_b32_dpp v222, v224 row_ror:8 row_mask:0xf bank_mask:0x3
    v_mov_b32_dpp v223, v225 row_ror:8 row_mask:0xf bank_mask:0x3
    v_mov_b32 v132, v220
    v_mov_b32 v133, v221
    v_mov_b32 v134, v222
    v_mov_b32 v135, v223
    s_waitcnt vmcnt(0)
    s_barrier
    s_add_u32 s56, s37, -1
    s_and_b32 s55, s56, 3
    s_mul_i32 s55, s55, 24576
    v_add_u32 v26, s55, v22
    v_add_u32 v27, s55, v23
    s_and_b32 s55, s56, 1
    s_mul_i32 s55, s55, 12288
    v_add_u32 v29, s55, v28
    ds_read_b128 v[204:207], v26 offset:0
    ds_read_b128 v[180:183], v29 offset:0
    ds_read_b128 v[184:187], v29 offset:1024
    ds_read_b64 v[208:209], v27 offset:0
    ds_read_b128 v[188:191], v29 offset:2048
    ds_read_b128 v[212:215], v26 offset:1536
    ds_read_b128 v[192:195], v29 offset:3072
    ds_read_b128 v[196:199], v29 offset:4096
    ds_read_b64 v[216:217], v27 offset:1536
    ds_read_b128 v[200:203], v29 offset:5120
    s_waitcnt lgkmcnt(5)
    v_mfma_f32_16x16x32_bf16 v[220:223], v[180:183], v[204:207], 0
    v_mfma_f32_16x16x32_bf16 v[224:227], v[184:187], v[204:207], 0
    v_mfma_f32_16x16x32_bf16 v[224:227], v[188:191], v[208:211], v[224:227]
    ds_read_b128 v[204:207], v26 offset:3072
    ds_read_b128 v[180:183], v29 offset:6144
    ds_read_b128 v[184:187], v29 offset:7168
    ds_read_b64 v[208:209], v27 offset:3072
    ds_read_b128 v[188:191], v29 offset:8192
    s_waitcnt lgkmcnt(5)
    v_mfma_f32_16x16x32_bf16 v[220:223], v[192:195], v[212:215], v[220:223]
    v_mfma_f32_16x16x32_bf16 v[224:227], v[196:199], v[212:215], v[224:227]
    v_mfma_f32_16x16x32_bf16 v[224:227], v[200:203], v[216:219], v[224:227]
    ds_read_b128 v[212:215], v26 offset:4608
    ds_read_b128 v[192:195], v29 offset:9216
    ds_read_b128 v[196:199], v29 offset:10240
    ds_read_b64 v[216:217], v27 offset:4608
    ds_read_b128 v[200:203], v29 offset:11264
    s_waitcnt lgkmcnt(5)
    v_mfma_f32_16x16x32_bf16 v[220:223], v[180:183], v[204:207], v[220:223]
    v_mfma_f32_16x16x32_bf16 v[224:227], v[184:187], v[204:207], v[224:227]
    v_mfma_f32_16x16x32_bf16 v[224:227], v[188:191], v[208:211], v[224:227]
    s_waitcnt lgkmcnt(0)
    v_mfma_f32_16x16x32_bf16 v[220:223], v[192:195], v[212:215], v[220:223]
    v_mfma_f32_16x16x32_bf16 v[224:227], v[196:199], v[212:215], v[224:227]
    v_mfma_f32_16x16x32_bf16 v[224:227], v[200:203], v[216:219], v[224:227]
    s_nop 0
    v_cvt_pk_bf16_f32 v220, v220, v221
    v_cvt_pk_bf16_f32 v221, v222, v223
    s_nop 4
    v_cvt_pk_bf16_f32 v222, v224, v225
    v_cvt_pk_bf16_f32 v223, v226, v227
    v_mov_b32 v224, v220
    v_mov_b32 v225, v221
    v_mov_b32_dpp v220, v222 row_ror:8 row_mask:0xf bank_mask:0xc
    v_mov_b32_dpp v221, v223 row_ror:8 row_mask:0xf bank_mask:0xc
    v_mov_b32_dpp v222, v224 row_ror:8 row_mask:0xf bank_mask:0x3
    v_mov_b32_dpp v223, v225 row_ror:8 row_mask:0xf bank_mask:0x3
    v_mov_b32 v80, v220
    v_mov_b32 v81, v221
    v_mov_b32 v82, v222
    v_mov_b32 v83, v223
    s_add_u32 s56, s37, 0
    s_and_b32 s55, s56, 3
    s_mul_i32 s55, s55, 114688
    s_add_u32 s55, s55, 53248
    s_add_u32 s48, s38, s55
    s_and_b32 s55, s56, 1
    s_add_u32 s56, s56, 1
    v_mov_b32 v35, -16
    v_writelane_b32 v35, s56, 12
    s_mul_i32 s55, s55, 12288
    s_add_u32 m0, s54, s55
    s_add_u32 s56, s37, 0
    s_and_b32 s55, s56, 3
    s_mul_i32 s55, s55, 24576
    v_add_u32 v26, s55, v22
    v_add_u32 v27, s55, v23
    s_and_b32 s55, s56, 1
    s_mul_i32 s55, s55, 12288
    v_add_u32 v29, s55, v28
    buffer_load_dword v36, v33, s[4:7], s38 offen sc1
    buffer_load_dword v36, v33, s[4:7], s38 offen sc1
    buffer_load_dword v36, v33, s[4:7], s38 offen sc1
    buffer_load_dword v36, v33, s[4:7], s38 offen sc1
    buffer_load_dword v36, v33, s[4:7], s38 offen sc1
L_sp_113:
    s_waitcnt vmcnt(4)
    v_cmp_lt_i32 vcc, v36, v35
    buffer_load_dword v36, v33, s[4:7], s38 offen sc1
    s_sub_u32 s36, s36, 1
    s_cbranch_scc1 L_exit
    s_cbranch_vccz L_sp_113x
    s_waitcnt vmcnt(4)
    v_cmp_lt_i32 vcc, v36, v35
    buffer_load_dword v36, v33, s[4:7], s38 offen sc1
    s_cbranch_vccz L_sp_113x
    s_waitcnt vmcnt(4)
    v_cmp_lt_i32 vcc, v36, v35
    buffer_load_dword v36, v33, s[4:7], s38 offen sc1
    s_cbranch_vccz L_sp_113x
    s_waitcnt vmcnt(4)
    v_cmp_lt_i32 vcc, v36, v35
    buffer_load_dword v36, v33, s[4:7], s38 offen sc1
    s_cbranch_vccnz L_sp_113
L_sp_113x:
    buffer_load_dwordx4 v37, s[4:7], s48 offen offset:0 sc1 lds
    buffer_load_dwordx4 v37, s[4:7], s48 offen offset:1024 sc1 lds
    buffer_load_dwordx4 v37, s[4:7], s48 offen offset:2048 sc1 lds
    s_waitcnt vmcnt(0)
    s_barrier
    s_mov_b32 s49, 7143424
    buffer_store_dwordx4 v[120:123], v30, s[4:7], s49 offen sc1
    s_mov_b32 s49, 6815744
    buffer_store_dwordx4 v[124:127], v30, s[4:7], s49 offen sc1
    s_mov_b32 s49, 6488064
    buffer_store_dwordx4 v[128:131], v30, s[4:7], s49 offen sc1
    s_mov_b32 s49, 6160384
    buffer_store_dwordx4 v[132:135], v30, s[4:7], s49 offen sc1
    s_mov_b32 s49, 5832704
    buffer_store_dwordx4 v[80:83], v30, s[4:7], s49 offen sc1
    ds_read_b128 v[204:207], v26 offset:0
    ds_read_b128 v[180:183], v29 offset:0
    ds_read_b128 v[184:187], v29 offset:1024
    ds_read_b64 v[208:209], v27 offset:0
    ds_read_b128 v[188:191], v29 offset:2048
    ds_read_b128 v[212:215], v26 offset:1536
    ds_read_b128 v[192:195], v29 offset:3072
    ds_read_b128 v[196:199], v29 offset:4096
    ds_read_b64 v[216:217], v27 offset:1536
    ds_read_b128 v[200:203], v29 offset:5120
    s_waitcnt lgkmcnt(5)
    v_mfma_f32_16x16x32_bf16 v[220:223], v[180:183], v[204:207], 0
    v_mfma_f32_16x16x32_bf16 v[224:227], v[184:187], v[204:207], 0
    v_mfma_f32_16x16x32_bf16 v[224:227], v[188:191], v[208:211], v[224:227]
    ds_read_b128 v[204:207], v26 offset:3072
    ds_read_b128 v[180:183], v29 offset:6144
    ds_read_b128 v[184:187], v29 offset:7168
    ds_read_b64 v[208:209], v27 offset:3072
    ds_read_b128 v[188:191], v29 offset:8192
    s_waitcnt lgkmcnt(5)
    v_mfma_f32_16x16x32_bf16 v[220:223], v[192:195], v[212:215], v[220:223]
    v_mfma_f32_16x16x32_bf16 v[224:227], v[196:199], v[212:215], v[224:227]
    v_mfma_f32_16x16x32_bf16 v[224:227], v[200:203], v[216:219], v[224:227]
    ds_read_b128 v[212:215], v26 offset:4608
    ds_read_b128 v[192:195], v29 offset:9216
    ds_read_b128 v[196:199], v29 offset:10240
    ds_read_b64 v[216:217], v27 offset:4608
    ds_read_b128 v[200:203], v29 offset:11264
    s_waitcnt lgkmcnt(5)
    v_mfma_f32_16x16x32_bf16 v[220:223], v[180:183], v[204:207], v[220:223]
    v_mfma_f32_16x16x32_bf16 v[224:227], v[184:187], v[204:207], v[224:227]
    v_mfma_f32_16x16x32_bf16 v[224:227], v[188:191], v[208:211], v[224:227]
    s_waitcnt lgkmcnt(0)
    v_mfma_f32_16x16x32_bf16 v[220:223], v[192:195], v[212:215], v[220:223]
    v_mfma_f32_16x16x32_bf16 v[224:227], v[196:199], v[212:215], v[224:227]
    v_mfma_f32_16x16x32_bf16 v[224:227], v[200:203], v[216:219], v[224:227]
    s_nop 0
    v_cvt_pk_bf16_f32 v220, v220, v221
    v_cvt_pk_bf16_f32 v221, v222, v223
    s_nop 4
    v_cvt_pk_bf16_f32 v222, v224, v225
    v_cvt_pk_bf16_f32 v223, v226, v227
    v_mov_b32 v224, v220
    v_mov_b32 v225, v221
    v_mov_b32_dpp v220, v222 row_ror:8 row_mask:0xf bank_mask:0xc
    v_mov_b32_dpp v221, v223 row_ror:8 row_mask:0xf bank_mask:0xc
    v_mov_b32_dpp v222, v224 row_ror:8 row_mask:0xf bank_mask:0x3
    v_mov_b32_dpp v223, v225 row_ror:8 row_mask:0xf bank_mask:0x3
    s_mov_b32 s49, 5505024
    buffer_store_dwordx4 v[220:223], v30, s[4:7], s49 offen sc1
    s_waitcnt vmcnt(0)
L_fp_114:
    s_mov_b32 s51, 5505024
    buffer_load_dwordx4 v[96:99], v31, s[4:7], s51 offen sc1
    s_mov_b32 s51, 7143424
    buffer_load_dwordx4 v[148:151], v31, s[4:7], s51 offen sc1
    s_mov_b32 s51, 6815744
    buffer_load_dwordx4 v[152:155], v31, s[4:7], s51 offen sc1
    s_mov_b32 s51, 6488064
    buffer_load_dwordx4 v[156:159], v31, s[4:7], s51 offen sc1
    s_mov_b32 s51, 6160384
    buffer_load_dwordx4 v[160:163], v31, s[4:7], s51 offen sc1
    s_mov_b32 s51, 5832704
    buffer_load_dwordx4 v[92:95], v31, s[4:7], s51 offen sc1
    s_sub_u32 s36, s36, 1
    s_cbranch_scc1 L_exit
    s_waitcnt vmcnt(0)
L_fp_114c:
    v_mov_b32 v41, 0
    v_max3_u32 v41, v41, v96, v97
    v_max3_u32 v41, v41, v98, v99
    v_max3_u32 v41, v41, v148, v149
    v_max3_u32 v41, v41, v150, v151
    v_max3_u32 v41, v41, v152, v153
    v_max3_u32 v41, v41, v154, v155
    v_max3_u32 v41, v41, v156, v157
    v_max3_u32 v41, v41, v158, v159
    v_max3_u32 v41, v41, v160, v161
    v_max3_u32 v41, v41, v162, v163
    v_max3_u32 v41, v41, v92, v93
    v_max3_u32 v41, v41, v94, v95
    v_cmp_eq_u32 vcc, -1, v41
    s_cbranch_vccnz L_fp_114
    s_mov_b32 s52, 5160960
    v_mfma_f32_16x16x32_bf16 v[232:235], a[144:147], v[96:99], 0
    s_nop 7
    v_cndmask_b32 v234, v232, v233, s[58:59]
    v_cndmask_b32 v235, v233, v232, s[58:59]
    s_nop 1
    v_add_f32_dpp v235, v234, v235 row_ror:8 row_mask:0xf bank_mask:0xf
    v_cvt_pk_bf16_f32 v235, v235, v235
    buffer_store_short v235, v32, s[28:31], s52 offen offset:0
    s_mov_b32 s52, 4751360
    v_mfma_f32_16x16x32_bf16 v[232:235], a[144:147], v[148:151], 0
    s_nop 7
    v_cndmask_b32 v234, v232, v233, s[58:59]
    v_cndmask_b32 v235, v233, v232, s[58:59]
    s_nop 1
    v_add_f32_dpp v235, v234, v235 row_ror:8 row_mask:0xf bank_mask:0xf
    v_cvt_pk_bf16_f32 v235, v235, v235
    buffer_store_short v235, v32, s[28:31], s52 offen offset:0
    s_mov_b32 s52, 4833280
    v_mfma_f32_16x16x32_bf16 v[232:235], a[144:147], v[152:155], 0
    s_nop 7
    v_cndmask_b32 v234, v232, v233, s[58:59]
    v_cndmask_b32 v235, v233, v232, s[58:59]
    s_nop 1
    v_add_f32_dpp v235, v234, v235 row_ror:8 row_mask:0xf bank_mask:0xf
    v_cvt_pk_bf16_f32 v235, v235, v235
    buffer_store_short v235, v32, s[28:31], s52 offen offset:0
    s_mov_b32 s52, 4915200
    v_mfma_f32_16x16x32_bf16 v[232:235], a[144:147], v[156:159], 0
    s_nop 7
    v_cndmask_b32 v234, v232, v233, s[58:59]
    v_cndmask_b32 v235, v233, v232, s[58:59]
    s_nop 1
    v_add_f32_dpp v235, v234, v235 row_ror:8 row_mask:0xf bank_mask:0xf
    v_cvt_pk_bf16_f32 v235, v235, v235
    buffer_store_short v235, v32, s[28:31], s52 offen offset:0
    s_mov_b32 s52, 4997120
    v_mfma_f32_16x16x32_bf16 v[232:235], a[144:147], v[160:163], 0
    s_nop 7
    v_cndmask_b32 v234, v232, v233, s[58:59]
    v_cndmask_b32 v235, v233, v232, s[58:59]
    s_nop 1
    v_add_f32_dpp v235, v234, v235 row_ror:8 row_mask:0xf bank_mask:0xf
    v_cvt_pk_bf16_f32 v235, v235, v235
    buffer_store_short v235, v32, s[28:31], s52 offen offset:0
    s_mov_b32 s52, 5079040
    v_mfma_f32_16x16x32_bf16 v[232:235], a[144:147], v[92:95], 0
    s_nop 7
    v_cndmask_b32 v234, v232, v233, s[58:59]
    v_cndmask_b32 v235, v233, v232, s[58:59]
    s_nop 1
    v_add_f32_dpp v235, v234, v235 row_ror:8 row_mask:0xf bank_mask:0xf
    v_cvt_pk_bf16_f32 v235, v235, v235
    buffer_store_short v235, v32, s[28:31], s52 offen offset:0
    s_endpgm
L_sd_89c:
    v_mov_b32 v3, 204
L_p0_115:
    buffer_load_dword v4, v3, s[8:11], 0 offen sc1
    s_sub_u32 s36, s36, 1
    s_cbranch_scc1 L_exit
    s_waitcnt vmcnt(0)
    v_readfirstlane_b32 s90, v4
    s_nop 0
    s_cmp_eq_u32 s90, 0
    s_cbranch_scc1 L_p0_115
    s_and_b32 s90, s90, 2
    s_lshl_b32 s90, s90, 12
    v_xor_b32 v140, s90, v140
    v_xor_b32 v141, s90, v141
    v_xor_b32 v143, s90, v143
    v_xor_b32 v144, s90, v144
    s_branch L_sd_89
L_an_90:
    s_cmp_lg_u32 s55, 0
    s_cbranch_scc1 L_an_90x
    buffer_load_dword v139, v142, s[4:7], s38 offen sc1
    buffer_load_dword v139, v142, s[4:7], s38 offen sc1
    buffer_load_dword v139, v142, s[4:7], s38 offen sc1
L_sp_116:
    buffer_load_dword v139, v142, s[4:7], s38 offen sc1
    s_sub_u32 s36, s36, 1
    s_cbranch_scc1 L_exit
    s_waitcnt vmcnt(3)
    v_cmp_ge_u32 vcc, s37, v139
    s_cbranch_vccnz L_sp_116
L_an_90x:
    s_barrier
    s_lshl_b32 s90, s32, 10
    s_add_u32 m0, s90, s47
    s_waitcnt lgkmcnt(2)
    v_mfma_f32_16x16x32_bf16 v[108:111], a[0:3], v[84:87], 0
    ds_read_b128 v[100:103], v11 offset:4096
    s_add_u32 s51, s37, 3
    v_mfma_f32_16x16x32_bf16 v[112:115], a[0:3], v[88:91], 0
    ds_read_b128 v[104:107], v11 offset:6144
    s_and_b32 s50, s51, 3
    v_mfma_f32_16x16x32_bf16 v[116:119], a[80:83], v[84:87], 0
    s_mul_i32 s50, s50, 114688
    s_add_u32 s50, s50, 65536
    v_mfma_f32_16x16x32_bf16 v[120:123], a[80:83], v[88:91], 0
    s_waitcnt lgkmcnt(2)
    s_add_u32 s44, s38, s50
    v_mfma_f32_16x16x32_bf16 v[108:111], a[4:7], v[92:95], v[108:111]
    ds_read_b128 v[84:87], v12 offset:4096
    s_add_u32 s45, s44, s56
    v_mfma_f32_16x16x32_bf16 v[112:115], a[4:7], v[96:99], v[112:115]
    ds_read_b128 v[88:91], v12 offset:6144
    s_add_u32 s37, s37, 1
    v_mfma_f32_16x16x32_bf16 v[116:119], a[84:87], v[92:95], v[116:119]
    s_mov_b32 s52, 0
    s_and_b32 s50, s37, 3
    v_mfma_f32_16x16x32_bf16 v[120:123], a[84:87], v[96:99], v[120:123]
    s_waitcnt lgkmcnt(2)
    s_mul_i32 s51, s50, 114688
    v_mfma_f32_16x16x32_bf16 v[108:111], a[8:11], v[100:103], v[108:111]
    ds_read_b128 v[92:95], v11 offset:8192
    s_add_u32 s41, s38, s51
    v_mfma_f32_16x16x32_bf16 v[112:115], a[8:11], v[104:107], v[112:115]
    ds_read_b128 v[96:99], v11 offset:10240
    v_mfma_f32_16x16x32_bf16 v[116:119], a[88:91], v[100:103], v[116:119]
    v_mfma_f32_16x16x32_bf16 v[120:123], a[88:91], v[104:107], v[120:123]
    s_waitcnt lgkmcnt(2)
    v_mfma_f32_16x16x32_bf16 v[108:111], a[12:15], v[84:87], v[108:111]
    ds_read_b128 v[100:103], v12 offset:8192
    v_mfma_f32_16x16x32_bf16 v[112:115], a[12:15], v[88:91], v[112:115]
    ds_read_b128 v[104:107], v12 offset:10240
    v_mfma_f32_16x16x32_bf16 v[116:119], a[92:95], v[84:87], v[116:119]
    v_mfma_f32_16x16x32_bf16 v[120:123], a[92:95], v[88:91], v[120:123]
    buffer_store_dword v20, v140, s[4:7], 0 offen sc1
    s_waitcnt lgkmcnt(2)
    v_mfma_f32_16x16x32_bf16 v[108:111], a[16:19], v[92:95], v[108:111]
    ds_read_b128 v[84:87], v11 offset:12288
    v_mfma_f32_16x16x32_bf16 v[112:115], a[16:19], v[96:99], v[112:115]
    ds_read_b128 v[88:91], v11 offset:14336
    v_mfma_f32_16x16x32_bf16 v[116:119], a[96:99], v[92:95], v[116:119]
    v_mfma_f32_16x16x32_bf16 v[120:123], a[96:99], v[96:99], v[120:123]
    buffer_store_dword v20, v141, s[4:7], 0 offen sc1
    s_waitcnt lgkmcnt(2)
    v_mfma_f32_16x16x32_bf16 v[108:111], a[20:23], v[100:103], v[108:111]
    ds_read_b128 v[92:95], v12 offset:12288
    v_mfma_f32_16x16x32_bf16 v[112:115], a[20:23], v[104:107], v[112:115]
    ds_read_b128 v[96:99], v12 offset:14336
    v_mfma_f32_16x16x32_bf16 v[116:119], a[100:103], v[100:103], v[116:119]
    v_mfma_f32_16x16x32_bf16 v[120:123], a[100:103], v[104:107], v[120:123]
    s_waitcnt lgkmcnt(2)
    v_mfma_f32_16x16x32_bf16 v[108:111], a[24:27], v[84:87], v[108:111]
    ds_read_b128 v[100:103], v11 offset:16384
    v_mfma_f32_16x16x32_bf16 v[112:115], a[24:27], v[88:91], v[112:115]
    ds_read_b128 v[104:107], v11 offset:18432
    v_mfma_f32_16x16x32_bf16 v[116:119], a[104:107], v[84:87], v[116:119]
    v_mfma_f32_16x16x32_bf16 v[120:123], a[104:107], v[88:91], v[120:123]
    s_waitcnt lgkmcnt(2)
    v_mfma_f32_16x16x32_bf16 v[108:111], a[28:31], v[92:95], v[108:111]
    ds_read_b128 v[84:87], v12 offset:16384
    v_mfma_f32_16x16x32_bf16 v[112:115], a[28:31], v[96:99], v[112:115]
    ds_read_b128 v[88:91], v12 offset:18432
    v_mfma_f32_16x16x32_bf16 v[116:119], a[108:111], v[92:95], v[116:119]
    v_mfma_f32_16x16x32_bf16 v[120:123], a[108:111], v[96:99], v[120:123]
    s_waitcnt lgkmcnt(2)
    v_mfma_f32_16x16x32_bf16 v[108:111], a[32:35], v[100:103], v[108:111]
    ds_read_b128 v[92:95], v11 offset:20480
    v_mfma_f32_16x16x32_bf16 v[112:115], a[32:35], v[104:107], v[112:115]
    ds_read_b128 v[96:99], v11 offset:22528
    v_mfma_f32_16x16x32_bf16 v[116:119], a[112:115], v[100:103], v[116:119]
    v_mfma_f32_16x16x32_bf16 v[120:123], a[112:115], v[104:107], v[120:123]
    s_waitcnt lgkmcnt(2)
    v_mfma_f32_16x16x32_bf16 v[108:111], a[36:39], v[84:87], v[108:111]
    ds_read_b128 v[100:103], v12 offset:20480
    v_mfma_f32_16x16x32_bf16 v[112:115], a[36:39], v[88:91], v[112:115]
    ds_read_b128 v[104:107], v12 offset:22528
    v_mfma_f32_16x16x32_bf16 v[116:119], a[116:119], v[84:87], v[116:119]
    v_mfma_f32_16x16x32_bf16 v[120:123], a[116:119], v[88:91], v[120:123]
    s_waitcnt lgkmcnt(2)
    v_mfma_f32_16x16x32_bf16 v[108:111], a[40:43], v[92:95], v[108:111]
    ds_read_b128 v[84:87], v11 offset:24576
    v_mfma_f32_16x16x32_bf16 v[112:115], a[40:43], v[96:99], v[112:115]
    ds_read_b128 v[88:91], v11 offset:26624
    v_mfma_f32_16x16x32_bf16 v[116:119], a[120:123], v[92:95], v[116:119]
    v_mfma_f32_16x16x32_bf16 v[120:123], a[120:123], v[96:99], v[120:123]
    s_waitcnt lgkmcnt(2)
    v_mfma_f32_16x16x32_bf16 v[108:111], a[44:47], v[100:103], v[108:111]
    ds_read_b128 v[92:95], v12 offset:24576
    v_mfma_f32_16x16x32_bf16 v[112:115], a[44:47], v[104:107], v[112:115]
    ds_read_b128 v[96:99], v12 offset:26624
    v_mfma_f32_16x16x32_bf16 v[116:119], a[124:127], v[100:103], v[116:119]
    v_mfma_f32_16x16x32_bf16 v[120:123], a[124:127], v[104:107], v[120:123]
    s_waitcnt lgkmcnt(2)
    v_mfma_f32_16x16x32_bf16 v[108:111], a[48:51], v[84:87], v[108:111]
    ds_read_b128 v[100:103], v11 offset:28672
    v_mfma_f32_16x16x32_bf16 v[112:115], a[48:51], v[88:91], v[112:115]
    ds_read_b128 v[104:107], v11 offset:30720
    v_mfma_f32_16x16x32_bf16 v[116:119], a[128:131], v[84:87], v[116:119]
    buffer_store_dword v20, v147, s[4:7], s38 offen sc1
    buffer_store_dword v22, v135, s[4:7], s42 offen offset:0 sc1
    buffer_store_dword v22, v135, s[4:7], s42 offen offset:1024 sc1
    v_mfma_f32_16x16x32_bf16 v[120:123], a[128:131], v[88:91], v[120:123]
    s_waitcnt lgkmcnt(2)
    v_mfma_f32_16x16x32_bf16 v[108:111], a[52:55], v[92:95], v[108:111]
    ds_read_b128 v[84:87], v12 offset:28672
    v_mfma_f32_16x16x32_bf16 v[112:115], a[52:55], v[96:99], v[112:115]
    ds_read_b128 v[88:91], v12 offset:30720
    v_mfma_f32_16x16x32_bf16 v[116:119], a[132:135], v[92:95], v[116:119]
    buffer_load_dwordx4 v10, s[24:27], s46 offen offset:0 lds
    s_add_u32 m0, m0, 3968
    v_mfma_f32_16x16x32_bf16 v[120:123], a[132:135], v[96:99], v[120:123]
    s_waitcnt lgkmcnt(2)
    v_mfma_f32_16x16x32_bf16 v[108:111], a[56:59], v[100:103], v[108:111]
    ds_read_b128 v[92:95], v11 offset:32768
    v_mfma_f32_16x16x32_bf16 v[112:115], a[56:59], v[104:107], v[112:115]
    ds_read_b128 v[96:99], v11 offset:34816
    v_mfma_f32_16x16x32_bf16 v[116:119], a[136:139], v[100:103], v[116:119]
    buffer_load_dwordx4 v10, s[24:27], s46 offen offset:128 lds
    s_add_u32 m0, m0, 3968
    v_mfma_f32_16x16x32_bf16 v[120:123], a[136:139], v[104:107], v[120:123]
    s_waitcnt lgkmcnt(2)
    v_mfma_f32_16x16x32_bf16 v[108:111], a[60:63], v[84:87], v[108:111]
    ds_read_b128 v[100:103], v12 offset:32768
    v_mfma_f32_16x16x32_bf16 v[112:115], a[60:63], v[88:91], v[112:115]
    ds_read_b128 v[104:107], v12 offset:34816
    v_mfma_f32_16x16x32_bf16 v[116:119], a[140:143], v[84:87], v[116:119]
    buffer_load_dwordx4 v10, s[24:27], s46 offen offset:256 lds
    s_add_u32 m0, m0, 3968
    v_mfma_f32_16x16x32_bf16 v[120:123], a[140:143], v[88:91], v[120:123]
    s_waitcnt lgkmcnt(2)
    v_mfma_f32_16x16x32_bf16 v[108:111], a[64:67], v[92:95], v[108:111]
    ds_read_b128 v[84:87], v11 offset:36864
    v_mfma_f32_16x16x32_bf16 v[112:115], a[64:67], v[96:99], v[112:115]
    ds_read_b128 v[88:91], v11 offset:38912
    v_mfma_f32_16x16x32_bf16 v[116:119], a[144:147], v[92:95], v[116:119]
    buffer_load_dwordx4 v10, s[24:27], s46 offen offset:384 lds
    s_add_u32 m0, m0, 3968
    v_mfma_f32_16x16x32_bf16 v[120:123], a[144:147], v[96:99], v[120:123]
    s_waitcnt lgkmcnt(2)
    v_mfma_f32_16x16x32_bf16 v[108:111], a[68:71], v[100:103], v[108:111]
    ds_read_b128 v[92:95], v12 offset:36864
    v_mfma_f32_16x16x32_bf16 v[112:115], a[68:71], v[104:107], v[112:115]
    ds_read_b128 v[96:99], v12 offset:38912
    v_mfma_f32_16x16x32_bf16 v[116:119], a[148:151], v[100:103], v[116:119]
    buffer_load_dwordx4 v10, s[24:27], s46 offen offset:512 lds
    s_add_u32 m0, m0, 3968
    v_mfma_f32_16x16x32_bf16 v[120:123], a[148:151], v[104:107], v[120:123]
    s_waitcnt lgkmcnt(0)
    buffer_load_dwordx4 v10, s[24:27], s46 offen offset:640 lds
    s_add_u32 m0, m0, 3968
    s_nop 0
    buffer_load_dwordx4 v10, s[24:27], s46 offen offset:768 lds
    s_add_u32 m0, m0, 3968
    s_nop 0
    buffer_load_dwordx4 v10, s[24:27], s46 offen offset:896 lds
    s_add_u32 m0, m0, 3968
    s_nop 0
    buffer_load_dwordx4 v10, s[24:27], s46 offen offset:1024 lds
    s_add_u32 m0, m0, 3968
    s_nop 0
    buffer_load_dwordx4 v10, s[24:27], s46 offen offset:1152 lds
    v_mfma_f32_16x16x32_bf16 v[108:111], a[72:75], v[84:87], v[108:111]
    v_add_u32 v11, s49, v11
    v_mfma_f32_16x16x32_bf16 v[112:115], a[72:75], v[88:91], v[112:115]
    v_add_u32 v12, s49, v12
    v_mfma_f32_16x16x32_bf16 v[108:111], a[76:79], v[92:95], v[108:111]
    s_sub_u32 s47, s47, s49
    v_mfma_f32_16x16x32_bf16 v[112:115], a[76:79], v[96:99], v[112:115]
    s_sub_u32 s49, 0, s49
    v_mfma_f32_16x16x32_bf16 v[116:119], a[152:155], v[84:87], v[116:119]
    v_mfma_f32_16x16x32_bf16 v[120:123], a[152:155], v[88:91], v[120:123]
    v_mfma_f32_16x16x32_bf16 v[116:119], a[156:159], v[92:95], v[116:119]
    v_mfma_f32_16x16x32_bf16 v[120:123], a[156:159], v[96:99], v[120:123]
    v_cvt_pk_bf16_f32 v124, v108, v109
    v_cvt_pk_bf16_f32 v125, v110, v111
    v_cvt_pk_bf16_f32 v126, v112, v113
    v_cvt_pk_bf16_f32 v127, v114, v115
    s_nop 0
    v_permlane16_swap_b32 v124, v126
    v_permlane16_swap_b32 v125, v127
    v_cvt_pk_bf16_f32 v128, v116, v117
    v_cvt_pk_bf16_f32 v129, v118, v119
    v_cvt_pk_bf16_f32 v130, v120, v121
    v_cvt_pk_bf16_f32 v131, v122, v123
    s_nop 0
    v_permlane16_swap_b32 v128, v130
    v_permlane16_swap_b32 v129, v131
    buffer_store_dwordx4 v[124:127], v19, s[4:7], s44 offen sc1
    buffer_store_dwordx4 v[128:131], v19, s[4:7], s45 offen sc1
    s_branch L_v_loop_s
L_fw_91c:
    v_mov_b32 v148, -1
    v_mov_b32 v149, -1
    v_mov_b32 v150, -1
    v_mov_b32 v151, -1
    v_mov_b32 v152, -1
    v_mov_b32 v153, -1
    v_mov_b32 v154, -1
    v_mov_b32 v155, -1
    s_add_u32 s53, s53, 2293760
    buffer_store_dwordx4 v[148:151], v143, s[4:7], s53 offen offset:0 sc1
    buffer_store_dwordx4 v[152:155], v143, s[4:7], s53 offen offset:1024 sc1
    s_sub_u32 s53, s53, 983040
    s_branch L_fw_91
L_sp_104:
    s_cmp_eq_u32 s57, s37
    s_cbranch_scc1 L_sg_105
    s_mov_b32 s57, s37
L_sp_104s:
    buffer_load_dwordx4 v[92:95], v38, s[4:7], s43 offen offset:0 sc1
    buffer_load_dwordx4 v[96:99], v38, s[4:7], s43 offen offset:1280 sc1
    buffer_load_dwordx4 v[100:103], v38, s[4:7], s43 offen offset:2560 sc1
    buffer_load_dword v104, v39, s[4:7], s43 offen offset:0 sc1
    buffer_load_dword v105, v39, s[4:7], s43 offen offset:1280 sc1
    buffer_load_dword v106, v39, s[4:7], s43 offen offset:2560 sc1
    s_sub_u32 s36, s36, 1
    s_cbranch_scc1 L_exit
    s_waitcnt vmcnt(0)
    v_max3_u32 v4, v104, v105, v106
    v_max3_u32 v4, v4, v92, v93
    v_max3_u32 v4, v4, v94, v95
    v_max3_u32 v4, v4, v96, v97
    v_max3_u32 v4, v4, v98, v99
    v_max3_u32 v4, v4, v100, v101
    v_max3_u32 v4, v4, v102, v103
    v_cmp_eq_u32 vcc, -1, v4
    s_cbranch_vccnz L_sp_104s
    v_mov_b32 v129, 0
    v_mov_b32 v130, 0
    v_mov_b32 v131, 0
    v_mov_b32 v132, 0
    v_mov_b32 v133, 0
    v_mov_b32 v134, 0
    v_mov_b32 v135, 0
    v_mov_b32 v116, 0
    v_mov_b32 v117, 0
    v_mov_b32 v118, 0
    v_mov_b32 v119, 0
L_sp_104v:
    buffer_load_dwordx4 v44, s[4:7], s43 offen offset:0 sc1 lds
    buffer_load_dwordx4 v44, s[4:7], s43 offen offset:1024 sc1 lds
    buffer_load_dwordx4 v44, s[4:7], s43 offen offset:2048 sc1 lds
    s_sub_u32 s36, s36, 1
    s_cbranch_scc1 L_exit
    v_add_u32 v5, s53, v12
    s_waitcnt vmcnt(0)
    ds_read_b128 v[136:139], v5 offset:0
    ds_read_b128 v[140:143], v5 offset:1024
    ds_read_b128 v[144:147], v5 offset:2048
    s_waitcnt lgkmcnt(0)
    v_max_u32 v4, v136, v137
    v_max3_u32 v4, v4, v138, v139
    v_max3_u32 v4, v4, v140, v141
    v_max3_u32 v4, v4, v142, v143
    v_max3_u32 v4, v4, v144, v145
    v_max3_u32 v4, v4, v146, v147
    v_cmp_eq_u32 vcc, -1, v4
    s_cbranch_vccnz L_sp_104v
    ds_read_b64_tr_b16 v[136:137], v16 offset:0
    ds_read_b64_tr_b16 v[138:139], v13 offset:0
    ds_read_b64_tr_b16 v[140:141], v16 offset:1024
    ds_read_b64_tr_b16 v[142:143], v13 offset:1024
    ds_read_b64_tr_b16 v[144:145], v16 offset:2048
    ds_read_b64_tr_b16 v[146:147], v13 offset:2048
    v_mov_b32 v148, 0
    v_mov_b32 v149, 0
    v_mov_b32 v150, 0
    v_mov_b32 v151, 0
    v_mov_b32 v152, 0
    v_mov_b32 v153, 0
    v_mov_b32 v154, 0
    v_mov_b32 v155, 0
    v_mov_b32 v156, 0
    v_mov_b32 v157, 0
    v_mov_b32 v158, 0
    v_mov_b32 v159, 0
    v_mov_b32 v160, 0
    v_mov_b32 v161, 0
    v_mov_b32 v162, 0
    v_mov_b32 v163, 0
    s_waitcnt lgkmcnt(0)
    v_smfmac_f32_16x16x64_bf16 v[148:151], v[136:139], a[0:7], v10
    v_smfmac_f32_16x16x64_bf16 v[152:155], v[136:139], a[24:31], v10
    v_smfmac_f32_16x16x64_bf16 v[156:159], v[136:139], a[48:55], v10
    v_smfmac_f32_16x16x64_bf16 v[160:163], v[136:139], a[72:79], v10
    v_smfmac_f32_16x16x64_bf16 v[148:151], v[140:143], a[8:15], v10
    v_smfmac_f32_16x16x64_bf16 v[152:155], v[140:143], a[32:39], v10
    v_smfmac_f32_16x16x64_bf16 v[156:159], v[140:143], a[56:63], v10
    v_smfmac_f32_16x16x64_bf16 v[160:163], v[140:143], a[80:87], v10
    v_smfmac_f32_16x16x64_bf16 v[148:151], v[144:147], a[16:23], v10
    v_smfmac_f32_16x16x64_bf16 v[152:155], v[144:147], a[40:47], v10
    v_smfmac_f32_16x16x64_bf16 v[156:159], v[144:147], a[64:71], v10
    v_smfmac_f32_16x16x64_bf16 v[160:163], v[144:147], a[88:95], v10
    s_nop 3
    s_branch L_sc_103
L_px_s:
    v_and_b32 v1, 15, v0
    v_lshrrev_b32 v2, 4, v0
    s_mul_i32 s90, s32, 12288
    v_lshl_add_u32 v10, v0, 4, s90
    s_mul_i32 s90, s32, 3072
    v_lshl_add_u32 v12, v0, 4, s90
    v_lshrrev_b32 v3, 2, v1
    v_lshlrev_b32 v3, 1, v3
    v_and_b32 v4, 1, v1
    v_or_b32 v3, v3, v4
    v_lshl_add_u32 v3, v2, 3, v3
    v_lshl_add_u32 v11, v3, 4, s90
    s_lshl_b32 s90, s32, 7
    v_min_u32 v3, 11, v0
    v_lshl_add_u32 v3, v3, 2, s90
    v_add_u32 v13, 458752, v3
    v_min_u32 v3, 2, v0
    v_lshl_add_u32 v3, v3, 2, s90
    v_add_u32 v14, 459264, v3
    v_add_u32 v22, 462336, v3
    s_add_u32 s90, s90, 459776
    v_mov_b32 v15, s90
    v_cmp_eq_u32 vcc, 0, v0
    v_mov_b32 v9, 2146435072
    s_nop 0
    v_cndmask_b32 v15, v9, v15, vcc
    s_nop 0
    v_mov_b32 v21, 0xd04e79ff
    s_mov_b32 s44, 0x3dd53b95
    v_lshl_add_u32 v3, v2, 2, 0
    v_cmp_le_u32 s[48:49], v3, v1
    v_lshl_add_u32 v3, v2, 2, 1
    v_cmp_le_u32 s[50:51], v3, v1
    v_lshl_add_u32 v3, v2, 2, 2
    v_cmp_le_u32 s[52:53], v3, v1
    v_lshl_add_u32 v3, v2, 2, 3
    v_cmp_le_u32 s[54:55], v3, v1
    v_mov_b32 v167, 0
    v_mov_b32 v171, 0
    v_mov_b32 v174, 0
    v_mov_b32 v175, 0
    s_mov_b32 s37, 0
    v_mov_b32 v1, 196
L_gw_118:
    buffer_load_dword v2, v1, s[8:11], 0 offen sc1
    s_sub_u32 s36, s36, 1
    s_cbranch_scc1 L_exit
    s_waitcnt vmcnt(0)
L_gw_118c:
    v_readfirstlane_b32 s90, v2
    s_nop 0
    s_cmp_eq_u32 s90, 0
    s_cbranch_scc1 L_gw_118
    s_cmp_lg_u32 s32, 0
    s_cbranch_scc1 L_xg_117
    s_lshl_b32 s92, s34, 14
    s_add_u32 s92, s92, 1966080
    s_add_u32 s93, s92, 8192
    v_lshlrev_b32 v3, 4, v0
    buffer_store_dwordx4 v[24:27], v3, s[4:7], s92 offen offset:0 sc1
    buffer_store_dwordx4 v[24:27], v3, s[4:7], s93 offen offset:0 sc1
    buffer_store_dwordx4 v[24:27], v3, s[4:7], s92 offen offset:1024 sc1
    buffer_store_dwordx4 v[24:27], v3, s[4:7], s93 offen offset:1024 sc1
    buffer_store_dwordx4 v[24:27], v3, s[4:7], s92 offen offset:2048 sc1
    buffer_store_dwordx4 v[24:27], v3, s[4:7], s93 offen offset:2048 sc1
    buffer_store_dwordx4 v[24:27], v3, s[4:7], s92 offen offset:3072 sc1
    buffer_store_dwordx4 v[24:27], v3, s[4:7], s93 offen offset:3072 sc1
    v_mov_b32 v3, 0
    s_mov_b32 s56, -1
    s_mov_b32 s57, -1
    s_mov_b32 s62, 0
    s_mov_b32 s63, 0
    s_waitcnt vmcnt(0)
L_pr_119:
    s_memtime s[58:59]
    s_waitcnt lgkmcnt(0)
    buffer_load_dword v4, v3, s[4:7], s92 offen sc1
    s_waitcnt vmcnt(0)
    s_memtime s[60:61]
    s_waitcnt lgkmcnt(0)
    s_sub_u32 s60, s60, s58
    s_min_u32 s56, s56, s60
    s_memtime s[58:59]
    s_waitcnt lgkmcnt(0)
    buffer_load_dword v4, v3, s[4:7], s93 offen sc1
    s_waitcnt vmcnt(0)
    s_memtime s[60:61]
    s_waitcnt lgkmcnt(0)
    s_sub_u32 s60, s60, s58
    s_min_u32 s57, s57, s60
    buffer_load_dword v4, v13, s[4:7], s38 offen sc1
    v_add_u32 v3, 128, v3
    s_add_u32 s62, s62, 1
    s_waitcnt vmcnt(0)
    v_cmp_eq_u32 vcc, 0, v4
    s_nop 0
    s_cmp_eq_u64 vcc, 0
    s_addc_u32 s63, s63, 0
    s_cmp_ge_u32 s63, 2
    s_cselect_b32 s62, 32, s62
    s_min_u32 s58, s56, s57
    s_max_u32 s59, s56, s57
    s_sub_u32 s59, s59, s58
    s_cmp_ge_u32 s59, 150
    s_cselect_b32 s58, s58, -1
    s_cmp_le_u32 s58, 540
    s_cselect_b32 s62, 32, s62
    s_cmp_lt_u32 s62, 32
    s_cbranch_scc1 L_pr_119
    s_cmp_lt_u32 s57, s56
    s_cselect_b32 s62, 2, 1
    s_nop 0
    v_mov_b32 v3, 460288
    v_mov_b32 v4, s62
    buffer_store_dword v4, v3, s[4:7], s38 offen sc1
    s_cmp_lg_u32 s34, 0
    s_cbranch_scc1 L_xg_117
    v_mov_b32 v3, 204
    buffer_store_dword v4, v3, s[8:11], 0 offen sc1
L_xg_117:
    s_barrier
    s_add_u32 s41, s38, 475136
    buffer_load_dword v16, v22, s[4:7], s38 offen sc1
    buffer_load_dword v16, v22, s[4:7], s38 offen sc1
L_sp_120:
    buffer_load_dword v16, v22, s[4:7], s38 offen sc1
    s_sub_u32 s36, s36, 1
    s_cbranch_scc1 L_exit
    s_waitcnt vmcnt(2)
    v_cmp_ge_u32 vcc, s37, v16
    s_cbranch_vccnz L_sp_120
    s_add_u32 s90, s41, 49152
    buffer_load_dwordx4 v[72:75], v10, s[4:7], s90 offen offset:0 sc1
    buffer_load_dwordx4 v[76:79], v10, s[4:7], s90 offen offset:1024 sc1
    buffer_load_dwordx4 v[80:83], v10, s[4:7], s90 offen offset:2048 sc1
    buffer_load_dwordx4 v[84:87], v10, s[4:7], s90 offen offset:3072 sc1
    s_add_u32 s90, s41, 53248
    buffer_load_dwordx4 v[88:91], v10, s[4:7], s90 offen offset:0 sc1
    buffer_load_dwordx4 v[92:95], v10, s[4:7], s90 offen offset:1024 sc1
    buffer_load_dwordx4 v[96:99], v10, s[4:7], s90 offen offset:2048 sc1
    buffer_load_dwordx4 v[100:103], v10, s[4:7], s90 offen offset:3072 sc1
    s_add_u32 s90, s41, 57344
    buffer_load_dwordx4 v[104:107], v10, s[4:7], s90 offen offset:0 sc1
    buffer_load_dwordx4 v[108:111], v10, s[4:7], s90 offen offset:1024 sc1
    buffer_load_dwordx4 v[112:115], v10, s[4:7], s90 offen offset:2048 sc1
    buffer_load_dwordx4 v[116:119], v10, s[4:7], s90 offen offset:3072 sc1
    s_add_u32 s90, s41, 0
    buffer_load_dwordx4 v[24:27], v10, s[4:7], s90 offen offset:0 sc1
    buffer_load_dwordx4 v[28:31], v10, s[4:7], s90 offen offset:1024 sc1
    buffer_load_dwordx4 v[32:35], v10, s[4:7], s90 offen offset:2048 sc1
    buffer_load_dwordx4 v[36:39], v10, s[4:7], s90 offen offset:3072 sc1
    s_add_u32 s90, s41, 4096
    buffer_load_dwordx4 v[40:43], v10, s[4:7], s90 offen offset:0 sc1
    buffer_load_dwordx4 v[44:47], v10, s[4:7], s90 offen offset:1024 sc1
    buffer_load_dwordx4 v[48:51], v10, s[4:7], s90 offen offset:2048 sc1
    buffer_load_dwordx4 v[52:55], v10, s[4:7], s90 offen offset:3072 sc1
    s_add_u32 s90, s41, 8192
    buffer_load_dwordx4 v[56:59], v10, s[4:7], s90 offen offset:0 sc1
    buffer_load_dwordx4 v[60:63], v10, s[4:7], s90 offen offset:1024 sc1
    buffer_load_dwordx4 v[64:67], v10, s[4:7], s90 offen offset:2048 sc1
    buffer_load_dwordx4 v[68:71], v10, s[4:7], s90 offen offset:3072 sc1
    s_waitcnt vmcnt(0)
L_px_loop_s:
    s_and_b32 s90, s37, 3
    s_mul_i32 s91, s90, 114688
    s_add_u32 s91, s91, s38
    s_add_u32 s42, s91, 40960
    s_add_u32 s43, s91, 53248
    s_add_u32 s90, s37, 1
    v_mov_b32 v17, s90
    s_and_b32 s90, s90, 3
    s_mul_i32 s91, s90, 98304
    s_add_u32 s91, s91, 475136
    s_add_u32 s41, s38, s91
    v_mfma_f32_16x16x32_bf16 v[144:147], v[72:75], v[24:27], 0
    v_mfma_f32_16x16x32_bf16 v[152:155], v[72:75], v[48:51], 0
    v_mfma_f32_16x16x32_bf16 v[156:159], v[96:99], v[48:51], 0
    v_mfma_f32_16x16x32_bf16 v[144:147], v[76:79], v[28:31], v[144:147]
    v_mfma_f32_16x16x32_bf16 v[152:155], v[76:79], v[52:55], v[152:155]
    v_mfma_f32_16x16x32_bf16 v[156:159], v[100:103], v[52:55], v[156:159]
    v_mfma_f32_16x16x32_bf16 v[144:147], v[80:83], v[32:35], v[144:147]
    v_mfma_f32_16x16x32_bf16 v[152:155], v[80:83], v[56:59], v[152:155]
    v_mfma_f32_16x16x32_bf16 v[156:159], v[104:107], v[56:59], v[156:159]
    v_mfma_f32_16x16x32_bf16 v[144:147], v[84:87], v[36:39], v[144:147]
    v_mfma_f32_16x16x32_bf16 v[152:155], v[84:87], v[60:63], v[152:155]
    v_mfma_f32_16x16x32_bf16 v[156:159], v[108:111], v[60:63], v[156:159]
    v_mfma_f32_16x16x32_bf16 v[144:147], v[88:91], v[40:43], v[144:147]
    v_mfma_f32_16x16x32_bf16 v[152:155], v[88:91], v[64:67], v[152:155]
    v_mfma_f32_16x16x32_bf16 v[156:159], v[112:115], v[64:67], v[156:159]
    v_mfma_f32_16x16x32_bf16 v[144:147], v[92:95], v[44:47], v[144:147]
    v_mfma_f32_16x16x32_bf16 v[152:155], v[92:95], v[68:71], v[152:155]
    v_mfma_f32_16x16x32_bf16 v[156:159], v[116:119], v[68:71], v[156:159]
    s_nop 0
    v_cndmask_b32 v144, v21, v144, s[48:49]
    v_cndmask_b32 v145, v21, v145, s[50:51]
    v_cndmask_b32 v146, v21, v146, s[52:53]
    v_cndmask_b32 v147, v21, v147, s[54:55]
    s_nop 2
    v_cndmask_b32 v156, v21, v156, s[48:49]
    v_cndmask_b32 v157, v21, v157, s[50:51]
    v_cndmask_b32 v158, v21, v158, s[52:53]
    v_cndmask_b32 v159, v21, v159, s[54:55]
    buffer_load_dword v16, v14, s[4:7], s38 offen sc1
    buffer_load_dword v16, v14, s[4:7], s38 offen sc1
L_sp_121:
    buffer_load_dword v16, v14, s[4:7], s38 offen sc1
    s_sub_u32 s36, s36, 1
    s_cbranch_scc1 L_exit
    s_waitcnt vmcnt(2)
    v_cmp_ge_u32 vcc, s37, v16
    s_cbranch_vccnz L_sp_121
    buffer_load_dwordx4 v[120:123], v11, s[4:7], s42 offen offset:0 sc1
    buffer_load_dwordx4 v[124:127], v11, s[4:7], s42 offen offset:512 sc1
    buffer_load_dwordx4 v[128:131], v11, s[4:7], s42 offen offset:1024 sc1
    buffer_load_dwordx4 v[132:135], v11, s[4:7], s42 offen offset:1536 sc1
    buffer_load_dwordx4 v[136:139], v11, s[4:7], s42 offen offset:2048 sc1
    buffer_load_dwordx4 v[140:143], v11, s[4:7], s42 offen offset:2560 sc1
    s_waitcnt vmcnt(5)
    v_mfma_f32_16x16x32_bf16 v[148:151], v[120:123], v[24:27], 0
    v_mfma_f32_16x16x32_bf16 v[160:163], v[120:123], v[48:51], 0
    s_waitcnt vmcnt(4)
    v_mfma_f32_16x16x32_bf16 v[148:151], v[124:127], v[28:31], v[148:151]
    v_mfma_f32_16x16x32_bf16 v[160:163], v[124:127], v[52:55], v[160:163]
    s_waitcnt vmcnt(3)
    v_mfma_f32_16x16x32_bf16 v[148:151], v[128:131], v[32:35], v[148:151]
    v_mfma_f32_16x16x32_bf16 v[160:163], v[128:131], v[56:59], v[160:163]
    s_waitcnt vmcnt(2)
    v_mfma_f32_16x16x32_bf16 v[148:151], v[132:135], v[36:39], v[148:151]
    v_mfma_f32_16x16x32_bf16 v[160:163], v[132:135], v[60:63], v[160:163]
    s_waitcnt vmcnt(1)
    v_mfma_f32_16x16x32_bf16 v[148:151], v[136:139], v[40:43], v[148:151]
    v_mfma_f32_16x16x32_bf16 v[160:163], v[136:139], v[64:67], v[160:163]
    s_waitcnt vmcnt(0)
    v_mfma_f32_16x16x32_bf16 v[148:151], v[140:143], v[44:47], v[148:151]
    v_mfma_f32_16x16x32_bf16 v[160:163], v[140:143], v[68:71], v[160:163]
    s_cmp_eq_u32 s37, 63
    s_nop 2
    s_cbranch_scc1 L_pxl_122
    s_add_u32 s90, s41, 49152
    v_max_f32 v18, v144, v145
    v_max3_f32 v18, v18, v146, v147
    v_max3_f32 v18, v18, v148, v149
    v_mov_b32 v19, v18
    buffer_load_dwordx4 v[72:75], v10, s[4:7], s90 offen offset:0 sc1
    s_nop 0
    v_permlane16_swap_b32 v18, v19
    v_max_f32 v18, v18, v19
    v_mov_b32 v19, v18
    s_nop 1
    v_permlane32_swap_b32 v18, v19
    buffer_load_dwordx4 v[76:79], v10, s[4:7], s90 offen offset:1024 sc1
    v_max_f32 v18, v18, v19
    v_sub_f32 v144, v144, v18
    v_sub_f32 v145, v145, v18
    v_sub_f32 v146, v146, v18
    buffer_load_dwordx4 v[80:83], v10, s[4:7], s90 offen offset:2048 sc1
    v_sub_f32 v147, v147, v18
    v_sub_f32 v148, v148, v18
    v_sub_f32 v149, v149, v18
    v_mul_f32 v144, s44, v144
    buffer_load_dwordx4 v[84:87], v10, s[4:7], s90 offen offset:3072 sc1
    v_mul_f32 v145, s44, v145
    v_mul_f32 v146, s44, v146
    v_mul_f32 v147, s44, v147
    v_mul_f32 v148, s44, v148
    s_add_u32 s90, s41, 53248
    v_mul_f32 v149, s44, v149
    v_exp_f32 v144, v144
    v_exp_f32 v145, v145
    v_exp_f32 v146, v146
    buffer_load_dwordx4 v[88:91], v10, s[4:7], s90 offen offset:0 sc1
    v_exp_f32 v147, v147
    v_exp_f32 v148, v148
    v_exp_f32 v149, v149
    v_add_f32 v20, v144, v145
    buffer_load_dwordx4 v[92:95], v10, s[4:7], s90 offen offset:1024 sc1
    v_add_f32 v20, v20, v146
    v_add_f32 v20, v20, v147
    v_add_f32 v20, v20, v148
    v_add_f32 v20, v20, v149
    buffer_load_dwordx4 v[96:99], v10, s[4:7], s90 offen offset:2048 sc1
    v_mov_b32 v19, v20
    s_nop 1
    v_permlane16_swap_b32 v20, v19
    v_add_f32 v20, v20, v19
    v_mov_b32 v19, v20
    buffer_load_dwordx4 v[100:103], v10, s[4:7], s90 offen offset:3072 sc1
    s_nop 0
    v_permlane32_swap_b32 v20, v19
    v_add_f32 v20, v20, v19
    v_rcp_f32 v20, v20
    s_nop 0
    v_mul_f32 v144, v144, v20
    s_add_u32 s90, s41, 57344
    v_mul_f32 v145, v145, v20
    v_mul_f32 v146, v146, v20
    v_mul_f32 v147, v147, v20
    v_mul_f32 v148, v148, v20
    buffer_load_dwordx4 v[104:107], v10, s[4:7], s90 offen offset:0 sc1
    v_mul_f32 v149, v149, v20
    v_cvt_pk_bf16_f32 v164, v144, v145
    v_cvt_pk_bf16_f32 v165, v146, v147
    v_cvt_pk_bf16_f32 v166, v148, v149
    buffer_load_dwordx4 v[108:111], v10, s[4:7], s90 offen offset:1024 sc1
    v_max_f32 v18, v152, v153
    v_max3_f32 v18, v18, v154, v155
    v_max3_f32 v18, v18, v160, v161
    v_max3_f32 v18, v18, v156, v157
    buffer_load_dwordx4 v[112:115], v10, s[4:7], s90 offen offset:2048 sc1
    v_max3_f32 v18, v18, v158, v159
    v_mov_b32 v19, v18
    s_nop 1
    v_permlane16_swap_b32 v18, v19
    v_max_f32 v18, v18, v19
    buffer_load_dwordx4 v[116:119], v10, s[4:7], s90 offen offset:3072 sc1
    v_mov_b32 v19, v18
    s_nop 1
    v_permlane32_swap_b32 v18, v19
    v_max_f32 v18, v18, v19
    v_sub_f32 v152, v152, v18
    s_add_u32 s90, s41, 0
    v_sub_f32 v153, v153, v18
    v_sub_f32 v154, v154, v18
    v_sub_f32 v155, v155, v18
    v_sub_f32 v160, v160, v18
    buffer_load_dwordx4 v[24:27], v10, s[4:7], s90 offen offset:0 sc1
    v_sub_f32 v161, v161, v18
    v_sub_f32 v156, v156, v18
    v_sub_f32 v157, v157, v18
    v_sub_f32 v158, v158, v18
    buffer_load_dwordx4 v[28:31], v10, s[4:7], s90 offen offset:1024 sc1
    v_sub_f32 v159, v159, v18
    v_mul_f32 v152, s44, v152
    v_mul_f32 v153, s44, v153
    v_mul_f32 v154, s44, v154
    buffer_load_dwordx4 v[32:35], v10, s[4:7], s90 offen offset:2048 sc1
    v_mul_f32 v155, s44, v155
    v_mul_f32 v160, s44, v160
    v_mul_f32 v161, s44, v161
    v_mul_f32 v156, s44, v156
    buffer_load_dwordx4 v[36:39], v10, s[4:7], s90 offen offset:3072 sc1
    v_mul_f32 v157, s44, v157
    v_mul_f32 v158, s44, v158
    v_mul_f32 v159, s44, v159
    v_exp_f32 v152, v152
    s_add_u32 s90, s41, 4096
    v_exp_f32 v153, v153
    v_exp_f32 v154, v154
    v_exp_f32 v155, v155
    v_exp_f32 v160, v160
    buffer_load_dwordx4 v[40:43], v10, s[4:7], s90 offen offset:0 sc1
    v_exp_f32 v161, v161
    v_exp_f32 v156, v156
    v_exp_f32 v157, v157
    v_exp_f32 v158, v158
    buffer_load_dwordx4 v[44:47], v10, s[4:7], s90 offen offset:1024 sc1
    v_exp_f32 v159, v159
    v_add_f32 v20, v152, v153
    v_add_f32 v20, v20, v154
    v_add_f32 v20, v20, v155
    buffer_load_dwordx4 v[48:51], v10, s[4:7], s90 offen offset:2048 sc1
    v_add_f32 v20, v20, v160
    v_add_f32 v20, v20, v161
    v_add_f32 v20, v20, v156
    v_add_f32 v20, v20, v157
    buffer_load_dwordx4 v[52:55], v10, s[4:7], s90 offen offset:3072 sc1
    v_add_f32 v20, v20, v158
    v_add_f32 v20, v20, v159
    v_mov_b32 v19, v20
    s_nop 1
    v_permlane16_swap_b32 v20, v19
    s_add_u32 s90, s41, 8192
    v_add_f32 v20, v20, v19
    v_mov_b32 v19, v20
    s_nop 1
    v_permlane32_swap_b32 v20, v19
    v_add_f32 v20, v20, v19
    buffer_load_dwordx4 v[56:59], v10, s[4:7], s90 offen offset:0 sc1
    v_rcp_f32 v20, v20
    s_nop 0
    v_mul_f32 v152, v152, v20
    v_mul_f32 v153, v153, v20
    v_mul_f32 v154, v154, v20
    buffer_load_dwordx4 v[60:63], v10, s[4:7], s90 offen offset:1024 sc1
    v_mul_f32 v155, v155, v20
    v_mul_f32 v160, v160, v20
    v_mul_f32 v161, v161, v20
    v_mul_f32 v156, v156, v20
    buffer_load_dwordx4 v[64:67], v10, s[4:7], s90 offen offset:2048 sc1
    v_mul_f32 v157, v157, v20
    v_mul_f32 v158, v158, v20
    v_mul_f32 v159, v159, v20
    v_cvt_pk_bf16_f32 v168, v152, v153
    buffer_load_dwordx4 v[68:71], v10, s[4:7], s90 offen offset:3072 sc1
    v_cvt_pk_bf16_f32 v169, v154, v155
    v_cvt_pk_bf16_f32 v170, v160, v161
    v_cvt_pk_bf16_f32 v172, v156, v157
    v_cvt_pk_bf16_f32 v173, v158, v159
    buffer_store_dwordx4 v[164:167], v12, s[4:7], s43 offen offset:0 sc1
    buffer_store_dwordx4 v[168:171], v12, s[4:7], s43 offen offset:1024 sc1
    buffer_store_dwordx4 v[172:175], v12, s[4:7], s43 offen offset:2048 sc1
    s_waitcnt vmcnt(0)
    buffer_store_dword v17, v15, s[4:7], s38 offen sc1
    s_add_u32 s37, s37, 1
    s_branch L_px_loop_s
L_pxl_122:
    v_max_f32 v18, v144, v145
    v_max3_f32 v18, v18, v146, v147
    v_max3_f32 v18, v18, v148, v149
    v_mov_b32 v19, v18
    s_nop 1
    v_permlane16_swap_b32 v18, v19
    v_max_f32 v18, v18, v19
    v_mov_b32 v19, v18
    s_nop 1
    v_permlane32_swap_b32 v18, v19
    v_max_f32 v18, v18, v19
    v_sub_f32 v144, v144, v18
    v_sub_f32 v145, v145, v18
    v_sub_f32 v146, v146, v18
    v_sub_f32 v147, v147, v18
    v_sub_f32 v148, v148, v18
    v_sub_f32 v149, v149, v18
    v_mul_f32 v144, s44, v144
    v_mul_f32 v145, s44, v145
    v_mul_f32 v146, s44, v146
    v_mul_f32 v147, s44, v147
    v_mul_f32 v148, s44, v148
    v_mul_f32 v149, s44, v149
    v_exp_f32 v144, v144
    v_exp_f32 v145, v145
    v_exp_f32 v146, v146
    v_exp_f32 v147, v147
    v_exp_f32 v148, v148
    v_exp_f32 v149, v149
    v_add_f32 v20, v144, v145
    v_add_f32 v20, v20, v146
    v_add_f32 v20, v20, v147
    v_add_f32 v20, v20, v148
    v_add_f32 v20, v20, v149
    v_mov_b32 v19, v20
    s_nop 1
    v_permlane16_swap_b32 v20, v19
    v_add_f32 v20, v20, v19
    v_mov_b32 v19, v20
    s_nop 1
    v_permlane32_swap_b32 v20, v19
    v_add_f32 v20, v20, v19
    v_rcp_f32 v20, v20
    s_nop 0
    v_mul_f32 v144, v144, v20
    v_mul_f32 v145, v145, v20
    v_mul_f32 v146, v146, v20
    v_mul_f32 v147, v147, v20
    v_mul_f32 v148, v148, v20
    v_mul_f32 v149, v149, v20
    v_cvt_pk_bf16_f32 v164, v144, v145
    v_cvt_pk_bf16_f32 v165, v146, v147
    v_cvt_pk_bf16_f32 v166, v148, v149
    v_max_f32 v18, v152, v153
    v_max3_f32 v18, v18, v154, v155
    v_max3_f32 v18, v18, v160, v161
    v_max3_f32 v18, v18, v156, v157
    v_max3_f32 v18, v18, v158, v159
    v_mov_b32 v19, v18
    s_nop 1
    v_permlane16_swap_b32 v18, v19
    v_max_f32 v18, v18, v19
    v_mov_b32 v19, v18
    s_nop 1
    v_permlane32_swap_b32 v18, v19
    v_max_f32 v18, v18, v19
    v_sub_f32 v152, v152, v18
    v_sub_f32 v153, v153, v18
    v_sub_f32 v154, v154, v18
    v_sub_f32 v155, v155, v18
    v_sub_f32 v160, v160, v18
    v_sub_f32 v161, v161, v18
    v_sub_f32 v156, v156, v18
    v_sub_f32 v157, v157, v18
    v_sub_f32 v158, v158, v18
    v_sub_f32 v159, v159, v18
    v_mul_f32 v152, s44, v152
    v_mul_f32 v153, s44, v153
    v_mul_f32 v154, s44, v154
    v_mul_f32 v155, s44, v155
    v_mul_f32 v160, s44, v160
    v_mul_f32 v161, s44, v161
    v_mul_f32 v156, s44, v156
    v_mul_f32 v157, s44, v157
    v_mul_f32 v158, s44, v158
    v_mul_f32 v159, s44, v159
    v_exp_f32 v152, v152
    v_exp_f32 v153, v153
    v_exp_f32 v154, v154
    v_exp_f32 v155, v155
    v_exp_f32 v160, v160
    v_exp_f32 v161, v161
    v_exp_f32 v156, v156
    v_exp_f32 v157, v157
    v_exp_f32 v158, v158
    v_exp_f32 v159, v159
    v_add_f32 v20, v152, v153
    v_add_f32 v20, v20, v154
    v_add_f32 v20, v20, v155
    v_add_f32 v20, v20, v160
    v_add_f32 v20, v20, v161
    v_add_f32 v20, v20, v156
    v_add_f32 v20, v20, v157
    v_add_f32 v20, v20, v158
    v_add_f32 v20, v20, v159
    v_mov_b32 v19, v20
    s_nop 1
    v_permlane16_swap_b32 v20, v19
    v_add_f32 v20, v20, v19
    v_mov_b32 v19, v20
    s_nop 1
    v_permlane32_swap_b32 v20, v19
    v_add_f32 v20, v20, v19
    v_rcp_f32 v20, v20
    s_nop 0
    v_mul_f32 v152, v152, v20
    v_mul_f32 v153, v153, v20
    v_mul_f32 v154, v154, v20
    v_mul_f32 v155, v155, v20
    v_mul_f32 v160, v160, v20
    v_mul_f32 v161, v161, v20
    v_mul_f32 v156, v156, v20
    v_mul_f32 v157, v157, v20
    v_mul_f32 v158, v158, v20
    v_mul_f32 v159, v159, v20
    v_cvt_pk_bf16_f32 v168, v152, v153
    v_cvt_pk_bf16_f32 v169, v154, v155
    v_cvt_pk_bf16_f32 v170, v160, v161
    v_cvt_pk_bf16_f32 v172, v156, v157
    v_cvt_pk_bf16_f32 v173, v158, v159
    buffer_store_dwordx4 v[164:167], v12, s[4:7], s43 offen offset:0 sc1
    buffer_store_dwordx4 v[168:171], v12, s[4:7], s43 offen offset:1024 sc1
    buffer_store_dwordx4 v[172:175], v12, s[4:7], s43 offen offset:2048 sc1
    s_waitcnt vmcnt(0)
    buffer_store_dword v17, v15, s[4:7], s38 offen sc1
    s_endpgm
L_pa_s:
    v_mov_b32 v1, 196
L_gw_123:
    buffer_load_dword v2, v1, s[8:11], 0 offen sc1
    s_sub_u32 s36, s36, 1
    s_cbranch_scc1 L_exit
    s_waitcnt vmcnt(0)
L_gw_123c:
    v_readfirstlane_b32 s90, v2
    s_nop 0
    s_cmp_eq_u32 s90, 0
    s_cbranch_scc1 L_gw_123
    s_branch L_pa_body
.section .rodata,"a"
.p2align 6
.amdhsa_kernel concat_heads__sliding_local_dilated__memory_aug_recurrent_mem_tr__prompt_kernel
  .amdhsa_next_free_vgpr 512
  .amdhsa_next_free_sgpr 102
  .amdhsa_accum_offset 256
  .amdhsa_group_segment_fixed_size 0
  .amdhsa_kernarg_size 104
  .amdhsa_user_sgpr_count 2
  .amdhsa_user_sgpr_kernarg_segment_ptr 1
  .amdhsa_system_sgpr_workgroup_id_x 1
  .amdhsa_float_denorm_mode_32 3
.end_amdhsa_kernel
```
